```python
import torch

def _softmax(x, axis=-1):
    return torch.softmax(x, dim=axis)

def _gelu(x):
    return torch.nn.functional.gelu(x, approximate='tanh')

def _silu(x):
    return torch.nn.functional.silu(x)

def _sigmoid(x):
    return torch.sigmoid(x)

def _layernorm(x, axis=-1, eps=1e-05):
    m = x.mean(dim=axis, keepdim=True)
    v = x.var(dim=axis, keepdim=True, unbiased=False)
    return (x - m) / torch.sqrt(v + eps)

def _scatter_add(tgt, idx, src, axis=0):
    return tgt.clone().index_add_(axis, idx, src)

def _segment_sum(src, seg, n):
    out = torch.zeros((n,) + src.shape[1:], dtype=src.dtype)
    return out.index_add_(0, seg, src)

def _pad(x, pw):
    flat = tuple((v for pair in reversed(pw) for v in pair))
    return torch.nn.functional.pad(x, flat)
kernel_name = 'adaLN_cond__linear_kernel_hedgehog__moe_arch_mod__prompt'

def setup_inputs():

    _w = lambda a: (lambda t: t.to(torch.bfloat16) if t.is_floating_point() else t)(torch.as_tensor(a))

    def _A_setup():
        B, S, D, H = (1, 2048, 1024, 32)
        Dh = D // H
        return {'x': _w((lambda *s: torch.randn(*s, dtype=torch.bfloat16) * 0.05)(B, S, D)), 'wqkv': _w((lambda *s: torch.randn(*s, dtype=torch.bfloat16) * 0.4)(D, 3 * D)), 'w_phi': _w((lambda *s: torch.randn(*s, dtype=torch.bfloat16) * 0.4)(H, Dh, Dh) * Dh ** (-0.5)), 'wo': _w((lambda *s: torch.randn(*s, dtype=torch.bfloat16) * 0.05)(D, D))}
    _A_in = _A_setup()

    def _B_setup():
        B, S, D, F, C = (1, 2048, 1024, 3584, 2)
        return {'x': _w((lambda *s: torch.randn(*s, dtype=torch.bfloat16) * 0.05)(B, S, D)), 'w_r': _w((lambda *s: torch.randn(*s, dtype=torch.bfloat16) * 0.1)(D)), 'w_gate': _w((lambda *s: torch.randn(*s, dtype=torch.bfloat16) * 0.05)(D, F)), 'w_up': _w((lambda *s: torch.randn(*s, dtype=torch.bfloat16) * 0.05)(D, F)), 'w_down': _w((lambda *s: torch.randn(*s, dtype=torch.bfloat16) * 0.05)(F, D))}
    _B_in = _B_setup()
    return {'A_x': _A_in['x'], 'A_wqkv': _A_in['wqkv'], 'A_w_phi': _A_in['w_phi'], 'A_wo': _A_in['wo'], 'B_x': _B_in['x'], 'B_w_r': _B_in['w_r'], 'B_w_gate': _B_in['w_gate'], 'B_w_up': _B_in['w_up'], 'B_w_down': _B_in['w_down'], 'c': _w((lambda *s: torch.randn(*s, dtype=torch.bfloat16) * 0.2)(1, 1024) * 8.0), 'w_mod': _w((lambda *s: torch.randn(*s, dtype=torch.bfloat16) * 0.2)(1024, 6 * 1024) * 1024 ** (-0.5) * 8.0)}

def reference(A_x, A_wqkv, A_w_phi, A_wo, B_x, B_w_r, B_w_gate, B_w_up, B_w_down, c, w_mod):

    def _A_ref(x, wqkv, w_phi, wo):
        B, S, D = x.shape
        H = 32
        Dh = D // H
        qkv = (lambda x, *d: x.permute(*d))((x @ wqkv).reshape(B, S, 3, H, Dh), 2, 0, 3, 1, 4)
        q, k, v = (qkv[0], qkv[1], qkv[2])
        pq = torch.einsum('bhsd,hdf->bhsf', q, w_phi)
        pk = torch.einsum('bhsd,hdf->bhsf', k, w_phi)
        phi_q = torch.concatenate([_softmax(pq, axis=-1), _softmax(-pq, axis=-1)], axis=-1)
        phi_k = torch.concatenate([_softmax(pk, axis=-1), _softmax(-pk, axis=-1)], axis=-1)
        kv = torch.einsum('bhsf,bhsd->bhfd', phi_k, v)
        z = torch.einsum('bhsf->bhf', phi_k)
        num = torch.einsum('bhqf,bhfd->bhqd', phi_q, kv)
        den = torch.einsum('bhqf,bhf->bhq', phi_q, z)[..., None] + 1e-06
        o = num / den
        return (lambda x, *d: x.permute(*d))(o, 0, 2, 1, 3).reshape(B, S, D) @ wo

    def _B_ref(x, w_r, w_gate, w_up, w_down):
        B, S, D = x.shape
        C = 2
        r = x @ w_r
        idx = torch.argsort(-r, axis=-1)[:, :C]
        idx_e = (lambda x, n, axis: torch.repeat_interleave(x, n, dim=axis))(idx.reshape(B, C, 1), D, axis=2)
        x_sel = (lambda x, i, axis: torch.take_along_dim(x, i, dim=axis))(x, idx_e, axis=1)
        g = _silu(x_sel @ w_gate)
        u = x_sel @ w_up
        y = g * u @ w_down
        r_sel = _sigmoid((lambda x, i, axis: torch.take_along_dim(x, i, dim=axis))(r, idx, axis=1))
        y = y * r_sel.reshape(B, C, 1)
        b_off = (torch.arange(B) * S).reshape(B, 1)
        flat_idx = (idx + b_off).reshape(B * C)
        zero = (x * 0.0).reshape(B * S, D)
        upd = _scatter_add(zero, flat_idx, y.reshape(B * C, D), axis=0)
        return x + upd.reshape(B, S, D)
    x = A_x
    mod = (_silu(c) @ w_mod).reshape(c.shape[0], 6, 1, -1)
    sa, ca, ga, sb, cb, gb = (mod[:, 0].clone(), mod[:, 1].clone(), mod[:, 2].clone(), mod[:, 3].clone(), mod[:, 4].clone(), mod[:, 5].clone())
    h = _layernorm(x, axis=-1) * (1 + ca) + sa
    x = x + ga * _A_ref(h, A_wqkv, A_w_phi, A_wo)
    h = _layernorm(x, axis=-1) * (1 + cb) + sb
    x = x + gb * _B_ref(h, B_w_r, B_w_gate, B_w_up, B_w_down)
    return x
```

```asm
; @launch grid=(256,1,1) block=(512,1,1) lds=163840
.amdgcn_target "amdgcn-amd-amdhsa--gfx950"
.text
.globl adaLN_cond__linear_kernel_hedgehog__moe_arch_mod__prompt_kernel
.p2align 8
.type adaLN_cond__linear_kernel_hedgehog__moe_arch_mod__prompt_kernel,@function
adaLN_cond__linear_kernel_hedgehog__moe_arch_mod__prompt_kernel:
    s_load_dwordx16 s[68:83], s[0:1], 0
    s_load_dwordx8 s[84:91], s[0:1], 64
    s_load_dwordx2 s[32:33], s[0:1], 104
    s_cmp_ge_u32 s2, 256
    s_cbranch_scc1 L_END
    v_lshrrev_b32 v4, 6, v0
    v_and_b32 v1, 63, v0
    v_mov_b32 v3, 0
    v_readfirstlane_b32 s3, v4
    v_lshlrev_b32 v2, 4, v1
    s_mov_b32 s38, 4194304
    s_mov_b32 s39, 0x20000
    s_mov_b32 s50, 12582912
    s_mov_b32 s51, 0x20000
    s_mov_b32 s34, 268435456
    s_mov_b32 s35, 0x20000
    s_mov_b32 s42, 6291456
    s_mov_b32 s43, 0x20000
    s_mov_b32 s46, 2097152
    s_mov_b32 s47, 0x20000
    s_mov_b32 s54, 7340032
    s_mov_b32 s55, 0x20000
    s_mov_b32 s58, 7340032
    s_mov_b32 s59, 0x20000
    s_mov_b32 s62, 7340032
    s_mov_b32 s63, 0x20000
    s_mov_b32 s66, 4194304
    s_mov_b32 s67, 0x20000
    s_mov_b32 s5, 0
    s_mov_b32 s6, 0xffff0000
    s_mov_b32 s7, 0x3fb8aa3b
    s_and_b32 s8, s2, 7
    s_lshr_b32 s9, s2, 3
    s_lshl_b32 s96, s8, 5
    s_add_u32 s97, s96, s9
    s_lshl3_add_u32 s93, s97, s3
    s_and_b32 s96, s8, 4
    s_lshr_b32 s97, s9, 2
    s_lshl1_add_u32 s10, s96, s97
    s_and_b32 s96, s8, 3
    s_and_b32 s97, s9, 3
    s_xor_b32 s98, s97, 2
    s_lshl2_add_u32 s11, s96, s98
    s_and_b32 s96, s8, 1
    s_and_b32 s97, s9, 7
    s_lshl3_add_u32 s12, s96, s97
    s_lshr_b32 s96, s8, 1
    s_lshr_b32 s97, s9, 3
    s_lshl2_add_u32 s21, s96, s97
    s_and_b32 s96, s3, 3
    s_lshl2_add_u32 s94, s21, s96
    s_lshr_b32 s96, s3, 2
    s_lshl1_add_u32 s95, s12, s96
    s_lshl_b32 s96, s2, 6
    s_add_u32 s97, s96, s3
    s_lshl_b32 s98, s97, 6
    s_add_u32 s92, s98, 1048576
    s_lshl_b32 s16, s93, 11
    s_lshl3_add_u32 s96, s8, s3
    s_lshl_b32 s15, s96, 5
    s_mul_i32 s96, s15, 6144
    s_xor_b32 s97, s9, 1
    s_lshl_b32 s98, s97, 7
    s_add_u32 s13, s96, s98
    s_add_u32 s14, s13, 98304
    s_lshl_b32 s96, s94, 16
    s_lshl_b32 s97, s95, 6
    s_add_u32 s18, s96, s97
    s_lshr_b32 s96, s8, 1
    s_lshl4_add_u32 s97, s96, s12
    s_lshl4_add_u32 s98, s97, s3
    s_lshl_b32 s99, s98, 9
    s_add_u32 s17, s99, 524288
    v_lshrrev_b32 v60, 3, v1
    v_mul_u32_u24 v60, 12288, v60
    v_and_b32 v9, 7, v1
    v_lshl_add_u32 v60, v9, 4, v60
    v_lshrrev_b32 v61, 3, v1
    v_lshl_add_u32 v61, v61, 1, s15
    v_and_b32 v10, 31, v1
    v_lshlrev_b32 v10, 11, v10
    v_lshrrev_b32 v9, 5, v1
    v_lshl_add_u32 v10, v9, 5, v10
    s_waitcnt lgkmcnt(0)
    s_mov_b64 s[36:37], s[68:69]
    buffer_load_dwordx4 v[88:91], v2, s[36:39], s16 offen
    buffer_load_dwordx4 v[92:95], v2, s[36:39], s16 offen offset:1024
    s_load_dword s4, s[32:33], 0
    s_mov_b64 s[48:49], s[88:89]
    s_load_dword s24, s[32:33], s92 offset:0 glc
    s_load_dword s25, s[32:33], s17 offset:508 glc
    s_load_dword s26, s[32:33], s17 offset:4604 glc
    global_load_ushort v78, v61, s[86:87]
    global_load_ushort v79, v61, s[86:87] offset:16
    s_barrier
    buffer_load_dwordx4 v[80:83], v60, s[48:51], s13 offen nt
    buffer_load_dwordx4 v[84:87], v60, s[48:51], s14 offen nt
    s_mov_b64 s[40:41], s[70:71]
    s_mov_b64 s[44:45], s[74:75]
    s_mov_b64 s[52:53], s[80:81]
    s_mov_b64 s[56:57], s[82:83]
    s_mov_b64 s[60:61], s[84:85]
    s_mov_b64 s[64:65], s[90:91]
    s_getpc_b64 s[22:23]
    s_and_b32 s22, s22, 0xfffffc00
    s_lshl3_add_u32 s96, s9, s3
    s_lshl_b32 s19, s96, 7
    v_lshrrev_b32 v4, 5, v1
    v_lshl_add_u32 v4, v4, 15, s19
    v_min_u32 v4, 36864, v4
    global_load_dword v11, v4, s[22:23]
    s_lshr_b32 s76, s3, 2
    s_lshr_b32 s96, s3, 2
    s_lshr_b32 s97, s9, 4
    s_xor_b32 s77, s96, s97
    s_lshr_b32 s96, s9, 3
    s_xor_b32 s97, s96, s9
    s_and_b32 s98, s97, 1
    s_lshl_b32 s83, s98, 3
    s_mul_i32 s96, s8, 7
    s_lshr_b32 s97, s9, 2
    s_add_u32 s74, s96, s97
    s_and_b32 s75, s9, 3
    s_and_b32 s85, s9, 12
    v_bfe_u32 v6, v1, 4, 1
    v_lshlrev_b32 v6, 6, v6
    v_and_b32 v62, 7, v1
    v_lshlrev_b32 v62, 4, v62
    v_xor_b32 v62, v62, v6
    v_lshrrev_b32 v6, 3, v1
    v_mul_u32_u24 v6, 6144, v6
    v_add_u32 v62, v62, v6
    v_lshlrev_b32 v63, 3, v1
    v_lshlrev_b32 v64, 5, v1
    v_add_u32 v64, 147456, v64
    s_lshl2_add_u32 s13, s3, 147456
    v_lshrrev_b32 v65, 4, v1
    v_lshl_add_u32 v65, v65, 6, s13
    v_and_b32 v9, 7, v1
    v_lshl_add_u32 v65, v9, 8, v65
    v_bfe_u32 v9, v1, 3, 1
    v_lshl_add_u32 v65, v9, 5, v65
    s_waitcnt vmcnt(5)
    v_mov_b32 v8, 0x3f803f80
    v_dot2_f32_bf16 v4, v88, v8, 0
    v_dot2_f32_bf16 v5, v88, v88, 0
    v_dot2_f32_bf16 v6, v89, v8, 0
    v_dot2_f32_bf16 v7, v89, v89, 0
    v_dot2_f32_bf16 v4, v90, v8, v4
    v_dot2_f32_bf16 v5, v90, v90, v5
    v_dot2_f32_bf16 v6, v91, v8, v6
    v_dot2_f32_bf16 v7, v91, v91, v7
    v_dot2_f32_bf16 v4, v92, v8, v4
    v_dot2_f32_bf16 v5, v92, v92, v5
    v_dot2_f32_bf16 v6, v93, v8, v6
    v_dot2_f32_bf16 v7, v93, v93, v7
    v_dot2_f32_bf16 v4, v94, v8, v4
    v_dot2_f32_bf16 v5, v94, v94, v5
    v_dot2_f32_bf16 v6, v95, v8, v6
    v_dot2_f32_bf16 v7, v95, v95, v7
    s_nop 2
    v_pk_add_f32 v[4:5], v[4:5], v[6:7]
    s_nop 1
    v_add_f32_dpp v4, v4, v4 quad_perm:[1,0,3,2] row_mask:0xf bank_mask:0xf
    v_add_f32_dpp v5, v5, v5 quad_perm:[1,0,3,2] row_mask:0xf bank_mask:0xf
    s_nop 0
    v_add_f32_dpp v4, v4, v4 quad_perm:[2,3,0,1] row_mask:0xf bank_mask:0xf
    v_add_f32_dpp v5, v5, v5 quad_perm:[2,3,0,1] row_mask:0xf bank_mask:0xf
    s_nop 0
    v_add_f32_dpp v4, v4, v4 row_half_mirror row_mask:0xf bank_mask:0xf
    v_add_f32_dpp v5, v5, v5 row_half_mirror row_mask:0xf bank_mask:0xf
    s_nop 0
    v_add_f32_dpp v4, v4, v4 row_ror:8 row_mask:0xf bank_mask:0xf
    v_add_f32_dpp v5, v5, v5 row_ror:8 row_mask:0xf bank_mask:0xf
    s_nop 1
    v_permlane16_swap_b32 v4, v5
    v_add_f32 v8, v4, v5
    v_add_f32 v4, v4, v5
    s_nop 1
    v_permlane32_swap_b32 v4, v8
    v_add_f32 v4, v4, v8
    v_mul_f32 v8, 0x3a800000, v4
    v_mul_f32 v4, 0x3a800000, v4
    s_nop 1
    v_permlane16_swap_b32 v4, v8
    v_fma_f32 v113, -v4, v4, v8
    v_cvt_pk_bf16_f32 v112, 0, v4
    v_max_f32 v113, 0, v113
    v_cvt_pk_bf16_f32 v113, 0, v113
    v_add_f32 v113, 0x3727c5ac, v113
    v_cvt_pk_bf16_f32 v113, 0, v113
    v_sqrt_f32 v113, v113
    s_nop 0
    v_cvt_pk_bf16_f32 v113, 0, v113
    s_lshl3_add_u32 s13, s3, 153600
    s_waitcnt lgkmcnt(0)
    s_mul_i32 s4, s4, 0x9e3779b1
    s_add_u32 s4, s4, 0x7f4a7c15
    v_lshrrev_b32 v112, 16, v112
    v_or_b32 v112, v112, v113
    v_mov_b32 v113, s4
    v_mov_b32 v4, s13
    ds_write_b64 v4, v[112:113]
    v_and_b32 v5, 3, v1
    v_lshlrev_b32 v5, 4, v5
    v_add_u32 v5, 153600, v5
    v_and_b32 v4, 3, v1
    v_lshlrev_b32 v4, 4, v4
    v_bfe_u32 v9, v1, 2, 1
    v_lshl_add_u32 v4, v9, 10, v4
    s_and_b32 s96, s8, 6
    s_and_b32 s97, s8, 1
    s_lshr_b32 s98, s9, 4
    s_lshl1_add_u32 s99, s97, s98
    s_lshl_b32 s97, s99, 6
    s_add_u32 s98, s96, s97
    s_lshl3_add_u32 s99, s3, s98
    s_lshl_b32 s96, s99, 10
    s_and_b32 s97, s9, 15
    s_lshl_b32 s98, s97, 6
    s_add_u32 s99, s96, s98
    s_add_u32 s13, s99, 262144
    s_waitcnt lgkmcnt(0)
    s_barrier
    ds_read_b128 v[112:115], v5
    s_waitcnt lgkmcnt(0)
    s_mov_b64 exec, 0xff
    buffer_store_dwordx4 v[112:115], v4, s[32:35], s13 offen sc1
    s_mov_b64 exec, -1
    buffer_load_dwordx4 v[12:15], v10, s[36:39], s18 offen
    buffer_load_dwordx4 v[16:19], v10, s[36:39], s18 offen offset:16
    s_lshl_b32 s96, s11, 12
    s_lshl_b32 s97, s3, 9
    s_add_u32 s13, s96, s97
    v_add_u32 v4, s13, v2
    s_lshl_b32 s96, s3, 9
    s_add_u32 m0, s96, 159744
    s_mov_b32 exec_hi, 0
    global_load_lds_dwordx4 v4, s[72:73]
    s_mov_b32 exec_hi, -1
    s_lshr_b32 s96, s9, 4
    s_lshl_b32 s20, s96, 1
    s_add_u32 s96, s20, s85
    s_and_b32 s97, s96, 15
    s_lshl3_add_u32 s98, s97, s3
    s_mul_i32 s99, s98, 49152
    s_lshl_b32 s96, s11, 7
    s_add_u32 s82, s99, s96
    s_mul_i32 s96, s20, 24576
    s_lshl_b32 s97, s3, 10
    s_add_u32 s20, s96, s97
    s_mov_b32 m0, s20
    s_nop 0
    buffer_load_dwordx4 v62, s[40:43], s82 offen lds
    s_add_u32 s82, s82, 2048
    s_add_u32 m0, s20, 8192
    s_nop 0
    buffer_load_dwordx4 v62, s[40:43], s82 offen lds
    s_add_u32 s82, s82, 2048
    s_waitcnt vmcnt(9)
    v_lshlrev_b32 v78, 16, v78
    v_mul_f32 v4, s7, v78
    v_exp_f32 v4, -v4
    s_nop 0
    v_add_f32 v4, 1.0, v4
    v_rcp_f32 v4, v4
    s_nop 0
    v_mul_f32 v78, v78, v4
    v_cvt_pk_bf16_f32 v78, 0, v78
    v_lshlrev_b32 v79, 16, v79
    v_mul_f32 v5, s7, v79
    v_exp_f32 v5, -v5
    s_nop 0
    v_add_f32 v5, 1.0, v5
    v_rcp_f32 v5, v5
    s_nop 0
    v_mul_f32 v79, v79, v5
    v_cvt_pk_bf16_f32 v79, 0, v79
    s_lshr_b32 s96, s3, 1
    s_xor_b32 s97, s9, 1
    s_and_b32 s98, s97, 15
    s_lshl4_add_u32 s99, s96, s98
    s_lshr_b32 s97, s9, 4
    s_lshl1_add_u32 s96, s99, s97
    s_lshl3_add_u32 s98, s96, s8
    s_lshl_b32 s99, s98, 9
    s_add_u32 s13, s99, 524288
    s_and_b32 s96, s3, 3
    s_lshl2_add_u32 s97, s2, s96
    s_lshl_b32 s98, s97, 8
    s_add_u32 s14, s98, 262144
    v_and_b32 v8, 31, v1
    v_lshlrev_b32 v8, 3, v8
    s_waitcnt vmcnt(7)
    v_lshlrev_b32 v4, 16, v80
    v_and_b32 v5, s6, v80
    v_pk_mul_f32 v[20:21], v[4:5], v[78:79] op_sel:[0,0] op_sel_hi:[1,0]
    v_lshlrev_b32 v6, 16, v81
    v_and_b32 v7, s6, v81
    v_pk_mul_f32 v[22:23], v[6:7], v[78:79] op_sel:[0,0] op_sel_hi:[1,0]
    v_lshlrev_b32 v4, 16, v82
    v_and_b32 v5, s6, v82
    v_pk_mul_f32 v[24:25], v[4:5], v[78:79] op_sel:[0,0] op_sel_hi:[1,0]
    v_lshlrev_b32 v6, 16, v83
    v_and_b32 v7, s6, v83
    v_pk_mul_f32 v[26:27], v[6:7], v[78:79] op_sel:[0,0] op_sel_hi:[1,0]
    v_lshlrev_b32 v4, 16, v84
    v_and_b32 v5, s6, v84
    v_pk_fma_f32 v[20:21], v[4:5], v[78:79], v[20:21] op_sel:[0,1,0] op_sel_hi:[1,1,1]
    v_lshlrev_b32 v6, 16, v85
    v_and_b32 v7, s6, v85
    v_pk_fma_f32 v[22:23], v[6:7], v[78:79], v[22:23] op_sel:[0,1,0] op_sel_hi:[1,1,1]
    v_lshlrev_b32 v4, 16, v86
    v_and_b32 v5, s6, v86
    v_pk_fma_f32 v[24:25], v[4:5], v[78:79], v[24:25] op_sel:[0,1,0] op_sel_hi:[1,1,1]
    v_lshlrev_b32 v6, 16, v87
    v_and_b32 v7, s6, v87
    v_pk_fma_f32 v[26:27], v[6:7], v[78:79], v[26:27] op_sel:[0,1,0] op_sel_hi:[1,1,1]
    v_permlane32_swap_b32 v20, v24
    v_permlane32_swap_b32 v21, v25
    v_permlane32_swap_b32 v22, v26
    v_permlane32_swap_b32 v23, v27
    v_add_f32 v20, v20, v24
    v_add_f32 v21, v21, v25
    v_add_f32 v22, v22, v26
    v_add_f32 v23, v23, v27
    s_nop 0
    v_permlane16_swap_b32 v20, v22
    v_permlane16_swap_b32 v21, v23
    v_add_f32 v20, v20, v22
    v_add_f32 v21, v21, v23
    s_nop 0
    v_add_f32_dpp v20, v20, v20 row_ror:8 row_mask:0xf bank_mask:0xf
    v_add_f32_dpp v21, v21, v21 row_ror:8 row_mask:0xf bank_mask:0xf
    s_nop 1
    v_mov_b32_dpp v20, v21 quad_perm:[0,1,2,3] row_mask:0xf bank_mask:0xc
    ds_write_b32 v65, v20
    s_waitcnt lgkmcnt(0)
    s_barrier
    buffer_load_dwordx2 v[112:113], v8, s[32:35], s14 offen sc1
    ds_read_b128 v[20:23], v64 offset:0
    ds_read_b128 v[24:27], v64 offset:16
    s_waitcnt lgkmcnt(0)
    v_pk_add_f32 v[20:21], v[20:21], v[22:23]
    v_pk_add_f32 v[24:25], v[24:25], v[26:27]
    v_pk_add_f32 v[20:21], v[20:21], v[24:25]
    v_add_f32 v20, v20, v21
    v_mov_b32 v21, s4
    s_bitcmp1_b32 s3, 0
    s_cselect_b32 exec_lo, 0, -1
    s_cselect_b32 exec_hi, -1, 0
    buffer_store_dwordx2 v[20:21], v63, s[32:35], s13 offen sc1
    s_mov_b64 exec, -1
    s_add_u32 m0, s20, 16384
    s_nop 0
    buffer_load_dwordx4 v62, s[40:43], s82 offen lds
    s_waitcnt vmcnt(2)
    v_cmp_ne_u32 vcc, s4, v113
    s_cbranch_vccz TOK_2
SPOLL_3:
    s_load_dword s24, s[32:33], s14 offset:60 glc
    s_load_dword s25, s[32:33], s14 offset:124 glc
    s_load_dword s26, s[32:33], s14 offset:188 glc
    s_load_dword s27, s[32:33], s14 offset:252 glc
SCHK_4:
    s_add_u32 s5, s5, 1
    s_cmp_ge_u32 s5, 200000
    s_waitcnt lgkmcnt(0)
    s_cbranch_scc1 SDONE_5
    s_cmp_lg_u32 s24, s4
    s_cbranch_scc1 SPOLL_3
    s_cmp_lg_u32 s25, s4
    s_cbranch_scc1 SPOLL_3
    s_cmp_lg_u32 s26, s4
    s_cbranch_scc1 SPOLL_3
    s_cmp_lg_u32 s27, s4
    s_cbranch_scc1 SPOLL_3
SDONE_5:
POLL_6:
    buffer_load_dwordx2 v[112:113], v8, s[32:35], s14 offen sc1
    s_waitcnt vmcnt(0)
    v_cmp_ne_u32 vcc, s4, v113
    s_cbranch_vccz PDONE_7
    s_add_u32 s5, s5, 1
    s_cmp_lt_u32 s5, 200000
    s_cbranch_scc1 POLL_6
PDONE_7:
TOK_2:
    v_and_b32 v4, 31, v1
    v_lshlrev_b32 v4, 4, v4
    v_lshrrev_b32 v9, 5, v1
    v_lshl_add_u32 v4, v9, 12, v4
    s_mov_b32 s13, s17
    s_lshl2_add_u32 s14, s3, 155648
    v_lshl_add_u32 v5, v1, 6, s14
    s_lshl_b32 s96, s76, 10
    s_add_u32 s14, s96, 155648
    v_and_b32 v6, 15, v1
    v_lshl_add_u32 v6, v6, 5, s14
    v_lshrrev_b32 v9, 5, v1
    v_lshl_add_u32 v6, v9, 9, v6
    s_load_dword s24, s[32:33], s13 offset:508 glc
    s_load_dword s25, s[32:33], s13 offset:4604 glc
    v_lshlrev_b32 v113, 16, v112
    v_and_b32 v112, s6, v112
    v_rcp_f32 v112, v112
    v_lshlrev_b32 v96, 16, v12
    v_and_b32 v97, s6, v12
    v_lshlrev_b32 v98, 16, v13
    v_and_b32 v99, s6, v13
    v_lshlrev_b32 v100, 16, v14
    v_and_b32 v101, s6, v14
    v_lshlrev_b32 v102, 16, v15
    v_and_b32 v103, s6, v15
    v_lshlrev_b32 v104, 16, v16
    v_and_b32 v105, s6, v16
    v_lshlrev_b32 v106, 16, v17
    v_and_b32 v107, s6, v17
    v_lshlrev_b32 v108, 16, v18
    v_and_b32 v109, s6, v18
    v_lshlrev_b32 v110, 16, v19
    v_and_b32 v111, s6, v19
    v_pk_add_f32 v[96:97], v[96:97], v[112:113] op_sel:[0,1] neg_lo:[0,1] neg_hi:[0,1]
    v_pk_add_f32 v[98:99], v[98:99], v[112:113] op_sel:[0,1] neg_lo:[0,1] neg_hi:[0,1]
    v_pk_add_f32 v[100:101], v[100:101], v[112:113] op_sel:[0,1] neg_lo:[0,1] neg_hi:[0,1]
    v_pk_add_f32 v[102:103], v[102:103], v[112:113] op_sel:[0,1] neg_lo:[0,1] neg_hi:[0,1]
    v_pk_add_f32 v[104:105], v[104:105], v[112:113] op_sel:[0,1] neg_lo:[0,1] neg_hi:[0,1]
    v_pk_add_f32 v[106:107], v[106:107], v[112:113] op_sel:[0,1] neg_lo:[0,1] neg_hi:[0,1]
    v_pk_add_f32 v[108:109], v[108:109], v[112:113] op_sel:[0,1] neg_lo:[0,1] neg_hi:[0,1]
    v_pk_add_f32 v[110:111], v[110:111], v[112:113] op_sel:[0,1] neg_lo:[0,1] neg_hi:[0,1]
    v_cvt_pk_bf16_f32 v96, 0, v96
    v_cvt_pk_bf16_f32 v97, 0, v97
    v_cvt_pk_bf16_f32 v98, 0, v98
    v_cvt_pk_bf16_f32 v99, 0, v99
    v_cvt_pk_bf16_f32 v100, 0, v100
    v_cvt_pk_bf16_f32 v101, 0, v101
    v_cvt_pk_bf16_f32 v102, 0, v102
    v_cvt_pk_bf16_f32 v103, 0, v103
    v_cvt_pk_bf16_f32 v104, 0, v104
    v_cvt_pk_bf16_f32 v105, 0, v105
    v_cvt_pk_bf16_f32 v106, 0, v106
    v_cvt_pk_bf16_f32 v107, 0, v107
    v_cvt_pk_bf16_f32 v108, 0, v108
    v_cvt_pk_bf16_f32 v109, 0, v109
    v_cvt_pk_bf16_f32 v110, 0, v110
    v_cvt_pk_bf16_f32 v111, 0, v111
    v_pk_mul_f32 v[96:97], v[96:97], v[112:113] op_sel_hi:[1,0]
    v_pk_mul_f32 v[98:99], v[98:99], v[112:113] op_sel_hi:[1,0]
    v_pk_mul_f32 v[100:101], v[100:101], v[112:113] op_sel_hi:[1,0]
    v_pk_mul_f32 v[102:103], v[102:103], v[112:113] op_sel_hi:[1,0]
    v_pk_mul_f32 v[104:105], v[104:105], v[112:113] op_sel_hi:[1,0]
    v_pk_mul_f32 v[106:107], v[106:107], v[112:113] op_sel_hi:[1,0]
    v_pk_mul_f32 v[108:109], v[108:109], v[112:113] op_sel_hi:[1,0]
    v_pk_mul_f32 v[110:111], v[110:111], v[112:113] op_sel_hi:[1,0]
    v_cvt_pk_bf16_f32 v96, 0, v96
    v_cvt_pk_bf16_f32 v97, 0, v97
    v_cvt_pk_bf16_f32 v98, 0, v98
    v_cvt_pk_bf16_f32 v99, 0, v99
    v_cvt_pk_bf16_f32 v100, 0, v100
    v_cvt_pk_bf16_f32 v101, 0, v101
    v_cvt_pk_bf16_f32 v102, 0, v102
    v_cvt_pk_bf16_f32 v103, 0, v103
    v_cvt_pk_bf16_f32 v104, 0, v104
    v_cvt_pk_bf16_f32 v105, 0, v105
    v_cvt_pk_bf16_f32 v106, 0, v106
    v_cvt_pk_bf16_f32 v107, 0, v107
    v_cvt_pk_bf16_f32 v108, 0, v108
    v_cvt_pk_bf16_f32 v109, 0, v109
    v_cvt_pk_bf16_f32 v110, 0, v110
    v_cvt_pk_bf16_f32 v111, 0, v111
    s_branch SCHK_9
SPOLL_8:
    s_load_dword s24, s[32:33], s13 offset:508 glc
    s_load_dword s25, s[32:33], s13 offset:4604 glc
SCHK_9:
    s_add_u32 s5, s5, 1
    s_cmp_ge_u32 s5, 200000
    s_waitcnt lgkmcnt(0)
    s_cbranch_scc1 SDONE_10
    s_cmp_lg_u32 s24, s4
    s_cbranch_scc1 SPOLL_8
    s_cmp_lg_u32 s25, s4
    s_cbranch_scc1 SPOLL_8
SDONE_10:
    s_barrier
    buffer_load_dwordx4 v[112:115], v4, s[32:35], s13 offen sc1
    s_lshr_b32 s96, s9, 4
    s_lshl_b32 s97, s96, 1
    s_xor_b32 s20, s97, 1
    s_add_u32 s96, s20, s85
    s_and_b32 s97, s96, 15
    s_lshl3_add_u32 s98, s97, s3
    s_mul_i32 s99, s98, 49152
    s_lshl_b32 s96, s11, 7
    s_add_u32 s82, s99, s96
    s_mul_i32 s96, s20, 24576
    s_lshl_b32 s97, s3, 10
    s_add_u32 s20, s96, s97
    s_mov_b32 m0, s20
    s_nop 0
    buffer_load_dwordx4 v62, s[40:43], s82 offen lds
    s_add_u32 s82, s82, 2048
    s_add_u32 m0, s20, 8192
    s_nop 0
    buffer_load_dwordx4 v62, s[40:43], s82 offen lds
    s_add_u32 s82, s82, 2048
    s_add_u32 m0, s20, 16384
    s_nop 0
    buffer_load_dwordx4 v62, s[40:43], s82 offen lds
    s_waitcnt vmcnt(3)
    v_bitop3_b32 v7, v113, v115, s4 bitop3:0x7e
    v_cmp_ne_u32 vcc, 0, v7
    s_cbranch_vccz TOK_12
POLL_13:
    buffer_load_dwordx4 v[112:115], v4, s[32:35], s13 offen sc1
    s_waitcnt vmcnt(0)
    v_bitop3_b32 v7, v113, v115, s4 bitop3:0x7e
    v_cmp_ne_u32 vcc, 0, v7
    s_cbranch_vccz PDONE_14
    s_add_u32 s5, s5, 1
    s_cmp_lt_u32 s5, 200000
    s_cbranch_scc1 POLL_13
PDONE_14:
TOK_12:
    ds_write2_b32 v5, v112, v114 offset0:0 offset1:8
    s_waitcnt lgkmcnt(0)
    s_barrier
    ds_read_b128 v[88:91], v6 offset:2048
    ds_read_b128 v[92:95], v6 offset:2064
    ds_read_b128 v[80:83], v6
    ds_read_b128 v[84:87], v6 offset:16
    s_lshl4_add_u32 s96, s21, s12
    s_and_b32 s97, s3, 3
    s_lshl2_add_u32 s98, s96, s97
    s_lshl1_add_u32 s99, s98, s76
    s_lshl_b32 s96, s99, 11
    s_add_u32 s13, s96, 4194304
    s_waitcnt lgkmcnt(2)
    v_pk_add_f32 v[88:89], v[88:89], v[90:91]
    v_pk_add_f32 v[92:93], v[92:93], v[94:95]
    v_pk_add_f32 v[88:89], v[88:89], v[92:93]
    v_add_f32 v88, v88, v89
    v_cvt_pk_bf16_f32 v88, 0, v88
    s_waitcnt lgkmcnt(0)
    v_pk_add_f32 v[80:81], v[80:81], v[82:83]
    v_pk_add_f32 v[84:85], v[84:85], v[86:87]
    v_pk_add_f32 v[80:81], v[80:81], v[84:85]
    v_add_f32 v80, v80, v81
    v_add_f32 v88, 1.0, v88
    v_cvt_pk_bf16_f32 v88, 0, v88
    v_cvt_pk_bf16_f32 v80, 0, v80
    s_nop 0
    v_mul_f32_dpp v96, v88, v96 row_newbcast:0 row_mask:0xf bank_mask:0xf
    v_mul_f32_dpp v97, v88, v97 row_newbcast:1 row_mask:0xf bank_mask:0xf
    v_mul_f32_dpp v98, v88, v98 row_newbcast:2 row_mask:0xf bank_mask:0xf
    v_mul_f32_dpp v99, v88, v99 row_newbcast:3 row_mask:0xf bank_mask:0xf
    v_mul_f32_dpp v100, v88, v100 row_newbcast:4 row_mask:0xf bank_mask:0xf
    v_mul_f32_dpp v101, v88, v101 row_newbcast:5 row_mask:0xf bank_mask:0xf
    v_mul_f32_dpp v102, v88, v102 row_newbcast:6 row_mask:0xf bank_mask:0xf
    v_mul_f32_dpp v103, v88, v103 row_newbcast:7 row_mask:0xf bank_mask:0xf
    v_cvt_pk_bf16_f32 v96, 0, v96
    v_cvt_pk_bf16_f32 v97, 0, v97
    v_cvt_pk_bf16_f32 v98, 0, v98
    v_cvt_pk_bf16_f32 v99, 0, v99
    v_cvt_pk_bf16_f32 v100, 0, v100
    v_cvt_pk_bf16_f32 v101, 0, v101
    v_cvt_pk_bf16_f32 v102, 0, v102
    v_cvt_pk_bf16_f32 v103, 0, v103
    v_add_f32_dpp v96, v80, v96 row_newbcast:0 row_mask:0xf bank_mask:0xf
    v_add_f32_dpp v97, v80, v97 row_newbcast:1 row_mask:0xf bank_mask:0xf
    v_add_f32_dpp v98, v80, v98 row_newbcast:2 row_mask:0xf bank_mask:0xf
    v_add_f32_dpp v99, v80, v99 row_newbcast:3 row_mask:0xf bank_mask:0xf
    v_add_f32_dpp v100, v80, v100 row_newbcast:4 row_mask:0xf bank_mask:0xf
    v_add_f32_dpp v101, v80, v101 row_newbcast:5 row_mask:0xf bank_mask:0xf
    v_add_f32_dpp v102, v80, v102 row_newbcast:6 row_mask:0xf bank_mask:0xf
    v_add_f32_dpp v103, v80, v103 row_newbcast:7 row_mask:0xf bank_mask:0xf
    v_cvt_pk_bf16_f32 v116, v96, v97
    v_cvt_pk_bf16_f32 v117, v98, v99
    v_cvt_pk_bf16_f32 v118, v100, v101
    v_cvt_pk_bf16_f32 v119, v102, v103
    buffer_store_dwordx4 v[116:119], v2, s[32:35], s13 offen sc1
    v_mul_f32_dpp v104, v88, v104 row_newbcast:8 row_mask:0xf bank_mask:0xf
    v_mul_f32_dpp v105, v88, v105 row_newbcast:9 row_mask:0xf bank_mask:0xf
    v_mul_f32_dpp v106, v88, v106 row_newbcast:10 row_mask:0xf bank_mask:0xf
    v_mul_f32_dpp v107, v88, v107 row_newbcast:11 row_mask:0xf bank_mask:0xf
    v_mul_f32_dpp v108, v88, v108 row_newbcast:12 row_mask:0xf bank_mask:0xf
    v_mul_f32_dpp v109, v88, v109 row_newbcast:13 row_mask:0xf bank_mask:0xf
    v_mul_f32_dpp v110, v88, v110 row_newbcast:14 row_mask:0xf bank_mask:0xf
    v_mul_f32_dpp v111, v88, v111 row_newbcast:15 row_mask:0xf bank_mask:0xf
    v_cvt_pk_bf16_f32 v104, 0, v104
    v_cvt_pk_bf16_f32 v105, 0, v105
    v_cvt_pk_bf16_f32 v106, 0, v106
    v_cvt_pk_bf16_f32 v107, 0, v107
    v_cvt_pk_bf16_f32 v108, 0, v108
    v_cvt_pk_bf16_f32 v109, 0, v109
    v_cvt_pk_bf16_f32 v110, 0, v110
    v_cvt_pk_bf16_f32 v111, 0, v111
    v_add_f32_dpp v104, v80, v104 row_newbcast:8 row_mask:0xf bank_mask:0xf
    v_add_f32_dpp v105, v80, v105 row_newbcast:9 row_mask:0xf bank_mask:0xf
    v_add_f32_dpp v106, v80, v106 row_newbcast:10 row_mask:0xf bank_mask:0xf
    v_add_f32_dpp v107, v80, v107 row_newbcast:11 row_mask:0xf bank_mask:0xf
    v_add_f32_dpp v108, v80, v108 row_newbcast:12 row_mask:0xf bank_mask:0xf
    v_add_f32_dpp v109, v80, v109 row_newbcast:13 row_mask:0xf bank_mask:0xf
    v_add_f32_dpp v110, v80, v110 row_newbcast:14 row_mask:0xf bank_mask:0xf
    v_add_f32_dpp v111, v80, v111 row_newbcast:15 row_mask:0xf bank_mask:0xf
    v_cvt_pk_bf16_f32 v120, v104, v105
    v_cvt_pk_bf16_f32 v121, v106, v107
    v_cvt_pk_bf16_f32 v122, v108, v109
    v_cvt_pk_bf16_f32 v123, v110, v111
    buffer_store_dwordx4 v[120:123], v2, s[32:35], s13 offen offset:1024 sc1
    v_bfe_u32 v66, v1, 2, 2
    v_lshlrev_b32 v66, 7, v66
    v_bfe_u32 v9, v1, 3, 1
    v_lshl_add_u32 v66, v9, 6, v66
    v_bfe_u32 v9, v1, 4, 1
    v_lshl_add_u32 v66, v9, 5, v66
    v_and_b32 v9, 3, v1
    v_lshl_add_u32 v66, v9, 3, v66
    v_lshrrev_b32 v9, 5, v1
    v_lshl_add_u32 v66, v9, 11, v66
    v_xor_b32 v67, 64, v66
    v_add_u32 v68, 49152, v66
    v_add_u32 v69, 49152, v67
    v_add_u32 v70, 98304, v66
    v_add_u32 v71, 98304, v67
    s_lshl_b32 s96, s76, 11
    s_add_u32 s14, s96, 159744
    v_bfe_u32 v4, v1, 2, 2
    v_lshl_add_u32 v4, v4, 6, s14
    v_bfe_u32 v9, v1, 4, 1
    v_lshl_add_u32 v4, v9, 5, v4
    v_and_b32 v9, 3, v1
    v_lshl_add_u32 v4, v9, 3, v4
    v_lshrrev_b32 v9, 5, v1
    v_lshl_add_u32 v4, v9, 8, v4
    v_and_b32 v5, 3, v1
    v_lshlrev_b32 v5, 15, v5
    v_bfe_u32 v9, v1, 2, 2
    v_lshl_add_u32 v5, v9, 12, v5
    s_and_b32 s96, s12, 1
    s_lshr_b32 s97, s21, 3
    s_and_b32 s98, s21, 7
    s_lshl_b32 s99, s98, 5
    s_lshl2_add_u32 s98, s97, s99
    s_lshl_b32 s97, s98, 12
    s_lshr_b32 s99, s12, 1
    s_lshl_b32 s98, s99, 6
    s_add_u32 s99, s97, s98
    s_lshl2_add_u32 s97, s96, s99
    s_add_u32 s13, s97, 1048576
    v_bfe_u32 v6, v1, 4, 1
    v_lshlrev_b32 v6, 6, v6
    v_and_b32 v74, 7, v1
    v_lshlrev_b32 v74, 4, v74
    v_xor_b32 v74, v74, v6
    v_lshrrev_b32 v6, 3, v1
    v_lshlrev_b32 v6, 11, v6
    v_add_u32 v74, v74, v6
    s_and_b32 s96, s3, 2
    s_lshl_b32 s14, s96, 5
    v_bfe_u32 v6, v1, 4, 1
    v_lshl_add_u32 v6, v6, 5, s14
    v_and_b32 v72, 7, v1
    v_lshlrev_b32 v72, 4, v72
    v_xor_b32 v72, v72, v6
    v_lshrrev_b32 v6, 3, v1
    v_mul_u32_u24 v6, 7168, v6
    v_add_u32 v72, v72, v6
    s_and_b32 s96, s3, 1
    s_lshl_b32 s14, s96, 7
    v_lshrrev_b32 v6, 5, v1
    v_lshl_add_u32 v6, v6, 6, s14
    v_and_b32 v73, 31, v1
    v_lshlrev_b32 v73, 4, v73
    v_lshrrev_b32 v9, 5, v1
    v_lshl_add_u32 v73, v9, 11, v73
    v_xor_b32 v73, v73, v6
    s_lshl3_add_u32 s96, s75, s3
    s_mul_i32 s97, s96, 229376
    s_lshl_b32 s98, s74, 7
    s_add_u32 s80, s97, s98
    s_lshl3_add_u32 s96, s74, s3
    s_lshl_b32 s97, s96, 14
    s_lshl_b32 s98, s75, 9
    s_add_u32 s81, s97, s98
    s_cmp_ge_u32 s9, 28
    s_cselect_b32 s54, 0, s54
    s_cselect_b32 s58, 0, s58
    s_cselect_b32 s62, 0, s62
    s_waitcnt vmcnt(0)
    s_barrier
    s_cmp_lg_u32 s3, 0
    s_cbranch_scc1 L_PB
    v_mov_b32 v6, s4
    s_mov_b32 exec_hi, 0
    s_mov_b32 exec_lo, 65535
    buffer_store_dword v6, v5, s[32:35], s13 offen sc1
    s_mov_b64 exec, -1
L_PB:
    s_lshr_b32 s96, s9, 4
    s_lshl_b32 s97, s96, 1
    s_xor_b32 s20, s97, 2
    s_add_u32 s96, s20, s85
    s_and_b32 s97, s96, 15
    s_lshl3_add_u32 s98, s97, s3
    s_mul_i32 s99, s98, 49152
    s_lshl_b32 s96, s11, 7
    s_add_u32 s82, s99, s96
    s_mul_i32 s96, s20, 24576
    s_lshl_b32 s97, s3, 10
    s_add_u32 s20, s96, s97
    s_mov_b32 m0, s20
    s_nop 0
    buffer_load_dwordx4 v62, s[40:43], s82 offen lds
    s_add_u32 s82, s82, 2048
    s_add_u32 m0, s20, 8192
    s_nop 0
    buffer_load_dwordx4 v62, s[40:43], s82 offen lds
    s_add_u32 s82, s82, 2048
    s_add_u32 m0, s20, 16384
    s_nop 0
    buffer_load_dwordx4 v62, s[40:43], s82 offen lds
    s_lshr_b32 s96, s9, 4
    s_lshl_b32 s97, s96, 1
    s_xor_b32 s20, s97, 3
    s_add_u32 s96, s20, s85
    s_and_b32 s97, s96, 15
    s_lshl3_add_u32 s98, s97, s3
    s_mul_i32 s99, s98, 49152
    s_lshl_b32 s96, s11, 7
    s_add_u32 s82, s99, s96
    s_mul_i32 s96, s20, 24576
    s_lshl_b32 s97, s3, 10
    s_add_u32 s20, s96, s97
    s_mov_b32 m0, s20
    s_nop 0
    buffer_load_dwordx4 v62, s[40:43], s82 offen lds
    s_add_u32 s82, s82, 2048
    s_add_u32 m0, s20, 8192
    s_nop 0
    buffer_load_dwordx4 v62, s[40:43], s82 offen lds
    s_add_u32 s82, s82, 2048
    s_add_u32 m0, s20, 16384
    s_nop 0
    buffer_load_dwordx4 v62, s[40:43], s82 offen lds
    ds_read_b64_tr_b16 v[28:29], v4
    ds_read_b64_tr_b16 v[30:31], v4 offset:512
    ds_read_b64_tr_b16 v[32:33], v4 offset:1024
    ds_read_b64_tr_b16 v[34:35], v4 offset:1536
    s_lshl_b32 s96, s10, 6
    s_add_u32 s97, s96, s3
    s_lshl_b32 s98, s97, 12
    s_add_u32 s15, s98, 4194304
    s_and_b32 s96, s3, 3
    s_lshl_b32 s97, s96, 12
    s_add_u32 s13, s97, 147456
    v_add_u32 v76, s13, v2
    s_and_b32 s96, s3, 3
    s_lshl_b32 s97, s96, 10
    s_lshl_b32 s98, s76, 14
    s_add_u32 s13, s97, s98
    v_and_b32 v75, 31, v1
    v_lshl_add_u32 v75, v75, 5, s13
    v_lshrrev_b32 v9, 5, v1
    v_lshl_add_u32 v75, v9, 4, v75
    s_lshl2_add_u32 s96, s83, s3
    s_lshl_b32 s84, s96, 14
    s_lshr_b32 s96, s9, 4
    s_lshl_b32 s97, s96, 20
    s_lshl_b32 s98, s12, 7
    s_add_u32 s88, s97, s98
    s_lshl_b32 s89, s3, 10
    s_lshl4_add_u32 s96, s8, s9
    s_add_u32 s97, s96, 16
    s_lshl_b32 s98, s97, 11
    s_add_u32 s90, s98, 131072
    s_cmp_ge_u32 s8, 3
    s_cselect_b32 s90, 0, s90
    s_cmp_ge_u32 s9, 16
    s_cselect_b32 s90, 0, s90
    s_cmp_lg_u32 s3, 1
    s_cselect_b32 s90, 0, s90
    s_load_dwordx2 s[24:25], s[32:33], s92 offset:0 glc
    s_add_u32 s96, s85, 4
    s_and_b32 s97, s96, 15
    s_lshl3_add_u32 s98, s97, s3
    s_mul_i32 s99, s98, 49152
    s_lshl_b32 s96, s11, 7
    s_add_u32 s82, s99, s96
    s_lshl_b32 s96, s3, 10
    s_add_u32 s20, s96, 98304
    s_mov_b32 m0, s20
    s_nop 0
    buffer_load_dwordx4 v62, s[40:43], s82 offen lds
    s_add_u32 s82, s82, 2048
    s_add_u32 m0, s20, 8192
    s_nop 0
    buffer_load_dwordx4 v62, s[40:43], s82 offen lds
    s_add_u32 s82, s82, 2048
    s_add_u32 m0, s20, 16384
    s_nop 0
    buffer_load_dwordx4 v62, s[40:43], s82 offen lds
    s_branch SCHK_16
SPOLL_15:
    s_load_dwordx2 s[24:25], s[32:33], s92 offset:0 glc
SCHK_16:
    s_add_u32 s5, s5, 1
    s_cmp_ge_u32 s5, 200000
    s_waitcnt lgkmcnt(0)
    s_cbranch_scc1 SDONE_17
    s_cmp_lg_u32 s24, s4
    s_cbranch_scc1 SPOLL_15
    s_cmp_lg_u32 s25, s4
    s_cbranch_scc1 SPOLL_15
SDONE_17:
    s_waitcnt vmcnt(6)
    s_barrier
    s_cmp_ge_u32 s3, 4
    s_cbranch_scc1 L_HELP
    s_setprio 2
    s_and_b32 s96, s85, 15
    s_lshl_b32 s97, s96, 14
    s_add_u32 s16, s97, s15
    buffer_load_dwordx4 v[176:179], v2, s[32:35], s16 offen sc1
    ds_read_b64_tr_b16 v[224:225], v66 offset:8192
    ds_read_b64_tr_b16 v[226:227], v66 offset:8704
    ds_read_b64_tr_b16 v[228:229], v67 offset:8192
    ds_read_b64_tr_b16 v[230:231], v67 offset:8704
    ds_read_b64_tr_b16 v[232:233], v66
    ds_read_b64_tr_b16 v[234:235], v66 offset:512
    ds_read_b64_tr_b16 v[236:237], v67
    ds_read_b64_tr_b16 v[238:239], v67 offset:512
    ds_read_b64_tr_b16 v[240:241], v66 offset:16384
    ds_read_b64_tr_b16 v[242:243], v66 offset:16896
    ds_read_b64_tr_b16 v[244:245], v67 offset:16384
    ds_read_b64_tr_b16 v[246:247], v67 offset:16896
    buffer_load_dwordx4 v[180:183], v2, s[32:35], s16 offen offset:1024 sc1
    buffer_load_dwordx4 v[184:187], v2, s[32:35], s16 offen offset:2048 sc1
    buffer_load_dwordx4 v[188:191], v2, s[32:35], s16 offen offset:3072 sc1
    s_waitcnt vmcnt(3)
    s_waitcnt lgkmcnt(10)
    v_mfma_f32_32x32x16_bf16 v[112:127], v[224:227], v[176:179], 0
    ds_read_b64_tr_b16 v[248:249], v66 offset:9216
    ds_read_b64_tr_b16 v[250:251], v66 offset:9728
    s_waitcnt lgkmcnt(10)
    v_mfma_f32_32x32x16_bf16 v[128:143], v[228:231], v[176:179], 0
    ds_read_b64_tr_b16 v[224:225], v67 offset:9216
    ds_read_b64_tr_b16 v[226:227], v67 offset:9728
    s_waitcnt lgkmcnt(10)
    v_mfma_f32_32x32x16_bf16 v[80:95], v[232:235], v[176:179], 0
    ds_read_b64_tr_b16 v[228:229], v66 offset:1024
    ds_read_b64_tr_b16 v[230:231], v66 offset:1536
    s_waitcnt lgkmcnt(10)
    v_mfma_f32_32x32x16_bf16 v[96:111], v[236:239], v[176:179], 0
    ds_read_b64_tr_b16 v[232:233], v67 offset:1024
    ds_read_b64_tr_b16 v[234:235], v67 offset:1536
    s_waitcnt lgkmcnt(10)
    v_mfma_f32_32x32x16_bf16 v[144:159], v[240:243], v[176:179], 0
    ds_read_b64_tr_b16 v[236:237], v66 offset:17408
    ds_read_b64_tr_b16 v[238:239], v66 offset:17920
    s_waitcnt lgkmcnt(10)
    v_mfma_f32_32x32x16_bf16 v[160:175], v[244:247], v[176:179], 0
    ds_read_b64_tr_b16 v[240:241], v67 offset:17408
    ds_read_b64_tr_b16 v[242:243], v67 offset:17920
    s_add_u32 s96, s85, 1
    s_and_b32 s97, s96, 15
    s_lshl_b32 s98, s97, 14
    s_add_u32 s16, s98, s15
    buffer_load_dwordx4 v[192:195], v2, s[32:35], s16 offen sc1
    buffer_load_dwordx4 v[196:199], v2, s[32:35], s16 offen offset:1024 sc1
    s_waitcnt vmcnt(4)
    s_waitcnt lgkmcnt(10)
    v_mfma_f32_32x32x16_bf16 v[112:127], v[248:251], v[180:183], v[112:127]
    ds_read_b64_tr_b16 v[244:245], v66 offset:12288
    ds_read_b64_tr_b16 v[246:247], v66 offset:12800
    s_waitcnt lgkmcnt(10)
    v_mfma_f32_32x32x16_bf16 v[128:143], v[224:227], v[180:183], v[128:143]
    ds_read_b64_tr_b16 v[248:249], v67 offset:12288
    ds_read_b64_tr_b16 v[250:251], v67 offset:12800
    s_waitcnt lgkmcnt(10)
    v_mfma_f32_32x32x16_bf16 v[80:95], v[228:231], v[180:183], v[80:95]
    ds_read_b64_tr_b16 v[224:225], v66 offset:4096
    ds_read_b64_tr_b16 v[226:227], v66 offset:4608
    s_waitcnt lgkmcnt(10)
    v_mfma_f32_32x32x16_bf16 v[96:111], v[232:235], v[180:183], v[96:111]
    ds_read_b64_tr_b16 v[228:229], v67 offset:4096
    ds_read_b64_tr_b16 v[230:231], v67 offset:4608
    s_waitcnt lgkmcnt(10)
    v_mfma_f32_32x32x16_bf16 v[144:159], v[236:239], v[180:183], v[144:159]
    ds_read_b64_tr_b16 v[232:233], v66 offset:20480
    ds_read_b64_tr_b16 v[234:235], v66 offset:20992
    s_waitcnt lgkmcnt(10)
    v_mfma_f32_32x32x16_bf16 v[160:175], v[240:243], v[180:183], v[160:175]
    ds_read_b64_tr_b16 v[236:237], v67 offset:20480
    ds_read_b64_tr_b16 v[238:239], v67 offset:20992
    buffer_load_dwordx4 v[200:203], v2, s[32:35], s16 offen offset:2048 sc1
    buffer_load_dwordx4 v[204:207], v2, s[32:35], s16 offen offset:3072 sc1
    s_waitcnt vmcnt(5)
    s_waitcnt lgkmcnt(10)
    v_mfma_f32_32x32x16_bf16 v[112:127], v[244:247], v[184:187], v[112:127]
    ds_read_b64_tr_b16 v[240:241], v66 offset:13312
    ds_read_b64_tr_b16 v[242:243], v66 offset:13824
    s_waitcnt lgkmcnt(10)
    v_mfma_f32_32x32x16_bf16 v[128:143], v[248:251], v[184:187], v[128:143]
    ds_read_b64_tr_b16 v[244:245], v67 offset:13312
    ds_read_b64_tr_b16 v[246:247], v67 offset:13824
    s_waitcnt lgkmcnt(10)
    v_mfma_f32_32x32x16_bf16 v[80:95], v[224:227], v[184:187], v[80:95]
    ds_read_b64_tr_b16 v[248:249], v66 offset:5120
    ds_read_b64_tr_b16 v[250:251], v66 offset:5632
    s_waitcnt lgkmcnt(10)
    v_mfma_f32_32x32x16_bf16 v[96:111], v[228:231], v[184:187], v[96:111]
    ds_read_b64_tr_b16 v[224:225], v67 offset:5120
    ds_read_b64_tr_b16 v[226:227], v67 offset:5632
    s_waitcnt lgkmcnt(10)
    v_mfma_f32_32x32x16_bf16 v[144:159], v[232:235], v[184:187], v[144:159]
    ds_read_b64_tr_b16 v[228:229], v66 offset:21504
    ds_read_b64_tr_b16 v[230:231], v66 offset:22016
    s_waitcnt lgkmcnt(10)
    v_mfma_f32_32x32x16_bf16 v[160:175], v[236:239], v[184:187], v[160:175]
    ds_read_b64_tr_b16 v[232:233], v67 offset:21504
    ds_read_b64_tr_b16 v[234:235], v67 offset:22016
    s_add_u32 s96, s85, 2
    s_and_b32 s97, s96, 15
    s_lshl_b32 s98, s97, 14
    s_add_u32 s16, s98, s15
    buffer_load_dwordx4 v[208:211], v2, s[32:35], s16 offen sc1
    buffer_load_dwordx4 v[212:215], v2, s[32:35], s16 offen offset:1024 sc1
    s_waitcnt vmcnt(6)
    s_waitcnt lgkmcnt(10)
    v_mfma_f32_32x32x16_bf16 v[112:127], v[240:243], v[188:191], v[112:127]
    s_barrier
    ds_read_b64_tr_b16 v[236:237], v66 offset:32768
    ds_read_b64_tr_b16 v[238:239], v66 offset:33280
    s_waitcnt lgkmcnt(10)
    v_mfma_f32_32x32x16_bf16 v[128:143], v[244:247], v[188:191], v[128:143]
    ds_read_b64_tr_b16 v[240:241], v67 offset:32768
    ds_read_b64_tr_b16 v[242:243], v67 offset:33280
    s_waitcnt lgkmcnt(10)
    v_mfma_f32_32x32x16_bf16 v[80:95], v[248:251], v[188:191], v[80:95]
    ds_read_b64_tr_b16 v[244:245], v66 offset:24576
    ds_read_b64_tr_b16 v[246:247], v66 offset:25088
    s_waitcnt lgkmcnt(10)
    v_mfma_f32_32x32x16_bf16 v[96:111], v[224:227], v[188:191], v[96:111]
    ds_read_b64_tr_b16 v[248:249], v67 offset:24576
    ds_read_b64_tr_b16 v[250:251], v67 offset:25088
    s_waitcnt lgkmcnt(10)
    v_mfma_f32_32x32x16_bf16 v[144:159], v[228:231], v[188:191], v[144:159]
    ds_read_b64_tr_b16 v[224:225], v66 offset:40960
    ds_read_b64_tr_b16 v[226:227], v66 offset:41472
    s_waitcnt lgkmcnt(10)
    v_mfma_f32_32x32x16_bf16 v[160:175], v[232:235], v[188:191], v[160:175]
    ds_read_b64_tr_b16 v[228:229], v67 offset:40960
    ds_read_b64_tr_b16 v[230:231], v67 offset:41472
    buffer_load_dwordx4 v[216:219], v2, s[32:35], s16 offen offset:2048 sc1
    buffer_load_dwordx4 v[220:223], v2, s[32:35], s16 offen offset:3072 sc1
    s_waitcnt vmcnt(7)
    s_waitcnt lgkmcnt(10)
    v_mfma_f32_32x32x16_bf16 v[112:127], v[236:239], v[192:195], v[112:127]
    ds_read_b64_tr_b16 v[232:233], v66 offset:33792
    ds_read_b64_tr_b16 v[234:235], v66 offset:34304
    s_waitcnt lgkmcnt(10)
    v_mfma_f32_32x32x16_bf16 v[128:143], v[240:243], v[192:195], v[128:143]
    ds_read_b64_tr_b16 v[236:237], v67 offset:33792
    ds_read_b64_tr_b16 v[238:239], v67 offset:34304
    s_waitcnt lgkmcnt(10)
    v_mfma_f32_32x32x16_bf16 v[80:95], v[244:247], v[192:195], v[80:95]
    ds_read_b64_tr_b16 v[240:241], v66 offset:25600
    ds_read_b64_tr_b16 v[242:243], v66 offset:26112
    s_waitcnt lgkmcnt(10)
    v_mfma_f32_32x32x16_bf16 v[96:111], v[248:251], v[192:195], v[96:111]
    ds_read_b64_tr_b16 v[244:245], v67 offset:25600
    ds_read_b64_tr_b16 v[246:247], v67 offset:26112
    s_waitcnt lgkmcnt(10)
    v_mfma_f32_32x32x16_bf16 v[144:159], v[224:227], v[192:195], v[144:159]
    ds_read_b64_tr_b16 v[248:249], v66 offset:41984
    ds_read_b64_tr_b16 v[250:251], v66 offset:42496
    s_waitcnt lgkmcnt(10)
    v_mfma_f32_32x32x16_bf16 v[160:175], v[228:231], v[192:195], v[160:175]
    ds_read_b64_tr_b16 v[224:225], v67 offset:41984
    ds_read_b64_tr_b16 v[226:227], v67 offset:42496
    s_add_u32 s96, s85, 3
    s_and_b32 s97, s96, 15
    s_lshl_b32 s98, s97, 14
    s_add_u32 s16, s98, s15
    buffer_load_dwordx4 v[176:179], v2, s[32:35], s16 offen sc1
    buffer_load_dwordx4 v[180:183], v2, s[32:35], s16 offen offset:1024 sc1
    s_waitcnt vmcnt(8)
    s_waitcnt lgkmcnt(10)
    v_mfma_f32_32x32x16_bf16 v[112:127], v[232:235], v[196:199], v[112:127]
    ds_read_b64_tr_b16 v[228:229], v66 offset:36864
    ds_read_b64_tr_b16 v[230:231], v66 offset:37376
    s_waitcnt lgkmcnt(10)
    v_mfma_f32_32x32x16_bf16 v[128:143], v[236:239], v[196:199], v[128:143]
    ds_read_b64_tr_b16 v[232:233], v67 offset:36864
    ds_read_b64_tr_b16 v[234:235], v67 offset:37376
    s_waitcnt lgkmcnt(10)
    v_mfma_f32_32x32x16_bf16 v[80:95], v[240:243], v[196:199], v[80:95]
    ds_read_b64_tr_b16 v[236:237], v66 offset:28672
    ds_read_b64_tr_b16 v[238:239], v66 offset:29184
    s_waitcnt lgkmcnt(10)
    v_mfma_f32_32x32x16_bf16 v[96:111], v[244:247], v[196:199], v[96:111]
    ds_read_b64_tr_b16 v[240:241], v67 offset:28672
    ds_read_b64_tr_b16 v[242:243], v67 offset:29184
    s_waitcnt lgkmcnt(10)
    v_mfma_f32_32x32x16_bf16 v[144:159], v[248:251], v[196:199], v[144:159]
    ds_read_b64_tr_b16 v[244:245], v66 offset:45056
    ds_read_b64_tr_b16 v[246:247], v66 offset:45568
    s_waitcnt lgkmcnt(10)
    v_mfma_f32_32x32x16_bf16 v[160:175], v[224:227], v[196:199], v[160:175]
    ds_read_b64_tr_b16 v[248:249], v67 offset:45056
    ds_read_b64_tr_b16 v[250:251], v67 offset:45568
    buffer_load_dwordx4 v[184:187], v2, s[32:35], s16 offen offset:2048 sc1
    buffer_load_dwordx4 v[188:191], v2, s[32:35], s16 offen offset:3072 sc1
    s_waitcnt vmcnt(9)
    s_waitcnt lgkmcnt(10)
    v_mfma_f32_32x32x16_bf16 v[112:127], v[228:231], v[200:203], v[112:127]
    ds_read_b64_tr_b16 v[224:225], v66 offset:37888
    ds_read_b64_tr_b16 v[226:227], v66 offset:38400
    s_waitcnt lgkmcnt(10)
    v_mfma_f32_32x32x16_bf16 v[128:143], v[232:235], v[200:203], v[128:143]
    ds_read_b64_tr_b16 v[228:229], v67 offset:37888
    ds_read_b64_tr_b16 v[230:231], v67 offset:38400
    s_waitcnt lgkmcnt(10)
    v_mfma_f32_32x32x16_bf16 v[80:95], v[236:239], v[200:203], v[80:95]
    ds_read_b64_tr_b16 v[232:233], v66 offset:29696
    ds_read_b64_tr_b16 v[234:235], v66 offset:30208
    s_waitcnt lgkmcnt(10)
    v_mfma_f32_32x32x16_bf16 v[96:111], v[240:243], v[200:203], v[96:111]
    ds_read_b64_tr_b16 v[236:237], v67 offset:29696
    ds_read_b64_tr_b16 v[238:239], v67 offset:30208
    s_waitcnt lgkmcnt(10)
    v_mfma_f32_32x32x16_bf16 v[144:159], v[244:247], v[200:203], v[144:159]
    ds_read_b64_tr_b16 v[240:241], v66 offset:46080
    ds_read_b64_tr_b16 v[242:243], v66 offset:46592
    s_waitcnt lgkmcnt(10)
    v_mfma_f32_32x32x16_bf16 v[160:175], v[248:251], v[200:203], v[160:175]
    ds_read_b64_tr_b16 v[244:245], v67 offset:46080
    ds_read_b64_tr_b16 v[246:247], v67 offset:46592
    s_add_u32 s96, s85, 4
    s_and_b32 s97, s96, 15
    s_lshl_b32 s98, s97, 14
    s_add_u32 s16, s98, s15
    buffer_load_dwordx4 v[192:195], v2, s[32:35], s16 offen sc1
    buffer_load_dwordx4 v[196:199], v2, s[32:35], s16 offen offset:1024 sc1
    s_waitcnt vmcnt(10)
    s_waitcnt lgkmcnt(10)
    v_mfma_f32_32x32x16_bf16 v[112:127], v[224:227], v[204:207], v[112:127]
    s_barrier
    ds_read_b64_tr_b16 v[248:249], v68 offset:8192
    ds_read_b64_tr_b16 v[250:251], v68 offset:8704
    s_waitcnt lgkmcnt(10)
    v_mfma_f32_32x32x16_bf16 v[128:143], v[228:231], v[204:207], v[128:143]
    ds_read_b64_tr_b16 v[224:225], v69 offset:8192
    ds_read_b64_tr_b16 v[226:227], v69 offset:8704
    s_waitcnt lgkmcnt(10)
    v_mfma_f32_32x32x16_bf16 v[80:95], v[232:235], v[204:207], v[80:95]
    ds_read_b64_tr_b16 v[228:229], v68
    ds_read_b64_tr_b16 v[230:231], v68 offset:512
    s_waitcnt lgkmcnt(10)
    v_mfma_f32_32x32x16_bf16 v[96:111], v[236:239], v[204:207], v[96:111]
    ds_read_b64_tr_b16 v[232:233], v69
    ds_read_b64_tr_b16 v[234:235], v69 offset:512
    s_waitcnt lgkmcnt(10)
    v_mfma_f32_32x32x16_bf16 v[144:159], v[240:243], v[204:207], v[144:159]
    ds_read_b64_tr_b16 v[236:237], v68 offset:16384
    ds_read_b64_tr_b16 v[238:239], v68 offset:16896
    s_waitcnt lgkmcnt(10)
    v_mfma_f32_32x32x16_bf16 v[160:175], v[244:247], v[204:207], v[160:175]
    ds_read_b64_tr_b16 v[240:241], v69 offset:16384
    ds_read_b64_tr_b16 v[242:243], v69 offset:16896
    buffer_load_dwordx4 v[200:203], v2, s[32:35], s16 offen offset:2048 sc1
    buffer_load_dwordx4 v[204:207], v2, s[32:35], s16 offen offset:3072 sc1
    s_waitcnt vmcnt(11)
    s_waitcnt lgkmcnt(10)
    v_mfma_f32_32x32x16_bf16 v[112:127], v[248:251], v[208:211], v[112:127]
    ds_read_b64_tr_b16 v[244:245], v68 offset:9216
    ds_read_b64_tr_b16 v[246:247], v68 offset:9728
    s_waitcnt lgkmcnt(10)
    v_mfma_f32_32x32x16_bf16 v[128:143], v[224:227], v[208:211], v[128:143]
    ds_read_b64_tr_b16 v[248:249], v69 offset:9216
    ds_read_b64_tr_b16 v[250:251], v69 offset:9728
    s_waitcnt lgkmcnt(10)
    v_mfma_f32_32x32x16_bf16 v[80:95], v[228:231], v[208:211], v[80:95]
    ds_read_b64_tr_b16 v[224:225], v68 offset:1024
    ds_read_b64_tr_b16 v[226:227], v68 offset:1536
    s_waitcnt lgkmcnt(10)
    v_mfma_f32_32x32x16_bf16 v[96:111], v[232:235], v[208:211], v[96:111]
    ds_read_b64_tr_b16 v[228:229], v69 offset:1024
    ds_read_b64_tr_b16 v[230:231], v69 offset:1536
    s_waitcnt lgkmcnt(10)
    v_mfma_f32_32x32x16_bf16 v[144:159], v[236:239], v[208:211], v[144:159]
    ds_read_b64_tr_b16 v[232:233], v68 offset:17408
    ds_read_b64_tr_b16 v[234:235], v68 offset:17920
    s_waitcnt lgkmcnt(10)
    v_mfma_f32_32x32x16_bf16 v[160:175], v[240:243], v[208:211], v[160:175]
    ds_read_b64_tr_b16 v[236:237], v69 offset:17408
    ds_read_b64_tr_b16 v[238:239], v69 offset:17920
    s_add_u32 s96, s85, 5
    s_and_b32 s97, s96, 15
    s_lshl_b32 s98, s97, 14
    s_add_u32 s16, s98, s15
    buffer_load_dwordx4 v[208:211], v2, s[32:35], s16 offen sc1
    s_waitcnt vmcnt(11)
    s_waitcnt lgkmcnt(10)
    v_mfma_f32_32x32x16_bf16 v[112:127], v[244:247], v[212:215], v[112:127]
    ds_read_b64_tr_b16 v[240:241], v68 offset:12288
    ds_read_b64_tr_b16 v[242:243], v68 offset:12800
    s_waitcnt lgkmcnt(10)
    v_mfma_f32_32x32x16_bf16 v[128:143], v[248:251], v[212:215], v[128:143]
    ds_read_b64_tr_b16 v[244:245], v69 offset:12288
    ds_read_b64_tr_b16 v[246:247], v69 offset:12800
    s_waitcnt lgkmcnt(10)
    v_mfma_f32_32x32x16_bf16 v[80:95], v[224:227], v[212:215], v[80:95]
    ds_read_b64_tr_b16 v[248:249], v68 offset:4096
    ds_read_b64_tr_b16 v[250:251], v68 offset:4608
    s_waitcnt lgkmcnt(10)
    v_mfma_f32_32x32x16_bf16 v[96:111], v[228:231], v[212:215], v[96:111]
    ds_read_b64_tr_b16 v[224:225], v69 offset:4096
    ds_read_b64_tr_b16 v[226:227], v69 offset:4608
    s_waitcnt lgkmcnt(10)
    v_mfma_f32_32x32x16_bf16 v[144:159], v[232:235], v[212:215], v[144:159]
    ds_read_b64_tr_b16 v[228:229], v68 offset:20480
    ds_read_b64_tr_b16 v[230:231], v68 offset:20992
    s_waitcnt lgkmcnt(10)
    v_mfma_f32_32x32x16_bf16 v[160:175], v[236:239], v[212:215], v[160:175]
    ds_read_b64_tr_b16 v[232:233], v69 offset:20480
    ds_read_b64_tr_b16 v[234:235], v69 offset:20992
    buffer_load_dwordx4 v[212:215], v2, s[32:35], s16 offen offset:1024 sc1
    s_waitcnt vmcnt(11)
    s_waitcnt lgkmcnt(10)
    v_mfma_f32_32x32x16_bf16 v[112:127], v[240:243], v[216:219], v[112:127]
    ds_read_b64_tr_b16 v[236:237], v68 offset:13312
    ds_read_b64_tr_b16 v[238:239], v68 offset:13824
    s_waitcnt lgkmcnt(10)
    v_mfma_f32_32x32x16_bf16 v[128:143], v[244:247], v[216:219], v[128:143]
    ds_read_b64_tr_b16 v[240:241], v69 offset:13312
    ds_read_b64_tr_b16 v[242:243], v69 offset:13824
    s_waitcnt lgkmcnt(10)
    v_mfma_f32_32x32x16_bf16 v[80:95], v[248:251], v[216:219], v[80:95]
    ds_read_b64_tr_b16 v[244:245], v68 offset:5120
    ds_read_b64_tr_b16 v[246:247], v68 offset:5632
    s_waitcnt lgkmcnt(10)
    v_mfma_f32_32x32x16_bf16 v[96:111], v[224:227], v[216:219], v[96:111]
    ds_read_b64_tr_b16 v[248:249], v69 offset:5120
    ds_read_b64_tr_b16 v[250:251], v69 offset:5632
    s_waitcnt lgkmcnt(10)
    v_mfma_f32_32x32x16_bf16 v[144:159], v[228:231], v[216:219], v[144:159]
    ds_read_b64_tr_b16 v[224:225], v68 offset:21504
    ds_read_b64_tr_b16 v[226:227], v68 offset:22016
    s_waitcnt lgkmcnt(10)
    v_mfma_f32_32x32x16_bf16 v[160:175], v[232:235], v[216:219], v[160:175]
    ds_read_b64_tr_b16 v[228:229], v69 offset:21504
    ds_read_b64_tr_b16 v[230:231], v69 offset:22016
    buffer_load_dwordx4 v[216:219], v2, s[32:35], s16 offen offset:2048 sc1
    s_waitcnt vmcnt(11)
    s_waitcnt lgkmcnt(10)
    v_mfma_f32_32x32x16_bf16 v[112:127], v[236:239], v[220:223], v[112:127]
    s_barrier
    ds_read_b64_tr_b16 v[232:233], v68 offset:32768
    ds_read_b64_tr_b16 v[234:235], v68 offset:33280
    s_waitcnt lgkmcnt(10)
    v_mfma_f32_32x32x16_bf16 v[128:143], v[240:243], v[220:223], v[128:143]
    ds_read_b64_tr_b16 v[236:237], v69 offset:32768
    ds_read_b64_tr_b16 v[238:239], v69 offset:33280
    s_waitcnt lgkmcnt(10)
    v_mfma_f32_32x32x16_bf16 v[80:95], v[244:247], v[220:223], v[80:95]
    ds_read_b64_tr_b16 v[240:241], v68 offset:24576
    ds_read_b64_tr_b16 v[242:243], v68 offset:25088
    s_waitcnt lgkmcnt(10)
    v_mfma_f32_32x32x16_bf16 v[96:111], v[248:251], v[220:223], v[96:111]
    ds_read_b64_tr_b16 v[244:245], v69 offset:24576
    ds_read_b64_tr_b16 v[246:247], v69 offset:25088
    s_waitcnt lgkmcnt(10)
    v_mfma_f32_32x32x16_bf16 v[144:159], v[224:227], v[220:223], v[144:159]
    ds_read_b64_tr_b16 v[248:249], v68 offset:40960
    ds_read_b64_tr_b16 v[250:251], v68 offset:41472
    s_waitcnt lgkmcnt(10)
    v_mfma_f32_32x32x16_bf16 v[160:175], v[228:231], v[220:223], v[160:175]
    ds_read_b64_tr_b16 v[224:225], v69 offset:40960
    ds_read_b64_tr_b16 v[226:227], v69 offset:41472
    buffer_load_dwordx4 v[220:223], v2, s[32:35], s16 offen offset:3072 sc1
    s_waitcnt vmcnt(11)
    s_waitcnt lgkmcnt(10)
    v_mfma_f32_32x32x16_bf16 v[112:127], v[232:235], v[176:179], v[112:127]
    ds_read_b64_tr_b16 v[228:229], v68 offset:33792
    ds_read_b64_tr_b16 v[230:231], v68 offset:34304
    s_waitcnt lgkmcnt(10)
    v_mfma_f32_32x32x16_bf16 v[128:143], v[236:239], v[176:179], v[128:143]
    ds_read_b64_tr_b16 v[232:233], v69 offset:33792
    ds_read_b64_tr_b16 v[234:235], v69 offset:34304
    s_waitcnt lgkmcnt(10)
    v_mfma_f32_32x32x16_bf16 v[80:95], v[240:243], v[176:179], v[80:95]
    ds_read_b64_tr_b16 v[236:237], v68 offset:25600
    ds_read_b64_tr_b16 v[238:239], v68 offset:26112
    s_waitcnt lgkmcnt(10)
    v_mfma_f32_32x32x16_bf16 v[96:111], v[244:247], v[176:179], v[96:111]
    ds_read_b64_tr_b16 v[240:241], v69 offset:25600
    ds_read_b64_tr_b16 v[242:243], v69 offset:26112
    s_waitcnt lgkmcnt(10)
    v_mfma_f32_32x32x16_bf16 v[144:159], v[248:251], v[176:179], v[144:159]
    ds_read_b64_tr_b16 v[244:245], v68 offset:41984
    ds_read_b64_tr_b16 v[246:247], v68 offset:42496
    s_waitcnt lgkmcnt(10)
    v_mfma_f32_32x32x16_bf16 v[160:175], v[224:227], v[176:179], v[160:175]
    ds_read_b64_tr_b16 v[248:249], v69 offset:41984
    ds_read_b64_tr_b16 v[250:251], v69 offset:42496
    s_add_u32 s96, s85, 6
    s_and_b32 s97, s96, 15
    s_lshl_b32 s98, s97, 14
    s_add_u32 s16, s98, s15
    buffer_load_dwordx4 v[176:179], v2, s[32:35], s16 offen sc1
    s_waitcnt vmcnt(11)
    s_waitcnt lgkmcnt(10)
    v_mfma_f32_32x32x16_bf16 v[112:127], v[228:231], v[180:183], v[112:127]
    ds_read_b64_tr_b16 v[224:225], v68 offset:36864
    ds_read_b64_tr_b16 v[226:227], v68 offset:37376
    s_waitcnt lgkmcnt(10)
    v_mfma_f32_32x32x16_bf16 v[128:143], v[232:235], v[180:183], v[128:143]
    ds_read_b64_tr_b16 v[228:229], v69 offset:36864
    ds_read_b64_tr_b16 v[230:231], v69 offset:37376
    s_waitcnt lgkmcnt(10)
    v_mfma_f32_32x32x16_bf16 v[80:95], v[236:239], v[180:183], v[80:95]
    ds_read_b64_tr_b16 v[232:233], v68 offset:28672
    ds_read_b64_tr_b16 v[234:235], v68 offset:29184
    s_waitcnt lgkmcnt(10)
    v_mfma_f32_32x32x16_bf16 v[96:111], v[240:243], v[180:183], v[96:111]
    ds_read_b64_tr_b16 v[236:237], v69 offset:28672
    ds_read_b64_tr_b16 v[238:239], v69 offset:29184
    s_waitcnt lgkmcnt(10)
    v_mfma_f32_32x32x16_bf16 v[144:159], v[244:247], v[180:183], v[144:159]
    ds_read_b64_tr_b16 v[240:241], v68 offset:45056
    ds_read_b64_tr_b16 v[242:243], v68 offset:45568
    s_waitcnt lgkmcnt(10)
    v_mfma_f32_32x32x16_bf16 v[160:175], v[248:251], v[180:183], v[160:175]
    ds_read_b64_tr_b16 v[244:245], v69 offset:45056
    ds_read_b64_tr_b16 v[246:247], v69 offset:45568
    buffer_load_dwordx4 v[180:183], v2, s[32:35], s16 offen offset:1024 sc1
    s_waitcnt vmcnt(11)
    s_waitcnt lgkmcnt(10)
    v_mfma_f32_32x32x16_bf16 v[112:127], v[224:227], v[184:187], v[112:127]
    ds_read_b64_tr_b16 v[248:249], v68 offset:37888
    ds_read_b64_tr_b16 v[250:251], v68 offset:38400
    s_waitcnt lgkmcnt(10)
    v_mfma_f32_32x32x16_bf16 v[128:143], v[228:231], v[184:187], v[128:143]
    ds_read_b64_tr_b16 v[224:225], v69 offset:37888
    ds_read_b64_tr_b16 v[226:227], v69 offset:38400
    s_waitcnt lgkmcnt(10)
    v_mfma_f32_32x32x16_bf16 v[80:95], v[232:235], v[184:187], v[80:95]
    ds_read_b64_tr_b16 v[228:229], v68 offset:29696
    ds_read_b64_tr_b16 v[230:231], v68 offset:30208
    s_waitcnt lgkmcnt(10)
    v_mfma_f32_32x32x16_bf16 v[96:111], v[236:239], v[184:187], v[96:111]
    ds_read_b64_tr_b16 v[232:233], v69 offset:29696
    ds_read_b64_tr_b16 v[234:235], v69 offset:30208
    s_waitcnt lgkmcnt(10)
    v_mfma_f32_32x32x16_bf16 v[144:159], v[240:243], v[184:187], v[144:159]
    ds_read_b64_tr_b16 v[236:237], v68 offset:46080
    ds_read_b64_tr_b16 v[238:239], v68 offset:46592
    s_waitcnt lgkmcnt(10)
    v_mfma_f32_32x32x16_bf16 v[160:175], v[244:247], v[184:187], v[160:175]
    ds_read_b64_tr_b16 v[240:241], v69 offset:46080
    ds_read_b64_tr_b16 v[242:243], v69 offset:46592
    buffer_load_dwordx4 v[184:187], v2, s[32:35], s16 offen offset:2048 sc1
    s_waitcnt vmcnt(11)
    s_waitcnt lgkmcnt(10)
    v_mfma_f32_32x32x16_bf16 v[112:127], v[248:251], v[188:191], v[112:127]
    s_barrier
    ds_read_b64_tr_b16 v[244:245], v70 offset:8192
    ds_read_b64_tr_b16 v[246:247], v70 offset:8704
    s_waitcnt lgkmcnt(10)
    v_mfma_f32_32x32x16_bf16 v[128:143], v[224:227], v[188:191], v[128:143]
    ds_read_b64_tr_b16 v[248:249], v71 offset:8192
    ds_read_b64_tr_b16 v[250:251], v71 offset:8704
    s_waitcnt lgkmcnt(10)
    v_mfma_f32_32x32x16_bf16 v[80:95], v[228:231], v[188:191], v[80:95]
    ds_read_b64_tr_b16 v[224:225], v70
    ds_read_b64_tr_b16 v[226:227], v70 offset:512
    s_waitcnt lgkmcnt(10)
    v_mfma_f32_32x32x16_bf16 v[96:111], v[232:235], v[188:191], v[96:111]
    ds_read_b64_tr_b16 v[228:229], v71
    ds_read_b64_tr_b16 v[230:231], v71 offset:512
    s_waitcnt lgkmcnt(10)
    v_mfma_f32_32x32x16_bf16 v[144:159], v[236:239], v[188:191], v[144:159]
    ds_read_b64_tr_b16 v[232:233], v70 offset:16384
    ds_read_b64_tr_b16 v[234:235], v70 offset:16896
    s_waitcnt lgkmcnt(10)
    v_mfma_f32_32x32x16_bf16 v[160:175], v[240:243], v[188:191], v[160:175]
    ds_read_b64_tr_b16 v[236:237], v71 offset:16384
    ds_read_b64_tr_b16 v[238:239], v71 offset:16896
    buffer_load_dwordx4 v[188:191], v2, s[32:35], s16 offen offset:3072 sc1
    s_waitcnt vmcnt(11)
    s_waitcnt lgkmcnt(10)
    v_mfma_f32_32x32x16_bf16 v[112:127], v[244:247], v[192:195], v[112:127]
    ds_read_b64_tr_b16 v[240:241], v70 offset:9216
    ds_read_b64_tr_b16 v[242:243], v70 offset:9728
    s_waitcnt lgkmcnt(10)
    v_mfma_f32_32x32x16_bf16 v[128:143], v[248:251], v[192:195], v[128:143]
    ds_read_b64_tr_b16 v[244:245], v71 offset:9216
    ds_read_b64_tr_b16 v[246:247], v71 offset:9728
    s_waitcnt lgkmcnt(10)
    v_mfma_f32_32x32x16_bf16 v[80:95], v[224:227], v[192:195], v[80:95]
    ds_read_b64_tr_b16 v[248:249], v70 offset:1024
    ds_read_b64_tr_b16 v[250:251], v70 offset:1536
    s_waitcnt lgkmcnt(10)
    v_mfma_f32_32x32x16_bf16 v[96:111], v[228:231], v[192:195], v[96:111]
    ds_read_b64_tr_b16 v[224:225], v71 offset:1024
    ds_read_b64_tr_b16 v[226:227], v71 offset:1536
    s_waitcnt lgkmcnt(10)
    v_mfma_f32_32x32x16_bf16 v[144:159], v[232:235], v[192:195], v[144:159]
    ds_read_b64_tr_b16 v[228:229], v70 offset:17408
    ds_read_b64_tr_b16 v[230:231], v70 offset:17920
    s_waitcnt lgkmcnt(10)
    v_mfma_f32_32x32x16_bf16 v[160:175], v[236:239], v[192:195], v[160:175]
    ds_read_b64_tr_b16 v[232:233], v71 offset:17408
    ds_read_b64_tr_b16 v[234:235], v71 offset:17920
    s_add_u32 s96, s85, 7
    s_and_b32 s97, s96, 15
    s_lshl_b32 s98, s97, 14
    s_add_u32 s16, s98, s15
    buffer_load_dwordx4 v[192:195], v2, s[32:35], s16 offen sc1
    s_waitcnt vmcnt(11)
    s_waitcnt lgkmcnt(10)
    v_mfma_f32_32x32x16_bf16 v[112:127], v[240:243], v[196:199], v[112:127]
    ds_read_b64_tr_b16 v[236:237], v70 offset:12288
    ds_read_b64_tr_b16 v[238:239], v70 offset:12800
    s_waitcnt lgkmcnt(10)
    v_mfma_f32_32x32x16_bf16 v[128:143], v[244:247], v[196:199], v[128:143]
    ds_read_b64_tr_b16 v[240:241], v71 offset:12288
    ds_read_b64_tr_b16 v[242:243], v71 offset:12800
    s_waitcnt lgkmcnt(10)
    v_mfma_f32_32x32x16_bf16 v[80:95], v[248:251], v[196:199], v[80:95]
    ds_read_b64_tr_b16 v[244:245], v70 offset:4096
    ds_read_b64_tr_b16 v[246:247], v70 offset:4608
    s_waitcnt lgkmcnt(10)
    v_mfma_f32_32x32x16_bf16 v[96:111], v[224:227], v[196:199], v[96:111]
    ds_read_b64_tr_b16 v[248:249], v71 offset:4096
    ds_read_b64_tr_b16 v[250:251], v71 offset:4608
    s_waitcnt lgkmcnt(10)
    v_mfma_f32_32x32x16_bf16 v[144:159], v[228:231], v[196:199], v[144:159]
    ds_read_b64_tr_b16 v[224:225], v70 offset:20480
    ds_read_b64_tr_b16 v[226:227], v70 offset:20992
    s_waitcnt lgkmcnt(10)
    v_mfma_f32_32x32x16_bf16 v[160:175], v[232:235], v[196:199], v[160:175]
    ds_read_b64_tr_b16 v[228:229], v71 offset:20480
    ds_read_b64_tr_b16 v[230:231], v71 offset:20992
    buffer_load_dwordx4 v[196:199], v2, s[32:35], s16 offen offset:1024 sc1
    s_waitcnt vmcnt(11)
    s_waitcnt lgkmcnt(10)
    v_mfma_f32_32x32x16_bf16 v[112:127], v[236:239], v[200:203], v[112:127]
    ds_read_b64_tr_b16 v[232:233], v70 offset:13312
    ds_read_b64_tr_b16 v[234:235], v70 offset:13824
    s_waitcnt lgkmcnt(10)
    v_mfma_f32_32x32x16_bf16 v[128:143], v[240:243], v[200:203], v[128:143]
    ds_read_b64_tr_b16 v[236:237], v71 offset:13312
    ds_read_b64_tr_b16 v[238:239], v71 offset:13824
    s_waitcnt lgkmcnt(10)
    v_mfma_f32_32x32x16_bf16 v[80:95], v[244:247], v[200:203], v[80:95]
    ds_read_b64_tr_b16 v[240:241], v70 offset:5120
    ds_read_b64_tr_b16 v[242:243], v70 offset:5632
    s_waitcnt lgkmcnt(10)
    v_mfma_f32_32x32x16_bf16 v[96:111], v[248:251], v[200:203], v[96:111]
    ds_read_b64_tr_b16 v[244:245], v71 offset:5120
    ds_read_b64_tr_b16 v[246:247], v71 offset:5632
    s_waitcnt lgkmcnt(10)
    v_mfma_f32_32x32x16_bf16 v[144:159], v[224:227], v[200:203], v[144:159]
    ds_read_b64_tr_b16 v[248:249], v70 offset:21504
    ds_read_b64_tr_b16 v[250:251], v70 offset:22016
    s_waitcnt lgkmcnt(10)
    v_mfma_f32_32x32x16_bf16 v[160:175], v[228:231], v[200:203], v[160:175]
    ds_read_b64_tr_b16 v[224:225], v71 offset:21504
    ds_read_b64_tr_b16 v[226:227], v71 offset:22016
    buffer_load_dwordx4 v[200:203], v2, s[32:35], s16 offen offset:2048 sc1
    s_waitcnt vmcnt(11)
    s_waitcnt lgkmcnt(10)
    v_mfma_f32_32x32x16_bf16 v[112:127], v[232:235], v[204:207], v[112:127]
    s_barrier
    ds_read_b64_tr_b16 v[228:229], v70 offset:32768
    ds_read_b64_tr_b16 v[230:231], v70 offset:33280
    s_waitcnt lgkmcnt(10)
    v_mfma_f32_32x32x16_bf16 v[128:143], v[236:239], v[204:207], v[128:143]
    ds_read_b64_tr_b16 v[232:233], v71 offset:32768
    ds_read_b64_tr_b16 v[234:235], v71 offset:33280
    s_waitcnt lgkmcnt(10)
    v_mfma_f32_32x32x16_bf16 v[80:95], v[240:243], v[204:207], v[80:95]
    ds_read_b64_tr_b16 v[236:237], v70 offset:24576
    ds_read_b64_tr_b16 v[238:239], v70 offset:25088
    s_waitcnt lgkmcnt(10)
    v_mfma_f32_32x32x16_bf16 v[96:111], v[244:247], v[204:207], v[96:111]
    ds_read_b64_tr_b16 v[240:241], v71 offset:24576
    ds_read_b64_tr_b16 v[242:243], v71 offset:25088
    s_waitcnt lgkmcnt(10)
    v_mfma_f32_32x32x16_bf16 v[144:159], v[248:251], v[204:207], v[144:159]
    ds_read_b64_tr_b16 v[244:245], v70 offset:40960
    ds_read_b64_tr_b16 v[246:247], v70 offset:41472
    s_waitcnt lgkmcnt(10)
    v_mfma_f32_32x32x16_bf16 v[160:175], v[224:227], v[204:207], v[160:175]
    ds_read_b64_tr_b16 v[248:249], v71 offset:40960
    ds_read_b64_tr_b16 v[250:251], v71 offset:41472
    buffer_load_dwordx4 v[204:207], v2, s[32:35], s16 offen offset:3072 sc1
    s_waitcnt vmcnt(11)
    s_waitcnt lgkmcnt(10)
    v_mfma_f32_32x32x16_bf16 v[112:127], v[228:231], v[208:211], v[112:127]
    ds_read_b64_tr_b16 v[224:225], v70 offset:33792
    ds_read_b64_tr_b16 v[226:227], v70 offset:34304
    s_waitcnt lgkmcnt(10)
    v_mfma_f32_32x32x16_bf16 v[128:143], v[232:235], v[208:211], v[128:143]
    ds_read_b64_tr_b16 v[228:229], v71 offset:33792
    ds_read_b64_tr_b16 v[230:231], v71 offset:34304
    s_waitcnt lgkmcnt(10)
    v_mfma_f32_32x32x16_bf16 v[80:95], v[236:239], v[208:211], v[80:95]
    ds_read_b64_tr_b16 v[232:233], v70 offset:25600
    ds_read_b64_tr_b16 v[234:235], v70 offset:26112
    s_waitcnt lgkmcnt(10)
    v_mfma_f32_32x32x16_bf16 v[96:111], v[240:243], v[208:211], v[96:111]
    ds_read_b64_tr_b16 v[236:237], v71 offset:25600
    ds_read_b64_tr_b16 v[238:239], v71 offset:26112
    s_waitcnt lgkmcnt(10)
    v_mfma_f32_32x32x16_bf16 v[144:159], v[244:247], v[208:211], v[144:159]
    ds_read_b64_tr_b16 v[240:241], v70 offset:41984
    ds_read_b64_tr_b16 v[242:243], v70 offset:42496
    s_waitcnt lgkmcnt(10)
    v_mfma_f32_32x32x16_bf16 v[160:175], v[248:251], v[208:211], v[160:175]
    ds_read_b64_tr_b16 v[244:245], v71 offset:41984
    ds_read_b64_tr_b16 v[246:247], v71 offset:42496
    s_add_u32 s96, s85, 8
    s_and_b32 s97, s96, 15
    s_lshl_b32 s98, s97, 14
    s_add_u32 s16, s98, s15
    buffer_load_dwordx4 v[208:211], v2, s[32:35], s16 offen sc1
    s_waitcnt vmcnt(11)
    s_waitcnt lgkmcnt(10)
    v_mfma_f32_32x32x16_bf16 v[112:127], v[224:227], v[212:215], v[112:127]
    ds_read_b64_tr_b16 v[248:249], v70 offset:36864
    ds_read_b64_tr_b16 v[250:251], v70 offset:37376
    s_waitcnt lgkmcnt(10)
    v_mfma_f32_32x32x16_bf16 v[128:143], v[228:231], v[212:215], v[128:143]
    ds_read_b64_tr_b16 v[224:225], v71 offset:36864
    ds_read_b64_tr_b16 v[226:227], v71 offset:37376
    s_waitcnt lgkmcnt(10)
    v_mfma_f32_32x32x16_bf16 v[80:95], v[232:235], v[212:215], v[80:95]
    ds_read_b64_tr_b16 v[228:229], v70 offset:28672
    ds_read_b64_tr_b16 v[230:231], v70 offset:29184
    s_waitcnt lgkmcnt(10)
    v_mfma_f32_32x32x16_bf16 v[96:111], v[236:239], v[212:215], v[96:111]
    ds_read_b64_tr_b16 v[232:233], v71 offset:28672
    ds_read_b64_tr_b16 v[234:235], v71 offset:29184
    s_waitcnt lgkmcnt(10)
    v_mfma_f32_32x32x16_bf16 v[144:159], v[240:243], v[212:215], v[144:159]
    ds_read_b64_tr_b16 v[236:237], v70 offset:45056
    ds_read_b64_tr_b16 v[238:239], v70 offset:45568
    s_waitcnt lgkmcnt(10)
    v_mfma_f32_32x32x16_bf16 v[160:175], v[244:247], v[212:215], v[160:175]
    ds_read_b64_tr_b16 v[240:241], v71 offset:45056
    ds_read_b64_tr_b16 v[242:243], v71 offset:45568
    buffer_load_dwordx4 v[212:215], v2, s[32:35], s16 offen offset:1024 sc1
    s_waitcnt vmcnt(11)
    s_waitcnt lgkmcnt(10)
    v_mfma_f32_32x32x16_bf16 v[112:127], v[248:251], v[216:219], v[112:127]
    ds_read_b64_tr_b16 v[244:245], v70 offset:37888
    ds_read_b64_tr_b16 v[246:247], v70 offset:38400
    s_waitcnt lgkmcnt(10)
    v_mfma_f32_32x32x16_bf16 v[128:143], v[224:227], v[216:219], v[128:143]
    ds_read_b64_tr_b16 v[248:249], v71 offset:37888
    ds_read_b64_tr_b16 v[250:251], v71 offset:38400
    s_waitcnt lgkmcnt(10)
    v_mfma_f32_32x32x16_bf16 v[80:95], v[228:231], v[216:219], v[80:95]
    ds_read_b64_tr_b16 v[224:225], v70 offset:29696
    ds_read_b64_tr_b16 v[226:227], v70 offset:30208
    s_waitcnt lgkmcnt(10)
    v_mfma_f32_32x32x16_bf16 v[96:111], v[232:235], v[216:219], v[96:111]
    ds_read_b64_tr_b16 v[228:229], v71 offset:29696
    ds_read_b64_tr_b16 v[230:231], v71 offset:30208
    s_waitcnt lgkmcnt(10)
    v_mfma_f32_32x32x16_bf16 v[144:159], v[236:239], v[216:219], v[144:159]
    ds_read_b64_tr_b16 v[232:233], v70 offset:46080
    ds_read_b64_tr_b16 v[234:235], v70 offset:46592
    s_waitcnt lgkmcnt(10)
    v_mfma_f32_32x32x16_bf16 v[160:175], v[240:243], v[216:219], v[160:175]
    ds_read_b64_tr_b16 v[236:237], v71 offset:46080
    ds_read_b64_tr_b16 v[238:239], v71 offset:46592
    buffer_load_dwordx4 v[216:219], v2, s[32:35], s16 offen offset:2048 sc1
    s_waitcnt vmcnt(11)
    s_waitcnt lgkmcnt(10)
    v_mfma_f32_32x32x16_bf16 v[112:127], v[244:247], v[220:223], v[112:127]
    s_barrier
    ds_read_b64_tr_b16 v[240:241], v66 offset:8192
    ds_read_b64_tr_b16 v[242:243], v66 offset:8704
    s_waitcnt lgkmcnt(10)
    v_mfma_f32_32x32x16_bf16 v[128:143], v[248:251], v[220:223], v[128:143]
    ds_read_b64_tr_b16 v[244:245], v67 offset:8192
    ds_read_b64_tr_b16 v[246:247], v67 offset:8704
    s_waitcnt lgkmcnt(10)
    v_mfma_f32_32x32x16_bf16 v[80:95], v[224:227], v[220:223], v[80:95]
    ds_read_b64_tr_b16 v[248:249], v66
    ds_read_b64_tr_b16 v[250:251], v66 offset:512
    s_waitcnt lgkmcnt(10)
    v_mfma_f32_32x32x16_bf16 v[96:111], v[228:231], v[220:223], v[96:111]
    ds_read_b64_tr_b16 v[224:225], v67
    ds_read_b64_tr_b16 v[226:227], v67 offset:512
    s_waitcnt lgkmcnt(10)
    v_mfma_f32_32x32x16_bf16 v[144:159], v[232:235], v[220:223], v[144:159]
    ds_read_b64_tr_b16 v[228:229], v66 offset:16384
    ds_read_b64_tr_b16 v[230:231], v66 offset:16896
    s_waitcnt lgkmcnt(10)
    v_mfma_f32_32x32x16_bf16 v[160:175], v[236:239], v[220:223], v[160:175]
    ds_read_b64_tr_b16 v[232:233], v67 offset:16384
    ds_read_b64_tr_b16 v[234:235], v67 offset:16896
    buffer_load_dwordx4 v[220:223], v2, s[32:35], s16 offen offset:3072 sc1
    s_waitcnt vmcnt(11)
    s_waitcnt lgkmcnt(10)
    v_mfma_f32_32x32x16_bf16 v[112:127], v[240:243], v[176:179], v[112:127]
    ds_read_b64_tr_b16 v[236:237], v66 offset:9216
    ds_read_b64_tr_b16 v[238:239], v66 offset:9728
    s_waitcnt lgkmcnt(10)
    v_mfma_f32_32x32x16_bf16 v[128:143], v[244:247], v[176:179], v[128:143]
    ds_read_b64_tr_b16 v[240:241], v67 offset:9216
    ds_read_b64_tr_b16 v[242:243], v67 offset:9728
    s_waitcnt lgkmcnt(10)
    v_mfma_f32_32x32x16_bf16 v[80:95], v[248:251], v[176:179], v[80:95]
    ds_read_b64_tr_b16 v[244:245], v66 offset:1024
    ds_read_b64_tr_b16 v[246:247], v66 offset:1536
    s_waitcnt lgkmcnt(10)
    v_mfma_f32_32x32x16_bf16 v[96:111], v[224:227], v[176:179], v[96:111]
    ds_read_b64_tr_b16 v[248:249], v67 offset:1024
    ds_read_b64_tr_b16 v[250:251], v67 offset:1536
    s_waitcnt lgkmcnt(10)
    v_mfma_f32_32x32x16_bf16 v[144:159], v[228:231], v[176:179], v[144:159]
    ds_read_b64_tr_b16 v[224:225], v66 offset:17408
    ds_read_b64_tr_b16 v[226:227], v66 offset:17920
    s_waitcnt lgkmcnt(10)
    v_mfma_f32_32x32x16_bf16 v[160:175], v[232:235], v[176:179], v[160:175]
    ds_read_b64_tr_b16 v[228:229], v67 offset:17408
    ds_read_b64_tr_b16 v[230:231], v67 offset:17920
    s_add_u32 s96, s85, 9
    s_and_b32 s97, s96, 15
    s_lshl_b32 s98, s97, 14
    s_add_u32 s16, s98, s15
    buffer_load_dwordx4 v[176:179], v2, s[32:35], s16 offen sc1
    s_waitcnt vmcnt(11)
    s_waitcnt lgkmcnt(10)
    v_mfma_f32_32x32x16_bf16 v[112:127], v[236:239], v[180:183], v[112:127]
    ds_read_b64_tr_b16 v[232:233], v66 offset:12288
    ds_read_b64_tr_b16 v[234:235], v66 offset:12800
    s_waitcnt lgkmcnt(10)
    v_mfma_f32_32x32x16_bf16 v[128:143], v[240:243], v[180:183], v[128:143]
    ds_read_b64_tr_b16 v[236:237], v67 offset:12288
    ds_read_b64_tr_b16 v[238:239], v67 offset:12800
    s_waitcnt lgkmcnt(10)
    v_mfma_f32_32x32x16_bf16 v[80:95], v[244:247], v[180:183], v[80:95]
    ds_read_b64_tr_b16 v[240:241], v66 offset:4096
    ds_read_b64_tr_b16 v[242:243], v66 offset:4608
    s_waitcnt lgkmcnt(10)
    v_mfma_f32_32x32x16_bf16 v[96:111], v[248:251], v[180:183], v[96:111]
    ds_read_b64_tr_b16 v[244:245], v67 offset:4096
    ds_read_b64_tr_b16 v[246:247], v67 offset:4608
    s_waitcnt lgkmcnt(10)
    v_mfma_f32_32x32x16_bf16 v[144:159], v[224:227], v[180:183], v[144:159]
    ds_read_b64_tr_b16 v[248:249], v66 offset:20480
    ds_read_b64_tr_b16 v[250:251], v66 offset:20992
    s_waitcnt lgkmcnt(10)
    v_mfma_f32_32x32x16_bf16 v[160:175], v[228:231], v[180:183], v[160:175]
    ds_read_b64_tr_b16 v[224:225], v67 offset:20480
    ds_read_b64_tr_b16 v[226:227], v67 offset:20992
    buffer_load_dwordx4 v[180:183], v2, s[32:35], s16 offen offset:1024 sc1
    s_waitcnt vmcnt(11)
    s_waitcnt lgkmcnt(10)
    v_mfma_f32_32x32x16_bf16 v[112:127], v[232:235], v[184:187], v[112:127]
    ds_read_b64_tr_b16 v[228:229], v66 offset:13312
    ds_read_b64_tr_b16 v[230:231], v66 offset:13824
    s_waitcnt lgkmcnt(10)
    v_mfma_f32_32x32x16_bf16 v[128:143], v[236:239], v[184:187], v[128:143]
    ds_read_b64_tr_b16 v[232:233], v67 offset:13312
    ds_read_b64_tr_b16 v[234:235], v67 offset:13824
    s_waitcnt lgkmcnt(10)
    v_mfma_f32_32x32x16_bf16 v[80:95], v[240:243], v[184:187], v[80:95]
    ds_read_b64_tr_b16 v[236:237], v66 offset:5120
    ds_read_b64_tr_b16 v[238:239], v66 offset:5632
    s_waitcnt lgkmcnt(10)
    v_mfma_f32_32x32x16_bf16 v[96:111], v[244:247], v[184:187], v[96:111]
    ds_read_b64_tr_b16 v[240:241], v67 offset:5120
    ds_read_b64_tr_b16 v[242:243], v67 offset:5632
    s_waitcnt lgkmcnt(10)
    v_mfma_f32_32x32x16_bf16 v[144:159], v[248:251], v[184:187], v[144:159]
    ds_read_b64_tr_b16 v[244:245], v66 offset:21504
    ds_read_b64_tr_b16 v[246:247], v66 offset:22016
    s_waitcnt lgkmcnt(10)
    v_mfma_f32_32x32x16_bf16 v[160:175], v[224:227], v[184:187], v[160:175]
    ds_read_b64_tr_b16 v[248:249], v67 offset:21504
    ds_read_b64_tr_b16 v[250:251], v67 offset:22016
    buffer_load_dwordx4 v[184:187], v2, s[32:35], s16 offen offset:2048 sc1
    s_waitcnt vmcnt(11)
    s_waitcnt lgkmcnt(10)
    v_mfma_f32_32x32x16_bf16 v[112:127], v[228:231], v[188:191], v[112:127]
    s_barrier
    ds_read_b64_tr_b16 v[224:225], v66 offset:32768
    ds_read_b64_tr_b16 v[226:227], v66 offset:33280
    s_waitcnt lgkmcnt(10)
    v_mfma_f32_32x32x16_bf16 v[128:143], v[232:235], v[188:191], v[128:143]
    ds_read_b64_tr_b16 v[228:229], v67 offset:32768
    ds_read_b64_tr_b16 v[230:231], v67 offset:33280
    s_waitcnt lgkmcnt(10)
    v_mfma_f32_32x32x16_bf16 v[80:95], v[236:239], v[188:191], v[80:95]
    ds_read_b64_tr_b16 v[232:233], v66 offset:24576
    ds_read_b64_tr_b16 v[234:235], v66 offset:25088
    s_waitcnt lgkmcnt(10)
    v_mfma_f32_32x32x16_bf16 v[96:111], v[240:243], v[188:191], v[96:111]
    ds_read_b64_tr_b16 v[236:237], v67 offset:24576
    ds_read_b64_tr_b16 v[238:239], v67 offset:25088
    s_waitcnt lgkmcnt(10)
    v_mfma_f32_32x32x16_bf16 v[144:159], v[244:247], v[188:191], v[144:159]
    ds_read_b64_tr_b16 v[240:241], v66 offset:40960
    ds_read_b64_tr_b16 v[242:243], v66 offset:41472
    s_waitcnt lgkmcnt(10)
    v_mfma_f32_32x32x16_bf16 v[160:175], v[248:251], v[188:191], v[160:175]
    ds_read_b64_tr_b16 v[244:245], v67 offset:40960
    ds_read_b64_tr_b16 v[246:247], v67 offset:41472
    buffer_load_dwordx4 v[188:191], v2, s[32:35], s16 offen offset:3072 sc1
    s_waitcnt vmcnt(11)
    s_waitcnt lgkmcnt(10)
    v_mfma_f32_32x32x16_bf16 v[112:127], v[224:227], v[192:195], v[112:127]
    ds_read_b64_tr_b16 v[248:249], v66 offset:33792
    ds_read_b64_tr_b16 v[250:251], v66 offset:34304
    s_waitcnt lgkmcnt(10)
    v_mfma_f32_32x32x16_bf16 v[128:143], v[228:231], v[192:195], v[128:143]
    ds_read_b64_tr_b16 v[224:225], v67 offset:33792
    ds_read_b64_tr_b16 v[226:227], v67 offset:34304
    s_waitcnt lgkmcnt(10)
    v_mfma_f32_32x32x16_bf16 v[80:95], v[232:235], v[192:195], v[80:95]
    ds_read_b64_tr_b16 v[228:229], v66 offset:25600
    ds_read_b64_tr_b16 v[230:231], v66 offset:26112
    s_waitcnt lgkmcnt(10)
    v_mfma_f32_32x32x16_bf16 v[96:111], v[236:239], v[192:195], v[96:111]
    ds_read_b64_tr_b16 v[232:233], v67 offset:25600
    ds_read_b64_tr_b16 v[234:235], v67 offset:26112
    s_waitcnt lgkmcnt(10)
    v_mfma_f32_32x32x16_bf16 v[144:159], v[240:243], v[192:195], v[144:159]
    ds_read_b64_tr_b16 v[236:237], v66 offset:41984
    ds_read_b64_tr_b16 v[238:239], v66 offset:42496
    s_waitcnt lgkmcnt(10)
    v_mfma_f32_32x32x16_bf16 v[160:175], v[244:247], v[192:195], v[160:175]
    ds_read_b64_tr_b16 v[240:241], v67 offset:41984
    ds_read_b64_tr_b16 v[242:243], v67 offset:42496
    s_add_u32 s96, s85, 10
    s_and_b32 s97, s96, 15
    s_lshl_b32 s98, s97, 14
    s_add_u32 s16, s98, s15
    buffer_load_dwordx4 v[192:195], v2, s[32:35], s16 offen sc1
    s_waitcnt vmcnt(11)
    s_waitcnt lgkmcnt(10)
    v_mfma_f32_32x32x16_bf16 v[112:127], v[248:251], v[196:199], v[112:127]
    ds_read_b64_tr_b16 v[244:245], v66 offset:36864
    ds_read_b64_tr_b16 v[246:247], v66 offset:37376
    s_waitcnt lgkmcnt(10)
    v_mfma_f32_32x32x16_bf16 v[128:143], v[224:227], v[196:199], v[128:143]
    ds_read_b64_tr_b16 v[248:249], v67 offset:36864
    ds_read_b64_tr_b16 v[250:251], v67 offset:37376
    s_waitcnt lgkmcnt(10)
    v_mfma_f32_32x32x16_bf16 v[80:95], v[228:231], v[196:199], v[80:95]
    ds_read_b64_tr_b16 v[224:225], v66 offset:28672
    ds_read_b64_tr_b16 v[226:227], v66 offset:29184
    s_waitcnt lgkmcnt(10)
    v_mfma_f32_32x32x16_bf16 v[96:111], v[232:235], v[196:199], v[96:111]
    ds_read_b64_tr_b16 v[228:229], v67 offset:28672
    ds_read_b64_tr_b16 v[230:231], v67 offset:29184
    s_waitcnt lgkmcnt(10)
    v_mfma_f32_32x32x16_bf16 v[144:159], v[236:239], v[196:199], v[144:159]
    ds_read_b64_tr_b16 v[232:233], v66 offset:45056
    ds_read_b64_tr_b16 v[234:235], v66 offset:45568
    s_waitcnt lgkmcnt(10)
    v_mfma_f32_32x32x16_bf16 v[160:175], v[240:243], v[196:199], v[160:175]
    ds_read_b64_tr_b16 v[236:237], v67 offset:45056
    ds_read_b64_tr_b16 v[238:239], v67 offset:45568
    buffer_load_dwordx4 v[196:199], v2, s[32:35], s16 offen offset:1024 sc1
    s_waitcnt vmcnt(11)
    s_waitcnt lgkmcnt(10)
    v_mfma_f32_32x32x16_bf16 v[112:127], v[244:247], v[200:203], v[112:127]
    ds_read_b64_tr_b16 v[240:241], v66 offset:37888
    ds_read_b64_tr_b16 v[242:243], v66 offset:38400
    s_waitcnt lgkmcnt(10)
    v_mfma_f32_32x32x16_bf16 v[128:143], v[248:251], v[200:203], v[128:143]
    ds_read_b64_tr_b16 v[244:245], v67 offset:37888
    ds_read_b64_tr_b16 v[246:247], v67 offset:38400
    s_waitcnt lgkmcnt(10)
    v_mfma_f32_32x32x16_bf16 v[80:95], v[224:227], v[200:203], v[80:95]
    ds_read_b64_tr_b16 v[248:249], v66 offset:29696
    ds_read_b64_tr_b16 v[250:251], v66 offset:30208
    s_waitcnt lgkmcnt(10)
    v_mfma_f32_32x32x16_bf16 v[96:111], v[228:231], v[200:203], v[96:111]
    ds_read_b64_tr_b16 v[224:225], v67 offset:29696
    ds_read_b64_tr_b16 v[226:227], v67 offset:30208
    s_waitcnt lgkmcnt(10)
    v_mfma_f32_32x32x16_bf16 v[144:159], v[232:235], v[200:203], v[144:159]
    ds_read_b64_tr_b16 v[228:229], v66 offset:46080
    ds_read_b64_tr_b16 v[230:231], v66 offset:46592
    s_waitcnt lgkmcnt(10)
    v_mfma_f32_32x32x16_bf16 v[160:175], v[236:239], v[200:203], v[160:175]
    ds_read_b64_tr_b16 v[232:233], v67 offset:46080
    ds_read_b64_tr_b16 v[234:235], v67 offset:46592
    buffer_load_dwordx4 v[200:203], v2, s[32:35], s16 offen offset:2048 sc1
    s_waitcnt vmcnt(11)
    s_waitcnt lgkmcnt(10)
    v_mfma_f32_32x32x16_bf16 v[112:127], v[240:243], v[204:207], v[112:127]
    s_barrier
    ds_read_b64_tr_b16 v[236:237], v68 offset:8192
    ds_read_b64_tr_b16 v[238:239], v68 offset:8704
    s_waitcnt lgkmcnt(10)
    v_mfma_f32_32x32x16_bf16 v[128:143], v[244:247], v[204:207], v[128:143]
    ds_read_b64_tr_b16 v[240:241], v69 offset:8192
    ds_read_b64_tr_b16 v[242:243], v69 offset:8704
    s_waitcnt lgkmcnt(10)
    v_mfma_f32_32x32x16_bf16 v[80:95], v[248:251], v[204:207], v[80:95]
    ds_read_b64_tr_b16 v[244:245], v68
    ds_read_b64_tr_b16 v[246:247], v68 offset:512
    s_waitcnt lgkmcnt(10)
    v_mfma_f32_32x32x16_bf16 v[96:111], v[224:227], v[204:207], v[96:111]
    ds_read_b64_tr_b16 v[248:249], v69
    ds_read_b64_tr_b16 v[250:251], v69 offset:512
    s_waitcnt lgkmcnt(10)
    v_mfma_f32_32x32x16_bf16 v[144:159], v[228:231], v[204:207], v[144:159]
    ds_read_b64_tr_b16 v[224:225], v68 offset:16384
    ds_read_b64_tr_b16 v[226:227], v68 offset:16896
    s_waitcnt lgkmcnt(10)
    v_mfma_f32_32x32x16_bf16 v[160:175], v[232:235], v[204:207], v[160:175]
    ds_read_b64_tr_b16 v[228:229], v69 offset:16384
    ds_read_b64_tr_b16 v[230:231], v69 offset:16896
    buffer_load_dwordx4 v[204:207], v2, s[32:35], s16 offen offset:3072 sc1
    s_waitcnt vmcnt(11)
    s_waitcnt lgkmcnt(10)
    v_mfma_f32_32x32x16_bf16 v[112:127], v[236:239], v[208:211], v[112:127]
    ds_read_b64_tr_b16 v[232:233], v68 offset:9216
    ds_read_b64_tr_b16 v[234:235], v68 offset:9728
    s_waitcnt lgkmcnt(10)
    v_mfma_f32_32x32x16_bf16 v[128:143], v[240:243], v[208:211], v[128:143]
    ds_read_b64_tr_b16 v[236:237], v69 offset:9216
    ds_read_b64_tr_b16 v[238:239], v69 offset:9728
    s_waitcnt lgkmcnt(10)
    v_mfma_f32_32x32x16_bf16 v[80:95], v[244:247], v[208:211], v[80:95]
    ds_read_b64_tr_b16 v[240:241], v68 offset:1024
    ds_read_b64_tr_b16 v[242:243], v68 offset:1536
    s_waitcnt lgkmcnt(10)
    v_mfma_f32_32x32x16_bf16 v[96:111], v[248:251], v[208:211], v[96:111]
    ds_read_b64_tr_b16 v[244:245], v69 offset:1024
    ds_read_b64_tr_b16 v[246:247], v69 offset:1536
    s_waitcnt lgkmcnt(10)
    v_mfma_f32_32x32x16_bf16 v[144:159], v[224:227], v[208:211], v[144:159]
    ds_read_b64_tr_b16 v[248:249], v68 offset:17408
    ds_read_b64_tr_b16 v[250:251], v68 offset:17920
    s_waitcnt lgkmcnt(10)
    v_mfma_f32_32x32x16_bf16 v[160:175], v[228:231], v[208:211], v[160:175]
    ds_read_b64_tr_b16 v[224:225], v69 offset:17408
    ds_read_b64_tr_b16 v[226:227], v69 offset:17920
    s_add_u32 s96, s85, 11
    s_and_b32 s97, s96, 15
    s_lshl_b32 s98, s97, 14
    s_add_u32 s16, s98, s15
    buffer_load_dwordx4 v[208:211], v2, s[32:35], s16 offen sc1
    s_waitcnt vmcnt(11)
    s_waitcnt lgkmcnt(10)
    v_mfma_f32_32x32x16_bf16 v[112:127], v[232:235], v[212:215], v[112:127]
    ds_read_b64_tr_b16 v[228:229], v68 offset:12288
    ds_read_b64_tr_b16 v[230:231], v68 offset:12800
    s_waitcnt lgkmcnt(10)
    v_mfma_f32_32x32x16_bf16 v[128:143], v[236:239], v[212:215], v[128:143]
    ds_read_b64_tr_b16 v[232:233], v69 offset:12288
    ds_read_b64_tr_b16 v[234:235], v69 offset:12800
    s_waitcnt lgkmcnt(10)
    v_mfma_f32_32x32x16_bf16 v[80:95], v[240:243], v[212:215], v[80:95]
    ds_read_b64_tr_b16 v[236:237], v68 offset:4096
    ds_read_b64_tr_b16 v[238:239], v68 offset:4608
    s_waitcnt lgkmcnt(10)
    v_mfma_f32_32x32x16_bf16 v[96:111], v[244:247], v[212:215], v[96:111]
    ds_read_b64_tr_b16 v[240:241], v69 offset:4096
    ds_read_b64_tr_b16 v[242:243], v69 offset:4608
    s_waitcnt lgkmcnt(10)
    v_mfma_f32_32x32x16_bf16 v[144:159], v[248:251], v[212:215], v[144:159]
    ds_read_b64_tr_b16 v[244:245], v68 offset:20480
    ds_read_b64_tr_b16 v[246:247], v68 offset:20992
    s_waitcnt lgkmcnt(10)
    v_mfma_f32_32x32x16_bf16 v[160:175], v[224:227], v[212:215], v[160:175]
    ds_read_b64_tr_b16 v[248:249], v69 offset:20480
    ds_read_b64_tr_b16 v[250:251], v69 offset:20992
    buffer_load_dwordx4 v[212:215], v2, s[32:35], s16 offen offset:1024 sc1
    s_waitcnt vmcnt(11)
    s_waitcnt lgkmcnt(10)
    v_mfma_f32_32x32x16_bf16 v[112:127], v[228:231], v[216:219], v[112:127]
    ds_read_b64_tr_b16 v[224:225], v68 offset:13312
    ds_read_b64_tr_b16 v[226:227], v68 offset:13824
    s_waitcnt lgkmcnt(10)
    v_mfma_f32_32x32x16_bf16 v[128:143], v[232:235], v[216:219], v[128:143]
    ds_read_b64_tr_b16 v[228:229], v69 offset:13312
    ds_read_b64_tr_b16 v[230:231], v69 offset:13824
    s_waitcnt lgkmcnt(10)
    v_mfma_f32_32x32x16_bf16 v[80:95], v[236:239], v[216:219], v[80:95]
    ds_read_b64_tr_b16 v[232:233], v68 offset:5120
    ds_read_b64_tr_b16 v[234:235], v68 offset:5632
    s_waitcnt lgkmcnt(10)
    v_mfma_f32_32x32x16_bf16 v[96:111], v[240:243], v[216:219], v[96:111]
    ds_read_b64_tr_b16 v[236:237], v69 offset:5120
    ds_read_b64_tr_b16 v[238:239], v69 offset:5632
    s_waitcnt lgkmcnt(10)
    v_mfma_f32_32x32x16_bf16 v[144:159], v[244:247], v[216:219], v[144:159]
    ds_read_b64_tr_b16 v[240:241], v68 offset:21504
    ds_read_b64_tr_b16 v[242:243], v68 offset:22016
    s_waitcnt lgkmcnt(10)
    v_mfma_f32_32x32x16_bf16 v[160:175], v[248:251], v[216:219], v[160:175]
    ds_read_b64_tr_b16 v[244:245], v69 offset:21504
    ds_read_b64_tr_b16 v[246:247], v69 offset:22016
    buffer_load_dwordx4 v[216:219], v2, s[32:35], s16 offen offset:2048 sc1
    s_waitcnt vmcnt(11)
    s_waitcnt lgkmcnt(10)
    v_mfma_f32_32x32x16_bf16 v[112:127], v[224:227], v[220:223], v[112:127]
    s_barrier
    ds_read_b64_tr_b16 v[248:249], v68 offset:32768
    ds_read_b64_tr_b16 v[250:251], v68 offset:33280
    s_waitcnt lgkmcnt(10)
    v_mfma_f32_32x32x16_bf16 v[128:143], v[228:231], v[220:223], v[128:143]
    ds_read_b64_tr_b16 v[224:225], v69 offset:32768
    ds_read_b64_tr_b16 v[226:227], v69 offset:33280
    s_waitcnt lgkmcnt(10)
    v_mfma_f32_32x32x16_bf16 v[80:95], v[232:235], v[220:223], v[80:95]
    ds_read_b64_tr_b16 v[228:229], v68 offset:24576
    ds_read_b64_tr_b16 v[230:231], v68 offset:25088
    s_waitcnt lgkmcnt(10)
    v_mfma_f32_32x32x16_bf16 v[96:111], v[236:239], v[220:223], v[96:111]
    ds_read_b64_tr_b16 v[232:233], v69 offset:24576
    ds_read_b64_tr_b16 v[234:235], v69 offset:25088
    s_waitcnt lgkmcnt(10)
    v_mfma_f32_32x32x16_bf16 v[144:159], v[240:243], v[220:223], v[144:159]
    ds_read_b64_tr_b16 v[236:237], v68 offset:40960
    ds_read_b64_tr_b16 v[238:239], v68 offset:41472
    s_waitcnt lgkmcnt(10)
    v_mfma_f32_32x32x16_bf16 v[160:175], v[244:247], v[220:223], v[160:175]
    ds_read_b64_tr_b16 v[240:241], v69 offset:40960
    ds_read_b64_tr_b16 v[242:243], v69 offset:41472
    buffer_load_dwordx4 v[220:223], v2, s[32:35], s16 offen offset:3072 sc1
    s_waitcnt vmcnt(11)
    s_waitcnt lgkmcnt(10)
    v_mfma_f32_32x32x16_bf16 v[112:127], v[248:251], v[176:179], v[112:127]
    ds_read_b64_tr_b16 v[244:245], v68 offset:33792
    ds_read_b64_tr_b16 v[246:247], v68 offset:34304
    s_waitcnt lgkmcnt(10)
    v_mfma_f32_32x32x16_bf16 v[128:143], v[224:227], v[176:179], v[128:143]
    ds_read_b64_tr_b16 v[248:249], v69 offset:33792
    ds_read_b64_tr_b16 v[250:251], v69 offset:34304
    s_waitcnt lgkmcnt(10)
    v_mfma_f32_32x32x16_bf16 v[80:95], v[228:231], v[176:179], v[80:95]
    ds_read_b64_tr_b16 v[224:225], v68 offset:25600
    ds_read_b64_tr_b16 v[226:227], v68 offset:26112
    s_waitcnt lgkmcnt(10)
    v_mfma_f32_32x32x16_bf16 v[96:111], v[232:235], v[176:179], v[96:111]
    ds_read_b64_tr_b16 v[228:229], v69 offset:25600
    ds_read_b64_tr_b16 v[230:231], v69 offset:26112
    s_waitcnt lgkmcnt(10)
    v_mfma_f32_32x32x16_bf16 v[144:159], v[236:239], v[176:179], v[144:159]
    ds_read_b64_tr_b16 v[232:233], v68 offset:41984
    ds_read_b64_tr_b16 v[234:235], v68 offset:42496
    s_waitcnt lgkmcnt(10)
    v_mfma_f32_32x32x16_bf16 v[160:175], v[240:243], v[176:179], v[160:175]
    ds_read_b64_tr_b16 v[236:237], v69 offset:41984
    ds_read_b64_tr_b16 v[238:239], v69 offset:42496
    s_add_u32 s96, s85, 12
    s_and_b32 s97, s96, 15
    s_lshl_b32 s98, s97, 14
    s_add_u32 s16, s98, s15
    buffer_load_dwordx4 v[176:179], v2, s[32:35], s16 offen sc1
    s_waitcnt vmcnt(11)
    s_waitcnt lgkmcnt(10)
    v_mfma_f32_32x32x16_bf16 v[112:127], v[244:247], v[180:183], v[112:127]
    ds_read_b64_tr_b16 v[240:241], v68 offset:36864
    ds_read_b64_tr_b16 v[242:243], v68 offset:37376
    s_waitcnt lgkmcnt(10)
    v_mfma_f32_32x32x16_bf16 v[128:143], v[248:251], v[180:183], v[128:143]
    ds_read_b64_tr_b16 v[244:245], v69 offset:36864
    ds_read_b64_tr_b16 v[246:247], v69 offset:37376
    s_waitcnt lgkmcnt(10)
    v_mfma_f32_32x32x16_bf16 v[80:95], v[224:227], v[180:183], v[80:95]
    ds_read_b64_tr_b16 v[248:249], v68 offset:28672
    ds_read_b64_tr_b16 v[250:251], v68 offset:29184
    s_waitcnt lgkmcnt(10)
    v_mfma_f32_32x32x16_bf16 v[96:111], v[228:231], v[180:183], v[96:111]
    ds_read_b64_tr_b16 v[224:225], v69 offset:28672
    ds_read_b64_tr_b16 v[226:227], v69 offset:29184
    s_waitcnt lgkmcnt(10)
    v_mfma_f32_32x32x16_bf16 v[144:159], v[232:235], v[180:183], v[144:159]
    ds_read_b64_tr_b16 v[228:229], v68 offset:45056
    ds_read_b64_tr_b16 v[230:231], v68 offset:45568
    s_waitcnt lgkmcnt(10)
    v_mfma_f32_32x32x16_bf16 v[160:175], v[236:239], v[180:183], v[160:175]
    ds_read_b64_tr_b16 v[232:233], v69 offset:45056
    ds_read_b64_tr_b16 v[234:235], v69 offset:45568
    buffer_load_dwordx4 v[180:183], v2, s[32:35], s16 offen offset:1024 sc1
    s_waitcnt vmcnt(11)
    s_waitcnt lgkmcnt(10)
    v_mfma_f32_32x32x16_bf16 v[112:127], v[240:243], v[184:187], v[112:127]
    ds_read_b64_tr_b16 v[236:237], v68 offset:37888
    ds_read_b64_tr_b16 v[238:239], v68 offset:38400
    s_waitcnt lgkmcnt(10)
    v_mfma_f32_32x32x16_bf16 v[128:143], v[244:247], v[184:187], v[128:143]
    ds_read_b64_tr_b16 v[240:241], v69 offset:37888
    ds_read_b64_tr_b16 v[242:243], v69 offset:38400
    s_waitcnt lgkmcnt(10)
    v_mfma_f32_32x32x16_bf16 v[80:95], v[248:251], v[184:187], v[80:95]
    ds_read_b64_tr_b16 v[244:245], v68 offset:29696
    ds_read_b64_tr_b16 v[246:247], v68 offset:30208
    s_waitcnt lgkmcnt(10)
    v_mfma_f32_32x32x16_bf16 v[96:111], v[224:227], v[184:187], v[96:111]
    ds_read_b64_tr_b16 v[248:249], v69 offset:29696
    ds_read_b64_tr_b16 v[250:251], v69 offset:30208
    s_waitcnt lgkmcnt(10)
    v_mfma_f32_32x32x16_bf16 v[144:159], v[228:231], v[184:187], v[144:159]
    ds_read_b64_tr_b16 v[224:225], v68 offset:46080
    ds_read_b64_tr_b16 v[226:227], v68 offset:46592
    s_waitcnt lgkmcnt(10)
    v_mfma_f32_32x32x16_bf16 v[160:175], v[232:235], v[184:187], v[160:175]
    ds_read_b64_tr_b16 v[228:229], v69 offset:46080
    ds_read_b64_tr_b16 v[230:231], v69 offset:46592
    buffer_load_dwordx4 v[184:187], v2, s[32:35], s16 offen offset:2048 sc1
    s_waitcnt vmcnt(11)
    s_waitcnt lgkmcnt(10)
    v_mfma_f32_32x32x16_bf16 v[112:127], v[236:239], v[188:191], v[112:127]
    s_barrier
    ds_read_b64_tr_b16 v[232:233], v70 offset:8192
    ds_read_b64_tr_b16 v[234:235], v70 offset:8704
    s_waitcnt lgkmcnt(10)
    v_mfma_f32_32x32x16_bf16 v[128:143], v[240:243], v[188:191], v[128:143]
    ds_read_b64_tr_b16 v[236:237], v71 offset:8192
    ds_read_b64_tr_b16 v[238:239], v71 offset:8704
    s_waitcnt lgkmcnt(10)
    v_mfma_f32_32x32x16_bf16 v[80:95], v[244:247], v[188:191], v[80:95]
    ds_read_b64_tr_b16 v[240:241], v70
    ds_read_b64_tr_b16 v[242:243], v70 offset:512
    s_waitcnt lgkmcnt(10)
    v_mfma_f32_32x32x16_bf16 v[96:111], v[248:251], v[188:191], v[96:111]
    ds_read_b64_tr_b16 v[244:245], v71
    ds_read_b64_tr_b16 v[246:247], v71 offset:512
    s_waitcnt lgkmcnt(10)
    v_mfma_f32_32x32x16_bf16 v[144:159], v[224:227], v[188:191], v[144:159]
    ds_read_b64_tr_b16 v[248:249], v70 offset:16384
    ds_read_b64_tr_b16 v[250:251], v70 offset:16896
    s_waitcnt lgkmcnt(10)
    v_mfma_f32_32x32x16_bf16 v[160:175], v[228:231], v[188:191], v[160:175]
    ds_read_b64_tr_b16 v[224:225], v71 offset:16384
    ds_read_b64_tr_b16 v[226:227], v71 offset:16896
    buffer_load_dwordx4 v[188:191], v2, s[32:35], s16 offen offset:3072 sc1
    s_waitcnt vmcnt(11)
    s_waitcnt lgkmcnt(10)
    v_mfma_f32_32x32x16_bf16 v[112:127], v[232:235], v[192:195], v[112:127]
    ds_read_b64_tr_b16 v[228:229], v70 offset:9216
    ds_read_b64_tr_b16 v[230:231], v70 offset:9728
    s_waitcnt lgkmcnt(10)
    v_mfma_f32_32x32x16_bf16 v[128:143], v[236:239], v[192:195], v[128:143]
    ds_read_b64_tr_b16 v[232:233], v71 offset:9216
    ds_read_b64_tr_b16 v[234:235], v71 offset:9728
    s_waitcnt lgkmcnt(10)
    v_mfma_f32_32x32x16_bf16 v[80:95], v[240:243], v[192:195], v[80:95]
    ds_read_b64_tr_b16 v[236:237], v70 offset:1024
    ds_read_b64_tr_b16 v[238:239], v70 offset:1536
    s_waitcnt lgkmcnt(10)
    v_mfma_f32_32x32x16_bf16 v[96:111], v[244:247], v[192:195], v[96:111]
    ds_read_b64_tr_b16 v[240:241], v71 offset:1024
    ds_read_b64_tr_b16 v[242:243], v71 offset:1536
    s_waitcnt lgkmcnt(10)
    v_mfma_f32_32x32x16_bf16 v[144:159], v[248:251], v[192:195], v[144:159]
    ds_read_b64_tr_b16 v[244:245], v70 offset:17408
    ds_read_b64_tr_b16 v[246:247], v70 offset:17920
    s_waitcnt lgkmcnt(10)
    v_mfma_f32_32x32x16_bf16 v[160:175], v[224:227], v[192:195], v[160:175]
    ds_read_b64_tr_b16 v[248:249], v71 offset:17408
    ds_read_b64_tr_b16 v[250:251], v71 offset:17920
    s_add_u32 s96, s85, 13
    s_and_b32 s97, s96, 15
    s_lshl_b32 s98, s97, 14
    s_add_u32 s16, s98, s15
    buffer_load_dwordx4 v[192:195], v2, s[32:35], s16 offen sc1
    s_waitcnt vmcnt(11)
    s_waitcnt lgkmcnt(10)
    v_mfma_f32_32x32x16_bf16 v[112:127], v[228:231], v[196:199], v[112:127]
    ds_read_b64_tr_b16 v[224:225], v70 offset:12288
    ds_read_b64_tr_b16 v[226:227], v70 offset:12800
    s_waitcnt lgkmcnt(10)
    v_mfma_f32_32x32x16_bf16 v[128:143], v[232:235], v[196:199], v[128:143]
    ds_read_b64_tr_b16 v[228:229], v71 offset:12288
    ds_read_b64_tr_b16 v[230:231], v71 offset:12800
    s_waitcnt lgkmcnt(10)
    v_mfma_f32_32x32x16_bf16 v[80:95], v[236:239], v[196:199], v[80:95]
    ds_read_b64_tr_b16 v[232:233], v70 offset:4096
    ds_read_b64_tr_b16 v[234:235], v70 offset:4608
    s_waitcnt lgkmcnt(10)
    v_mfma_f32_32x32x16_bf16 v[96:111], v[240:243], v[196:199], v[96:111]
    ds_read_b64_tr_b16 v[236:237], v71 offset:4096
    ds_read_b64_tr_b16 v[238:239], v71 offset:4608
    s_waitcnt lgkmcnt(10)
    v_mfma_f32_32x32x16_bf16 v[144:159], v[244:247], v[196:199], v[144:159]
    ds_read_b64_tr_b16 v[240:241], v70 offset:20480
    ds_read_b64_tr_b16 v[242:243], v70 offset:20992
    s_waitcnt lgkmcnt(10)
    v_mfma_f32_32x32x16_bf16 v[160:175], v[248:251], v[196:199], v[160:175]
    ds_read_b64_tr_b16 v[244:245], v71 offset:20480
    ds_read_b64_tr_b16 v[246:247], v71 offset:20992
    buffer_load_dwordx4 v[196:199], v2, s[32:35], s16 offen offset:1024 sc1
    s_waitcnt vmcnt(11)
    s_waitcnt lgkmcnt(10)
    v_mfma_f32_32x32x16_bf16 v[112:127], v[224:227], v[200:203], v[112:127]
    ds_read_b64_tr_b16 v[248:249], v70 offset:13312
    ds_read_b64_tr_b16 v[250:251], v70 offset:13824
    s_waitcnt lgkmcnt(10)
    v_mfma_f32_32x32x16_bf16 v[128:143], v[228:231], v[200:203], v[128:143]
    ds_read_b64_tr_b16 v[224:225], v71 offset:13312
    ds_read_b64_tr_b16 v[226:227], v71 offset:13824
    s_waitcnt lgkmcnt(10)
    v_mfma_f32_32x32x16_bf16 v[80:95], v[232:235], v[200:203], v[80:95]
    ds_read_b64_tr_b16 v[228:229], v70 offset:5120
    ds_read_b64_tr_b16 v[230:231], v70 offset:5632
    s_waitcnt lgkmcnt(10)
    v_mfma_f32_32x32x16_bf16 v[96:111], v[236:239], v[200:203], v[96:111]
    ds_read_b64_tr_b16 v[232:233], v71 offset:5120
    ds_read_b64_tr_b16 v[234:235], v71 offset:5632
    s_waitcnt lgkmcnt(10)
    v_mfma_f32_32x32x16_bf16 v[144:159], v[240:243], v[200:203], v[144:159]
    ds_read_b64_tr_b16 v[236:237], v70 offset:21504
    ds_read_b64_tr_b16 v[238:239], v70 offset:22016
    s_waitcnt lgkmcnt(10)
    v_mfma_f32_32x32x16_bf16 v[160:175], v[244:247], v[200:203], v[160:175]
    ds_read_b64_tr_b16 v[240:241], v71 offset:21504
    ds_read_b64_tr_b16 v[242:243], v71 offset:22016
    buffer_load_dwordx4 v[200:203], v2, s[32:35], s16 offen offset:2048 sc1
    s_waitcnt vmcnt(11)
    s_waitcnt lgkmcnt(10)
    v_mfma_f32_32x32x16_bf16 v[112:127], v[248:251], v[204:207], v[112:127]
    s_barrier
    ds_read_b64_tr_b16 v[244:245], v70 offset:32768
    ds_read_b64_tr_b16 v[246:247], v70 offset:33280
    s_waitcnt lgkmcnt(10)
    v_mfma_f32_32x32x16_bf16 v[128:143], v[224:227], v[204:207], v[128:143]
    ds_read_b64_tr_b16 v[248:249], v71 offset:32768
    ds_read_b64_tr_b16 v[250:251], v71 offset:33280
    s_waitcnt lgkmcnt(10)
    v_mfma_f32_32x32x16_bf16 v[80:95], v[228:231], v[204:207], v[80:95]
    ds_read_b64_tr_b16 v[224:225], v70 offset:24576
    ds_read_b64_tr_b16 v[226:227], v70 offset:25088
    s_waitcnt lgkmcnt(10)
    v_mfma_f32_32x32x16_bf16 v[96:111], v[232:235], v[204:207], v[96:111]
    ds_read_b64_tr_b16 v[228:229], v71 offset:24576
    ds_read_b64_tr_b16 v[230:231], v71 offset:25088
    s_waitcnt lgkmcnt(10)
    v_mfma_f32_32x32x16_bf16 v[144:159], v[236:239], v[204:207], v[144:159]
    ds_read_b64_tr_b16 v[232:233], v70 offset:40960
    ds_read_b64_tr_b16 v[234:235], v70 offset:41472
    s_waitcnt lgkmcnt(10)
    v_mfma_f32_32x32x16_bf16 v[160:175], v[240:243], v[204:207], v[160:175]
    ds_read_b64_tr_b16 v[236:237], v71 offset:40960
    ds_read_b64_tr_b16 v[238:239], v71 offset:41472
    buffer_load_dwordx4 v[204:207], v2, s[32:35], s16 offen offset:3072 sc1
    s_waitcnt vmcnt(11)
    s_waitcnt lgkmcnt(10)
    v_mfma_f32_32x32x16_bf16 v[112:127], v[244:247], v[208:211], v[112:127]
    ds_read_b64_tr_b16 v[240:241], v70 offset:33792
    ds_read_b64_tr_b16 v[242:243], v70 offset:34304
    s_waitcnt lgkmcnt(10)
    v_mfma_f32_32x32x16_bf16 v[128:143], v[248:251], v[208:211], v[128:143]
    ds_read_b64_tr_b16 v[244:245], v71 offset:33792
    ds_read_b64_tr_b16 v[246:247], v71 offset:34304
    s_waitcnt lgkmcnt(10)
    v_mfma_f32_32x32x16_bf16 v[80:95], v[224:227], v[208:211], v[80:95]
    ds_read_b64_tr_b16 v[248:249], v70 offset:25600
    ds_read_b64_tr_b16 v[250:251], v70 offset:26112
    s_waitcnt lgkmcnt(10)
    v_mfma_f32_32x32x16_bf16 v[96:111], v[228:231], v[208:211], v[96:111]
    ds_read_b64_tr_b16 v[224:225], v71 offset:25600
    ds_read_b64_tr_b16 v[226:227], v71 offset:26112
    s_waitcnt lgkmcnt(10)
    v_mfma_f32_32x32x16_bf16 v[144:159], v[232:235], v[208:211], v[144:159]
    ds_read_b64_tr_b16 v[228:229], v70 offset:41984
    ds_read_b64_tr_b16 v[230:231], v70 offset:42496
    s_waitcnt lgkmcnt(10)
    v_mfma_f32_32x32x16_bf16 v[160:175], v[236:239], v[208:211], v[160:175]
    ds_read_b64_tr_b16 v[232:233], v71 offset:41984
    ds_read_b64_tr_b16 v[234:235], v71 offset:42496
    s_add_u32 s96, s85, 14
    s_and_b32 s97, s96, 15
    s_lshl_b32 s98, s97, 14
    s_add_u32 s16, s98, s15
    buffer_load_dwordx4 v[208:211], v2, s[32:35], s16 offen sc1
    s_waitcnt vmcnt(11)
    s_waitcnt lgkmcnt(10)
    v_mfma_f32_32x32x16_bf16 v[112:127], v[240:243], v[212:215], v[112:127]
    ds_read_b64_tr_b16 v[236:237], v70 offset:36864
    ds_read_b64_tr_b16 v[238:239], v70 offset:37376
    s_waitcnt lgkmcnt(10)
    v_mfma_f32_32x32x16_bf16 v[128:143], v[244:247], v[212:215], v[128:143]
    ds_read_b64_tr_b16 v[240:241], v71 offset:36864
    ds_read_b64_tr_b16 v[242:243], v71 offset:37376
    s_waitcnt lgkmcnt(10)
    v_mfma_f32_32x32x16_bf16 v[80:95], v[248:251], v[212:215], v[80:95]
    ds_read_b64_tr_b16 v[244:245], v70 offset:28672
    ds_read_b64_tr_b16 v[246:247], v70 offset:29184
    s_waitcnt lgkmcnt(10)
    v_mfma_f32_32x32x16_bf16 v[96:111], v[224:227], v[212:215], v[96:111]
    ds_read_b64_tr_b16 v[248:249], v71 offset:28672
    ds_read_b64_tr_b16 v[250:251], v71 offset:29184
    s_waitcnt lgkmcnt(10)
    v_mfma_f32_32x32x16_bf16 v[144:159], v[228:231], v[212:215], v[144:159]
    ds_read_b64_tr_b16 v[224:225], v70 offset:45056
    ds_read_b64_tr_b16 v[226:227], v70 offset:45568
    s_waitcnt lgkmcnt(10)
    v_mfma_f32_32x32x16_bf16 v[160:175], v[232:235], v[212:215], v[160:175]
    ds_read_b64_tr_b16 v[228:229], v71 offset:45056
    ds_read_b64_tr_b16 v[230:231], v71 offset:45568
    buffer_load_dwordx4 v[212:215], v2, s[32:35], s16 offen offset:1024 sc1
    s_waitcnt vmcnt(11)
    s_waitcnt lgkmcnt(10)
    v_mfma_f32_32x32x16_bf16 v[112:127], v[236:239], v[216:219], v[112:127]
    ds_read_b64_tr_b16 v[232:233], v70 offset:37888
    ds_read_b64_tr_b16 v[234:235], v70 offset:38400
    s_waitcnt lgkmcnt(10)
    v_mfma_f32_32x32x16_bf16 v[128:143], v[240:243], v[216:219], v[128:143]
    ds_read_b64_tr_b16 v[236:237], v71 offset:37888
    ds_read_b64_tr_b16 v[238:239], v71 offset:38400
    s_waitcnt lgkmcnt(10)
    v_mfma_f32_32x32x16_bf16 v[80:95], v[244:247], v[216:219], v[80:95]
    ds_read_b64_tr_b16 v[240:241], v70 offset:29696
    ds_read_b64_tr_b16 v[242:243], v70 offset:30208
    s_waitcnt lgkmcnt(10)
    v_mfma_f32_32x32x16_bf16 v[96:111], v[248:251], v[216:219], v[96:111]
    ds_read_b64_tr_b16 v[244:245], v71 offset:29696
    ds_read_b64_tr_b16 v[246:247], v71 offset:30208
    s_waitcnt lgkmcnt(10)
    v_mfma_f32_32x32x16_bf16 v[144:159], v[224:227], v[216:219], v[144:159]
    ds_read_b64_tr_b16 v[248:249], v70 offset:46080
    ds_read_b64_tr_b16 v[250:251], v70 offset:46592
    s_waitcnt lgkmcnt(10)
    v_mfma_f32_32x32x16_bf16 v[160:175], v[228:231], v[216:219], v[160:175]
    ds_read_b64_tr_b16 v[224:225], v71 offset:46080
    ds_read_b64_tr_b16 v[226:227], v71 offset:46592
    buffer_load_dwordx4 v[216:219], v2, s[32:35], s16 offen offset:2048 sc1
    s_waitcnt vmcnt(11)
    s_waitcnt lgkmcnt(10)
    v_mfma_f32_32x32x16_bf16 v[112:127], v[232:235], v[220:223], v[112:127]
    s_barrier
    ds_read_b64_tr_b16 v[228:229], v66 offset:8192
    ds_read_b64_tr_b16 v[230:231], v66 offset:8704
    s_waitcnt lgkmcnt(10)
    v_mfma_f32_32x32x16_bf16 v[128:143], v[236:239], v[220:223], v[128:143]
    ds_read_b64_tr_b16 v[232:233], v67 offset:8192
    ds_read_b64_tr_b16 v[234:235], v67 offset:8704
    s_waitcnt lgkmcnt(10)
    v_mfma_f32_32x32x16_bf16 v[80:95], v[240:243], v[220:223], v[80:95]
    ds_read_b64_tr_b16 v[236:237], v66
    ds_read_b64_tr_b16 v[238:239], v66 offset:512
    s_waitcnt lgkmcnt(10)
    v_mfma_f32_32x32x16_bf16 v[96:111], v[244:247], v[220:223], v[96:111]
    ds_read_b64_tr_b16 v[240:241], v67
    ds_read_b64_tr_b16 v[242:243], v67 offset:512
    s_waitcnt lgkmcnt(10)
    v_mfma_f32_32x32x16_bf16 v[144:159], v[248:251], v[220:223], v[144:159]
    ds_read_b64_tr_b16 v[244:245], v66 offset:16384
    ds_read_b64_tr_b16 v[246:247], v66 offset:16896
    s_waitcnt lgkmcnt(10)
    v_mfma_f32_32x32x16_bf16 v[160:175], v[224:227], v[220:223], v[160:175]
    ds_read_b64_tr_b16 v[248:249], v67 offset:16384
    ds_read_b64_tr_b16 v[250:251], v67 offset:16896
    buffer_load_dwordx4 v[220:223], v2, s[32:35], s16 offen offset:3072 sc1
    s_waitcnt vmcnt(11)
    s_waitcnt lgkmcnt(10)
    v_mfma_f32_32x32x16_bf16 v[112:127], v[228:231], v[176:179], v[112:127]
    ds_read_b64_tr_b16 v[224:225], v66 offset:9216
    ds_read_b64_tr_b16 v[226:227], v66 offset:9728
    s_waitcnt lgkmcnt(10)
    v_mfma_f32_32x32x16_bf16 v[128:143], v[232:235], v[176:179], v[128:143]
    ds_read_b64_tr_b16 v[228:229], v67 offset:9216
    ds_read_b64_tr_b16 v[230:231], v67 offset:9728
    s_waitcnt lgkmcnt(10)
    v_mfma_f32_32x32x16_bf16 v[80:95], v[236:239], v[176:179], v[80:95]
    ds_read_b64_tr_b16 v[232:233], v66 offset:1024
    ds_read_b64_tr_b16 v[234:235], v66 offset:1536
    s_waitcnt lgkmcnt(10)
    v_mfma_f32_32x32x16_bf16 v[96:111], v[240:243], v[176:179], v[96:111]
    ds_read_b64_tr_b16 v[236:237], v67 offset:1024
    ds_read_b64_tr_b16 v[238:239], v67 offset:1536
    s_waitcnt lgkmcnt(10)
    v_mfma_f32_32x32x16_bf16 v[144:159], v[244:247], v[176:179], v[144:159]
    ds_read_b64_tr_b16 v[240:241], v66 offset:17408
    ds_read_b64_tr_b16 v[242:243], v66 offset:17920
    s_waitcnt lgkmcnt(10)
    v_mfma_f32_32x32x16_bf16 v[160:175], v[248:251], v[176:179], v[160:175]
    ds_read_b64_tr_b16 v[244:245], v67 offset:17408
    ds_read_b64_tr_b16 v[246:247], v67 offset:17920
    s_add_u32 s96, s85, 15
    s_and_b32 s97, s96, 15
    s_lshl_b32 s98, s97, 14
    s_add_u32 s16, s98, s15
    buffer_load_dwordx4 v[176:179], v2, s[32:35], s16 offen sc1
    s_waitcnt vmcnt(11)
    s_waitcnt lgkmcnt(10)
    v_mfma_f32_32x32x16_bf16 v[112:127], v[224:227], v[180:183], v[112:127]
    ds_read_b64_tr_b16 v[248:249], v66 offset:12288
    ds_read_b64_tr_b16 v[250:251], v66 offset:12800
    s_waitcnt lgkmcnt(10)
    v_mfma_f32_32x32x16_bf16 v[128:143], v[228:231], v[180:183], v[128:143]
    ds_read_b64_tr_b16 v[224:225], v67 offset:12288
    ds_read_b64_tr_b16 v[226:227], v67 offset:12800
    s_waitcnt lgkmcnt(10)
    v_mfma_f32_32x32x16_bf16 v[80:95], v[232:235], v[180:183], v[80:95]
    ds_read_b64_tr_b16 v[228:229], v66 offset:4096
    ds_read_b64_tr_b16 v[230:231], v66 offset:4608
    s_waitcnt lgkmcnt(10)
    v_mfma_f32_32x32x16_bf16 v[96:111], v[236:239], v[180:183], v[96:111]
    ds_read_b64_tr_b16 v[232:233], v67 offset:4096
    ds_read_b64_tr_b16 v[234:235], v67 offset:4608
    s_waitcnt lgkmcnt(10)
    v_mfma_f32_32x32x16_bf16 v[144:159], v[240:243], v[180:183], v[144:159]
    ds_read_b64_tr_b16 v[236:237], v66 offset:20480
    ds_read_b64_tr_b16 v[238:239], v66 offset:20992
    s_waitcnt lgkmcnt(10)
    v_mfma_f32_32x32x16_bf16 v[160:175], v[244:247], v[180:183], v[160:175]
    ds_read_b64_tr_b16 v[240:241], v67 offset:20480
    ds_read_b64_tr_b16 v[242:243], v67 offset:20992
    buffer_load_dwordx4 v[180:183], v2, s[32:35], s16 offen offset:1024 sc1
    s_waitcnt vmcnt(11)
    s_waitcnt lgkmcnt(10)
    v_mfma_f32_32x32x16_bf16 v[112:127], v[248:251], v[184:187], v[112:127]
    ds_read_b64_tr_b16 v[244:245], v66 offset:13312
    ds_read_b64_tr_b16 v[246:247], v66 offset:13824
    s_waitcnt lgkmcnt(10)
    v_mfma_f32_32x32x16_bf16 v[128:143], v[224:227], v[184:187], v[128:143]
    ds_read_b64_tr_b16 v[248:249], v67 offset:13312
    ds_read_b64_tr_b16 v[250:251], v67 offset:13824
    s_waitcnt lgkmcnt(10)
    v_mfma_f32_32x32x16_bf16 v[80:95], v[228:231], v[184:187], v[80:95]
    ds_read_b64_tr_b16 v[224:225], v66 offset:5120
    ds_read_b64_tr_b16 v[226:227], v66 offset:5632
    s_waitcnt lgkmcnt(10)
    v_mfma_f32_32x32x16_bf16 v[96:111], v[232:235], v[184:187], v[96:111]
    ds_read_b64_tr_b16 v[228:229], v67 offset:5120
    ds_read_b64_tr_b16 v[230:231], v67 offset:5632
    s_waitcnt lgkmcnt(10)
    v_mfma_f32_32x32x16_bf16 v[144:159], v[236:239], v[184:187], v[144:159]
    ds_read_b64_tr_b16 v[232:233], v66 offset:21504
    ds_read_b64_tr_b16 v[234:235], v66 offset:22016
    s_waitcnt lgkmcnt(10)
    v_mfma_f32_32x32x16_bf16 v[160:175], v[240:243], v[184:187], v[160:175]
    ds_read_b64_tr_b16 v[236:237], v67 offset:21504
    ds_read_b64_tr_b16 v[238:239], v67 offset:22016
    buffer_load_dwordx4 v[184:187], v2, s[32:35], s16 offen offset:2048 sc1
    s_waitcnt vmcnt(11)
    s_waitcnt lgkmcnt(10)
    v_mfma_f32_32x32x16_bf16 v[112:127], v[244:247], v[188:191], v[112:127]
    s_barrier
    ds_read_b64_tr_b16 v[240:241], v66 offset:32768
    ds_read_b64_tr_b16 v[242:243], v66 offset:33280
    s_waitcnt lgkmcnt(10)
    v_mfma_f32_32x32x16_bf16 v[128:143], v[248:251], v[188:191], v[128:143]
    ds_read_b64_tr_b16 v[244:245], v67 offset:32768
    ds_read_b64_tr_b16 v[246:247], v67 offset:33280
    s_waitcnt lgkmcnt(10)
    v_mfma_f32_32x32x16_bf16 v[80:95], v[224:227], v[188:191], v[80:95]
    ds_read_b64_tr_b16 v[248:249], v66 offset:24576
    ds_read_b64_tr_b16 v[250:251], v66 offset:25088
    s_waitcnt lgkmcnt(10)
    v_mfma_f32_32x32x16_bf16 v[96:111], v[228:231], v[188:191], v[96:111]
    ds_read_b64_tr_b16 v[224:225], v67 offset:24576
    ds_read_b64_tr_b16 v[226:227], v67 offset:25088
    s_waitcnt lgkmcnt(10)
    v_mfma_f32_32x32x16_bf16 v[144:159], v[232:235], v[188:191], v[144:159]
    ds_read_b64_tr_b16 v[228:229], v66 offset:40960
    ds_read_b64_tr_b16 v[230:231], v66 offset:41472
    s_waitcnt lgkmcnt(10)
    v_mfma_f32_32x32x16_bf16 v[160:175], v[236:239], v[188:191], v[160:175]
    ds_read_b64_tr_b16 v[232:233], v67 offset:40960
    ds_read_b64_tr_b16 v[234:235], v67 offset:41472
    buffer_load_dwordx4 v[188:191], v2, s[32:35], s16 offen offset:3072 sc1
    s_barrier
    s_waitcnt vmcnt(11)
    s_waitcnt lgkmcnt(10)
    v_mfma_f32_32x32x16_bf16 v[112:127], v[240:243], v[192:195], v[112:127]
    ds_read_b64_tr_b16 v[236:237], v66 offset:33792
    ds_read_b64_tr_b16 v[238:239], v66 offset:34304
    s_waitcnt lgkmcnt(10)
    v_mfma_f32_32x32x16_bf16 v[128:143], v[244:247], v[192:195], v[128:143]
    ds_read_b64_tr_b16 v[240:241], v67 offset:33792
    ds_read_b64_tr_b16 v[242:243], v67 offset:34304
    s_waitcnt lgkmcnt(10)
    v_mfma_f32_32x32x16_bf16 v[80:95], v[248:251], v[192:195], v[80:95]
    ds_read_b64_tr_b16 v[244:245], v66 offset:25600
    ds_read_b64_tr_b16 v[246:247], v66 offset:26112
    s_waitcnt lgkmcnt(10)
    v_mfma_f32_32x32x16_bf16 v[96:111], v[224:227], v[192:195], v[96:111]
    ds_read_b64_tr_b16 v[248:249], v67 offset:25600
    ds_read_b64_tr_b16 v[250:251], v67 offset:26112
    s_waitcnt lgkmcnt(10)
    v_mfma_f32_32x32x16_bf16 v[144:159], v[228:231], v[192:195], v[144:159]
    ds_read_b64_tr_b16 v[224:225], v66 offset:41984
    ds_read_b64_tr_b16 v[226:227], v66 offset:42496
    s_waitcnt lgkmcnt(10)
    v_mfma_f32_32x32x16_bf16 v[160:175], v[232:235], v[192:195], v[160:175]
    ds_read_b64_tr_b16 v[228:229], v67 offset:41984
    ds_read_b64_tr_b16 v[230:231], v67 offset:42496
    s_waitcnt vmcnt(10)
    s_waitcnt lgkmcnt(10)
    v_mfma_f32_32x32x16_bf16 v[112:127], v[236:239], v[196:199], v[112:127]
    ds_read_b64_tr_b16 v[232:233], v66 offset:36864
    ds_read_b64_tr_b16 v[234:235], v66 offset:37376
    s_waitcnt lgkmcnt(10)
    v_mfma_f32_32x32x16_bf16 v[128:143], v[240:243], v[196:199], v[128:143]
    ds_read_b64_tr_b16 v[236:237], v67 offset:36864
    ds_read_b64_tr_b16 v[238:239], v67 offset:37376
    s_waitcnt lgkmcnt(10)
    v_mfma_f32_32x32x16_bf16 v[80:95], v[244:247], v[196:199], v[80:95]
    ds_read_b64_tr_b16 v[240:241], v66 offset:28672
    ds_read_b64_tr_b16 v[242:243], v66 offset:29184
    s_waitcnt lgkmcnt(10)
    v_mfma_f32_32x32x16_bf16 v[96:111], v[248:251], v[196:199], v[96:111]
    ds_read_b64_tr_b16 v[244:245], v67 offset:28672
    ds_read_b64_tr_b16 v[246:247], v67 offset:29184
    s_waitcnt lgkmcnt(10)
    v_mfma_f32_32x32x16_bf16 v[144:159], v[224:227], v[196:199], v[144:159]
    ds_read_b64_tr_b16 v[248:249], v66 offset:45056
    ds_read_b64_tr_b16 v[250:251], v66 offset:45568
    s_waitcnt lgkmcnt(10)
    v_mfma_f32_32x32x16_bf16 v[160:175], v[228:231], v[196:199], v[160:175]
    ds_read_b64_tr_b16 v[224:225], v67 offset:45056
    ds_read_b64_tr_b16 v[226:227], v67 offset:45568
    s_waitcnt vmcnt(9)
    s_waitcnt lgkmcnt(10)
    v_mfma_f32_32x32x16_bf16 v[112:127], v[232:235], v[200:203], v[112:127]
    ds_read_b64_tr_b16 v[228:229], v66 offset:37888
    ds_read_b64_tr_b16 v[230:231], v66 offset:38400
    s_waitcnt lgkmcnt(10)
    v_mfma_f32_32x32x16_bf16 v[128:143], v[236:239], v[200:203], v[128:143]
    ds_read_b64_tr_b16 v[232:233], v67 offset:37888
    ds_read_b64_tr_b16 v[234:235], v67 offset:38400
    s_waitcnt lgkmcnt(10)
    v_mfma_f32_32x32x16_bf16 v[80:95], v[240:243], v[200:203], v[80:95]
    ds_read_b64_tr_b16 v[236:237], v66 offset:29696
    ds_read_b64_tr_b16 v[238:239], v66 offset:30208
    s_waitcnt lgkmcnt(10)
    v_mfma_f32_32x32x16_bf16 v[96:111], v[244:247], v[200:203], v[96:111]
    ds_read_b64_tr_b16 v[240:241], v67 offset:29696
    ds_read_b64_tr_b16 v[242:243], v67 offset:30208
    s_waitcnt lgkmcnt(10)
    v_mfma_f32_32x32x16_bf16 v[144:159], v[248:251], v[200:203], v[144:159]
    ds_read_b64_tr_b16 v[244:245], v66 offset:46080
    ds_read_b64_tr_b16 v[246:247], v66 offset:46592
    s_waitcnt lgkmcnt(10)
    v_mfma_f32_32x32x16_bf16 v[160:175], v[224:227], v[200:203], v[160:175]
    ds_read_b64_tr_b16 v[248:249], v67 offset:46080
    ds_read_b64_tr_b16 v[250:251], v67 offset:46592
    s_waitcnt vmcnt(8)
    s_waitcnt lgkmcnt(10)
    v_mfma_f32_32x32x16_bf16 v[112:127], v[228:231], v[204:207], v[112:127]
    ds_read_b64_tr_b16 v[224:225], v68 offset:8192
    ds_read_b64_tr_b16 v[226:227], v68 offset:8704
    s_waitcnt lgkmcnt(10)
    v_mfma_f32_32x32x16_bf16 v[128:143], v[232:235], v[204:207], v[128:143]
    ds_read_b64_tr_b16 v[228:229], v69 offset:8192
    ds_read_b64_tr_b16 v[230:231], v69 offset:8704
    s_waitcnt lgkmcnt(10)
    v_mfma_f32_32x32x16_bf16 v[80:95], v[236:239], v[204:207], v[80:95]
    ds_read_b64_tr_b16 v[232:233], v68
    ds_read_b64_tr_b16 v[234:235], v68 offset:512
    s_waitcnt lgkmcnt(10)
    v_mfma_f32_32x32x16_bf16 v[96:111], v[240:243], v[204:207], v[96:111]
    ds_read_b64_tr_b16 v[236:237], v69
    ds_read_b64_tr_b16 v[238:239], v69 offset:512
    s_waitcnt lgkmcnt(10)
    v_mfma_f32_32x32x16_bf16 v[144:159], v[244:247], v[204:207], v[144:159]
    ds_read_b64_tr_b16 v[240:241], v68 offset:16384
    ds_read_b64_tr_b16 v[242:243], v68 offset:16896
    s_waitcnt lgkmcnt(10)
    v_mfma_f32_32x32x16_bf16 v[160:175], v[248:251], v[204:207], v[160:175]
    ds_read_b64_tr_b16 v[244:245], v69 offset:16384
    ds_read_b64_tr_b16 v[246:247], v69 offset:16896
    s_waitcnt vmcnt(7)
    s_waitcnt lgkmcnt(10)
    v_mfma_f32_32x32x16_bf16 v[112:127], v[224:227], v[208:211], v[112:127]
    ds_read_b64_tr_b16 v[248:249], v68 offset:9216
    ds_read_b64_tr_b16 v[250:251], v68 offset:9728
    s_waitcnt lgkmcnt(10)
    v_mfma_f32_32x32x16_bf16 v[128:143], v[228:231], v[208:211], v[128:143]
    ds_read_b64_tr_b16 v[224:225], v69 offset:9216
    ds_read_b64_tr_b16 v[226:227], v69 offset:9728
    s_waitcnt lgkmcnt(10)
    v_mfma_f32_32x32x16_bf16 v[80:95], v[232:235], v[208:211], v[80:95]
    ds_read_b64_tr_b16 v[228:229], v68 offset:1024
    ds_read_b64_tr_b16 v[230:231], v68 offset:1536
    s_waitcnt lgkmcnt(10)
    v_mfma_f32_32x32x16_bf16 v[96:111], v[236:239], v[208:211], v[96:111]
    ds_read_b64_tr_b16 v[232:233], v69 offset:1024
    ds_read_b64_tr_b16 v[234:235], v69 offset:1536
    s_waitcnt lgkmcnt(10)
    v_mfma_f32_32x32x16_bf16 v[144:159], v[240:243], v[208:211], v[144:159]
    ds_read_b64_tr_b16 v[236:237], v68 offset:17408
    ds_read_b64_tr_b16 v[238:239], v68 offset:17920
    s_waitcnt lgkmcnt(10)
    v_mfma_f32_32x32x16_bf16 v[160:175], v[244:247], v[208:211], v[160:175]
    ds_read_b64_tr_b16 v[240:241], v69 offset:17408
    ds_read_b64_tr_b16 v[242:243], v69 offset:17920
    s_waitcnt vmcnt(6)
    s_waitcnt lgkmcnt(10)
    v_mfma_f32_32x32x16_bf16 v[112:127], v[248:251], v[212:215], v[112:127]
    ds_read_b64_tr_b16 v[244:245], v68 offset:12288
    ds_read_b64_tr_b16 v[246:247], v68 offset:12800
    s_waitcnt lgkmcnt(10)
    v_mfma_f32_32x32x16_bf16 v[128:143], v[224:227], v[212:215], v[128:143]
    ds_read_b64_tr_b16 v[248:249], v69 offset:12288
    ds_read_b64_tr_b16 v[250:251], v69 offset:12800
    s_waitcnt lgkmcnt(10)
    v_mfma_f32_32x32x16_bf16 v[80:95], v[228:231], v[212:215], v[80:95]
    ds_read_b64_tr_b16 v[224:225], v68 offset:4096
    ds_read_b64_tr_b16 v[226:227], v68 offset:4608
    s_waitcnt lgkmcnt(10)
    v_mfma_f32_32x32x16_bf16 v[96:111], v[232:235], v[212:215], v[96:111]
    ds_read_b64_tr_b16 v[228:229], v69 offset:4096
    ds_read_b64_tr_b16 v[230:231], v69 offset:4608
    s_waitcnt lgkmcnt(10)
    v_mfma_f32_32x32x16_bf16 v[144:159], v[236:239], v[212:215], v[144:159]
    ds_read_b64_tr_b16 v[232:233], v68 offset:20480
    ds_read_b64_tr_b16 v[234:235], v68 offset:20992
    s_waitcnt lgkmcnt(10)
    v_mfma_f32_32x32x16_bf16 v[160:175], v[240:243], v[212:215], v[160:175]
    ds_read_b64_tr_b16 v[236:237], v69 offset:20480
    ds_read_b64_tr_b16 v[238:239], v69 offset:20992
    s_waitcnt vmcnt(5)
    s_waitcnt lgkmcnt(10)
    v_mfma_f32_32x32x16_bf16 v[112:127], v[244:247], v[216:219], v[112:127]
    ds_read_b64_tr_b16 v[240:241], v68 offset:13312
    ds_read_b64_tr_b16 v[242:243], v68 offset:13824
    s_waitcnt lgkmcnt(10)
    v_mfma_f32_32x32x16_bf16 v[128:143], v[248:251], v[216:219], v[128:143]
    ds_read_b64_tr_b16 v[244:245], v69 offset:13312
    ds_read_b64_tr_b16 v[246:247], v69 offset:13824
    s_waitcnt lgkmcnt(10)
    v_mfma_f32_32x32x16_bf16 v[80:95], v[224:227], v[216:219], v[80:95]
    ds_read_b64_tr_b16 v[248:249], v68 offset:5120
    ds_read_b64_tr_b16 v[250:251], v68 offset:5632
    s_waitcnt lgkmcnt(10)
    v_mfma_f32_32x32x16_bf16 v[96:111], v[228:231], v[216:219], v[96:111]
    ds_read_b64_tr_b16 v[224:225], v69 offset:5120
    ds_read_b64_tr_b16 v[226:227], v69 offset:5632
    s_waitcnt lgkmcnt(10)
    v_mfma_f32_32x32x16_bf16 v[144:159], v[232:235], v[216:219], v[144:159]
    ds_read_b64_tr_b16 v[228:229], v68 offset:21504
    ds_read_b64_tr_b16 v[230:231], v68 offset:22016
    s_waitcnt lgkmcnt(10)
    v_mfma_f32_32x32x16_bf16 v[160:175], v[236:239], v[216:219], v[160:175]
    ds_read_b64_tr_b16 v[232:233], v69 offset:21504
    ds_read_b64_tr_b16 v[234:235], v69 offset:22016
    s_waitcnt vmcnt(4)
    s_waitcnt lgkmcnt(10)
    v_mfma_f32_32x32x16_bf16 v[112:127], v[240:243], v[220:223], v[112:127]
    ds_read_b64_tr_b16 v[236:237], v68 offset:32768
    ds_read_b64_tr_b16 v[238:239], v68 offset:33280
    s_waitcnt lgkmcnt(10)
    v_mfma_f32_32x32x16_bf16 v[128:143], v[244:247], v[220:223], v[128:143]
    ds_read_b64_tr_b16 v[240:241], v69 offset:32768
    ds_read_b64_tr_b16 v[242:243], v69 offset:33280
    s_waitcnt lgkmcnt(10)
    v_mfma_f32_32x32x16_bf16 v[80:95], v[248:251], v[220:223], v[80:95]
    ds_read_b64_tr_b16 v[244:245], v68 offset:24576
    ds_read_b64_tr_b16 v[246:247], v68 offset:25088
    s_waitcnt lgkmcnt(10)
    v_mfma_f32_32x32x16_bf16 v[96:111], v[224:227], v[220:223], v[96:111]
    ds_read_b64_tr_b16 v[248:249], v69 offset:24576
    ds_read_b64_tr_b16 v[250:251], v69 offset:25088
    s_waitcnt lgkmcnt(10)
    v_mfma_f32_32x32x16_bf16 v[144:159], v[228:231], v[220:223], v[144:159]
    ds_read_b64_tr_b16 v[224:225], v68 offset:40960
    ds_read_b64_tr_b16 v[226:227], v68 offset:41472
    s_waitcnt lgkmcnt(10)
    v_mfma_f32_32x32x16_bf16 v[160:175], v[232:235], v[220:223], v[160:175]
    ds_read_b64_tr_b16 v[228:229], v69 offset:40960
    ds_read_b64_tr_b16 v[230:231], v69 offset:41472
    s_waitcnt vmcnt(3)
    s_waitcnt lgkmcnt(10)
    v_mfma_f32_32x32x16_bf16 v[112:127], v[236:239], v[176:179], v[112:127]
    ds_read_b64_tr_b16 v[232:233], v68 offset:33792
    ds_read_b64_tr_b16 v[234:235], v68 offset:34304
    s_waitcnt lgkmcnt(10)
    v_mfma_f32_32x32x16_bf16 v[128:143], v[240:243], v[176:179], v[128:143]
    ds_read_b64_tr_b16 v[236:237], v69 offset:33792
    ds_read_b64_tr_b16 v[238:239], v69 offset:34304
    s_waitcnt lgkmcnt(10)
    v_mfma_f32_32x32x16_bf16 v[80:95], v[244:247], v[176:179], v[80:95]
    ds_read_b64_tr_b16 v[240:241], v68 offset:25600
    ds_read_b64_tr_b16 v[242:243], v68 offset:26112
    s_waitcnt lgkmcnt(10)
    v_mfma_f32_32x32x16_bf16 v[96:111], v[248:251], v[176:179], v[96:111]
    ds_read_b64_tr_b16 v[244:245], v69 offset:25600
    ds_read_b64_tr_b16 v[246:247], v69 offset:26112
    s_waitcnt lgkmcnt(10)
    v_mfma_f32_32x32x16_bf16 v[144:159], v[224:227], v[176:179], v[144:159]
    ds_read_b64_tr_b16 v[248:249], v68 offset:41984
    ds_read_b64_tr_b16 v[250:251], v68 offset:42496
    s_waitcnt lgkmcnt(10)
    v_mfma_f32_32x32x16_bf16 v[160:175], v[228:231], v[176:179], v[160:175]
    ds_read_b64_tr_b16 v[224:225], v69 offset:41984
    ds_read_b64_tr_b16 v[226:227], v69 offset:42496
    s_waitcnt vmcnt(2)
    s_waitcnt lgkmcnt(10)
    v_mfma_f32_32x32x16_bf16 v[112:127], v[232:235], v[180:183], v[112:127]
    ds_read_b64_tr_b16 v[228:229], v68 offset:36864
    ds_read_b64_tr_b16 v[230:231], v68 offset:37376
    s_waitcnt lgkmcnt(10)
    v_mfma_f32_32x32x16_bf16 v[128:143], v[236:239], v[180:183], v[128:143]
    ds_read_b64_tr_b16 v[232:233], v69 offset:36864
    ds_read_b64_tr_b16 v[234:235], v69 offset:37376
    s_waitcnt lgkmcnt(10)
    v_mfma_f32_32x32x16_bf16 v[80:95], v[240:243], v[180:183], v[80:95]
    ds_read_b64_tr_b16 v[236:237], v68 offset:28672
    ds_read_b64_tr_b16 v[238:239], v68 offset:29184
    s_waitcnt lgkmcnt(10)
    v_mfma_f32_32x32x16_bf16 v[96:111], v[244:247], v[180:183], v[96:111]
    ds_read_b64_tr_b16 v[240:241], v69 offset:28672
    ds_read_b64_tr_b16 v[242:243], v69 offset:29184
    s_waitcnt lgkmcnt(10)
    v_mfma_f32_32x32x16_bf16 v[144:159], v[248:251], v[180:183], v[144:159]
    ds_read_b64_tr_b16 v[244:245], v68 offset:45056
    ds_read_b64_tr_b16 v[246:247], v68 offset:45568
    s_waitcnt lgkmcnt(10)
    v_mfma_f32_32x32x16_bf16 v[160:175], v[224:227], v[180:183], v[160:175]
    ds_read_b64_tr_b16 v[248:249], v69 offset:45056
    ds_read_b64_tr_b16 v[250:251], v69 offset:45568
    s_waitcnt vmcnt(1)
    s_waitcnt lgkmcnt(10)
    v_mfma_f32_32x32x16_bf16 v[112:127], v[228:231], v[184:187], v[112:127]
    ds_read_b64_tr_b16 v[224:225], v68 offset:37888
    ds_read_b64_tr_b16 v[226:227], v68 offset:38400
    s_waitcnt lgkmcnt(10)
    v_mfma_f32_32x32x16_bf16 v[128:143], v[232:235], v[184:187], v[128:143]
    ds_read_b64_tr_b16 v[228:229], v69 offset:37888
    ds_read_b64_tr_b16 v[230:231], v69 offset:38400
    s_waitcnt lgkmcnt(10)
    v_mfma_f32_32x32x16_bf16 v[80:95], v[236:239], v[184:187], v[80:95]
    ds_read_b64_tr_b16 v[232:233], v68 offset:29696
    ds_read_b64_tr_b16 v[234:235], v68 offset:30208
    s_waitcnt lgkmcnt(10)
    v_mfma_f32_32x32x16_bf16 v[96:111], v[240:243], v[184:187], v[96:111]
    ds_read_b64_tr_b16 v[236:237], v69 offset:29696
    ds_read_b64_tr_b16 v[238:239], v69 offset:30208
    s_waitcnt lgkmcnt(10)
    v_mfma_f32_32x32x16_bf16 v[144:159], v[244:247], v[184:187], v[144:159]
    ds_read_b64_tr_b16 v[240:241], v68 offset:46080
    ds_read_b64_tr_b16 v[242:243], v68 offset:46592
    s_waitcnt lgkmcnt(10)
    v_mfma_f32_32x32x16_bf16 v[160:175], v[248:251], v[184:187], v[160:175]
    ds_read_b64_tr_b16 v[244:245], v69 offset:46080
    ds_read_b64_tr_b16 v[246:247], v69 offset:46592
    s_waitcnt vmcnt(0)
    s_waitcnt lgkmcnt(10)
    v_mfma_f32_32x32x16_bf16 v[112:127], v[224:227], v[188:191], v[112:127]
    s_waitcnt lgkmcnt(8)
    v_mfma_f32_32x32x16_bf16 v[128:143], v[228:231], v[188:191], v[128:143]
    s_waitcnt lgkmcnt(6)
    v_mfma_f32_32x32x16_bf16 v[80:95], v[232:235], v[188:191], v[80:95]
    s_waitcnt lgkmcnt(4)
    v_mfma_f32_32x32x16_bf16 v[96:111], v[236:239], v[188:191], v[96:111]
    s_waitcnt lgkmcnt(2)
    v_mfma_f32_32x32x16_bf16 v[144:159], v[240:243], v[188:191], v[144:159]
    s_waitcnt lgkmcnt(0)
    v_mfma_f32_32x32x16_bf16 v[160:175], v[244:247], v[188:191], v[160:175]
    s_nop 3
    v_cvt_pk_bf16_f32 v52, v128, v129
    v_cvt_pk_bf16_f32 v53, v130, v131
    v_cvt_pk_bf16_f32 v54, v132, v133
    v_cvt_pk_bf16_f32 v55, v134, v135
    v_cvt_pk_bf16_f32 v56, v136, v137
    v_cvt_pk_bf16_f32 v57, v138, v139
    v_cvt_pk_bf16_f32 v58, v140, v141
    v_cvt_pk_bf16_f32 v59, v142, v143
    ds_write_b128 v76, v[52:55]
    ds_write_b128 v76, v[56:59] offset:1024
    v_cvt_pk_bf16_f32 v36, v112, v113
    v_cvt_pk_bf16_f32 v37, v114, v115
    v_cvt_pk_bf16_f32 v38, v116, v117
    v_cvt_pk_bf16_f32 v39, v118, v119
    v_cvt_pk_bf16_f32 v40, v120, v121
    v_cvt_pk_bf16_f32 v41, v122, v123
    v_cvt_pk_bf16_f32 v42, v124, v125
    v_cvt_pk_bf16_f32 v43, v126, v127
    s_waitcnt lgkmcnt(0)
    s_barrier
    s_setprio 0
    v_mfma_f32_32x32x16_bf16 v[112:127], v[28:31], v[36:39], 0
    v_mfma_f32_32x32x16_bf16 v[112:127], v[32:35], v[40:43], v[112:127]
    v_cvt_pk_bf16_f32 v52, v144, v145
    v_cvt_pk_bf16_f32 v53, v146, v147
    v_cvt_pk_bf16_f32 v54, v148, v149
    v_cvt_pk_bf16_f32 v55, v150, v151
    v_cvt_pk_bf16_f32 v56, v152, v153
    v_cvt_pk_bf16_f32 v57, v154, v155
    v_cvt_pk_bf16_f32 v58, v156, v157
    v_cvt_pk_bf16_f32 v59, v158, v159
    ds_write_b128 v75, v[52:55] offset:32768
    ds_write_b128 v75, v[56:59] offset:36864
    v_cvt_pk_bf16_f32 v44, v160, v161
    v_cvt_pk_bf16_f32 v45, v162, v163
    v_cvt_pk_bf16_f32 v46, v164, v165
    v_cvt_pk_bf16_f32 v47, v166, v167
    v_cvt_pk_bf16_f32 v48, v168, v169
    v_cvt_pk_bf16_f32 v49, v170, v171
    v_cvt_pk_bf16_f32 v50, v172, v173
    v_cvt_pk_bf16_f32 v51, v174, v175
    ds_write_b128 v75, v[44:47] offset:40960
    ds_write_b128 v75, v[48:51] offset:45056
    v_cvt_pk_bf16_f32 v36, v96, v97
    v_cvt_pk_bf16_f32 v37, v98, v99
    v_cvt_pk_bf16_f32 v38, v100, v101
    v_cvt_pk_bf16_f32 v39, v102, v103
    v_cvt_pk_bf16_f32 v40, v104, v105
    v_cvt_pk_bf16_f32 v41, v106, v107
    v_cvt_pk_bf16_f32 v42, v108, v109
    v_cvt_pk_bf16_f32 v43, v110, v111
    ds_write_b128 v76, v[36:39] offset:2048
    ds_write_b128 v76, v[40:43] offset:3072
    v_cvt_pk_bf16_f32 v44, v80, v81
    v_cvt_pk_bf16_f32 v45, v82, v83
    v_cvt_pk_bf16_f32 v46, v84, v85
    v_cvt_pk_bf16_f32 v47, v86, v87
    v_cvt_pk_bf16_f32 v48, v88, v89
    v_cvt_pk_bf16_f32 v49, v90, v91
    v_cvt_pk_bf16_f32 v50, v92, v93
    v_cvt_pk_bf16_f32 v51, v94, v95
    s_branch L_JOIN
L_HELP:
    s_add_u32 s96, s85, 5
    s_and_b32 s97, s96, 15
    s_lshl3_add_u32 s98, s97, s3
    s_sub_u32 s99, s98, 4
    s_mul_i32 s96, s99, 49152
    s_lshl_b32 s97, s11, 7
    s_add_u32 s82, s96, s97
    s_sub_u32 s96, s3, 4
    s_lshl_b32 s97, s96, 10
    s_add_u32 s20, s97, 122880
    s_mov_b32 m0, s20
    s_nop 0
    buffer_load_dwordx4 v62, s[40:43], s82 offen lds
    s_add_u32 s82, s82, 2048
    s_add_u32 m0, s20, 8192
    s_nop 0
    buffer_load_dwordx4 v62, s[40:43], s82 offen lds
    s_add_u32 s82, s82, 2048
    s_add_u32 m0, s20, 16384
    s_nop 0
    buffer_load_dwordx4 v62, s[40:43], s82 offen lds
    s_add_u32 s96, s85, 5
    s_and_b32 s97, s96, 15
    s_lshl3_add_u32 s98, s97, s3
    s_mul_i32 s99, s98, 49152
    s_lshl_b32 s96, s11, 7
    s_add_u32 s82, s99, s96
    s_lshl_b32 s96, s3, 10
    s_add_u32 s20, s96, 122880
    s_mov_b32 m0, s20
    s_nop 0
    buffer_load_dwordx4 v62, s[40:43], s82 offen lds
    s_add_u32 s82, s82, 2048
    s_add_u32 m0, s20, 8192
    s_nop 0
    buffer_load_dwordx4 v62, s[40:43], s82 offen lds
    s_add_u32 s82, s82, 2048
    s_add_u32 m0, s20, 16384
    s_nop 0
    buffer_load_dwordx4 v62, s[40:43], s82 offen lds
    s_and_b32 s96, s8, 3
    s_lshl2_add_u32 s97, s96, s3
    s_sub_u32 s98, s97, 4
    s_lshl_b32 s13, s98, 7
    v_lshrrev_b32 v61, 3, v1
    v_lshl_add_u32 v61, v61, 1, s13
    s_mul_i32 s96, s13, 6144
    s_lshr_b32 s97, s8, 2
    s_lshl1_add_u32 s98, s9, s97
    s_lshl_b32 s99, s98, 7
    s_add_u32 s97, s96, s99
    s_add_u32 s17, s97, 4096
    global_load_ushort v112, v61, s[86:87] offset:0
    global_load_ushort v113, v61, s[86:87] offset:16
    global_load_ushort v114, v61, s[86:87] offset:32
    global_load_ushort v115, v61, s[86:87] offset:48
    global_load_ushort v116, v61, s[86:87] offset:64
    global_load_ushort v117, v61, s[86:87] offset:80
    global_load_ushort v118, v61, s[86:87] offset:96
    global_load_ushort v119, v61, s[86:87] offset:112
    s_waitcnt vmcnt(14)
    s_barrier
    buffer_load_dwordx4 v[80:83], v60, s[48:51], s17 offen nt
    s_add_u32 s17, s17, 98304
    buffer_load_dwordx4 v[84:87], v60, s[48:51], s17 offen nt
    s_add_u32 s17, s17, 98304
    s_waitcnt lgkmcnt(0)
    s_load_dword s24, s[32:33], s92 offset:512 glc
    s_load_dword s25, s[32:33], s92 offset:256 glc
    s_load_dword s26, s[32:33], s92 offset:1024 glc
    s_load_dword s27, s[32:33], s92 offset:768 glc
    s_barrier
    s_add_u32 s96, s85, 6
    s_and_b32 s97, s96, 15
    s_lshl3_add_u32 s98, s97, s3
    s_sub_u32 s99, s98, 4
    s_mul_i32 s96, s99, 49152
    s_lshl_b32 s97, s11, 7
    s_add_u32 s82, s96, s97
    s_sub_u32 s96, s3, 4
    s_lshl_b32 s20, s96, 10
    s_mov_b32 m0, s20
    s_nop 0
    buffer_load_dwordx4 v62, s[40:43], s82 offen lds
    s_add_u32 s82, s82, 2048
    s_add_u32 m0, s20, 8192
    s_nop 0
    buffer_load_dwordx4 v62, s[40:43], s82 offen lds
    s_add_u32 s82, s82, 2048
    s_add_u32 m0, s20, 16384
    s_nop 0
    buffer_load_dwordx4 v62, s[40:43], s82 offen lds
    s_add_u32 s96, s85, 6
    s_and_b32 s97, s96, 15
    s_lshl3_add_u32 s98, s97, s3
    s_mul_i32 s99, s98, 49152
    s_lshl_b32 s96, s11, 7
    s_add_u32 s82, s99, s96
    s_lshl_b32 s20, s3, 10
    s_mov_b32 m0, s20
    s_nop 0
    buffer_load_dwordx4 v62, s[40:43], s82 offen lds
    s_add_u32 s82, s82, 2048
    s_add_u32 m0, s20, 8192
    s_nop 0
    buffer_load_dwordx4 v62, s[40:43], s82 offen lds
    s_add_u32 s82, s82, 2048
    s_add_u32 m0, s20, 16384
    s_nop 0
    buffer_load_dwordx4 v62, s[40:43], s82 offen lds
    s_waitcnt vmcnt(8)
    v_lshlrev_b32 v112, 16, v112
    v_mul_f32 v4, s7, v112
    v_exp_f32 v4, -v4
    s_nop 0
    v_add_f32 v4, 1.0, v4
    v_rcp_f32 v4, v4
    s_nop 0
    v_mul_f32 v112, v112, v4
    v_cvt_pk_bf16_f32 v112, 0, v112
    v_lshlrev_b32 v113, 16, v113
    v_mul_f32 v5, s7, v113
    v_exp_f32 v5, -v5
    s_nop 0
    v_add_f32 v5, 1.0, v5
    v_rcp_f32 v5, v5
    s_nop 0
    v_mul_f32 v113, v113, v5
    v_cvt_pk_bf16_f32 v113, 0, v113
    v_lshlrev_b32 v114, 16, v114
    v_mul_f32 v4, s7, v114
    v_exp_f32 v4, -v4
    s_nop 0
    v_add_f32 v4, 1.0, v4
    v_rcp_f32 v4, v4
    s_nop 0
    v_mul_f32 v114, v114, v4
    v_cvt_pk_bf16_f32 v114, 0, v114
    v_lshlrev_b32 v115, 16, v115
    v_mul_f32 v5, s7, v115
    v_exp_f32 v5, -v5
    s_nop 0
    v_add_f32 v5, 1.0, v5
    v_rcp_f32 v5, v5
    s_nop 0
    v_mul_f32 v115, v115, v5
    v_cvt_pk_bf16_f32 v115, 0, v115
    s_barrier
    s_add_u32 s96, s85, 7
    s_and_b32 s97, s96, 15
    s_lshl3_add_u32 s98, s97, s3
    s_sub_u32 s99, s98, 4
    s_mul_i32 s96, s99, 49152
    s_lshl_b32 s97, s11, 7
    s_add_u32 s82, s96, s97
    s_sub_u32 s96, s3, 4
    s_lshl_b32 s97, s96, 10
    s_add_u32 s20, s97, 24576
    s_mov_b32 m0, s20
    s_nop 0
    buffer_load_dwordx4 v62, s[40:43], s82 offen lds
    s_add_u32 s82, s82, 2048
    s_add_u32 m0, s20, 8192
    s_nop 0
    buffer_load_dwordx4 v62, s[40:43], s82 offen lds
    s_add_u32 s82, s82, 2048
    s_add_u32 m0, s20, 16384
    s_nop 0
    buffer_load_dwordx4 v62, s[40:43], s82 offen lds
    s_add_u32 s96, s85, 7
    s_and_b32 s97, s96, 15
    s_lshl3_add_u32 s98, s97, s3
    s_mul_i32 s99, s98, 49152
    s_lshl_b32 s96, s11, 7
    s_add_u32 s82, s99, s96
    s_lshl_b32 s96, s3, 10
    s_add_u32 s20, s96, 24576
    s_mov_b32 m0, s20
    s_nop 0
    buffer_load_dwordx4 v62, s[40:43], s82 offen lds
    s_add_u32 s82, s82, 2048
    s_add_u32 m0, s20, 8192
    s_nop 0
    buffer_load_dwordx4 v62, s[40:43], s82 offen lds
    s_add_u32 s82, s82, 2048
    s_add_u32 m0, s20, 16384
    s_nop 0
    buffer_load_dwordx4 v62, s[40:43], s82 offen lds
    buffer_load_dwordx4 v[88:91], v60, s[48:51], s17 offen nt
    s_add_u32 s17, s17, 98304
    buffer_load_dwordx4 v[92:95], v60, s[48:51], s17 offen nt
    s_add_u32 s17, s17, 98304
    v_lshlrev_b32 v116, 16, v116
    v_mul_f32 v4, s7, v116
    v_exp_f32 v4, -v4
    s_nop 0
    v_add_f32 v4, 1.0, v4
    v_rcp_f32 v4, v4
    s_nop 0
    v_mul_f32 v116, v116, v4
    v_cvt_pk_bf16_f32 v116, 0, v116
    v_lshlrev_b32 v117, 16, v117
    v_mul_f32 v5, s7, v117
    v_exp_f32 v5, -v5
    s_nop 0
    v_add_f32 v5, 1.0, v5
    v_rcp_f32 v5, v5
    s_nop 0
    v_mul_f32 v117, v117, v5
    v_cvt_pk_bf16_f32 v117, 0, v117
    v_lshlrev_b32 v118, 16, v118
    v_mul_f32 v4, s7, v118
    v_exp_f32 v4, -v4
    s_nop 0
    v_add_f32 v4, 1.0, v4
    v_rcp_f32 v4, v4
    s_nop 0
    v_mul_f32 v118, v118, v4
    v_cvt_pk_bf16_f32 v118, 0, v118
    v_lshlrev_b32 v119, 16, v119
    v_mul_f32 v5, s7, v119
    v_exp_f32 v5, -v5
    s_nop 0
    v_add_f32 v5, 1.0, v5
    v_rcp_f32 v5, v5
    s_nop 0
    v_mul_f32 v119, v119, v5
    v_cvt_pk_bf16_f32 v119, 0, v119
    s_barrier
    s_add_u32 s96, s85, 8
    s_and_b32 s97, s96, 15
    s_lshl3_add_u32 s98, s97, s3
    s_sub_u32 s99, s98, 4
    s_mul_i32 s96, s99, 49152
    s_lshl_b32 s97, s11, 7
    s_add_u32 s82, s96, s97
    s_sub_u32 s96, s3, 4
    s_lshl_b32 s97, s96, 10
    s_add_u32 s20, s97, 49152
    s_mov_b32 m0, s20
    s_nop 0
    buffer_load_dwordx4 v62, s[40:43], s82 offen lds
    s_add_u32 s82, s82, 2048
    s_add_u32 m0, s20, 8192
    s_nop 0
    buffer_load_dwordx4 v62, s[40:43], s82 offen lds
    s_add_u32 s82, s82, 2048
    s_add_u32 m0, s20, 16384
    s_nop 0
    buffer_load_dwordx4 v62, s[40:43], s82 offen lds
    s_add_u32 s96, s85, 8
    s_and_b32 s97, s96, 15
    s_lshl3_add_u32 s98, s97, s3
    s_mul_i32 s99, s98, 49152
    s_lshl_b32 s96, s11, 7
    s_add_u32 s82, s99, s96
    s_lshl_b32 s96, s3, 10
    s_add_u32 s20, s96, 49152
    s_mov_b32 m0, s20
    s_nop 0
    buffer_load_dwordx4 v62, s[40:43], s82 offen lds
    s_add_u32 s82, s82, 2048
    s_add_u32 m0, s20, 8192
    s_nop 0
    buffer_load_dwordx4 v62, s[40:43], s82 offen lds
    s_add_u32 s82, s82, 2048
    s_add_u32 m0, s20, 16384
    s_nop 0
    buffer_load_dwordx4 v62, s[40:43], s82 offen lds
    s_waitcnt lgkmcnt(0)
    s_load_dword s24, s[32:33], s92 offset:1536 glc
    s_load_dword s25, s[32:33], s92 offset:1280 glc
    s_load_dword s26, s[32:33], s92 offset:2048 glc
    s_load_dword s27, s[32:33], s92 offset:1792 glc
    s_barrier
    s_add_u32 s96, s85, 9
    s_and_b32 s97, s96, 15
    s_lshl3_add_u32 s98, s97, s3
    s_sub_u32 s99, s98, 4
    s_mul_i32 s96, s99, 49152
    s_lshl_b32 s97, s11, 7
    s_add_u32 s82, s96, s97
    s_sub_u32 s96, s3, 4
    s_lshl_b32 s97, s96, 10
    s_add_u32 s20, s97, 73728
    s_mov_b32 m0, s20
    s_nop 0
    buffer_load_dwordx4 v62, s[40:43], s82 offen lds
    s_add_u32 s82, s82, 2048
    s_add_u32 m0, s20, 8192
    s_nop 0
    buffer_load_dwordx4 v62, s[40:43], s82 offen lds
    s_add_u32 s82, s82, 2048
    s_add_u32 m0, s20, 16384
    s_nop 0
    buffer_load_dwordx4 v62, s[40:43], s82 offen lds
    s_add_u32 s96, s85, 9
    s_and_b32 s97, s96, 15
    s_lshl3_add_u32 s98, s97, s3
    s_mul_i32 s99, s98, 49152
    s_lshl_b32 s96, s11, 7
    s_add_u32 s82, s99, s96
    s_lshl_b32 s96, s3, 10
    s_add_u32 s20, s96, 73728
    s_mov_b32 m0, s20
    s_nop 0
    buffer_load_dwordx4 v62, s[40:43], s82 offen lds
    s_add_u32 s82, s82, 2048
    s_add_u32 m0, s20, 8192
    s_nop 0
    buffer_load_dwordx4 v62, s[40:43], s82 offen lds
    s_add_u32 s82, s82, 2048
    s_add_u32 m0, s20, 16384
    s_nop 0
    buffer_load_dwordx4 v62, s[40:43], s82 offen lds
    buffer_load_dwordx4 v[96:99], v60, s[48:51], s17 offen nt
    s_add_u32 s17, s17, 98304
    buffer_load_dwordx4 v[100:103], v60, s[48:51], s17 offen nt
    s_add_u32 s17, s17, 98304
    s_waitcnt vmcnt(29)
    v_lshlrev_b32 v4, 16, v80
    v_and_b32 v5, s6, v80
    v_mul_f32 v20, v4, v112
    v_mul_f32 v21, v5, v112
    v_lshlrev_b32 v6, 16, v81
    v_and_b32 v7, s6, v81
    v_mul_f32 v22, v6, v112
    v_mul_f32 v23, v7, v112
    v_lshlrev_b32 v4, 16, v82
    v_and_b32 v5, s6, v82
    v_mul_f32 v24, v4, v112
    v_mul_f32 v25, v5, v112
    v_lshlrev_b32 v6, 16, v83
    v_and_b32 v7, s6, v83
    v_mul_f32 v26, v6, v112
    v_mul_f32 v27, v7, v112
    s_waitcnt vmcnt(28)
    v_lshlrev_b32 v4, 16, v84
    v_and_b32 v5, s6, v84
    v_fmac_f32 v20, v4, v113
    v_fmac_f32 v21, v5, v113
    v_lshlrev_b32 v6, 16, v85
    v_and_b32 v7, s6, v85
    v_fmac_f32 v22, v6, v113
    v_fmac_f32 v23, v7, v113
    v_lshlrev_b32 v4, 16, v86
    v_and_b32 v5, s6, v86
    v_fmac_f32 v24, v4, v113
    v_fmac_f32 v25, v5, v113
    v_lshlrev_b32 v6, 16, v87
    v_and_b32 v7, s6, v87
    v_fmac_f32 v26, v6, v113
    v_fmac_f32 v27, v7, v113
    s_waitcnt vmcnt(22)
    s_barrier
    s_add_u32 s96, s85, 10
    s_and_b32 s97, s96, 15
    s_lshl3_add_u32 s98, s97, s3
    s_sub_u32 s99, s98, 4
    s_mul_i32 s96, s99, 49152
    s_lshl_b32 s97, s11, 7
    s_add_u32 s82, s96, s97
    s_sub_u32 s96, s3, 4
    s_lshl_b32 s97, s96, 10
    s_add_u32 s20, s97, 98304
    s_mov_b32 m0, s20
    s_nop 0
    buffer_load_dwordx4 v62, s[40:43], s82 offen lds
    s_add_u32 s82, s82, 2048
    s_add_u32 m0, s20, 8192
    s_nop 0
    buffer_load_dwordx4 v62, s[40:43], s82 offen lds
    s_add_u32 s82, s82, 2048
    s_add_u32 m0, s20, 16384
    s_nop 0
    buffer_load_dwordx4 v62, s[40:43], s82 offen lds
    s_add_u32 s96, s85, 10
    s_and_b32 s97, s96, 15
    s_lshl3_add_u32 s98, s97, s3
    s_mul_i32 s99, s98, 49152
    s_lshl_b32 s96, s11, 7
    s_add_u32 s82, s99, s96
    s_lshl_b32 s96, s3, 10
    s_add_u32 s20, s96, 98304
    s_mov_b32 m0, s20
    s_nop 0
    buffer_load_dwordx4 v62, s[40:43], s82 offen lds
    s_add_u32 s82, s82, 2048
    s_add_u32 m0, s20, 8192
    s_nop 0
    buffer_load_dwordx4 v62, s[40:43], s82 offen lds
    s_add_u32 s82, s82, 2048
    s_add_u32 m0, s20, 16384
    s_nop 0
    buffer_load_dwordx4 v62, s[40:43], s82 offen lds
    s_waitcnt vmcnt(22)
    s_barrier
    s_add_u32 s96, s85, 11
    s_and_b32 s97, s96, 15
    s_lshl3_add_u32 s98, s97, s3
    s_sub_u32 s99, s98, 4
    s_mul_i32 s96, s99, 49152
    s_lshl_b32 s97, s11, 7
    s_add_u32 s82, s96, s97
    s_sub_u32 s96, s3, 4
    s_lshl_b32 s97, s96, 10
    s_add_u32 s20, s97, 122880
    s_mov_b32 m0, s20
    s_nop 0
    buffer_load_dwordx4 v62, s[40:43], s82 offen lds
    s_add_u32 s82, s82, 2048
    s_add_u32 m0, s20, 8192
    s_nop 0
    buffer_load_dwordx4 v62, s[40:43], s82 offen lds
    s_add_u32 s82, s82, 2048
    s_add_u32 m0, s20, 16384
    s_nop 0
    buffer_load_dwordx4 v62, s[40:43], s82 offen lds
    s_add_u32 s96, s85, 11
    s_and_b32 s97, s96, 15
    s_lshl3_add_u32 s98, s97, s3
    s_mul_i32 s99, s98, 49152
    s_lshl_b32 s96, s11, 7
    s_add_u32 s82, s99, s96
    s_lshl_b32 s96, s3, 10
    s_add_u32 s20, s96, 122880
    s_mov_b32 m0, s20
    s_nop 0
    buffer_load_dwordx4 v62, s[40:43], s82 offen lds
    s_add_u32 s82, s82, 2048
    s_add_u32 m0, s20, 8192
    s_nop 0
    buffer_load_dwordx4 v62, s[40:43], s82 offen lds
    s_add_u32 s82, s82, 2048
    s_add_u32 m0, s20, 16384
    s_nop 0
    buffer_load_dwordx4 v62, s[40:43], s82 offen lds
    buffer_load_dwordx4 v[104:107], v60, s[48:51], s17 offen nt
    s_add_u32 s17, s17, 98304
    buffer_load_dwordx4 v[108:111], v60, s[48:51], s17 offen nt
    s_waitcnt vmcnt(29)
    v_lshlrev_b32 v4, 16, v88
    v_and_b32 v5, s6, v88
    v_fmac_f32 v20, v4, v114
    v_fmac_f32 v21, v5, v114
    v_lshlrev_b32 v6, 16, v89
    v_and_b32 v7, s6, v89
    v_fmac_f32 v22, v6, v114
    v_fmac_f32 v23, v7, v114
    v_lshlrev_b32 v4, 16, v90
    v_and_b32 v5, s6, v90
    v_fmac_f32 v24, v4, v114
    v_fmac_f32 v25, v5, v114
    v_lshlrev_b32 v6, 16, v91
    v_and_b32 v7, s6, v91
    v_fmac_f32 v26, v6, v114
    v_fmac_f32 v27, v7, v114
    s_waitcnt vmcnt(28)
    v_lshlrev_b32 v4, 16, v92
    v_and_b32 v5, s6, v92
    v_fmac_f32 v20, v4, v115
    v_fmac_f32 v21, v5, v115
    v_lshlrev_b32 v6, 16, v93
    v_and_b32 v7, s6, v93
    v_fmac_f32 v22, v6, v115
    v_fmac_f32 v23, v7, v115
    v_lshlrev_b32 v4, 16, v94
    v_and_b32 v5, s6, v94
    v_fmac_f32 v24, v4, v115
    v_fmac_f32 v25, v5, v115
    v_lshlrev_b32 v6, 16, v95
    v_and_b32 v7, s6, v95
    v_fmac_f32 v26, v6, v115
    v_fmac_f32 v27, v7, v115
    s_waitcnt lgkmcnt(0)
    s_load_dword s24, s[32:33], s92 offset:2560 glc
    s_load_dword s25, s[32:33], s92 offset:2304 glc
    s_load_dword s26, s[32:33], s92 offset:3072 glc
    s_load_dword s27, s[32:33], s92 offset:2816 glc
    s_load_dword s28, s[32:33], s92 offset:3584 glc
    s_load_dword s29, s[32:33], s92 offset:3328 glc
    s_waitcnt vmcnt(22)
    s_barrier
    s_add_u32 s96, s85, 12
    s_and_b32 s97, s96, 15
    s_lshl3_add_u32 s98, s97, s3
    s_sub_u32 s99, s98, 4
    s_mul_i32 s96, s99, 49152
    s_lshl_b32 s97, s11, 7
    s_add_u32 s82, s96, s97
    s_sub_u32 s96, s3, 4
    s_lshl_b32 s20, s96, 10
    s_mov_b32 m0, s20
    s_nop 0
    buffer_load_dwordx4 v62, s[40:43], s82 offen lds
    s_add_u32 s82, s82, 2048
    s_add_u32 m0, s20, 8192
    s_nop 0
    buffer_load_dwordx4 v62, s[40:43], s82 offen lds
    s_add_u32 s82, s82, 2048
    s_add_u32 m0, s20, 16384
    s_nop 0
    buffer_load_dwordx4 v62, s[40:43], s82 offen lds
    s_add_u32 s96, s85, 12
    s_and_b32 s97, s96, 15
    s_lshl3_add_u32 s98, s97, s3
    s_mul_i32 s99, s98, 49152
    s_lshl_b32 s96, s11, 7
    s_add_u32 s82, s99, s96
    s_lshl_b32 s20, s3, 10
    s_mov_b32 m0, s20
    s_nop 0
    buffer_load_dwordx4 v62, s[40:43], s82 offen lds
    s_add_u32 s82, s82, 2048
    s_add_u32 m0, s20, 8192
    s_nop 0
    buffer_load_dwordx4 v62, s[40:43], s82 offen lds
    s_add_u32 s82, s82, 2048
    s_add_u32 m0, s20, 16384
    s_nop 0
    buffer_load_dwordx4 v62, s[40:43], s82 offen lds
    s_waitcnt vmcnt(22)
    s_barrier
    s_add_u32 s96, s85, 13
    s_and_b32 s97, s96, 15
    s_lshl3_add_u32 s98, s97, s3
    s_sub_u32 s99, s98, 4
    s_mul_i32 s96, s99, 49152
    s_lshl_b32 s97, s11, 7
    s_add_u32 s82, s96, s97
    s_sub_u32 s96, s3, 4
    s_lshl_b32 s97, s96, 10
    s_add_u32 s20, s97, 24576
    s_mov_b32 m0, s20
    s_nop 0
    buffer_load_dwordx4 v62, s[40:43], s82 offen lds
    s_add_u32 s82, s82, 2048
    s_add_u32 m0, s20, 8192
    s_nop 0
    buffer_load_dwordx4 v62, s[40:43], s82 offen lds
    s_add_u32 s82, s82, 2048
    s_add_u32 m0, s20, 16384
    s_nop 0
    buffer_load_dwordx4 v62, s[40:43], s82 offen lds
    s_add_u32 s96, s85, 13
    s_and_b32 s97, s96, 15
    s_lshl3_add_u32 s98, s97, s3
    s_mul_i32 s99, s98, 49152
    s_lshl_b32 s96, s11, 7
    s_add_u32 s82, s99, s96
    s_lshl_b32 s96, s3, 10
    s_add_u32 s20, s96, 24576
    s_mov_b32 m0, s20
    s_nop 0
    buffer_load_dwordx4 v62, s[40:43], s82 offen lds
    s_add_u32 s82, s82, 2048
    s_add_u32 m0, s20, 8192
    s_nop 0
    buffer_load_dwordx4 v62, s[40:43], s82 offen lds
    s_add_u32 s82, s82, 2048
    s_add_u32 m0, s20, 16384
    s_nop 0
    buffer_load_dwordx4 v62, s[40:43], s82 offen lds
    s_waitcnt vmcnt(27)
    v_lshlrev_b32 v4, 16, v96
    v_and_b32 v5, s6, v96
    v_fmac_f32 v20, v4, v116
    v_fmac_f32 v21, v5, v116
    v_lshlrev_b32 v6, 16, v97
    v_and_b32 v7, s6, v97
    v_fmac_f32 v22, v6, v116
    v_fmac_f32 v23, v7, v116
    v_lshlrev_b32 v4, 16, v98
    v_and_b32 v5, s6, v98
    v_fmac_f32 v24, v4, v116
    v_fmac_f32 v25, v5, v116
    v_lshlrev_b32 v6, 16, v99
    v_and_b32 v7, s6, v99
    v_fmac_f32 v26, v6, v116
    v_fmac_f32 v27, v7, v116
    s_waitcnt vmcnt(26)
    v_lshlrev_b32 v4, 16, v100
    v_and_b32 v5, s6, v100
    v_fmac_f32 v20, v4, v117
    v_fmac_f32 v21, v5, v117
    v_lshlrev_b32 v6, 16, v101
    v_and_b32 v7, s6, v101
    v_fmac_f32 v22, v6, v117
    v_fmac_f32 v23, v7, v117
    v_lshlrev_b32 v4, 16, v102
    v_and_b32 v5, s6, v102
    v_fmac_f32 v24, v4, v117
    v_fmac_f32 v25, v5, v117
    v_lshlrev_b32 v6, 16, v103
    v_and_b32 v7, s6, v103
    v_fmac_f32 v26, v6, v117
    v_fmac_f32 v27, v7, v117
    s_lshl_b32 s96, s74, 13
    s_sub_u32 s97, s3, 4
    s_lshl_b32 s98, s97, 8
    s_add_u32 s99, s96, s98
    s_add_u32 s13, s99, 20971520
    s_waitcnt lgkmcnt(0)
    s_load_dword s24, s[32:33], s13 offset:1276 glc
    s_load_dword s25, s[32:33], s13 offset:3324 glc
    s_load_dword s26, s[32:33], s13 offset:5372 glc
    s_load_dword s27, s[32:33], s13 offset:7420 glc
    s_waitcnt vmcnt(20)
    s_barrier
    s_add_u32 s96, s85, 14
    s_and_b32 s97, s96, 15
    s_lshl3_add_u32 s98, s97, s3
    s_sub_u32 s99, s98, 4
    s_mul_i32 s96, s99, 49152
    s_lshl_b32 s97, s11, 7
    s_add_u32 s82, s96, s97
    s_sub_u32 s96, s3, 4
    s_lshl_b32 s97, s96, 10
    s_add_u32 s20, s97, 49152
    s_mov_b32 m0, s20
    s_nop 0
    buffer_load_dwordx4 v62, s[40:43], s82 offen lds
    s_add_u32 s82, s82, 2048
    s_add_u32 m0, s20, 8192
    s_nop 0
    buffer_load_dwordx4 v62, s[40:43], s82 offen lds
    s_add_u32 s82, s82, 2048
    s_add_u32 m0, s20, 16384
    s_nop 0
    buffer_load_dwordx4 v62, s[40:43], s82 offen lds
    s_add_u32 s96, s85, 14
    s_and_b32 s97, s96, 15
    s_lshl3_add_u32 s98, s97, s3
    s_mul_i32 s99, s98, 49152
    s_lshl_b32 s96, s11, 7
    s_add_u32 s82, s99, s96
    s_lshl_b32 s96, s3, 10
    s_add_u32 s20, s96, 49152
    s_mov_b32 m0, s20
    s_nop 0
    buffer_load_dwordx4 v62, s[40:43], s82 offen lds
    s_add_u32 s82, s82, 2048
    s_add_u32 m0, s20, 8192
    s_nop 0
    buffer_load_dwordx4 v62, s[40:43], s82 offen lds
    s_add_u32 s82, s82, 2048
    s_add_u32 m0, s20, 16384
    s_nop 0
    buffer_load_dwordx4 v62, s[40:43], s82 offen lds
    s_waitcnt vmcnt(19)
    v_lshlrev_b32 v4, 16, v104
    v_and_b32 v5, s6, v104
    v_fmac_f32 v20, v4, v118
    v_fmac_f32 v21, v5, v118
    v_lshlrev_b32 v6, 16, v105
    v_and_b32 v7, s6, v105
    v_fmac_f32 v22, v6, v118
    v_fmac_f32 v23, v7, v118
    v_lshlrev_b32 v4, 16, v106
    v_and_b32 v5, s6, v106
    v_fmac_f32 v24, v4, v118
    v_fmac_f32 v25, v5, v118
    v_lshlrev_b32 v6, 16, v107
    v_and_b32 v7, s6, v107
    v_fmac_f32 v26, v6, v118
    v_fmac_f32 v27, v7, v118
    s_waitcnt vmcnt(18)
    v_lshlrev_b32 v4, 16, v108
    v_and_b32 v5, s6, v108
    v_fmac_f32 v20, v4, v119
    v_fmac_f32 v21, v5, v119
    v_lshlrev_b32 v6, 16, v109
    v_and_b32 v7, s6, v109
    v_fmac_f32 v22, v6, v119
    v_fmac_f32 v23, v7, v119
    v_lshlrev_b32 v4, 16, v110
    v_and_b32 v5, s6, v110
    v_fmac_f32 v24, v4, v119
    v_fmac_f32 v25, v5, v119
    v_lshlrev_b32 v6, 16, v111
    v_and_b32 v7, s6, v111
    v_fmac_f32 v26, v6, v119
    v_fmac_f32 v27, v7, v119
    s_barrier
    s_add_u32 s96, s85, 15
    s_and_b32 s97, s96, 15
    s_lshl3_add_u32 s98, s97, s3
    s_sub_u32 s99, s98, 4
    s_mul_i32 s96, s99, 49152
    s_lshl_b32 s97, s11, 7
    s_add_u32 s82, s96, s97
    s_sub_u32 s96, s3, 4
    s_lshl_b32 s97, s96, 10
    s_add_u32 s20, s97, 73728
    s_mov_b32 m0, s20
    s_nop 0
    buffer_load_dwordx4 v62, s[40:43], s82 offen lds
    s_add_u32 s82, s82, 2048
    s_add_u32 m0, s20, 8192
    s_nop 0
    buffer_load_dwordx4 v62, s[40:43], s82 offen lds
    s_add_u32 s82, s82, 2048
    s_add_u32 m0, s20, 16384
    s_nop 0
    buffer_load_dwordx4 v62, s[40:43], s82 offen lds
    s_add_u32 s96, s85, 15
    s_and_b32 s97, s96, 15
    s_lshl3_add_u32 s98, s97, s3
    s_mul_i32 s99, s98, 49152
    s_lshl_b32 s96, s11, 7
    s_add_u32 s82, s99, s96
    s_lshl_b32 s96, s3, 10
    s_add_u32 s20, s96, 73728
    s_mov_b32 m0, s20
    s_nop 0
    buffer_load_dwordx4 v62, s[40:43], s82 offen lds
    s_add_u32 s82, s82, 2048
    s_add_u32 m0, s20, 8192
    s_nop 0
    buffer_load_dwordx4 v62, s[40:43], s82 offen lds
    s_add_u32 s82, s82, 2048
    s_add_u32 m0, s20, 16384
    s_nop 0
    buffer_load_dwordx4 v62, s[40:43], s82 offen lds
    v_permlane32_swap_b32 v20, v24
    v_permlane32_swap_b32 v21, v25
    v_permlane32_swap_b32 v22, v26
    v_permlane32_swap_b32 v23, v27
    v_add_f32 v20, v20, v24
    v_add_f32 v21, v21, v25
    v_add_f32 v22, v22, v26
    v_add_f32 v23, v23, v27
    s_nop 0
    v_permlane16_swap_b32 v20, v22
    v_permlane16_swap_b32 v21, v23
    v_add_f32 v20, v20, v22
    v_add_f32 v21, v21, v23
    s_nop 0
    v_add_f32_dpp v20, v20, v20 row_ror:8 row_mask:0xf bank_mask:0xf
    v_add_f32_dpp v21, v21, v21 row_ror:8 row_mask:0xf bank_mask:0xf
    s_nop 1
    v_mov_b32_dpp v20, v21 quad_perm:[0,1,2,3] row_mask:0xf bank_mask:0xc
    ds_write_b32 v65, v20 offset:2048
    s_waitcnt lgkmcnt(0)
    s_waitcnt vmcnt(18)
    s_barrier
    s_cmp_lg_u32 s3, 4
    s_cbranch_scc1 L_M2F
    ds_read_b128 v[20:23], v64 offset:2064
    s_lshr_b32 s96, s8, 2
    s_lshl1_add_u32 s97, s9, s96
    s_and_b32 s98, s8, 3
    s_lshl2_add_u32 s99, s97, s98
    s_lshl_b32 s96, s99, 9
    s_add_u32 s13, s96, 131072
    s_waitcnt lgkmcnt(0)
    v_add_f32 v20, v20, v21
    v_add_f32 v22, v22, v23
    v_mov_b32 v21, s4
    v_add_f32 v20, v20, v22
    buffer_store_dwordx2 v[20:21], v63, s[32:35], s13 offen sc1
L_M2F:
    s_waitcnt vmcnt(12)
    s_waitcnt vmcnt(6)
    s_waitcnt vmcnt(0)
    s_barrier
    s_barrier
    s_add_u32 s96, s84, 983040
    s_and_b32 s97, s96, 1048575
    s_xor_b32 s98, s88, 1048576
    s_add_u32 s13, s97, s98
    s_add_u32 m0, s89, 94208
    s_nop 0
    buffer_load_dwordx4 v74, s[44:47], s13 offen lds
    s_add_u32 s96, s84, 1048576
    s_and_b32 s97, s96, 1048575
    s_xor_b32 s98, s88, 1048576
    s_add_u32 s13, s97, s98
    s_add_u32 m0, s89, 98304
    s_nop 0
    buffer_load_dwordx4 v74, s[44:47], s13 offen lds
    s_add_u32 s96, s84, 1114112
    s_and_b32 s97, s96, 1048575
    s_xor_b32 s98, s88, 1048576
    s_add_u32 s13, s97, s98
    s_add_u32 m0, s89, 102400
    s_nop 0
    buffer_load_dwordx4 v74, s[44:47], s13 offen lds
    s_add_u32 s96, s84, 1179648
    s_and_b32 s97, s96, 1048575
    s_xor_b32 s98, s88, 1048576
    s_add_u32 s13, s97, s98
    s_add_u32 m0, s89, 106496
    s_nop 0
    buffer_load_dwordx4 v74, s[44:47], s13 offen lds
    s_add_u32 s96, s84, 1245184
    s_and_b32 s97, s96, 1048575
    s_xor_b32 s98, s88, 1048576
    s_add_u32 s13, s97, s98
    s_add_u32 m0, s89, 110592
    s_nop 0
    buffer_load_dwordx4 v74, s[44:47], s13 offen lds
    s_add_u32 s96, s84, 1310720
    s_and_b32 s97, s96, 1048575
    s_xor_b32 s98, s88, 1048576
    s_add_u32 s13, s97, s98
    s_add_u32 m0, s89, 114688
    s_nop 0
    buffer_load_dwordx4 v74, s[44:47], s13 offen lds
    s_add_u32 s96, s84, 1376256
    s_and_b32 s97, s96, 1048575
    s_xor_b32 s98, s88, 1048576
    s_add_u32 s13, s97, s98
    s_add_u32 m0, s89, 118784
    s_nop 0
    buffer_load_dwordx4 v74, s[44:47], s13 offen lds
    s_add_u32 s96, s84, 1441792
    s_and_b32 s97, s96, 1048575
    s_xor_b32 s98, s88, 1048576
    s_add_u32 s13, s97, s98
    s_add_u32 m0, s89, 122880
    s_nop 0
    buffer_load_dwordx4 v74, s[44:47], s13 offen lds
    s_mov_b32 s13, s80
    buffer_load_dwordx4 v[176:179], v72, s[52:55], s13 offen nt
    s_add_u32 s13, s80, 4294049792
    buffer_load_dwordx4 v[180:183], v72, s[52:55], s13 offen nt
    s_add_u32 s13, s80, 57344
    buffer_load_dwordx4 v[184:187], v72, s[52:55], s13 offen nt
    s_add_u32 s13, s80, 4294107136
    buffer_load_dwordx4 v[188:191], v72, s[52:55], s13 offen nt
    s_add_u32 s13, s80, 114688
    buffer_load_dwordx4 v[192:195], v72, s[52:55], s13 offen nt
    s_add_u32 s13, s80, 4294164480
    buffer_load_dwordx4 v[196:199], v72, s[52:55], s13 offen nt
    s_add_u32 s13, s80, 172032
    buffer_load_dwordx4 v[200:203], v72, s[52:55], s13 offen nt
    s_add_u32 s13, s80, 4294221824
    buffer_load_dwordx4 v[204:207], v72, s[52:55], s13 offen nt
    s_waitcnt lgkmcnt(0)
    s_barrier
    ds_read_b128 v[36:39], v76
    ds_read_b128 v[40:43], v76 offset:1024
    s_waitcnt lgkmcnt(0)
    v_mfma_f32_32x32x16_bf16 v[112:127], v[28:31], v[36:39], 0
    v_mfma_f32_32x32x16_bf16 v[112:127], v[32:35], v[40:43], v[112:127]
    s_mov_b32 s13, s80
    buffer_load_dwordx4 v[208:211], v72, s[56:59], s13 offen nt
    s_add_u32 s13, s80, 4294049792
    buffer_load_dwordx4 v[212:215], v72, s[56:59], s13 offen nt
    s_add_u32 s13, s80, 57344
    buffer_load_dwordx4 v[216:219], v72, s[56:59], s13 offen nt
    s_add_u32 s13, s80, 4294107136
    buffer_load_dwordx4 v[220:223], v72, s[56:59], s13 offen nt
L_JOIN:
    s_nop 3
    v_cvt_pk_bf16_f32 v112, 0, v112
    v_cvt_pk_bf16_f32 v113, 0, v113
    v_cvt_pk_bf16_f32 v114, 0, v114
    v_cvt_pk_bf16_f32 v115, 0, v115
    v_cvt_pk_bf16_f32 v116, 0, v116
    v_cvt_pk_bf16_f32 v117, 0, v117
    v_cvt_pk_bf16_f32 v118, 0, v118
    v_cvt_pk_bf16_f32 v119, 0, v119
    v_cvt_pk_bf16_f32 v120, 0, v120
    v_cvt_pk_bf16_f32 v121, 0, v121
    v_cvt_pk_bf16_f32 v122, 0, v122
    v_cvt_pk_bf16_f32 v123, 0, v123
    v_cvt_pk_bf16_f32 v124, 0, v124
    v_cvt_pk_bf16_f32 v125, 0, v125
    v_cvt_pk_bf16_f32 v126, 0, v126
    v_cvt_pk_bf16_f32 v127, 0, v127
    v_max3_f32 v4, v112, v113, v114
    v_min3_f32 v5, v112, v113, v114
    v_max3_f32 v4, v4, v115, v116
    v_min3_f32 v5, v5, v115, v116
    v_max3_f32 v4, v4, v117, v118
    v_min3_f32 v5, v5, v117, v118
    v_max3_f32 v4, v4, v119, v120
    v_min3_f32 v5, v5, v119, v120
    v_max3_f32 v4, v4, v121, v122
    v_min3_f32 v5, v5, v121, v122
    v_max3_f32 v4, v4, v123, v124
    v_min3_f32 v5, v5, v123, v124
    v_max3_f32 v4, v4, v125, v126
    v_min3_f32 v5, v5, v125, v126
    v_max_f32 v6, v4, v127
    v_min_f32 v7, v5, v127
    v_max_f32 v4, v4, v127
    v_min_f32 v5, v5, v127
    s_nop 0
    v_permlane32_swap_b32 v4, v6
    v_permlane32_swap_b32 v5, v7
    v_max_f32 v4, v4, v6
    v_min_f32 v5, v5, v7
    v_pk_mul_f32 v[4:5], v[4:5], s[6:7] op_sel:[0,1]
    v_pk_fma_f32 v[128:129], v[112:113], s[6:7], v[4:5] op_sel:[0,1,0] op_sel_hi:[1,1,0] neg_lo:[0,0,1] neg_hi:[0,0,1]
    v_pk_fma_f32 v[112:113], v[112:113], s[6:7], v[4:5] op_sel:[0,1,1] neg_lo:[1,0,0] neg_hi:[1,0,0]
    v_pk_fma_f32 v[130:131], v[114:115], s[6:7], v[4:5] op_sel:[0,1,0] op_sel_hi:[1,1,0] neg_lo:[0,0,1] neg_hi:[0,0,1]
    v_pk_fma_f32 v[114:115], v[114:115], s[6:7], v[4:5] op_sel:[0,1,1] neg_lo:[1,0,0] neg_hi:[1,0,0]
    v_pk_fma_f32 v[132:133], v[116:117], s[6:7], v[4:5] op_sel:[0,1,0] op_sel_hi:[1,1,0] neg_lo:[0,0,1] neg_hi:[0,0,1]
    v_pk_fma_f32 v[116:117], v[116:117], s[6:7], v[4:5] op_sel:[0,1,1] neg_lo:[1,0,0] neg_hi:[1,0,0]
    v_pk_fma_f32 v[134:135], v[118:119], s[6:7], v[4:5] op_sel:[0,1,0] op_sel_hi:[1,1,0] neg_lo:[0,0,1] neg_hi:[0,0,1]
    v_pk_fma_f32 v[118:119], v[118:119], s[6:7], v[4:5] op_sel:[0,1,1] neg_lo:[1,0,0] neg_hi:[1,0,0]
    v_pk_fma_f32 v[136:137], v[120:121], s[6:7], v[4:5] op_sel:[0,1,0] op_sel_hi:[1,1,0] neg_lo:[0,0,1] neg_hi:[0,0,1]
    v_pk_fma_f32 v[120:121], v[120:121], s[6:7], v[4:5] op_sel:[0,1,1] neg_lo:[1,0,0] neg_hi:[1,0,0]
    v_pk_fma_f32 v[138:139], v[122:123], s[6:7], v[4:5] op_sel:[0,1,0] op_sel_hi:[1,1,0] neg_lo:[0,0,1] neg_hi:[0,0,1]
    v_pk_fma_f32 v[122:123], v[122:123], s[6:7], v[4:5] op_sel:[0,1,1] neg_lo:[1,0,0] neg_hi:[1,0,0]
    v_pk_fma_f32 v[140:141], v[124:125], s[6:7], v[4:5] op_sel:[0,1,0] op_sel_hi:[1,1,0] neg_lo:[0,0,1] neg_hi:[0,0,1]
    v_pk_fma_f32 v[124:125], v[124:125], s[6:7], v[4:5] op_sel:[0,1,1] neg_lo:[1,0,0] neg_hi:[1,0,0]
    v_pk_fma_f32 v[142:143], v[126:127], s[6:7], v[4:5] op_sel:[0,1,0] op_sel_hi:[1,1,0] neg_lo:[0,0,1] neg_hi:[0,0,1]
    v_pk_fma_f32 v[126:127], v[126:127], s[6:7], v[4:5] op_sel:[0,1,1] neg_lo:[1,0,0] neg_hi:[1,0,0]
    v_exp_f32 v128, v128
    v_exp_f32 v112, v112
    v_exp_f32 v129, v129
    v_exp_f32 v113, v113
    v_exp_f32 v130, v130
    v_exp_f32 v114, v114
    v_exp_f32 v131, v131
    v_exp_f32 v115, v115
    v_exp_f32 v132, v132
    v_exp_f32 v116, v116
    v_exp_f32 v133, v133
    v_exp_f32 v117, v117
    v_exp_f32 v134, v134
    v_exp_f32 v118, v118
    v_exp_f32 v135, v135
    v_exp_f32 v119, v119
    v_exp_f32 v136, v136
    v_exp_f32 v120, v120
    v_exp_f32 v137, v137
    v_exp_f32 v121, v121
    v_exp_f32 v138, v138
    v_exp_f32 v122, v122
    v_exp_f32 v139, v139
    v_exp_f32 v123, v123
    v_exp_f32 v140, v140
    v_exp_f32 v124, v124
    v_exp_f32 v141, v141
    v_exp_f32 v125, v125
    v_exp_f32 v142, v142
    v_exp_f32 v126, v126
    v_exp_f32 v143, v143
    v_exp_f32 v127, v127
    v_pk_add_f32 v[8:9], v[128:129], v[130:131]
    v_pk_add_f32 v[10:11], v[112:113], v[114:115]
    v_pk_add_f32 v[8:9], v[8:9], v[132:133]
    v_pk_add_f32 v[10:11], v[10:11], v[116:117]
    v_pk_add_f32 v[8:9], v[8:9], v[134:135]
    v_pk_add_f32 v[10:11], v[10:11], v[118:119]
    v_pk_add_f32 v[8:9], v[8:9], v[136:137]
    v_pk_add_f32 v[10:11], v[10:11], v[120:121]
    v_pk_add_f32 v[8:9], v[8:9], v[138:139]
    v_pk_add_f32 v[10:11], v[10:11], v[122:123]
    v_pk_add_f32 v[8:9], v[8:9], v[140:141]
    v_pk_add_f32 v[10:11], v[10:11], v[124:125]
    v_pk_add_f32 v[8:9], v[8:9], v[142:143]
    v_pk_add_f32 v[10:11], v[10:11], v[126:127]
    v_add_f32 v6, v8, v9
    v_add_f32 v7, v10, v11
    v_add_f32 v4, v8, v9
    v_add_f32 v5, v10, v11
    s_nop 0
    v_permlane32_swap_b32 v4, v6
    v_permlane32_swap_b32 v5, v7
    v_pk_add_f32 v[4:5], v[4:5], v[6:7]
    v_rcp_f32 v4, v4
    v_rcp_f32 v5, v5
    s_nop 0
    v_pk_mul_f32 v[128:129], v[128:129], v[4:5] op_sel_hi:[1,0]
    v_pk_mul_f32 v[112:113], v[112:113], v[4:5] op_sel:[0,1]
    v_pk_mul_f32 v[130:131], v[130:131], v[4:5] op_sel_hi:[1,0]
    v_pk_mul_f32 v[114:115], v[114:115], v[4:5] op_sel:[0,1]
    v_pk_mul_f32 v[132:133], v[132:133], v[4:5] op_sel_hi:[1,0]
    v_pk_mul_f32 v[116:117], v[116:117], v[4:5] op_sel:[0,1]
    v_pk_mul_f32 v[134:135], v[134:135], v[4:5] op_sel_hi:[1,0]
    v_pk_mul_f32 v[118:119], v[118:119], v[4:5] op_sel:[0,1]
    v_pk_mul_f32 v[136:137], v[136:137], v[4:5] op_sel_hi:[1,0]
    v_pk_mul_f32 v[120:121], v[120:121], v[4:5] op_sel:[0,1]
    v_pk_mul_f32 v[138:139], v[138:139], v[4:5] op_sel_hi:[1,0]
    v_pk_mul_f32 v[122:123], v[122:123], v[4:5] op_sel:[0,1]
    v_pk_mul_f32 v[140:141], v[140:141], v[4:5] op_sel_hi:[1,0]
    v_pk_mul_f32 v[124:125], v[124:125], v[4:5] op_sel:[0,1]
    v_pk_mul_f32 v[142:143], v[142:143], v[4:5] op_sel_hi:[1,0]
    v_pk_mul_f32 v[126:127], v[126:127], v[4:5] op_sel:[0,1]
    v_cvt_pk_bf16_f32 v80, v128, v129
    v_cvt_pk_bf16_f32 v88, v112, v113
    v_cvt_pk_bf16_f32 v81, v130, v131
    v_cvt_pk_bf16_f32 v89, v114, v115
    v_cvt_pk_bf16_f32 v82, v132, v133
    v_cvt_pk_bf16_f32 v90, v116, v117
    v_cvt_pk_bf16_f32 v83, v134, v135
    v_cvt_pk_bf16_f32 v91, v118, v119
    v_cvt_pk_bf16_f32 v84, v136, v137
    v_cvt_pk_bf16_f32 v92, v120, v121
    v_cvt_pk_bf16_f32 v85, v138, v139
    v_cvt_pk_bf16_f32 v93, v122, v123
    v_cvt_pk_bf16_f32 v86, v140, v141
    v_cvt_pk_bf16_f32 v94, v124, v125
    v_cvt_pk_bf16_f32 v87, v142, v143
    v_cvt_pk_bf16_f32 v95, v126, v127
    ds_write_b128 v75, v[80:83]
    ds_write_b128 v75, v[84:87] offset:4096
    ds_write_b128 v75, v[88:91] offset:8192
    ds_write_b128 v75, v[92:95] offset:12288
    s_lshl_b32 s13, s3, 12
    v_add_u32 v20, s13, v63
    s_lshl_b32 s96, s76, 13
    s_add_u32 s13, s96, 32768
    v_add_u32 v21, s13, v63
    v_mov_b32 v36, 0x3f803f80
    v_mov_b32 v37, 0x3f803f80
    v_mov_b32 v38, 0x3f803f80
    v_mov_b32 v39, 0x3f803f80
    s_lshl3_add_u32 s96, s11, s3
    s_lshl_b32 s97, s96, 5
    s_add_u32 s98, s97, s10
    s_lshl_b32 s99, s98, 10
    s_add_u32 s13, s99, 25165824
    s_add_u32 s15, s13, 16384
    s_lshl3_add_u32 s96, s11, s3
    s_lshl_b32 s97, s96, 10
    s_add_u32 s16, s97, 21495808
    s_lshl_b32 s96, s10, 6
    s_add_u32 s14, s96, s16
    s_waitcnt lgkmcnt(0)
    s_barrier
    ds_read_b64_tr_b16 v[128:129], v20
    ds_read_b64_tr_b16 v[130:131], v20 offset:512
    ds_read_b64_tr_b16 v[144:145], v21
    ds_read_b64_tr_b16 v[146:147], v21 offset:512
    ds_read_b64_tr_b16 v[148:149], v21 offset:4096
    ds_read_b64_tr_b16 v[150:151], v21 offset:4608
    ds_read_b64_tr_b16 v[132:133], v20 offset:1024
    ds_read_b64_tr_b16 v[134:135], v20 offset:1536
    ds_read_b64_tr_b16 v[152:153], v21 offset:1024
    ds_read_b64_tr_b16 v[154:155], v21 offset:1536
    ds_read_b64_tr_b16 v[156:157], v21 offset:5120
    ds_read_b64_tr_b16 v[158:159], v21 offset:5632
    ds_read_b64_tr_b16 v[136:137], v20 offset:2048
    ds_read_b64_tr_b16 v[138:139], v20 offset:2560
    ds_read_b64_tr_b16 v[160:161], v21 offset:2048
    ds_read_b64_tr_b16 v[162:163], v21 offset:2560
    ds_read_b64_tr_b16 v[164:165], v21 offset:6144
    ds_read_b64_tr_b16 v[166:167], v21 offset:6656
    s_waitcnt lgkmcnt(12)
    v_mfma_f32_16x16x32_bf16 v[52:55], v[128:131], v[144:147], 0
    v_mfma_f32_16x16x32_bf16 v[56:59], v[128:131], v[148:151], 0
    v_mfma_f32_16x16x32_bf16 v[40:43], v[128:131], v[36:39], 0
    ds_read_b64_tr_b16 v[140:141], v20 offset:3072
    ds_read_b64_tr_b16 v[142:143], v20 offset:3584
    ds_read_b64_tr_b16 v[168:169], v21 offset:3072
    ds_read_b64_tr_b16 v[170:171], v21 offset:3584
    ds_read_b64_tr_b16 v[172:173], v21 offset:7168
    ds_read_b64_tr_b16 v[174:175], v21 offset:7680
    s_waitcnt lgkmcnt(12)
    v_mfma_f32_16x16x32_bf16 v[52:55], v[132:135], v[152:155], v[52:55]
    v_mfma_f32_16x16x32_bf16 v[56:59], v[132:135], v[156:159], v[56:59]
    v_mfma_f32_16x16x32_bf16 v[40:43], v[132:135], v[36:39], v[40:43]
    s_waitcnt lgkmcnt(6)
    v_mfma_f32_16x16x32_bf16 v[52:55], v[136:139], v[160:163], v[52:55]
    v_mfma_f32_16x16x32_bf16 v[56:59], v[136:139], v[164:167], v[56:59]
    v_mfma_f32_16x16x32_bf16 v[40:43], v[136:139], v[36:39], v[40:43]
    s_waitcnt lgkmcnt(0)
    v_mfma_f32_16x16x32_bf16 v[52:55], v[140:143], v[168:171], v[52:55]
    v_mfma_f32_16x16x32_bf16 v[56:59], v[140:143], v[172:175], v[56:59]
    v_mfma_f32_16x16x32_bf16 v[40:43], v[140:143], v[36:39], v[40:43]
    s_cmp_lt_u32 s3, 4
    s_cbranch_scc1 L_NOQX
    ds_read_b128 v[44:47], v76 offset:2048
    ds_read_b128 v[48:51], v76 offset:3072
L_NOQX:
    s_nop 3
    buffer_store_dwordx4 v[52:55], v2, s[32:35], s13 offen sc1
    buffer_store_dwordx4 v[56:59], v2, s[32:35], s15 offen sc1
    s_mov_b32 exec_lo, 0x00010001
    s_mov_b32 exec_hi, 0x00010001
    buffer_store_dwordx4 v[40:43], v1, s[32:35], s14 offen sc1
    s_mov_b64 exec, -1
    s_waitcnt lgkmcnt(0)
    v_mfma_f32_32x32x16_bf16 v[112:127], v[28:31], v[44:47], 0
    v_mfma_f32_32x32x16_bf16 v[112:127], v[32:35], v[48:51], v[112:127]
    v_and_b32 v75, 7, v1
    v_lshlrev_b32 v75, 17, v75
    v_bfe_u32 v9, v1, 3, 1
    v_lshl_add_u32 v75, v9, 14, v75
    s_and_b32 s96, s10, 1
    s_and_b32 s97, s2, 27
    s_lshl_b32 s98, s97, 12
    s_lshr_b32 s99, s10, 1
    s_lshl_b32 s97, s99, 6
    s_add_u32 s99, s98, s97
    s_lshl2_add_u32 s98, s96, s99
    s_add_u32 s97, s98, 1048576
    s_add_u32 s17, s97, 512
    v_and_b32 v22, 15, v1
    v_lshlrev_b32 v22, 3, v22
    v_lshrrev_b32 v9, 5, v1
    v_lshl_add_u32 v22, v9, 7, v22
    v_lshrrev_b32 v23, 3, v1
    v_lshlrev_b32 v23, 10, v23
    v_and_b32 v9, 7, v1
    v_lshl_add_u32 v23, v9, 4, v23
    v_and_b32 v76, 7, v1
    v_lshlrev_b32 v76, 4, v76
    v_lshrrev_b32 v9, 5, v1
    v_lshl_add_u32 v76, v9, 3, v76
    s_lshl_b32 s96, s12, 11
    s_lshl_b32 s97, s76, 8
    s_add_u32 s98, s96, s97
    s_add_u32 s18, s98, 131072
    v_cvt_pk_bf16_f32 v112, 0, v112
    v_cvt_pk_bf16_f32 v113, 0, v113
    v_cvt_pk_bf16_f32 v114, 0, v114
    v_cvt_pk_bf16_f32 v115, 0, v115
    v_cvt_pk_bf16_f32 v116, 0, v116
    v_cvt_pk_bf16_f32 v117, 0, v117
    v_cvt_pk_bf16_f32 v118, 0, v118
    v_cvt_pk_bf16_f32 v119, 0, v119
    v_cvt_pk_bf16_f32 v120, 0, v120
    v_cvt_pk_bf16_f32 v121, 0, v121
    v_cvt_pk_bf16_f32 v122, 0, v122
    v_cvt_pk_bf16_f32 v123, 0, v123
    v_cvt_pk_bf16_f32 v124, 0, v124
    v_cvt_pk_bf16_f32 v125, 0, v125
    v_cvt_pk_bf16_f32 v126, 0, v126
    v_cvt_pk_bf16_f32 v127, 0, v127
    v_max3_f32 v4, v112, v113, v114
    v_min3_f32 v5, v112, v113, v114
    v_max3_f32 v4, v4, v115, v116
    v_min3_f32 v5, v5, v115, v116
    v_max3_f32 v4, v4, v117, v118
    v_min3_f32 v5, v5, v117, v118
    v_max3_f32 v4, v4, v119, v120
    v_min3_f32 v5, v5, v119, v120
    v_max3_f32 v4, v4, v121, v122
    v_min3_f32 v5, v5, v121, v122
    v_max3_f32 v4, v4, v123, v124
    v_min3_f32 v5, v5, v123, v124
    v_max3_f32 v4, v4, v125, v126
    v_min3_f32 v5, v5, v125, v126
    v_max_f32 v6, v4, v127
    v_min_f32 v7, v5, v127
    v_max_f32 v4, v4, v127
    v_min_f32 v5, v5, v127
    s_nop 0
    v_permlane32_swap_b32 v4, v6
    v_permlane32_swap_b32 v5, v7
    v_max_f32 v4, v4, v6
    v_min_f32 v5, v5, v7
    v_pk_mul_f32 v[4:5], v[4:5], s[6:7] op_sel:[0,1]
    v_pk_fma_f32 v[128:129], v[112:113], s[6:7], v[4:5] op_sel:[0,1,0] op_sel_hi:[1,1,0] neg_lo:[0,0,1] neg_hi:[0,0,1]
    v_pk_fma_f32 v[112:113], v[112:113], s[6:7], v[4:5] op_sel:[0,1,1] neg_lo:[1,0,0] neg_hi:[1,0,0]
    v_pk_fma_f32 v[130:131], v[114:115], s[6:7], v[4:5] op_sel:[0,1,0] op_sel_hi:[1,1,0] neg_lo:[0,0,1] neg_hi:[0,0,1]
    v_pk_fma_f32 v[114:115], v[114:115], s[6:7], v[4:5] op_sel:[0,1,1] neg_lo:[1,0,0] neg_hi:[1,0,0]
    v_pk_fma_f32 v[132:133], v[116:117], s[6:7], v[4:5] op_sel:[0,1,0] op_sel_hi:[1,1,0] neg_lo:[0,0,1] neg_hi:[0,0,1]
    v_pk_fma_f32 v[116:117], v[116:117], s[6:7], v[4:5] op_sel:[0,1,1] neg_lo:[1,0,0] neg_hi:[1,0,0]
    v_pk_fma_f32 v[134:135], v[118:119], s[6:7], v[4:5] op_sel:[0,1,0] op_sel_hi:[1,1,0] neg_lo:[0,0,1] neg_hi:[0,0,1]
    v_pk_fma_f32 v[118:119], v[118:119], s[6:7], v[4:5] op_sel:[0,1,1] neg_lo:[1,0,0] neg_hi:[1,0,0]
    v_pk_fma_f32 v[136:137], v[120:121], s[6:7], v[4:5] op_sel:[0,1,0] op_sel_hi:[1,1,0] neg_lo:[0,0,1] neg_hi:[0,0,1]
    v_pk_fma_f32 v[120:121], v[120:121], s[6:7], v[4:5] op_sel:[0,1,1] neg_lo:[1,0,0] neg_hi:[1,0,0]
    v_pk_fma_f32 v[138:139], v[122:123], s[6:7], v[4:5] op_sel:[0,1,0] op_sel_hi:[1,1,0] neg_lo:[0,0,1] neg_hi:[0,0,1]
    v_pk_fma_f32 v[122:123], v[122:123], s[6:7], v[4:5] op_sel:[0,1,1] neg_lo:[1,0,0] neg_hi:[1,0,0]
    v_pk_fma_f32 v[140:141], v[124:125], s[6:7], v[4:5] op_sel:[0,1,0] op_sel_hi:[1,1,0] neg_lo:[0,0,1] neg_hi:[0,0,1]
    v_pk_fma_f32 v[124:125], v[124:125], s[6:7], v[4:5] op_sel:[0,1,1] neg_lo:[1,0,0] neg_hi:[1,0,0]
    v_pk_fma_f32 v[142:143], v[126:127], s[6:7], v[4:5] op_sel:[0,1,0] op_sel_hi:[1,1,0] neg_lo:[0,0,1] neg_hi:[0,0,1]
    v_pk_fma_f32 v[126:127], v[126:127], s[6:7], v[4:5] op_sel:[0,1,1] neg_lo:[1,0,0] neg_hi:[1,0,0]
    v_exp_f32 v128, v128
    v_exp_f32 v112, v112
    v_exp_f32 v129, v129
    v_exp_f32 v113, v113
    v_exp_f32 v130, v130
    v_exp_f32 v114, v114
    v_exp_f32 v131, v131
    v_exp_f32 v115, v115
    v_exp_f32 v132, v132
    v_exp_f32 v116, v116
    v_exp_f32 v133, v133
    v_exp_f32 v117, v117
    v_exp_f32 v134, v134
    v_exp_f32 v118, v118
    v_exp_f32 v135, v135
    v_exp_f32 v119, v119
    s_waitcnt vmcnt(0)
    s_barrier
    s_cmp_lg_u32 s3, 0
    s_cbranch_scc1 L_PC
    v_mov_b32 v21, s4
    s_mov_b32 exec_hi, 0
    s_mov_b32 exec_lo, 65535
    buffer_store_dword v21, v75, s[32:35], s17 offen sc1
    s_mov_b64 exec, -1
L_PC:
    s_cmp_eq_u32 s90, 0
    s_cbranch_scc1 L_NOMF0
    buffer_load_dwordx2 v[52:53], v63, s[32:35], s90 offen sc1
    buffer_load_dwordx2 v[54:55], v63, s[32:35], s90 offen offset:512 sc1
    buffer_load_dwordx2 v[56:57], v63, s[32:35], s90 offen offset:1024 sc1
    buffer_load_dwordx2 v[58:59], v63, s[32:35], s90 offen offset:1536 sc1
L_NOMF0:
    s_add_u32 s96, s84, 262144
    s_and_b32 s97, s96, 1048575
    s_add_u32 s19, s97, s88
    s_add_u32 m0, s89, 49152
    s_nop 0
    buffer_load_dwordx4 v74, s[44:47], s19 offen lds
    v_exp_f32 v136, v136
    v_exp_f32 v120, v120
    v_exp_f32 v137, v137
    v_exp_f32 v121, v121
    v_exp_f32 v138, v138
    v_exp_f32 v122, v122
    v_exp_f32 v139, v139
    v_exp_f32 v123, v123
    s_add_u32 s96, s84, 393216
    s_and_b32 s97, s96, 1048575
    s_add_u32 s19, s97, s88
    s_add_u32 m0, s89, 57344
    s_nop 0
    buffer_load_dwordx4 v74, s[44:47], s19 offen lds
    v_exp_f32 v140, v140
    v_exp_f32 v124, v124
    v_exp_f32 v141, v141
    v_exp_f32 v125, v125
    v_exp_f32 v142, v142
    v_exp_f32 v126, v126
    v_exp_f32 v143, v143
    v_exp_f32 v127, v127
    s_lshl4_add_u32 s96, s11, s10
    s_lshl_b32 s97, s96, 14
    s_lshl_b32 s98, s3, 7
    s_add_u32 s99, s97, s98
    s_add_u32 s13, s99, 25165824
    s_add_u32 s14, s13, 8192
    s_lshl4_add_u32 s96, s11, s10
    s_lshl_b32 s97, s96, 10
    s_lshl_b32 s98, s3, 7
    s_add_u32 s99, s97, s98
    s_add_u32 s15, s99, 29360128
    s_add_u32 s17, s17, 3072
    s_load_dwordx2 s[24:25], s[32:33], s92 offset:512 glc
    s_add_u32 s96, s84, 524288
    s_and_b32 s97, s96, 1048575
    s_add_u32 s19, s97, s88
    s_add_u32 m0, s89, 65536
    s_nop 0
    buffer_load_dwordx4 v74, s[44:47], s19 offen lds
    v_pk_add_f32 v[8:9], v[128:129], v[130:131]
    v_pk_add_f32 v[10:11], v[112:113], v[114:115]
    v_pk_add_f32 v[8:9], v[8:9], v[132:133]
    v_pk_add_f32 v[10:11], v[10:11], v[116:117]
    v_pk_add_f32 v[8:9], v[8:9], v[134:135]
    v_pk_add_f32 v[10:11], v[10:11], v[118:119]
    v_pk_add_f32 v[8:9], v[8:9], v[136:137]
    v_pk_add_f32 v[10:11], v[10:11], v[120:121]
    v_pk_add_f32 v[8:9], v[8:9], v[138:139]
    v_pk_add_f32 v[10:11], v[10:11], v[122:123]
    v_pk_add_f32 v[8:9], v[8:9], v[140:141]
    v_pk_add_f32 v[10:11], v[10:11], v[124:125]
    v_pk_add_f32 v[8:9], v[8:9], v[142:143]
    v_pk_add_f32 v[10:11], v[10:11], v[126:127]
    s_add_u32 s96, s84, 655360
    s_and_b32 s97, s96, 1048575
    s_add_u32 s19, s97, s88
    s_add_u32 m0, s89, 73728
    s_nop 0
    buffer_load_dwordx4 v74, s[44:47], s19 offen lds
    v_add_f32 v6, v8, v9
    v_add_f32 v7, v10, v11
    v_add_f32 v4, v8, v9
    v_add_f32 v5, v10, v11
    s_nop 0
    v_permlane32_swap_b32 v4, v6
    v_permlane32_swap_b32 v5, v7
    v_pk_add_f32 v[4:5], v[4:5], v[6:7]
    v_rcp_f32 v4, v4
    v_rcp_f32 v5, v5
    s_nop 0
    v_pk_mul_f32 v[128:129], v[128:129], v[4:5] op_sel_hi:[1,0]
    v_pk_mul_f32 v[112:113], v[112:113], v[4:5] op_sel:[0,1]
    v_pk_mul_f32 v[130:131], v[130:131], v[4:5] op_sel_hi:[1,0]
    v_pk_mul_f32 v[114:115], v[114:115], v[4:5] op_sel:[0,1]
    v_pk_mul_f32 v[132:133], v[132:133], v[4:5] op_sel_hi:[1,0]
    s_add_u32 s96, s84, 786432
    s_and_b32 s97, s96, 1048575
    s_add_u32 s19, s97, s88
    s_add_u32 m0, s89, 81920
    s_nop 0
    buffer_load_dwordx4 v74, s[44:47], s19 offen lds
    v_pk_mul_f32 v[116:117], v[116:117], v[4:5] op_sel:[0,1]
    v_pk_mul_f32 v[134:135], v[134:135], v[4:5] op_sel_hi:[1,0]
    v_pk_mul_f32 v[118:119], v[118:119], v[4:5] op_sel:[0,1]
    v_pk_mul_f32 v[136:137], v[136:137], v[4:5] op_sel_hi:[1,0]
    v_pk_mul_f32 v[120:121], v[120:121], v[4:5] op_sel:[0,1]
    v_pk_mul_f32 v[138:139], v[138:139], v[4:5] op_sel_hi:[1,0]
    v_pk_mul_f32 v[122:123], v[122:123], v[4:5] op_sel:[0,1]
    v_pk_mul_f32 v[140:141], v[140:141], v[4:5] op_sel_hi:[1,0]
    v_pk_mul_f32 v[124:125], v[124:125], v[4:5] op_sel:[0,1]
    v_pk_mul_f32 v[142:143], v[142:143], v[4:5] op_sel_hi:[1,0]
    v_pk_mul_f32 v[126:127], v[126:127], v[4:5] op_sel:[0,1]
    v_cvt_pk_bf16_f32 v80, v128, v129
    v_cvt_pk_bf16_f32 v88, v112, v113
    v_cvt_pk_bf16_f32 v81, v130, v131
    s_add_u32 s96, s84, 917504
    s_and_b32 s97, s96, 1048575
    s_add_u32 s19, s97, s88
    s_add_u32 m0, s89, 90112
    s_nop 0
    buffer_load_dwordx4 v74, s[44:47], s19 offen lds
    v_cvt_pk_bf16_f32 v89, v114, v115
    v_cvt_pk_bf16_f32 v82, v132, v133
    v_cvt_pk_bf16_f32 v90, v116, v117
    v_cvt_pk_bf16_f32 v83, v134, v135
    v_cvt_pk_bf16_f32 v91, v118, v119
    v_cvt_pk_bf16_f32 v84, v136, v137
    v_cvt_pk_bf16_f32 v92, v120, v121
    v_cvt_pk_bf16_f32 v85, v138, v139
    v_cvt_pk_bf16_f32 v93, v122, v123
    v_cvt_pk_bf16_f32 v86, v140, v141
    v_cvt_pk_bf16_f32 v94, v124, v125
    v_cvt_pk_bf16_f32 v87, v142, v143
    v_cvt_pk_bf16_f32 v95, v126, v127
    s_branch SCHK_19
SPOLL_18:
    s_load_dwordx2 s[24:25], s[32:33], s92 offset:512 glc
SCHK_19:
    s_add_u32 s5, s5, 1
    s_cmp_ge_u32 s5, 200000
    s_waitcnt lgkmcnt(0)
    s_cbranch_scc1 SDONE_20
    s_cmp_lg_u32 s24, s4
    s_cbranch_scc1 SPOLL_18
    s_cmp_lg_u32 s25, s4
    s_cbranch_scc1 SPOLL_18
SDONE_20:
    s_barrier
    buffer_load_dwordx4 v[144:147], v23, s[32:35], s13 offen sc1
    buffer_load_dwordx4 v[148:151], v23, s[32:35], s14 offen sc1
    s_lshl_b32 s96, s3, 5
    s_add_u32 s14, s96, 8192
    v_and_b32 v6, 3, v1
    v_lshl_add_u32 v6, v6, 3, s14
    v_lshrrev_b32 v9, 5, v1
    v_lshl_add_u32 v6, v9, 2, v6
    s_lshl_b32 s14, s3, 10
    v_and_b32 v5, 15, v1
    v_lshl_add_u32 v5, v5, 4, s14
    v_lshrrev_b32 v9, 5, v1
    v_lshl_add_u32 v5, v9, 9, v5
    v_bfe_u32 v9, v1, 4, 1
    v_lshl_add_u32 v5, v9, 3, v5
    s_lshl_b32 s96, s76, 7
    s_add_u32 s14, s96, 8192
    v_lshrrev_b32 v7, 5, v1
    v_lshl_add_u32 v7, v7, 4, s14
    s_lshl_b32 s14, s76, 12
    v_add_u32 v20, s14, v2
    buffer_load_dwordx4 v[160:163], v2, s[32:35], s16 offen sc1
    s_waitcnt vmcnt(1)
    v_pk_add_f32 v[144:145], v[144:145], v[148:149]
    v_pk_add_f32 v[146:147], v[146:147], v[150:151]
    s_nop 1
    v_permlane32_swap_b32 v144, v146
    v_permlane32_swap_b32 v145, v147
    v_pk_add_f32 v[144:145], v[144:145], v[146:147]
    s_nop 1
    v_add_f32_dpp v144, v144, v144 row_ror:8 row_mask:0xf bank_mask:0xf
    v_add_f32_dpp v145, v145, v145 row_ror:8 row_mask:0xf bank_mask:0xf
    v_mov_b32 v146, v144
    v_mov_b32 v147, v145
    s_nop 0
    v_permlane16_swap_b32 v144, v146
    v_permlane16_swap_b32 v145, v147
    v_pk_add_f32 v[144:145], v[144:145], v[146:147]
    v_cvt_pk_bf16_f32 v144, v144, v145
    v_mov_b32 v145, s4
    s_mov_b32 exec_lo, 0xff
    s_mov_b32 exec_hi, 0xff
    buffer_store_dwordx2 v[144:145], v76, s[32:35], s15 offen sc1
    s_mov_b64 exec, -1
    s_barrier
    s_cmp_lg_u32 s3, 0
    s_cbranch_scc1 L_PC2
    v_mov_b32 v21, s4
    s_mov_b32 exec_hi, 0
    s_mov_b32 exec_lo, 65535
    buffer_store_dword v21, v75, s[32:35], s17 offen sc1
    s_mov_b64 exec, -1
L_PC2:
    s_waitcnt vmcnt(1)
    s_add_u32 s96, s84, 1572864
    s_and_b32 s97, s96, 1048575
    s_xor_b32 s98, s88, 1048576
    s_add_u32 s19, s97, s98
    s_add_u32 m0, s89, 131072
    s_nop 0
    buffer_load_dwordx4 v74, s[44:47], s19 offen lds
    v_permlane32_swap_b32 v160, v162
    v_permlane32_swap_b32 v161, v163
    v_pk_add_f32 v[160:161], v[160:161], v[162:163]
    s_nop 1
    v_add_f32_dpp v160, v160, v160 row_ror:4 row_mask:0xf bank_mask:0xf
    v_add_f32_dpp v161, v161, v161 row_ror:4 row_mask:0xf bank_mask:0xf
    s_add_u32 s96, s84, 1703936
    s_and_b32 s97, s96, 1048575
    s_xor_b32 s98, s88, 1048576
    s_add_u32 s19, s97, s98
    s_add_u32 m0, s89, 139264
    s_nop 0
    buffer_load_dwordx4 v74, s[44:47], s19 offen lds
    v_add_f32_dpp v160, v160, v160 row_ror:8 row_mask:0xf bank_mask:0xf
    v_add_f32_dpp v161, v161, v161 row_ror:8 row_mask:0xf bank_mask:0xf
    v_mov_b32 v162, v160
    v_mov_b32 v163, v161
    s_add_u32 s96, s84, 1835008
    s_and_b32 s97, s96, 1048575
    s_xor_b32 s98, s88, 1048576
    s_add_u32 s19, s97, s98
    s_add_u32 m0, s89, 147456
    s_nop 0
    buffer_load_dwordx4 v74, s[44:47], s19 offen lds
    v_permlane16_swap_b32 v160, v162
    v_permlane16_swap_b32 v161, v163
    v_pk_add_f32 v[160:161], v[160:161], v[162:163]
    v_cvt_pk_bf16_f32 v160, v160, v161
    ds_write_b32 v6, v160
    s_waitcnt lgkmcnt(0)
    s_barrier
    ds_read_b128 v[160:163], v7
    ds_read_b128 v[164:167], v7 offset:32
    ds_read_b128 v[168:171], v7 offset:64
    ds_read_b128 v[172:175], v7 offset:96
    s_waitcnt lgkmcnt(0)
    s_lshl3_add_u32 s96, s11, s3
    s_lshl_b32 s97, s96, 11
    s_add_u32 s13, s97, 29360128
    s_load_dwordx2 s[24:25], s[32:33], s92 offset:3584 glc
    v_mfma_f32_32x32x16_bf16 v[128:143], v[160:163], v[80:83], 0
    v_mfma_f32_32x32x16_bf16 v[128:143], v[164:167], v[84:87], v[128:143]
    v_mfma_f32_32x32x16_bf16 v[128:143], v[168:171], v[88:91], v[128:143]
    v_mfma_f32_32x32x16_bf16 v[128:143], v[172:175], v[92:95], v[128:143]
    s_nop 11
    v_cvt_pk_bf16_f32 v128, 0, v128
    v_add_f32 v128, 0x358637bd, v128
    v_cvt_pk_bf16_f32 v128, 0, v128
    v_rcp_f32 v128, v128
    s_cmp_eq_u32 s90, 0
    s_cbranch_scc1 L_NOMF1
    v_bitop3_b32 v4, v53, v55, s4 bitop3:0x7e
    v_bitop3_b32 v4, v4, v57, s4 bitop3:0xf6
    v_bitop3_b32 v4, v4, v59, s4 bitop3:0xf6
    v_cmp_ne_u32 vcc, 0, v4
    s_cbranch_vccz L_MFOK
POLL_24:
    buffer_load_dwordx2 v[52:53], v63, s[32:35], s90 offen sc1
    buffer_load_dwordx2 v[54:55], v63, s[32:35], s90 offen offset:512 sc1
    buffer_load_dwordx2 v[56:57], v63, s[32:35], s90 offen offset:1024 sc1
    buffer_load_dwordx2 v[58:59], v63, s[32:35], s90 offen offset:1536 sc1
    s_waitcnt vmcnt(0)
    v_bitop3_b32 v4, v53, v55, s4 bitop3:0x7e
    v_bitop3_b32 v4, v4, v57, s4 bitop3:0xf6
    v_bitop3_b32 v4, v4, v59, s4 bitop3:0xf6
    v_cmp_ne_u32 vcc, 0, v4
    s_cbranch_vccz PDONE_25
    s_add_u32 s5, s5, 1
    s_cmp_lt_u32 s5, 200000
    s_cbranch_scc1 POLL_24
PDONE_25:
L_MFOK:
    v_add_f32 v52, v52, v54
    v_add_f32 v56, v56, v58
    v_add_f32 v52, v52, v56
    v_cvt_pk_bf16_f32 v52, 0, v52
    s_cmp_eq_u32 s8, 1
    s_cselect_b32 s19, 1.0, 0
    v_add_f32 v52, s19, v52
    v_cvt_pk_bf16_f32 v52, 0, v52
    s_lshl4_add_u32 s96, s8, s9
    s_lshl_b32 s97, s96, 9
    s_add_u32 s19, s97, 65536
    buffer_store_dwordx2 v[52:53], v63, s[32:35], s19 offen sc1
L_NOMF1:
    s_branch SCHK_22
SPOLL_21:
    s_load_dwordx2 s[24:25], s[32:33], s92 offset:3584 glc
SCHK_22:
    s_add_u32 s5, s5, 1
    s_cmp_ge_u32 s5, 200000
    s_waitcnt lgkmcnt(0)
    s_cbranch_scc1 SDONE_23
    s_cmp_lg_u32 s24, s4
    s_cbranch_scc1 SPOLL_21
    s_cmp_lg_u32 s25, s4
    s_cbranch_scc1 SPOLL_21
SDONE_23:
POLL_26:
    buffer_load_dwordx4 v[152:155], v2, s[32:35], s13 offen sc1
    buffer_load_dwordx4 v[156:159], v2, s[32:35], s13 offen offset:1024 sc1
    s_waitcnt vmcnt(0)
    v_bitop3_b32 v4, v153, v155, s4 bitop3:0x7e
    v_bitop3_b32 v4, v4, v157, s4 bitop3:0xf6
    v_bitop3_b32 v4, v4, v159, s4 bitop3:0xf6
    v_cmp_ne_u32 vcc, 0, v4
    s_cbranch_vccz PDONE_27
    s_add_u32 s5, s5, 1
    s_cmp_lt_u32 s5, 200000
    s_cbranch_scc1 POLL_26
PDONE_27:
    ds_write2_b32 v5, v152, v154 offset0:0 offset1:1
    ds_write2_b32 v5, v156, v158 offset0:64 offset1:65
    s_waitcnt lgkmcnt(0)
    s_barrier
    ds_read_b128 v[144:147], v20
    ds_read_b128 v[148:151], v20 offset:1024
    ds_read_b128 v[152:155], v20 offset:2048
    ds_read_b128 v[156:159], v20 offset:3072
    buffer_load_dwordx2 v[96:97], v22, s[32:35], s18 offen sc1
    buffer_load_dwordx2 v[98:99], v22, s[32:35], s18 offen offset:512 sc1
    buffer_load_dwordx2 v[100:101], v22, s[32:35], s18 offen offset:1024 sc1
    buffer_load_dwordx2 v[102:103], v22, s[32:35], s18 offen offset:1536 sc1
    s_lshl_b32 s13, s3, 8
    v_lshl_add_u32 v4, v1, 2, s13
    global_load_dword v104, v4, s[78:79]
    s_and_b32 s96, s3, 3
    s_lshl2_add_u32 s97, s10, s96
    s_lshl4_add_u32 s98, s97, s11
    s_lshl1_add_u32 s99, s98, s76
    s_lshl_b32 s96, s99, 11
    s_add_u32 s13, s96, 8388608
    s_waitcnt lgkmcnt(3)
    v_mfma_f32_32x32x16_bf16 v[112:127], v[144:147], v[80:83], 0
    s_waitcnt lgkmcnt(2)
    v_mfma_f32_32x32x16_bf16 v[112:127], v[148:151], v[84:87], v[112:127]
    s_waitcnt lgkmcnt(1)
    v_mfma_f32_32x32x16_bf16 v[112:127], v[152:155], v[88:91], v[112:127]
    s_waitcnt lgkmcnt(0)
    v_mfma_f32_32x32x16_bf16 v[112:127], v[156:159], v[92:95], v[112:127]
    s_nop 11
    v_cvt_pk_bf16_f32 v112, 0, v112
    v_cvt_pk_bf16_f32 v113, 0, v113
    v_cvt_pk_bf16_f32 v114, 0, v114
    v_cvt_pk_bf16_f32 v115, 0, v115
    v_cvt_pk_bf16_f32 v116, 0, v116
    v_cvt_pk_bf16_f32 v117, 0, v117
    v_cvt_pk_bf16_f32 v118, 0, v118
    v_cvt_pk_bf16_f32 v119, 0, v119
    v_pk_mul_f32 v[112:113], v[112:113], v[128:129] op_sel_hi:[1,0]
    v_pk_mul_f32 v[114:115], v[114:115], v[128:129] op_sel_hi:[1,0]
    v_pk_mul_f32 v[116:117], v[116:117], v[128:129] op_sel_hi:[1,0]
    v_pk_mul_f32 v[118:119], v[118:119], v[128:129] op_sel_hi:[1,0]
    v_cvt_pk_bf16_f32 v44, v112, v113
    v_cvt_pk_bf16_f32 v45, v114, v115
    v_cvt_pk_bf16_f32 v46, v116, v117
    v_cvt_pk_bf16_f32 v47, v118, v119
    buffer_store_dwordx4 v[44:47], v2, s[32:35], s13 offen sc1
    v_cvt_pk_bf16_f32 v120, 0, v120
    v_cvt_pk_bf16_f32 v121, 0, v121
    v_cvt_pk_bf16_f32 v122, 0, v122
    v_cvt_pk_bf16_f32 v123, 0, v123
    v_cvt_pk_bf16_f32 v124, 0, v124
    v_cvt_pk_bf16_f32 v125, 0, v125
    v_cvt_pk_bf16_f32 v126, 0, v126
    v_cvt_pk_bf16_f32 v127, 0, v127
    v_pk_mul_f32 v[120:121], v[120:121], v[128:129] op_sel_hi:[1,0]
    v_pk_mul_f32 v[122:123], v[122:123], v[128:129] op_sel_hi:[1,0]
    v_pk_mul_f32 v[124:125], v[124:125], v[128:129] op_sel_hi:[1,0]
    v_pk_mul_f32 v[126:127], v[126:127], v[128:129] op_sel_hi:[1,0]
    v_cvt_pk_bf16_f32 v48, v120, v121
    v_cvt_pk_bf16_f32 v49, v122, v123
    v_cvt_pk_bf16_f32 v50, v124, v125
    v_cvt_pk_bf16_f32 v51, v126, v127
    buffer_store_dwordx4 v[48:51], v2, s[32:35], s13 offen offset:1024 sc1
    s_mul_i32 s96, s76, 65600
    s_add_u32 s17, s96, 32768
    v_bfe_u32 v20, v1, 2, 2
    v_lshlrev_b32 v20, 7, v20
    v_bfe_u32 v9, v1, 3, 1
    v_lshl_add_u32 v20, v9, 6, v20
    v_lshrrev_b32 v9, 5, v1
    v_lshl_add_u32 v20, v9, 10, v20
    v_and_b32 v9, 1, v1
    v_lshl_add_u32 v20, v9, 5, v20
    v_bfe_u32 v9, v1, 4, 1
    v_lshl_add_u32 v20, v9, 4, v20
    v_bfe_u32 v9, v1, 1, 1
    v_lshl_add_u32 v20, v9, 3, v20
    v_xor_b32 v20, s17, v20
    v_xor_b32 v21, 64, v20
    v_and_b32 v5, 7, v1
    v_lshlrev_b32 v5, 15, v5
    v_bfe_u32 v9, v1, 3, 1
    v_lshl_add_u32 v5, v9, 12, v5
    s_and_b32 s96, s11, 1
    s_lshr_b32 s97, s10, 2
    s_and_b32 s98, s10, 3
    s_lshl_b32 s99, s98, 6
    s_lshl1_add_u32 s98, s97, s99
    s_lshl_b32 s97, s98, 12
    s_lshr_b32 s99, s11, 1
    s_lshl_b32 s98, s99, 6
    s_add_u32 s99, s97, s98
    s_lshl2_add_u32 s97, s96, s99
    s_add_u32 s98, s97, 1048576
    s_add_u32 s15, s98, 1024
    v_lshlrev_b32 v24, 16, v12
    v_and_b32 v25, s6, v12
    v_lshlrev_b32 v26, 16, v13
    v_and_b32 v27, s6, v13
    v_lshlrev_b32 v28, 16, v14
    v_and_b32 v29, s6, v14
    v_lshlrev_b32 v30, 16, v15
    v_and_b32 v31, s6, v15
    v_lshlrev_b32 v32, 16, v16
    v_and_b32 v33, s6, v16
    v_lshlrev_b32 v34, 16, v17
    v_and_b32 v35, s6, v17
    v_lshlrev_b32 v36, 16, v18
    v_and_b32 v37, s6, v18
    v_lshlrev_b32 v38, 16, v19
    v_and_b32 v39, s6, v19
    s_lshl1_add_u32 s96, s94, s77
    s_lshl_b32 s97, s96, 15
    s_add_u32 s19, s97, 8388608
    s_waitcnt vmcnt(0)
    s_barrier
    s_cmp_lg_u32 s3, 0
    s_cbranch_scc1 L_PD
    v_mov_b32 v6, s4
    s_mov_b32 exec_hi, 0
    s_mov_b32 exec_lo, 65535
    buffer_store_dword v6, v5, s[32:35], s15 offen sc1
    s_mov_b64 exec, -1
L_PD:
    s_add_u32 s96, s84, 1966080
    s_and_b32 s97, s96, 1048575
    s_xor_b32 s98, s88, 1048576
    s_add_u32 s13, s97, s98
    s_add_u32 m0, s89, 155648
    s_nop 0
    buffer_load_dwordx4 v74, s[44:47], s13 offen lds
    s_and_b32 s96, s84, 1048575
    s_add_u32 s13, s96, s88
    s_add_u32 m0, s89, 32768
    s_nop 0
    buffer_load_dwordx4 v74, s[44:47], s13 offen lds
    s_add_u32 s96, s84, 131072
    s_and_b32 s97, s96, 1048575
    s_add_u32 s13, s97, s88
    s_add_u32 m0, s89, 40960
    s_nop 0
    buffer_load_dwordx4 v74, s[44:47], s13 offen lds
    s_lshl_b32 s96, s3, 10
    s_add_u32 s13, s96, 65536
    s_add_u32 s14, s13, 8192
    s_add_u32 s15, s13, 16384
    buffer_load_dwordx4 v[76:79], v2, s[32:35], s13 offen sc1
    buffer_load_dwordx4 v[80:83], v2, s[32:35], s14 offen sc1
    buffer_load_dwordx4 v[84:87], v2, s[32:35], s15 offen sc1
    s_load_dwordx2 s[24:25], s[32:33], s92 offset:1024 glc
    s_waitcnt vmcnt(0)
    v_bitop3_b32 v4, v97, v99, s4 bitop3:0x7e
    v_bitop3_b32 v4, v4, v101, s4 bitop3:0xf6
    v_bitop3_b32 v4, v4, v103, s4 bitop3:0xf6
    v_bitop3_b32 v4, v4, v77, s4 bitop3:0xf6
    v_bitop3_b32 v4, v4, v79, s4 bitop3:0xf6
    v_bitop3_b32 v4, v4, v81, s4 bitop3:0xf6
    v_bitop3_b32 v4, v4, v83, s4 bitop3:0xf6
    v_bitop3_b32 v4, v4, v85, s4 bitop3:0xf6
    v_bitop3_b32 v4, v4, v87, s4 bitop3:0xf6
    v_cmp_ne_u32 vcc, 0, v4
    s_cbranch_vccz L_MGOK
POLL_31:
    buffer_load_dwordx2 v[96:97], v22, s[32:35], s18 offen sc1
    buffer_load_dwordx2 v[98:99], v22, s[32:35], s18 offen offset:512 sc1
    buffer_load_dwordx2 v[100:101], v22, s[32:35], s18 offen offset:1024 sc1
    buffer_load_dwordx2 v[102:103], v22, s[32:35], s18 offen offset:1536 sc1
    buffer_load_dwordx4 v[76:79], v2, s[32:35], s13 offen sc1
    buffer_load_dwordx4 v[80:83], v2, s[32:35], s14 offen sc1
    buffer_load_dwordx4 v[84:87], v2, s[32:35], s15 offen sc1
    s_waitcnt vmcnt(0)
    v_bitop3_b32 v4, v97, v99, s4 bitop3:0x7e
    v_bitop3_b32 v4, v4, v101, s4 bitop3:0xf6
    v_bitop3_b32 v4, v4, v103, s4 bitop3:0xf6
    v_bitop3_b32 v4, v4, v77, s4 bitop3:0xf6
    v_bitop3_b32 v4, v4, v79, s4 bitop3:0xf6
    v_bitop3_b32 v4, v4, v81, s4 bitop3:0xf6
    v_bitop3_b32 v4, v4, v83, s4 bitop3:0xf6
    v_bitop3_b32 v4, v4, v85, s4 bitop3:0xf6
    v_bitop3_b32 v4, v4, v87, s4 bitop3:0xf6
    v_cmp_ne_u32 vcc, 0, v4
    s_cbranch_vccz PDONE_32
    s_add_u32 s5, s5, 1
    s_cmp_lt_u32 s5, 200000
    s_cbranch_scc1 POLL_31
PDONE_32:
L_MGOK:
    v_add_f32 v96, v96, v98
    v_add_f32 v100, v100, v102
    v_add_f32 v96, v96, v100
    v_cvt_pk_bf16_f32 v96, 0, v96
    v_cvt_pk_bf16_f32 v97, v76, v78
    v_cvt_pk_bf16_f32 v98, v80, v82
    v_cvt_pk_bf16_f32 v99, v84, v86
    v_mov_b32_dpp v40, v96 row_newbcast:0 row_mask:0xf bank_mask:0xf
    v_mov_b32_dpp v41, v96 row_newbcast:1 row_mask:0xf bank_mask:0xf
    v_mov_b32_dpp v42, v96 row_newbcast:2 row_mask:0xf bank_mask:0xf
    v_mov_b32_dpp v43, v96 row_newbcast:3 row_mask:0xf bank_mask:0xf
    v_mov_b32_dpp v44, v96 row_newbcast:4 row_mask:0xf bank_mask:0xf
    v_mov_b32_dpp v45, v96 row_newbcast:5 row_mask:0xf bank_mask:0xf
    v_mov_b32_dpp v46, v96 row_newbcast:6 row_mask:0xf bank_mask:0xf
    v_mov_b32_dpp v47, v96 row_newbcast:7 row_mask:0xf bank_mask:0xf
    v_mov_b32_dpp v48, v96 row_newbcast:8 row_mask:0xf bank_mask:0xf
    v_mov_b32_dpp v49, v96 row_newbcast:9 row_mask:0xf bank_mask:0xf
    v_mov_b32_dpp v50, v96 row_newbcast:10 row_mask:0xf bank_mask:0xf
    v_mov_b32_dpp v51, v96 row_newbcast:11 row_mask:0xf bank_mask:0xf
    v_mov_b32_dpp v52, v96 row_newbcast:12 row_mask:0xf bank_mask:0xf
    v_mov_b32_dpp v53, v96 row_newbcast:13 row_mask:0xf bank_mask:0xf
    v_mov_b32_dpp v54, v96 row_newbcast:14 row_mask:0xf bank_mask:0xf
    v_mov_b32_dpp v55, v96 row_newbcast:15 row_mask:0xf bank_mask:0xf
    s_branch SCHK_29
SPOLL_28:
    s_load_dwordx2 s[24:25], s[32:33], s92 offset:1024 glc
SCHK_29:
    s_add_u32 s5, s5, 1
    s_cmp_ge_u32 s5, 200000
    s_waitcnt lgkmcnt(0)
    s_cbranch_scc1 SDONE_30
    s_cmp_lg_u32 s24, s4
    s_cbranch_scc1 SPOLL_28
    s_cmp_lg_u32 s25, s4
    s_cbranch_scc1 SPOLL_28
SDONE_30:
    s_barrier
    s_and_b32 s96, s83, 15
    s_lshl_b32 s97, s96, 11
    s_add_u32 s20, s97, s19
    buffer_load_dwordx4 v[144:147], v2, s[32:35], s20 offen sc1
    ds_read_b64_tr_b16 v[164:165], v21
    ds_read_b64_tr_b16 v[166:167], v21 offset:512
    ds_read_b64_tr_b16 v[160:161], v20
    ds_read_b64_tr_b16 v[162:163], v20 offset:512
    buffer_load_dwordx4 v[148:151], v2, s[32:35], s20 offen offset:1024 sc1
    s_add_u32 s96, s83, 1
    s_and_b32 s97, s96, 15
    s_lshl_b32 s98, s97, 11
    s_add_u32 s20, s98, s19
    buffer_load_dwordx4 v[152:155], v2, s[32:35], s20 offen sc1
    buffer_load_dwordx4 v[156:159], v2, s[32:35], s20 offen offset:1024 sc1
    s_waitcnt vmcnt(3)
    s_waitcnt lgkmcnt(2)
    v_mfma_f32_32x32x16_bf16 v[128:143], v[164:167], v[144:147], 0
    ds_read_b64_tr_b16 v[172:173], v21 offset:2048
    ds_read_b64_tr_b16 v[174:175], v21 offset:2560
    s_waitcnt lgkmcnt(2)
    v_mfma_f32_32x32x16_bf16 v[112:127], v[160:163], v[144:147], 0
    ds_read_b64_tr_b16 v[168:169], v20 offset:2048
    ds_read_b64_tr_b16 v[170:171], v20 offset:2560
    s_add_u32 s96, s83, 2
    s_and_b32 s97, s96, 15
    s_lshl_b32 s98, s97, 11
    s_add_u32 s20, s98, s19
    buffer_load_dwordx4 v[144:147], v2, s[32:35], s20 offen sc1
    s_waitcnt vmcnt(3)
    s_waitcnt lgkmcnt(2)
    v_mfma_f32_32x32x16_bf16 v[128:143], v[172:175], v[148:151], v[128:143]
    ds_read_b64_tr_b16 v[164:165], v21 offset:4096
    ds_read_b64_tr_b16 v[166:167], v21 offset:4608
    s_waitcnt lgkmcnt(2)
    v_mfma_f32_32x32x16_bf16 v[112:127], v[168:171], v[148:151], v[112:127]
    ds_read_b64_tr_b16 v[160:161], v20 offset:4096
    ds_read_b64_tr_b16 v[162:163], v20 offset:4608
    buffer_load_dwordx4 v[148:151], v2, s[32:35], s20 offen offset:1024 sc1
    s_waitcnt vmcnt(3)
    s_waitcnt lgkmcnt(2)
    v_mfma_f32_32x32x16_bf16 v[128:143], v[164:167], v[152:155], v[128:143]
    ds_read_b64_tr_b16 v[172:173], v21 offset:6144
    ds_read_b64_tr_b16 v[174:175], v21 offset:6656
    s_waitcnt lgkmcnt(2)
    v_mfma_f32_32x32x16_bf16 v[112:127], v[160:163], v[152:155], v[112:127]
    ds_read_b64_tr_b16 v[168:169], v20 offset:6144
    ds_read_b64_tr_b16 v[170:171], v20 offset:6656
    s_add_u32 s96, s83, 3
    s_and_b32 s97, s96, 15
    s_lshl_b32 s98, s97, 11
    s_add_u32 s20, s98, s19
    buffer_load_dwordx4 v[152:155], v2, s[32:35], s20 offen sc1
    s_waitcnt vmcnt(3)
    s_waitcnt lgkmcnt(2)
    v_mfma_f32_32x32x16_bf16 v[128:143], v[172:175], v[156:159], v[128:143]
    ds_read_b64_tr_b16 v[164:165], v21 offset:8192
    ds_read_b64_tr_b16 v[166:167], v21 offset:8704
    s_waitcnt lgkmcnt(2)
    v_mfma_f32_32x32x16_bf16 v[112:127], v[168:171], v[156:159], v[112:127]
    ds_read_b64_tr_b16 v[160:161], v20 offset:8192
    ds_read_b64_tr_b16 v[162:163], v20 offset:8704
    buffer_load_dwordx4 v[156:159], v2, s[32:35], s20 offen offset:1024 sc1
    s_waitcnt vmcnt(3)
    s_waitcnt lgkmcnt(2)
    v_mfma_f32_32x32x16_bf16 v[128:143], v[164:167], v[144:147], v[128:143]
    ds_read_b64_tr_b16 v[172:173], v21 offset:10240
    ds_read_b64_tr_b16 v[174:175], v21 offset:10752
    s_waitcnt lgkmcnt(2)
    v_mfma_f32_32x32x16_bf16 v[112:127], v[160:163], v[144:147], v[112:127]
    ds_read_b64_tr_b16 v[168:169], v20 offset:10240
    ds_read_b64_tr_b16 v[170:171], v20 offset:10752
    s_add_u32 s96, s83, 4
    s_and_b32 s97, s96, 15
    s_lshl_b32 s98, s97, 11
    s_add_u32 s20, s98, s19
    buffer_load_dwordx4 v[144:147], v2, s[32:35], s20 offen sc1
    s_waitcnt vmcnt(3)
    s_waitcnt lgkmcnt(2)
    v_mfma_f32_32x32x16_bf16 v[128:143], v[172:175], v[148:151], v[128:143]
    ds_read_b64_tr_b16 v[164:165], v21 offset:12288
    ds_read_b64_tr_b16 v[166:167], v21 offset:12800
    s_waitcnt lgkmcnt(2)
    v_mfma_f32_32x32x16_bf16 v[112:127], v[168:171], v[148:151], v[112:127]
    ds_read_b64_tr_b16 v[160:161], v20 offset:12288
    ds_read_b64_tr_b16 v[162:163], v20 offset:12800
    buffer_load_dwordx4 v[148:151], v2, s[32:35], s20 offen offset:1024 sc1
    s_waitcnt vmcnt(3)
    s_waitcnt lgkmcnt(2)
    v_mfma_f32_32x32x16_bf16 v[128:143], v[164:167], v[152:155], v[128:143]
    ds_read_b64_tr_b16 v[172:173], v21 offset:14336
    ds_read_b64_tr_b16 v[174:175], v21 offset:14848
    s_waitcnt lgkmcnt(2)
    v_mfma_f32_32x32x16_bf16 v[112:127], v[160:163], v[152:155], v[112:127]
    ds_read_b64_tr_b16 v[168:169], v20 offset:14336
    ds_read_b64_tr_b16 v[170:171], v20 offset:14848
    s_add_u32 s96, s83, 5
    s_and_b32 s97, s96, 15
    s_lshl_b32 s98, s97, 11
    s_add_u32 s20, s98, s19
    buffer_load_dwordx4 v[152:155], v2, s[32:35], s20 offen sc1
    s_waitcnt vmcnt(3)
    s_waitcnt lgkmcnt(2)
    v_mfma_f32_32x32x16_bf16 v[128:143], v[172:175], v[156:159], v[128:143]
    ds_read_b64_tr_b16 v[164:165], v21 offset:16384
    ds_read_b64_tr_b16 v[166:167], v21 offset:16896
    s_waitcnt lgkmcnt(2)
    v_mfma_f32_32x32x16_bf16 v[112:127], v[168:171], v[156:159], v[112:127]
    ds_read_b64_tr_b16 v[160:161], v20 offset:16384
    ds_read_b64_tr_b16 v[162:163], v20 offset:16896
    buffer_load_dwordx4 v[156:159], v2, s[32:35], s20 offen offset:1024 sc1
    s_waitcnt vmcnt(3)
    s_waitcnt lgkmcnt(2)
    v_mfma_f32_32x32x16_bf16 v[128:143], v[164:167], v[144:147], v[128:143]
    ds_read_b64_tr_b16 v[172:173], v21 offset:18432
    ds_read_b64_tr_b16 v[174:175], v21 offset:18944
    s_waitcnt lgkmcnt(2)
    v_mfma_f32_32x32x16_bf16 v[112:127], v[160:163], v[144:147], v[112:127]
    ds_read_b64_tr_b16 v[168:169], v20 offset:18432
    ds_read_b64_tr_b16 v[170:171], v20 offset:18944
    s_add_u32 s96, s83, 6
    s_and_b32 s97, s96, 15
    s_lshl_b32 s98, s97, 11
    s_add_u32 s20, s98, s19
    buffer_load_dwordx4 v[144:147], v2, s[32:35], s20 offen sc1
    s_waitcnt vmcnt(3)
    s_waitcnt lgkmcnt(2)
    v_mfma_f32_32x32x16_bf16 v[128:143], v[172:175], v[148:151], v[128:143]
    ds_read_b64_tr_b16 v[164:165], v21 offset:20480
    ds_read_b64_tr_b16 v[166:167], v21 offset:20992
    s_waitcnt lgkmcnt(2)
    v_mfma_f32_32x32x16_bf16 v[112:127], v[168:171], v[148:151], v[112:127]
    ds_read_b64_tr_b16 v[160:161], v20 offset:20480
    ds_read_b64_tr_b16 v[162:163], v20 offset:20992
    buffer_load_dwordx4 v[148:151], v2, s[32:35], s20 offen offset:1024 sc1
    s_waitcnt vmcnt(3)
    s_waitcnt lgkmcnt(2)
    v_mfma_f32_32x32x16_bf16 v[128:143], v[164:167], v[152:155], v[128:143]
    ds_read_b64_tr_b16 v[172:173], v21 offset:22528
    ds_read_b64_tr_b16 v[174:175], v21 offset:23040
    s_waitcnt lgkmcnt(2)
    v_mfma_f32_32x32x16_bf16 v[112:127], v[160:163], v[152:155], v[112:127]
    ds_read_b64_tr_b16 v[168:169], v20 offset:22528
    ds_read_b64_tr_b16 v[170:171], v20 offset:23040
    s_add_u32 s96, s83, 7
    s_and_b32 s97, s96, 15
    s_lshl_b32 s98, s97, 11
    s_add_u32 s20, s98, s19
    buffer_load_dwordx4 v[152:155], v2, s[32:35], s20 offen sc1
    s_waitcnt vmcnt(3)
    s_waitcnt lgkmcnt(2)
    v_mfma_f32_32x32x16_bf16 v[128:143], v[172:175], v[156:159], v[128:143]
    ds_read_b64_tr_b16 v[164:165], v21 offset:24576
    ds_read_b64_tr_b16 v[166:167], v21 offset:25088
    s_waitcnt lgkmcnt(2)
    v_mfma_f32_32x32x16_bf16 v[112:127], v[168:171], v[156:159], v[112:127]
    ds_read_b64_tr_b16 v[160:161], v20 offset:24576
    ds_read_b64_tr_b16 v[162:163], v20 offset:25088
    buffer_load_dwordx4 v[156:159], v2, s[32:35], s20 offen offset:1024 sc1
    s_waitcnt vmcnt(3)
    s_waitcnt lgkmcnt(2)
    v_mfma_f32_32x32x16_bf16 v[128:143], v[164:167], v[144:147], v[128:143]
    ds_read_b64_tr_b16 v[172:173], v21 offset:26624
    ds_read_b64_tr_b16 v[174:175], v21 offset:27136
    s_waitcnt lgkmcnt(2)
    v_mfma_f32_32x32x16_bf16 v[112:127], v[160:163], v[144:147], v[112:127]
    ds_read_b64_tr_b16 v[168:169], v20 offset:26624
    ds_read_b64_tr_b16 v[170:171], v20 offset:27136
    s_add_u32 s96, s83, 8
    s_and_b32 s97, s96, 15
    s_lshl_b32 s98, s97, 11
    s_add_u32 s20, s98, s19
    buffer_load_dwordx4 v[144:147], v2, s[32:35], s20 offen sc1
    s_waitcnt vmcnt(3)
    s_waitcnt lgkmcnt(2)
    v_mfma_f32_32x32x16_bf16 v[128:143], v[172:175], v[148:151], v[128:143]
    ds_read_b64_tr_b16 v[164:165], v21 offset:28672
    ds_read_b64_tr_b16 v[166:167], v21 offset:29184
    s_waitcnt lgkmcnt(2)
    v_mfma_f32_32x32x16_bf16 v[112:127], v[168:171], v[148:151], v[112:127]
    ds_read_b64_tr_b16 v[160:161], v20 offset:28672
    ds_read_b64_tr_b16 v[162:163], v20 offset:29184
    buffer_load_dwordx4 v[148:151], v2, s[32:35], s20 offen offset:1024 sc1
    s_waitcnt vmcnt(3)
    s_waitcnt lgkmcnt(2)
    v_mfma_f32_32x32x16_bf16 v[128:143], v[164:167], v[152:155], v[128:143]
    ds_read_b64_tr_b16 v[172:173], v21 offset:30720
    ds_read_b64_tr_b16 v[174:175], v21 offset:31232
    s_waitcnt lgkmcnt(2)
    v_mfma_f32_32x32x16_bf16 v[112:127], v[160:163], v[152:155], v[112:127]
    ds_read_b64_tr_b16 v[168:169], v20 offset:30720
    ds_read_b64_tr_b16 v[170:171], v20 offset:31232
    s_add_u32 s96, s83, 9
    s_and_b32 s97, s96, 15
    s_lshl_b32 s98, s97, 11
    s_add_u32 s20, s98, s19
    buffer_load_dwordx4 v[152:155], v2, s[32:35], s20 offen sc1
    s_waitcnt vmcnt(3)
    s_waitcnt lgkmcnt(2)
    v_mfma_f32_32x32x16_bf16 v[128:143], v[172:175], v[156:159], v[128:143]
    ds_read_b64_tr_b16 v[164:165], v21 offset:32768
    ds_read_b64_tr_b16 v[166:167], v21 offset:33280
    s_waitcnt lgkmcnt(2)
    v_mfma_f32_32x32x16_bf16 v[112:127], v[168:171], v[156:159], v[112:127]
    ds_read_b64_tr_b16 v[160:161], v20 offset:32768
    ds_read_b64_tr_b16 v[162:163], v20 offset:33280
    buffer_load_dwordx4 v[156:159], v2, s[32:35], s20 offen offset:1024 sc1
    s_waitcnt vmcnt(3)
    s_waitcnt lgkmcnt(2)
    v_mfma_f32_32x32x16_bf16 v[128:143], v[164:167], v[144:147], v[128:143]
    ds_read_b64_tr_b16 v[172:173], v21 offset:34816
    ds_read_b64_tr_b16 v[174:175], v21 offset:35328
    s_waitcnt lgkmcnt(2)
    v_mfma_f32_32x32x16_bf16 v[112:127], v[160:163], v[144:147], v[112:127]
    ds_read_b64_tr_b16 v[168:169], v20 offset:34816
    ds_read_b64_tr_b16 v[170:171], v20 offset:35328
    s_add_u32 s96, s83, 10
    s_and_b32 s97, s96, 15
    s_lshl_b32 s98, s97, 11
    s_add_u32 s20, s98, s19
    buffer_load_dwordx4 v[144:147], v2, s[32:35], s20 offen sc1
    s_waitcnt vmcnt(3)
    s_waitcnt lgkmcnt(2)
    v_mfma_f32_32x32x16_bf16 v[128:143], v[172:175], v[148:151], v[128:143]
    ds_read_b64_tr_b16 v[164:165], v21 offset:36864
    ds_read_b64_tr_b16 v[166:167], v21 offset:37376
    s_waitcnt lgkmcnt(2)
    v_mfma_f32_32x32x16_bf16 v[112:127], v[168:171], v[148:151], v[112:127]
    ds_read_b64_tr_b16 v[160:161], v20 offset:36864
    ds_read_b64_tr_b16 v[162:163], v20 offset:37376
    buffer_load_dwordx4 v[148:151], v2, s[32:35], s20 offen offset:1024 sc1
    s_waitcnt vmcnt(3)
    s_waitcnt lgkmcnt(2)
    v_mfma_f32_32x32x16_bf16 v[128:143], v[164:167], v[152:155], v[128:143]
    ds_read_b64_tr_b16 v[172:173], v21 offset:38912
    ds_read_b64_tr_b16 v[174:175], v21 offset:39424
    s_waitcnt lgkmcnt(2)
    v_mfma_f32_32x32x16_bf16 v[112:127], v[160:163], v[152:155], v[112:127]
    ds_read_b64_tr_b16 v[168:169], v20 offset:38912
    ds_read_b64_tr_b16 v[170:171], v20 offset:39424
    s_add_u32 s96, s83, 11
    s_and_b32 s97, s96, 15
    s_lshl_b32 s98, s97, 11
    s_add_u32 s20, s98, s19
    buffer_load_dwordx4 v[152:155], v2, s[32:35], s20 offen sc1
    s_waitcnt vmcnt(3)
    s_waitcnt lgkmcnt(2)
    v_mfma_f32_32x32x16_bf16 v[128:143], v[172:175], v[156:159], v[128:143]
    ds_read_b64_tr_b16 v[164:165], v21 offset:40960
    ds_read_b64_tr_b16 v[166:167], v21 offset:41472
    s_waitcnt lgkmcnt(2)
    v_mfma_f32_32x32x16_bf16 v[112:127], v[168:171], v[156:159], v[112:127]
    ds_read_b64_tr_b16 v[160:161], v20 offset:40960
    ds_read_b64_tr_b16 v[162:163], v20 offset:41472
    buffer_load_dwordx4 v[156:159], v2, s[32:35], s20 offen offset:1024 sc1
    s_waitcnt vmcnt(3)
    s_waitcnt lgkmcnt(2)
    v_mfma_f32_32x32x16_bf16 v[128:143], v[164:167], v[144:147], v[128:143]
    ds_read_b64_tr_b16 v[172:173], v21 offset:43008
    ds_read_b64_tr_b16 v[174:175], v21 offset:43520
    s_waitcnt lgkmcnt(2)
    v_mfma_f32_32x32x16_bf16 v[112:127], v[160:163], v[144:147], v[112:127]
    ds_read_b64_tr_b16 v[168:169], v20 offset:43008
    ds_read_b64_tr_b16 v[170:171], v20 offset:43520
    s_add_u32 s96, s83, 12
    s_and_b32 s97, s96, 15
    s_lshl_b32 s98, s97, 11
    s_add_u32 s20, s98, s19
    buffer_load_dwordx4 v[144:147], v2, s[32:35], s20 offen sc1
    s_waitcnt vmcnt(3)
    s_waitcnt lgkmcnt(2)
    v_mfma_f32_32x32x16_bf16 v[128:143], v[172:175], v[148:151], v[128:143]
    ds_read_b64_tr_b16 v[164:165], v21 offset:45056
    ds_read_b64_tr_b16 v[166:167], v21 offset:45568
    s_waitcnt lgkmcnt(2)
    v_mfma_f32_32x32x16_bf16 v[112:127], v[168:171], v[148:151], v[112:127]
    ds_read_b64_tr_b16 v[160:161], v20 offset:45056
    ds_read_b64_tr_b16 v[162:163], v20 offset:45568
    buffer_load_dwordx4 v[148:151], v2, s[32:35], s20 offen offset:1024 sc1
    s_waitcnt vmcnt(3)
    s_waitcnt lgkmcnt(2)
    v_mfma_f32_32x32x16_bf16 v[128:143], v[164:167], v[152:155], v[128:143]
    ds_read_b64_tr_b16 v[172:173], v21 offset:47104
    ds_read_b64_tr_b16 v[174:175], v21 offset:47616
    s_waitcnt lgkmcnt(2)
    v_mfma_f32_32x32x16_bf16 v[112:127], v[160:163], v[152:155], v[112:127]
    ds_read_b64_tr_b16 v[168:169], v20 offset:47104
    ds_read_b64_tr_b16 v[170:171], v20 offset:47616
    s_add_u32 s96, s83, 13
    s_and_b32 s97, s96, 15
    s_lshl_b32 s98, s97, 11
    s_add_u32 s20, s98, s19
    buffer_load_dwordx4 v[152:155], v2, s[32:35], s20 offen sc1
    s_waitcnt vmcnt(3)
    s_waitcnt lgkmcnt(2)
    v_mfma_f32_32x32x16_bf16 v[128:143], v[172:175], v[156:159], v[128:143]
    ds_read_b64_tr_b16 v[164:165], v21 offset:49152
    ds_read_b64_tr_b16 v[166:167], v21 offset:49664
    s_waitcnt lgkmcnt(2)
    v_mfma_f32_32x32x16_bf16 v[112:127], v[168:171], v[156:159], v[112:127]
    ds_read_b64_tr_b16 v[160:161], v20 offset:49152
    ds_read_b64_tr_b16 v[162:163], v20 offset:49664
    buffer_load_dwordx4 v[156:159], v2, s[32:35], s20 offen offset:1024 sc1
    s_waitcnt vmcnt(3)
    s_waitcnt lgkmcnt(2)
    v_mfma_f32_32x32x16_bf16 v[128:143], v[164:167], v[144:147], v[128:143]
    ds_read_b64_tr_b16 v[172:173], v21 offset:51200
    ds_read_b64_tr_b16 v[174:175], v21 offset:51712
    s_waitcnt lgkmcnt(2)
    v_mfma_f32_32x32x16_bf16 v[112:127], v[160:163], v[144:147], v[112:127]
    ds_read_b64_tr_b16 v[168:169], v20 offset:51200
    ds_read_b64_tr_b16 v[170:171], v20 offset:51712
    s_add_u32 s96, s83, 14
    s_and_b32 s97, s96, 15
    s_lshl_b32 s98, s97, 11
    s_add_u32 s20, s98, s19
    buffer_load_dwordx4 v[144:147], v2, s[32:35], s20 offen sc1
    s_waitcnt vmcnt(3)
    s_waitcnt lgkmcnt(2)
    v_mfma_f32_32x32x16_bf16 v[128:143], v[172:175], v[148:151], v[128:143]
    ds_read_b64_tr_b16 v[164:165], v21 offset:53248
    ds_read_b64_tr_b16 v[166:167], v21 offset:53760
    s_waitcnt lgkmcnt(2)
    v_mfma_f32_32x32x16_bf16 v[112:127], v[168:171], v[148:151], v[112:127]
    ds_read_b64_tr_b16 v[160:161], v20 offset:53248
    ds_read_b64_tr_b16 v[162:163], v20 offset:53760
    buffer_load_dwordx4 v[148:151], v2, s[32:35], s20 offen offset:1024 sc1
    s_waitcnt vmcnt(3)
    s_waitcnt lgkmcnt(2)
    v_mfma_f32_32x32x16_bf16 v[128:143], v[164:167], v[152:155], v[128:143]
    ds_read_b64_tr_b16 v[172:173], v21 offset:55296
    ds_read_b64_tr_b16 v[174:175], v21 offset:55808
    s_waitcnt lgkmcnt(2)
    v_mfma_f32_32x32x16_bf16 v[112:127], v[160:163], v[152:155], v[112:127]
    ds_read_b64_tr_b16 v[168:169], v20 offset:55296
    ds_read_b64_tr_b16 v[170:171], v20 offset:55808
    s_add_u32 s96, s83, 15
    s_and_b32 s97, s96, 15
    s_lshl_b32 s98, s97, 11
    s_add_u32 s20, s98, s19
    buffer_load_dwordx4 v[152:155], v2, s[32:35], s20 offen sc1
    s_waitcnt vmcnt(3)
    s_waitcnt lgkmcnt(2)
    v_mfma_f32_32x32x16_bf16 v[128:143], v[172:175], v[156:159], v[128:143]
    ds_read_b64_tr_b16 v[164:165], v21 offset:57344
    ds_read_b64_tr_b16 v[166:167], v21 offset:57856
    s_waitcnt lgkmcnt(2)
    v_mfma_f32_32x32x16_bf16 v[112:127], v[168:171], v[156:159], v[112:127]
    ds_read_b64_tr_b16 v[160:161], v20 offset:57344
    ds_read_b64_tr_b16 v[162:163], v20 offset:57856
    buffer_load_dwordx4 v[156:159], v2, s[32:35], s20 offen offset:1024 sc1
    s_waitcnt vmcnt(3)
    s_waitcnt lgkmcnt(2)
    v_mfma_f32_32x32x16_bf16 v[128:143], v[164:167], v[144:147], v[128:143]
    ds_read_b64_tr_b16 v[172:173], v21 offset:59392
    ds_read_b64_tr_b16 v[174:175], v21 offset:59904
    s_waitcnt lgkmcnt(2)
    v_mfma_f32_32x32x16_bf16 v[112:127], v[160:163], v[144:147], v[112:127]
    ds_read_b64_tr_b16 v[168:169], v20 offset:59392
    ds_read_b64_tr_b16 v[170:171], v20 offset:59904
    s_waitcnt vmcnt(2)
    s_waitcnt lgkmcnt(2)
    v_mfma_f32_32x32x16_bf16 v[128:143], v[172:175], v[148:151], v[128:143]
    ds_read_b64_tr_b16 v[164:165], v21 offset:61440
    ds_read_b64_tr_b16 v[166:167], v21 offset:61952
    s_waitcnt lgkmcnt(2)
    v_mfma_f32_32x32x16_bf16 v[112:127], v[168:171], v[148:151], v[112:127]
    ds_read_b64_tr_b16 v[160:161], v20 offset:61440
    ds_read_b64_tr_b16 v[162:163], v20 offset:61952
    s_waitcnt vmcnt(1)
    s_waitcnt lgkmcnt(2)
    v_mfma_f32_32x32x16_bf16 v[128:143], v[164:167], v[152:155], v[128:143]
    ds_read_b64_tr_b16 v[172:173], v21 offset:63488
    ds_read_b64_tr_b16 v[174:175], v21 offset:64000
    s_waitcnt lgkmcnt(2)
    v_mfma_f32_32x32x16_bf16 v[112:127], v[160:163], v[152:155], v[112:127]
    ds_read_b64_tr_b16 v[168:169], v20 offset:63488
    ds_read_b64_tr_b16 v[170:171], v20 offset:64000
    s_waitcnt vmcnt(0)
    s_waitcnt lgkmcnt(2)
    v_mfma_f32_32x32x16_bf16 v[128:143], v[172:175], v[156:159], v[128:143]
    s_waitcnt lgkmcnt(0)
    v_mfma_f32_32x32x16_bf16 v[112:127], v[168:171], v[156:159], v[112:127]
    s_lshl_b32 s13, s3, 12
    v_add_u32 v4, s13, v2
    v_xor_b32 v5, 0x4000, v4
    s_lshl_b32 s96, s94, 5
    s_add_u32 s97, s96, s95
    s_lshl_b32 s98, s97, 11
    s_add_u32 s13, s98, 12582912
    v_and_b32 v6, 31, v1
    v_lshlrev_b32 v6, 4, v6
    v_lshrrev_b32 v9, 5, v1
    v_lshl_add_u32 v6, v9, 10, v6
    ds_write_b128 v4, v[128:131]
    ds_write_b128 v4, v[132:135] offset:1024
    ds_write_b128 v4, v[136:139] offset:2048
    ds_write_b128 v4, v[140:143] offset:3072
    s_waitcnt lgkmcnt(0)
    s_barrier
    ds_read_b128 v[128:131], v5
    ds_read_b128 v[132:135], v5 offset:1024
    ds_read_b128 v[136:139], v5 offset:2048
    ds_read_b128 v[140:143], v5 offset:3072
    s_waitcnt lgkmcnt(3)
    v_pk_add_f32 v[112:113], v[112:113], v[128:129]
    v_pk_add_f32 v[114:115], v[114:115], v[130:131]
    s_waitcnt lgkmcnt(2)
    v_pk_add_f32 v[116:117], v[116:117], v[132:133]
    v_pk_add_f32 v[118:119], v[118:119], v[134:135]
    v_cvt_pk_bf16_f32 v112, 0, v112
    v_cvt_pk_bf16_f32 v113, 0, v113
    v_cvt_pk_bf16_f32 v114, 0, v114
    v_cvt_pk_bf16_f32 v115, 0, v115
    v_cvt_pk_bf16_f32 v116, 0, v116
    v_cvt_pk_bf16_f32 v117, 0, v117
    v_cvt_pk_bf16_f32 v118, 0, v118
    v_cvt_pk_bf16_f32 v119, 0, v119
    v_pk_mul_f32 v[112:113], v[112:113], v[40:41]
    v_pk_mul_f32 v[114:115], v[114:115], v[42:43]
    v_pk_mul_f32 v[116:117], v[116:117], v[44:45]
    v_pk_mul_f32 v[118:119], v[118:119], v[46:47]
    v_cvt_pk_bf16_f32 v112, 0, v112
    v_cvt_pk_bf16_f32 v113, 0, v113
    v_cvt_pk_bf16_f32 v114, 0, v114
    v_cvt_pk_bf16_f32 v115, 0, v115
    v_cvt_pk_bf16_f32 v116, 0, v116
    v_cvt_pk_bf16_f32 v117, 0, v117
    v_cvt_pk_bf16_f32 v118, 0, v118
    v_cvt_pk_bf16_f32 v119, 0, v119
    v_pk_add_f32 v[112:113], v[112:113], v[24:25]
    v_pk_add_f32 v[114:115], v[114:115], v[26:27]
    v_pk_add_f32 v[116:117], v[116:117], v[28:29]
    v_pk_add_f32 v[118:119], v[118:119], v[30:31]
    v_cvt_pk_bf16_f32 v12, v112, v113
    v_cvt_pk_bf16_f32 v13, v114, v115
    v_cvt_pk_bf16_f32 v14, v116, v117
    v_cvt_pk_bf16_f32 v15, v118, v119
    buffer_store_dwordx4 v[12:15], v6, s[32:35], s13 offen sc1
    s_waitcnt lgkmcnt(1)
    v_pk_add_f32 v[120:121], v[120:121], v[136:137]
    v_pk_add_f32 v[122:123], v[122:123], v[138:139]
    s_waitcnt lgkmcnt(0)
    v_pk_add_f32 v[124:125], v[124:125], v[140:141]
    v_pk_add_f32 v[126:127], v[126:127], v[142:143]
    v_cvt_pk_bf16_f32 v120, 0, v120
    v_cvt_pk_bf16_f32 v121, 0, v121
    v_cvt_pk_bf16_f32 v122, 0, v122
    v_cvt_pk_bf16_f32 v123, 0, v123
    v_cvt_pk_bf16_f32 v124, 0, v124
    v_cvt_pk_bf16_f32 v125, 0, v125
    v_cvt_pk_bf16_f32 v126, 0, v126
    v_cvt_pk_bf16_f32 v127, 0, v127
    v_pk_mul_f32 v[120:121], v[120:121], v[48:49]
    v_pk_mul_f32 v[122:123], v[122:123], v[50:51]
    v_pk_mul_f32 v[124:125], v[124:125], v[52:53]
    v_pk_mul_f32 v[126:127], v[126:127], v[54:55]
    v_cvt_pk_bf16_f32 v120, 0, v120
    v_cvt_pk_bf16_f32 v121, 0, v121
    v_cvt_pk_bf16_f32 v122, 0, v122
    v_cvt_pk_bf16_f32 v123, 0, v123
    v_cvt_pk_bf16_f32 v124, 0, v124
    v_cvt_pk_bf16_f32 v125, 0, v125
    v_cvt_pk_bf16_f32 v126, 0, v126
    v_cvt_pk_bf16_f32 v127, 0, v127
    v_pk_add_f32 v[120:121], v[120:121], v[32:33]
    v_pk_add_f32 v[122:123], v[122:123], v[34:35]
    v_pk_add_f32 v[124:125], v[124:125], v[36:37]
    v_pk_add_f32 v[126:127], v[126:127], v[38:39]
    v_cvt_pk_bf16_f32 v16, v120, v121
    v_cvt_pk_bf16_f32 v17, v122, v123
    v_cvt_pk_bf16_f32 v18, v124, v125
    v_cvt_pk_bf16_f32 v19, v126, v127
    buffer_store_dwordx4 v[16:19], v6, s[32:35], s13 offen offset:512 sc1
    s_cmp_lt_u32 s3, 4
    s_cbranch_scc1 L_NOST
    s_sub_u32 s96, s3, 4
    s_lshl_b32 s97, s96, 12
    s_add_u32 s13, s97, 32768
    v_add_u32 v4, s13, v2
    v_add_u32 v7, 65536, v4
    ds_write_b128 v4, v[176:179] offset:16384
    ds_write_b128 v4, v[180:183]
    ds_write_b128 v4, v[184:187] offset:17408
    ds_write_b128 v4, v[188:191] offset:1024
    ds_write_b128 v4, v[192:195] offset:18432
    ds_write_b128 v4, v[196:199] offset:2048
    ds_write_b128 v4, v[200:203] offset:19456
    ds_write_b128 v4, v[204:207] offset:3072
    ds_write_b128 v4, v[208:211] offset:49152
    ds_write_b128 v4, v[212:215] offset:32768
    ds_write_b128 v4, v[216:219] offset:50176
    ds_write_b128 v4, v[220:223] offset:33792
L_NOST:
    v_and_b32 v5, 15, v1
    v_lshlrev_b32 v5, 15, v5
    s_and_b32 s96, s12, 1
    s_lshr_b32 s97, s21, 1
    s_and_b32 s98, s21, 1
    s_lshl_b32 s99, s98, 7
    s_add_u32 s98, s97, s99
    s_lshl_b32 s97, s98, 12
    s_lshr_b32 s99, s12, 1
    s_lshl_b32 s98, s99, 6
    s_add_u32 s99, s97, s98
    s_lshl2_add_u32 s97, s96, s99
    s_add_u32 s98, s97, 1048576
    s_add_u32 s16, s98, 1536
    s_waitcnt vmcnt(0)
    s_barrier
    s_cmp_lg_u32 s3, 0
    s_cbranch_scc1 L_PE
    v_mov_b32 v6, s4
    s_mov_b32 exec_hi, 0
    s_mov_b32 exec_lo, 65535
    buffer_store_dword v6, v5, s[32:35], s16 offen sc1
    s_mov_b64 exec, -1
L_PE:
    s_add_u32 s13, s80, 114688
    s_lshl2_add_u32 m0, s89, 67584
    s_nop 0
    buffer_load_dwordx4 v72, s[56:59], s13 offen nt lds
    s_lshl_b32 s96, s3, 8
    s_add_u32 s13, s96, 16640
    v_lshl_add_u32 v4, v1, 2, s13
    ds_write_b32 v4, v97
    ds_write_b32 v4, v98 offset:2048
    ds_write_b32 v4, v99 offset:4096
    ds_write_b32 v4, v104 offset:6144
    s_waitcnt lgkmcnt(0)
    s_barrier
    ds_read_b128 v[20:23], v2 offset:16640
    ds_read_b128 v[24:27], v2 offset:17664
    ds_read_b128 v[28:31], v2 offset:18688
    ds_read_b128 v[32:35], v2 offset:19712
    ds_read_b128 v[36:39], v2 offset:20736
    ds_read_b128 v[40:43], v2 offset:21760
    ds_read_b128 v[44:47], v2 offset:22784
    ds_read_b128 v[48:51], v2 offset:23808
    s_lshr_b32 s96, s93, 5
    s_lshl3_add_u32 s97, s96, s3
    s_lshl_b32 s98, s97, 13
    s_lshl_b32 s99, s75, 7
    s_add_u32 s96, s98, s99
    s_add_u32 s14, s96, 12582912
    s_add_u32 s16, s14, 4096
    v_lshrrev_b32 v7, 3, v1
    v_lshlrev_b32 v7, 9, v7
    v_and_b32 v9, 7, v1
    v_lshl_add_u32 v7, v9, 4, v7
    s_lshl_b32 s17, s3, 8
    v_and_b32 v10, 7, v1
    v_mul_u32_u24 v10, 2064, v10
    v_lshrrev_b32 v9, 3, v1
    v_lshl_add_u32 v10, v9, 4, v10
    v_add_u32 v10, s17, v10
    s_mul_i32 s17, s3, 2064
    v_add_u32 v11, s17, v2
    s_waitcnt lgkmcnt(0)
    s_load_dwordx2 s[24:25], s[32:33], s92 offset:1536 glc
    v_lshlrev_b32 v124, 16, v20
    v_and_b32 v125, s6, v20
    v_lshlrev_b32 v126, 16, v21
    v_and_b32 v127, s6, v21
    v_lshlrev_b32 v128, 16, v22
    v_and_b32 v129, s6, v22
    v_lshlrev_b32 v130, 16, v23
    v_and_b32 v131, s6, v23
    v_lshlrev_b32 v132, 16, v24
    v_and_b32 v133, s6, v24
    v_lshlrev_b32 v134, 16, v25
    v_and_b32 v135, s6, v25
    v_lshlrev_b32 v136, 16, v26
    v_and_b32 v137, s6, v26
    v_lshlrev_b32 v138, 16, v27
    v_and_b32 v139, s6, v27
    v_lshlrev_b32 v140, 16, v28
    v_and_b32 v141, s6, v28
    v_lshlrev_b32 v142, 16, v29
    v_and_b32 v143, s6, v29
    v_lshlrev_b32 v144, 16, v30
    v_and_b32 v145, s6, v30
    v_lshlrev_b32 v146, 16, v31
    v_and_b32 v147, s6, v31
    v_lshlrev_b32 v148, 16, v32
    v_and_b32 v149, s6, v32
    v_lshlrev_b32 v150, 16, v33
    v_and_b32 v151, s6, v33
    v_lshlrev_b32 v152, 16, v34
    v_and_b32 v153, s6, v34
    v_lshlrev_b32 v154, 16, v35
    v_and_b32 v155, s6, v35
    v_mov_b32 v205, s4
    v_mov_b32 v207, s4
    v_mov_b32 v209, s4
    v_mov_b32 v211, s4
    v_mov_b32 v213, s4
    v_mov_b32 v215, s4
    v_mov_b32 v217, s4
    v_mov_b32 v219, s4
    s_branch SCHK_34
SPOLL_33:
    s_load_dwordx2 s[24:25], s[32:33], s92 offset:1536 glc
SCHK_34:
    s_add_u32 s5, s5, 1
    s_cmp_ge_u32 s5, 200000
    s_waitcnt lgkmcnt(0)
    s_cbranch_scc1 SDONE_35
    s_cmp_lg_u32 s24, s4
    s_cbranch_scc1 SPOLL_33
    s_cmp_lg_u32 s25, s4
    s_cbranch_scc1 SPOLL_33
SDONE_35:
    buffer_load_dwordx4 v[12:15], v7, s[32:35], s14 offen sc1
    buffer_load_dwordx4 v[16:19], v7, s[32:35], s16 offen sc1
    s_waitcnt vmcnt(1)
    ds_write_b128 v10, v[12:15]
    s_waitcnt vmcnt(0)
    ds_write_b128 v10, v[16:19] offset:128
    s_waitcnt lgkmcnt(0)
    s_barrier
    ds_read_b128 v[12:15], v11
    ds_read_b128 v[16:19], v11 offset:1024
    s_add_u32 s13, s80, 172032
    s_lshl2_add_u32 m0, s89, 68608
    s_nop 0
    buffer_load_dwordx4 v72, s[56:59], s13 offen nt lds
    s_mov_b32 s13, s81
    s_lshl2_add_u32 m0, s89, 98304
    s_nop 0
    buffer_load_dwordx4 v73, s[60:63], s13 offen nt lds
    s_add_u32 s13, s81, 4096
    s_lshl2_add_u32 m0, s89, 99328
    s_nop 0
    buffer_load_dwordx4 v73, s[60:63], s13 offen nt lds
    s_add_u32 s13, s81, 8192
    s_lshl2_add_u32 m0, s89, 100352
    s_nop 0
    buffer_load_dwordx4 v73, s[60:63], s13 offen nt lds
    s_waitcnt lgkmcnt(0)
    v_mov_b32 v8, 0x3f803f80
    v_dot2_f32_bf16 v4, v12, v8, 0
    v_dot2_f32_bf16 v5, v12, v12, 0
    v_dot2_f32_bf16 v6, v13, v8, 0
    v_dot2_f32_bf16 v7, v13, v13, 0
    v_dot2_f32_bf16 v4, v14, v8, v4
    v_dot2_f32_bf16 v5, v14, v14, v5
    v_dot2_f32_bf16 v6, v15, v8, v6
    v_dot2_f32_bf16 v7, v15, v15, v7
    v_dot2_f32_bf16 v4, v16, v8, v4
    v_dot2_f32_bf16 v5, v16, v16, v5
    v_dot2_f32_bf16 v6, v17, v8, v6
    v_dot2_f32_bf16 v7, v17, v17, v7
    v_dot2_f32_bf16 v4, v18, v8, v4
    v_dot2_f32_bf16 v5, v18, v18, v5
    v_dot2_f32_bf16 v6, v19, v8, v6
    v_dot2_f32_bf16 v7, v19, v19, v7
    v_lshlrev_b32 v156, 16, v12
    v_and_b32 v157, s6, v12
    v_lshlrev_b32 v158, 16, v13
    v_pk_add_f32 v[4:5], v[4:5], v[6:7]
    v_and_b32 v159, s6, v13
    v_lshlrev_b32 v160, 16, v14
    v_add_f32_dpp v4, v4, v4 quad_perm:[1,0,3,2] row_mask:0xf bank_mask:0xf
    v_add_f32_dpp v5, v5, v5 quad_perm:[1,0,3,2] row_mask:0xf bank_mask:0xf
    v_and_b32 v161, s6, v14
    v_add_f32_dpp v4, v4, v4 quad_perm:[2,3,0,1] row_mask:0xf bank_mask:0xf
    v_add_f32_dpp v5, v5, v5 quad_perm:[2,3,0,1] row_mask:0xf bank_mask:0xf
    v_lshlrev_b32 v162, 16, v15
    v_add_f32_dpp v4, v4, v4 row_half_mirror row_mask:0xf bank_mask:0xf
    v_add_f32_dpp v5, v5, v5 row_half_mirror row_mask:0xf bank_mask:0xf
    v_and_b32 v163, s6, v15
    v_add_f32_dpp v4, v4, v4 row_ror:8 row_mask:0xf bank_mask:0xf
    v_add_f32_dpp v5, v5, v5 row_ror:8 row_mask:0xf bank_mask:0xf
    v_lshlrev_b32 v164, 16, v16
    v_and_b32 v165, s6, v16
    v_permlane16_swap_b32 v4, v5
    v_add_f32 v8, v4, v5
    v_add_f32 v4, v4, v5
    v_lshlrev_b32 v166, 16, v17
    v_and_b32 v167, s6, v17
    v_permlane32_swap_b32 v4, v8
    v_add_f32 v4, v4, v8
    v_mul_f32 v8, 0x3a800000, v4
    v_mul_f32 v4, 0x3a800000, v4
    v_lshlrev_b32 v168, 16, v18
    v_and_b32 v169, s6, v18
    v_permlane16_swap_b32 v4, v8
    v_fma_f32 v53, -v4, v4, v8
    v_cvt_pk_bf16_f32 v52, 0, v4
    v_max_f32 v53, 0, v53
    v_cvt_pk_bf16_f32 v53, 0, v53
    v_add_f32 v53, 0x3727c5ac, v53
    v_cvt_pk_bf16_f32 v53, 0, v53
    v_sqrt_f32 v53, v53
    v_lshlrev_b32 v170, 16, v19
    v_and_b32 v171, s6, v19
    v_cvt_pk_bf16_f32 v53, 0, v53
    v_rcp_f32 v53, v53
    s_nop 0
    v_pk_add_f32 v[172:173], v[156:157], v[52:53] op_sel_hi:[1,0] neg_lo:[0,1] neg_hi:[0,1]
    v_pk_add_f32 v[174:175], v[158:159], v[52:53] op_sel_hi:[1,0] neg_lo:[0,1] neg_hi:[0,1]
    v_pk_add_f32 v[176:177], v[160:161], v[52:53] op_sel_hi:[1,0] neg_lo:[0,1] neg_hi:[0,1]
    v_pk_add_f32 v[178:179], v[162:163], v[52:53] op_sel_hi:[1,0] neg_lo:[0,1] neg_hi:[0,1]
    v_pk_add_f32 v[180:181], v[164:165], v[52:53] op_sel_hi:[1,0] neg_lo:[0,1] neg_hi:[0,1]
    v_pk_add_f32 v[182:183], v[166:167], v[52:53] op_sel_hi:[1,0] neg_lo:[0,1] neg_hi:[0,1]
    v_pk_add_f32 v[184:185], v[168:169], v[52:53] op_sel_hi:[1,0] neg_lo:[0,1] neg_hi:[0,1]
    v_pk_add_f32 v[186:187], v[170:171], v[52:53] op_sel_hi:[1,0] neg_lo:[0,1] neg_hi:[0,1]
    v_cvt_pk_bf16_f32 v172, 0, v172
    v_cvt_pk_bf16_f32 v173, 0, v173
    v_cvt_pk_bf16_f32 v174, 0, v174
    v_cvt_pk_bf16_f32 v175, 0, v175
    v_cvt_pk_bf16_f32 v176, 0, v176
    v_cvt_pk_bf16_f32 v177, 0, v177
    v_cvt_pk_bf16_f32 v178, 0, v178
    v_cvt_pk_bf16_f32 v179, 0, v179
    v_cvt_pk_bf16_f32 v180, 0, v180
    v_cvt_pk_bf16_f32 v181, 0, v181
    v_cvt_pk_bf16_f32 v182, 0, v182
    v_cvt_pk_bf16_f32 v183, 0, v183
    v_cvt_pk_bf16_f32 v184, 0, v184
    v_cvt_pk_bf16_f32 v185, 0, v185
    v_cvt_pk_bf16_f32 v186, 0, v186
    v_cvt_pk_bf16_f32 v187, 0, v187
    v_pk_mul_f32 v[172:173], v[172:173], v[52:53] op_sel:[0,1]
    v_pk_mul_f32 v[174:175], v[174:175], v[52:53] op_sel:[0,1]
    v_pk_mul_f32 v[176:177], v[176:177], v[52:53] op_sel:[0,1]
    v_pk_mul_f32 v[178:179], v[178:179], v[52:53] op_sel:[0,1]
    v_pk_mul_f32 v[180:181], v[180:181], v[52:53] op_sel:[0,1]
    v_pk_mul_f32 v[182:183], v[182:183], v[52:53] op_sel:[0,1]
    v_pk_mul_f32 v[184:185], v[184:185], v[52:53] op_sel:[0,1]
    v_pk_mul_f32 v[186:187], v[186:187], v[52:53] op_sel:[0,1]
    v_cvt_pk_bf16_f32 v172, 0, v172
    v_cvt_pk_bf16_f32 v173, 0, v173
    v_cvt_pk_bf16_f32 v174, 0, v174
    v_cvt_pk_bf16_f32 v175, 0, v175
    v_cvt_pk_bf16_f32 v176, 0, v176
    v_cvt_pk_bf16_f32 v177, 0, v177
    v_cvt_pk_bf16_f32 v178, 0, v178
    v_cvt_pk_bf16_f32 v179, 0, v179
    v_cvt_pk_bf16_f32 v180, 0, v180
    v_cvt_pk_bf16_f32 v181, 0, v181
    v_cvt_pk_bf16_f32 v182, 0, v182
    v_cvt_pk_bf16_f32 v183, 0, v183
    v_cvt_pk_bf16_f32 v184, 0, v184
    v_cvt_pk_bf16_f32 v185, 0, v185
    v_cvt_pk_bf16_f32 v186, 0, v186
    v_cvt_pk_bf16_f32 v187, 0, v187
    v_pk_mul_f32 v[172:173], v[172:173], v[140:141]
    v_pk_mul_f32 v[174:175], v[174:175], v[142:143]
    v_pk_mul_f32 v[176:177], v[176:177], v[144:145]
    v_pk_mul_f32 v[178:179], v[178:179], v[146:147]
    v_pk_mul_f32 v[180:181], v[180:181], v[148:149]
    v_pk_mul_f32 v[182:183], v[182:183], v[150:151]
    v_pk_mul_f32 v[184:185], v[184:185], v[152:153]
    v_pk_mul_f32 v[186:187], v[186:187], v[154:155]
    v_cvt_pk_bf16_f32 v172, 0, v172
    v_cvt_pk_bf16_f32 v173, 0, v173
    v_cvt_pk_bf16_f32 v174, 0, v174
    v_cvt_pk_bf16_f32 v175, 0, v175
    v_cvt_pk_bf16_f32 v176, 0, v176
    v_cvt_pk_bf16_f32 v177, 0, v177
    v_cvt_pk_bf16_f32 v178, 0, v178
    v_cvt_pk_bf16_f32 v179, 0, v179
    v_cvt_pk_bf16_f32 v180, 0, v180
    v_cvt_pk_bf16_f32 v181, 0, v181
    v_cvt_pk_bf16_f32 v182, 0, v182
    v_cvt_pk_bf16_f32 v183, 0, v183
    v_cvt_pk_bf16_f32 v184, 0, v184
    v_cvt_pk_bf16_f32 v185, 0, v185
    v_cvt_pk_bf16_f32 v186, 0, v186
    v_cvt_pk_bf16_f32 v187, 0, v187
    v_pk_add_f32 v[172:173], v[172:173], v[124:125]
    v_pk_add_f32 v[174:175], v[174:175], v[126:127]
    v_pk_add_f32 v[176:177], v[176:177], v[128:129]
    v_pk_add_f32 v[178:179], v[178:179], v[130:131]
    v_pk_add_f32 v[180:181], v[180:181], v[132:133]
    v_pk_add_f32 v[182:183], v[182:183], v[134:135]
    v_pk_add_f32 v[184:185], v[184:185], v[136:137]
    v_pk_add_f32 v[186:187], v[186:187], v[138:139]
    v_cvt_pk_bf16_f32 v204, v172, v173
    v_cvt_pk_bf16_f32 v206, v174, v175
    v_cvt_pk_bf16_f32 v208, v176, v177
    v_cvt_pk_bf16_f32 v210, v178, v179
    v_cvt_pk_bf16_f32 v212, v180, v181
    v_cvt_pk_bf16_f32 v214, v182, v183
    v_cvt_pk_bf16_f32 v216, v184, v185
    v_cvt_pk_bf16_f32 v218, v186, v187
    v_dot2_f32_bf16 v52, v204, v44, 0
    v_dot2_f32_bf16 v53, v206, v45, 0
    v_dot2_f32_bf16 v52, v208, v46, v52
    v_dot2_f32_bf16 v53, v210, v47, v53
    v_dot2_f32_bf16 v52, v212, v48, v52
    v_dot2_f32_bf16 v53, v214, v49, v53
    v_dot2_f32_bf16 v52, v216, v50, v52
    v_dot2_f32_bf16 v53, v218, v51, v53
    s_nop 2
    v_add_f32 v52, v52, v53
    s_nop 1
    v_add_f32_dpp v52, v52, v52 quad_perm:[1,0,3,2] row_mask:0xf bank_mask:0xf
    s_nop 1
    v_add_f32_dpp v52, v52, v52 quad_perm:[2,3,0,1] row_mask:0xf bank_mask:0xf
    s_nop 1
    v_add_f32_dpp v52, v52, v52 row_half_mirror row_mask:0xf bank_mask:0xf
    s_nop 1
    v_add_f32_dpp v52, v52, v52 row_ror:8 row_mask:0xf bank_mask:0xf
    v_mov_b32 v53, v52
    s_nop 1
    v_permlane16_swap_b32 v52, v53
    v_add_f32 v52, v52, v53
    v_mov_b32 v53, v52
    s_nop 1
    v_permlane32_swap_b32 v52, v53
    v_add_f32 v52, v52, v53
    s_sub_u32 s13, 2047, s93
    s_lshl2_add_u32 s14, s3, 24832
    v_cvt_pk_bf16_f32 v52, 0, v52
    v_ashrrev_i32 v53, 31, v52
    v_or_b32 v53, 0x80000000, v53
    v_xor_b32 v52, v52, v53
    v_lshrrev_b32 v52, 16, v52
    v_lshl_or_b32 v52, v52, 11, s13
    v_mov_b32 v53, s14
    v_readfirstlane_b32 s13, v52
    s_nop 1
    v_mov_b32 v52, s13
    ds_write_b32 v53, v52
    v_and_b32 v4, 7, v1
    v_lshlrev_b32 v4, 2, v4
    v_add_u32 v4, 24832, v4
    v_and_b32 v6, 15, v1
    v_lshlrev_b32 v6, 15, v6
    s_lshl_b32 s16, s93, 11
    s_lshl_b32 s96, s93, 12
    s_add_u32 s17, s96, 33554432
    s_and_b32 s96, s9, 1
    s_and_b32 s97, s2, 135
    s_lshl_b32 s98, s97, 12
    s_bfe_u32 s99, s9, 196609
    s_lshl_b32 s97, s99, 6
    s_add_u32 s99, s98, s97
    s_lshl4_add_u32 s98, s96, s99
    s_add_u32 s97, s98, 1048576
    s_add_u32 s14, s97, 2048
    s_waitcnt lgkmcnt(0)
    s_barrier
    ds_read_b32 v5, v4
    v_mov_b32 v53, s4
    s_waitcnt lgkmcnt(0)
    v_cmp_gt_u32 vcc, v5, v52
    s_nop 0
    s_and_b32 s15, vcc_lo, 0xff
    s_bcnt1_i32_b32 s15, s15
    s_cmp_ge_u32 s15, 2
    s_cbranch_scc1 L_NOC1
    s_lshl3_add_u32 s14, s15, s14
    s_mov_b64 exec, 0xffff
    buffer_store_dwordx2 v[52:53], v6, s[32:35], s14 offen sc1
    s_mov_b64 exec, -1
L_NOC1:
    s_add_u32 s13, s81, 12288
    s_lshl2_add_u32 m0, s89, 101376
    s_nop 0
    buffer_load_dwordx4 v73, s[60:63], s13 offen nt lds
    v_lshlrev_b32 v172, 16, v204
    v_and_b32 v173, s6, v204
    v_lshlrev_b32 v174, 16, v206
    v_and_b32 v175, s6, v206
    v_lshlrev_b32 v176, 16, v208
    v_and_b32 v177, s6, v208
    v_lshlrev_b32 v178, 16, v210
    v_and_b32 v179, s6, v210
    v_lshlrev_b32 v180, 16, v212
    v_and_b32 v181, s6, v212
    v_lshlrev_b32 v182, 16, v214
    v_and_b32 v183, s6, v214
    v_lshlrev_b32 v184, 16, v216
    v_and_b32 v185, s6, v216
    v_lshlrev_b32 v186, 16, v218
    v_and_b32 v187, s6, v218
    v_lshlrev_b32 v124, 16, v36
    v_and_b32 v125, s6, v36
    v_lshlrev_b32 v126, 16, v37
    v_and_b32 v127, s6, v37
    v_lshlrev_b32 v128, 16, v38
    v_and_b32 v129, s6, v38
    v_lshlrev_b32 v130, 16, v39
    v_and_b32 v131, s6, v39
    v_lshlrev_b32 v132, 16, v40
    v_and_b32 v133, s6, v40
    v_lshlrev_b32 v134, 16, v41
    v_and_b32 v135, s6, v41
    v_lshlrev_b32 v136, 16, v42
    v_and_b32 v137, s6, v42
    v_lshlrev_b32 v138, 16, v43
    v_and_b32 v139, s6, v43
    v_bfe_u32 v7, v1, 1, 3
    v_lshlrev_b32 v7, 12, v7
    v_and_b32 v9, 1, v1
    v_lshl_add_u32 v7, v9, 19, v7
    s_lshr_b32 s96, s9, 4
    s_and_b32 s97, s9, 15
    s_lshl_b32 s98, s97, 15
    s_lshl_b32 s99, s8, 6
    s_add_u32 s97, s98, s99
    s_lshl4_add_u32 s98, s96, s97
    s_add_u32 s99, s98, 1048576
    s_add_u32 s14, s99, 2560
    s_lshl3_add_u32 s13, s3, 24896
    v_mov_b32 v4, s13
    v_mov_b32 v5, 24896
SPOLL_36:
    s_load_dwordx8 s[24:31], s[32:33], s92 offset:2048 glc
SCHK_37:
    s_add_u32 s5, s5, 1
    s_cmp_ge_u32 s5, 200000
    s_waitcnt lgkmcnt(0)
    s_cbranch_scc1 SDONE_38
    s_cmp_lg_u32 s25, s4
    s_cbranch_scc1 SPOLL_36
    s_cmp_lg_u32 s27, s4
    s_cbranch_scc1 SPOLL_36
    s_cmp_lg_u32 s29, s4
    s_cbranch_scc1 SPOLL_36
    s_cmp_lg_u32 s31, s4
    s_cbranch_scc1 SPOLL_36
SDONE_38:
    s_min_u32 s25, s24, s28
    s_max_u32 s24, s24, s28
    s_max_u32 s26, s26, s30
    s_max_u32 s25, s25, s26
    v_mov_b32 v188, s24
    v_mov_b32 v189, s25
    ds_write_b64 v4, v[188:189]
    s_cmp_ge_u32 s15, 2
    s_cbranch_scc1 L_NOC3
    buffer_store_dwordx4 v[204:207], v2, s[32:35], s17 offen sc1
    buffer_store_dwordx4 v[208:211], v2, s[32:35], s17 offen offset:2048 sc1
    buffer_store_dwordx4 v[212:215], v2, s[32:35], s17 offen offset:1024 sc1
    buffer_store_dwordx4 v[216:219], v2, s[32:35], s17 offen offset:3072 sc1
L_NOC3:
    s_waitcnt lgkmcnt(0)
    s_barrier
    s_cmp_lg_u32 s3, 0
    s_cbranch_scc1 L_NOF2
    ds_read_b128 v[188:191], v5 offset:0
    ds_read_b128 v[192:195], v5 offset:16
    ds_read_b128 v[196:199], v5 offset:32
    ds_read_b128 v[200:203], v5 offset:48
    s_waitcnt lgkmcnt(0)
    v_min_u32 v6, v188, v190
    v_max_u32 v188, v188, v190
    v_max3_u32 v189, v189, v191, v6
    v_min_u32 v6, v192, v194
    v_max_u32 v192, v192, v194
    v_max3_u32 v193, v193, v195, v6
    v_min_u32 v6, v196, v198
    v_max_u32 v196, v196, v198
    v_max3_u32 v197, v197, v199, v6
    v_min_u32 v6, v200, v202
    v_max_u32 v200, v200, v202
    v_max3_u32 v201, v201, v203, v6
    v_min_u32 v6, v188, v192
    v_max_u32 v188, v188, v192
    v_max3_u32 v189, v189, v193, v6
    v_min_u32 v6, v196, v200
    v_max_u32 v196, v196, v200
    v_max3_u32 v197, v197, v201, v6
    v_min_u32 v6, v188, v196
    v_max_u32 v188, v188, v196
    v_max3_u32 v189, v189, v197, v6
    v_mov_b32 v190, v189
    v_mov_b32 v189, s4
    v_mov_b32 v191, s4
    s_mov_b64 exec, 0xffff
    buffer_store_dwordx4 v[188:191], v7, s[32:35], s14 offen sc1
    s_mov_b64 exec, -1
L_NOF2:
    s_lshr_b32 s96, s3, 2
    s_lshl_b32 s97, s96, 15
    s_and_b32 s98, s3, 3
    s_lshl_b32 s99, s98, 5
    s_add_u32 s96, s97, s99
    s_add_u32 s13, s96, 32768
    v_lshrrev_b32 v54, 4, v1
    v_lshlrev_b32 v54, 13, v54
    v_bfe_u32 v9, v1, 2, 2
    v_lshl_add_u32 v54, v9, 7, v54
    v_bfe_u32 v9, v1, 3, 2
    v_lshl_add_u32 v54, v9, 5, v54
    v_and_b32 v9, 3, v1
    v_lshl_add_u32 v54, v9, 3, v54
    v_xor_b32 v54, s13, v54
    s_lshl_b32 s13, s3, 6
    v_bfe_u32 v55, v1, 2, 1
    v_lshlrev_b32 v55, 9, v55
    v_bfe_u32 v9, v1, 3, 1
    v_lshl_add_u32 v55, v9, 12, v55
    v_lshrrev_b32 v9, 5, v1
    v_lshl_add_u32 v55, v9, 11, v55
    v_bfe_u32 v9, v1, 2, 2
    v_lshl_add_u32 v55, v9, 6, v55
    v_bfe_u32 v9, v1, 4, 1
    v_lshl_add_u32 v55, v9, 5, v55
    v_and_b32 v9, 3, v1
    v_lshl_add_u32 v55, v9, 3, v55
    v_xor_b32 v55, s13, v55
    v_add_u32 v55, 98304, v55
    s_lshl_b32 s96, s75, 9
    s_add_u32 s13, s96, 33554432
    v_and_b32 v56, 7, v1
    v_lshl_add_u32 v56, v56, 4, s13
    v_lshrrev_b32 v9, 4, v1
    v_lshl_add_u32 v56, v9, 7, v56
    v_and_b32 v8, 8, v1
    v_cmp_eq_u32 s[22:23], 0, v8
    v_and_b32 v8, 15, v1
    v_lshlrev_b32 v8, 4, v8
    v_lshrrev_b32 v9, 5, v1
    v_lshl_add_u32 v8, v9, 3, v8
    s_lshl_b32 s96, s74, 13
    s_add_u32 s14, s96, 20971520
    s_lshl3_add_u32 s96, s75, s3
    s_lshl_b32 s97, s96, 8
    s_add_u32 s20, s97, s14
    s_lshl3_add_u32 s13, s3, 24960
    v_mov_b32 v4, s13
    v_mov_b32 v5, 24960
    s_load_dwordx8 s[24:31], s[32:33], s92 offset:2560 glc
    v_pk_mul_f32 v[172:173], v[172:173], v[124:125]
    v_pk_mul_f32 v[174:175], v[174:175], v[126:127]
    v_pk_mul_f32 v[176:177], v[176:177], v[128:129]
    v_pk_mul_f32 v[178:179], v[178:179], v[130:131]
    v_pk_mul_f32 v[180:181], v[180:181], v[132:133]
    v_pk_mul_f32 v[182:183], v[182:183], v[134:135]
    v_pk_mul_f32 v[184:185], v[184:185], v[136:137]
    v_pk_mul_f32 v[186:187], v[186:187], v[138:139]
    v_cvt_pk_bf16_f32 v172, 0, v172
    v_cvt_pk_bf16_f32 v173, 0, v173
    v_cvt_pk_bf16_f32 v174, 0, v174
    v_cvt_pk_bf16_f32 v175, 0, v175
    v_cvt_pk_bf16_f32 v176, 0, v176
    v_cvt_pk_bf16_f32 v177, 0, v177
    v_cvt_pk_bf16_f32 v178, 0, v178
    v_cvt_pk_bf16_f32 v179, 0, v179
    v_cvt_pk_bf16_f32 v180, 0, v180
    v_cvt_pk_bf16_f32 v181, 0, v181
    v_cvt_pk_bf16_f32 v182, 0, v182
    v_cvt_pk_bf16_f32 v183, 0, v183
    v_cvt_pk_bf16_f32 v184, 0, v184
    v_cvt_pk_bf16_f32 v185, 0, v185
    v_cvt_pk_bf16_f32 v186, 0, v186
    v_cvt_pk_bf16_f32 v187, 0, v187
    v_pk_add_f32 v[172:173], v[172:173], v[156:157]
    v_pk_add_f32 v[174:175], v[174:175], v[158:159]
    v_pk_add_f32 v[176:177], v[176:177], v[160:161]
    v_pk_add_f32 v[178:179], v[178:179], v[162:163]
    v_pk_add_f32 v[180:181], v[180:181], v[164:165]
    v_pk_add_f32 v[182:183], v[182:183], v[166:167]
    v_pk_add_f32 v[184:185], v[184:185], v[168:169]
    v_pk_add_f32 v[186:187], v[186:187], v[170:171]
    v_cvt_pk_bf16_f32 v64, v172, v173
    v_cvt_pk_bf16_f32 v65, v174, v175
    v_cvt_pk_bf16_f32 v66, v176, v177
    v_cvt_pk_bf16_f32 v67, v178, v179
    v_cvt_pk_bf16_f32 v68, v180, v181
    v_cvt_pk_bf16_f32 v69, v182, v183
    v_cvt_pk_bf16_f32 v70, v184, v185
    v_cvt_pk_bf16_f32 v71, v186, v187
    s_cmp_lt_u32 s15, 2
    s_cbranch_scc1 L_NOC2
    buffer_store_dwordx4 v[64:67], v2, s[64:67], s16 offen
    buffer_store_dwordx4 v[68:71], v2, s[64:67], s16 offen offset:1024
L_NOC2:
    s_branch SCHK_40
SPOLL_39:
    s_load_dwordx8 s[24:31], s[32:33], s92 offset:2560 glc
SCHK_40:
    s_add_u32 s5, s5, 1
    s_cmp_ge_u32 s5, 200000
    s_waitcnt lgkmcnt(0)
    s_cbranch_scc1 SDONE_41
    s_cmp_lg_u32 s25, s4
    s_cbranch_scc1 SPOLL_39
    s_cmp_lg_u32 s27, s4
    s_cbranch_scc1 SPOLL_39
    s_cmp_lg_u32 s29, s4
    s_cbranch_scc1 SPOLL_39
    s_cmp_lg_u32 s31, s4
    s_cbranch_scc1 SPOLL_39
SDONE_41:
    s_min_u32 s25, s24, s28
    s_max_u32 s24, s24, s28
    s_max_u32 s26, s26, s30
    s_max_u32 s25, s25, s26
    v_mov_b32 v188, s24
    v_mov_b32 v189, s25
    ds_write_b64 v4, v[188:189]
    s_waitcnt vmcnt(0)
    s_waitcnt lgkmcnt(0)
    s_barrier
    ds_read_b128 v[188:191], v5
    ds_read_b128 v[192:195], v5 offset:16
    ds_read_b128 v[196:199], v5 offset:32
    ds_read_b128 v[200:203], v5 offset:48
    s_waitcnt lgkmcnt(0)
    v_min_u32 v6, v188, v190
    v_max_u32 v188, v188, v190
    v_max3_u32 v189, v189, v191, v6
    v_min_u32 v6, v192, v194
    v_max_u32 v192, v192, v194
    v_max3_u32 v193, v193, v195, v6
    v_min_u32 v6, v196, v198
    v_max_u32 v196, v196, v198
    v_max3_u32 v197, v197, v199, v6
    v_min_u32 v6, v200, v202
    v_max_u32 v200, v200, v202
    v_max3_u32 v201, v201, v203, v6
    v_min_u32 v6, v188, v192
    v_max_u32 v188, v188, v192
    v_max3_u32 v189, v189, v193, v6
    v_min_u32 v6, v196, v200
    v_max_u32 v196, v196, v200
    v_max3_u32 v197, v197, v201, v6
    v_min_u32 v6, v188, v196
    v_max_u32 v188, v188, v196
    v_max3_u32 v189, v189, v197, v6
    v_cndmask_b32 v4, v189, v188, s[22:23]
    v_readfirstlane_b32 s68, v188
    v_not_b32 v4, v4
    v_readfirstlane_b32 s69, v189
    v_and_b32 v4, 2047, v4
    v_lshl_add_u32 v4, v4, 12, v56
    buffer_load_dwordx4 v[192:195], v4, s[32:35], 0 offen sc1
    buffer_load_dwordx4 v[196:199], v4, s[32:35], 0 offen offset:2048 sc1
    ds_read_b64_tr_b16 v[76:77], v54
    ds_read_b64_tr_b16 v[78:79], v54 offset:512
    ds_read_b64_tr_b16 v[80:81], v54 offset:1024
    ds_read_b64_tr_b16 v[82:83], v54 offset:1536
    ds_read_b64_tr_b16 v[84:85], v54 offset:2048
    ds_read_b64_tr_b16 v[86:87], v54 offset:2560
    ds_read_b64_tr_b16 v[88:89], v54 offset:3072
    ds_read_b64_tr_b16 v[90:91], v54 offset:3584
    ds_read_b64_tr_b16 v[92:93], v54 offset:4096
    ds_read_b64_tr_b16 v[94:95], v54 offset:4608
    ds_read_b64_tr_b16 v[96:97], v54 offset:5120
    ds_read_b64_tr_b16 v[98:99], v54 offset:5632
    ds_read_b64_tr_b16 v[100:101], v54 offset:6144
    ds_read_b64_tr_b16 v[102:103], v54 offset:6656
    ds_read_b64_tr_b16 v[104:105], v54 offset:7168
    ds_read_b64_tr_b16 v[106:107], v54 offset:7680
    s_andn2_b32 s70, 2047, s68
    s_andn2_b32 s71, 2047, s69
    s_waitcnt lgkmcnt(0)
    s_waitcnt vmcnt(0)
    v_bitop3_b32 v5, v193, v195, s4 bitop3:0x7e
    v_bitop3_b32 v5, v5, v197, s4 bitop3:0xf6
    v_bitop3_b32 v5, v5, v199, s4 bitop3:0xf6
    v_cmp_ne_u32 vcc, 0, v5
    s_cbranch_vccz TOK_43
POLL_44:
    buffer_load_dwordx4 v[192:195], v4, s[32:35], 0 offen sc1
    buffer_load_dwordx4 v[196:199], v4, s[32:35], 0 offen offset:2048 sc1
    s_waitcnt vmcnt(0)
    v_bitop3_b32 v5, v193, v195, s4 bitop3:0x7e
    v_bitop3_b32 v5, v5, v197, s4 bitop3:0xf6
    v_bitop3_b32 v5, v5, v199, s4 bitop3:0xf6
    v_cmp_ne_u32 vcc, 0, v5
    s_cbranch_vccz PDONE_45
    s_add_u32 s5, s5, 1
    s_cmp_lt_u32 s5, 200000
    s_cbranch_scc1 POLL_44
PDONE_45:
TOK_43:
    v_mov_b32 v193, v194
    v_mov_b32 v194, v196
    v_mov_b32 v195, v198
    s_nop 1
    v_mfma_f32_16x16x32_bf16 v[156:159], v[192:195], v[76:79], 0
    v_mfma_f32_16x16x32_bf16 v[160:163], v[192:195], v[80:83], 0
    v_mfma_f32_16x16x32_bf16 v[164:167], v[192:195], v[84:87], 0
    v_mfma_f32_16x16x32_bf16 v[168:171], v[192:195], v[88:91], 0
    v_mfma_f32_16x16x32_bf16 v[172:175], v[192:195], v[92:95], 0
    v_mfma_f32_16x16x32_bf16 v[176:179], v[192:195], v[96:99], 0
    v_mfma_f32_16x16x32_bf16 v[180:183], v[192:195], v[100:103], 0
    v_mfma_f32_16x16x32_bf16 v[184:187], v[192:195], v[104:107], 0
    ds_read_b64_tr_b16 v[108:109], v55
    ds_read_b64_tr_b16 v[110:111], v55 offset:1024
    ds_read_b64_tr_b16 v[112:113], v55 offset:8192
    ds_read_b64_tr_b16 v[114:115], v55 offset:9216
    ds_read_b64_tr_b16 v[116:117], v55 offset:16384
    ds_read_b64_tr_b16 v[118:119], v55 offset:17408
    ds_read_b64_tr_b16 v[120:121], v55 offset:24576
    ds_read_b64_tr_b16 v[122:123], v55 offset:25600
    v_add_f32 v188, v156, v161
    v_add_f32 v189, v166, v171
    v_add_f32 v190, v172, v177
    v_add_f32 v191, v182, v187
    v_add_f32 v188, v188, v189
    v_add_f32 v190, v190, v191
    v_mov_b32 v189, s4
    s_nop 0
    v_permlane16_swap_b32 v190, v191
    s_cmp_ge_u32 s9, 28
    s_cbranch_scc1 L_NOHP
    v_add_f32 v188, v188, v191
    s_mov_b32 exec_lo, 0xffff
    s_mov_b32 exec_hi, 0xffff
    buffer_store_dwordx2 v[188:189], v8, s[32:35], s20 offen sc1
    s_mov_b64 exec, -1
L_NOHP:
    s_bitcmp1_b32 s9, 1
    s_cselect_b32 s17, s71, s70
    s_cselect_b32 s18, s69, s68
    s_cmp_ge_u32 s15, 2
    s_cbranch_scc1 L_NOOUT
    s_cmp_eq_u32 s93, s70
    s_cbranch_scc1 L_NOOUT
    s_cmp_eq_u32 s93, s71
    s_cbranch_scc1 L_NOOUT
    buffer_store_dwordx4 v[64:67], v2, s[64:67], s16 offen
    buffer_store_dwordx4 v[68:71], v2, s[64:67], s16 offen offset:1024
L_NOOUT:
    s_cmp_lg_u32 s93, 7
    s_cbranch_scc1 L_NONON
    v_mov_b32 v6, s4
    s_mov_b64 exec, 1
    buffer_store_dword v6, v3, s[32:35], 0 offen sc1
    s_mov_b64 exec, -1
L_NONON:
    s_cmp_ge_u32 s9, 28
    s_cbranch_scc1 L_FIN
    s_cmp_lg_u32 s3, 7
    s_cbranch_scc1 L_NOFZ
    s_bfe_u32 s96, s9, 131074
    s_lshl2_add_u32 s97, s8, s96
    s_and_b32 s98, s9, 1
    s_lshl1_add_u32 s19, s97, s98
    s_and_b32 s96, s9, 15
    s_lshl4_add_u32 s97, s8, s96
    s_mul_i32 s98, s97, 7168
    s_add_u32 s20, s98, 22020096
    s_lshl_b32 s96, s17, 11
    s_lshl_b32 s97, s19, 5
    s_add_u32 s82, s96, s97
    v_and_b32 v10, 7, v1
    v_lshlrev_b32 v10, 2, v10
    s_lshl_b32 s96, s19, 5
    s_add_u32 s97, s96, 16640
    s_add_u32 s13, s97, 4096
    v_add_u32 v5, s13, v10
    ds_read_b32 v74, v5
    s_lshl_b32 s96, s17, 12
    s_lshl_b32 s97, s19, 5
    s_add_u32 s98, s96, s97
    s_add_u32 s68, s98, 33554432
    v_bfe_u32 v11, v1, 2, 1
    v_lshlrev_b32 v11, 4, v11
    v_bfe_u32 v9, v1, 1, 1
    v_lshl_add_u32 v11, v9, 11, v11
    v_and_b32 v9, 1, v1
    v_lshl_add_u32 v11, v9, 3, v11
    s_and_b32 s96, s17, 31
    s_lshr_b32 s97, s17, 5
    s_lshl_b32 s98, s97, 6
    s_add_u32 s99, s98, s19
    s_lshl_b32 s97, s99, 10
    s_lshl4_add_u32 s98, s96, s97
    s_add_u32 s13, s98, 12582912
    v_bfe_u32 v5, v1, 2, 1
    v_lshlrev_b32 v5, 9, v5
    v_and_b32 v9, 3, v1
    v_lshl_add_u32 v5, v9, 2, v5
    buffer_load_dword v73, v5, s[32:35], s13 offen sc1
    s_lshr_b32 s13, s18, 11
    s_lshl_b32 s13, s13, 16
    s_ashr_i32 s15, s13, 31
    s_andn2_b32 s15, 0x7fff0000, s15
    s_or_b32 s15, s15, 0x80000000
    s_xor_b32 s13, s13, s15
    v_mov_b32 v75, s13
    v_mul_f32 v75, s7, v75
    v_exp_f32 v75, -v75
    s_nop 0
    v_add_f32 v75, 1.0, v75
    v_rcp_f32 v75, v75
    s_nop 0
    v_cvt_pk_bf16_f32 v75, 0, v75
L_NOFZ:
    s_cmp_ge_u32 s3, 4
    s_cbranch_scc1 L_NOH
    s_lshl_b32 s96, s3, 8
    s_add_u32 s13, s96, s14
    v_lshrrev_b32 v4, 4, v1
    v_lshlrev_b32 v4, 11, v4
    v_and_b32 v9, 15, v1
    v_lshl_add_u32 v4, v9, 4, v4
    s_lshl_b32 s96, s3, 5
    s_add_u32 s15, s96, 25088
    v_lshrrev_b32 v5, 5, v1
    v_lshl_add_u32 v5, v5, 7, s15
    v_bfe_u32 v9, v1, 2, 1
    v_lshl_add_u32 v5, v9, 4, v5
    v_bfe_u32 v9, v1, 1, 1
    v_lshl_add_u32 v5, v9, 3, v5
    v_bfe_u32 v9, v1, 3, 1
    v_lshl_add_u32 v5, v9, 2, v5
    v_and_b32 v9, 1, v1
    v_lshl_add_u32 v5, v9, 1, v5
SPOLL_46:
    s_load_dword s24, s[32:33], s13 offset:1276 glc
    s_load_dword s25, s[32:33], s13 offset:3324 glc
    s_load_dword s26, s[32:33], s13 offset:5372 glc
    s_load_dword s27, s[32:33], s13 offset:7420 glc
SCHK_47:
    s_add_u32 s5, s5, 1
    s_cmp_ge_u32 s5, 200000
    s_waitcnt lgkmcnt(0)
    s_cbranch_scc1 SDONE_48
    s_cmp_lg_u32 s24, s4
    s_cbranch_scc1 SPOLL_46
    s_cmp_lg_u32 s25, s4
    s_cbranch_scc1 SPOLL_46
    s_cmp_lg_u32 s26, s4
    s_cbranch_scc1 SPOLL_46
    s_cmp_lg_u32 s27, s4
    s_cbranch_scc1 SPOLL_46
SDONE_48:
POLL_49:
    buffer_load_dwordx4 v[156:159], v4, s[32:35], s13 offen sc1
    buffer_load_dwordx4 v[160:163], v4, s[32:35], s13 offen offset:1024 sc1
    s_waitcnt vmcnt(0)
    v_bitop3_b32 v6, v157, v159, s4 bitop3:0x7e
    v_bitop3_b32 v6, v6, v161, s4 bitop3:0xf6
    v_bitop3_b32 v6, v6, v163, s4 bitop3:0xf6
    v_cmp_ne_u32 vcc, 0, v6
    s_cbranch_vccz PDONE_50
    s_add_u32 s5, s5, 1
    s_cmp_lt_u32 s5, 200000
    s_cbranch_scc1 POLL_49
PDONE_50:
    v_permlane32_swap_b32 v156, v158
    v_permlane32_swap_b32 v160, v162
    v_add_f32 v156, v156, v158
    v_add_f32 v160, v160, v162
    v_mov_b32 v158, v156
    v_mov_b32 v162, v160
    s_nop 0
    v_permlane16_swap_b32 v156, v158
    v_permlane16_swap_b32 v160, v162
    v_add_f32 v156, v156, v158
    v_add_f32 v160, v160, v162
    v_cvt_pk_bf16_f32 v156, 0, v156
    v_cvt_pk_bf16_f32 v160, 0, v160
    v_mul_f32 v6, s7, v156
    v_exp_f32 v6, -v6
    s_nop 0
    v_add_f32 v6, 1.0, v6
    v_rcp_f32 v6, v6
    s_nop 0
    v_mul_f32 v156, v156, v6
    v_cvt_pk_bf16_f32 v156, 0, v156
    v_mul_f32 v156, v156, v160
    v_cvt_pk_bf16_f32 v156, v156, v156
    ds_write_b16 v5, v156
L_NOH:
    v_bfe_u32 v4, v1, 2, 1
    v_lshlrev_b32 v4, 7, v4
    v_lshrrev_b32 v9, 5, v1
    v_lshl_add_u32 v4, v9, 4, v4
    v_add_u32 v4, 25088, v4
    v_lshrrev_b32 v5, 4, v1
    v_mul_u32_u24 v5, 7168, v5
    v_and_b32 v9, 15, v1
    v_lshl_add_u32 v5, v9, 3, v5
    v_and_b32 v6, 3, v1
    v_lshlrev_b32 v6, 15, v6
    s_lshl3_add_u32 s96, s75, s3
    s_mul_i32 s97, s96, 28672
    s_lshl_b32 s98, s74, 7
    s_add_u32 s99, s97, s98
    s_add_u32 s13, s99, 22020096
    s_lshr_b32 s96, s9, 2
    s_lshr_b32 s97, s3, 2
    s_lshl1_add_u32 s98, s75, s97
    s_and_b32 s99, s3, 3
    s_lshl_b32 s97, s99, 5
    s_add_u32 s99, s98, s97
    s_lshl_b32 s98, s99, 12
    s_lshl_b32 s97, s8, 6
    s_add_u32 s99, s98, s97
    s_lshl2_add_u32 s98, s96, s99
    s_add_u32 s97, s98, 1048576
    s_add_u32 s14, s97, 3072
    s_waitcnt lgkmcnt(0)
    s_barrier
    ds_read_b128 v[156:159], v4
    ds_read_b128 v[160:163], v4 offset:32
    ds_read_b128 v[164:167], v4 offset:64
    ds_read_b128 v[168:171], v4 offset:96
    s_waitcnt lgkmcnt(3)
    v_mfma_f32_32x32x16_bf16 v[172:187], v[156:159], v[108:111], 0
    s_waitcnt lgkmcnt(2)
    v_mfma_f32_32x32x16_bf16 v[172:187], v[160:163], v[112:115], v[172:187]
    s_waitcnt lgkmcnt(1)
    v_mfma_f32_32x32x16_bf16 v[172:187], v[164:167], v[116:119], v[172:187]
    s_waitcnt lgkmcnt(0)
    v_mfma_f32_32x32x16_bf16 v[172:187], v[168:171], v[120:123], v[172:187]
    s_nop 11
    v_mov_b32 v173, s4
    buffer_store_dwordx2 v[172:173], v5, s[32:35], s13 offen sc1
    s_mov_b64 exec, 15
    buffer_store_dword v173, v6, s[32:35], s14 offen sc1
    s_mov_b64 exec, -1
    s_cmp_ge_u32 s9, 16
    s_cbranch_scc1 L_FIN
SPOLL_51:
    s_load_dwordx8 s[24:31], s[32:33], s92 offset:3072 glc
SCHK_52:
    s_add_u32 s5, s5, 1
    s_cmp_ge_u32 s5, 200000
    s_waitcnt lgkmcnt(0)
    s_cbranch_scc1 SDONE_53
    s_cmp_lg_u32 s24, s4
    s_cbranch_scc1 SPOLL_51
    s_cmp_lg_u32 s25, s4
    s_cbranch_scc1 SPOLL_51
    s_cmp_lg_u32 s26, s4
    s_cbranch_scc1 SPOLL_51
    s_cmp_lg_u32 s27, s4
    s_cbranch_scc1 SPOLL_51
    s_cmp_lg_u32 s28, s4
    s_cbranch_scc1 SPOLL_51
    s_cmp_lg_u32 s29, s4
    s_cbranch_scc1 SPOLL_51
    s_cmp_lg_u32 s30, s4
    s_cbranch_scc1 SPOLL_51
SDONE_53:
    s_barrier
    s_cmp_lg_u32 s3, 7
    s_cbranch_scc1 L_FIN
    s_add_u32 s13, s20, 4096
POLL_54:
    buffer_load_dwordx4 v[156:159], v2, s[32:35], s20 offen sc1
    buffer_load_dwordx4 v[160:163], v2, s[32:35], s20 offen offset:1024 sc1
    buffer_load_dwordx4 v[164:167], v2, s[32:35], s20 offen offset:2048 sc1
    buffer_load_dwordx4 v[168:171], v2, s[32:35], s20 offen offset:3072 sc1
    buffer_load_dwordx4 v[188:191], v2, s[32:35], s13 offen sc1
    buffer_load_dwordx4 v[192:195], v2, s[32:35], s13 offen offset:1024 sc1
    buffer_load_dwordx4 v[196:199], v2, s[32:35], s13 offen offset:2048 sc1
    buffer_load_dwordx2 v[52:53], v11, s[32:35], s68 offen sc1
    s_waitcnt vmcnt(0)
    v_bitop3_b32 v4, v157, v159, s4 bitop3:0x7e
    v_bitop3_b32 v4, v4, v161, s4 bitop3:0xf6
    v_bitop3_b32 v4, v4, v163, s4 bitop3:0xf6
    v_bitop3_b32 v4, v4, v165, s4 bitop3:0xf6
    v_bitop3_b32 v4, v4, v167, s4 bitop3:0xf6
    v_bitop3_b32 v4, v4, v169, s4 bitop3:0xf6
    v_bitop3_b32 v4, v4, v171, s4 bitop3:0xf6
    v_bitop3_b32 v4, v4, v189, s4 bitop3:0xf6
    v_bitop3_b32 v4, v4, v191, s4 bitop3:0xf6
    v_bitop3_b32 v4, v4, v193, s4 bitop3:0xf6
    v_bitop3_b32 v4, v4, v195, s4 bitop3:0xf6
    v_bitop3_b32 v4, v4, v197, s4 bitop3:0xf6
    v_bitop3_b32 v4, v4, v199, s4 bitop3:0xf6
    v_bitop3_b32 v4, v4, v53, s4 bitop3:0xf6
    v_cmp_ne_u32 vcc, 0, v4
    s_cbranch_vccz PDONE_55
    s_add_u32 s5, s5, 1
    s_cmp_lt_u32 s5, 200000
    s_cbranch_scc1 POLL_54
PDONE_55:
    v_add_f32 v156, v156, v160
    v_add_f32 v158, v158, v162
    v_add_f32 v156, v156, v164
    v_add_f32 v158, v158, v166
    v_add_f32 v156, v156, v168
    v_add_f32 v158, v158, v170
    v_add_f32 v156, v156, v188
    v_add_f32 v158, v158, v190
    v_add_f32 v156, v156, v192
    v_add_f32 v158, v158, v194
    v_add_f32 v156, v156, v196
    v_add_f32 v158, v158, v198
    v_mov_b32 v157, v158
    v_add_f32_dpp v156, v156, v156 row_ror:8 row_mask:0xf bank_mask:0xf
    s_nop 0
    v_add_f32_dpp v157, v157, v157 row_ror:8 row_mask:0xf bank_mask:0xf
    v_mov_b32 v158, v156
    v_mov_b32 v159, v157
    s_nop 0
    v_permlane16_swap_b32 v156, v158
    v_permlane16_swap_b32 v157, v159
    v_pk_add_f32 v[156:157], v[156:157], v[158:159]
    v_mov_b32 v158, v156
    v_mov_b32 v159, v157
    s_nop 0
    v_permlane32_swap_b32 v156, v158
    v_permlane32_swap_b32 v157, v159
    v_pk_add_f32 v[156:157], v[156:157], v[158:159]
    v_cvt_pk_bf16_f32 v156, 0, v156
    v_cvt_pk_bf16_f32 v157, 0, v157
    v_pk_mul_f32 v[156:157], v[156:157], v[74:75] op_sel:[0,1]
    v_lshlrev_b32 v4, 16, v52
    v_and_b32 v5, s6, v52
    v_cvt_pk_bf16_f32 v156, 0, v156
    v_cvt_pk_bf16_f32 v157, 0, v157
    v_pk_add_f32 v[156:157], v[156:157], v[4:5]
    v_lshlrev_b32 v4, 16, v74
    v_and_b32 v5, s6, v74
    v_cvt_pk_bf16_f32 v156, 0, v156
    v_cvt_pk_bf16_f32 v157, 0, v157
    v_pk_mul_f32 v[156:157], v[156:157], v[4:5]
    v_lshlrev_b32 v4, 16, v73
    v_and_b32 v5, s6, v73
    v_cvt_pk_bf16_f32 v156, 0, v156
    v_cvt_pk_bf16_f32 v157, 0, v157
    v_pk_add_f32 v[156:157], v[156:157], v[4:5]
    v_cvt_pk_bf16_f32 v156, v156, v157
    s_mov_b64 exec, 0xff
    buffer_store_dword v156, v10, s[64:67], s82 offen sc1
    s_mov_b64 exec, -1
L_FIN:
L_END:
    s_endpgm
.p2align 10
.fill 768, 4, 0xbf800000
.section .rodata,"a"
.p2align 6
.amdhsa_kernel adaLN_cond__linear_kernel_hedgehog__moe_arch_mod__prompt_kernel
  .amdhsa_next_free_vgpr 256
  .amdhsa_next_free_sgpr 102
  .amdhsa_accum_offset 256
  .amdhsa_group_segment_fixed_size 0
  .amdhsa_kernarg_size 112
  .amdhsa_user_sgpr_count 2
  .amdhsa_user_sgpr_kernarg_segment_ptr 1
  .amdhsa_system_sgpr_workgroup_id_x 1
  .amdhsa_float_denorm_mode_32 3
  .amdhsa_float_denorm_mode_16_64 3
.end_amdhsa_kernel
```

```asm
; @launch grid=(256,1,1) block=(512,1,1) lds=163840
.amdgcn_target "amdgcn-amd-amdhsa--gfx950"
.text
.globl adaLN_cond__linear_kernel_hedgehog__moe_arch_mod__prompt_kernel
.p2align 8
.type adaLN_cond__linear_kernel_hedgehog__moe_arch_mod__prompt_kernel,@function
adaLN_cond__linear_kernel_hedgehog__moe_arch_mod__prompt_kernel:
    s_load_dwordx16 s[68:83], s[0:1], 0
    s_load_dwordx8 s[84:91], s[0:1], 64
    s_load_dwordx2 s[32:33], s[0:1], 104
    s_load_dwordx2 s[30:31], s[0:1], 96
    s_cmp_ge_u32 s2, 256
    s_cbranch_scc1 L_END
    v_lshrrev_b32 v4, 6, v0
    v_and_b32 v1, 63, v0
    v_mov_b32 v3, 0
    v_readfirstlane_b32 s3, v4
    v_lshlrev_b32 v2, 4, v1
    s_and_b32 s8, s2, 7
    s_lshr_b32 s9, s2, 3
    s_lshl2_add_u32 s96, s8, s3
    s_lshl_b32 s15, s96, 6
    s_mul_i32 s96, s15, 6144
    s_xor_b32 s97, s9, 1
    s_lshl_b32 s98, s97, 7
    s_add_u32 s13, s96, s98
    v_lshrrev_b32 v60, 3, v1
    v_mul_u32_u24 v60, 49152, v60
    v_and_b32 v9, 7, v1
    v_lshl_add_u32 v60, v9, 4, v60
    v_lshrrev_b32 v61, 3, v1
    v_lshl_add_u32 v61, v61, 3, s15
    s_lshl_b32 s96, s8, 5
    s_add_u32 s97, s96, s9
    s_lshl2_add_u32 s98, s97, s3
    s_sub_u32 s99, s98, 4
    s_lshl_b32 s16, s99, 12
    s_mov_b32 s50, 12582912
    s_mov_b32 s51, 0x20000
    s_mov_b32 s38, 4194304
    s_mov_b32 s39, 0x20000
    s_mov_b32 s34, 268435456
    s_mov_b32 s35, 0x20000
    s_getreg_b32 s94, hwreg(HW_REG_XCC_ID, 0, 3)
    s_getpc_b64 s[22:23]
    s_mul_i32 s96, s9, 7
    s_add_u32 s97, s96, s3
    s_lshl_b32 s19, s97, 7
    v_lshrrev_b32 v10, 5, v1
    v_mul_u32_u24 v10, 28672, v10
    v_add_u32 v10, s19, v10
    v_min_u32 v10, 39936, v10
    s_cmp_ge_u32 s3, 4
    s_waitcnt lgkmcnt(0)
    s_mov_b64 s[48:49], s[88:89]
    s_mov_b64 s[36:37], s[68:69]
    s_load_dword s4, s[32:33], 0
    s_cbranch_scc1 L_FS
    global_load_dwordx2 v[96:97], v61, s[86:87]
    buffer_load_dwordx4 v[80:83], v60, s[48:51], s13 offen nt
    s_add_u32 s13, s13, 12288
    buffer_load_dwordx4 v[84:87], v60, s[48:51], s13 offen nt
    s_add_u32 s13, s13, 12288
    buffer_load_dwordx4 v[88:91], v60, s[48:51], s13 offen nt
    s_add_u32 s13, s13, 12288
    buffer_load_dwordx4 v[92:95], v60, s[48:51], s13 offen nt
    s_barrier
    s_barrier
    s_and_b32 s22, s22, 0xfffffc00
    global_load_dword v78, v10, s[22:23]
    s_mov_b32 s42, 6291456
    s_mov_b32 s43, 0x20000
    s_mov_b32 s46, 2097152
    s_mov_b32 s47, 0x20000
    s_mov_b32 s54, 7340032
    s_mov_b32 s55, 0x20000
    s_mov_b32 s58, 7340032
    s_mov_b32 s59, 0x20000
    s_mov_b32 s62, 7340032
    s_mov_b32 s63, 0x20000
    s_mov_b32 s66, 4194304
    s_mov_b32 s67, 0x20000
    s_mov_b64 s[40:41], s[70:71]
    s_mov_b64 s[44:45], s[74:75]
    s_mov_b64 s[52:53], s[80:81]
    s_mov_b64 s[56:57], s[82:83]
    s_mov_b64 s[60:61], s[84:85]
    s_mov_b64 s[64:65], s[90:91]
    s_mov_b32 s5, 0
    s_mov_b32 s6, 0xffff0000
    s_mov_b32 s7, 0x3fb8aa3b
    s_lshr_b32 s76, s3, 2
    v_bfe_u32 v6, v1, 4, 1
    v_lshlrev_b32 v6, 6, v6
    v_and_b32 v62, 7, v1
    v_lshlrev_b32 v62, 4, v62
    v_xor_b32 v62, v62, v6
    v_lshrrev_b32 v6, 3, v1
    v_mul_u32_u24 v6, 6144, v6
    v_add_u32 v62, v62, v6
    v_lshlrev_b32 v63, 3, v1
    v_add_u32 v64, 147456, v2
    s_and_b32 s96, s3, 3
    s_lshl2_add_u32 s13, s96, 147456
    v_lshrrev_b32 v65, 4, v1
    v_lshl_add_u32 v65, v65, 5, s13
    v_and_b32 v9, 7, v1
    v_lshl_add_u32 v65, v9, 7, v65
    v_bfe_u32 v9, v1, 3, 1
    v_lshl_add_u32 v65, v9, 4, v65
    s_and_b32 s96, s8, 6
    s_and_b32 s97, s8, 1
    s_lshr_b32 s98, s9, 4
    s_lshl1_add_u32 s99, s97, s98
    s_lshl_b32 s97, s99, 6
    s_add_u32 s98, s96, s97
    s_lshl3_add_u32 s99, s3, s98
    s_lshl_b32 s96, s99, 10
    s_and_b32 s97, s9, 15
    s_lshl_b32 s98, s97, 6
    s_add_u32 s99, s96, s98
    s_add_u32 s14, s99, 262144
    s_xor_b32 s96, s9, 1
    s_and_b32 s97, s96, 15
    s_lshl4_add_u32 s98, s3, s97
    s_lshr_b32 s99, s9, 4
    s_lshl1_add_u32 s96, s98, s99
    s_lshl3_add_u32 s97, s96, s8
    s_lshl_b32 s98, s97, 9
    s_add_u32 s13, s98, 524288
    s_lshr_b32 s96, s9, 4
    s_xor_b32 s97, s9, 1
    s_and_b32 s98, s97, 7
    s_lshl_b32 s99, s3, 1
    s_lshl3_add_u32 s97, s98, s99
    s_bfe_u32 s98, s9, 65539
    s_add_u32 s99, s97, s98
    s_lshl_b32 s97, s99, 9
    s_lshl_b32 s98, s8, 6
    s_add_u32 s99, s97, s98
    s_lshl2_add_u32 s97, s96, s99
    s_add_u32 s15, s97, 2097152
    v_and_b32 v10, 3, v1
    v_lshlrev_b32 v10, 15, v10
    s_waitcnt vmcnt(5)
    v_lshlrev_b32 v98, 16, v97
    v_and_b32 v99, s6, v97
    v_and_b32 v97, s6, v96
    v_lshlrev_b32 v96, 16, v96
    v_mul_f32 v4, s7, v96
    v_exp_f32 v4, -v4
    s_nop 0
    v_add_f32 v4, 1.0, v4
    v_rcp_f32 v4, v4
    s_nop 0
    v_mul_f32 v96, v96, v4
    v_cvt_pk_bf16_f32 v96, 0, v96
    v_mul_f32 v5, s7, v97
    v_exp_f32 v5, -v5
    s_nop 0
    v_add_f32 v5, 1.0, v5
    v_rcp_f32 v5, v5
    s_nop 0
    v_mul_f32 v97, v97, v5
    v_cvt_pk_bf16_f32 v97, 0, v97
    v_mul_f32 v4, s7, v98
    v_exp_f32 v4, -v4
    s_nop 0
    v_add_f32 v4, 1.0, v4
    v_rcp_f32 v4, v4
    s_nop 0
    v_mul_f32 v98, v98, v4
    v_cvt_pk_bf16_f32 v98, 0, v98
    v_mul_f32 v5, s7, v99
    v_exp_f32 v5, -v5
    s_nop 0
    v_add_f32 v5, 1.0, v5
    v_rcp_f32 v5, v5
    s_nop 0
    v_mul_f32 v99, v99, v5
    v_cvt_pk_bf16_f32 v99, 0, v99
    s_waitcnt vmcnt(4)
    v_lshlrev_b32 v4, 16, v80
    v_and_b32 v5, s6, v80
    v_pk_mul_f32 v[20:21], v[4:5], v[96:97] op_sel:[0,0] op_sel_hi:[1,0]
    v_lshlrev_b32 v6, 16, v81
    v_and_b32 v7, s6, v81
    v_pk_mul_f32 v[22:23], v[6:7], v[96:97] op_sel:[0,0] op_sel_hi:[1,0]
    v_lshlrev_b32 v4, 16, v82
    v_and_b32 v5, s6, v82
    v_pk_mul_f32 v[24:25], v[4:5], v[96:97] op_sel:[0,0] op_sel_hi:[1,0]
    v_lshlrev_b32 v6, 16, v83
    v_and_b32 v7, s6, v83
    v_pk_mul_f32 v[26:27], v[6:7], v[96:97] op_sel:[0,0] op_sel_hi:[1,0]
    s_waitcnt vmcnt(3)
    v_lshlrev_b32 v4, 16, v84
    v_and_b32 v5, s6, v84
    v_pk_fma_f32 v[20:21], v[4:5], v[96:97], v[20:21] op_sel:[0,1,0] op_sel_hi:[1,1,1]
    v_lshlrev_b32 v6, 16, v85
    v_and_b32 v7, s6, v85
    v_pk_fma_f32 v[22:23], v[6:7], v[96:97], v[22:23] op_sel:[0,1,0] op_sel_hi:[1,1,1]
    v_lshlrev_b32 v4, 16, v86
    v_and_b32 v5, s6, v86
    v_pk_fma_f32 v[24:25], v[4:5], v[96:97], v[24:25] op_sel:[0,1,0] op_sel_hi:[1,1,1]
    v_lshlrev_b32 v6, 16, v87
    v_and_b32 v7, s6, v87
    v_pk_fma_f32 v[26:27], v[6:7], v[96:97], v[26:27] op_sel:[0,1,0] op_sel_hi:[1,1,1]
    s_waitcnt vmcnt(2)
    v_lshlrev_b32 v4, 16, v88
    v_and_b32 v5, s6, v88
    v_pk_fma_f32 v[20:21], v[4:5], v[98:99], v[20:21] op_sel:[0,0,0] op_sel_hi:[1,0,1]
    v_lshlrev_b32 v6, 16, v89
    v_and_b32 v7, s6, v89
    v_pk_fma_f32 v[22:23], v[6:7], v[98:99], v[22:23] op_sel:[0,0,0] op_sel_hi:[1,0,1]
    v_lshlrev_b32 v4, 16, v90
    v_and_b32 v5, s6, v90
    v_pk_fma_f32 v[24:25], v[4:5], v[98:99], v[24:25] op_sel:[0,0,0] op_sel_hi:[1,0,1]
    v_lshlrev_b32 v6, 16, v91
    v_and_b32 v7, s6, v91
    v_pk_fma_f32 v[26:27], v[6:7], v[98:99], v[26:27] op_sel:[0,0,0] op_sel_hi:[1,0,1]
    s_waitcnt vmcnt(1)
    v_lshlrev_b32 v4, 16, v92
    v_and_b32 v5, s6, v92
    v_pk_fma_f32 v[20:21], v[4:5], v[98:99], v[20:21] op_sel:[0,1,0] op_sel_hi:[1,1,1]
    v_lshlrev_b32 v6, 16, v93
    v_and_b32 v7, s6, v93
    v_pk_fma_f32 v[22:23], v[6:7], v[98:99], v[22:23] op_sel:[0,1,0] op_sel_hi:[1,1,1]
    v_lshlrev_b32 v4, 16, v94
    v_and_b32 v5, s6, v94
    v_pk_fma_f32 v[24:25], v[4:5], v[98:99], v[24:25] op_sel:[0,1,0] op_sel_hi:[1,1,1]
    v_lshlrev_b32 v6, 16, v95
    v_and_b32 v7, s6, v95
    v_pk_fma_f32 v[26:27], v[6:7], v[98:99], v[26:27] op_sel:[0,1,0] op_sel_hi:[1,1,1]
    v_permlane32_swap_b32 v20, v24
    v_permlane32_swap_b32 v21, v25
    v_permlane32_swap_b32 v22, v26
    v_permlane32_swap_b32 v23, v27
    v_add_f32 v20, v20, v24
    v_add_f32 v21, v21, v25
    v_add_f32 v22, v22, v26
    v_add_f32 v23, v23, v27
    s_nop 0
    v_permlane16_swap_b32 v20, v22
    v_permlane16_swap_b32 v21, v23
    v_add_f32 v20, v20, v22
    v_add_f32 v21, v21, v23
    s_nop 0
    v_add_f32_dpp v20, v20, v20 row_ror:8 row_mask:0xf bank_mask:0xf
    v_add_f32_dpp v21, v21, v21 row_ror:8 row_mask:0xf bank_mask:0xf
    s_nop 1
    v_mov_b32_dpp v20, v21 quad_perm:[0,1,2,3] row_mask:0xf bank_mask:0xc
    ds_write_b32 v65, v20
    s_waitcnt lgkmcnt(0)
    s_barrier
    ds_read_b128 v[20:23], v64 offset:0
    s_mul_i32 s4, s4, 0x9e3779b1
    s_add_u32 s4, s4, 0x7f4a7c15
    s_waitcnt lgkmcnt(0)
    v_pk_add_f32 v[20:21], v[20:21], v[22:23]
    v_add_f32 v20, v20, v21
    v_mov_b32 v21, s4
    buffer_store_dwordx2 v[20:21], v63, s[32:35], s13 offen sc1
    s_mov_b64 exec, 15
    buffer_store_dword v21, v10, s[32:35], s15 offen sc1
    s_mov_b64 exec, -1
    s_lshl2_add_u32 s96, s2, s3
    s_mul_i32 s13, s96, 6144
    s_branch L_FJ
L_FS:
    s_barrier
    buffer_load_dwordx4 v[80:83], v2, s[36:39], s16 offen
    buffer_load_dwordx4 v[84:87], v2, s[36:39], s16 offen offset:1024
    buffer_load_dwordx4 v[88:91], v2, s[36:39], s16 offen offset:2048
    buffer_load_dwordx4 v[92:95], v2, s[36:39], s16 offen offset:3072
    s_lshl2_add_u32 s96, s2, s3
    s_sub_u32 s97, s96, 4
    s_lshl_b32 s98, s97, 7
    s_add_u32 s17, s98, 2097152
    s_load_dword s24, s[32:33], s17 offset:0 glc
    s_load_dword s25, s[32:33], s17 offset:64 glc
    s_lshl_b32 s96, s2, 5
    s_add_u32 s97, s96, s3
    s_sub_u32 s98, s97, 4
    s_lshl_b32 s99, s98, 7
    s_add_u32 s17, s99, 1048576
    s_load_dword s24, s[32:33], s17 offset:0 glc
    s_load_dword s25, s[32:33], s17 offset:64 glc
    s_lshl_b32 s19, s94, 5
    v_mov_b32 v78, 1
    v_mov_b32 v79, s19
    s_barrier
    s_cmp_lg_u32 s3, 7
    s_cbranch_scc1 L_NOTK
    s_mov_b64 exec, 1
    global_atomic_add v78, v79, v78, s[30:31] sc0 sc1
    s_mov_b64 exec, -1
    s_branch L_TK0
L_NOTK:
    s_and_b32 s22, s22, 0xfffffc00
    global_load_dword v78, v10, s[22:23]
L_TK0:
    s_mov_b32 s42, 6291456
    s_mov_b32 s43, 0x20000
    s_mov_b32 s46, 2097152
    s_mov_b32 s47, 0x20000
    s_mov_b32 s54, 7340032
    s_mov_b32 s55, 0x20000
    s_mov_b32 s58, 7340032
    s_mov_b32 s59, 0x20000
    s_mov_b32 s62, 7340032
    s_mov_b32 s63, 0x20000
    s_mov_b32 s66, 4194304
    s_mov_b32 s67, 0x20000
    s_mov_b64 s[40:41], s[70:71]
    s_mov_b64 s[44:45], s[74:75]
    s_mov_b64 s[52:53], s[80:81]
    s_mov_b64 s[56:57], s[82:83]
    s_mov_b64 s[60:61], s[84:85]
    s_mov_b64 s[64:65], s[90:91]
    s_mov_b32 s5, 0
    s_mov_b32 s6, 0xffff0000
    s_mov_b32 s7, 0x3fb8aa3b
    s_lshr_b32 s76, s3, 2
    v_bfe_u32 v6, v1, 4, 1
    v_lshlrev_b32 v6, 6, v6
    v_and_b32 v62, 7, v1
    v_lshlrev_b32 v62, 4, v62
    v_xor_b32 v62, v62, v6
    v_lshrrev_b32 v6, 3, v1
    v_mul_u32_u24 v6, 6144, v6
    v_add_u32 v62, v62, v6
    v_lshlrev_b32 v63, 3, v1
    v_add_u32 v64, 147456, v2
    s_and_b32 s96, s3, 3
    s_lshl2_add_u32 s13, s96, 147456
    v_lshrrev_b32 v65, 4, v1
    v_lshl_add_u32 v65, v65, 5, s13
    v_and_b32 v9, 7, v1
    v_lshl_add_u32 v65, v9, 7, v65
    v_bfe_u32 v9, v1, 3, 1
    v_lshl_add_u32 v65, v9, 4, v65
    s_and_b32 s96, s8, 6
    s_and_b32 s97, s8, 1
    s_lshr_b32 s98, s9, 4
    s_lshl1_add_u32 s99, s97, s98
    s_lshl_b32 s97, s99, 6
    s_add_u32 s98, s96, s97
    s_lshl3_add_u32 s99, s3, s98
    s_lshl_b32 s96, s99, 10
    s_and_b32 s97, s9, 15
    s_lshl_b32 s98, s97, 6
    s_add_u32 s99, s96, s98
    s_add_u32 s14, s99, 262144
    s_sub_u32 s96, s3, 4
    s_lshl4_add_u32 s13, s96, 153600
    v_lshrrev_b32 v10, 5, v1
    v_lshl_add_u32 v10, v10, 3, s13
    s_barrier
    s_waitcnt vmcnt(1)
    s_waitcnt lgkmcnt(0)
    s_mul_i32 s4, s4, 0x9e3779b1
    s_add_u32 s4, s4, 0x7f4a7c15
    v_mov_b32 v104, 0x3f803f80
    v_dot2_f32_bf16 v100, v80, v104, 0
    v_dot2_f32_bf16 v102, v80, v80, 0
    v_dot2_f32_bf16 v101, v88, v104, 0
    v_dot2_f32_bf16 v103, v88, v88, 0
    v_dot2_f32_bf16 v100, v81, v104, v100
    v_dot2_f32_bf16 v102, v81, v81, v102
    v_dot2_f32_bf16 v101, v89, v104, v101
    v_dot2_f32_bf16 v103, v89, v89, v103
    v_dot2_f32_bf16 v100, v82, v104, v100
    v_dot2_f32_bf16 v102, v82, v82, v102
    v_dot2_f32_bf16 v101, v90, v104, v101
    v_dot2_f32_bf16 v103, v90, v90, v103
    v_dot2_f32_bf16 v100, v83, v104, v100
    v_dot2_f32_bf16 v102, v83, v83, v102
    v_dot2_f32_bf16 v101, v91, v104, v101
    v_dot2_f32_bf16 v103, v91, v91, v103
    v_dot2_f32_bf16 v100, v84, v104, v100
    v_dot2_f32_bf16 v102, v84, v84, v102
    v_dot2_f32_bf16 v101, v92, v104, v101
    v_dot2_f32_bf16 v103, v92, v92, v103
    v_dot2_f32_bf16 v100, v85, v104, v100
    v_dot2_f32_bf16 v102, v85, v85, v102
    v_dot2_f32_bf16 v101, v93, v104, v101
    v_dot2_f32_bf16 v103, v93, v93, v103
    v_dot2_f32_bf16 v100, v86, v104, v100
    v_dot2_f32_bf16 v102, v86, v86, v102
    v_dot2_f32_bf16 v101, v94, v104, v101
    v_dot2_f32_bf16 v103, v94, v94, v103
    v_dot2_f32_bf16 v100, v87, v104, v100
    v_dot2_f32_bf16 v102, v87, v87, v102
    v_dot2_f32_bf16 v101, v95, v104, v101
    v_dot2_f32_bf16 v103, v95, v95, v103
    s_nop 1
    v_permlane32_swap_b32 v100, v101
    v_permlane32_swap_b32 v102, v103
    v_add_f32 v100, v100, v101
    v_add_f32 v102, v102, v103
    s_nop 1
    v_permlane16_swap_b32 v100, v102
    v_add_f32 v100, v100, v102
    s_nop 1
    v_add_f32_dpp v100, v100, v100 quad_perm:[1,0,3,2] row_mask:0xf bank_mask:0xf
    s_nop 1
    v_add_f32_dpp v100, v100, v100 quad_perm:[2,3,0,1] row_mask:0xf bank_mask:0xf
    s_nop 1
    v_add_f32_dpp v100, v100, v100 row_half_mirror row_mask:0xf bank_mask:0xf
    s_nop 1
    v_add_f32_dpp v100, v100, v100 row_ror:8 row_mask:0xf bank_mask:0xf
    v_mul_f32 v102, 0x3a800000, v100
    v_mul_f32 v100, 0x3a800000, v100
    s_nop 1
    v_permlane16_swap_b32 v100, v102
    v_fma_f32 v117, -v100, v100, v102
    v_cvt_pk_bf16_f32 v116, 0, v100
    v_max_f32 v117, 0, v117
    v_cvt_pk_bf16_f32 v117, 0, v117
    v_add_f32 v117, 0x3727c5ac, v117
    v_cvt_pk_bf16_f32 v117, 0, v117
    v_sqrt_f32 v117, v117
    s_nop 0
    v_cvt_pk_bf16_f32 v117, 0, v117
    v_lshrrev_b32 v116, 16, v116
    v_or_b32 v116, v116, v117
    v_mov_b32 v117, s4
    ds_write_b64 v10, v[116:117]
L_FJ:
    v_and_b32 v5, 3, v1
    v_lshlrev_b32 v5, 4, v5
    v_add_u32 v5, 153600, v5
    v_and_b32 v4, 3, v1
    v_lshlrev_b32 v4, 4, v4
    v_bfe_u32 v9, v1, 2, 1
    v_lshl_add_u32 v4, v9, 10, v4
    v_and_b32 v10, 31, v1
    v_lshlrev_b32 v10, 11, v10
    v_lshrrev_b32 v9, 5, v1
    v_lshl_add_u32 v10, v9, 5, v10
    v_and_b32 v6, 1, v1
    v_lshlrev_b32 v6, 9, v6
    s_and_b32 s96, s9, 1
    s_and_b32 s97, s8, 6
    s_and_b32 s98, s8, 1
    s_lshr_b32 s99, s9, 4
    s_lshl1_add_u32 s98, s98, s99
    s_lshl_b32 s99, s98, 6
    s_add_u32 s98, s97, s99
    s_lshl3_add_u32 s97, s3, s98
    s_lshl_b32 s99, s97, 9
    s_bfe_u32 s98, s9, 196609
    s_lshl_b32 s97, s98, 6
    s_add_u32 s98, s99, s97
    s_lshl2_add_u32 s99, s96, s98
    s_add_u32 s97, s99, 8
    s_add_u32 s15, s97, 2097152
    s_waitcnt lgkmcnt(0)
    s_barrier
    ds_read_b128 v[116:119], v5
    s_waitcnt lgkmcnt(0)
    s_mov_b64 exec, 0xff
    buffer_store_dwordx4 v[116:119], v4, s[32:35], s14 offen sc1
    s_mov_b64 exec, 3
    buffer_store_dword v117, v6, s[32:35], s15 offen sc1
    s_mov_b64 exec, -1
    s_cmp_lg_u32 s3, 7
    s_cbranch_scc1 L_NOTK2
    s_mov_b32 s13, 0
    s_waitcnt vmcnt(2)
L_TK:
    v_readfirstlane_b32 s15, v78
    s_nop 0
    s_cmp_lt_u32 s15, 32
    s_cbranch_scc1 L_TKOK
    v_mov_b32 v78, s4
    s_mov_b64 exec, 1
    buffer_store_dword v78, v3, s[32:35], 0 offen offset:256 sc1
    s_mov_b64 exec, -1
    s_add_u32 s13, s13, 1
    s_cmp_lt_u32 s13, 8
    s_cbranch_scc0 L_TKNO
    s_add_u32 s94, s94, 1
    s_and_b32 s94, s94, 7
    s_lshl_b32 s19, s94, 5
    v_mov_b32 v78, 1
    v_mov_b32 v79, s19
    s_mov_b64 exec, 1
    global_atomic_add v78, v79, v78, s[30:31] sc0 sc1
    s_mov_b64 exec, -1
    s_waitcnt vmcnt(0)
    s_branch L_TK
L_TKNO:
    s_and_b32 s94, s2, 7
    s_lshr_b32 s15, s2, 3
L_TKOK:
    s_lshl3_add_u32 s15, s15, s94
    v_mov_b32 v78, s15
    ds_write_b32 v5, v78 offset:64
L_NOTK2:
    s_waitcnt lgkmcnt(0)
    s_barrier
    ds_read_b32 v120, v5 offset:64
    s_waitcnt lgkmcnt(0)
    v_readfirstlane_b32 s2, v120
    s_nop 0
    s_and_b32 s8, s2, 7
    s_lshr_b32 s9, s2, 3
    s_and_b32 s96, s8, 1
    s_and_b32 s97, s9, 7
    s_lshl3_add_u32 s12, s96, s97
    s_lshr_b32 s96, s8, 1
    s_lshr_b32 s97, s9, 3
    s_lshl2_add_u32 s21, s96, s97
    s_and_b32 s96, s3, 3
    s_lshl2_add_u32 s94, s21, s96
    s_lshl1_add_u32 s95, s12, s76
    s_lshl_b32 s96, s94, 16
    s_lshl_b32 s97, s95, 6
    s_add_u32 s18, s96, s97
    buffer_load_dwordx4 v[12:15], v10, s[36:39], s18 offen
    buffer_load_dwordx4 v[16:19], v10, s[36:39], s18 offen offset:16
    s_lshr_b32 s96, s8, 1
    s_lshl4_add_u32 s97, s96, s12
    s_lshl4_add_u32 s98, s97, s3
    s_lshl_b32 s99, s98, 9
    s_add_u32 s13, s99, 524288
    s_lshl3_add_u32 s96, s2, s3
    s_lshl_b32 s97, s96, 6
    s_add_u32 s15, s97, 2097152
    s_and_b32 s96, s3, 3
    s_lshl2_add_u32 s97, s2, s96
    s_lshl_b32 s98, s97, 8
    s_add_u32 s14, s98, 262144
    s_load_dwordx4 s[24:27], s[32:33], s15 offset:0 glc
    s_and_b32 s96, s8, 4
    s_lshr_b32 s97, s9, 2
    s_lshl1_add_u32 s10, s96, s97
    s_and_b32 s96, s8, 3
    s_and_b32 s97, s9, 3
    s_xor_b32 s98, s97, 2
    s_lshl2_add_u32 s11, s96, s98
    s_and_b32 s85, s9, 12
    s_lshl_b32 s96, s2, 6
    s_add_u32 s97, s96, s3
    s_lshl_b32 s98, s97, 6
    s_add_u32 s92, s98, 1048576
    s_lshr_b32 s96, s9, 4
    s_xor_b32 s77, s76, s96
    s_lshr_b32 s96, s9, 3
    s_xor_b32 s97, s96, s9
    s_and_b32 s98, s97, 1
    s_lshl_b32 s83, s98, 3
    s_mul_i32 s96, s8, 7
    s_lshr_b32 s97, s9, 2
    s_add_u32 s74, s96, s97
    s_and_b32 s75, s9, 3
    v_and_b32 v8, 31, v1
    v_lshlrev_b32 v8, 3, v8
    v_and_b32 v4, 31, v1
    v_lshlrev_b32 v4, 4, v4
    v_lshrrev_b32 v9, 5, v1
    v_lshl_add_u32 v4, v9, 12, v4
    s_lshl2_add_u32 s16, s3, 155648
    v_lshl_add_u32 v5, v1, 6, s16
    s_lshl_b32 s96, s76, 10
    s_add_u32 s16, s96, 155648
    v_and_b32 v6, 15, v1
    v_lshl_add_u32 v6, v6, 5, s16
    v_lshrrev_b32 v9, 5, v1
    v_lshl_add_u32 v6, v9, 9, v6
    s_branch SCHK_2
SPOLL_1:
    s_load_dwordx4 s[24:27], s[32:33], s15 offset:0 glc
SCHK_2:
    s_add_u32 s5, s5, 1
    s_cmp_ge_u32 s5, 300000
    s_waitcnt lgkmcnt(0)
    s_cbranch_scc1 SDONE_3
    s_cmp_lg_u32 s24, s4
    s_cbranch_scc1 SPOLL_1
    s_cmp_lg_u32 s25, s4
    s_cbranch_scc1 SPOLL_1
    s_cmp_lg_u32 s26, s4
    s_cbranch_scc1 SPOLL_1
    s_cmp_lg_u32 s27, s4
    s_cbranch_scc1 SPOLL_1
SDONE_3:
    s_barrier
    buffer_load_dwordx4 v[120:123], v4, s[32:35], s13 offen sc1
    buffer_load_dwordx2 v[116:117], v8, s[32:35], s14 offen sc1
    s_lshl_b32 s96, s11, 12
    s_lshl_b32 s97, s3, 9
    s_add_u32 s16, s96, s97
    v_add_u32 v10, s16, v2
    s_lshl_b32 s96, s3, 9
    s_add_u32 m0, s96, 159744
    s_mov_b32 exec_hi, 0
    global_load_lds_dwordx4 v10, s[72:73]
    s_mov_b32 exec_hi, -1
    s_lshr_b32 s96, s8, 2
    s_lshr_b32 s97, s9, 4
    s_lshl1_add_u32 s20, s96, s97
    s_add_u32 s96, s20, s85
    s_and_b32 s97, s96, 15
    s_lshl3_add_u32 s98, s97, s3
    s_mul_i32 s99, s98, 49152
    s_lshl_b32 s96, s11, 7
    s_add_u32 s82, s99, s96
    s_mul_i32 s96, s20, 24576
    s_lshl_b32 s97, s3, 10
    s_add_u32 s20, s96, s97
    s_mov_b32 m0, s20
    s_nop 0
    buffer_load_dwordx4 v62, s[40:43], s82 offen lds
    s_add_u32 s82, s82, 2048
    s_add_u32 m0, s20, 8192
    s_nop 0
    buffer_load_dwordx4 v62, s[40:43], s82 offen lds
    s_add_u32 s82, s82, 2048
    s_add_u32 m0, s20, 16384
    s_nop 0
    buffer_load_dwordx4 v62, s[40:43], s82 offen lds
    s_waitcnt vmcnt(5)
    v_bitop3_b32 v7, v121, v123, s4 bitop3:0x7e
    v_cmp_ne_u32 vcc, 0, v7
    s_cbranch_vccz TOK_5
POLL_6:
    buffer_load_dwordx4 v[120:123], v4, s[32:35], s13 offen sc1
    s_waitcnt vmcnt(0)
    v_bitop3_b32 v7, v121, v123, s4 bitop3:0x7e
    v_cmp_ne_u32 vcc, 0, v7
    s_cbranch_vccz PDONE_7
    s_add_u32 s5, s5, 1
    s_cmp_lt_u32 s5, 300000
    s_cbranch_scc1 POLL_6
PDONE_7:
TOK_5:
    ds_write2_b32 v5, v120, v122 offset0:0 offset1:8
    v_lshlrev_b32 v100, 16, v12
    v_and_b32 v101, s6, v12
    v_lshlrev_b32 v102, 16, v13
    v_and_b32 v103, s6, v13
    v_lshlrev_b32 v104, 16, v14
    v_and_b32 v105, s6, v14
    v_lshlrev_b32 v106, 16, v15
    v_and_b32 v107, s6, v15
    v_lshlrev_b32 v108, 16, v16
    v_and_b32 v109, s6, v16
    v_lshlrev_b32 v110, 16, v17
    v_and_b32 v111, s6, v17
    v_lshlrev_b32 v112, 16, v18
    v_and_b32 v113, s6, v18
    v_lshlrev_b32 v114, 16, v19
    v_and_b32 v115, s6, v19
    s_waitcnt lgkmcnt(0)
    s_barrier
    ds_read_b128 v[88:91], v6 offset:2048
    ds_read_b128 v[92:95], v6 offset:2064
    ds_read_b128 v[80:83], v6
    ds_read_b128 v[84:87], v6 offset:16
    s_waitcnt vmcnt(4)
    v_cmp_ne_u32 vcc, s4, v117
    s_cbranch_vccz TOK_8
POLL_9:
    buffer_load_dwordx2 v[116:117], v8, s[32:35], s14 offen sc1
    s_waitcnt vmcnt(0)
    v_cmp_ne_u32 vcc, s4, v117
    s_cbranch_vccz PDONE_10
    s_add_u32 s5, s5, 1
    s_cmp_lt_u32 s5, 300000
    s_cbranch_scc1 POLL_9
PDONE_10:
TOK_8:
    v_lshlrev_b32 v117, 16, v116
    v_and_b32 v116, s6, v116
    v_rcp_f32 v116, v116
    s_nop 0
    v_pk_add_f32 v[100:101], v[100:101], v[116:117] op_sel:[0,1] neg_lo:[0,1] neg_hi:[0,1]
    v_pk_add_f32 v[102:103], v[102:103], v[116:117] op_sel:[0,1] neg_lo:[0,1] neg_hi:[0,1]
    v_pk_add_f32 v[104:105], v[104:105], v[116:117] op_sel:[0,1] neg_lo:[0,1] neg_hi:[0,1]
    v_pk_add_f32 v[106:107], v[106:107], v[116:117] op_sel:[0,1] neg_lo:[0,1] neg_hi:[0,1]
    v_pk_add_f32 v[108:109], v[108:109], v[116:117] op_sel:[0,1] neg_lo:[0,1] neg_hi:[0,1]
    v_pk_add_f32 v[110:111], v[110:111], v[116:117] op_sel:[0,1] neg_lo:[0,1] neg_hi:[0,1]
    v_pk_add_f32 v[112:113], v[112:113], v[116:117] op_sel:[0,1] neg_lo:[0,1] neg_hi:[0,1]
    v_pk_add_f32 v[114:115], v[114:115], v[116:117] op_sel:[0,1] neg_lo:[0,1] neg_hi:[0,1]
    s_lshl4_add_u32 s96, s21, s12
    s_and_b32 s97, s3, 3
    s_lshl2_add_u32 s98, s96, s97
    s_lshl1_add_u32 s99, s98, s76
    s_lshl_b32 s96, s99, 11
    s_add_u32 s13, s96, 4194304
    s_waitcnt lgkmcnt(2)
    v_pk_add_f32 v[88:89], v[88:89], v[90:91]
    v_pk_add_f32 v[92:93], v[92:93], v[94:95]
    v_pk_add_f32 v[88:89], v[88:89], v[92:93]
    v_add_f32 v88, v88, v89
    v_cvt_pk_bf16_f32 v88, 0, v88
    s_waitcnt lgkmcnt(0)
    v_pk_add_f32 v[80:81], v[80:81], v[82:83]
    v_pk_add_f32 v[84:85], v[84:85], v[86:87]
    v_pk_add_f32 v[80:81], v[80:81], v[84:85]
    v_add_f32 v80, v80, v81
    v_add_f32 v88, 1.0, v88
    v_cvt_pk_bf16_f32 v88, 0, v88
    v_cvt_pk_bf16_f32 v80, 0, v80
    v_cvt_pk_bf16_f32 v100, 0, v100
    v_cvt_pk_bf16_f32 v101, 0, v101
    v_cvt_pk_bf16_f32 v102, 0, v102
    v_cvt_pk_bf16_f32 v103, 0, v103
    v_cvt_pk_bf16_f32 v104, 0, v104
    v_cvt_pk_bf16_f32 v105, 0, v105
    v_cvt_pk_bf16_f32 v106, 0, v106
    v_cvt_pk_bf16_f32 v107, 0, v107
    v_pk_mul_f32 v[100:101], v[100:101], v[116:117] op_sel_hi:[1,0]
    v_pk_mul_f32 v[102:103], v[102:103], v[116:117] op_sel_hi:[1,0]
    v_pk_mul_f32 v[104:105], v[104:105], v[116:117] op_sel_hi:[1,0]
    v_pk_mul_f32 v[106:107], v[106:107], v[116:117] op_sel_hi:[1,0]
    v_cvt_pk_bf16_f32 v100, 0, v100
    v_cvt_pk_bf16_f32 v101, 0, v101
    v_cvt_pk_bf16_f32 v102, 0, v102
    v_cvt_pk_bf16_f32 v103, 0, v103
    v_cvt_pk_bf16_f32 v104, 0, v104
    v_cvt_pk_bf16_f32 v105, 0, v105
    v_cvt_pk_bf16_f32 v106, 0, v106
    v_cvt_pk_bf16_f32 v107, 0, v107
    v_mul_f32_dpp v100, v88, v100 row_newbcast:0 row_mask:0xf bank_mask:0xf
    v_mul_f32_dpp v101, v88, v101 row_newbcast:1 row_mask:0xf bank_mask:0xf
    v_mul_f32_dpp v102, v88, v102 row_newbcast:2 row_mask:0xf bank_mask:0xf
    v_mul_f32_dpp v103, v88, v103 row_newbcast:3 row_mask:0xf bank_mask:0xf
    v_mul_f32_dpp v104, v88, v104 row_newbcast:4 row_mask:0xf bank_mask:0xf
    v_mul_f32_dpp v105, v88, v105 row_newbcast:5 row_mask:0xf bank_mask:0xf
    v_mul_f32_dpp v106, v88, v106 row_newbcast:6 row_mask:0xf bank_mask:0xf
    v_mul_f32_dpp v107, v88, v107 row_newbcast:7 row_mask:0xf bank_mask:0xf
    v_cvt_pk_bf16_f32 v100, 0, v100
    v_cvt_pk_bf16_f32 v101, 0, v101
    v_cvt_pk_bf16_f32 v102, 0, v102
    v_cvt_pk_bf16_f32 v103, 0, v103
    v_cvt_pk_bf16_f32 v104, 0, v104
    v_cvt_pk_bf16_f32 v105, 0, v105
    v_cvt_pk_bf16_f32 v106, 0, v106
    v_cvt_pk_bf16_f32 v107, 0, v107
    v_add_f32_dpp v100, v80, v100 row_newbcast:0 row_mask:0xf bank_mask:0xf
    v_add_f32_dpp v101, v80, v101 row_newbcast:1 row_mask:0xf bank_mask:0xf
    v_add_f32_dpp v102, v80, v102 row_newbcast:2 row_mask:0xf bank_mask:0xf
    v_add_f32_dpp v103, v80, v103 row_newbcast:3 row_mask:0xf bank_mask:0xf
    v_add_f32_dpp v104, v80, v104 row_newbcast:4 row_mask:0xf bank_mask:0xf
    v_add_f32_dpp v105, v80, v105 row_newbcast:5 row_mask:0xf bank_mask:0xf
    v_add_f32_dpp v106, v80, v106 row_newbcast:6 row_mask:0xf bank_mask:0xf
    v_add_f32_dpp v107, v80, v107 row_newbcast:7 row_mask:0xf bank_mask:0xf
    v_cvt_pk_bf16_f32 v124, v100, v101
    v_cvt_pk_bf16_f32 v125, v102, v103
    v_cvt_pk_bf16_f32 v126, v104, v105
    v_cvt_pk_bf16_f32 v127, v106, v107
    buffer_store_dwordx4 v[124:127], v2, s[32:35], s13 offen sc1
    v_cvt_pk_bf16_f32 v108, 0, v108
    v_cvt_pk_bf16_f32 v109, 0, v109
    v_cvt_pk_bf16_f32 v110, 0, v110
    v_cvt_pk_bf16_f32 v111, 0, v111
    v_cvt_pk_bf16_f32 v112, 0, v112
    v_cvt_pk_bf16_f32 v113, 0, v113
    v_cvt_pk_bf16_f32 v114, 0, v114
    v_cvt_pk_bf16_f32 v115, 0, v115
    v_pk_mul_f32 v[108:109], v[108:109], v[116:117] op_sel_hi:[1,0]
    v_pk_mul_f32 v[110:111], v[110:111], v[116:117] op_sel_hi:[1,0]
    v_pk_mul_f32 v[112:113], v[112:113], v[116:117] op_sel_hi:[1,0]
    v_pk_mul_f32 v[114:115], v[114:115], v[116:117] op_sel_hi:[1,0]
    v_cvt_pk_bf16_f32 v108, 0, v108
    v_cvt_pk_bf16_f32 v109, 0, v109
    v_cvt_pk_bf16_f32 v110, 0, v110
    v_cvt_pk_bf16_f32 v111, 0, v111
    v_cvt_pk_bf16_f32 v112, 0, v112
    v_cvt_pk_bf16_f32 v113, 0, v113
    v_cvt_pk_bf16_f32 v114, 0, v114
    v_cvt_pk_bf16_f32 v115, 0, v115
    v_mul_f32_dpp v108, v88, v108 row_newbcast:8 row_mask:0xf bank_mask:0xf
    v_mul_f32_dpp v109, v88, v109 row_newbcast:9 row_mask:0xf bank_mask:0xf
    v_mul_f32_dpp v110, v88, v110 row_newbcast:10 row_mask:0xf bank_mask:0xf
    v_mul_f32_dpp v111, v88, v111 row_newbcast:11 row_mask:0xf bank_mask:0xf
    v_mul_f32_dpp v112, v88, v112 row_newbcast:12 row_mask:0xf bank_mask:0xf
    v_mul_f32_dpp v113, v88, v113 row_newbcast:13 row_mask:0xf bank_mask:0xf
    v_mul_f32_dpp v114, v88, v114 row_newbcast:14 row_mask:0xf bank_mask:0xf
    v_mul_f32_dpp v115, v88, v115 row_newbcast:15 row_mask:0xf bank_mask:0xf
    v_cvt_pk_bf16_f32 v108, 0, v108
    v_cvt_pk_bf16_f32 v109, 0, v109
    v_cvt_pk_bf16_f32 v110, 0, v110
    v_cvt_pk_bf16_f32 v111, 0, v111
    v_cvt_pk_bf16_f32 v112, 0, v112
    v_cvt_pk_bf16_f32 v113, 0, v113
    v_cvt_pk_bf16_f32 v114, 0, v114
    v_cvt_pk_bf16_f32 v115, 0, v115
    v_add_f32_dpp v108, v80, v108 row_newbcast:8 row_mask:0xf bank_mask:0xf
    v_add_f32_dpp v109, v80, v109 row_newbcast:9 row_mask:0xf bank_mask:0xf
    v_add_f32_dpp v110, v80, v110 row_newbcast:10 row_mask:0xf bank_mask:0xf
    v_add_f32_dpp v111, v80, v111 row_newbcast:11 row_mask:0xf bank_mask:0xf
    v_add_f32_dpp v112, v80, v112 row_newbcast:12 row_mask:0xf bank_mask:0xf
    v_add_f32_dpp v113, v80, v113 row_newbcast:13 row_mask:0xf bank_mask:0xf
    v_add_f32_dpp v114, v80, v114 row_newbcast:14 row_mask:0xf bank_mask:0xf
    v_add_f32_dpp v115, v80, v115 row_newbcast:15 row_mask:0xf bank_mask:0xf
    v_cvt_pk_bf16_f32 v128, v108, v109
    v_cvt_pk_bf16_f32 v129, v110, v111
    v_cvt_pk_bf16_f32 v130, v112, v113
    v_cvt_pk_bf16_f32 v131, v114, v115
    buffer_store_dwordx4 v[128:131], v2, s[32:35], s13 offen offset:1024 sc1
    v_bfe_u32 v66, v1, 2, 2
    v_lshlrev_b32 v66, 7, v66
    v_bfe_u32 v9, v1, 3, 1
    v_lshl_add_u32 v66, v9, 6, v66
    v_bfe_u32 v9, v1, 4, 1
    v_lshl_add_u32 v66, v9, 5, v66
    v_and_b32 v9, 3, v1
    v_lshl_add_u32 v66, v9, 3, v66
    v_lshrrev_b32 v9, 5, v1
    v_lshl_add_u32 v66, v9, 11, v66
    v_xor_b32 v67, 64, v66
    v_add_u32 v68, 49152, v66
    v_add_u32 v69, 49152, v67
    v_add_u32 v70, 98304, v66
    v_add_u32 v71, 98304, v67
    s_lshl_b32 s96, s76, 11
    s_add_u32 s14, s96, 159744
    v_bfe_u32 v4, v1, 2, 2
    v_lshl_add_u32 v4, v4, 6, s14
    v_bfe_u32 v9, v1, 4, 1
    v_lshl_add_u32 v4, v9, 5, v4
    v_and_b32 v9, 3, v1
    v_lshl_add_u32 v4, v9, 3, v4
    v_lshrrev_b32 v9, 5, v1
    v_lshl_add_u32 v4, v9, 8, v4
    v_and_b32 v5, 3, v1
    v_lshlrev_b32 v5, 15, v5
    v_bfe_u32 v9, v1, 2, 2
    v_lshl_add_u32 v5, v9, 12, v5
    s_and_b32 s96, s12, 1
    s_lshr_b32 s97, s21, 3
    s_and_b32 s98, s21, 7
    s_lshl_b32 s99, s98, 5
    s_lshl2_add_u32 s98, s97, s99
    s_lshl_b32 s97, s98, 12
    s_lshr_b32 s99, s12, 1
    s_lshl_b32 s98, s99, 6
    s_add_u32 s99, s97, s98
    s_lshl2_add_u32 s97, s96, s99
    s_add_u32 s13, s97, 1048576
    v_bfe_u32 v6, v1, 4, 1
    v_lshlrev_b32 v6, 6, v6
    v_and_b32 v74, 7, v1
    v_lshlrev_b32 v74, 4, v74
    v_xor_b32 v74, v74, v6
    v_lshrrev_b32 v6, 3, v1
    v_lshlrev_b32 v6, 11, v6
    v_add_u32 v74, v74, v6
    s_and_b32 s96, s3, 2
    s_lshl_b32 s14, s96, 5
    v_bfe_u32 v6, v1, 4, 1
    v_lshl_add_u32 v6, v6, 5, s14
    v_and_b32 v72, 7, v1
    v_lshlrev_b32 v72, 4, v72
    v_xor_b32 v72, v72, v6
    v_lshrrev_b32 v6, 3, v1
    v_mul_u32_u24 v6, 7168, v6
    v_add_u32 v72, v72, v6
    s_and_b32 s96, s3, 1
    s_lshl_b32 s14, s96, 7
    v_lshrrev_b32 v6, 5, v1
    v_lshl_add_u32 v6, v6, 6, s14
    v_and_b32 v73, 31, v1
    v_lshlrev_b32 v73, 4, v73
    v_lshrrev_b32 v9, 5, v1
    v_lshl_add_u32 v73, v9, 11, v73
    v_xor_b32 v73, v73, v6
    s_lshl3_add_u32 s96, s75, s3
    s_mul_i32 s97, s96, 229376
    s_lshl_b32 s98, s74, 7
    s_add_u32 s80, s97, s98
    s_lshl3_add_u32 s96, s74, s3
    s_lshl_b32 s97, s96, 14
    s_lshl_b32 s98, s75, 9
    s_add_u32 s81, s97, s98
    s_cmp_ge_u32 s9, 28
    s_cselect_b32 s54, 0, s54
    s_cselect_b32 s58, 0, s58
    s_cselect_b32 s62, 0, s62
    s_waitcnt vmcnt(0)
    s_barrier
    s_cmp_lg_u32 s3, 0
    s_cbranch_scc1 L_PB
    v_mov_b32 v6, s4
    s_mov_b32 exec_hi, 0
    s_mov_b32 exec_lo, 65535
    buffer_store_dword v6, v5, s[32:35], s13 offen sc1
    s_mov_b64 exec, -1
L_PB:
    s_lshr_b32 s96, s8, 2
    s_lshr_b32 s97, s9, 4
    s_lshl1_add_u32 s20, s96, s97
    s_cmp_le_u32 s20, 0
    s_cselect_b32 s20, 1, 0
    s_add_u32 s96, s20, s85
    s_and_b32 s97, s96, 15
    s_lshl3_add_u32 s98, s97, s3
    s_mul_i32 s99, s98, 49152
    s_lshl_b32 s96, s11, 7
    s_add_u32 s82, s99, s96
    s_mul_i32 s96, s20, 24576
    s_lshl_b32 s97, s3, 10
    s_add_u32 s20, s96, s97
    s_mov_b32 m0, s20
    s_nop 0
    buffer_load_dwordx4 v62, s[40:43], s82 offen lds
    s_add_u32 s82, s82, 2048
    s_add_u32 m0, s20, 8192
    s_nop 0
    buffer_load_dwordx4 v62, s[40:43], s82 offen lds
    s_add_u32 s82, s82, 2048
    s_add_u32 m0, s20, 16384
    s_nop 0
    buffer_load_dwordx4 v62, s[40:43], s82 offen lds
    ds_read_b64_tr_b16 v[28:29], v4
    ds_read_b64_tr_b16 v[30:31], v4 offset:512
    ds_read_b64_tr_b16 v[32:33], v4 offset:1024
    ds_read_b64_tr_b16 v[34:35], v4 offset:1536
    s_lshl_b32 s96, s10, 6
    s_add_u32 s97, s96, s3
    s_lshl_b32 s98, s97, 12
    s_add_u32 s15, s98, 4194304
    s_and_b32 s96, s3, 3
    s_lshl_b32 s97, s96, 12
    s_add_u32 s13, s97, 147456
    v_add_u32 v76, s13, v2
    s_and_b32 s96, s3, 3
    s_lshl_b32 s97, s96, 10
    s_lshl_b32 s98, s76, 14
    s_add_u32 s13, s97, s98
    v_and_b32 v75, 31, v1
    v_lshl_add_u32 v75, v75, 5, s13
    v_lshrrev_b32 v9, 5, v1
    v_lshl_add_u32 v75, v9, 4, v75
    s_lshl2_add_u32 s96, s83, s3
    s_lshl_b32 s84, s96, 14
    s_lshr_b32 s96, s9, 4
    s_lshl_b32 s97, s96, 20
    s_lshl_b32 s98, s12, 7
    s_add_u32 s88, s97, s98
    s_lshl_b32 s89, s3, 10
    s_load_dwordx2 s[24:25], s[32:33], s92 offset:0 glc
    s_lshr_b32 s96, s8, 2
    s_lshr_b32 s97, s9, 4
    s_lshl1_add_u32 s20, s96, s97
    s_cmp_le_u32 s20, 1
    s_cselect_b32 s20, 2, 1
    s_add_u32 s96, s20, s85
    s_and_b32 s97, s96, 15
    s_lshl3_add_u32 s98, s97, s3
    s_mul_i32 s99, s98, 49152
    s_lshl_b32 s96, s11, 7
    s_add_u32 s82, s99, s96
    s_mul_i32 s96, s20, 24576
    s_lshl_b32 s97, s3, 10
    s_add_u32 s20, s96, s97
    s_mov_b32 m0, s20
    s_nop 0
    buffer_load_dwordx4 v62, s[40:43], s82 offen lds
    s_add_u32 s82, s82, 2048
    s_add_u32 m0, s20, 8192
    s_nop 0
    buffer_load_dwordx4 v62, s[40:43], s82 offen lds
    s_add_u32 s82, s82, 2048
    s_add_u32 m0, s20, 16384
    s_nop 0
    buffer_load_dwordx4 v62, s[40:43], s82 offen lds
    s_branch SCHK_12
SPOLL_11:
    s_load_dwordx2 s[24:25], s[32:33], s92 offset:0 glc
SCHK_12:
    s_add_u32 s5, s5, 1
    s_cmp_ge_u32 s5, 300000
    s_waitcnt lgkmcnt(0)
    s_cbranch_scc1 SDONE_13
    s_cmp_lg_u32 s24, s4
    s_cbranch_scc1 SPOLL_11
    s_cmp_lg_u32 s25, s4
    s_cbranch_scc1 SPOLL_11
SDONE_13:
    s_waitcnt vmcnt(3)
    s_barrier
    s_cmp_ge_u32 s3, 4
    s_cbranch_scc1 L_HELP
    s_setprio 2
    s_and_b32 s96, s85, 15
    s_lshl_b32 s97, s96, 14
    s_add_u32 s16, s97, s15
    buffer_load_dwordx4 v[176:179], v2, s[32:35], s16 offen sc1
    ds_read_b64_tr_b16 v[224:225], v66 offset:8192
    ds_read_b64_tr_b16 v[226:227], v66 offset:8704
    ds_read_b64_tr_b16 v[228:229], v67 offset:8192
    ds_read_b64_tr_b16 v[230:231], v67 offset:8704
    ds_read_b64_tr_b16 v[232:233], v66
    ds_read_b64_tr_b16 v[234:235], v66 offset:512
    ds_read_b64_tr_b16 v[236:237], v67
    ds_read_b64_tr_b16 v[238:239], v67 offset:512
    ds_read_b64_tr_b16 v[240:241], v66 offset:16384
    ds_read_b64_tr_b16 v[242:243], v66 offset:16896
    ds_read_b64_tr_b16 v[244:245], v67 offset:16384
    ds_read_b64_tr_b16 v[246:247], v67 offset:16896
    buffer_load_dwordx4 v[180:183], v2, s[32:35], s16 offen offset:1024 sc1
    buffer_load_dwordx4 v[184:187], v2, s[32:35], s16 offen offset:2048 sc1
    buffer_load_dwordx4 v[188:191], v2, s[32:35], s16 offen offset:3072 sc1
    s_waitcnt vmcnt(3)
    s_waitcnt lgkmcnt(10)
    v_mfma_f32_32x32x16_bf16 v[112:127], v[224:227], v[176:179], 0
    ds_read_b64_tr_b16 v[248:249], v66 offset:9216
    ds_read_b64_tr_b16 v[250:251], v66 offset:9728
    s_waitcnt lgkmcnt(10)
    v_mfma_f32_32x32x16_bf16 v[128:143], v[228:231], v[176:179], 0
    ds_read_b64_tr_b16 v[224:225], v67 offset:9216
    ds_read_b64_tr_b16 v[226:227], v67 offset:9728
    s_waitcnt lgkmcnt(10)
    v_mfma_f32_32x32x16_bf16 v[80:95], v[232:235], v[176:179], 0
    ds_read_b64_tr_b16 v[228:229], v66 offset:1024
    ds_read_b64_tr_b16 v[230:231], v66 offset:1536
    s_waitcnt lgkmcnt(10)
    v_mfma_f32_32x32x16_bf16 v[96:111], v[236:239], v[176:179], 0
    ds_read_b64_tr_b16 v[232:233], v67 offset:1024
    ds_read_b64_tr_b16 v[234:235], v67 offset:1536
    s_waitcnt lgkmcnt(10)
    v_mfma_f32_32x32x16_bf16 v[144:159], v[240:243], v[176:179], 0
    ds_read_b64_tr_b16 v[236:237], v66 offset:17408
    ds_read_b64_tr_b16 v[238:239], v66 offset:17920
    s_waitcnt lgkmcnt(10)
    v_mfma_f32_32x32x16_bf16 v[160:175], v[244:247], v[176:179], 0
    ds_read_b64_tr_b16 v[240:241], v67 offset:17408
    ds_read_b64_tr_b16 v[242:243], v67 offset:17920
    s_add_u32 s96, s85, 1
    s_and_b32 s97, s96, 15
    s_lshl_b32 s98, s97, 14
    s_add_u32 s16, s98, s15
    buffer_load_dwordx4 v[192:195], v2, s[32:35], s16 offen sc1
    buffer_load_dwordx4 v[196:199], v2, s[32:35], s16 offen offset:1024 sc1
    s_waitcnt vmcnt(4)
    s_waitcnt lgkmcnt(10)
    v_mfma_f32_32x32x16_bf16 v[112:127], v[248:251], v[180:183], v[112:127]
    ds_read_b64_tr_b16 v[244:245], v66 offset:12288
    ds_read_b64_tr_b16 v[246:247], v66 offset:12800
    s_waitcnt lgkmcnt(10)
    v_mfma_f32_32x32x16_bf16 v[128:143], v[224:227], v[180:183], v[128:143]
    ds_read_b64_tr_b16 v[248:249], v67 offset:12288
    ds_read_b64_tr_b16 v[250:251], v67 offset:12800
    s_waitcnt lgkmcnt(10)
    v_mfma_f32_32x32x16_bf16 v[80:95], v[228:231], v[180:183], v[80:95]
    ds_read_b64_tr_b16 v[224:225], v66 offset:4096
    ds_read_b64_tr_b16 v[226:227], v66 offset:4608
    s_waitcnt lgkmcnt(10)
    v_mfma_f32_32x32x16_bf16 v[96:111], v[232:235], v[180:183], v[96:111]
    ds_read_b64_tr_b16 v[228:229], v67 offset:4096
    ds_read_b64_tr_b16 v[230:231], v67 offset:4608
    s_waitcnt lgkmcnt(10)
    v_mfma_f32_32x32x16_bf16 v[144:159], v[236:239], v[180:183], v[144:159]
    ds_read_b64_tr_b16 v[232:233], v66 offset:20480
    ds_read_b64_tr_b16 v[234:235], v66 offset:20992
    s_waitcnt lgkmcnt(10)
    v_mfma_f32_32x32x16_bf16 v[160:175], v[240:243], v[180:183], v[160:175]
    ds_read_b64_tr_b16 v[236:237], v67 offset:20480
    ds_read_b64_tr_b16 v[238:239], v67 offset:20992
    buffer_load_dwordx4 v[200:203], v2, s[32:35], s16 offen offset:2048 sc1
    buffer_load_dwordx4 v[204:207], v2, s[32:35], s16 offen offset:3072 sc1
    s_waitcnt vmcnt(5)
    s_waitcnt lgkmcnt(10)
    v_mfma_f32_32x32x16_bf16 v[112:127], v[244:247], v[184:187], v[112:127]
    ds_read_b64_tr_b16 v[240:241], v66 offset:13312
    ds_read_b64_tr_b16 v[242:243], v66 offset:13824
    s_waitcnt lgkmcnt(10)
    v_mfma_f32_32x32x16_bf16 v[128:143], v[248:251], v[184:187], v[128:143]
    ds_read_b64_tr_b16 v[244:245], v67 offset:13312
    ds_read_b64_tr_b16 v[246:247], v67 offset:13824
    s_waitcnt lgkmcnt(10)
    v_mfma_f32_32x32x16_bf16 v[80:95], v[224:227], v[184:187], v[80:95]
    ds_read_b64_tr_b16 v[248:249], v66 offset:5120
    ds_read_b64_tr_b16 v[250:251], v66 offset:5632
    s_waitcnt lgkmcnt(10)
    v_mfma_f32_32x32x16_bf16 v[96:111], v[228:231], v[184:187], v[96:111]
    ds_read_b64_tr_b16 v[224:225], v67 offset:5120
    ds_read_b64_tr_b16 v[226:227], v67 offset:5632
    s_waitcnt lgkmcnt(10)
    v_mfma_f32_32x32x16_bf16 v[144:159], v[232:235], v[184:187], v[144:159]
    ds_read_b64_tr_b16 v[228:229], v66 offset:21504
    ds_read_b64_tr_b16 v[230:231], v66 offset:22016
    s_waitcnt lgkmcnt(10)
    v_mfma_f32_32x32x16_bf16 v[160:175], v[236:239], v[184:187], v[160:175]
    ds_read_b64_tr_b16 v[232:233], v67 offset:21504
    ds_read_b64_tr_b16 v[234:235], v67 offset:22016
    s_add_u32 s96, s85, 2
    s_and_b32 s97, s96, 15
    s_lshl_b32 s98, s97, 14
    s_add_u32 s16, s98, s15
    buffer_load_dwordx4 v[208:211], v2, s[32:35], s16 offen sc1
    buffer_load_dwordx4 v[212:215], v2, s[32:35], s16 offen offset:1024 sc1
    s_waitcnt vmcnt(6)
    s_waitcnt lgkmcnt(10)
    v_mfma_f32_32x32x16_bf16 v[112:127], v[240:243], v[188:191], v[112:127]
    s_barrier
    ds_read_b64_tr_b16 v[236:237], v66 offset:32768
    ds_read_b64_tr_b16 v[238:239], v66 offset:33280
    s_waitcnt lgkmcnt(10)
    v_mfma_f32_32x32x16_bf16 v[128:143], v[244:247], v[188:191], v[128:143]
    ds_read_b64_tr_b16 v[240:241], v67 offset:32768
    ds_read_b64_tr_b16 v[242:243], v67 offset:33280
    s_waitcnt lgkmcnt(10)
    v_mfma_f32_32x32x16_bf16 v[80:95], v[248:251], v[188:191], v[80:95]
    ds_read_b64_tr_b16 v[244:245], v66 offset:24576
    ds_read_b64_tr_b16 v[246:247], v66 offset:25088
    s_waitcnt lgkmcnt(10)
    v_mfma_f32_32x32x16_bf16 v[96:111], v[224:227], v[188:191], v[96:111]
    ds_read_b64_tr_b16 v[248:249], v67 offset:24576
    ds_read_b64_tr_b16 v[250:251], v67 offset:25088
    s_waitcnt lgkmcnt(10)
    v_mfma_f32_32x32x16_bf16 v[144:159], v[228:231], v[188:191], v[144:159]
    ds_read_b64_tr_b16 v[224:225], v66 offset:40960
    ds_read_b64_tr_b16 v[226:227], v66 offset:41472
    s_waitcnt lgkmcnt(10)
    v_mfma_f32_32x32x16_bf16 v[160:175], v[232:235], v[188:191], v[160:175]
    ds_read_b64_tr_b16 v[228:229], v67 offset:40960
    ds_read_b64_tr_b16 v[230:231], v67 offset:41472
    buffer_load_dwordx4 v[216:219], v2, s[32:35], s16 offen offset:2048 sc1
    buffer_load_dwordx4 v[220:223], v2, s[32:35], s16 offen offset:3072 sc1
    s_waitcnt vmcnt(7)
    s_waitcnt lgkmcnt(10)
    v_mfma_f32_32x32x16_bf16 v[112:127], v[236:239], v[192:195], v[112:127]
    ds_read_b64_tr_b16 v[232:233], v66 offset:33792
    ds_read_b64_tr_b16 v[234:235], v66 offset:34304
    s_waitcnt lgkmcnt(10)
    v_mfma_f32_32x32x16_bf16 v[128:143], v[240:243], v[192:195], v[128:143]
    ds_read_b64_tr_b16 v[236:237], v67 offset:33792
    ds_read_b64_tr_b16 v[238:239], v67 offset:34304
    s_waitcnt lgkmcnt(10)
    v_mfma_f32_32x32x16_bf16 v[80:95], v[244:247], v[192:195], v[80:95]
    ds_read_b64_tr_b16 v[240:241], v66 offset:25600
    ds_read_b64_tr_b16 v[242:243], v66 offset:26112
    s_waitcnt lgkmcnt(10)
    v_mfma_f32_32x32x16_bf16 v[96:111], v[248:251], v[192:195], v[96:111]
    ds_read_b64_tr_b16 v[244:245], v67 offset:25600
    ds_read_b64_tr_b16 v[246:247], v67 offset:26112
    s_waitcnt lgkmcnt(10)
    v_mfma_f32_32x32x16_bf16 v[144:159], v[224:227], v[192:195], v[144:159]
    ds_read_b64_tr_b16 v[248:249], v66 offset:41984
    ds_read_b64_tr_b16 v[250:251], v66 offset:42496
    s_waitcnt lgkmcnt(10)
    v_mfma_f32_32x32x16_bf16 v[160:175], v[228:231], v[192:195], v[160:175]
    ds_read_b64_tr_b16 v[224:225], v67 offset:41984
    ds_read_b64_tr_b16 v[226:227], v67 offset:42496
    s_add_u32 s96, s85, 3
    s_and_b32 s97, s96, 15
    s_lshl_b32 s98, s97, 14
    s_add_u32 s16, s98, s15
    buffer_load_dwordx4 v[176:179], v2, s[32:35], s16 offen sc1
    buffer_load_dwordx4 v[180:183], v2, s[32:35], s16 offen offset:1024 sc1
    s_waitcnt vmcnt(8)
    s_waitcnt lgkmcnt(10)
    v_mfma_f32_32x32x16_bf16 v[112:127], v[232:235], v[196:199], v[112:127]
    ds_read_b64_tr_b16 v[228:229], v66 offset:36864
    ds_read_b64_tr_b16 v[230:231], v66 offset:37376
    s_waitcnt lgkmcnt(10)
    v_mfma_f32_32x32x16_bf16 v[128:143], v[236:239], v[196:199], v[128:143]
    ds_read_b64_tr_b16 v[232:233], v67 offset:36864
    ds_read_b64_tr_b16 v[234:235], v67 offset:37376
    s_waitcnt lgkmcnt(10)
    v_mfma_f32_32x32x16_bf16 v[80:95], v[240:243], v[196:199], v[80:95]
    ds_read_b64_tr_b16 v[236:237], v66 offset:28672
    ds_read_b64_tr_b16 v[238:239], v66 offset:29184
    s_waitcnt lgkmcnt(10)
    v_mfma_f32_32x32x16_bf16 v[96:111], v[244:247], v[196:199], v[96:111]
    ds_read_b64_tr_b16 v[240:241], v67 offset:28672
    ds_read_b64_tr_b16 v[242:243], v67 offset:29184
    s_waitcnt lgkmcnt(10)
    v_mfma_f32_32x32x16_bf16 v[144:159], v[248:251], v[196:199], v[144:159]
    ds_read_b64_tr_b16 v[244:245], v66 offset:45056
    ds_read_b64_tr_b16 v[246:247], v66 offset:45568
    s_waitcnt lgkmcnt(10)
    v_mfma_f32_32x32x16_bf16 v[160:175], v[224:227], v[196:199], v[160:175]
    ds_read_b64_tr_b16 v[248:249], v67 offset:45056
    ds_read_b64_tr_b16 v[250:251], v67 offset:45568
    buffer_load_dwordx4 v[184:187], v2, s[32:35], s16 offen offset:2048 sc1
    buffer_load_dwordx4 v[188:191], v2, s[32:35], s16 offen offset:3072 sc1
    s_waitcnt vmcnt(9)
    s_waitcnt lgkmcnt(10)
    v_mfma_f32_32x32x16_bf16 v[112:127], v[228:231], v[200:203], v[112:127]
    ds_read_b64_tr_b16 v[224:225], v66 offset:37888
    ds_read_b64_tr_b16 v[226:227], v66 offset:38400
    s_waitcnt lgkmcnt(10)
    v_mfma_f32_32x32x16_bf16 v[128:143], v[232:235], v[200:203], v[128:143]
    ds_read_b64_tr_b16 v[228:229], v67 offset:37888
    ds_read_b64_tr_b16 v[230:231], v67 offset:38400
    s_waitcnt lgkmcnt(10)
    v_mfma_f32_32x32x16_bf16 v[80:95], v[236:239], v[200:203], v[80:95]
    ds_read_b64_tr_b16 v[232:233], v66 offset:29696
    ds_read_b64_tr_b16 v[234:235], v66 offset:30208
    s_waitcnt lgkmcnt(10)
    v_mfma_f32_32x32x16_bf16 v[96:111], v[240:243], v[200:203], v[96:111]
    ds_read_b64_tr_b16 v[236:237], v67 offset:29696
    ds_read_b64_tr_b16 v[238:239], v67 offset:30208
    s_waitcnt lgkmcnt(10)
    v_mfma_f32_32x32x16_bf16 v[144:159], v[244:247], v[200:203], v[144:159]
    ds_read_b64_tr_b16 v[240:241], v66 offset:46080
    ds_read_b64_tr_b16 v[242:243], v66 offset:46592
    s_waitcnt lgkmcnt(10)
    v_mfma_f32_32x32x16_bf16 v[160:175], v[248:251], v[200:203], v[160:175]
    ds_read_b64_tr_b16 v[244:245], v67 offset:46080
    ds_read_b64_tr_b16 v[246:247], v67 offset:46592
    s_add_u32 s96, s85, 4
    s_and_b32 s97, s96, 15
    s_lshl_b32 s98, s97, 14
    s_add_u32 s16, s98, s15
    buffer_load_dwordx4 v[192:195], v2, s[32:35], s16 offen sc1
    buffer_load_dwordx4 v[196:199], v2, s[32:35], s16 offen offset:1024 sc1
    s_waitcnt vmcnt(10)
    s_waitcnt lgkmcnt(10)
    v_mfma_f32_32x32x16_bf16 v[112:127], v[224:227], v[204:207], v[112:127]
    s_barrier
    ds_read_b64_tr_b16 v[248:249], v68 offset:8192
    ds_read_b64_tr_b16 v[250:251], v68 offset:8704
    s_waitcnt lgkmcnt(10)
    v_mfma_f32_32x32x16_bf16 v[128:143], v[228:231], v[204:207], v[128:143]
    ds_read_b64_tr_b16 v[224:225], v69 offset:8192
    ds_read_b64_tr_b16 v[226:227], v69 offset:8704
    s_waitcnt lgkmcnt(10)
    v_mfma_f32_32x32x16_bf16 v[80:95], v[232:235], v[204:207], v[80:95]
    ds_read_b64_tr_b16 v[228:229], v68
    ds_read_b64_tr_b16 v[230:231], v68 offset:512
    s_waitcnt lgkmcnt(10)
    v_mfma_f32_32x32x16_bf16 v[96:111], v[236:239], v[204:207], v[96:111]
    ds_read_b64_tr_b16 v[232:233], v69
    ds_read_b64_tr_b16 v[234:235], v69 offset:512
    s_waitcnt lgkmcnt(10)
    v_mfma_f32_32x32x16_bf16 v[144:159], v[240:243], v[204:207], v[144:159]
    ds_read_b64_tr_b16 v[236:237], v68 offset:16384
    ds_read_b64_tr_b16 v[238:239], v68 offset:16896
    s_waitcnt lgkmcnt(10)
    v_mfma_f32_32x32x16_bf16 v[160:175], v[244:247], v[204:207], v[160:175]
    ds_read_b64_tr_b16 v[240:241], v69 offset:16384
    ds_read_b64_tr_b16 v[242:243], v69 offset:16896
    buffer_load_dwordx4 v[200:203], v2, s[32:35], s16 offen offset:2048 sc1
    buffer_load_dwordx4 v[204:207], v2, s[32:35], s16 offen offset:3072 sc1
    s_waitcnt vmcnt(11)
    s_waitcnt lgkmcnt(10)
    v_mfma_f32_32x32x16_bf16 v[112:127], v[248:251], v[208:211], v[112:127]
    ds_read_b64_tr_b16 v[244:245], v68 offset:9216
    ds_read_b64_tr_b16 v[246:247], v68 offset:9728
    s_waitcnt lgkmcnt(10)
    v_mfma_f32_32x32x16_bf16 v[128:143], v[224:227], v[208:211], v[128:143]
    ds_read_b64_tr_b16 v[248:249], v69 offset:9216
    ds_read_b64_tr_b16 v[250:251], v69 offset:9728
    s_waitcnt lgkmcnt(10)
    v_mfma_f32_32x32x16_bf16 v[80:95], v[228:231], v[208:211], v[80:95]
    ds_read_b64_tr_b16 v[224:225], v68 offset:1024
    ds_read_b64_tr_b16 v[226:227], v68 offset:1536
    s_waitcnt lgkmcnt(10)
    v_mfma_f32_32x32x16_bf16 v[96:111], v[232:235], v[208:211], v[96:111]
    ds_read_b64_tr_b16 v[228:229], v69 offset:1024
    ds_read_b64_tr_b16 v[230:231], v69 offset:1536
    s_waitcnt lgkmcnt(10)
    v_mfma_f32_32x32x16_bf16 v[144:159], v[236:239], v[208:211], v[144:159]
    ds_read_b64_tr_b16 v[232:233], v68 offset:17408
    ds_read_b64_tr_b16 v[234:235], v68 offset:17920
    s_waitcnt lgkmcnt(10)
    v_mfma_f32_32x32x16_bf16 v[160:175], v[240:243], v[208:211], v[160:175]
    ds_read_b64_tr_b16 v[236:237], v69 offset:17408
    ds_read_b64_tr_b16 v[238:239], v69 offset:17920
    s_add_u32 s96, s85, 5
    s_and_b32 s97, s96, 15
    s_lshl_b32 s98, s97, 14
    s_add_u32 s16, s98, s15
    buffer_load_dwordx4 v[208:211], v2, s[32:35], s16 offen sc1
    s_waitcnt vmcnt(11)
    s_waitcnt lgkmcnt(10)
    v_mfma_f32_32x32x16_bf16 v[112:127], v[244:247], v[212:215], v[112:127]
    ds_read_b64_tr_b16 v[240:241], v68 offset:12288
    ds_read_b64_tr_b16 v[242:243], v68 offset:12800
    s_waitcnt lgkmcnt(10)
    v_mfma_f32_32x32x16_bf16 v[128:143], v[248:251], v[212:215], v[128:143]
    ds_read_b64_tr_b16 v[244:245], v69 offset:12288
    ds_read_b64_tr_b16 v[246:247], v69 offset:12800
    s_waitcnt lgkmcnt(10)
    v_mfma_f32_32x32x16_bf16 v[80:95], v[224:227], v[212:215], v[80:95]
    ds_read_b64_tr_b16 v[248:249], v68 offset:4096
    ds_read_b64_tr_b16 v[250:251], v68 offset:4608
    s_waitcnt lgkmcnt(10)
    v_mfma_f32_32x32x16_bf16 v[96:111], v[228:231], v[212:215], v[96:111]
    ds_read_b64_tr_b16 v[224:225], v69 offset:4096
    ds_read_b64_tr_b16 v[226:227], v69 offset:4608
    s_waitcnt lgkmcnt(10)
    v_mfma_f32_32x32x16_bf16 v[144:159], v[232:235], v[212:215], v[144:159]
    ds_read_b64_tr_b16 v[228:229], v68 offset:20480
    ds_read_b64_tr_b16 v[230:231], v68 offset:20992
    s_waitcnt lgkmcnt(10)
    v_mfma_f32_32x32x16_bf16 v[160:175], v[236:239], v[212:215], v[160:175]
    ds_read_b64_tr_b16 v[232:233], v69 offset:20480
    ds_read_b64_tr_b16 v[234:235], v69 offset:20992
    buffer_load_dwordx4 v[212:215], v2, s[32:35], s16 offen offset:1024 sc1
    s_waitcnt vmcnt(11)
    s_waitcnt lgkmcnt(10)
    v_mfma_f32_32x32x16_bf16 v[112:127], v[240:243], v[216:219], v[112:127]
    ds_read_b64_tr_b16 v[236:237], v68 offset:13312
    ds_read_b64_tr_b16 v[238:239], v68 offset:13824
    s_waitcnt lgkmcnt(10)
    v_mfma_f32_32x32x16_bf16 v[128:143], v[244:247], v[216:219], v[128:143]
    ds_read_b64_tr_b16 v[240:241], v69 offset:13312
    ds_read_b64_tr_b16 v[242:243], v69 offset:13824
    s_waitcnt lgkmcnt(10)
    v_mfma_f32_32x32x16_bf16 v[80:95], v[248:251], v[216:219], v[80:95]
    ds_read_b64_tr_b16 v[244:245], v68 offset:5120
    ds_read_b64_tr_b16 v[246:247], v68 offset:5632
    s_waitcnt lgkmcnt(10)
    v_mfma_f32_32x32x16_bf16 v[96:111], v[224:227], v[216:219], v[96:111]
    ds_read_b64_tr_b16 v[248:249], v69 offset:5120
    ds_read_b64_tr_b16 v[250:251], v69 offset:5632
    s_waitcnt lgkmcnt(10)
    v_mfma_f32_32x32x16_bf16 v[144:159], v[228:231], v[216:219], v[144:159]
    ds_read_b64_tr_b16 v[224:225], v68 offset:21504
    ds_read_b64_tr_b16 v[226:227], v68 offset:22016
    s_waitcnt lgkmcnt(10)
    v_mfma_f32_32x32x16_bf16 v[160:175], v[232:235], v[216:219], v[160:175]
    ds_read_b64_tr_b16 v[228:229], v69 offset:21504
    ds_read_b64_tr_b16 v[230:231], v69 offset:22016
    buffer_load_dwordx4 v[216:219], v2, s[32:35], s16 offen offset:2048 sc1
    s_waitcnt vmcnt(11)
    s_waitcnt lgkmcnt(10)
    v_mfma_f32_32x32x16_bf16 v[112:127], v[236:239], v[220:223], v[112:127]
    s_barrier
    ds_read_b64_tr_b16 v[232:233], v68 offset:32768
    ds_read_b64_tr_b16 v[234:235], v68 offset:33280
    s_waitcnt lgkmcnt(10)
    v_mfma_f32_32x32x16_bf16 v[128:143], v[240:243], v[220:223], v[128:143]
    ds_read_b64_tr_b16 v[236:237], v69 offset:32768
    ds_read_b64_tr_b16 v[238:239], v69 offset:33280
    s_waitcnt lgkmcnt(10)
    v_mfma_f32_32x32x16_bf16 v[80:95], v[244:247], v[220:223], v[80:95]
    ds_read_b64_tr_b16 v[240:241], v68 offset:24576
    ds_read_b64_tr_b16 v[242:243], v68 offset:25088
    s_waitcnt lgkmcnt(10)
    v_mfma_f32_32x32x16_bf16 v[96:111], v[248:251], v[220:223], v[96:111]
    ds_read_b64_tr_b16 v[244:245], v69 offset:24576
    ds_read_b64_tr_b16 v[246:247], v69 offset:25088
    s_waitcnt lgkmcnt(10)
    v_mfma_f32_32x32x16_bf16 v[144:159], v[224:227], v[220:223], v[144:159]
    ds_read_b64_tr_b16 v[248:249], v68 offset:40960
    ds_read_b64_tr_b16 v[250:251], v68 offset:41472
    s_waitcnt lgkmcnt(10)
    v_mfma_f32_32x32x16_bf16 v[160:175], v[228:231], v[220:223], v[160:175]
    ds_read_b64_tr_b16 v[224:225], v69 offset:40960
    ds_read_b64_tr_b16 v[226:227], v69 offset:41472
    buffer_load_dwordx4 v[220:223], v2, s[32:35], s16 offen offset:3072 sc1
    s_waitcnt vmcnt(11)
    s_waitcnt lgkmcnt(10)
    v_mfma_f32_32x32x16_bf16 v[112:127], v[232:235], v[176:179], v[112:127]
    ds_read_b64_tr_b16 v[228:229], v68 offset:33792
    ds_read_b64_tr_b16 v[230:231], v68 offset:34304
    s_waitcnt lgkmcnt(10)
    v_mfma_f32_32x32x16_bf16 v[128:143], v[236:239], v[176:179], v[128:143]
    ds_read_b64_tr_b16 v[232:233], v69 offset:33792
    ds_read_b64_tr_b16 v[234:235], v69 offset:34304
    s_waitcnt lgkmcnt(10)
    v_mfma_f32_32x32x16_bf16 v[80:95], v[240:243], v[176:179], v[80:95]
    ds_read_b64_tr_b16 v[236:237], v68 offset:25600
    ds_read_b64_tr_b16 v[238:239], v68 offset:26112
    s_waitcnt lgkmcnt(10)
    v_mfma_f32_32x32x16_bf16 v[96:111], v[244:247], v[176:179], v[96:111]
    ds_read_b64_tr_b16 v[240:241], v69 offset:25600
    ds_read_b64_tr_b16 v[242:243], v69 offset:26112
    s_waitcnt lgkmcnt(10)
    v_mfma_f32_32x32x16_bf16 v[144:159], v[248:251], v[176:179], v[144:159]
    ds_read_b64_tr_b16 v[244:245], v68 offset:41984
    ds_read_b64_tr_b16 v[246:247], v68 offset:42496
    s_waitcnt lgkmcnt(10)
    v_mfma_f32_32x32x16_bf16 v[160:175], v[224:227], v[176:179], v[160:175]
    ds_read_b64_tr_b16 v[248:249], v69 offset:41984
    ds_read_b64_tr_b16 v[250:251], v69 offset:42496
    s_add_u32 s96, s85, 6
    s_and_b32 s97, s96, 15
    s_lshl_b32 s98, s97, 14
    s_add_u32 s16, s98, s15
    buffer_load_dwordx4 v[176:179], v2, s[32:35], s16 offen sc1
    s_waitcnt vmcnt(11)
    s_waitcnt lgkmcnt(10)
    v_mfma_f32_32x32x16_bf16 v[112:127], v[228:231], v[180:183], v[112:127]
    ds_read_b64_tr_b16 v[224:225], v68 offset:36864
    ds_read_b64_tr_b16 v[226:227], v68 offset:37376
    s_waitcnt lgkmcnt(10)
    v_mfma_f32_32x32x16_bf16 v[128:143], v[232:235], v[180:183], v[128:143]
    ds_read_b64_tr_b16 v[228:229], v69 offset:36864
    ds_read_b64_tr_b16 v[230:231], v69 offset:37376
    s_waitcnt lgkmcnt(10)
    v_mfma_f32_32x32x16_bf16 v[80:95], v[236:239], v[180:183], v[80:95]
    ds_read_b64_tr_b16 v[232:233], v68 offset:28672
    ds_read_b64_tr_b16 v[234:235], v68 offset:29184
    s_waitcnt lgkmcnt(10)
    v_mfma_f32_32x32x16_bf16 v[96:111], v[240:243], v[180:183], v[96:111]
    ds_read_b64_tr_b16 v[236:237], v69 offset:28672
    ds_read_b64_tr_b16 v[238:239], v69 offset:29184
    s_waitcnt lgkmcnt(10)
    v_mfma_f32_32x32x16_bf16 v[144:159], v[244:247], v[180:183], v[144:159]
    ds_read_b64_tr_b16 v[240:241], v68 offset:45056
    ds_read_b64_tr_b16 v[242:243], v68 offset:45568
    s_waitcnt lgkmcnt(10)
    v_mfma_f32_32x32x16_bf16 v[160:175], v[248:251], v[180:183], v[160:175]
    ds_read_b64_tr_b16 v[244:245], v69 offset:45056
    ds_read_b64_tr_b16 v[246:247], v69 offset:45568
    buffer_load_dwordx4 v[180:183], v2, s[32:35], s16 offen offset:1024 sc1
    s_waitcnt vmcnt(11)
    s_waitcnt lgkmcnt(10)
    v_mfma_f32_32x32x16_bf16 v[112:127], v[224:227], v[184:187], v[112:127]
    ds_read_b64_tr_b16 v[248:249], v68 offset:37888
    ds_read_b64_tr_b16 v[250:251], v68 offset:38400
    s_waitcnt lgkmcnt(10)
    v_mfma_f32_32x32x16_bf16 v[128:143], v[228:231], v[184:187], v[128:143]
    ds_read_b64_tr_b16 v[224:225], v69 offset:37888
    ds_read_b64_tr_b16 v[226:227], v69 offset:38400
    s_waitcnt lgkmcnt(10)
    v_mfma_f32_32x32x16_bf16 v[80:95], v[232:235], v[184:187], v[80:95]
    ds_read_b64_tr_b16 v[228:229], v68 offset:29696
    ds_read_b64_tr_b16 v[230:231], v68 offset:30208
    s_waitcnt lgkmcnt(10)
    v_mfma_f32_32x32x16_bf16 v[96:111], v[236:239], v[184:187], v[96:111]
    ds_read_b64_tr_b16 v[232:233], v69 offset:29696
    ds_read_b64_tr_b16 v[234:235], v69 offset:30208
    s_waitcnt lgkmcnt(10)
    v_mfma_f32_32x32x16_bf16 v[144:159], v[240:243], v[184:187], v[144:159]
    ds_read_b64_tr_b16 v[236:237], v68 offset:46080
    ds_read_b64_tr_b16 v[238:239], v68 offset:46592
    s_waitcnt lgkmcnt(10)
    v_mfma_f32_32x32x16_bf16 v[160:175], v[244:247], v[184:187], v[160:175]
    ds_read_b64_tr_b16 v[240:241], v69 offset:46080
    ds_read_b64_tr_b16 v[242:243], v69 offset:46592
    buffer_load_dwordx4 v[184:187], v2, s[32:35], s16 offen offset:2048 sc1
    s_waitcnt vmcnt(11)
    s_waitcnt lgkmcnt(10)
    v_mfma_f32_32x32x16_bf16 v[112:127], v[248:251], v[188:191], v[112:127]
    s_barrier
    ds_read_b64_tr_b16 v[244:245], v70 offset:8192
    ds_read_b64_tr_b16 v[246:247], v70 offset:8704
    s_waitcnt lgkmcnt(10)
    v_mfma_f32_32x32x16_bf16 v[128:143], v[224:227], v[188:191], v[128:143]
    ds_read_b64_tr_b16 v[248:249], v71 offset:8192
    ds_read_b64_tr_b16 v[250:251], v71 offset:8704
    s_waitcnt lgkmcnt(10)
    v_mfma_f32_32x32x16_bf16 v[80:95], v[228:231], v[188:191], v[80:95]
    ds_read_b64_tr_b16 v[224:225], v70
    ds_read_b64_tr_b16 v[226:227], v70 offset:512
    s_waitcnt lgkmcnt(10)
    v_mfma_f32_32x32x16_bf16 v[96:111], v[232:235], v[188:191], v[96:111]
    ds_read_b64_tr_b16 v[228:229], v71
    ds_read_b64_tr_b16 v[230:231], v71 offset:512
    s_waitcnt lgkmcnt(10)
    v_mfma_f32_32x32x16_bf16 v[144:159], v[236:239], v[188:191], v[144:159]
    ds_read_b64_tr_b16 v[232:233], v70 offset:16384
    ds_read_b64_tr_b16 v[234:235], v70 offset:16896
    s_waitcnt lgkmcnt(10)
    v_mfma_f32_32x32x16_bf16 v[160:175], v[240:243], v[188:191], v[160:175]
    ds_read_b64_tr_b16 v[236:237], v71 offset:16384
    ds_read_b64_tr_b16 v[238:239], v71 offset:16896
    buffer_load_dwordx4 v[188:191], v2, s[32:35], s16 offen offset:3072 sc1
    s_waitcnt vmcnt(11)
    s_waitcnt lgkmcnt(10)
    v_mfma_f32_32x32x16_bf16 v[112:127], v[244:247], v[192:195], v[112:127]
    ds_read_b64_tr_b16 v[240:241], v70 offset:9216
    ds_read_b64_tr_b16 v[242:243], v70 offset:9728
    s_waitcnt lgkmcnt(10)
    v_mfma_f32_32x32x16_bf16 v[128:143], v[248:251], v[192:195], v[128:143]
    ds_read_b64_tr_b16 v[244:245], v71 offset:9216
    ds_read_b64_tr_b16 v[246:247], v71 offset:9728
    s_waitcnt lgkmcnt(10)
    v_mfma_f32_32x32x16_bf16 v[80:95], v[224:227], v[192:195], v[80:95]
    ds_read_b64_tr_b16 v[248:249], v70 offset:1024
    ds_read_b64_tr_b16 v[250:251], v70 offset:1536
    s_waitcnt lgkmcnt(10)
    v_mfma_f32_32x32x16_bf16 v[96:111], v[228:231], v[192:195], v[96:111]
    ds_read_b64_tr_b16 v[224:225], v71 offset:1024
    ds_read_b64_tr_b16 v[226:227], v71 offset:1536
    s_waitcnt lgkmcnt(10)
    v_mfma_f32_32x32x16_bf16 v[144:159], v[232:235], v[192:195], v[144:159]
    ds_read_b64_tr_b16 v[228:229], v70 offset:17408
    ds_read_b64_tr_b16 v[230:231], v70 offset:17920
    s_waitcnt lgkmcnt(10)
    v_mfma_f32_32x32x16_bf16 v[160:175], v[236:239], v[192:195], v[160:175]
    ds_read_b64_tr_b16 v[232:233], v71 offset:17408
    ds_read_b64_tr_b16 v[234:235], v71 offset:17920
    s_add_u32 s96, s85, 7
    s_and_b32 s97, s96, 15
    s_lshl_b32 s98, s97, 14
    s_add_u32 s16, s98, s15
    buffer_load_dwordx4 v[192:195], v2, s[32:35], s16 offen sc1
    s_waitcnt vmcnt(11)
    s_waitcnt lgkmcnt(10)
    v_mfma_f32_32x32x16_bf16 v[112:127], v[240:243], v[196:199], v[112:127]
    ds_read_b64_tr_b16 v[236:237], v70 offset:12288
    ds_read_b64_tr_b16 v[238:239], v70 offset:12800
    s_waitcnt lgkmcnt(10)
    v_mfma_f32_32x32x16_bf16 v[128:143], v[244:247], v[196:199], v[128:143]
    ds_read_b64_tr_b16 v[240:241], v71 offset:12288
    ds_read_b64_tr_b16 v[242:243], v71 offset:12800
    s_waitcnt lgkmcnt(10)
    v_mfma_f32_32x32x16_bf16 v[80:95], v[248:251], v[196:199], v[80:95]
    ds_read_b64_tr_b16 v[244:245], v70 offset:4096
    ds_read_b64_tr_b16 v[246:247], v70 offset:4608
    s_waitcnt lgkmcnt(10)
    v_mfma_f32_32x32x16_bf16 v[96:111], v[224:227], v[196:199], v[96:111]
    ds_read_b64_tr_b16 v[248:249], v71 offset:4096
    ds_read_b64_tr_b16 v[250:251], v71 offset:4608
    s_waitcnt lgkmcnt(10)
    v_mfma_f32_32x32x16_bf16 v[144:159], v[228:231], v[196:199], v[144:159]
    ds_read_b64_tr_b16 v[224:225], v70 offset:20480
    ds_read_b64_tr_b16 v[226:227], v70 offset:20992
    s_waitcnt lgkmcnt(10)
    v_mfma_f32_32x32x16_bf16 v[160:175], v[232:235], v[196:199], v[160:175]
    ds_read_b64_tr_b16 v[228:229], v71 offset:20480
    ds_read_b64_tr_b16 v[230:231], v71 offset:20992
    buffer_load_dwordx4 v[196:199], v2, s[32:35], s16 offen offset:1024 sc1
    s_waitcnt vmcnt(11)
    s_waitcnt lgkmcnt(10)
    v_mfma_f32_32x32x16_bf16 v[112:127], v[236:239], v[200:203], v[112:127]
    ds_read_b64_tr_b16 v[232:233], v70 offset:13312
    ds_read_b64_tr_b16 v[234:235], v70 offset:13824
    s_waitcnt lgkmcnt(10)
    v_mfma_f32_32x32x16_bf16 v[128:143], v[240:243], v[200:203], v[128:143]
    ds_read_b64_tr_b16 v[236:237], v71 offset:13312
    ds_read_b64_tr_b16 v[238:239], v71 offset:13824
    s_waitcnt lgkmcnt(10)
    v_mfma_f32_32x32x16_bf16 v[80:95], v[244:247], v[200:203], v[80:95]
    ds_read_b64_tr_b16 v[240:241], v70 offset:5120
    ds_read_b64_tr_b16 v[242:243], v70 offset:5632
    s_waitcnt lgkmcnt(10)
    v_mfma_f32_32x32x16_bf16 v[96:111], v[248:251], v[200:203], v[96:111]
    ds_read_b64_tr_b16 v[244:245], v71 offset:5120
    ds_read_b64_tr_b16 v[246:247], v71 offset:5632
    s_waitcnt lgkmcnt(10)
    v_mfma_f32_32x32x16_bf16 v[144:159], v[224:227], v[200:203], v[144:159]
    ds_read_b64_tr_b16 v[248:249], v70 offset:21504
    ds_read_b64_tr_b16 v[250:251], v70 offset:22016
    s_waitcnt lgkmcnt(10)
    v_mfma_f32_32x32x16_bf16 v[160:175], v[228:231], v[200:203], v[160:175]
    ds_read_b64_tr_b16 v[224:225], v71 offset:21504
    ds_read_b64_tr_b16 v[226:227], v71 offset:22016
    buffer_load_dwordx4 v[200:203], v2, s[32:35], s16 offen offset:2048 sc1
    s_waitcnt vmcnt(11)
    s_waitcnt lgkmcnt(10)
    v_mfma_f32_32x32x16_bf16 v[112:127], v[232:235], v[204:207], v[112:127]
    s_barrier
    ds_read_b64_tr_b16 v[228:229], v70 offset:32768
    ds_read_b64_tr_b16 v[230:231], v70 offset:33280
    s_waitcnt lgkmcnt(10)
    v_mfma_f32_32x32x16_bf16 v[128:143], v[236:239], v[204:207], v[128:143]
    ds_read_b64_tr_b16 v[232:233], v71 offset:32768
    ds_read_b64_tr_b16 v[234:235], v71 offset:33280
    s_waitcnt lgkmcnt(10)
    v_mfma_f32_32x32x16_bf16 v[80:95], v[240:243], v[204:207], v[80:95]
    ds_read_b64_tr_b16 v[236:237], v70 offset:24576
    ds_read_b64_tr_b16 v[238:239], v70 offset:25088
    s_waitcnt lgkmcnt(10)
    v_mfma_f32_32x32x16_bf16 v[96:111], v[244:247], v[204:207], v[96:111]
    ds_read_b64_tr_b16 v[240:241], v71 offset:24576
    ds_read_b64_tr_b16 v[242:243], v71 offset:25088
    s_waitcnt lgkmcnt(10)
    v_mfma_f32_32x32x16_bf16 v[144:159], v[248:251], v[204:207], v[144:159]
    ds_read_b64_tr_b16 v[244:245], v70 offset:40960
    ds_read_b64_tr_b16 v[246:247], v70 offset:41472
    s_waitcnt lgkmcnt(10)
    v_mfma_f32_32x32x16_bf16 v[160:175], v[224:227], v[204:207], v[160:175]
    ds_read_b64_tr_b16 v[248:249], v71 offset:40960
    ds_read_b64_tr_b16 v[250:251], v71 offset:41472
    buffer_load_dwordx4 v[204:207], v2, s[32:35], s16 offen offset:3072 sc1
    s_waitcnt vmcnt(11)
    s_waitcnt lgkmcnt(10)
    v_mfma_f32_32x32x16_bf16 v[112:127], v[228:231], v[208:211], v[112:127]
    ds_read_b64_tr_b16 v[224:225], v70 offset:33792
    ds_read_b64_tr_b16 v[226:227], v70 offset:34304
    s_waitcnt lgkmcnt(10)
    v_mfma_f32_32x32x16_bf16 v[128:143], v[232:235], v[208:211], v[128:143]
    ds_read_b64_tr_b16 v[228:229], v71 offset:33792
    ds_read_b64_tr_b16 v[230:231], v71 offset:34304
    s_waitcnt lgkmcnt(10)
    v_mfma_f32_32x32x16_bf16 v[80:95], v[236:239], v[208:211], v[80:95]
    ds_read_b64_tr_b16 v[232:233], v70 offset:25600
    ds_read_b64_tr_b16 v[234:235], v70 offset:26112
    s_waitcnt lgkmcnt(10)
    v_mfma_f32_32x32x16_bf16 v[96:111], v[240:243], v[208:211], v[96:111]
    ds_read_b64_tr_b16 v[236:237], v71 offset:25600
    ds_read_b64_tr_b16 v[238:239], v71 offset:26112
    s_waitcnt lgkmcnt(10)
    v_mfma_f32_32x32x16_bf16 v[144:159], v[244:247], v[208:211], v[144:159]
    ds_read_b64_tr_b16 v[240:241], v70 offset:41984
    ds_read_b64_tr_b16 v[242:243], v70 offset:42496
    s_waitcnt lgkmcnt(10)
    v_mfma_f32_32x32x16_bf16 v[160:175], v[248:251], v[208:211], v[160:175]
    ds_read_b64_tr_b16 v[244:245], v71 offset:41984
    ds_read_b64_tr_b16 v[246:247], v71 offset:42496
    s_add_u32 s96, s85, 8
    s_and_b32 s97, s96, 15
    s_lshl_b32 s98, s97, 14
    s_add_u32 s16, s98, s15
    buffer_load_dwordx4 v[208:211], v2, s[32:35], s16 offen sc1
    s_waitcnt vmcnt(11)
    s_waitcnt lgkmcnt(10)
    v_mfma_f32_32x32x16_bf16 v[112:127], v[224:227], v[212:215], v[112:127]
    ds_read_b64_tr_b16 v[248:249], v70 offset:36864
    ds_read_b64_tr_b16 v[250:251], v70 offset:37376
    s_waitcnt lgkmcnt(10)
    v_mfma_f32_32x32x16_bf16 v[128:143], v[228:231], v[212:215], v[128:143]
    ds_read_b64_tr_b16 v[224:225], v71 offset:36864
    ds_read_b64_tr_b16 v[226:227], v71 offset:37376
    s_waitcnt lgkmcnt(10)
    v_mfma_f32_32x32x16_bf16 v[80:95], v[232:235], v[212:215], v[80:95]
    ds_read_b64_tr_b16 v[228:229], v70 offset:28672
    ds_read_b64_tr_b16 v[230:231], v70 offset:29184
    s_waitcnt lgkmcnt(10)
    v_mfma_f32_32x32x16_bf16 v[96:111], v[236:239], v[212:215], v[96:111]
    ds_read_b64_tr_b16 v[232:233], v71 offset:28672
    ds_read_b64_tr_b16 v[234:235], v71 offset:29184
    s_waitcnt lgkmcnt(10)
    v_mfma_f32_32x32x16_bf16 v[144:159], v[240:243], v[212:215], v[144:159]
    ds_read_b64_tr_b16 v[236:237], v70 offset:45056
    ds_read_b64_tr_b16 v[238:239], v70 offset:45568
    s_waitcnt lgkmcnt(10)
    v_mfma_f32_32x32x16_bf16 v[160:175], v[244:247], v[212:215], v[160:175]
    ds_read_b64_tr_b16 v[240:241], v71 offset:45056
    ds_read_b64_tr_b16 v[242:243], v71 offset:45568
    buffer_load_dwordx4 v[212:215], v2, s[32:35], s16 offen offset:1024 sc1
    s_waitcnt vmcnt(11)
    s_waitcnt lgkmcnt(10)
    v_mfma_f32_32x32x16_bf16 v[112:127], v[248:251], v[216:219], v[112:127]
    ds_read_b64_tr_b16 v[244:245], v70 offset:37888
    ds_read_b64_tr_b16 v[246:247], v70 offset:38400
    s_waitcnt lgkmcnt(10)
    v_mfma_f32_32x32x16_bf16 v[128:143], v[224:227], v[216:219], v[128:143]
    ds_read_b64_tr_b16 v[248:249], v71 offset:37888
    ds_read_b64_tr_b16 v[250:251], v71 offset:38400
    s_waitcnt lgkmcnt(10)
    v_mfma_f32_32x32x16_bf16 v[80:95], v[228:231], v[216:219], v[80:95]
    ds_read_b64_tr_b16 v[224:225], v70 offset:29696
    ds_read_b64_tr_b16 v[226:227], v70 offset:30208
    s_waitcnt lgkmcnt(10)
    v_mfma_f32_32x32x16_bf16 v[96:111], v[232:235], v[216:219], v[96:111]
    ds_read_b64_tr_b16 v[228:229], v71 offset:29696
    ds_read_b64_tr_b16 v[230:231], v71 offset:30208
    s_waitcnt lgkmcnt(10)
    v_mfma_f32_32x32x16_bf16 v[144:159], v[236:239], v[216:219], v[144:159]
    ds_read_b64_tr_b16 v[232:233], v70 offset:46080
    ds_read_b64_tr_b16 v[234:235], v70 offset:46592
    s_waitcnt lgkmcnt(10)
    v_mfma_f32_32x32x16_bf16 v[160:175], v[240:243], v[216:219], v[160:175]
    ds_read_b64_tr_b16 v[236:237], v71 offset:46080
    ds_read_b64_tr_b16 v[238:239], v71 offset:46592
    buffer_load_dwordx4 v[216:219], v2, s[32:35], s16 offen offset:2048 sc1
    s_waitcnt vmcnt(11)
    s_waitcnt lgkmcnt(10)
    v_mfma_f32_32x32x16_bf16 v[112:127], v[244:247], v[220:223], v[112:127]
    s_barrier
    ds_read_b64_tr_b16 v[240:241], v66 offset:8192
    ds_read_b64_tr_b16 v[242:243], v66 offset:8704
    s_waitcnt lgkmcnt(10)
    v_mfma_f32_32x32x16_bf16 v[128:143], v[248:251], v[220:223], v[128:143]
    ds_read_b64_tr_b16 v[244:245], v67 offset:8192
    ds_read_b64_tr_b16 v[246:247], v67 offset:8704
    s_waitcnt lgkmcnt(10)
    v_mfma_f32_32x32x16_bf16 v[80:95], v[224:227], v[220:223], v[80:95]
    ds_read_b64_tr_b16 v[248:249], v66
    ds_read_b64_tr_b16 v[250:251], v66 offset:512
    s_waitcnt lgkmcnt(10)
    v_mfma_f32_32x32x16_bf16 v[96:111], v[228:231], v[220:223], v[96:111]
    ds_read_b64_tr_b16 v[224:225], v67
    ds_read_b64_tr_b16 v[226:227], v67 offset:512
    s_waitcnt lgkmcnt(10)
    v_mfma_f32_32x32x16_bf16 v[144:159], v[232:235], v[220:223], v[144:159]
    ds_read_b64_tr_b16 v[228:229], v66 offset:16384
    ds_read_b64_tr_b16 v[230:231], v66 offset:16896
    s_waitcnt lgkmcnt(10)
    v_mfma_f32_32x32x16_bf16 v[160:175], v[236:239], v[220:223], v[160:175]
    ds_read_b64_tr_b16 v[232:233], v67 offset:16384
    ds_read_b64_tr_b16 v[234:235], v67 offset:16896
    buffer_load_dwordx4 v[220:223], v2, s[32:35], s16 offen offset:3072 sc1
    s_waitcnt vmcnt(11)
    s_waitcnt lgkmcnt(10)
    v_mfma_f32_32x32x16_bf16 v[112:127], v[240:243], v[176:179], v[112:127]
    ds_read_b64_tr_b16 v[236:237], v66 offset:9216
    ds_read_b64_tr_b16 v[238:239], v66 offset:9728
    s_waitcnt lgkmcnt(10)
    v_mfma_f32_32x32x16_bf16 v[128:143], v[244:247], v[176:179], v[128:143]
    ds_read_b64_tr_b16 v[240:241], v67 offset:9216
    ds_read_b64_tr_b16 v[242:243], v67 offset:9728
    s_waitcnt lgkmcnt(10)
    v_mfma_f32_32x32x16_bf16 v[80:95], v[248:251], v[176:179], v[80:95]
    ds_read_b64_tr_b16 v[244:245], v66 offset:1024
    ds_read_b64_tr_b16 v[246:247], v66 offset:1536
    s_waitcnt lgkmcnt(10)
    v_mfma_f32_32x32x16_bf16 v[96:111], v[224:227], v[176:179], v[96:111]
    ds_read_b64_tr_b16 v[248:249], v67 offset:1024
    ds_read_b64_tr_b16 v[250:251], v67 offset:1536
    s_waitcnt lgkmcnt(10)
    v_mfma_f32_32x32x16_bf16 v[144:159], v[228:231], v[176:179], v[144:159]
    ds_read_b64_tr_b16 v[224:225], v66 offset:17408
    ds_read_b64_tr_b16 v[226:227], v66 offset:17920
    s_waitcnt lgkmcnt(10)
    v_mfma_f32_32x32x16_bf16 v[160:175], v[232:235], v[176:179], v[160:175]
    ds_read_b64_tr_b16 v[228:229], v67 offset:17408
    ds_read_b64_tr_b16 v[230:231], v67 offset:17920
    s_add_u32 s96, s85, 9
    s_and_b32 s97, s96, 15
    s_lshl_b32 s98, s97, 14
    s_add_u32 s16, s98, s15
    buffer_load_dwordx4 v[176:179], v2, s[32:35], s16 offen sc1
    s_waitcnt vmcnt(11)
    s_waitcnt lgkmcnt(10)
    v_mfma_f32_32x32x16_bf16 v[112:127], v[236:239], v[180:183], v[112:127]
    ds_read_b64_tr_b16 v[232:233], v66 offset:12288
    ds_read_b64_tr_b16 v[234:235], v66 offset:12800
    s_waitcnt lgkmcnt(10)
    v_mfma_f32_32x32x16_bf16 v[128:143], v[240:243], v[180:183], v[128:143]
    ds_read_b64_tr_b16 v[236:237], v67 offset:12288
    ds_read_b64_tr_b16 v[238:239], v67 offset:12800
    s_waitcnt lgkmcnt(10)
    v_mfma_f32_32x32x16_bf16 v[80:95], v[244:247], v[180:183], v[80:95]
    ds_read_b64_tr_b16 v[240:241], v66 offset:4096
    ds_read_b64_tr_b16 v[242:243], v66 offset:4608
    s_waitcnt lgkmcnt(10)
    v_mfma_f32_32x32x16_bf16 v[96:111], v[248:251], v[180:183], v[96:111]
    ds_read_b64_tr_b16 v[244:245], v67 offset:4096
    ds_read_b64_tr_b16 v[246:247], v67 offset:4608
    s_waitcnt lgkmcnt(10)
    v_mfma_f32_32x32x16_bf16 v[144:159], v[224:227], v[180:183], v[144:159]
    ds_read_b64_tr_b16 v[248:249], v66 offset:20480
    ds_read_b64_tr_b16 v[250:251], v66 offset:20992
    s_waitcnt lgkmcnt(10)
    v_mfma_f32_32x32x16_bf16 v[160:175], v[228:231], v[180:183], v[160:175]
    ds_read_b64_tr_b16 v[224:225], v67 offset:20480
    ds_read_b64_tr_b16 v[226:227], v67 offset:20992
    buffer_load_dwordx4 v[180:183], v2, s[32:35], s16 offen offset:1024 sc1
    s_waitcnt vmcnt(11)
    s_waitcnt lgkmcnt(10)
    v_mfma_f32_32x32x16_bf16 v[112:127], v[232:235], v[184:187], v[112:127]
    ds_read_b64_tr_b16 v[228:229], v66 offset:13312
    ds_read_b64_tr_b16 v[230:231], v66 offset:13824
    s_waitcnt lgkmcnt(10)
    v_mfma_f32_32x32x16_bf16 v[128:143], v[236:239], v[184:187], v[128:143]
    ds_read_b64_tr_b16 v[232:233], v67 offset:13312
    ds_read_b64_tr_b16 v[234:235], v67 offset:13824
    s_waitcnt lgkmcnt(10)
    v_mfma_f32_32x32x16_bf16 v[80:95], v[240:243], v[184:187], v[80:95]
    ds_read_b64_tr_b16 v[236:237], v66 offset:5120
    ds_read_b64_tr_b16 v[238:239], v66 offset:5632
    s_waitcnt lgkmcnt(10)
    v_mfma_f32_32x32x16_bf16 v[96:111], v[244:247], v[184:187], v[96:111]
    ds_read_b64_tr_b16 v[240:241], v67 offset:5120
    ds_read_b64_tr_b16 v[242:243], v67 offset:5632
    s_waitcnt lgkmcnt(10)
    v_mfma_f32_32x32x16_bf16 v[144:159], v[248:251], v[184:187], v[144:159]
    ds_read_b64_tr_b16 v[244:245], v66 offset:21504
    ds_read_b64_tr_b16 v[246:247], v66 offset:22016
    s_waitcnt lgkmcnt(10)
    v_mfma_f32_32x32x16_bf16 v[160:175], v[224:227], v[184:187], v[160:175]
    ds_read_b64_tr_b16 v[248:249], v67 offset:21504
    ds_read_b64_tr_b16 v[250:251], v67 offset:22016
    buffer_load_dwordx4 v[184:187], v2, s[32:35], s16 offen offset:2048 sc1
    s_waitcnt vmcnt(11)
    s_waitcnt lgkmcnt(10)
    v_mfma_f32_32x32x16_bf16 v[112:127], v[228:231], v[188:191], v[112:127]
    s_barrier
    ds_read_b64_tr_b16 v[224:225], v66 offset:32768
    ds_read_b64_tr_b16 v[226:227], v66 offset:33280
    s_waitcnt lgkmcnt(10)
    v_mfma_f32_32x32x16_bf16 v[128:143], v[232:235], v[188:191], v[128:143]
    ds_read_b64_tr_b16 v[228:229], v67 offset:32768
    ds_read_b64_tr_b16 v[230:231], v67 offset:33280
    s_waitcnt lgkmcnt(10)
    v_mfma_f32_32x32x16_bf16 v[80:95], v[236:239], v[188:191], v[80:95]
    ds_read_b64_tr_b16 v[232:233], v66 offset:24576
    ds_read_b64_tr_b16 v[234:235], v66 offset:25088
    s_waitcnt lgkmcnt(10)
    v_mfma_f32_32x32x16_bf16 v[96:111], v[240:243], v[188:191], v[96:111]
    ds_read_b64_tr_b16 v[236:237], v67 offset:24576
    ds_read_b64_tr_b16 v[238:239], v67 offset:25088
    s_waitcnt lgkmcnt(10)
    v_mfma_f32_32x32x16_bf16 v[144:159], v[244:247], v[188:191], v[144:159]
    ds_read_b64_tr_b16 v[240:241], v66 offset:40960
    ds_read_b64_tr_b16 v[242:243], v66 offset:41472
    s_waitcnt lgkmcnt(10)
    v_mfma_f32_32x32x16_bf16 v[160:175], v[248:251], v[188:191], v[160:175]
    ds_read_b64_tr_b16 v[244:245], v67 offset:40960
    ds_read_b64_tr_b16 v[246:247], v67 offset:41472
    buffer_load_dwordx4 v[188:191], v2, s[32:35], s16 offen offset:3072 sc1
    s_waitcnt vmcnt(11)
    s_waitcnt lgkmcnt(10)
    v_mfma_f32_32x32x16_bf16 v[112:127], v[224:227], v[192:195], v[112:127]
    ds_read_b64_tr_b16 v[248:249], v66 offset:33792
    ds_read_b64_tr_b16 v[250:251], v66 offset:34304
    s_waitcnt lgkmcnt(10)
    v_mfma_f32_32x32x16_bf16 v[128:143], v[228:231], v[192:195], v[128:143]
    ds_read_b64_tr_b16 v[224:225], v67 offset:33792
    ds_read_b64_tr_b16 v[226:227], v67 offset:34304
    s_waitcnt lgkmcnt(10)
    v_mfma_f32_32x32x16_bf16 v[80:95], v[232:235], v[192:195], v[80:95]
    ds_read_b64_tr_b16 v[228:229], v66 offset:25600
    ds_read_b64_tr_b16 v[230:231], v66 offset:26112
    s_waitcnt lgkmcnt(10)
    v_mfma_f32_32x32x16_bf16 v[96:111], v[236:239], v[192:195], v[96:111]
    ds_read_b64_tr_b16 v[232:233], v67 offset:25600
    ds_read_b64_tr_b16 v[234:235], v67 offset:26112
    s_waitcnt lgkmcnt(10)
    v_mfma_f32_32x32x16_bf16 v[144:159], v[240:243], v[192:195], v[144:159]
    ds_read_b64_tr_b16 v[236:237], v66 offset:41984
    ds_read_b64_tr_b16 v[238:239], v66 offset:42496
    s_waitcnt lgkmcnt(10)
    v_mfma_f32_32x32x16_bf16 v[160:175], v[244:247], v[192:195], v[160:175]
    ds_read_b64_tr_b16 v[240:241], v67 offset:41984
    ds_read_b64_tr_b16 v[242:243], v67 offset:42496
    s_add_u32 s96, s85, 10
    s_and_b32 s97, s96, 15
    s_lshl_b32 s98, s97, 14
    s_add_u32 s16, s98, s15
    buffer_load_dwordx4 v[192:195], v2, s[32:35], s16 offen sc1
    s_waitcnt vmcnt(11)
    s_waitcnt lgkmcnt(10)
    v_mfma_f32_32x32x16_bf16 v[112:127], v[248:251], v[196:199], v[112:127]
    ds_read_b64_tr_b16 v[244:245], v66 offset:36864
    ds_read_b64_tr_b16 v[246:247], v66 offset:37376
    s_waitcnt lgkmcnt(10)
    v_mfma_f32_32x32x16_bf16 v[128:143], v[224:227], v[196:199], v[128:143]
    ds_read_b64_tr_b16 v[248:249], v67 offset:36864
    ds_read_b64_tr_b16 v[250:251], v67 offset:37376
    s_waitcnt lgkmcnt(10)
    v_mfma_f32_32x32x16_bf16 v[80:95], v[228:231], v[196:199], v[80:95]
    ds_read_b64_tr_b16 v[224:225], v66 offset:28672
    ds_read_b64_tr_b16 v[226:227], v66 offset:29184
    s_waitcnt lgkmcnt(10)
    v_mfma_f32_32x32x16_bf16 v[96:111], v[232:235], v[196:199], v[96:111]
    ds_read_b64_tr_b16 v[228:229], v67 offset:28672
    ds_read_b64_tr_b16 v[230:231], v67 offset:29184
    s_waitcnt lgkmcnt(10)
    v_mfma_f32_32x32x16_bf16 v[144:159], v[236:239], v[196:199], v[144:159]
    ds_read_b64_tr_b16 v[232:233], v66 offset:45056
    ds_read_b64_tr_b16 v[234:235], v66 offset:45568
    s_waitcnt lgkmcnt(10)
    v_mfma_f32_32x32x16_bf16 v[160:175], v[240:243], v[196:199], v[160:175]
    ds_read_b64_tr_b16 v[236:237], v67 offset:45056
    ds_read_b64_tr_b16 v[238:239], v67 offset:45568
    buffer_load_dwordx4 v[196:199], v2, s[32:35], s16 offen offset:1024 sc1
    s_waitcnt vmcnt(11)
    s_waitcnt lgkmcnt(10)
    v_mfma_f32_32x32x16_bf16 v[112:127], v[244:247], v[200:203], v[112:127]
    ds_read_b64_tr_b16 v[240:241], v66 offset:37888
    ds_read_b64_tr_b16 v[242:243], v66 offset:38400
    s_waitcnt lgkmcnt(10)
    v_mfma_f32_32x32x16_bf16 v[128:143], v[248:251], v[200:203], v[128:143]
    ds_read_b64_tr_b16 v[244:245], v67 offset:37888
    ds_read_b64_tr_b16 v[246:247], v67 offset:38400
    s_waitcnt lgkmcnt(10)
    v_mfma_f32_32x32x16_bf16 v[80:95], v[224:227], v[200:203], v[80:95]
    ds_read_b64_tr_b16 v[248:249], v66 offset:29696
    ds_read_b64_tr_b16 v[250:251], v66 offset:30208
    s_waitcnt lgkmcnt(10)
    v_mfma_f32_32x32x16_bf16 v[96:111], v[228:231], v[200:203], v[96:111]
    ds_read_b64_tr_b16 v[224:225], v67 offset:29696
    ds_read_b64_tr_b16 v[226:227], v67 offset:30208
    s_waitcnt lgkmcnt(10)
    v_mfma_f32_32x32x16_bf16 v[144:159], v[232:235], v[200:203], v[144:159]
    ds_read_b64_tr_b16 v[228:229], v66 offset:46080
    ds_read_b64_tr_b16 v[230:231], v66 offset:46592
    s_waitcnt lgkmcnt(10)
    v_mfma_f32_32x32x16_bf16 v[160:175], v[236:239], v[200:203], v[160:175]
    ds_read_b64_tr_b16 v[232:233], v67 offset:46080
    ds_read_b64_tr_b16 v[234:235], v67 offset:46592
    buffer_load_dwordx4 v[200:203], v2, s[32:35], s16 offen offset:2048 sc1
    s_waitcnt vmcnt(11)
    s_waitcnt lgkmcnt(10)
    v_mfma_f32_32x32x16_bf16 v[112:127], v[240:243], v[204:207], v[112:127]
    s_barrier
    ds_read_b64_tr_b16 v[236:237], v68 offset:8192
    ds_read_b64_tr_b16 v[238:239], v68 offset:8704
    s_waitcnt lgkmcnt(10)
    v_mfma_f32_32x32x16_bf16 v[128:143], v[244:247], v[204:207], v[128:143]
    ds_read_b64_tr_b16 v[240:241], v69 offset:8192
    ds_read_b64_tr_b16 v[242:243], v69 offset:8704
    s_waitcnt lgkmcnt(10)
    v_mfma_f32_32x32x16_bf16 v[80:95], v[248:251], v[204:207], v[80:95]
    ds_read_b64_tr_b16 v[244:245], v68
    ds_read_b64_tr_b16 v[246:247], v68 offset:512
    s_waitcnt lgkmcnt(10)
    v_mfma_f32_32x32x16_bf16 v[96:111], v[224:227], v[204:207], v[96:111]
    ds_read_b64_tr_b16 v[248:249], v69
    ds_read_b64_tr_b16 v[250:251], v69 offset:512
    s_waitcnt lgkmcnt(10)
    v_mfma_f32_32x32x16_bf16 v[144:159], v[228:231], v[204:207], v[144:159]
    ds_read_b64_tr_b16 v[224:225], v68 offset:16384
    ds_read_b64_tr_b16 v[226:227], v68 offset:16896
    s_waitcnt lgkmcnt(10)
    v_mfma_f32_32x32x16_bf16 v[160:175], v[232:235], v[204:207], v[160:175]
    ds_read_b64_tr_b16 v[228:229], v69 offset:16384
    ds_read_b64_tr_b16 v[230:231], v69 offset:16896
    buffer_load_dwordx4 v[204:207], v2, s[32:35], s16 offen offset:3072 sc1
    s_waitcnt vmcnt(11)
    s_waitcnt lgkmcnt(10)
    v_mfma_f32_32x32x16_bf16 v[112:127], v[236:239], v[208:211], v[112:127]
    ds_read_b64_tr_b16 v[232:233], v68 offset:9216
    ds_read_b64_tr_b16 v[234:235], v68 offset:9728
    s_waitcnt lgkmcnt(10)
    v_mfma_f32_32x32x16_bf16 v[128:143], v[240:243], v[208:211], v[128:143]
    ds_read_b64_tr_b16 v[236:237], v69 offset:9216
    ds_read_b64_tr_b16 v[238:239], v69 offset:9728
    s_waitcnt lgkmcnt(10)
    v_mfma_f32_32x32x16_bf16 v[80:95], v[244:247], v[208:211], v[80:95]
    ds_read_b64_tr_b16 v[240:241], v68 offset:1024
    ds_read_b64_tr_b16 v[242:243], v68 offset:1536
    s_waitcnt lgkmcnt(10)
    v_mfma_f32_32x32x16_bf16 v[96:111], v[248:251], v[208:211], v[96:111]
    ds_read_b64_tr_b16 v[244:245], v69 offset:1024
    ds_read_b64_tr_b16 v[246:247], v69 offset:1536
    s_waitcnt lgkmcnt(10)
    v_mfma_f32_32x32x16_bf16 v[144:159], v[224:227], v[208:211], v[144:159]
    ds_read_b64_tr_b16 v[248:249], v68 offset:17408
    ds_read_b64_tr_b16 v[250:251], v68 offset:17920
    s_waitcnt lgkmcnt(10)
    v_mfma_f32_32x32x16_bf16 v[160:175], v[228:231], v[208:211], v[160:175]
    ds_read_b64_tr_b16 v[224:225], v69 offset:17408
    ds_read_b64_tr_b16 v[226:227], v69 offset:17920
    s_add_u32 s96, s85, 11
    s_and_b32 s97, s96, 15
    s_lshl_b32 s98, s97, 14
    s_add_u32 s16, s98, s15
    buffer_load_dwordx4 v[208:211], v2, s[32:35], s16 offen sc1
    s_waitcnt vmcnt(11)
    s_waitcnt lgkmcnt(10)
    v_mfma_f32_32x32x16_bf16 v[112:127], v[232:235], v[212:215], v[112:127]
    ds_read_b64_tr_b16 v[228:229], v68 offset:12288
    ds_read_b64_tr_b16 v[230:231], v68 offset:12800
    s_waitcnt lgkmcnt(10)
    v_mfma_f32_32x32x16_bf16 v[128:143], v[236:239], v[212:215], v[128:143]
    ds_read_b64_tr_b16 v[232:233], v69 offset:12288
    ds_read_b64_tr_b16 v[234:235], v69 offset:12800
    s_waitcnt lgkmcnt(10)
    v_mfma_f32_32x32x16_bf16 v[80:95], v[240:243], v[212:215], v[80:95]
    ds_read_b64_tr_b16 v[236:237], v68 offset:4096
    ds_read_b64_tr_b16 v[238:239], v68 offset:4608
    s_waitcnt lgkmcnt(10)
    v_mfma_f32_32x32x16_bf16 v[96:111], v[244:247], v[212:215], v[96:111]
    ds_read_b64_tr_b16 v[240:241], v69 offset:4096
    ds_read_b64_tr_b16 v[242:243], v69 offset:4608
    s_waitcnt lgkmcnt(10)
    v_mfma_f32_32x32x16_bf16 v[144:159], v[248:251], v[212:215], v[144:159]
    ds_read_b64_tr_b16 v[244:245], v68 offset:20480
    ds_read_b64_tr_b16 v[246:247], v68 offset:20992
    s_waitcnt lgkmcnt(10)
    v_mfma_f32_32x32x16_bf16 v[160:175], v[224:227], v[212:215], v[160:175]
    ds_read_b64_tr_b16 v[248:249], v69 offset:20480
    ds_read_b64_tr_b16 v[250:251], v69 offset:20992
    buffer_load_dwordx4 v[212:215], v2, s[32:35], s16 offen offset:1024 sc1
    s_waitcnt vmcnt(11)
    s_waitcnt lgkmcnt(10)
    v_mfma_f32_32x32x16_bf16 v[112:127], v[228:231], v[216:219], v[112:127]
    ds_read_b64_tr_b16 v[224:225], v68 offset:13312
    ds_read_b64_tr_b16 v[226:227], v68 offset:13824
    s_waitcnt lgkmcnt(10)
    v_mfma_f32_32x32x16_bf16 v[128:143], v[232:235], v[216:219], v[128:143]
    ds_read_b64_tr_b16 v[228:229], v69 offset:13312
    ds_read_b64_tr_b16 v[230:231], v69 offset:13824
    s_waitcnt lgkmcnt(10)
    v_mfma_f32_32x32x16_bf16 v[80:95], v[236:239], v[216:219], v[80:95]
    ds_read_b64_tr_b16 v[232:233], v68 offset:5120
    ds_read_b64_tr_b16 v[234:235], v68 offset:5632
    s_waitcnt lgkmcnt(10)
    v_mfma_f32_32x32x16_bf16 v[96:111], v[240:243], v[216:219], v[96:111]
    ds_read_b64_tr_b16 v[236:237], v69 offset:5120
    ds_read_b64_tr_b16 v[238:239], v69 offset:5632
    s_waitcnt lgkmcnt(10)
    v_mfma_f32_32x32x16_bf16 v[144:159], v[244:247], v[216:219], v[144:159]
    ds_read_b64_tr_b16 v[240:241], v68 offset:21504
    ds_read_b64_tr_b16 v[242:243], v68 offset:22016
    s_waitcnt lgkmcnt(10)
    v_mfma_f32_32x32x16_bf16 v[160:175], v[248:251], v[216:219], v[160:175]
    ds_read_b64_tr_b16 v[244:245], v69 offset:21504
    ds_read_b64_tr_b16 v[246:247], v69 offset:22016
    buffer_load_dwordx4 v[216:219], v2, s[32:35], s16 offen offset:2048 sc1
    s_waitcnt vmcnt(11)
    s_waitcnt lgkmcnt(10)
    v_mfma_f32_32x32x16_bf16 v[112:127], v[224:227], v[220:223], v[112:127]
    s_barrier
    ds_read_b64_tr_b16 v[248:249], v68 offset:32768
    ds_read_b64_tr_b16 v[250:251], v68 offset:33280
    s_waitcnt lgkmcnt(10)
    v_mfma_f32_32x32x16_bf16 v[128:143], v[228:231], v[220:223], v[128:143]
    ds_read_b64_tr_b16 v[224:225], v69 offset:32768
    ds_read_b64_tr_b16 v[226:227], v69 offset:33280
    s_waitcnt lgkmcnt(10)
    v_mfma_f32_32x32x16_bf16 v[80:95], v[232:235], v[220:223], v[80:95]
    ds_read_b64_tr_b16 v[228:229], v68 offset:24576
    ds_read_b64_tr_b16 v[230:231], v68 offset:25088
    s_waitcnt lgkmcnt(10)
    v_mfma_f32_32x32x16_bf16 v[96:111], v[236:239], v[220:223], v[96:111]
    ds_read_b64_tr_b16 v[232:233], v69 offset:24576
    ds_read_b64_tr_b16 v[234:235], v69 offset:25088
    s_waitcnt lgkmcnt(10)
    v_mfma_f32_32x32x16_bf16 v[144:159], v[240:243], v[220:223], v[144:159]
    ds_read_b64_tr_b16 v[236:237], v68 offset:40960
    ds_read_b64_tr_b16 v[238:239], v68 offset:41472
    s_waitcnt lgkmcnt(10)
    v_mfma_f32_32x32x16_bf16 v[160:175], v[244:247], v[220:223], v[160:175]
    ds_read_b64_tr_b16 v[240:241], v69 offset:40960
    ds_read_b64_tr_b16 v[242:243], v69 offset:41472
    buffer_load_dwordx4 v[220:223], v2, s[32:35], s16 offen offset:3072 sc1
    s_waitcnt vmcnt(11)
    s_waitcnt lgkmcnt(10)
    v_mfma_f32_32x32x16_bf16 v[112:127], v[248:251], v[176:179], v[112:127]
    ds_read_b64_tr_b16 v[244:245], v68 offset:33792
    ds_read_b64_tr_b16 v[246:247], v68 offset:34304
    s_waitcnt lgkmcnt(10)
    v_mfma_f32_32x32x16_bf16 v[128:143], v[224:227], v[176:179], v[128:143]
    ds_read_b64_tr_b16 v[248:249], v69 offset:33792
    ds_read_b64_tr_b16 v[250:251], v69 offset:34304
    s_waitcnt lgkmcnt(10)
    v_mfma_f32_32x32x16_bf16 v[80:95], v[228:231], v[176:179], v[80:95]
    ds_read_b64_tr_b16 v[224:225], v68 offset:25600
    ds_read_b64_tr_b16 v[226:227], v68 offset:26112
    s_waitcnt lgkmcnt(10)
    v_mfma_f32_32x32x16_bf16 v[96:111], v[232:235], v[176:179], v[96:111]
    ds_read_b64_tr_b16 v[228:229], v69 offset:25600
    ds_read_b64_tr_b16 v[230:231], v69 offset:26112
    s_waitcnt lgkmcnt(10)
    v_mfma_f32_32x32x16_bf16 v[144:159], v[236:239], v[176:179], v[144:159]
    ds_read_b64_tr_b16 v[232:233], v68 offset:41984
    ds_read_b64_tr_b16 v[234:235], v68 offset:42496
    s_waitcnt lgkmcnt(10)
    v_mfma_f32_32x32x16_bf16 v[160:175], v[240:243], v[176:179], v[160:175]
    ds_read_b64_tr_b16 v[236:237], v69 offset:41984
    ds_read_b64_tr_b16 v[238:239], v69 offset:42496
    s_add_u32 s96, s85, 12
    s_and_b32 s97, s96, 15
    s_lshl_b32 s98, s97, 14
    s_add_u32 s16, s98, s15
    buffer_load_dwordx4 v[176:179], v2, s[32:35], s16 offen sc1
    s_waitcnt vmcnt(11)
    s_waitcnt lgkmcnt(10)
    v_mfma_f32_32x32x16_bf16 v[112:127], v[244:247], v[180:183], v[112:127]
    ds_read_b64_tr_b16 v[240:241], v68 offset:36864
    ds_read_b64_tr_b16 v[242:243], v68 offset:37376
    s_waitcnt lgkmcnt(10)
    v_mfma_f32_32x32x16_bf16 v[128:143], v[248:251], v[180:183], v[128:143]
    ds_read_b64_tr_b16 v[244:245], v69 offset:36864
    ds_read_b64_tr_b16 v[246:247], v69 offset:37376
    s_waitcnt lgkmcnt(10)
    v_mfma_f32_32x32x16_bf16 v[80:95], v[224:227], v[180:183], v[80:95]
    ds_read_b64_tr_b16 v[248:249], v68 offset:28672
    ds_read_b64_tr_b16 v[250:251], v68 offset:29184
    s_waitcnt lgkmcnt(10)
    v_mfma_f32_32x32x16_bf16 v[96:111], v[228:231], v[180:183], v[96:111]
    ds_read_b64_tr_b16 v[224:225], v69 offset:28672
    ds_read_b64_tr_b16 v[226:227], v69 offset:29184
    s_waitcnt lgkmcnt(10)
    v_mfma_f32_32x32x16_bf16 v[144:159], v[232:235], v[180:183], v[144:159]
    ds_read_b64_tr_b16 v[228:229], v68 offset:45056
    ds_read_b64_tr_b16 v[230:231], v68 offset:45568
    s_waitcnt lgkmcnt(10)
    v_mfma_f32_32x32x16_bf16 v[160:175], v[236:239], v[180:183], v[160:175]
    ds_read_b64_tr_b16 v[232:233], v69 offset:45056
    ds_read_b64_tr_b16 v[234:235], v69 offset:45568
    buffer_load_dwordx4 v[180:183], v2, s[32:35], s16 offen offset:1024 sc1
    s_waitcnt vmcnt(11)
    s_waitcnt lgkmcnt(10)
    v_mfma_f32_32x32x16_bf16 v[112:127], v[240:243], v[184:187], v[112:127]
    ds_read_b64_tr_b16 v[236:237], v68 offset:37888
    ds_read_b64_tr_b16 v[238:239], v68 offset:38400
    s_waitcnt lgkmcnt(10)
    v_mfma_f32_32x32x16_bf16 v[128:143], v[244:247], v[184:187], v[128:143]
    ds_read_b64_tr_b16 v[240:241], v69 offset:37888
    ds_read_b64_tr_b16 v[242:243], v69 offset:38400
    s_waitcnt lgkmcnt(10)
    v_mfma_f32_32x32x16_bf16 v[80:95], v[248:251], v[184:187], v[80:95]
    ds_read_b64_tr_b16 v[244:245], v68 offset:29696
    ds_read_b64_tr_b16 v[246:247], v68 offset:30208
    s_waitcnt lgkmcnt(10)
    v_mfma_f32_32x32x16_bf16 v[96:111], v[224:227], v[184:187], v[96:111]
    ds_read_b64_tr_b16 v[248:249], v69 offset:29696
    ds_read_b64_tr_b16 v[250:251], v69 offset:30208
    s_waitcnt lgkmcnt(10)
    v_mfma_f32_32x32x16_bf16 v[144:159], v[228:231], v[184:187], v[144:159]
    ds_read_b64_tr_b16 v[224:225], v68 offset:46080
    ds_read_b64_tr_b16 v[226:227], v68 offset:46592
    s_waitcnt lgkmcnt(10)
    v_mfma_f32_32x32x16_bf16 v[160:175], v[232:235], v[184:187], v[160:175]
    ds_read_b64_tr_b16 v[228:229], v69 offset:46080
    ds_read_b64_tr_b16 v[230:231], v69 offset:46592
    buffer_load_dwordx4 v[184:187], v2, s[32:35], s16 offen offset:2048 sc1
    s_waitcnt vmcnt(11)
    s_waitcnt lgkmcnt(10)
    v_mfma_f32_32x32x16_bf16 v[112:127], v[236:239], v[188:191], v[112:127]
    s_barrier
    ds_read_b64_tr_b16 v[232:233], v70 offset:8192
    ds_read_b64_tr_b16 v[234:235], v70 offset:8704
    s_waitcnt lgkmcnt(10)
    v_mfma_f32_32x32x16_bf16 v[128:143], v[240:243], v[188:191], v[128:143]
    ds_read_b64_tr_b16 v[236:237], v71 offset:8192
    ds_read_b64_tr_b16 v[238:239], v71 offset:8704
    s_waitcnt lgkmcnt(10)
    v_mfma_f32_32x32x16_bf16 v[80:95], v[244:247], v[188:191], v[80:95]
    ds_read_b64_tr_b16 v[240:241], v70
    ds_read_b64_tr_b16 v[242:243], v70 offset:512
    s_waitcnt lgkmcnt(10)
    v_mfma_f32_32x32x16_bf16 v[96:111], v[248:251], v[188:191], v[96:111]
    ds_read_b64_tr_b16 v[244:245], v71
    ds_read_b64_tr_b16 v[246:247], v71 offset:512
    s_waitcnt lgkmcnt(10)
    v_mfma_f32_32x32x16_bf16 v[144:159], v[224:227], v[188:191], v[144:159]
    ds_read_b64_tr_b16 v[248:249], v70 offset:16384
    ds_read_b64_tr_b16 v[250:251], v70 offset:16896
    s_waitcnt lgkmcnt(10)
    v_mfma_f32_32x32x16_bf16 v[160:175], v[228:231], v[188:191], v[160:175]
    ds_read_b64_tr_b16 v[224:225], v71 offset:16384
    ds_read_b64_tr_b16 v[226:227], v71 offset:16896
    buffer_load_dwordx4 v[188:191], v2, s[32:35], s16 offen offset:3072 sc1
    s_waitcnt vmcnt(11)
    s_waitcnt lgkmcnt(10)
    v_mfma_f32_32x32x16_bf16 v[112:127], v[232:235], v[192:195], v[112:127]
    ds_read_b64_tr_b16 v[228:229], v70 offset:9216
    ds_read_b64_tr_b16 v[230:231], v70 offset:9728
    s_waitcnt lgkmcnt(10)
    v_mfma_f32_32x32x16_bf16 v[128:143], v[236:239], v[192:195], v[128:143]
    ds_read_b64_tr_b16 v[232:233], v71 offset:9216
    ds_read_b64_tr_b16 v[234:235], v71 offset:9728
    s_waitcnt lgkmcnt(10)
    v_mfma_f32_32x32x16_bf16 v[80:95], v[240:243], v[192:195], v[80:95]
    ds_read_b64_tr_b16 v[236:237], v70 offset:1024
    ds_read_b64_tr_b16 v[238:239], v70 offset:1536
    s_waitcnt lgkmcnt(10)
    v_mfma_f32_32x32x16_bf16 v[96:111], v[244:247], v[192:195], v[96:111]
    ds_read_b64_tr_b16 v[240:241], v71 offset:1024
    ds_read_b64_tr_b16 v[242:243], v71 offset:1536
    s_waitcnt lgkmcnt(10)
    v_mfma_f32_32x32x16_bf16 v[144:159], v[248:251], v[192:195], v[144:159]
    ds_read_b64_tr_b16 v[244:245], v70 offset:17408
    ds_read_b64_tr_b16 v[246:247], v70 offset:17920
    s_waitcnt lgkmcnt(10)
    v_mfma_f32_32x32x16_bf16 v[160:175], v[224:227], v[192:195], v[160:175]
    ds_read_b64_tr_b16 v[248:249], v71 offset:17408
    ds_read_b64_tr_b16 v[250:251], v71 offset:17920
    s_add_u32 s96, s85, 13
    s_and_b32 s97, s96, 15
    s_lshl_b32 s98, s97, 14
    s_add_u32 s16, s98, s15
    buffer_load_dwordx4 v[192:195], v2, s[32:35], s16 offen sc1
    s_waitcnt vmcnt(11)
    s_waitcnt lgkmcnt(10)
    v_mfma_f32_32x32x16_bf16 v[112:127], v[228:231], v[196:199], v[112:127]
    ds_read_b64_tr_b16 v[224:225], v70 offset:12288
    ds_read_b64_tr_b16 v[226:227], v70 offset:12800
    s_waitcnt lgkmcnt(10)
    v_mfma_f32_32x32x16_bf16 v[128:143], v[232:235], v[196:199], v[128:143]
    ds_read_b64_tr_b16 v[228:229], v71 offset:12288
    ds_read_b64_tr_b16 v[230:231], v71 offset:12800
    s_waitcnt lgkmcnt(10)
    v_mfma_f32_32x32x16_bf16 v[80:95], v[236:239], v[196:199], v[80:95]
    ds_read_b64_tr_b16 v[232:233], v70 offset:4096
    ds_read_b64_tr_b16 v[234:235], v70 offset:4608
    s_waitcnt lgkmcnt(10)
    v_mfma_f32_32x32x16_bf16 v[96:111], v[240:243], v[196:199], v[96:111]
    ds_read_b64_tr_b16 v[236:237], v71 offset:4096
    ds_read_b64_tr_b16 v[238:239], v71 offset:4608
    s_waitcnt lgkmcnt(10)
    v_mfma_f32_32x32x16_bf16 v[144:159], v[244:247], v[196:199], v[144:159]
    ds_read_b64_tr_b16 v[240:241], v70 offset:20480
    ds_read_b64_tr_b16 v[242:243], v70 offset:20992
    s_waitcnt lgkmcnt(10)
    v_mfma_f32_32x32x16_bf16 v[160:175], v[248:251], v[196:199], v[160:175]
    ds_read_b64_tr_b16 v[244:245], v71 offset:20480
    ds_read_b64_tr_b16 v[246:247], v71 offset:20992
    buffer_load_dwordx4 v[196:199], v2, s[32:35], s16 offen offset:1024 sc1
    s_waitcnt vmcnt(11)
    s_waitcnt lgkmcnt(10)
    v_mfma_f32_32x32x16_bf16 v[112:127], v[224:227], v[200:203], v[112:127]
    ds_read_b64_tr_b16 v[248:249], v70 offset:13312
    ds_read_b64_tr_b16 v[250:251], v70 offset:13824
    s_waitcnt lgkmcnt(10)
    v_mfma_f32_32x32x16_bf16 v[128:143], v[228:231], v[200:203], v[128:143]
    ds_read_b64_tr_b16 v[224:225], v71 offset:13312
    ds_read_b64_tr_b16 v[226:227], v71 offset:13824
    s_waitcnt lgkmcnt(10)
    v_mfma_f32_32x32x16_bf16 v[80:95], v[232:235], v[200:203], v[80:95]
    ds_read_b64_tr_b16 v[228:229], v70 offset:5120
    ds_read_b64_tr_b16 v[230:231], v70 offset:5632
    s_waitcnt lgkmcnt(10)
    v_mfma_f32_32x32x16_bf16 v[96:111], v[236:239], v[200:203], v[96:111]
    ds_read_b64_tr_b16 v[232:233], v71 offset:5120
    ds_read_b64_tr_b16 v[234:235], v71 offset:5632
    s_waitcnt lgkmcnt(10)
    v_mfma_f32_32x32x16_bf16 v[144:159], v[240:243], v[200:203], v[144:159]
    ds_read_b64_tr_b16 v[236:237], v70 offset:21504
    ds_read_b64_tr_b16 v[238:239], v70 offset:22016
    s_waitcnt lgkmcnt(10)
    v_mfma_f32_32x32x16_bf16 v[160:175], v[244:247], v[200:203], v[160:175]
    ds_read_b64_tr_b16 v[240:241], v71 offset:21504
    ds_read_b64_tr_b16 v[242:243], v71 offset:22016
    buffer_load_dwordx4 v[200:203], v2, s[32:35], s16 offen offset:2048 sc1
    s_waitcnt vmcnt(11)
    s_waitcnt lgkmcnt(10)
    v_mfma_f32_32x32x16_bf16 v[112:127], v[248:251], v[204:207], v[112:127]
    s_barrier
    ds_read_b64_tr_b16 v[244:245], v70 offset:32768
    ds_read_b64_tr_b16 v[246:247], v70 offset:33280
    s_waitcnt lgkmcnt(10)
    v_mfma_f32_32x32x16_bf16 v[128:143], v[224:227], v[204:207], v[128:143]
    ds_read_b64_tr_b16 v[248:249], v71 offset:32768
    ds_read_b64_tr_b16 v[250:251], v71 offset:33280
    s_waitcnt lgkmcnt(10)
    v_mfma_f32_32x32x16_bf16 v[80:95], v[228:231], v[204:207], v[80:95]
    ds_read_b64_tr_b16 v[224:225], v70 offset:24576
    ds_read_b64_tr_b16 v[226:227], v70 offset:25088
    s_waitcnt lgkmcnt(10)
    v_mfma_f32_32x32x16_bf16 v[96:111], v[232:235], v[204:207], v[96:111]
    ds_read_b64_tr_b16 v[228:229], v71 offset:24576
    ds_read_b64_tr_b16 v[230:231], v71 offset:25088
    s_waitcnt lgkmcnt(10)
    v_mfma_f32_32x32x16_bf16 v[144:159], v[236:239], v[204:207], v[144:159]
    ds_read_b64_tr_b16 v[232:233], v70 offset:40960
    ds_read_b64_tr_b16 v[234:235], v70 offset:41472
    s_waitcnt lgkmcnt(10)
    v_mfma_f32_32x32x16_bf16 v[160:175], v[240:243], v[204:207], v[160:175]
    ds_read_b64_tr_b16 v[236:237], v71 offset:40960
    ds_read_b64_tr_b16 v[238:239], v71 offset:41472
    buffer_load_dwordx4 v[204:207], v2, s[32:35], s16 offen offset:3072 sc1
    s_waitcnt vmcnt(11)
    s_waitcnt lgkmcnt(10)
    v_mfma_f32_32x32x16_bf16 v[112:127], v[244:247], v[208:211], v[112:127]
    ds_read_b64_tr_b16 v[240:241], v70 offset:33792
    ds_read_b64_tr_b16 v[242:243], v70 offset:34304
    s_waitcnt lgkmcnt(10)
    v_mfma_f32_32x32x16_bf16 v[128:143], v[248:251], v[208:211], v[128:143]
    ds_read_b64_tr_b16 v[244:245], v71 offset:33792
    ds_read_b64_tr_b16 v[246:247], v71 offset:34304
    s_waitcnt lgkmcnt(10)
    v_mfma_f32_32x32x16_bf16 v[80:95], v[224:227], v[208:211], v[80:95]
    ds_read_b64_tr_b16 v[248:249], v70 offset:25600
    ds_read_b64_tr_b16 v[250:251], v70 offset:26112
    s_waitcnt lgkmcnt(10)
    v_mfma_f32_32x32x16_bf16 v[96:111], v[228:231], v[208:211], v[96:111]
    ds_read_b64_tr_b16 v[224:225], v71 offset:25600
    ds_read_b64_tr_b16 v[226:227], v71 offset:26112
    s_waitcnt lgkmcnt(10)
    v_mfma_f32_32x32x16_bf16 v[144:159], v[232:235], v[208:211], v[144:159]
    ds_read_b64_tr_b16 v[228:229], v70 offset:41984
    ds_read_b64_tr_b16 v[230:231], v70 offset:42496
    s_waitcnt lgkmcnt(10)
    v_mfma_f32_32x32x16_bf16 v[160:175], v[236:239], v[208:211], v[160:175]
    ds_read_b64_tr_b16 v[232:233], v71 offset:41984
    ds_read_b64_tr_b16 v[234:235], v71 offset:42496
    s_add_u32 s96, s85, 14
    s_and_b32 s97, s96, 15
    s_lshl_b32 s98, s97, 14
    s_add_u32 s16, s98, s15
    buffer_load_dwordx4 v[208:211], v2, s[32:35], s16 offen sc1
    s_waitcnt vmcnt(11)
    s_waitcnt lgkmcnt(10)
    v_mfma_f32_32x32x16_bf16 v[112:127], v[240:243], v[212:215], v[112:127]
    ds_read_b64_tr_b16 v[236:237], v70 offset:36864
    ds_read_b64_tr_b16 v[238:239], v70 offset:37376
    s_waitcnt lgkmcnt(10)
    v_mfma_f32_32x32x16_bf16 v[128:143], v[244:247], v[212:215], v[128:143]
    ds_read_b64_tr_b16 v[240:241], v71 offset:36864
    ds_read_b64_tr_b16 v[242:243], v71 offset:37376
    s_waitcnt lgkmcnt(10)
    v_mfma_f32_32x32x16_bf16 v[80:95], v[248:251], v[212:215], v[80:95]
    ds_read_b64_tr_b16 v[244:245], v70 offset:28672
    ds_read_b64_tr_b16 v[246:247], v70 offset:29184
    s_waitcnt lgkmcnt(10)
    v_mfma_f32_32x32x16_bf16 v[96:111], v[224:227], v[212:215], v[96:111]
    ds_read_b64_tr_b16 v[248:249], v71 offset:28672
    ds_read_b64_tr_b16 v[250:251], v71 offset:29184
    s_waitcnt lgkmcnt(10)
    v_mfma_f32_32x32x16_bf16 v[144:159], v[228:231], v[212:215], v[144:159]
    ds_read_b64_tr_b16 v[224:225], v70 offset:45056
    ds_read_b64_tr_b16 v[226:227], v70 offset:45568
    s_waitcnt lgkmcnt(10)
    v_mfma_f32_32x32x16_bf16 v[160:175], v[232:235], v[212:215], v[160:175]
    ds_read_b64_tr_b16 v[228:229], v71 offset:45056
    ds_read_b64_tr_b16 v[230:231], v71 offset:45568
    buffer_load_dwordx4 v[212:215], v2, s[32:35], s16 offen offset:1024 sc1
    s_waitcnt vmcnt(11)
    s_waitcnt lgkmcnt(10)
    v_mfma_f32_32x32x16_bf16 v[112:127], v[236:239], v[216:219], v[112:127]
    ds_read_b64_tr_b16 v[232:233], v70 offset:37888
    ds_read_b64_tr_b16 v[234:235], v70 offset:38400
    s_waitcnt lgkmcnt(10)
    v_mfma_f32_32x32x16_bf16 v[128:143], v[240:243], v[216:219], v[128:143]
    ds_read_b64_tr_b16 v[236:237], v71 offset:37888
    ds_read_b64_tr_b16 v[238:239], v71 offset:38400
    s_waitcnt lgkmcnt(10)
    v_mfma_f32_32x32x16_bf16 v[80:95], v[244:247], v[216:219], v[80:95]
    ds_read_b64_tr_b16 v[240:241], v70 offset:29696
    ds_read_b64_tr_b16 v[242:243], v70 offset:30208
    s_waitcnt lgkmcnt(10)
    v_mfma_f32_32x32x16_bf16 v[96:111], v[248:251], v[216:219], v[96:111]
    ds_read_b64_tr_b16 v[244:245], v71 offset:29696
    ds_read_b64_tr_b16 v[246:247], v71 offset:30208
    s_waitcnt lgkmcnt(10)
    v_mfma_f32_32x32x16_bf16 v[144:159], v[224:227], v[216:219], v[144:159]
    ds_read_b64_tr_b16 v[248:249], v70 offset:46080
    ds_read_b64_tr_b16 v[250:251], v70 offset:46592
    s_waitcnt lgkmcnt(10)
    v_mfma_f32_32x32x16_bf16 v[160:175], v[228:231], v[216:219], v[160:175]
    ds_read_b64_tr_b16 v[224:225], v71 offset:46080
    ds_read_b64_tr_b16 v[226:227], v71 offset:46592
    buffer_load_dwordx4 v[216:219], v2, s[32:35], s16 offen offset:2048 sc1
    s_waitcnt vmcnt(11)
    s_waitcnt lgkmcnt(10)
    v_mfma_f32_32x32x16_bf16 v[112:127], v[232:235], v[220:223], v[112:127]
    s_barrier
    ds_read_b64_tr_b16 v[228:229], v66 offset:8192
    ds_read_b64_tr_b16 v[230:231], v66 offset:8704
    s_waitcnt lgkmcnt(10)
    v_mfma_f32_32x32x16_bf16 v[128:143], v[236:239], v[220:223], v[128:143]
    ds_read_b64_tr_b16 v[232:233], v67 offset:8192
    ds_read_b64_tr_b16 v[234:235], v67 offset:8704
    s_waitcnt lgkmcnt(10)
    v_mfma_f32_32x32x16_bf16 v[80:95], v[240:243], v[220:223], v[80:95]
    ds_read_b64_tr_b16 v[236:237], v66
    ds_read_b64_tr_b16 v[238:239], v66 offset:512
    s_waitcnt lgkmcnt(10)
    v_mfma_f32_32x32x16_bf16 v[96:111], v[244:247], v[220:223], v[96:111]
    ds_read_b64_tr_b16 v[240:241], v67
    ds_read_b64_tr_b16 v[242:243], v67 offset:512
    s_waitcnt lgkmcnt(10)
    v_mfma_f32_32x32x16_bf16 v[144:159], v[248:251], v[220:223], v[144:159]
    ds_read_b64_tr_b16 v[244:245], v66 offset:16384
    ds_read_b64_tr_b16 v[246:247], v66 offset:16896
    s_waitcnt lgkmcnt(10)
    v_mfma_f32_32x32x16_bf16 v[160:175], v[224:227], v[220:223], v[160:175]
    ds_read_b64_tr_b16 v[248:249], v67 offset:16384
    ds_read_b64_tr_b16 v[250:251], v67 offset:16896
    buffer_load_dwordx4 v[220:223], v2, s[32:35], s16 offen offset:3072 sc1
    s_waitcnt vmcnt(11)
    s_waitcnt lgkmcnt(10)
    v_mfma_f32_32x32x16_bf16 v[112:127], v[228:231], v[176:179], v[112:127]
    ds_read_b64_tr_b16 v[224:225], v66 offset:9216
    ds_read_b64_tr_b16 v[226:227], v66 offset:9728
    s_waitcnt lgkmcnt(10)
    v_mfma_f32_32x32x16_bf16 v[128:143], v[232:235], v[176:179], v[128:143]
    ds_read_b64_tr_b16 v[228:229], v67 offset:9216
    ds_read_b64_tr_b16 v[230:231], v67 offset:9728
    s_waitcnt lgkmcnt(10)
    v_mfma_f32_32x32x16_bf16 v[80:95], v[236:239], v[176:179], v[80:95]
    ds_read_b64_tr_b16 v[232:233], v66 offset:1024
    ds_read_b64_tr_b16 v[234:235], v66 offset:1536
    s_waitcnt lgkmcnt(10)
    v_mfma_f32_32x32x16_bf16 v[96:111], v[240:243], v[176:179], v[96:111]
    ds_read_b64_tr_b16 v[236:237], v67 offset:1024
    ds_read_b64_tr_b16 v[238:239], v67 offset:1536
    s_waitcnt lgkmcnt(10)
    v_mfma_f32_32x32x16_bf16 v[144:159], v[244:247], v[176:179], v[144:159]
    ds_read_b64_tr_b16 v[240:241], v66 offset:17408
    ds_read_b64_tr_b16 v[242:243], v66 offset:17920
    s_waitcnt lgkmcnt(10)
    v_mfma_f32_32x32x16_bf16 v[160:175], v[248:251], v[176:179], v[160:175]
    ds_read_b64_tr_b16 v[244:245], v67 offset:17408
    ds_read_b64_tr_b16 v[246:247], v67 offset:17920
    s_add_u32 s96, s85, 15
    s_and_b32 s97, s96, 15
    s_lshl_b32 s98, s97, 14
    s_add_u32 s16, s98, s15
    buffer_load_dwordx4 v[176:179], v2, s[32:35], s16 offen sc1
    s_waitcnt vmcnt(11)
    s_waitcnt lgkmcnt(10)
    v_mfma_f32_32x32x16_bf16 v[112:127], v[224:227], v[180:183], v[112:127]
    ds_read_b64_tr_b16 v[248:249], v66 offset:12288
    ds_read_b64_tr_b16 v[250:251], v66 offset:12800
    s_waitcnt lgkmcnt(10)
    v_mfma_f32_32x32x16_bf16 v[128:143], v[228:231], v[180:183], v[128:143]
    ds_read_b64_tr_b16 v[224:225], v67 offset:12288
    ds_read_b64_tr_b16 v[226:227], v67 offset:12800
    s_waitcnt lgkmcnt(10)
    v_mfma_f32_32x32x16_bf16 v[80:95], v[232:235], v[180:183], v[80:95]
    ds_read_b64_tr_b16 v[228:229], v66 offset:4096
    ds_read_b64_tr_b16 v[230:231], v66 offset:4608
    s_waitcnt lgkmcnt(10)
    v_mfma_f32_32x32x16_bf16 v[96:111], v[236:239], v[180:183], v[96:111]
    ds_read_b64_tr_b16 v[232:233], v67 offset:4096
    ds_read_b64_tr_b16 v[234:235], v67 offset:4608
    s_waitcnt lgkmcnt(10)
    v_mfma_f32_32x32x16_bf16 v[144:159], v[240:243], v[180:183], v[144:159]
    ds_read_b64_tr_b16 v[236:237], v66 offset:20480
    ds_read_b64_tr_b16 v[238:239], v66 offset:20992
    s_waitcnt lgkmcnt(10)
    v_mfma_f32_32x32x16_bf16 v[160:175], v[244:247], v[180:183], v[160:175]
    ds_read_b64_tr_b16 v[240:241], v67 offset:20480
    ds_read_b64_tr_b16 v[242:243], v67 offset:20992
    buffer_load_dwordx4 v[180:183], v2, s[32:35], s16 offen offset:1024 sc1
    s_waitcnt vmcnt(11)
    s_waitcnt lgkmcnt(10)
    v_mfma_f32_32x32x16_bf16 v[112:127], v[248:251], v[184:187], v[112:127]
    ds_read_b64_tr_b16 v[244:245], v66 offset:13312
    ds_read_b64_tr_b16 v[246:247], v66 offset:13824
    s_waitcnt lgkmcnt(10)
    v_mfma_f32_32x32x16_bf16 v[128:143], v[224:227], v[184:187], v[128:143]
    ds_read_b64_tr_b16 v[248:249], v67 offset:13312
    ds_read_b64_tr_b16 v[250:251], v67 offset:13824
    s_waitcnt lgkmcnt(10)
    v_mfma_f32_32x32x16_bf16 v[80:95], v[228:231], v[184:187], v[80:95]
    ds_read_b64_tr_b16 v[224:225], v66 offset:5120
    ds_read_b64_tr_b16 v[226:227], v66 offset:5632
    s_waitcnt lgkmcnt(10)
    v_mfma_f32_32x32x16_bf16 v[96:111], v[232:235], v[184:187], v[96:111]
    ds_read_b64_tr_b16 v[228:229], v67 offset:5120
    ds_read_b64_tr_b16 v[230:231], v67 offset:5632
    s_waitcnt lgkmcnt(10)
    v_mfma_f32_32x32x16_bf16 v[144:159], v[236:239], v[184:187], v[144:159]
    ds_read_b64_tr_b16 v[232:233], v66 offset:21504
    ds_read_b64_tr_b16 v[234:235], v66 offset:22016
    s_waitcnt lgkmcnt(10)
    v_mfma_f32_32x32x16_bf16 v[160:175], v[240:243], v[184:187], v[160:175]
    ds_read_b64_tr_b16 v[236:237], v67 offset:21504
    ds_read_b64_tr_b16 v[238:239], v67 offset:22016
    buffer_load_dwordx4 v[184:187], v2, s[32:35], s16 offen offset:2048 sc1
    s_waitcnt vmcnt(11)
    s_waitcnt lgkmcnt(10)
    v_mfma_f32_32x32x16_bf16 v[112:127], v[244:247], v[188:191], v[112:127]
    s_barrier
    ds_read_b64_tr_b16 v[240:241], v66 offset:32768
    ds_read_b64_tr_b16 v[242:243], v66 offset:33280
    s_waitcnt lgkmcnt(10)
    v_mfma_f32_32x32x16_bf16 v[128:143], v[248:251], v[188:191], v[128:143]
    ds_read_b64_tr_b16 v[244:245], v67 offset:32768
    ds_read_b64_tr_b16 v[246:247], v67 offset:33280
    s_waitcnt lgkmcnt(10)
    v_mfma_f32_32x32x16_bf16 v[80:95], v[224:227], v[188:191], v[80:95]
    ds_read_b64_tr_b16 v[248:249], v66 offset:24576
    ds_read_b64_tr_b16 v[250:251], v66 offset:25088
    s_waitcnt lgkmcnt(10)
    v_mfma_f32_32x32x16_bf16 v[96:111], v[228:231], v[188:191], v[96:111]
    ds_read_b64_tr_b16 v[224:225], v67 offset:24576
    ds_read_b64_tr_b16 v[226:227], v67 offset:25088
    s_waitcnt lgkmcnt(10)
    v_mfma_f32_32x32x16_bf16 v[144:159], v[232:235], v[188:191], v[144:159]
    ds_read_b64_tr_b16 v[228:229], v66 offset:40960
    ds_read_b64_tr_b16 v[230:231], v66 offset:41472
    s_waitcnt lgkmcnt(10)
    v_mfma_f32_32x32x16_bf16 v[160:175], v[236:239], v[188:191], v[160:175]
    ds_read_b64_tr_b16 v[232:233], v67 offset:40960
    ds_read_b64_tr_b16 v[234:235], v67 offset:41472
    buffer_load_dwordx4 v[188:191], v2, s[32:35], s16 offen offset:3072 sc1
    s_barrier
    s_waitcnt vmcnt(11)
    s_waitcnt lgkmcnt(10)
    v_mfma_f32_32x32x16_bf16 v[112:127], v[240:243], v[192:195], v[112:127]
    ds_read_b64_tr_b16 v[236:237], v66 offset:33792
    ds_read_b64_tr_b16 v[238:239], v66 offset:34304
    s_waitcnt lgkmcnt(10)
    v_mfma_f32_32x32x16_bf16 v[128:143], v[244:247], v[192:195], v[128:143]
    ds_read_b64_tr_b16 v[240:241], v67 offset:33792
    ds_read_b64_tr_b16 v[242:243], v67 offset:34304
    s_waitcnt lgkmcnt(10)
    v_mfma_f32_32x32x16_bf16 v[80:95], v[248:251], v[192:195], v[80:95]
    ds_read_b64_tr_b16 v[244:245], v66 offset:25600
    ds_read_b64_tr_b16 v[246:247], v66 offset:26112
    s_waitcnt lgkmcnt(10)
    v_mfma_f32_32x32x16_bf16 v[96:111], v[224:227], v[192:195], v[96:111]
    ds_read_b64_tr_b16 v[248:249], v67 offset:25600
    ds_read_b64_tr_b16 v[250:251], v67 offset:26112
    s_waitcnt lgkmcnt(10)
    v_mfma_f32_32x32x16_bf16 v[144:159], v[228:231], v[192:195], v[144:159]
    ds_read_b64_tr_b16 v[224:225], v66 offset:41984
    ds_read_b64_tr_b16 v[226:227], v66 offset:42496
    s_waitcnt lgkmcnt(10)
    v_mfma_f32_32x32x16_bf16 v[160:175], v[232:235], v[192:195], v[160:175]
    ds_read_b64_tr_b16 v[228:229], v67 offset:41984
    ds_read_b64_tr_b16 v[230:231], v67 offset:42496
    s_waitcnt vmcnt(10)
    s_waitcnt lgkmcnt(10)
    v_mfma_f32_32x32x16_bf16 v[112:127], v[236:239], v[196:199], v[112:127]
    ds_read_b64_tr_b16 v[232:233], v66 offset:36864
    ds_read_b64_tr_b16 v[234:235], v66 offset:37376
    s_waitcnt lgkmcnt(10)
    v_mfma_f32_32x32x16_bf16 v[128:143], v[240:243], v[196:199], v[128:143]
    ds_read_b64_tr_b16 v[236:237], v67 offset:36864
    ds_read_b64_tr_b16 v[238:239], v67 offset:37376
    s_waitcnt lgkmcnt(10)
    v_mfma_f32_32x32x16_bf16 v[80:95], v[244:247], v[196:199], v[80:95]
    ds_read_b64_tr_b16 v[240:241], v66 offset:28672
    ds_read_b64_tr_b16 v[242:243], v66 offset:29184
    s_waitcnt lgkmcnt(10)
    v_mfma_f32_32x32x16_bf16 v[96:111], v[248:251], v[196:199], v[96:111]
    ds_read_b64_tr_b16 v[244:245], v67 offset:28672
    ds_read_b64_tr_b16 v[246:247], v67 offset:29184
    s_waitcnt lgkmcnt(10)
    v_mfma_f32_32x32x16_bf16 v[144:159], v[224:227], v[196:199], v[144:159]
    ds_read_b64_tr_b16 v[248:249], v66 offset:45056
    ds_read_b64_tr_b16 v[250:251], v66 offset:45568
    s_waitcnt lgkmcnt(10)
    v_mfma_f32_32x32x16_bf16 v[160:175], v[228:231], v[196:199], v[160:175]
    ds_read_b64_tr_b16 v[224:225], v67 offset:45056
    ds_read_b64_tr_b16 v[226:227], v67 offset:45568
    s_waitcnt vmcnt(9)
    s_waitcnt lgkmcnt(10)
    v_mfma_f32_32x32x16_bf16 v[112:127], v[232:235], v[200:203], v[112:127]
    ds_read_b64_tr_b16 v[228:229], v66 offset:37888
    ds_read_b64_tr_b16 v[230:231], v66 offset:38400
    s_waitcnt lgkmcnt(10)
    v_mfma_f32_32x32x16_bf16 v[128:143], v[236:239], v[200:203], v[128:143]
    ds_read_b64_tr_b16 v[232:233], v67 offset:37888
    ds_read_b64_tr_b16 v[234:235], v67 offset:38400
    s_waitcnt lgkmcnt(10)
    v_mfma_f32_32x32x16_bf16 v[80:95], v[240:243], v[200:203], v[80:95]
    ds_read_b64_tr_b16 v[236:237], v66 offset:29696
    ds_read_b64_tr_b16 v[238:239], v66 offset:30208
    s_waitcnt lgkmcnt(10)
    v_mfma_f32_32x32x16_bf16 v[96:111], v[244:247], v[200:203], v[96:111]
    ds_read_b64_tr_b16 v[240:241], v67 offset:29696
    ds_read_b64_tr_b16 v[242:243], v67 offset:30208
    s_waitcnt lgkmcnt(10)
    v_mfma_f32_32x32x16_bf16 v[144:159], v[248:251], v[200:203], v[144:159]
    ds_read_b64_tr_b16 v[244:245], v66 offset:46080
    ds_read_b64_tr_b16 v[246:247], v66 offset:46592
    s_waitcnt lgkmcnt(10)
    v_mfma_f32_32x32x16_bf16 v[160:175], v[224:227], v[200:203], v[160:175]
    ds_read_b64_tr_b16 v[248:249], v67 offset:46080
    ds_read_b64_tr_b16 v[250:251], v67 offset:46592
    s_waitcnt vmcnt(8)
    s_waitcnt lgkmcnt(10)
    v_mfma_f32_32x32x16_bf16 v[112:127], v[228:231], v[204:207], v[112:127]
    ds_read_b64_tr_b16 v[224:225], v68 offset:8192
    ds_read_b64_tr_b16 v[226:227], v68 offset:8704
    s_waitcnt lgkmcnt(10)
    v_mfma_f32_32x32x16_bf16 v[128:143], v[232:235], v[204:207], v[128:143]
    ds_read_b64_tr_b16 v[228:229], v69 offset:8192
    ds_read_b64_tr_b16 v[230:231], v69 offset:8704
    s_waitcnt lgkmcnt(10)
    v_mfma_f32_32x32x16_bf16 v[80:95], v[236:239], v[204:207], v[80:95]
    ds_read_b64_tr_b16 v[232:233], v68
    ds_read_b64_tr_b16 v[234:235], v68 offset:512
    s_waitcnt lgkmcnt(10)
    v_mfma_f32_32x32x16_bf16 v[96:111], v[240:243], v[204:207], v[96:111]
    ds_read_b64_tr_b16 v[236:237], v69
    ds_read_b64_tr_b16 v[238:239], v69 offset:512
    s_waitcnt lgkmcnt(10)
    v_mfma_f32_32x32x16_bf16 v[144:159], v[244:247], v[204:207], v[144:159]
    ds_read_b64_tr_b16 v[240:241], v68 offset:16384
    ds_read_b64_tr_b16 v[242:243], v68 offset:16896
    s_waitcnt lgkmcnt(10)
    v_mfma_f32_32x32x16_bf16 v[160:175], v[248:251], v[204:207], v[160:175]
    ds_read_b64_tr_b16 v[244:245], v69 offset:16384
    ds_read_b64_tr_b16 v[246:247], v69 offset:16896
    s_waitcnt vmcnt(7)
    s_waitcnt lgkmcnt(10)
    v_mfma_f32_32x32x16_bf16 v[112:127], v[224:227], v[208:211], v[112:127]
    ds_read_b64_tr_b16 v[248:249], v68 offset:9216
    ds_read_b64_tr_b16 v[250:251], v68 offset:9728
    s_waitcnt lgkmcnt(10)
    v_mfma_f32_32x32x16_bf16 v[128:143], v[228:231], v[208:211], v[128:143]
    ds_read_b64_tr_b16 v[224:225], v69 offset:9216
    ds_read_b64_tr_b16 v[226:227], v69 offset:9728
    s_waitcnt lgkmcnt(10)
    v_mfma_f32_32x32x16_bf16 v[80:95], v[232:235], v[208:211], v[80:95]
    ds_read_b64_tr_b16 v[228:229], v68 offset:1024
    ds_read_b64_tr_b16 v[230:231], v68 offset:1536
    s_waitcnt lgkmcnt(10)
    v_mfma_f32_32x32x16_bf16 v[96:111], v[236:239], v[208:211], v[96:111]
    ds_read_b64_tr_b16 v[232:233], v69 offset:1024
    ds_read_b64_tr_b16 v[234:235], v69 offset:1536
    s_waitcnt lgkmcnt(10)
    v_mfma_f32_32x32x16_bf16 v[144:159], v[240:243], v[208:211], v[144:159]
    ds_read_b64_tr_b16 v[236:237], v68 offset:17408
    ds_read_b64_tr_b16 v[238:239], v68 offset:17920
    s_waitcnt lgkmcnt(10)
    v_mfma_f32_32x32x16_bf16 v[160:175], v[244:247], v[208:211], v[160:175]
    ds_read_b64_tr_b16 v[240:241], v69 offset:17408
    ds_read_b64_tr_b16 v[242:243], v69 offset:17920
    s_waitcnt vmcnt(6)
    s_waitcnt lgkmcnt(10)
    v_mfma_f32_32x32x16_bf16 v[112:127], v[248:251], v[212:215], v[112:127]
    ds_read_b64_tr_b16 v[244:245], v68 offset:12288
    ds_read_b64_tr_b16 v[246:247], v68 offset:12800
    s_waitcnt lgkmcnt(10)
    v_mfma_f32_32x32x16_bf16 v[128:143], v[224:227], v[212:215], v[128:143]
    ds_read_b64_tr_b16 v[248:249], v69 offset:12288
    ds_read_b64_tr_b16 v[250:251], v69 offset:12800
    s_waitcnt lgkmcnt(10)
    v_mfma_f32_32x32x16_bf16 v[80:95], v[228:231], v[212:215], v[80:95]
    ds_read_b64_tr_b16 v[224:225], v68 offset:4096
    ds_read_b64_tr_b16 v[226:227], v68 offset:4608
    s_waitcnt lgkmcnt(10)
    v_mfma_f32_32x32x16_bf16 v[96:111], v[232:235], v[212:215], v[96:111]
    ds_read_b64_tr_b16 v[228:229], v69 offset:4096
    ds_read_b64_tr_b16 v[230:231], v69 offset:4608
    s_waitcnt lgkmcnt(10)
    v_mfma_f32_32x32x16_bf16 v[144:159], v[236:239], v[212:215], v[144:159]
    ds_read_b64_tr_b16 v[232:233], v68 offset:20480
    ds_read_b64_tr_b16 v[234:235], v68 offset:20992
    s_waitcnt lgkmcnt(10)
    v_mfma_f32_32x32x16_bf16 v[160:175], v[240:243], v[212:215], v[160:175]
    ds_read_b64_tr_b16 v[236:237], v69 offset:20480
    ds_read_b64_tr_b16 v[238:239], v69 offset:20992
    s_waitcnt vmcnt(5)
    s_waitcnt lgkmcnt(10)
    v_mfma_f32_32x32x16_bf16 v[112:127], v[244:247], v[216:219], v[112:127]
    ds_read_b64_tr_b16 v[240:241], v68 offset:13312
    ds_read_b64_tr_b16 v[242:243], v68 offset:13824
    s_waitcnt lgkmcnt(10)
    v_mfma_f32_32x32x16_bf16 v[128:143], v[248:251], v[216:219], v[128:143]
    ds_read_b64_tr_b16 v[244:245], v69 offset:13312
    ds_read_b64_tr_b16 v[246:247], v69 offset:13824
    s_waitcnt lgkmcnt(10)
    v_mfma_f32_32x32x16_bf16 v[80:95], v[224:227], v[216:219], v[80:95]
    ds_read_b64_tr_b16 v[248:249], v68 offset:5120
    ds_read_b64_tr_b16 v[250:251], v68 offset:5632
    s_waitcnt lgkmcnt(10)
    v_mfma_f32_32x32x16_bf16 v[96:111], v[228:231], v[216:219], v[96:111]
    ds_read_b64_tr_b16 v[224:225], v69 offset:5120
    ds_read_b64_tr_b16 v[226:227], v69 offset:5632
    s_waitcnt lgkmcnt(10)
    v_mfma_f32_32x32x16_bf16 v[144:159], v[232:235], v[216:219], v[144:159]
    ds_read_b64_tr_b16 v[228:229], v68 offset:21504
    ds_read_b64_tr_b16 v[230:231], v68 offset:22016
    s_waitcnt lgkmcnt(10)
    v_mfma_f32_32x32x16_bf16 v[160:175], v[236:239], v[216:219], v[160:175]
    ds_read_b64_tr_b16 v[232:233], v69 offset:21504
    ds_read_b64_tr_b16 v[234:235], v69 offset:22016
    s_waitcnt vmcnt(4)
    s_waitcnt lgkmcnt(10)
    v_mfma_f32_32x32x16_bf16 v[112:127], v[240:243], v[220:223], v[112:127]
    ds_read_b64_tr_b16 v[236:237], v68 offset:32768
    ds_read_b64_tr_b16 v[238:239], v68 offset:33280
    s_waitcnt lgkmcnt(10)
    v_mfma_f32_32x32x16_bf16 v[128:143], v[244:247], v[220:223], v[128:143]
    ds_read_b64_tr_b16 v[240:241], v69 offset:32768
    ds_read_b64_tr_b16 v[242:243], v69 offset:33280
    s_waitcnt lgkmcnt(10)
    v_mfma_f32_32x32x16_bf16 v[80:95], v[248:251], v[220:223], v[80:95]
    ds_read_b64_tr_b16 v[244:245], v68 offset:24576
    ds_read_b64_tr_b16 v[246:247], v68 offset:25088
    s_waitcnt lgkmcnt(10)
    v_mfma_f32_32x32x16_bf16 v[96:111], v[224:227], v[220:223], v[96:111]
    ds_read_b64_tr_b16 v[248:249], v69 offset:24576
    ds_read_b64_tr_b16 v[250:251], v69 offset:25088
    s_waitcnt lgkmcnt(10)
    v_mfma_f32_32x32x16_bf16 v[144:159], v[228:231], v[220:223], v[144:159]
    ds_read_b64_tr_b16 v[224:225], v68 offset:40960
    ds_read_b64_tr_b16 v[226:227], v68 offset:41472
    s_waitcnt lgkmcnt(10)
    v_mfma_f32_32x32x16_bf16 v[160:175], v[232:235], v[220:223], v[160:175]
    ds_read_b64_tr_b16 v[228:229], v69 offset:40960
    ds_read_b64_tr_b16 v[230:231], v69 offset:41472
    s_waitcnt vmcnt(3)
    s_waitcnt lgkmcnt(10)
    v_mfma_f32_32x32x16_bf16 v[112:127], v[236:239], v[176:179], v[112:127]
    ds_read_b64_tr_b16 v[232:233], v68 offset:33792
    ds_read_b64_tr_b16 v[234:235], v68 offset:34304
    s_waitcnt lgkmcnt(10)
    v_mfma_f32_32x32x16_bf16 v[128:143], v[240:243], v[176:179], v[128:143]
    ds_read_b64_tr_b16 v[236:237], v69 offset:33792
    ds_read_b64_tr_b16 v[238:239], v69 offset:34304
    s_waitcnt lgkmcnt(10)
    v_mfma_f32_32x32x16_bf16 v[80:95], v[244:247], v[176:179], v[80:95]
    ds_read_b64_tr_b16 v[240:241], v68 offset:25600
    ds_read_b64_tr_b16 v[242:243], v68 offset:26112
    s_waitcnt lgkmcnt(10)
    v_mfma_f32_32x32x16_bf16 v[96:111], v[248:251], v[176:179], v[96:111]
    ds_read_b64_tr_b16 v[244:245], v69 offset:25600
    ds_read_b64_tr_b16 v[246:247], v69 offset:26112
    s_waitcnt lgkmcnt(10)
    v_mfma_f32_32x32x16_bf16 v[144:159], v[224:227], v[176:179], v[144:159]
    ds_read_b64_tr_b16 v[248:249], v68 offset:41984
    ds_read_b64_tr_b16 v[250:251], v68 offset:42496
    s_waitcnt lgkmcnt(10)
    v_mfma_f32_32x32x16_bf16 v[160:175], v[228:231], v[176:179], v[160:175]
    ds_read_b64_tr_b16 v[224:225], v69 offset:41984
    ds_read_b64_tr_b16 v[226:227], v69 offset:42496
    s_waitcnt vmcnt(2)
    s_waitcnt lgkmcnt(10)
    v_mfma_f32_32x32x16_bf16 v[112:127], v[232:235], v[180:183], v[112:127]
    ds_read_b64_tr_b16 v[228:229], v68 offset:36864
    ds_read_b64_tr_b16 v[230:231], v68 offset:37376
    s_waitcnt lgkmcnt(10)
    v_mfma_f32_32x32x16_bf16 v[128:143], v[236:239], v[180:183], v[128:143]
    ds_read_b64_tr_b16 v[232:233], v69 offset:36864
    ds_read_b64_tr_b16 v[234:235], v69 offset:37376
    s_waitcnt lgkmcnt(10)
    v_mfma_f32_32x32x16_bf16 v[80:95], v[240:243], v[180:183], v[80:95]
    ds_read_b64_tr_b16 v[236:237], v68 offset:28672
    ds_read_b64_tr_b16 v[238:239], v68 offset:29184
    s_waitcnt lgkmcnt(10)
    v_mfma_f32_32x32x16_bf16 v[96:111], v[244:247], v[180:183], v[96:111]
    ds_read_b64_tr_b16 v[240:241], v69 offset:28672
    ds_read_b64_tr_b16 v[242:243], v69 offset:29184
    s_waitcnt lgkmcnt(10)
    v_mfma_f32_32x32x16_bf16 v[144:159], v[248:251], v[180:183], v[144:159]
    ds_read_b64_tr_b16 v[244:245], v68 offset:45056
    ds_read_b64_tr_b16 v[246:247], v68 offset:45568
    s_waitcnt lgkmcnt(10)
    v_mfma_f32_32x32x16_bf16 v[160:175], v[224:227], v[180:183], v[160:175]
    ds_read_b64_tr_b16 v[248:249], v69 offset:45056
    ds_read_b64_tr_b16 v[250:251], v69 offset:45568
    s_waitcnt vmcnt(1)
    s_waitcnt lgkmcnt(10)
    v_mfma_f32_32x32x16_bf16 v[112:127], v[228:231], v[184:187], v[112:127]
    ds_read_b64_tr_b16 v[224:225], v68 offset:37888
    ds_read_b64_tr_b16 v[226:227], v68 offset:38400
    s_waitcnt lgkmcnt(10)
    v_mfma_f32_32x32x16_bf16 v[128:143], v[232:235], v[184:187], v[128:143]
    ds_read_b64_tr_b16 v[228:229], v69 offset:37888
    ds_read_b64_tr_b16 v[230:231], v69 offset:38400
    s_waitcnt lgkmcnt(10)
    v_mfma_f32_32x32x16_bf16 v[80:95], v[236:239], v[184:187], v[80:95]
    ds_read_b64_tr_b16 v[232:233], v68 offset:29696
    ds_read_b64_tr_b16 v[234:235], v68 offset:30208
    s_waitcnt lgkmcnt(10)
    v_mfma_f32_32x32x16_bf16 v[96:111], v[240:243], v[184:187], v[96:111]
    ds_read_b64_tr_b16 v[236:237], v69 offset:29696
    ds_read_b64_tr_b16 v[238:239], v69 offset:30208
    s_waitcnt lgkmcnt(10)
    v_mfma_f32_32x32x16_bf16 v[144:159], v[244:247], v[184:187], v[144:159]
    ds_read_b64_tr_b16 v[240:241], v68 offset:46080
    ds_read_b64_tr_b16 v[242:243], v68 offset:46592
    s_waitcnt lgkmcnt(10)
    v_mfma_f32_32x32x16_bf16 v[160:175], v[248:251], v[184:187], v[160:175]
    ds_read_b64_tr_b16 v[244:245], v69 offset:46080
    ds_read_b64_tr_b16 v[246:247], v69 offset:46592
    s_waitcnt vmcnt(0)
    s_waitcnt lgkmcnt(10)
    v_mfma_f32_32x32x16_bf16 v[112:127], v[224:227], v[188:191], v[112:127]
    s_waitcnt lgkmcnt(8)
    v_mfma_f32_32x32x16_bf16 v[128:143], v[228:231], v[188:191], v[128:143]
    s_waitcnt lgkmcnt(6)
    v_mfma_f32_32x32x16_bf16 v[80:95], v[232:235], v[188:191], v[80:95]
    s_waitcnt lgkmcnt(4)
    v_mfma_f32_32x32x16_bf16 v[96:111], v[236:239], v[188:191], v[96:111]
    s_waitcnt lgkmcnt(2)
    v_mfma_f32_32x32x16_bf16 v[144:159], v[240:243], v[188:191], v[144:159]
    s_waitcnt lgkmcnt(0)
    v_mfma_f32_32x32x16_bf16 v[160:175], v[244:247], v[188:191], v[160:175]
    s_nop 3
    v_cvt_pk_bf16_f32 v52, v128, v129
    v_cvt_pk_bf16_f32 v53, v130, v131
    v_cvt_pk_bf16_f32 v54, v132, v133
    v_cvt_pk_bf16_f32 v55, v134, v135
    v_cvt_pk_bf16_f32 v56, v136, v137
    v_cvt_pk_bf16_f32 v57, v138, v139
    v_cvt_pk_bf16_f32 v58, v140, v141
    v_cvt_pk_bf16_f32 v59, v142, v143
    ds_write_b128 v76, v[52:55]
    ds_write_b128 v76, v[56:59] offset:1024
    v_cvt_pk_bf16_f32 v36, v112, v113
    v_cvt_pk_bf16_f32 v37, v114, v115
    v_cvt_pk_bf16_f32 v38, v116, v117
    v_cvt_pk_bf16_f32 v39, v118, v119
    v_cvt_pk_bf16_f32 v40, v120, v121
    v_cvt_pk_bf16_f32 v41, v122, v123
    v_cvt_pk_bf16_f32 v42, v124, v125
    v_cvt_pk_bf16_f32 v43, v126, v127
    s_waitcnt lgkmcnt(0)
    s_barrier
    s_setprio 0
    v_mfma_f32_32x32x16_bf16 v[112:127], v[28:31], v[36:39], 0
    v_mfma_f32_32x32x16_bf16 v[112:127], v[32:35], v[40:43], v[112:127]
    v_cvt_pk_bf16_f32 v52, v144, v145
    v_cvt_pk_bf16_f32 v53, v146, v147
    v_cvt_pk_bf16_f32 v54, v148, v149
    v_cvt_pk_bf16_f32 v55, v150, v151
    v_cvt_pk_bf16_f32 v56, v152, v153
    v_cvt_pk_bf16_f32 v57, v154, v155
    v_cvt_pk_bf16_f32 v58, v156, v157
    v_cvt_pk_bf16_f32 v59, v158, v159
    ds_write_b128 v75, v[52:55] offset:32768
    ds_write_b128 v75, v[56:59] offset:36864
    v_cvt_pk_bf16_f32 v44, v160, v161
    v_cvt_pk_bf16_f32 v45, v162, v163
    v_cvt_pk_bf16_f32 v46, v164, v165
    v_cvt_pk_bf16_f32 v47, v166, v167
    v_cvt_pk_bf16_f32 v48, v168, v169
    v_cvt_pk_bf16_f32 v49, v170, v171
    v_cvt_pk_bf16_f32 v50, v172, v173
    v_cvt_pk_bf16_f32 v51, v174, v175
    ds_write_b128 v75, v[44:47] offset:40960
    ds_write_b128 v75, v[48:51] offset:45056
    v_cvt_pk_bf16_f32 v36, v96, v97
    v_cvt_pk_bf16_f32 v37, v98, v99
    v_cvt_pk_bf16_f32 v38, v100, v101
    v_cvt_pk_bf16_f32 v39, v102, v103
    v_cvt_pk_bf16_f32 v40, v104, v105
    v_cvt_pk_bf16_f32 v41, v106, v107
    v_cvt_pk_bf16_f32 v42, v108, v109
    v_cvt_pk_bf16_f32 v43, v110, v111
    ds_write_b128 v76, v[36:39] offset:2048
    ds_write_b128 v76, v[40:43] offset:3072
    v_cvt_pk_bf16_f32 v44, v80, v81
    v_cvt_pk_bf16_f32 v45, v82, v83
    v_cvt_pk_bf16_f32 v46, v84, v85
    v_cvt_pk_bf16_f32 v47, v86, v87
    v_cvt_pk_bf16_f32 v48, v88, v89
    v_cvt_pk_bf16_f32 v49, v90, v91
    v_cvt_pk_bf16_f32 v50, v92, v93
    v_cvt_pk_bf16_f32 v51, v94, v95
    s_branch L_JOIN
L_HELP:
    s_lshr_b32 s96, s8, 2
    s_lshr_b32 s97, s9, 4
    s_lshl1_add_u32 s20, s96, s97
    s_cmp_le_u32 s20, 2
    s_cselect_b32 s20, 3, 2
    s_add_u32 s96, s20, s85
    s_and_b32 s97, s96, 15
    s_lshl3_add_u32 s98, s97, s3
    s_sub_u32 s99, s98, 4
    s_mul_i32 s96, s99, 49152
    s_lshl_b32 s97, s11, 7
    s_add_u32 s82, s96, s97
    s_mul_i32 s96, s20, 24576
    s_sub_u32 s97, s3, 4
    s_lshl_b32 s98, s97, 10
    s_add_u32 s20, s96, s98
    s_mov_b32 m0, s20
    s_nop 0
    buffer_load_dwordx4 v62, s[40:43], s82 offen lds
    s_add_u32 s82, s82, 2048
    s_add_u32 m0, s20, 8192
    s_nop 0
    buffer_load_dwordx4 v62, s[40:43], s82 offen lds
    s_add_u32 s82, s82, 2048
    s_add_u32 m0, s20, 16384
    s_nop 0
    buffer_load_dwordx4 v62, s[40:43], s82 offen lds
    s_lshr_b32 s96, s8, 2
    s_lshr_b32 s97, s9, 4
    s_lshl1_add_u32 s20, s96, s97
    s_cmp_le_u32 s20, 2
    s_cselect_b32 s20, 3, 2
    s_add_u32 s96, s20, s85
    s_and_b32 s97, s96, 15
    s_lshl3_add_u32 s98, s97, s3
    s_mul_i32 s99, s98, 49152
    s_lshl_b32 s96, s11, 7
    s_add_u32 s82, s99, s96
    s_mul_i32 s96, s20, 24576
    s_lshl_b32 s97, s3, 10
    s_add_u32 s20, s96, s97
    s_mov_b32 m0, s20
    s_nop 0
    buffer_load_dwordx4 v62, s[40:43], s82 offen lds
    s_add_u32 s82, s82, 2048
    s_add_u32 m0, s20, 8192
    s_nop 0
    buffer_load_dwordx4 v62, s[40:43], s82 offen lds
    s_add_u32 s82, s82, 2048
    s_add_u32 m0, s20, 16384
    s_nop 0
    buffer_load_dwordx4 v62, s[40:43], s82 offen lds
    s_add_u32 s96, s85, 4
    s_and_b32 s97, s96, 15
    s_lshl3_add_u32 s98, s97, s3
    s_sub_u32 s99, s98, 4
    s_mul_i32 s96, s99, 49152
    s_lshl_b32 s97, s11, 7
    s_add_u32 s82, s96, s97
    s_sub_u32 s96, s3, 4
    s_lshl_b32 s97, s96, 10
    s_add_u32 s20, s97, 98304
    s_mov_b32 m0, s20
    s_nop 0
    buffer_load_dwordx4 v62, s[40:43], s82 offen lds
    s_add_u32 s82, s82, 2048
    s_add_u32 m0, s20, 8192
    s_nop 0
    buffer_load_dwordx4 v62, s[40:43], s82 offen lds
    s_add_u32 s82, s82, 2048
    s_add_u32 m0, s20, 16384
    s_nop 0
    buffer_load_dwordx4 v62, s[40:43], s82 offen lds
    s_add_u32 s96, s85, 4
    s_and_b32 s97, s96, 15
    s_lshl3_add_u32 s98, s97, s3
    s_mul_i32 s99, s98, 49152
    s_lshl_b32 s96, s11, 7
    s_add_u32 s82, s99, s96
    s_lshl_b32 s96, s3, 10
    s_add_u32 s20, s96, 98304
    s_mov_b32 m0, s20
    s_nop 0
    buffer_load_dwordx4 v62, s[40:43], s82 offen lds
    s_add_u32 s82, s82, 2048
    s_add_u32 m0, s20, 8192
    s_nop 0
    buffer_load_dwordx4 v62, s[40:43], s82 offen lds
    s_add_u32 s82, s82, 2048
    s_add_u32 m0, s20, 16384
    s_nop 0
    buffer_load_dwordx4 v62, s[40:43], s82 offen lds
    s_add_u32 s96, s85, 5
    s_and_b32 s97, s96, 15
    s_lshl3_add_u32 s98, s97, s3
    s_sub_u32 s99, s98, 4
    s_mul_i32 s96, s99, 49152
    s_lshl_b32 s97, s11, 7
    s_add_u32 s82, s96, s97
    s_sub_u32 s96, s3, 4
    s_lshl_b32 s97, s96, 10
    s_add_u32 s20, s97, 122880
    s_mov_b32 m0, s20
    s_nop 0
    buffer_load_dwordx4 v62, s[40:43], s82 offen lds
    s_add_u32 s82, s82, 2048
    s_add_u32 m0, s20, 8192
    s_nop 0
    buffer_load_dwordx4 v62, s[40:43], s82 offen lds
    s_add_u32 s82, s82, 2048
    s_add_u32 m0, s20, 16384
    s_nop 0
    buffer_load_dwordx4 v62, s[40:43], s82 offen lds
    s_add_u32 s96, s85, 5
    s_and_b32 s97, s96, 15
    s_lshl3_add_u32 s98, s97, s3
    s_mul_i32 s99, s98, 49152
    s_lshl_b32 s96, s11, 7
    s_add_u32 s82, s99, s96
    s_lshl_b32 s96, s3, 10
    s_add_u32 s20, s96, 122880
    s_mov_b32 m0, s20
    s_nop 0
    buffer_load_dwordx4 v62, s[40:43], s82 offen lds
    s_add_u32 s82, s82, 2048
    s_add_u32 m0, s20, 8192
    s_nop 0
    buffer_load_dwordx4 v62, s[40:43], s82 offen lds
    s_add_u32 s82, s82, 2048
    s_add_u32 m0, s20, 16384
    s_nop 0
    buffer_load_dwordx4 v62, s[40:43], s82 offen lds
    s_and_b32 s96, s8, 3
    s_lshl2_add_u32 s97, s96, s3
    s_sub_u32 s98, s97, 4
    s_lshl_b32 s13, s98, 7
    v_lshrrev_b32 v61, 3, v1
    v_lshl_add_u32 v61, v61, 4, s13
    v_lshrrev_b32 v60, 3, v1
    v_mul_u32_u24 v60, 98304, v60
    v_and_b32 v9, 7, v1
    v_lshl_add_u32 v60, v9, 4, v60
    s_mul_i32 s96, s13, 6144
    s_lshr_b32 s97, s8, 2
    s_lshl1_add_u32 s98, s9, s97
    s_lshl_b32 s99, s98, 7
    s_add_u32 s97, s96, s99
    s_add_u32 s17, s97, 4096
    global_load_dwordx4 v[120:123], v61, s[86:87]
    s_waitcnt vmcnt(19)
    s_barrier
    buffer_load_dwordx4 v[80:83], v60, s[48:51], s17 offen nt
    s_add_u32 s17, s17, 12288
    buffer_load_dwordx4 v[84:87], v60, s[48:51], s17 offen nt
    s_add_u32 s17, s17, 12288
    s_waitcnt lgkmcnt(0)
    s_load_dword s24, s[32:33], s92 offset:512 glc
    s_load_dword s25, s[32:33], s92 offset:256 glc
    s_load_dword s26, s[32:33], s92 offset:1024 glc
    s_load_dword s27, s[32:33], s92 offset:768 glc
    s_waitcnt vmcnt(15)
    s_barrier
    s_add_u32 s96, s85, 6
    s_and_b32 s97, s96, 15
    s_lshl3_add_u32 s98, s97, s3
    s_sub_u32 s99, s98, 4
    s_mul_i32 s96, s99, 49152
    s_lshl_b32 s97, s11, 7
    s_add_u32 s82, s96, s97
    s_sub_u32 s96, s3, 4
    s_lshl_b32 s20, s96, 10
    s_mov_b32 m0, s20
    s_nop 0
    buffer_load_dwordx4 v62, s[40:43], s82 offen lds
    s_add_u32 s82, s82, 2048
    s_add_u32 m0, s20, 8192
    s_nop 0
    buffer_load_dwordx4 v62, s[40:43], s82 offen lds
    s_add_u32 s82, s82, 2048
    s_add_u32 m0, s20, 16384
    s_nop 0
    buffer_load_dwordx4 v62, s[40:43], s82 offen lds
    s_add_u32 s96, s85, 6
    s_and_b32 s97, s96, 15
    s_lshl3_add_u32 s98, s97, s3
    s_mul_i32 s99, s98, 49152
    s_lshl_b32 s96, s11, 7
    s_add_u32 s82, s99, s96
    s_lshl_b32 s20, s3, 10
    s_mov_b32 m0, s20
    s_nop 0
    buffer_load_dwordx4 v62, s[40:43], s82 offen lds
    s_add_u32 s82, s82, 2048
    s_add_u32 m0, s20, 8192
    s_nop 0
    buffer_load_dwordx4 v62, s[40:43], s82 offen lds
    s_add_u32 s82, s82, 2048
    s_add_u32 m0, s20, 16384
    s_nop 0
    buffer_load_dwordx4 v62, s[40:43], s82 offen lds
    s_waitcnt vmcnt(8)
    v_lshlrev_b32 v112, 16, v120
    v_mul_f32 v4, s7, v112
    v_exp_f32 v4, -v4
    s_nop 0
    v_add_f32 v4, 1.0, v4
    v_rcp_f32 v4, v4
    s_nop 0
    v_mul_f32 v112, v112, v4
    v_cvt_pk_bf16_f32 v112, 0, v112
    v_and_b32 v113, s6, v120
    v_mul_f32 v5, s7, v113
    v_exp_f32 v5, -v5
    s_nop 0
    v_add_f32 v5, 1.0, v5
    v_rcp_f32 v5, v5
    s_nop 0
    v_mul_f32 v113, v113, v5
    v_cvt_pk_bf16_f32 v113, 0, v113
    v_lshlrev_b32 v114, 16, v121
    v_mul_f32 v4, s7, v114
    v_exp_f32 v4, -v4
    s_nop 0
    v_add_f32 v4, 1.0, v4
    v_rcp_f32 v4, v4
    s_nop 0
    v_mul_f32 v114, v114, v4
    v_cvt_pk_bf16_f32 v114, 0, v114
    v_and_b32 v115, s6, v121
    v_mul_f32 v5, s7, v115
    v_exp_f32 v5, -v5
    s_nop 0
    v_add_f32 v5, 1.0, v5
    v_rcp_f32 v5, v5
    s_nop 0
    v_mul_f32 v115, v115, v5
    v_cvt_pk_bf16_f32 v115, 0, v115
    s_barrier
    s_add_u32 s96, s85, 7
    s_and_b32 s97, s96, 15
    s_lshl3_add_u32 s98, s97, s3
    s_sub_u32 s99, s98, 4
    s_mul_i32 s96, s99, 49152
    s_lshl_b32 s97, s11, 7
    s_add_u32 s82, s96, s97
    s_sub_u32 s96, s3, 4
    s_lshl_b32 s97, s96, 10
    s_add_u32 s20, s97, 24576
    s_mov_b32 m0, s20
    s_nop 0
    buffer_load_dwordx4 v62, s[40:43], s82 offen lds
    s_add_u32 s82, s82, 2048
    s_add_u32 m0, s20, 8192
    s_nop 0
    buffer_load_dwordx4 v62, s[40:43], s82 offen lds
    s_add_u32 s82, s82, 2048
    s_add_u32 m0, s20, 16384
    s_nop 0
    buffer_load_dwordx4 v62, s[40:43], s82 offen lds
    s_add_u32 s96, s85, 7
    s_and_b32 s97, s96, 15
    s_lshl3_add_u32 s98, s97, s3
    s_mul_i32 s99, s98, 49152
    s_lshl_b32 s96, s11, 7
    s_add_u32 s82, s99, s96
    s_lshl_b32 s96, s3, 10
    s_add_u32 s20, s96, 24576
    s_mov_b32 m0, s20
    s_nop 0
    buffer_load_dwordx4 v62, s[40:43], s82 offen lds
    s_add_u32 s82, s82, 2048
    s_add_u32 m0, s20, 8192
    s_nop 0
    buffer_load_dwordx4 v62, s[40:43], s82 offen lds
    s_add_u32 s82, s82, 2048
    s_add_u32 m0, s20, 16384
    s_nop 0
    buffer_load_dwordx4 v62, s[40:43], s82 offen lds
    buffer_load_dwordx4 v[88:91], v60, s[48:51], s17 offen nt
    s_add_u32 s17, s17, 12288
    buffer_load_dwordx4 v[92:95], v60, s[48:51], s17 offen nt
    s_add_u32 s17, s17, 12288
    v_lshlrev_b32 v116, 16, v122
    v_mul_f32 v4, s7, v116
    v_exp_f32 v4, -v4
    s_nop 0
    v_add_f32 v4, 1.0, v4
    v_rcp_f32 v4, v4
    s_nop 0
    v_mul_f32 v116, v116, v4
    v_cvt_pk_bf16_f32 v116, 0, v116
    v_and_b32 v117, s6, v122
    v_mul_f32 v5, s7, v117
    v_exp_f32 v5, -v5
    s_nop 0
    v_add_f32 v5, 1.0, v5
    v_rcp_f32 v5, v5
    s_nop 0
    v_mul_f32 v117, v117, v5
    v_cvt_pk_bf16_f32 v117, 0, v117
    v_lshlrev_b32 v118, 16, v123
    v_mul_f32 v4, s7, v118
    v_exp_f32 v4, -v4
    s_nop 0
    v_add_f32 v4, 1.0, v4
    v_rcp_f32 v4, v4
    s_nop 0
    v_mul_f32 v118, v118, v4
    v_cvt_pk_bf16_f32 v118, 0, v118
    v_and_b32 v119, s6, v123
    v_mul_f32 v5, s7, v119
    v_exp_f32 v5, -v5
    s_nop 0
    v_add_f32 v5, 1.0, v5
    v_rcp_f32 v5, v5
    s_nop 0
    v_mul_f32 v119, v119, v5
    v_cvt_pk_bf16_f32 v119, 0, v119
    s_barrier
    s_add_u32 s96, s85, 8
    s_and_b32 s97, s96, 15
    s_lshl3_add_u32 s98, s97, s3
    s_sub_u32 s99, s98, 4
    s_mul_i32 s96, s99, 49152
    s_lshl_b32 s97, s11, 7
    s_add_u32 s82, s96, s97
    s_sub_u32 s96, s3, 4
    s_lshl_b32 s97, s96, 10
    s_add_u32 s20, s97, 49152
    s_mov_b32 m0, s20
    s_nop 0
    buffer_load_dwordx4 v62, s[40:43], s82 offen lds
    s_add_u32 s82, s82, 2048
    s_add_u32 m0, s20, 8192
    s_nop 0
    buffer_load_dwordx4 v62, s[40:43], s82 offen lds
    s_add_u32 s82, s82, 2048
    s_add_u32 m0, s20, 16384
    s_nop 0
    buffer_load_dwordx4 v62, s[40:43], s82 offen lds
    s_add_u32 s96, s85, 8
    s_and_b32 s97, s96, 15
    s_lshl3_add_u32 s98, s97, s3
    s_mul_i32 s99, s98, 49152
    s_lshl_b32 s96, s11, 7
    s_add_u32 s82, s99, s96
    s_lshl_b32 s96, s3, 10
    s_add_u32 s20, s96, 49152
    s_mov_b32 m0, s20
    s_nop 0
    buffer_load_dwordx4 v62, s[40:43], s82 offen lds
    s_add_u32 s82, s82, 2048
    s_add_u32 m0, s20, 8192
    s_nop 0
    buffer_load_dwordx4 v62, s[40:43], s82 offen lds
    s_add_u32 s82, s82, 2048
    s_add_u32 m0, s20, 16384
    s_nop 0
    buffer_load_dwordx4 v62, s[40:43], s82 offen lds
    s_waitcnt lgkmcnt(0)
    s_load_dword s24, s[32:33], s92 offset:1536 glc
    s_load_dword s25, s[32:33], s92 offset:1280 glc
    s_load_dword s26, s[32:33], s92 offset:2048 glc
    s_load_dword s27, s[32:33], s92 offset:1792 glc
    s_barrier
    s_add_u32 s96, s85, 9
    s_and_b32 s97, s96, 15
    s_lshl3_add_u32 s98, s97, s3
    s_sub_u32 s99, s98, 4
    s_mul_i32 s96, s99, 49152
    s_lshl_b32 s97, s11, 7
    s_add_u32 s82, s96, s97
    s_sub_u32 s96, s3, 4
    s_lshl_b32 s97, s96, 10
    s_add_u32 s20, s97, 73728
    s_mov_b32 m0, s20
    s_nop 0
    buffer_load_dwordx4 v62, s[40:43], s82 offen lds
    s_add_u32 s82, s82, 2048
    s_add_u32 m0, s20, 8192
    s_nop 0
    buffer_load_dwordx4 v62, s[40:43], s82 offen lds
    s_add_u32 s82, s82, 2048
    s_add_u32 m0, s20, 16384
    s_nop 0
    buffer_load_dwordx4 v62, s[40:43], s82 offen lds
    s_add_u32 s96, s85, 9
    s_and_b32 s97, s96, 15
    s_lshl3_add_u32 s98, s97, s3
    s_mul_i32 s99, s98, 49152
    s_lshl_b32 s96, s11, 7
    s_add_u32 s82, s99, s96
    s_lshl_b32 s96, s3, 10
    s_add_u32 s20, s96, 73728
    s_mov_b32 m0, s20
    s_nop 0
    buffer_load_dwordx4 v62, s[40:43], s82 offen lds
    s_add_u32 s82, s82, 2048
    s_add_u32 m0, s20, 8192
    s_nop 0
    buffer_load_dwordx4 v62, s[40:43], s82 offen lds
    s_add_u32 s82, s82, 2048
    s_add_u32 m0, s20, 16384
    s_nop 0
    buffer_load_dwordx4 v62, s[40:43], s82 offen lds
    buffer_load_dwordx4 v[96:99], v60, s[48:51], s17 offen nt
    s_add_u32 s17, s17, 12288
    buffer_load_dwordx4 v[100:103], v60, s[48:51], s17 offen nt
    s_add_u32 s17, s17, 12288
    s_waitcnt vmcnt(29)
    v_lshlrev_b32 v4, 16, v80
    v_and_b32 v5, s6, v80
    v_mul_f32 v20, v4, v112
    v_mul_f32 v21, v5, v112
    v_lshlrev_b32 v6, 16, v81
    v_and_b32 v7, s6, v81
    v_mul_f32 v22, v6, v112
    v_mul_f32 v23, v7, v112
    v_lshlrev_b32 v4, 16, v82
    v_and_b32 v5, s6, v82
    v_mul_f32 v24, v4, v112
    v_mul_f32 v25, v5, v112
    v_lshlrev_b32 v6, 16, v83
    v_and_b32 v7, s6, v83
    v_mul_f32 v26, v6, v112
    v_mul_f32 v27, v7, v112
    s_waitcnt vmcnt(28)
    v_lshlrev_b32 v4, 16, v84
    v_and_b32 v5, s6, v84
    v_fmac_f32 v20, v4, v113
    v_fmac_f32 v21, v5, v113
    v_lshlrev_b32 v6, 16, v85
    v_and_b32 v7, s6, v85
    v_fmac_f32 v22, v6, v113
    v_fmac_f32 v23, v7, v113
    v_lshlrev_b32 v4, 16, v86
    v_and_b32 v5, s6, v86
    v_fmac_f32 v24, v4, v113
    v_fmac_f32 v25, v5, v113
    v_lshlrev_b32 v6, 16, v87
    v_and_b32 v7, s6, v87
    v_fmac_f32 v26, v6, v113
    v_fmac_f32 v27, v7, v113
    s_waitcnt vmcnt(22)
    s_barrier
    s_add_u32 s96, s85, 10
    s_and_b32 s97, s96, 15
    s_lshl3_add_u32 s98, s97, s3
    s_sub_u32 s99, s98, 4
    s_mul_i32 s96, s99, 49152
    s_lshl_b32 s97, s11, 7
    s_add_u32 s82, s96, s97
    s_sub_u32 s96, s3, 4
    s_lshl_b32 s97, s96, 10
    s_add_u32 s20, s97, 98304
    s_mov_b32 m0, s20
    s_nop 0
    buffer_load_dwordx4 v62, s[40:43], s82 offen lds
    s_add_u32 s82, s82, 2048
    s_add_u32 m0, s20, 8192
    s_nop 0
    buffer_load_dwordx4 v62, s[40:43], s82 offen lds
    s_add_u32 s82, s82, 2048
    s_add_u32 m0, s20, 16384
    s_nop 0
    buffer_load_dwordx4 v62, s[40:43], s82 offen lds
    s_add_u32 s96, s85, 10
    s_and_b32 s97, s96, 15
    s_lshl3_add_u32 s98, s97, s3
    s_mul_i32 s99, s98, 49152
    s_lshl_b32 s96, s11, 7
    s_add_u32 s82, s99, s96
    s_lshl_b32 s96, s3, 10
    s_add_u32 s20, s96, 98304
    s_mov_b32 m0, s20
    s_nop 0
    buffer_load_dwordx4 v62, s[40:43], s82 offen lds
    s_add_u32 s82, s82, 2048
    s_add_u32 m0, s20, 8192
    s_nop 0
    buffer_load_dwordx4 v62, s[40:43], s82 offen lds
    s_add_u32 s82, s82, 2048
    s_add_u32 m0, s20, 16384
    s_nop 0
    buffer_load_dwordx4 v62, s[40:43], s82 offen lds
    s_waitcnt vmcnt(22)
    s_barrier
    s_add_u32 s96, s85, 11
    s_and_b32 s97, s96, 15
    s_lshl3_add_u32 s98, s97, s3
    s_sub_u32 s99, s98, 4
    s_mul_i32 s96, s99, 49152
    s_lshl_b32 s97, s11, 7
    s_add_u32 s82, s96, s97
    s_sub_u32 s96, s3, 4
    s_lshl_b32 s97, s96, 10
    s_add_u32 s20, s97, 122880
    s_mov_b32 m0, s20
    s_nop 0
    buffer_load_dwordx4 v62, s[40:43], s82 offen lds
    s_add_u32 s82, s82, 2048
    s_add_u32 m0, s20, 8192
    s_nop 0
    buffer_load_dwordx4 v62, s[40:43], s82 offen lds
    s_add_u32 s82, s82, 2048
    s_add_u32 m0, s20, 16384
    s_nop 0
    buffer_load_dwordx4 v62, s[40:43], s82 offen lds
    s_add_u32 s96, s85, 11
    s_and_b32 s97, s96, 15
    s_lshl3_add_u32 s98, s97, s3
    s_mul_i32 s99, s98, 49152
    s_lshl_b32 s96, s11, 7
    s_add_u32 s82, s99, s96
    s_lshl_b32 s96, s3, 10
    s_add_u32 s20, s96, 122880
    s_mov_b32 m0, s20
    s_nop 0
    buffer_load_dwordx4 v62, s[40:43], s82 offen lds
    s_add_u32 s82, s82, 2048
    s_add_u32 m0, s20, 8192
    s_nop 0
    buffer_load_dwordx4 v62, s[40:43], s82 offen lds
    s_add_u32 s82, s82, 2048
    s_add_u32 m0, s20, 16384
    s_nop 0
    buffer_load_dwordx4 v62, s[40:43], s82 offen lds
    buffer_load_dwordx4 v[104:107], v60, s[48:51], s17 offen nt
    s_add_u32 s17, s17, 12288
    buffer_load_dwordx4 v[108:111], v60, s[48:51], s17 offen nt
    s_lshl2_add_u32 s96, s74, s75
    s_lshl_b32 s97, s96, 11
    s_and_b32 s98, s3, 1
    s_lshl_b32 s99, s98, 10
    s_add_u32 s96, s97, s99
    s_add_u32 s13, s96, 20971520
    s_lshl4_add_u32 s96, s21, s12
    s_lshl_b32 s97, s96, 11
    s_and_b32 s98, s3, 1
    s_lshl_b32 s99, s98, 10
    s_add_u32 s96, s97, s99
    s_add_u32 s14, s96, 12582912
    buffer_load_dwordx4 v[124:127], v2, s[32:35], s13 offen
    s_waitcnt vmcnt(30)
    v_lshlrev_b32 v4, 16, v88
    v_and_b32 v5, s6, v88
    v_fmac_f32 v20, v4, v114
    v_fmac_f32 v21, v5, v114
    v_lshlrev_b32 v6, 16, v89
    v_and_b32 v7, s6, v89
    v_fmac_f32 v22, v6, v114
    v_fmac_f32 v23, v7, v114
    v_lshlrev_b32 v4, 16, v90
    v_and_b32 v5, s6, v90
    v_fmac_f32 v24, v4, v114
    v_fmac_f32 v25, v5, v114
    v_lshlrev_b32 v6, 16, v91
    v_and_b32 v7, s6, v91
    v_fmac_f32 v26, v6, v114
    v_fmac_f32 v27, v7, v114
    s_waitcnt vmcnt(29)
    v_lshlrev_b32 v4, 16, v92
    v_and_b32 v5, s6, v92
    v_fmac_f32 v20, v4, v115
    v_fmac_f32 v21, v5, v115
    v_lshlrev_b32 v6, 16, v93
    v_and_b32 v7, s6, v93
    v_fmac_f32 v22, v6, v115
    v_fmac_f32 v23, v7, v115
    v_lshlrev_b32 v4, 16, v94
    v_and_b32 v5, s6, v94
    v_fmac_f32 v24, v4, v115
    v_fmac_f32 v25, v5, v115
    v_lshlrev_b32 v6, 16, v95
    v_and_b32 v7, s6, v95
    v_fmac_f32 v26, v6, v115
    v_fmac_f32 v27, v7, v115
    s_waitcnt lgkmcnt(0)
    s_load_dword s24, s[32:33], s92 offset:2560 glc
    s_load_dword s25, s[32:33], s92 offset:2304 glc
    s_load_dword s26, s[32:33], s92 offset:3072 glc
    s_load_dword s27, s[32:33], s92 offset:2816 glc
    s_load_dword s28, s[32:33], s92 offset:3584 glc
    s_load_dword s29, s[32:33], s92 offset:3328 glc
    s_waitcnt vmcnt(23)
    s_barrier
    s_add_u32 s96, s85, 12
    s_and_b32 s97, s96, 15
    s_lshl3_add_u32 s98, s97, s3
    s_sub_u32 s99, s98, 4
    s_mul_i32 s96, s99, 49152
    s_lshl_b32 s97, s11, 7
    s_add_u32 s82, s96, s97
    s_sub_u32 s96, s3, 4
    s_lshl_b32 s20, s96, 10
    s_mov_b32 m0, s20
    s_nop 0
    buffer_load_dwordx4 v62, s[40:43], s82 offen lds
    s_add_u32 s82, s82, 2048
    s_add_u32 m0, s20, 8192
    s_nop 0
    buffer_load_dwordx4 v62, s[40:43], s82 offen lds
    s_add_u32 s82, s82, 2048
    s_add_u32 m0, s20, 16384
    s_nop 0
    buffer_load_dwordx4 v62, s[40:43], s82 offen lds
    s_add_u32 s96, s85, 12
    s_and_b32 s97, s96, 15
    s_lshl3_add_u32 s98, s97, s3
    s_mul_i32 s99, s98, 49152
    s_lshl_b32 s96, s11, 7
    s_add_u32 s82, s99, s96
    s_lshl_b32 s20, s3, 10
    s_mov_b32 m0, s20
    s_nop 0
    buffer_load_dwordx4 v62, s[40:43], s82 offen lds
    s_add_u32 s82, s82, 2048
    s_add_u32 m0, s20, 8192
    s_nop 0
    buffer_load_dwordx4 v62, s[40:43], s82 offen lds
    s_add_u32 s82, s82, 2048
    s_add_u32 m0, s20, 16384
    s_nop 0
    buffer_load_dwordx4 v62, s[40:43], s82 offen lds
    s_waitcnt vmcnt(23)
    s_barrier
    s_add_u32 s96, s85, 13
    s_and_b32 s97, s96, 15
    s_lshl3_add_u32 s98, s97, s3
    s_sub_u32 s99, s98, 4
    s_mul_i32 s96, s99, 49152
    s_lshl_b32 s97, s11, 7
    s_add_u32 s82, s96, s97
    s_sub_u32 s96, s3, 4
    s_lshl_b32 s97, s96, 10
    s_add_u32 s20, s97, 24576
    s_mov_b32 m0, s20
    s_nop 0
    buffer_load_dwordx4 v62, s[40:43], s82 offen lds
    s_add_u32 s82, s82, 2048
    s_add_u32 m0, s20, 8192
    s_nop 0
    buffer_load_dwordx4 v62, s[40:43], s82 offen lds
    s_add_u32 s82, s82, 2048
    s_add_u32 m0, s20, 16384
    s_nop 0
    buffer_load_dwordx4 v62, s[40:43], s82 offen lds
    s_add_u32 s96, s85, 13
    s_and_b32 s97, s96, 15
    s_lshl3_add_u32 s98, s97, s3
    s_mul_i32 s99, s98, 49152
    s_lshl_b32 s96, s11, 7
    s_add_u32 s82, s99, s96
    s_lshl_b32 s96, s3, 10
    s_add_u32 s20, s96, 24576
    s_mov_b32 m0, s20
    s_nop 0
    buffer_load_dwordx4 v62, s[40:43], s82 offen lds
    s_add_u32 s82, s82, 2048
    s_add_u32 m0, s20, 8192
    s_nop 0
    buffer_load_dwordx4 v62, s[40:43], s82 offen lds
    s_add_u32 s82, s82, 2048
    s_add_u32 m0, s20, 16384
    s_nop 0
    buffer_load_dwordx4 v62, s[40:43], s82 offen lds
    s_waitcnt vmcnt(28)
    v_lshlrev_b32 v4, 16, v96
    v_and_b32 v5, s6, v96
    v_fmac_f32 v20, v4, v116
    v_fmac_f32 v21, v5, v116
    v_lshlrev_b32 v6, 16, v97
    v_and_b32 v7, s6, v97
    v_fmac_f32 v22, v6, v116
    v_fmac_f32 v23, v7, v116
    v_lshlrev_b32 v4, 16, v98
    v_and_b32 v5, s6, v98
    v_fmac_f32 v24, v4, v116
    v_fmac_f32 v25, v5, v116
    v_lshlrev_b32 v6, 16, v99
    v_and_b32 v7, s6, v99
    v_fmac_f32 v26, v6, v116
    v_fmac_f32 v27, v7, v116
    s_waitcnt vmcnt(27)
    v_lshlrev_b32 v4, 16, v100
    v_and_b32 v5, s6, v100
    v_fmac_f32 v20, v4, v117
    v_fmac_f32 v21, v5, v117
    v_lshlrev_b32 v6, 16, v101
    v_and_b32 v7, s6, v101
    v_fmac_f32 v22, v6, v117
    v_fmac_f32 v23, v7, v117
    v_lshlrev_b32 v4, 16, v102
    v_and_b32 v5, s6, v102
    v_fmac_f32 v24, v4, v117
    v_fmac_f32 v25, v5, v117
    v_lshlrev_b32 v6, 16, v103
    v_and_b32 v7, s6, v103
    v_fmac_f32 v26, v6, v117
    v_fmac_f32 v27, v7, v117
    s_waitcnt vmcnt(21)
    s_barrier
    s_add_u32 s96, s85, 14
    s_and_b32 s97, s96, 15
    s_lshl3_add_u32 s98, s97, s3
    s_sub_u32 s99, s98, 4
    s_mul_i32 s96, s99, 49152
    s_lshl_b32 s97, s11, 7
    s_add_u32 s82, s96, s97
    s_sub_u32 s96, s3, 4
    s_lshl_b32 s97, s96, 10
    s_add_u32 s20, s97, 49152
    s_mov_b32 m0, s20
    s_nop 0
    buffer_load_dwordx4 v62, s[40:43], s82 offen lds
    s_add_u32 s82, s82, 2048
    s_add_u32 m0, s20, 8192
    s_nop 0
    buffer_load_dwordx4 v62, s[40:43], s82 offen lds
    s_add_u32 s82, s82, 2048
    s_add_u32 m0, s20, 16384
    s_nop 0
    buffer_load_dwordx4 v62, s[40:43], s82 offen lds
    s_add_u32 s96, s85, 14
    s_and_b32 s97, s96, 15
    s_lshl3_add_u32 s98, s97, s3
    s_mul_i32 s99, s98, 49152
    s_lshl_b32 s96, s11, 7
    s_add_u32 s82, s99, s96
    s_lshl_b32 s96, s3, 10
    s_add_u32 s20, s96, 49152
    s_mov_b32 m0, s20
    s_nop 0
    buffer_load_dwordx4 v62, s[40:43], s82 offen lds
    s_add_u32 s82, s82, 2048
    s_add_u32 m0, s20, 8192
    s_nop 0
    buffer_load_dwordx4 v62, s[40:43], s82 offen lds
    s_add_u32 s82, s82, 2048
    s_add_u32 m0, s20, 16384
    s_nop 0
    buffer_load_dwordx4 v62, s[40:43], s82 offen lds
    s_waitcnt vmcnt(20)
    v_lshlrev_b32 v4, 16, v104
    v_and_b32 v5, s6, v104
    v_fmac_f32 v20, v4, v118
    v_fmac_f32 v21, v5, v118
    v_lshlrev_b32 v6, 16, v105
    v_and_b32 v7, s6, v105
    v_fmac_f32 v22, v6, v118
    v_fmac_f32 v23, v7, v118
    v_lshlrev_b32 v4, 16, v106
    v_and_b32 v5, s6, v106
    v_fmac_f32 v24, v4, v118
    v_fmac_f32 v25, v5, v118
    v_lshlrev_b32 v6, 16, v107
    v_and_b32 v7, s6, v107
    v_fmac_f32 v26, v6, v118
    v_fmac_f32 v27, v7, v118
    s_waitcnt vmcnt(19)
    v_lshlrev_b32 v4, 16, v108
    v_and_b32 v5, s6, v108
    v_fmac_f32 v20, v4, v119
    v_fmac_f32 v21, v5, v119
    v_lshlrev_b32 v6, 16, v109
    v_and_b32 v7, s6, v109
    v_fmac_f32 v22, v6, v119
    v_fmac_f32 v23, v7, v119
    v_lshlrev_b32 v4, 16, v110
    v_and_b32 v5, s6, v110
    v_fmac_f32 v24, v4, v119
    v_fmac_f32 v25, v5, v119
    v_lshlrev_b32 v6, 16, v111
    v_and_b32 v7, s6, v111
    v_fmac_f32 v26, v6, v119
    v_fmac_f32 v27, v7, v119
    s_barrier
    s_add_u32 s96, s85, 15
    s_and_b32 s97, s96, 15
    s_lshl3_add_u32 s98, s97, s3
    s_sub_u32 s99, s98, 4
    s_mul_i32 s96, s99, 49152
    s_lshl_b32 s97, s11, 7
    s_add_u32 s82, s96, s97
    s_sub_u32 s96, s3, 4
    s_lshl_b32 s97, s96, 10
    s_add_u32 s20, s97, 73728
    s_mov_b32 m0, s20
    s_nop 0
    buffer_load_dwordx4 v62, s[40:43], s82 offen lds
    s_add_u32 s82, s82, 2048
    s_add_u32 m0, s20, 8192
    s_nop 0
    buffer_load_dwordx4 v62, s[40:43], s82 offen lds
    s_add_u32 s82, s82, 2048
    s_add_u32 m0, s20, 16384
    s_nop 0
    buffer_load_dwordx4 v62, s[40:43], s82 offen lds
    s_add_u32 s96, s85, 15
    s_and_b32 s97, s96, 15
    s_lshl3_add_u32 s98, s97, s3
    s_mul_i32 s99, s98, 49152
    s_lshl_b32 s96, s11, 7
    s_add_u32 s82, s99, s96
    s_lshl_b32 s96, s3, 10
    s_add_u32 s20, s96, 73728
    s_mov_b32 m0, s20
    s_nop 0
    buffer_load_dwordx4 v62, s[40:43], s82 offen lds
    s_add_u32 s82, s82, 2048
    s_add_u32 m0, s20, 8192
    s_nop 0
    buffer_load_dwordx4 v62, s[40:43], s82 offen lds
    s_add_u32 s82, s82, 2048
    s_add_u32 m0, s20, 16384
    s_nop 0
    buffer_load_dwordx4 v62, s[40:43], s82 offen lds
    v_permlane32_swap_b32 v20, v24
    v_permlane32_swap_b32 v21, v25
    v_permlane32_swap_b32 v22, v26
    v_permlane32_swap_b32 v23, v27
    v_add_f32 v20, v20, v24
    v_add_f32 v21, v21, v25
    v_add_f32 v22, v22, v26
    v_add_f32 v23, v23, v27
    s_nop 0
    v_permlane16_swap_b32 v20, v22
    v_permlane16_swap_b32 v21, v23
    v_add_f32 v20, v20, v22
    v_add_f32 v21, v21, v23
    s_nop 0
    v_add_f32_dpp v20, v20, v20 row_ror:8 row_mask:0xf bank_mask:0xf
    v_add_f32_dpp v21, v21, v21 row_ror:8 row_mask:0xf bank_mask:0xf
    s_nop 1
    v_mov_b32_dpp v20, v21 quad_perm:[0,1,2,3] row_mask:0xf bank_mask:0xc
    ds_write_b32 v65, v20 offset:2048
    s_waitcnt lgkmcnt(0)
    s_waitcnt vmcnt(18)
    s_barrier
    s_cmp_lg_u32 s3, 4
    s_cbranch_scc1 L_M2F
    ds_read_b128 v[20:23], v64 offset:2048
    s_lshr_b32 s96, s8, 2
    s_lshl1_add_u32 s97, s9, s96
    s_and_b32 s98, s8, 3
    s_lshl2_add_u32 s99, s97, s98
    s_lshl_b32 s96, s99, 9
    s_add_u32 s13, s96, 131072
    s_waitcnt lgkmcnt(0)
    v_add_f32 v20, v20, v21
    v_add_f32 v22, v22, v23
    v_mov_b32 v21, s4
    v_add_f32 v20, v20, v22
    buffer_store_dwordx2 v[20:21], v63, s[32:35], s13 offen sc1
L_M2F:
    s_waitcnt vmcnt(12)
    s_waitcnt vmcnt(6)
    s_waitcnt vmcnt(0)
    s_barrier
    s_barrier
    s_add_u32 s96, s84, 983040
    s_and_b32 s97, s96, 1048575
    s_xor_b32 s98, s88, 1048576
    s_add_u32 s13, s97, s98
    s_add_u32 m0, s89, 94208
    s_nop 0
    buffer_load_dwordx4 v74, s[44:47], s13 offen lds
    s_add_u32 s96, s84, 1048576
    s_and_b32 s97, s96, 1048575
    s_xor_b32 s98, s88, 1048576
    s_add_u32 s13, s97, s98
    s_add_u32 m0, s89, 98304
    s_nop 0
    buffer_load_dwordx4 v74, s[44:47], s13 offen lds
    s_add_u32 s96, s84, 1114112
    s_and_b32 s97, s96, 1048575
    s_xor_b32 s98, s88, 1048576
    s_add_u32 s13, s97, s98
    s_add_u32 m0, s89, 102400
    s_nop 0
    buffer_load_dwordx4 v74, s[44:47], s13 offen lds
    s_add_u32 s96, s84, 1179648
    s_and_b32 s97, s96, 1048575
    s_xor_b32 s98, s88, 1048576
    s_add_u32 s13, s97, s98
    s_add_u32 m0, s89, 106496
    s_nop 0
    buffer_load_dwordx4 v74, s[44:47], s13 offen lds
    s_add_u32 s96, s84, 1245184
    s_and_b32 s97, s96, 1048575
    s_xor_b32 s98, s88, 1048576
    s_add_u32 s13, s97, s98
    s_add_u32 m0, s89, 110592
    s_nop 0
    buffer_load_dwordx4 v74, s[44:47], s13 offen lds
    s_add_u32 s96, s84, 1310720
    s_and_b32 s97, s96, 1048575
    s_xor_b32 s98, s88, 1048576
    s_add_u32 s13, s97, s98
    s_add_u32 m0, s89, 114688
    s_nop 0
    buffer_load_dwordx4 v74, s[44:47], s13 offen lds
    s_add_u32 s96, s84, 1376256
    s_and_b32 s97, s96, 1048575
    s_xor_b32 s98, s88, 1048576
    s_add_u32 s13, s97, s98
    s_add_u32 m0, s89, 118784
    s_nop 0
    buffer_load_dwordx4 v74, s[44:47], s13 offen lds
    s_add_u32 s96, s84, 1441792
    s_and_b32 s97, s96, 1048575
    s_xor_b32 s98, s88, 1048576
    s_add_u32 s13, s97, s98
    s_add_u32 m0, s89, 122880
    s_nop 0
    buffer_load_dwordx4 v74, s[44:47], s13 offen lds
    s_mov_b32 s13, s80
    buffer_load_dwordx4 v[176:179], v72, s[52:55], s13 offen nt
    s_add_u32 s13, s80, 4294049792
    buffer_load_dwordx4 v[180:183], v72, s[52:55], s13 offen nt
    s_add_u32 s13, s80, 57344
    buffer_load_dwordx4 v[184:187], v72, s[52:55], s13 offen nt
    s_add_u32 s13, s80, 4294107136
    buffer_load_dwordx4 v[188:191], v72, s[52:55], s13 offen nt
    s_add_u32 s13, s80, 114688
    buffer_load_dwordx4 v[192:195], v72, s[52:55], s13 offen nt
    s_add_u32 s13, s80, 4294164480
    buffer_load_dwordx4 v[196:199], v72, s[52:55], s13 offen nt
    s_add_u32 s13, s80, 172032
    buffer_load_dwordx4 v[200:203], v72, s[52:55], s13 offen nt
    s_add_u32 s13, s80, 4294221824
    buffer_load_dwordx4 v[204:207], v72, s[52:55], s13 offen nt
    s_waitcnt lgkmcnt(0)
    s_barrier
    ds_read_b128 v[36:39], v76
    ds_read_b128 v[40:43], v76 offset:1024
    s_waitcnt lgkmcnt(0)
    v_mfma_f32_32x32x16_bf16 v[112:127], v[28:31], v[36:39], 0
    v_mfma_f32_32x32x16_bf16 v[112:127], v[32:35], v[40:43], v[112:127]
    s_mov_b32 s13, s80
    buffer_load_dwordx4 v[208:211], v72, s[56:59], s13 offen nt
    s_add_u32 s13, s80, 4294049792
    buffer_load_dwordx4 v[212:215], v72, s[56:59], s13 offen nt
    s_add_u32 s13, s80, 57344
    buffer_load_dwordx4 v[216:219], v72, s[56:59], s13 offen nt
    s_add_u32 s13, s80, 4294107136
    buffer_load_dwordx4 v[220:223], v72, s[56:59], s13 offen nt
L_JOIN:
    s_nop 3
    v_cvt_pk_bf16_f32 v112, 0, v112
    v_cvt_pk_bf16_f32 v113, 0, v113
    v_cvt_pk_bf16_f32 v114, 0, v114
    v_cvt_pk_bf16_f32 v115, 0, v115
    v_cvt_pk_bf16_f32 v116, 0, v116
    v_cvt_pk_bf16_f32 v117, 0, v117
    v_cvt_pk_bf16_f32 v118, 0, v118
    v_cvt_pk_bf16_f32 v119, 0, v119
    v_cvt_pk_bf16_f32 v120, 0, v120
    v_cvt_pk_bf16_f32 v121, 0, v121
    v_cvt_pk_bf16_f32 v122, 0, v122
    v_cvt_pk_bf16_f32 v123, 0, v123
    v_cvt_pk_bf16_f32 v124, 0, v124
    v_cvt_pk_bf16_f32 v125, 0, v125
    v_cvt_pk_bf16_f32 v126, 0, v126
    v_cvt_pk_bf16_f32 v127, 0, v127
    v_max3_f32 v4, v112, v113, v114
    v_min3_f32 v5, v112, v113, v114
    v_max3_f32 v4, v4, v115, v116
    v_min3_f32 v5, v5, v115, v116
    v_max3_f32 v4, v4, v117, v118
    v_min3_f32 v5, v5, v117, v118
    v_max3_f32 v4, v4, v119, v120
    v_min3_f32 v5, v5, v119, v120
    v_max3_f32 v4, v4, v121, v122
    v_min3_f32 v5, v5, v121, v122
    v_max3_f32 v4, v4, v123, v124
    v_min3_f32 v5, v5, v123, v124
    v_max3_f32 v4, v4, v125, v126
    v_min3_f32 v5, v5, v125, v126
    v_max_f32 v6, v4, v127
    v_min_f32 v7, v5, v127
    v_max_f32 v4, v4, v127
    v_min_f32 v5, v5, v127
    s_nop 0
    v_permlane32_swap_b32 v4, v6
    v_permlane32_swap_b32 v5, v7
    v_max_f32 v4, v4, v6
    v_min_f32 v5, v5, v7
    v_pk_mul_f32 v[4:5], v[4:5], s[6:7] op_sel:[0,1]
    v_pk_fma_f32 v[128:129], v[112:113], s[6:7], v[4:5] op_sel:[0,1,0] op_sel_hi:[1,1,0] neg_lo:[0,0,1] neg_hi:[0,0,1]
    v_pk_fma_f32 v[112:113], v[112:113], s[6:7], v[4:5] op_sel:[0,1,1] neg_lo:[1,0,0] neg_hi:[1,0,0]
    v_pk_fma_f32 v[130:131], v[114:115], s[6:7], v[4:5] op_sel:[0,1,0] op_sel_hi:[1,1,0] neg_lo:[0,0,1] neg_hi:[0,0,1]
    v_pk_fma_f32 v[114:115], v[114:115], s[6:7], v[4:5] op_sel:[0,1,1] neg_lo:[1,0,0] neg_hi:[1,0,0]
    v_pk_fma_f32 v[132:133], v[116:117], s[6:7], v[4:5] op_sel:[0,1,0] op_sel_hi:[1,1,0] neg_lo:[0,0,1] neg_hi:[0,0,1]
    v_pk_fma_f32 v[116:117], v[116:117], s[6:7], v[4:5] op_sel:[0,1,1] neg_lo:[1,0,0] neg_hi:[1,0,0]
    v_pk_fma_f32 v[134:135], v[118:119], s[6:7], v[4:5] op_sel:[0,1,0] op_sel_hi:[1,1,0] neg_lo:[0,0,1] neg_hi:[0,0,1]
    v_pk_fma_f32 v[118:119], v[118:119], s[6:7], v[4:5] op_sel:[0,1,1] neg_lo:[1,0,0] neg_hi:[1,0,0]
    v_pk_fma_f32 v[136:137], v[120:121], s[6:7], v[4:5] op_sel:[0,1,0] op_sel_hi:[1,1,0] neg_lo:[0,0,1] neg_hi:[0,0,1]
    v_pk_fma_f32 v[120:121], v[120:121], s[6:7], v[4:5] op_sel:[0,1,1] neg_lo:[1,0,0] neg_hi:[1,0,0]
    v_pk_fma_f32 v[138:139], v[122:123], s[6:7], v[4:5] op_sel:[0,1,0] op_sel_hi:[1,1,0] neg_lo:[0,0,1] neg_hi:[0,0,1]
    v_pk_fma_f32 v[122:123], v[122:123], s[6:7], v[4:5] op_sel:[0,1,1] neg_lo:[1,0,0] neg_hi:[1,0,0]
    v_pk_fma_f32 v[140:141], v[124:125], s[6:7], v[4:5] op_sel:[0,1,0] op_sel_hi:[1,1,0] neg_lo:[0,0,1] neg_hi:[0,0,1]
    v_pk_fma_f32 v[124:125], v[124:125], s[6:7], v[4:5] op_sel:[0,1,1] neg_lo:[1,0,0] neg_hi:[1,0,0]
    v_pk_fma_f32 v[142:143], v[126:127], s[6:7], v[4:5] op_sel:[0,1,0] op_sel_hi:[1,1,0] neg_lo:[0,0,1] neg_hi:[0,0,1]
    v_pk_fma_f32 v[126:127], v[126:127], s[6:7], v[4:5] op_sel:[0,1,1] neg_lo:[1,0,0] neg_hi:[1,0,0]
    v_exp_f32 v128, v128
    v_exp_f32 v112, v112
    v_exp_f32 v129, v129
    v_exp_f32 v113, v113
    v_exp_f32 v130, v130
    v_exp_f32 v114, v114
    v_exp_f32 v131, v131
    v_exp_f32 v115, v115
    v_exp_f32 v132, v132
    v_exp_f32 v116, v116
    v_exp_f32 v133, v133
    v_exp_f32 v117, v117
    v_exp_f32 v134, v134
    v_exp_f32 v118, v118
    v_exp_f32 v135, v135
    v_exp_f32 v119, v119
    v_exp_f32 v136, v136
    v_exp_f32 v120, v120
    v_exp_f32 v137, v137
    v_exp_f32 v121, v121
    v_exp_f32 v138, v138
    v_exp_f32 v122, v122
    v_exp_f32 v139, v139
    v_exp_f32 v123, v123
    v_exp_f32 v140, v140
    v_exp_f32 v124, v124
    v_exp_f32 v141, v141
    v_exp_f32 v125, v125
    v_exp_f32 v142, v142
    v_exp_f32 v126, v126
    v_exp_f32 v143, v143
    v_exp_f32 v127, v127
    v_pk_add_f32 v[8:9], v[128:129], v[130:131]
    v_pk_add_f32 v[10:11], v[112:113], v[114:115]
    v_pk_add_f32 v[8:9], v[8:9], v[132:133]
    v_pk_add_f32 v[10:11], v[10:11], v[116:117]
    v_pk_add_f32 v[8:9], v[8:9], v[134:135]
    v_pk_add_f32 v[10:11], v[10:11], v[118:119]
    v_pk_add_f32 v[8:9], v[8:9], v[136:137]
    v_pk_add_f32 v[10:11], v[10:11], v[120:121]
    v_pk_add_f32 v[8:9], v[8:9], v[138:139]
    v_pk_add_f32 v[10:11], v[10:11], v[122:123]
    v_pk_add_f32 v[8:9], v[8:9], v[140:141]
    v_pk_add_f32 v[10:11], v[10:11], v[124:125]
    v_pk_add_f32 v[8:9], v[8:9], v[142:143]
    v_pk_add_f32 v[10:11], v[10:11], v[126:127]
    v_add_f32 v6, v8, v9
    v_add_f32 v7, v10, v11
    v_add_f32 v4, v8, v9
    v_add_f32 v5, v10, v11
    s_nop 0
    v_permlane32_swap_b32 v4, v6
    v_permlane32_swap_b32 v5, v7
    v_pk_add_f32 v[4:5], v[4:5], v[6:7]
    v_rcp_f32 v4, v4
    v_rcp_f32 v5, v5
    s_nop 0
    v_pk_mul_f32 v[128:129], v[128:129], v[4:5] op_sel_hi:[1,0]
    v_pk_mul_f32 v[112:113], v[112:113], v[4:5] op_sel:[0,1]
    v_pk_mul_f32 v[130:131], v[130:131], v[4:5] op_sel_hi:[1,0]
    v_pk_mul_f32 v[114:115], v[114:115], v[4:5] op_sel:[0,1]
    v_pk_mul_f32 v[132:133], v[132:133], v[4:5] op_sel_hi:[1,0]
    v_pk_mul_f32 v[116:117], v[116:117], v[4:5] op_sel:[0,1]
    v_pk_mul_f32 v[134:135], v[134:135], v[4:5] op_sel_hi:[1,0]
    v_pk_mul_f32 v[118:119], v[118:119], v[4:5] op_sel:[0,1]
    v_pk_mul_f32 v[136:137], v[136:137], v[4:5] op_sel_hi:[1,0]
    v_pk_mul_f32 v[120:121], v[120:121], v[4:5] op_sel:[0,1]
    v_pk_mul_f32 v[138:139], v[138:139], v[4:5] op_sel_hi:[1,0]
    v_pk_mul_f32 v[122:123], v[122:123], v[4:5] op_sel:[0,1]
    v_pk_mul_f32 v[140:141], v[140:141], v[4:5] op_sel_hi:[1,0]
    v_pk_mul_f32 v[124:125], v[124:125], v[4:5] op_sel:[0,1]
    v_pk_mul_f32 v[142:143], v[142:143], v[4:5] op_sel_hi:[1,0]
    v_pk_mul_f32 v[126:127], v[126:127], v[4:5] op_sel:[0,1]
    v_cvt_pk_bf16_f32 v80, v128, v129
    v_cvt_pk_bf16_f32 v88, v112, v113
    v_cvt_pk_bf16_f32 v81, v130, v131
    v_cvt_pk_bf16_f32 v89, v114, v115
    v_cvt_pk_bf16_f32 v82, v132, v133
    v_cvt_pk_bf16_f32 v90, v116, v117
    v_cvt_pk_bf16_f32 v83, v134, v135
    v_cvt_pk_bf16_f32 v91, v118, v119
    v_cvt_pk_bf16_f32 v84, v136, v137
    v_cvt_pk_bf16_f32 v92, v120, v121
    v_cvt_pk_bf16_f32 v85, v138, v139
    v_cvt_pk_bf16_f32 v93, v122, v123
    v_cvt_pk_bf16_f32 v86, v140, v141
    v_cvt_pk_bf16_f32 v94, v124, v125
    v_cvt_pk_bf16_f32 v87, v142, v143
    v_cvt_pk_bf16_f32 v95, v126, v127
    ds_write_b128 v75, v[80:83]
    ds_write_b128 v75, v[84:87] offset:4096
    ds_write_b128 v75, v[88:91] offset:8192
    ds_write_b128 v75, v[92:95] offset:12288
    s_lshl_b32 s13, s3, 12
    v_add_u32 v20, s13, v63
    s_lshl_b32 s96, s76, 13
    s_add_u32 s13, s96, 32768
    v_add_u32 v21, s13, v63
    v_mov_b32 v36, 0x3f803f80
    v_mov_b32 v37, 0x3f803f80
    v_mov_b32 v38, 0x3f803f80
    v_mov_b32 v39, 0x3f803f80
    s_lshl3_add_u32 s96, s11, s3
    s_lshl_b32 s97, s96, 5
    s_add_u32 s98, s97, s10
    s_lshl_b32 s99, s98, 10
    s_add_u32 s13, s99, 25165824
    s_add_u32 s15, s13, 16384
    s_lshl3_add_u32 s96, s11, s3
    s_lshl_b32 s97, s96, 10
    s_add_u32 s16, s97, 21495808
    s_lshl_b32 s96, s10, 6
    s_add_u32 s14, s96, s16
    s_waitcnt lgkmcnt(0)
    s_barrier
    ds_read_b64_tr_b16 v[128:129], v20
    ds_read_b64_tr_b16 v[130:131], v20 offset:512
    ds_read_b64_tr_b16 v[144:145], v21
    ds_read_b64_tr_b16 v[146:147], v21 offset:512
    ds_read_b64_tr_b16 v[148:149], v21 offset:4096
    ds_read_b64_tr_b16 v[150:151], v21 offset:4608
    ds_read_b64_tr_b16 v[132:133], v20 offset:1024
    ds_read_b64_tr_b16 v[134:135], v20 offset:1536
    ds_read_b64_tr_b16 v[152:153], v21 offset:1024
    ds_read_b64_tr_b16 v[154:155], v21 offset:1536
    ds_read_b64_tr_b16 v[156:157], v21 offset:5120
    ds_read_b64_tr_b16 v[158:159], v21 offset:5632
    ds_read_b64_tr_b16 v[136:137], v20 offset:2048
    ds_read_b64_tr_b16 v[138:139], v20 offset:2560
    ds_read_b64_tr_b16 v[160:161], v21 offset:2048
    ds_read_b64_tr_b16 v[162:163], v21 offset:2560
    ds_read_b64_tr_b16 v[164:165], v21 offset:6144
    ds_read_b64_tr_b16 v[166:167], v21 offset:6656
    s_waitcnt lgkmcnt(12)
    v_mfma_f32_16x16x32_bf16 v[52:55], v[128:131], v[144:147], 0
    v_mfma_f32_16x16x32_bf16 v[56:59], v[128:131], v[148:151], 0
    v_mfma_f32_16x16x32_bf16 v[40:43], v[128:131], v[36:39], 0
    ds_read_b64_tr_b16 v[140:141], v20 offset:3072
    ds_read_b64_tr_b16 v[142:143], v20 offset:3584
    ds_read_b64_tr_b16 v[168:169], v21 offset:3072
    ds_read_b64_tr_b16 v[170:171], v21 offset:3584
    ds_read_b64_tr_b16 v[172:173], v21 offset:7168
    ds_read_b64_tr_b16 v[174:175], v21 offset:7680
    s_waitcnt lgkmcnt(12)
    v_mfma_f32_16x16x32_bf16 v[52:55], v[132:135], v[152:155], v[52:55]
    v_mfma_f32_16x16x32_bf16 v[56:59], v[132:135], v[156:159], v[56:59]
    v_mfma_f32_16x16x32_bf16 v[40:43], v[132:135], v[36:39], v[40:43]
    v_and_b32 v75, 7, v1
    v_lshlrev_b32 v75, 17, v75
    v_bfe_u32 v9, v1, 3, 1
    v_lshl_add_u32 v75, v9, 14, v75
    s_and_b32 s96, s10, 1
    s_and_b32 s97, s2, 27
    s_lshl_b32 s98, s97, 12
    s_lshr_b32 s99, s10, 1
    s_lshl_b32 s97, s99, 6
    s_add_u32 s99, s98, s97
    s_lshl2_add_u32 s98, s96, s99
    s_add_u32 s97, s98, 1048576
    s_add_u32 s17, s97, 512
    s_waitcnt lgkmcnt(6)
    v_mfma_f32_16x16x32_bf16 v[52:55], v[136:139], v[160:163], v[52:55]
    v_mfma_f32_16x16x32_bf16 v[56:59], v[136:139], v[164:167], v[56:59]
    v_mfma_f32_16x16x32_bf16 v[40:43], v[136:139], v[36:39], v[40:43]
    s_waitcnt lgkmcnt(0)
    v_mfma_f32_16x16x32_bf16 v[52:55], v[140:143], v[168:171], v[52:55]
    v_mfma_f32_16x16x32_bf16 v[56:59], v[140:143], v[172:175], v[56:59]
    v_mfma_f32_16x16x32_bf16 v[40:43], v[140:143], v[36:39], v[40:43]
    s_cmp_lt_u32 s3, 4
    s_cbranch_scc1 L_NOQX
    ds_read_b128 v[44:47], v76 offset:2048
    ds_read_b128 v[48:51], v76 offset:3072
L_NOQX:
    s_nop 3
    buffer_store_dwordx4 v[52:55], v2, s[32:35], s13 offen sc1
    buffer_store_dwordx4 v[56:59], v2, s[32:35], s15 offen sc1
    s_mov_b32 exec_lo, 0x00010001
    s_mov_b32 exec_hi, 0x00010001
    buffer_store_dwordx4 v[40:43], v1, s[32:35], s14 offen sc1
    s_mov_b64 exec, -1
    s_waitcnt lgkmcnt(0)
    v_mfma_f32_32x32x16_bf16 v[112:127], v[28:31], v[44:47], 0
    v_mfma_f32_32x32x16_bf16 v[112:127], v[32:35], v[48:51], v[112:127]
    v_lshrrev_b32 v22, 3, v1
    v_lshlrev_b32 v22, 10, v22
    v_and_b32 v9, 7, v1
    v_lshl_add_u32 v22, v9, 4, v22
    v_and_b32 v76, 7, v1
    v_lshlrev_b32 v76, 4, v76
    v_lshrrev_b32 v9, 5, v1
    v_lshl_add_u32 v76, v9, 3, v76
    s_nop 3
    v_cvt_pk_bf16_f32 v112, 0, v112
    v_cvt_pk_bf16_f32 v113, 0, v113
    v_cvt_pk_bf16_f32 v114, 0, v114
    v_cvt_pk_bf16_f32 v115, 0, v115
    v_cvt_pk_bf16_f32 v116, 0, v116
    v_cvt_pk_bf16_f32 v117, 0, v117
    v_cvt_pk_bf16_f32 v118, 0, v118
    v_cvt_pk_bf16_f32 v119, 0, v119
    v_cvt_pk_bf16_f32 v120, 0, v120
    v_cvt_pk_bf16_f32 v121, 0, v121
    v_cvt_pk_bf16_f32 v122, 0, v122
    v_cvt_pk_bf16_f32 v123, 0, v123
    v_cvt_pk_bf16_f32 v124, 0, v124
    v_cvt_pk_bf16_f32 v125, 0, v125
    v_cvt_pk_bf16_f32 v126, 0, v126
    v_cvt_pk_bf16_f32 v127, 0, v127
    v_max3_f32 v52, v112, v113, v114
    v_min3_f32 v53, v112, v113, v114
    v_max3_f32 v52, v52, v115, v116
    v_min3_f32 v53, v53, v115, v116
    v_max3_f32 v52, v52, v117, v118
    v_min3_f32 v53, v53, v117, v118
    v_max3_f32 v52, v52, v119, v120
    v_min3_f32 v53, v53, v119, v120
    v_max3_f32 v52, v52, v121, v122
    v_min3_f32 v53, v53, v121, v122
    v_max3_f32 v52, v52, v123, v124
    v_min3_f32 v53, v53, v123, v124
    v_max3_f32 v52, v52, v125, v126
    v_min3_f32 v53, v53, v125, v126
    v_max_f32 v54, v52, v127
    v_min_f32 v55, v53, v127
    v_max_f32 v52, v52, v127
    v_min_f32 v53, v53, v127
    s_nop 0
    v_permlane32_swap_b32 v52, v54
    v_permlane32_swap_b32 v53, v55
    v_max_f32 v52, v52, v54
    v_min_f32 v53, v53, v55
    v_pk_mul_f32 v[52:53], v[52:53], s[6:7] op_sel:[0,1]
    v_pk_fma_f32 v[128:129], v[112:113], s[6:7], v[52:53] op_sel:[0,1,0] op_sel_hi:[1,1,0] neg_lo:[0,0,1] neg_hi:[0,0,1]
    v_pk_fma_f32 v[112:113], v[112:113], s[6:7], v[52:53] op_sel:[0,1,1] neg_lo:[1,0,0] neg_hi:[1,0,0]
    v_pk_fma_f32 v[130:131], v[114:115], s[6:7], v[52:53] op_sel:[0,1,0] op_sel_hi:[1,1,0] neg_lo:[0,0,1] neg_hi:[0,0,1]
    v_pk_fma_f32 v[114:115], v[114:115], s[6:7], v[52:53] op_sel:[0,1,1] neg_lo:[1,0,0] neg_hi:[1,0,0]
    v_pk_fma_f32 v[132:133], v[116:117], s[6:7], v[52:53] op_sel:[0,1,0] op_sel_hi:[1,1,0] neg_lo:[0,0,1] neg_hi:[0,0,1]
    v_pk_fma_f32 v[116:117], v[116:117], s[6:7], v[52:53] op_sel:[0,1,1] neg_lo:[1,0,0] neg_hi:[1,0,0]
    v_pk_fma_f32 v[134:135], v[118:119], s[6:7], v[52:53] op_sel:[0,1,0] op_sel_hi:[1,1,0] neg_lo:[0,0,1] neg_hi:[0,0,1]
    v_pk_fma_f32 v[118:119], v[118:119], s[6:7], v[52:53] op_sel:[0,1,1] neg_lo:[1,0,0] neg_hi:[1,0,0]
    v_pk_fma_f32 v[136:137], v[120:121], s[6:7], v[52:53] op_sel:[0,1,0] op_sel_hi:[1,1,0] neg_lo:[0,0,1] neg_hi:[0,0,1]
    v_pk_fma_f32 v[120:121], v[120:121], s[6:7], v[52:53] op_sel:[0,1,1] neg_lo:[1,0,0] neg_hi:[1,0,0]
    v_pk_fma_f32 v[138:139], v[122:123], s[6:7], v[52:53] op_sel:[0,1,0] op_sel_hi:[1,1,0] neg_lo:[0,0,1] neg_hi:[0,0,1]
    v_pk_fma_f32 v[122:123], v[122:123], s[6:7], v[52:53] op_sel:[0,1,1] neg_lo:[1,0,0] neg_hi:[1,0,0]
    v_pk_fma_f32 v[140:141], v[124:125], s[6:7], v[52:53] op_sel:[0,1,0] op_sel_hi:[1,1,0] neg_lo:[0,0,1] neg_hi:[0,0,1]
    v_pk_fma_f32 v[124:125], v[124:125], s[6:7], v[52:53] op_sel:[0,1,1] neg_lo:[1,0,0] neg_hi:[1,0,0]
    v_pk_fma_f32 v[142:143], v[126:127], s[6:7], v[52:53] op_sel:[0,1,0] op_sel_hi:[1,1,0] neg_lo:[0,0,1] neg_hi:[0,0,1]
    v_pk_fma_f32 v[126:127], v[126:127], s[6:7], v[52:53] op_sel:[0,1,1] neg_lo:[1,0,0] neg_hi:[1,0,0]
    v_exp_f32 v128, v128
    v_exp_f32 v112, v112
    v_exp_f32 v129, v129
    s_waitcnt vmcnt(0)
    s_barrier
    s_cmp_lg_u32 s3, 0
    s_cbranch_scc1 L_PC
    v_mov_b32 v21, s4
    s_mov_b32 exec_hi, 0
    s_mov_b32 exec_lo, 65535
    buffer_store_dword v21, v75, s[32:35], s17 offen sc1
    s_mov_b64 exec, -1
L_PC:
    s_lshl4_add_u32 s96, s11, s10
    s_lshl_b32 s97, s96, 14
    s_lshl_b32 s98, s3, 7
    s_add_u32 s99, s97, s98
    s_add_u32 s13, s99, 25165824
    s_lshl4_add_u32 s96, s11, s10
    s_lshl_b32 s97, s96, 10
    s_lshl_b32 s98, s3, 7
    s_add_u32 s99, s97, s98
    s_add_u32 s15, s99, 29360128
    s_add_u32 s17, s17, 3072
    s_load_dwordx2 s[24:25], s[32:33], s92 offset:512 glc
    s_add_u32 s96, s84, 262144
    s_and_b32 s97, s96, 1048575
    s_add_u32 s19, s97, s88
    s_add_u32 m0, s89, 49152
    s_nop 0
    buffer_load_dwordx4 v74, s[44:47], s19 offen lds
    v_exp_f32 v113, v113
    v_exp_f32 v130, v130
    v_exp_f32 v114, v114
    v_exp_f32 v131, v131
    v_exp_f32 v115, v115
    v_exp_f32 v132, v132
    v_exp_f32 v116, v116
    v_exp_f32 v133, v133
    v_exp_f32 v117, v117
    v_exp_f32 v134, v134
    s_add_u32 s96, s84, 393216
    s_and_b32 s97, s96, 1048575
    s_add_u32 s19, s97, s88
    s_add_u32 m0, s89, 57344
    s_nop 0
    buffer_load_dwordx4 v74, s[44:47], s19 offen lds
    v_exp_f32 v118, v118
    v_exp_f32 v135, v135
    v_exp_f32 v119, v119
    v_exp_f32 v136, v136
    v_exp_f32 v120, v120
    v_exp_f32 v137, v137
    v_exp_f32 v121, v121
    v_exp_f32 v138, v138
    v_exp_f32 v122, v122
    s_add_u32 s96, s84, 524288
    s_and_b32 s97, s96, 1048575
    s_add_u32 s19, s97, s88
    s_add_u32 m0, s89, 65536
    s_nop 0
    buffer_load_dwordx4 v74, s[44:47], s19 offen lds
    v_exp_f32 v139, v139
    v_exp_f32 v123, v123
    v_exp_f32 v140, v140
    v_exp_f32 v124, v124
    v_exp_f32 v141, v141
    v_exp_f32 v125, v125
    v_exp_f32 v142, v142
    v_exp_f32 v126, v126
    v_exp_f32 v143, v143
    v_exp_f32 v127, v127
    s_add_u32 s96, s84, 655360
    s_and_b32 s97, s96, 1048575
    s_add_u32 s19, s97, s88
    s_add_u32 m0, s89, 73728
    s_nop 0
    buffer_load_dwordx4 v74, s[44:47], s19 offen lds
    v_pk_add_f32 v[56:57], v[128:129], v[130:131]
    v_pk_add_f32 v[58:59], v[112:113], v[114:115]
    v_pk_add_f32 v[56:57], v[56:57], v[132:133]
    v_pk_add_f32 v[58:59], v[58:59], v[116:117]
    v_pk_add_f32 v[56:57], v[56:57], v[134:135]
    v_pk_add_f32 v[58:59], v[58:59], v[118:119]
    v_pk_add_f32 v[56:57], v[56:57], v[136:137]
    v_pk_add_f32 v[58:59], v[58:59], v[120:121]
    v_pk_add_f32 v[56:57], v[56:57], v[138:139]
    s_add_u32 s96, s84, 786432
    s_and_b32 s97, s96, 1048575
    s_add_u32 s19, s97, s88
    s_add_u32 m0, s89, 81920
    s_nop 0
    buffer_load_dwordx4 v74, s[44:47], s19 offen lds
    v_pk_add_f32 v[58:59], v[58:59], v[122:123]
    v_pk_add_f32 v[56:57], v[56:57], v[140:141]
    v_pk_add_f32 v[58:59], v[58:59], v[124:125]
    v_pk_add_f32 v[56:57], v[56:57], v[142:143]
    v_pk_add_f32 v[58:59], v[58:59], v[126:127]
    v_add_f32 v54, v56, v57
    v_add_f32 v55, v58, v59
    v_add_f32 v52, v56, v57
    v_add_f32 v53, v58, v59
    s_nop 0
    v_permlane32_swap_b32 v52, v54
    s_add_u32 s96, s84, 917504
    s_and_b32 s97, s96, 1048575
    s_add_u32 s19, s97, s88
    s_add_u32 m0, s89, 90112
    s_nop 0
    buffer_load_dwordx4 v74, s[44:47], s19 offen lds
    v_permlane32_swap_b32 v53, v55
    v_pk_add_f32 v[52:53], v[52:53], v[54:55]
    v_rcp_f32 v52, v52
    v_rcp_f32 v53, v53
    s_nop 0
    v_pk_mul_f32 v[128:129], v[128:129], v[52:53] op_sel_hi:[1,0]
    v_pk_mul_f32 v[112:113], v[112:113], v[52:53] op_sel:[0,1]
    v_pk_mul_f32 v[130:131], v[130:131], v[52:53] op_sel_hi:[1,0]
    v_pk_mul_f32 v[114:115], v[114:115], v[52:53] op_sel:[0,1]
    v_pk_mul_f32 v[132:133], v[132:133], v[52:53] op_sel_hi:[1,0]
    s_branch SCHK_15
SPOLL_14:
    s_load_dwordx2 s[24:25], s[32:33], s92 offset:512 glc
SCHK_15:
    s_add_u32 s5, s5, 1
    s_cmp_ge_u32 s5, 300000
    s_waitcnt lgkmcnt(0)
    s_cbranch_scc1 SDONE_16
    s_cmp_lg_u32 s24, s4
    s_cbranch_scc1 SPOLL_14
    s_cmp_lg_u32 s25, s4
    s_cbranch_scc1 SPOLL_14
SDONE_16:
    s_barrier
    s_add_u32 s18, s13, 8192
    buffer_load_dwordx4 v[144:147], v22, s[32:35], s13 offen sc1
    buffer_load_dwordx4 v[148:151], v22, s[32:35], s18 offen sc1
    buffer_load_dwordx4 v[160:163], v2, s[32:35], s16 offen sc1
    s_lshl_b32 s96, s3, 5
    s_add_u32 s14, s96, 8192
    v_and_b32 v6, 3, v1
    v_lshl_add_u32 v6, v6, 3, s14
    v_lshrrev_b32 v9, 5, v1
    v_lshl_add_u32 v6, v9, 2, v6
    s_lshl_b32 s14, s3, 10
    v_and_b32 v5, 15, v1
    v_lshl_add_u32 v5, v5, 4, s14
    v_lshrrev_b32 v9, 5, v1
    v_lshl_add_u32 v5, v9, 9, v5
    v_bfe_u32 v9, v1, 4, 1
    v_lshl_add_u32 v5, v9, 3, v5
    s_lshl_b32 s96, s76, 7
    s_add_u32 s14, s96, 8192
    v_lshrrev_b32 v7, 5, v1
    v_lshl_add_u32 v7, v7, 4, s14
    s_lshl_b32 s14, s76, 12
    v_add_u32 v20, s14, v2
    v_pk_mul_f32 v[116:117], v[116:117], v[52:53] op_sel:[0,1]
    v_pk_mul_f32 v[134:135], v[134:135], v[52:53] op_sel_hi:[1,0]
    v_pk_mul_f32 v[118:119], v[118:119], v[52:53] op_sel:[0,1]
    v_pk_mul_f32 v[136:137], v[136:137], v[52:53] op_sel_hi:[1,0]
    v_pk_mul_f32 v[120:121], v[120:121], v[52:53] op_sel:[0,1]
    v_pk_mul_f32 v[138:139], v[138:139], v[52:53] op_sel_hi:[1,0]
    v_pk_mul_f32 v[122:123], v[122:123], v[52:53] op_sel:[0,1]
    v_pk_mul_f32 v[140:141], v[140:141], v[52:53] op_sel_hi:[1,0]
    v_pk_mul_f32 v[124:125], v[124:125], v[52:53] op_sel:[0,1]
    v_pk_mul_f32 v[142:143], v[142:143], v[52:53] op_sel_hi:[1,0]
    v_pk_mul_f32 v[126:127], v[126:127], v[52:53] op_sel:[0,1]
    v_cvt_pk_bf16_f32 v80, v128, v129
    v_cvt_pk_bf16_f32 v88, v112, v113
    v_cvt_pk_bf16_f32 v81, v130, v131
    v_cvt_pk_bf16_f32 v89, v114, v115
    v_cvt_pk_bf16_f32 v82, v132, v133
    v_cvt_pk_bf16_f32 v90, v116, v117
    v_cvt_pk_bf16_f32 v83, v134, v135
    v_cvt_pk_bf16_f32 v91, v118, v119
    v_cvt_pk_bf16_f32 v84, v136, v137
    v_cvt_pk_bf16_f32 v92, v120, v121
    v_cvt_pk_bf16_f32 v85, v138, v139
    v_cvt_pk_bf16_f32 v93, v122, v123
    v_cvt_pk_bf16_f32 v86, v140, v141
    v_cvt_pk_bf16_f32 v94, v124, v125
    v_cvt_pk_bf16_f32 v87, v142, v143
    v_cvt_pk_bf16_f32 v95, v126, v127
    s_waitcnt vmcnt(1)
    v_pk_add_f32 v[144:145], v[144:145], v[148:149]
    v_pk_add_f32 v[146:147], v[146:147], v[150:151]
    s_nop 1
    v_permlane32_swap_b32 v144, v146
    v_permlane32_swap_b32 v145, v147
    v_pk_add_f32 v[144:145], v[144:145], v[146:147]
    s_nop 1
    v_add_f32_dpp v144, v144, v144 row_ror:8 row_mask:0xf bank_mask:0xf
    v_add_f32_dpp v145, v145, v145 row_ror:8 row_mask:0xf bank_mask:0xf
    v_mov_b32 v146, v144
    v_mov_b32 v147, v145
    s_nop 0
    v_permlane16_swap_b32 v144, v146
    v_permlane16_swap_b32 v145, v147
    v_pk_add_f32 v[144:145], v[144:145], v[146:147]
    v_cvt_pk_bf16_f32 v144, v144, v145
    v_mov_b32 v145, s4
    s_mov_b32 exec_lo, 0xff
    s_mov_b32 exec_hi, 0xff
    buffer_store_dwordx2 v[144:145], v76, s[32:35], s15 offen sc1
    s_mov_b64 exec, -1
    s_barrier
    s_cmp_lg_u32 s3, 0
    s_cbranch_scc1 L_PC2
    v_mov_b32 v21, s4
    s_mov_b32 exec_hi, 0
    s_mov_b32 exec_lo, 65535
    buffer_store_dword v21, v75, s[32:35], s17 offen sc1
    s_mov_b64 exec, -1
L_PC2:
    s_waitcnt vmcnt(1)
    s_add_u32 s96, s84, 1572864
    s_and_b32 s97, s96, 1048575
    s_xor_b32 s98, s88, 1048576
    s_add_u32 s19, s97, s98
    s_add_u32 m0, s89, 131072
    s_nop 0
    buffer_load_dwordx4 v74, s[44:47], s19 offen lds
    v_permlane32_swap_b32 v160, v162
    v_permlane32_swap_b32 v161, v163
    v_pk_add_f32 v[160:161], v[160:161], v[162:163]
    s_nop 1
    v_add_f32_dpp v160, v160, v160 row_ror:4 row_mask:0xf bank_mask:0xf
    v_add_f32_dpp v161, v161, v161 row_ror:4 row_mask:0xf bank_mask:0xf
    s_nop 0
    v_add_f32_dpp v160, v160, v160 row_ror:8 row_mask:0xf bank_mask:0xf
    v_add_f32_dpp v161, v161, v161 row_ror:8 row_mask:0xf bank_mask:0xf
    s_add_u32 s96, s84, 1703936
    s_and_b32 s97, s96, 1048575
    s_xor_b32 s98, s88, 1048576
    s_add_u32 s19, s97, s98
    s_add_u32 m0, s89, 139264
    s_nop 0
    buffer_load_dwordx4 v74, s[44:47], s19 offen lds
    v_mov_b32 v162, v160
    v_mov_b32 v163, v161
    s_nop 0
    v_permlane16_swap_b32 v160, v162
    v_permlane16_swap_b32 v161, v163
    v_pk_add_f32 v[160:161], v[160:161], v[162:163]
    v_cvt_pk_bf16_f32 v160, v160, v161
    ds_write_b32 v6, v160
    s_waitcnt lgkmcnt(0)
    s_barrier
    ds_read_b128 v[160:163], v7
    ds_read_b128 v[164:167], v7 offset:32
    ds_read_b128 v[168:171], v7 offset:64
    ds_read_b128 v[172:175], v7 offset:96
    s_waitcnt lgkmcnt(0)
    s_lshl3_add_u32 s96, s11, s3
    s_lshl_b32 s97, s96, 11
    s_add_u32 s13, s97, 29360128
    s_load_dwordx2 s[24:25], s[32:33], s92 offset:3584 glc
    v_mfma_f32_32x32x16_bf16 v[128:143], v[160:163], v[80:83], 0
    v_mfma_f32_32x32x16_bf16 v[128:143], v[164:167], v[84:87], v[128:143]
    v_mfma_f32_32x32x16_bf16 v[128:143], v[168:171], v[88:91], v[128:143]
    v_mfma_f32_32x32x16_bf16 v[128:143], v[172:175], v[92:95], v[128:143]
    s_nop 11
    v_cvt_pk_bf16_f32 v128, 0, v128
    v_add_f32 v128, 0x358637bd, v128
    v_cvt_pk_bf16_f32 v128, 0, v128
    v_rcp_f32 v128, v128
    s_branch SCHK_18
SPOLL_17:
    s_load_dwordx2 s[24:25], s[32:33], s92 offset:3584 glc
SCHK_18:
    s_add_u32 s5, s5, 1
    s_cmp_ge_u32 s5, 300000
    s_waitcnt lgkmcnt(0)
    s_cbranch_scc1 SDONE_19
    s_cmp_lg_u32 s24, s4
    s_cbranch_scc1 SPOLL_17
    s_cmp_lg_u32 s25, s4
    s_cbranch_scc1 SPOLL_17
SDONE_19:
POLL_20:
    buffer_load_dwordx4 v[152:155], v2, s[32:35], s13 offen sc1
    buffer_load_dwordx4 v[156:159], v2, s[32:35], s13 offen offset:1024 sc1
    s_waitcnt vmcnt(0)
    v_bitop3_b32 v4, v153, v155, s4 bitop3:0x7e
    v_bitop3_b32 v4, v4, v157, s4 bitop3:0xf6
    v_bitop3_b32 v4, v4, v159, s4 bitop3:0xf6
    v_cmp_ne_u32 vcc, 0, v4
    s_cbranch_vccz PDONE_21
    s_add_u32 s5, s5, 1
    s_cmp_lt_u32 s5, 300000
    s_cbranch_scc1 POLL_20
PDONE_21:
    ds_write2_b32 v5, v152, v154 offset0:0 offset1:1
    ds_write2_b32 v5, v156, v158 offset0:64 offset1:65
    s_waitcnt lgkmcnt(0)
    s_barrier
    ds_read_b128 v[144:147], v20
    ds_read_b128 v[148:151], v20 offset:1024
    ds_read_b128 v[152:155], v20 offset:2048
    ds_read_b128 v[156:159], v20 offset:3072
    v_and_b32 v23, 31, v1
    v_lshlrev_b32 v23, 4, v23
    v_lshrrev_b32 v9, 5, v1
    v_lshl_add_u32 v23, v9, 9, v23
    s_and_b32 s96, s3, 3
    s_lshl4_add_u32 s97, s96, s12
    s_lshl_b32 s98, s97, 11
    s_add_u32 s18, s98, 131072
    s_lshl_b32 s13, s12, 7
    v_and_b32 v4, 31, v1
    v_lshl_add_u32 v4, v4, 2, s13
    global_load_dword v104, v4, s[78:79]
    buffer_load_dword v105, v3, s[32:35], 0 offen offset:256 sc1
    buffer_load_dwordx4 v[96:99], v23, s[32:35], s18 offen sc1
    buffer_load_dwordx4 v[100:103], v23, s[32:35], s18 offen offset:1024 sc1
    s_and_b32 s96, s3, 3
    s_lshl2_add_u32 s97, s10, s96
    s_lshl4_add_u32 s98, s97, s11
    s_lshl1_add_u32 s99, s98, s76
    s_lshl_b32 s96, s99, 11
    s_add_u32 s13, s96, 8388608
    s_waitcnt lgkmcnt(3)
    v_mfma_f32_32x32x16_bf16 v[112:127], v[144:147], v[80:83], 0
    s_waitcnt lgkmcnt(2)
    v_mfma_f32_32x32x16_bf16 v[112:127], v[148:151], v[84:87], v[112:127]
    s_waitcnt lgkmcnt(1)
    v_mfma_f32_32x32x16_bf16 v[112:127], v[152:155], v[88:91], v[112:127]
    s_waitcnt lgkmcnt(0)
    v_mfma_f32_32x32x16_bf16 v[112:127], v[156:159], v[92:95], v[112:127]
    s_nop 11
    v_cvt_pk_bf16_f32 v112, 0, v112
    v_cvt_pk_bf16_f32 v113, 0, v113
    v_cvt_pk_bf16_f32 v114, 0, v114
    v_cvt_pk_bf16_f32 v115, 0, v115
    v_cvt_pk_bf16_f32 v116, 0, v116
    v_cvt_pk_bf16_f32 v117, 0, v117
    v_cvt_pk_bf16_f32 v118, 0, v118
    v_cvt_pk_bf16_f32 v119, 0, v119
    v_pk_mul_f32 v[112:113], v[112:113], v[128:129] op_sel_hi:[1,0]
    v_pk_mul_f32 v[114:115], v[114:115], v[128:129] op_sel_hi:[1,0]
    v_pk_mul_f32 v[116:117], v[116:117], v[128:129] op_sel_hi:[1,0]
    v_pk_mul_f32 v[118:119], v[118:119], v[128:129] op_sel_hi:[1,0]
    v_cvt_pk_bf16_f32 v44, v112, v113
    v_cvt_pk_bf16_f32 v45, v114, v115
    v_cvt_pk_bf16_f32 v46, v116, v117
    v_cvt_pk_bf16_f32 v47, v118, v119
    buffer_store_dwordx4 v[44:47], v2, s[32:35], s13 offen sc1
    v_cvt_pk_bf16_f32 v120, 0, v120
    v_cvt_pk_bf16_f32 v121, 0, v121
    v_cvt_pk_bf16_f32 v122, 0, v122
    v_cvt_pk_bf16_f32 v123, 0, v123
    v_cvt_pk_bf16_f32 v124, 0, v124
    v_cvt_pk_bf16_f32 v125, 0, v125
    v_cvt_pk_bf16_f32 v126, 0, v126
    v_cvt_pk_bf16_f32 v127, 0, v127
    v_pk_mul_f32 v[120:121], v[120:121], v[128:129] op_sel_hi:[1,0]
    v_pk_mul_f32 v[122:123], v[122:123], v[128:129] op_sel_hi:[1,0]
    v_pk_mul_f32 v[124:125], v[124:125], v[128:129] op_sel_hi:[1,0]
    v_pk_mul_f32 v[126:127], v[126:127], v[128:129] op_sel_hi:[1,0]
    v_cvt_pk_bf16_f32 v48, v120, v121
    v_cvt_pk_bf16_f32 v49, v122, v123
    v_cvt_pk_bf16_f32 v50, v124, v125
    v_cvt_pk_bf16_f32 v51, v126, v127
    buffer_store_dwordx4 v[48:51], v2, s[32:35], s13 offen offset:1024 sc1
    s_mul_i32 s96, s76, 65600
    s_add_u32 s17, s96, 32768
    v_bfe_u32 v20, v1, 2, 2
    v_lshlrev_b32 v20, 7, v20
    v_bfe_u32 v9, v1, 3, 1
    v_lshl_add_u32 v20, v9, 6, v20
    v_lshrrev_b32 v9, 5, v1
    v_lshl_add_u32 v20, v9, 10, v20
    v_and_b32 v9, 1, v1
    v_lshl_add_u32 v20, v9, 5, v20
    v_bfe_u32 v9, v1, 4, 1
    v_lshl_add_u32 v20, v9, 4, v20
    v_bfe_u32 v9, v1, 1, 1
    v_lshl_add_u32 v20, v9, 3, v20
    v_xor_b32 v20, s17, v20
    v_xor_b32 v21, 64, v20
    v_and_b32 v5, 7, v1
    v_lshlrev_b32 v5, 15, v5
    v_bfe_u32 v9, v1, 3, 1
    v_lshl_add_u32 v5, v9, 12, v5
    s_and_b32 s96, s11, 1
    s_lshr_b32 s97, s10, 2
    s_and_b32 s98, s10, 3
    s_lshl_b32 s99, s98, 6
    s_lshl1_add_u32 s98, s97, s99
    s_lshl_b32 s97, s98, 12
    s_lshr_b32 s99, s11, 1
    s_lshl_b32 s98, s99, 6
    s_add_u32 s99, s97, s98
    s_lshl2_add_u32 s97, s96, s99
    s_add_u32 s98, s97, 1048576
    s_add_u32 s15, s98, 1024
    v_lshlrev_b32 v24, 16, v12
    v_and_b32 v25, s6, v12
    v_lshlrev_b32 v26, 16, v13
    v_and_b32 v27, s6, v13
    v_lshlrev_b32 v28, 16, v14
    v_and_b32 v29, s6, v14
    v_lshlrev_b32 v30, 16, v15
    v_and_b32 v31, s6, v15
    v_lshlrev_b32 v32, 16, v16
    v_and_b32 v33, s6, v16
    v_lshlrev_b32 v34, 16, v17
    v_and_b32 v35, s6, v17
    v_lshlrev_b32 v36, 16, v18
    v_and_b32 v37, s6, v18
    v_lshlrev_b32 v38, 16, v19
    v_and_b32 v39, s6, v19
    s_lshl1_add_u32 s96, s94, s77
    s_lshl_b32 s97, s96, 15
    s_add_u32 s19, s97, 8388608
    s_waitcnt vmcnt(0)
    s_barrier
    s_cmp_lg_u32 s3, 0
    s_cbranch_scc1 L_PD
    v_mov_b32 v6, s4
    s_mov_b32 exec_hi, 0
    s_mov_b32 exec_lo, 65535
    buffer_store_dword v6, v5, s[32:35], s15 offen sc1
    s_mov_b64 exec, -1
L_PD:
    s_add_u32 s96, s84, 1835008
    s_and_b32 s97, s96, 1048575
    s_xor_b32 s98, s88, 1048576
    s_add_u32 s13, s97, s98
    s_add_u32 m0, s89, 147456
    s_nop 0
    buffer_load_dwordx4 v74, s[44:47], s13 offen lds
    s_add_u32 s96, s84, 1966080
    s_and_b32 s97, s96, 1048575
    s_xor_b32 s98, s88, 1048576
    s_add_u32 s13, s97, s98
    s_add_u32 m0, s89, 155648
    s_nop 0
    buffer_load_dwordx4 v74, s[44:47], s13 offen lds
    s_and_b32 s96, s84, 1048575
    s_add_u32 s13, s96, s88
    s_add_u32 m0, s89, 32768
    s_nop 0
    buffer_load_dwordx4 v74, s[44:47], s13 offen lds
    s_add_u32 s96, s84, 131072
    s_and_b32 s97, s96, 1048575
    s_add_u32 s13, s97, s88
    s_add_u32 m0, s89, 40960
    s_nop 0
    buffer_load_dwordx4 v74, s[44:47], s13 offen lds
    v_bitop3_b32 v4, v97, v99, s4 bitop3:0x7e
    v_bitop3_b32 v4, v4, v101, s4 bitop3:0xf6
    v_bitop3_b32 v4, v4, v103, s4 bitop3:0xf6
    v_cmp_ne_u32 vcc, 0, v4
    s_cbranch_vccz TOK_22
POLL_23:
    buffer_load_dwordx4 v[96:99], v23, s[32:35], s18 offen sc1
    buffer_load_dwordx4 v[100:103], v23, s[32:35], s18 offen offset:1024 sc1
    s_waitcnt vmcnt(0)
    v_bitop3_b32 v4, v97, v99, s4 bitop3:0x7e
    v_bitop3_b32 v4, v4, v101, s4 bitop3:0xf6
    v_bitop3_b32 v4, v4, v103, s4 bitop3:0xf6
    v_cmp_ne_u32 vcc, 0, v4
    s_cbranch_vccz PDONE_24
    s_add_u32 s5, s5, 1
    s_cmp_lt_u32 s5, 300000
    s_cbranch_scc1 POLL_23
PDONE_24:
TOK_22:
    v_cmp_eq_u32 vcc, s4, v105
    s_nop 0
    s_cmp_eq_u32 vcc_lo, 0
    s_cselect_b32 s93, 1, 0
    s_and_b32 s96, s3, 3
    s_lshl_b32 s97, s96, 7
    s_add_u32 s13, s97, 12288
    v_and_b32 v4, 31, v1
    v_lshl_add_u32 v4, v4, 2, s13
    s_and_b32 s14, s3, 3
    v_add_f32 v96, v96, v100
    v_add_f32 v97, v98, v102
    v_mov_b32 v98, v96
    v_mov_b32 v99, v97
    s_cmp_eq_u32 s14, 2
    s_cselect_b32 s15, 1.0, 0
    v_permlane32_swap_b32 v96, v98
    v_permlane32_swap_b32 v97, v99
    v_pk_add_f32 v[96:97], v[96:97], v[98:99]
    v_cvt_pk_bf16_f32 v96, 0, v96
    v_cvt_pk_bf16_f32 v97, 0, v97
    v_add_f32 v96, s15, v96
    v_add_f32 v97, s15, v97
    v_cvt_pk_bf16_f32 v98, v96, v97
    ds_write_b32 v4, v98
    s_cbranch_scc0 L_NOG
    v_lshlrev_b32 v96, 16, v98
    v_and_b32 v97, s6, v98
    v_lshlrev_b32 v100, 16, v104
    v_and_b32 v101, s6, v104
    v_pk_mul_f32 v[100:101], v[100:101], v[96:97]
    v_cvt_pk_bf16_f32 v102, v100, v101
    v_lshlrev_b32 v96, 16, v102
    v_and_b32 v97, s6, v102
    v_pk_add_f32 v[96:97], v[100:101], v[96:97] neg_lo:[0,1] neg_hi:[0,1]
    v_cvt_pk_bf16_f32 v103, v96, v97
    v_add_f32 v96, v100, v101
    ds_write2_b32 v4, v102, v103 offset0:64 offset1:96
    ds_write_b32 v4, v104 offset:512
    v_add_f32_dpp v96, v96, v96 quad_perm:[1,0,3,2] row_mask:0xf bank_mask:0xf
    s_nop 1
    v_add_f32_dpp v96, v96, v96 quad_perm:[2,3,0,1] row_mask:0xf bank_mask:0xf
    s_nop 1
    v_add_f32_dpp v96, v96, v96 row_half_mirror row_mask:0xf bank_mask:0xf
    s_nop 1
    v_add_f32_dpp v96, v96, v96 row_ror:8 row_mask:0xf bank_mask:0xf
    s_lshl4_add_u32 s96, s21, s12
    s_lshl3_add_u32 s13, s96, 65536
    v_mov_b32 v98, v96
    v_mov_b32 v97, s4
    s_nop 0
    v_permlane16_swap_b32 v96, v98
    v_add_f32 v96, v96, v98
    s_mov_b64 exec, 1
    buffer_store_dwordx2 v[96:97], v3, s[32:35], s13 offen sc1
    s_mov_b64 exec, -1
L_NOG:
    s_lshl_b32 s96, s76, 6
    s_add_u32 s13, s96, 12288
    v_lshrrev_b32 v7, 5, v1
    v_lshl_add_u32 v7, v7, 5, s13
    v_and_b32 v8, 7, v1
    v_lshlrev_b32 v8, 2, v8
    v_add_u32 v8, v8, v7
    s_waitcnt lgkmcnt(0)
    s_barrier
    ds_read_b128 v[96:99], v7
    ds_read_b128 v[76:79], v7 offset:512
    ds_read_b128 v[84:87], v7 offset:640
    ds_read_b128 v[100:103], v7 offset:16
    ds_read_b128 v[80:83], v7 offset:528
    ds_read_b128 v[88:91], v7 offset:656
    ds_read_b32 v56, v8 offset:128
    ds_read_b32 v57, v8 offset:256
    ds_read_b32 v58, v8 offset:384
    ds_read_b32 v59, v8 offset:768
    s_waitcnt lgkmcnt(0)
    s_load_dwordx2 s[24:25], s[32:33], s92 offset:1024 glc
    v_lshlrev_b32 v40, 16, v96
    v_and_b32 v41, s6, v96
    v_lshlrev_b32 v42, 16, v97
    v_and_b32 v43, s6, v97
    v_lshlrev_b32 v44, 16, v98
    v_and_b32 v45, s6, v98
    v_lshlrev_b32 v46, 16, v99
    v_and_b32 v47, s6, v99
    v_lshlrev_b32 v48, 16, v100
    v_and_b32 v49, s6, v100
    v_lshlrev_b32 v50, 16, v101
    v_and_b32 v51, s6, v101
    v_lshlrev_b32 v52, 16, v102
    v_and_b32 v53, s6, v102
    v_lshlrev_b32 v54, 16, v103
    v_and_b32 v55, s6, v103
    v_and_b32 v60, 15, v1
    v_lshlrev_b32 v60, 3, v60
    s_waitcnt vmcnt(0)
    s_branch SCHK_26
SPOLL_25:
    s_load_dwordx2 s[24:25], s[32:33], s92 offset:1024 glc
SCHK_26:
    s_add_u32 s5, s5, 1
    s_cmp_ge_u32 s5, 300000
    s_waitcnt lgkmcnt(0)
    s_cbranch_scc1 SDONE_27
    s_cmp_lg_u32 s24, s4
    s_cbranch_scc1 SPOLL_25
    s_cmp_lg_u32 s25, s4
    s_cbranch_scc1 SPOLL_25
SDONE_27:
    s_barrier
    s_cmp_lt_u32 s3, 4
    s_cbranch_scc1 L_P2
    s_setprio 1
L_P2:
    s_and_b32 s96, s83, 15
    s_lshl_b32 s97, s96, 11
    s_add_u32 s20, s97, s19
    buffer_load_dwordx4 v[144:147], v2, s[32:35], s20 offen sc1
    ds_read_b64_tr_b16 v[164:165], v21
    ds_read_b64_tr_b16 v[166:167], v21 offset:512
    ds_read_b64_tr_b16 v[160:161], v20
    ds_read_b64_tr_b16 v[162:163], v20 offset:512
    buffer_load_dwordx4 v[148:151], v2, s[32:35], s20 offen offset:1024 sc1
    s_add_u32 s96, s83, 1
    s_and_b32 s97, s96, 15
    s_lshl_b32 s98, s97, 11
    s_add_u32 s20, s98, s19
    buffer_load_dwordx4 v[152:155], v2, s[32:35], s20 offen sc1
    buffer_load_dwordx4 v[156:159], v2, s[32:35], s20 offen offset:1024 sc1
    s_waitcnt vmcnt(3)
    s_waitcnt lgkmcnt(2)
    v_mfma_f32_32x32x16_bf16 v[128:143], v[164:167], v[144:147], 0
    ds_read_b64_tr_b16 v[172:173], v21 offset:2048
    ds_read_b64_tr_b16 v[174:175], v21 offset:2560
    s_waitcnt lgkmcnt(2)
    v_mfma_f32_32x32x16_bf16 v[112:127], v[160:163], v[144:147], 0
    ds_read_b64_tr_b16 v[168:169], v20 offset:2048
    ds_read_b64_tr_b16 v[170:171], v20 offset:2560
    s_add_u32 s96, s83, 2
    s_and_b32 s97, s96, 15
    s_lshl_b32 s98, s97, 11
    s_add_u32 s20, s98, s19
    buffer_load_dwordx4 v[144:147], v2, s[32:35], s20 offen sc1
    s_waitcnt vmcnt(3)
    s_waitcnt lgkmcnt(2)
    v_mfma_f32_32x32x16_bf16 v[128:143], v[172:175], v[148:151], v[128:143]
    ds_read_b64_tr_b16 v[164:165], v21 offset:4096
    ds_read_b64_tr_b16 v[166:167], v21 offset:4608
    s_waitcnt lgkmcnt(2)
    v_mfma_f32_32x32x16_bf16 v[112:127], v[168:171], v[148:151], v[112:127]
    ds_read_b64_tr_b16 v[160:161], v20 offset:4096
    ds_read_b64_tr_b16 v[162:163], v20 offset:4608
    buffer_load_dwordx4 v[148:151], v2, s[32:35], s20 offen offset:1024 sc1
    s_waitcnt vmcnt(3)
    s_waitcnt lgkmcnt(2)
    v_mfma_f32_32x32x16_bf16 v[128:143], v[164:167], v[152:155], v[128:143]
    ds_read_b64_tr_b16 v[172:173], v21 offset:6144
    ds_read_b64_tr_b16 v[174:175], v21 offset:6656
    s_waitcnt lgkmcnt(2)
    v_mfma_f32_32x32x16_bf16 v[112:127], v[160:163], v[152:155], v[112:127]
    ds_read_b64_tr_b16 v[168:169], v20 offset:6144
    ds_read_b64_tr_b16 v[170:171], v20 offset:6656
    s_add_u32 s96, s83, 3
    s_and_b32 s97, s96, 15
    s_lshl_b32 s98, s97, 11
    s_add_u32 s20, s98, s19
    buffer_load_dwordx4 v[152:155], v2, s[32:35], s20 offen sc1
    s_waitcnt vmcnt(3)
    s_waitcnt lgkmcnt(2)
    v_mfma_f32_32x32x16_bf16 v[128:143], v[172:175], v[156:159], v[128:143]
    ds_read_b64_tr_b16 v[164:165], v21 offset:8192
    ds_read_b64_tr_b16 v[166:167], v21 offset:8704
    s_waitcnt lgkmcnt(2)
    v_mfma_f32_32x32x16_bf16 v[112:127], v[168:171], v[156:159], v[112:127]
    ds_read_b64_tr_b16 v[160:161], v20 offset:8192
    ds_read_b64_tr_b16 v[162:163], v20 offset:8704
    buffer_load_dwordx4 v[156:159], v2, s[32:35], s20 offen offset:1024 sc1
    s_waitcnt vmcnt(3)
    s_waitcnt lgkmcnt(2)
    v_mfma_f32_32x32x16_bf16 v[128:143], v[164:167], v[144:147], v[128:143]
    ds_read_b64_tr_b16 v[172:173], v21 offset:10240
    ds_read_b64_tr_b16 v[174:175], v21 offset:10752
    s_waitcnt lgkmcnt(2)
    v_mfma_f32_32x32x16_bf16 v[112:127], v[160:163], v[144:147], v[112:127]
    ds_read_b64_tr_b16 v[168:169], v20 offset:10240
    ds_read_b64_tr_b16 v[170:171], v20 offset:10752
    s_add_u32 s96, s83, 4
    s_and_b32 s97, s96, 15
    s_lshl_b32 s98, s97, 11
    s_add_u32 s20, s98, s19
    buffer_load_dwordx4 v[144:147], v2, s[32:35], s20 offen sc1
    s_waitcnt vmcnt(3)
    s_waitcnt lgkmcnt(2)
    v_mfma_f32_32x32x16_bf16 v[128:143], v[172:175], v[148:151], v[128:143]
    ds_read_b64_tr_b16 v[164:165], v21 offset:12288
    ds_read_b64_tr_b16 v[166:167], v21 offset:12800
    s_waitcnt lgkmcnt(2)
    v_mfma_f32_32x32x16_bf16 v[112:127], v[168:171], v[148:151], v[112:127]
    ds_read_b64_tr_b16 v[160:161], v20 offset:12288
    ds_read_b64_tr_b16 v[162:163], v20 offset:12800
    buffer_load_dwordx4 v[148:151], v2, s[32:35], s20 offen offset:1024 sc1
    s_waitcnt vmcnt(3)
    s_waitcnt lgkmcnt(2)
    v_mfma_f32_32x32x16_bf16 v[128:143], v[164:167], v[152:155], v[128:143]
    ds_read_b64_tr_b16 v[172:173], v21 offset:14336
    ds_read_b64_tr_b16 v[174:175], v21 offset:14848
    s_waitcnt lgkmcnt(2)
    v_mfma_f32_32x32x16_bf16 v[112:127], v[160:163], v[152:155], v[112:127]
    ds_read_b64_tr_b16 v[168:169], v20 offset:14336
    ds_read_b64_tr_b16 v[170:171], v20 offset:14848
    s_add_u32 s96, s83, 5
    s_and_b32 s97, s96, 15
    s_lshl_b32 s98, s97, 11
    s_add_u32 s20, s98, s19
    buffer_load_dwordx4 v[152:155], v2, s[32:35], s20 offen sc1
    s_waitcnt vmcnt(3)
    s_waitcnt lgkmcnt(2)
    v_mfma_f32_32x32x16_bf16 v[128:143], v[172:175], v[156:159], v[128:143]
    ds_read_b64_tr_b16 v[164:165], v21 offset:16384
    ds_read_b64_tr_b16 v[166:167], v21 offset:16896
    s_waitcnt lgkmcnt(2)
    v_mfma_f32_32x32x16_bf16 v[112:127], v[168:171], v[156:159], v[112:127]
    ds_read_b64_tr_b16 v[160:161], v20 offset:16384
    ds_read_b64_tr_b16 v[162:163], v20 offset:16896
    buffer_load_dwordx4 v[156:159], v2, s[32:35], s20 offen offset:1024 sc1
    s_waitcnt vmcnt(3)
    s_waitcnt lgkmcnt(2)
    v_mfma_f32_32x32x16_bf16 v[128:143], v[164:167], v[144:147], v[128:143]
    ds_read_b64_tr_b16 v[172:173], v21 offset:18432
    ds_read_b64_tr_b16 v[174:175], v21 offset:18944
    s_waitcnt lgkmcnt(2)
    v_mfma_f32_32x32x16_bf16 v[112:127], v[160:163], v[144:147], v[112:127]
    ds_read_b64_tr_b16 v[168:169], v20 offset:18432
    ds_read_b64_tr_b16 v[170:171], v20 offset:18944
    s_add_u32 s96, s83, 6
    s_and_b32 s97, s96, 15
    s_lshl_b32 s98, s97, 11
    s_add_u32 s20, s98, s19
    buffer_load_dwordx4 v[144:147], v2, s[32:35], s20 offen sc1
    s_waitcnt vmcnt(3)
    s_waitcnt lgkmcnt(2)
    v_mfma_f32_32x32x16_bf16 v[128:143], v[172:175], v[148:151], v[128:143]
    ds_read_b64_tr_b16 v[164:165], v21 offset:20480
    ds_read_b64_tr_b16 v[166:167], v21 offset:20992
    s_waitcnt lgkmcnt(2)
    v_mfma_f32_32x32x16_bf16 v[112:127], v[168:171], v[148:151], v[112:127]
    ds_read_b64_tr_b16 v[160:161], v20 offset:20480
    ds_read_b64_tr_b16 v[162:163], v20 offset:20992
    buffer_load_dwordx4 v[148:151], v2, s[32:35], s20 offen offset:1024 sc1
    s_waitcnt vmcnt(3)
    s_waitcnt lgkmcnt(2)
    v_mfma_f32_32x32x16_bf16 v[128:143], v[164:167], v[152:155], v[128:143]
    ds_read_b64_tr_b16 v[172:173], v21 offset:22528
    ds_read_b64_tr_b16 v[174:175], v21 offset:23040
    s_waitcnt lgkmcnt(2)
    v_mfma_f32_32x32x16_bf16 v[112:127], v[160:163], v[152:155], v[112:127]
    ds_read_b64_tr_b16 v[168:169], v20 offset:22528
    ds_read_b64_tr_b16 v[170:171], v20 offset:23040
    s_add_u32 s96, s83, 7
    s_and_b32 s97, s96, 15
    s_lshl_b32 s98, s97, 11
    s_add_u32 s20, s98, s19
    buffer_load_dwordx4 v[152:155], v2, s[32:35], s20 offen sc1
    s_waitcnt vmcnt(3)
    s_waitcnt lgkmcnt(2)
    v_mfma_f32_32x32x16_bf16 v[128:143], v[172:175], v[156:159], v[128:143]
    ds_read_b64_tr_b16 v[164:165], v21 offset:24576
    ds_read_b64_tr_b16 v[166:167], v21 offset:25088
    s_waitcnt lgkmcnt(2)
    v_mfma_f32_32x32x16_bf16 v[112:127], v[168:171], v[156:159], v[112:127]
    ds_read_b64_tr_b16 v[160:161], v20 offset:24576
    ds_read_b64_tr_b16 v[162:163], v20 offset:25088
    buffer_load_dwordx4 v[156:159], v2, s[32:35], s20 offen offset:1024 sc1
    s_waitcnt vmcnt(3)
    s_waitcnt lgkmcnt(2)
    v_mfma_f32_32x32x16_bf16 v[128:143], v[164:167], v[144:147], v[128:143]
    ds_read_b64_tr_b16 v[172:173], v21 offset:26624
    ds_read_b64_tr_b16 v[174:175], v21 offset:27136
    s_waitcnt lgkmcnt(2)
    v_mfma_f32_32x32x16_bf16 v[112:127], v[160:163], v[144:147], v[112:127]
    ds_read_b64_tr_b16 v[168:169], v20 offset:26624
    ds_read_b64_tr_b16 v[170:171], v20 offset:27136
    s_setprio 0
    s_add_u32 s96, s83, 8
    s_and_b32 s97, s96, 15
    s_lshl_b32 s98, s97, 11
    s_add_u32 s20, s98, s19
    buffer_load_dwordx4 v[144:147], v2, s[32:35], s20 offen sc1
    s_waitcnt vmcnt(3)
    s_waitcnt lgkmcnt(2)
    v_mfma_f32_32x32x16_bf16 v[128:143], v[172:175], v[148:151], v[128:143]
    ds_read_b64_tr_b16 v[164:165], v21 offset:28672
    ds_read_b64_tr_b16 v[166:167], v21 offset:29184
    s_waitcnt lgkmcnt(2)
    v_mfma_f32_32x32x16_bf16 v[112:127], v[168:171], v[148:151], v[112:127]
    ds_read_b64_tr_b16 v[160:161], v20 offset:28672
    ds_read_b64_tr_b16 v[162:163], v20 offset:29184
    buffer_load_dwordx4 v[148:151], v2, s[32:35], s20 offen offset:1024 sc1
    s_waitcnt vmcnt(3)
    s_waitcnt lgkmcnt(2)
    v_mfma_f32_32x32x16_bf16 v[128:143], v[164:167], v[152:155], v[128:143]
    ds_read_b64_tr_b16 v[172:173], v21 offset:30720
    ds_read_b64_tr_b16 v[174:175], v21 offset:31232
    s_waitcnt lgkmcnt(2)
    v_mfma_f32_32x32x16_bf16 v[112:127], v[160:163], v[152:155], v[112:127]
    ds_read_b64_tr_b16 v[168:169], v20 offset:30720
    ds_read_b64_tr_b16 v[170:171], v20 offset:31232
    s_add_u32 s96, s83, 9
    s_and_b32 s97, s96, 15
    s_lshl_b32 s98, s97, 11
    s_add_u32 s20, s98, s19
    buffer_load_dwordx4 v[152:155], v2, s[32:35], s20 offen sc1
    s_waitcnt vmcnt(3)
    s_waitcnt lgkmcnt(2)
    v_mfma_f32_32x32x16_bf16 v[128:143], v[172:175], v[156:159], v[128:143]
    ds_read_b64_tr_b16 v[164:165], v21 offset:32768
    ds_read_b64_tr_b16 v[166:167], v21 offset:33280
    s_waitcnt lgkmcnt(2)
    v_mfma_f32_32x32x16_bf16 v[112:127], v[168:171], v[156:159], v[112:127]
    ds_read_b64_tr_b16 v[160:161], v20 offset:32768
    ds_read_b64_tr_b16 v[162:163], v20 offset:33280
    buffer_load_dwordx4 v[156:159], v2, s[32:35], s20 offen offset:1024 sc1
    s_waitcnt vmcnt(3)
    s_waitcnt lgkmcnt(2)
    v_mfma_f32_32x32x16_bf16 v[128:143], v[164:167], v[144:147], v[128:143]
    ds_read_b64_tr_b16 v[172:173], v21 offset:34816
    ds_read_b64_tr_b16 v[174:175], v21 offset:35328
    s_waitcnt lgkmcnt(2)
    v_mfma_f32_32x32x16_bf16 v[112:127], v[160:163], v[144:147], v[112:127]
    ds_read_b64_tr_b16 v[168:169], v20 offset:34816
    ds_read_b64_tr_b16 v[170:171], v20 offset:35328
    s_add_u32 s96, s83, 10
    s_and_b32 s97, s96, 15
    s_lshl_b32 s98, s97, 11
    s_add_u32 s20, s98, s19
    buffer_load_dwordx4 v[144:147], v2, s[32:35], s20 offen sc1
    s_waitcnt vmcnt(3)
    s_waitcnt lgkmcnt(2)
    v_mfma_f32_32x32x16_bf16 v[128:143], v[172:175], v[148:151], v[128:143]
    ds_read_b64_tr_b16 v[164:165], v21 offset:36864
    ds_read_b64_tr_b16 v[166:167], v21 offset:37376
    s_waitcnt lgkmcnt(2)
    v_mfma_f32_32x32x16_bf16 v[112:127], v[168:171], v[148:151], v[112:127]
    ds_read_b64_tr_b16 v[160:161], v20 offset:36864
    ds_read_b64_tr_b16 v[162:163], v20 offset:37376
    buffer_load_dwordx4 v[148:151], v2, s[32:35], s20 offen offset:1024 sc1
    s_waitcnt vmcnt(3)
    s_waitcnt lgkmcnt(2)
    v_mfma_f32_32x32x16_bf16 v[128:143], v[164:167], v[152:155], v[128:143]
    ds_read_b64_tr_b16 v[172:173], v21 offset:38912
    ds_read_b64_tr_b16 v[174:175], v21 offset:39424
    s_waitcnt lgkmcnt(2)
    v_mfma_f32_32x32x16_bf16 v[112:127], v[160:163], v[152:155], v[112:127]
    ds_read_b64_tr_b16 v[168:169], v20 offset:38912
    ds_read_b64_tr_b16 v[170:171], v20 offset:39424
    s_add_u32 s96, s83, 11
    s_and_b32 s97, s96, 15
    s_lshl_b32 s98, s97, 11
    s_add_u32 s20, s98, s19
    buffer_load_dwordx4 v[152:155], v2, s[32:35], s20 offen sc1
    s_waitcnt vmcnt(3)
    s_waitcnt lgkmcnt(2)
    v_mfma_f32_32x32x16_bf16 v[128:143], v[172:175], v[156:159], v[128:143]
    ds_read_b64_tr_b16 v[164:165], v21 offset:40960
    ds_read_b64_tr_b16 v[166:167], v21 offset:41472
    s_waitcnt lgkmcnt(2)
    v_mfma_f32_32x32x16_bf16 v[112:127], v[168:171], v[156:159], v[112:127]
    ds_read_b64_tr_b16 v[160:161], v20 offset:40960
    ds_read_b64_tr_b16 v[162:163], v20 offset:41472
    buffer_load_dwordx4 v[156:159], v2, s[32:35], s20 offen offset:1024 sc1
    s_waitcnt vmcnt(3)
    s_waitcnt lgkmcnt(2)
    v_mfma_f32_32x32x16_bf16 v[128:143], v[164:167], v[144:147], v[128:143]
    ds_read_b64_tr_b16 v[172:173], v21 offset:43008
    ds_read_b64_tr_b16 v[174:175], v21 offset:43520
    s_waitcnt lgkmcnt(2)
    v_mfma_f32_32x32x16_bf16 v[112:127], v[160:163], v[144:147], v[112:127]
    ds_read_b64_tr_b16 v[168:169], v20 offset:43008
    ds_read_b64_tr_b16 v[170:171], v20 offset:43520
    s_add_u32 s96, s83, 12
    s_and_b32 s97, s96, 15
    s_lshl_b32 s98, s97, 11
    s_add_u32 s20, s98, s19
    buffer_load_dwordx4 v[144:147], v2, s[32:35], s20 offen sc1
    s_waitcnt vmcnt(3)
    s_waitcnt lgkmcnt(2)
    v_mfma_f32_32x32x16_bf16 v[128:143], v[172:175], v[148:151], v[128:143]
    ds_read_b64_tr_b16 v[164:165], v21 offset:45056
    ds_read_b64_tr_b16 v[166:167], v21 offset:45568
    s_waitcnt lgkmcnt(2)
    v_mfma_f32_32x32x16_bf16 v[112:127], v[168:171], v[148:151], v[112:127]
    ds_read_b64_tr_b16 v[160:161], v20 offset:45056
    ds_read_b64_tr_b16 v[162:163], v20 offset:45568
    buffer_load_dwordx4 v[148:151], v2, s[32:35], s20 offen offset:1024 sc1
    s_waitcnt vmcnt(3)
    s_waitcnt lgkmcnt(2)
    v_mfma_f32_32x32x16_bf16 v[128:143], v[164:167], v[152:155], v[128:143]
    ds_read_b64_tr_b16 v[172:173], v21 offset:47104
    ds_read_b64_tr_b16 v[174:175], v21 offset:47616
    s_waitcnt lgkmcnt(2)
    v_mfma_f32_32x32x16_bf16 v[112:127], v[160:163], v[152:155], v[112:127]
    ds_read_b64_tr_b16 v[168:169], v20 offset:47104
    ds_read_b64_tr_b16 v[170:171], v20 offset:47616
    s_add_u32 s96, s83, 13
    s_and_b32 s97, s96, 15
    s_lshl_b32 s98, s97, 11
    s_add_u32 s20, s98, s19
    buffer_load_dwordx4 v[152:155], v2, s[32:35], s20 offen sc1
    s_waitcnt vmcnt(3)
    s_waitcnt lgkmcnt(2)
    v_mfma_f32_32x32x16_bf16 v[128:143], v[172:175], v[156:159], v[128:143]
    ds_read_b64_tr_b16 v[164:165], v21 offset:49152
    ds_read_b64_tr_b16 v[166:167], v21 offset:49664
    s_waitcnt lgkmcnt(2)
    v_mfma_f32_32x32x16_bf16 v[112:127], v[168:171], v[156:159], v[112:127]
    ds_read_b64_tr_b16 v[160:161], v20 offset:49152
    ds_read_b64_tr_b16 v[162:163], v20 offset:49664
    buffer_load_dwordx4 v[156:159], v2, s[32:35], s20 offen offset:1024 sc1
    s_waitcnt vmcnt(3)
    s_waitcnt lgkmcnt(2)
    v_mfma_f32_32x32x16_bf16 v[128:143], v[164:167], v[144:147], v[128:143]
    ds_read_b64_tr_b16 v[172:173], v21 offset:51200
    ds_read_b64_tr_b16 v[174:175], v21 offset:51712
    s_waitcnt lgkmcnt(2)
    v_mfma_f32_32x32x16_bf16 v[112:127], v[160:163], v[144:147], v[112:127]
    ds_read_b64_tr_b16 v[168:169], v20 offset:51200
    ds_read_b64_tr_b16 v[170:171], v20 offset:51712
    s_add_u32 s96, s83, 14
    s_and_b32 s97, s96, 15
    s_lshl_b32 s98, s97, 11
    s_add_u32 s20, s98, s19
    buffer_load_dwordx4 v[144:147], v2, s[32:35], s20 offen sc1
    s_waitcnt vmcnt(3)
    s_waitcnt lgkmcnt(2)
    v_mfma_f32_32x32x16_bf16 v[128:143], v[172:175], v[148:151], v[128:143]
    ds_read_b64_tr_b16 v[164:165], v21 offset:53248
    ds_read_b64_tr_b16 v[166:167], v21 offset:53760
    s_waitcnt lgkmcnt(2)
    v_mfma_f32_32x32x16_bf16 v[112:127], v[168:171], v[148:151], v[112:127]
    ds_read_b64_tr_b16 v[160:161], v20 offset:53248
    ds_read_b64_tr_b16 v[162:163], v20 offset:53760
    buffer_load_dwordx4 v[148:151], v2, s[32:35], s20 offen offset:1024 sc1
    s_waitcnt vmcnt(3)
    s_waitcnt lgkmcnt(2)
    v_mfma_f32_32x32x16_bf16 v[128:143], v[164:167], v[152:155], v[128:143]
    ds_read_b64_tr_b16 v[172:173], v21 offset:55296
    ds_read_b64_tr_b16 v[174:175], v21 offset:55808
    s_waitcnt lgkmcnt(2)
    v_mfma_f32_32x32x16_bf16 v[112:127], v[160:163], v[152:155], v[112:127]
    ds_read_b64_tr_b16 v[168:169], v20 offset:55296
    ds_read_b64_tr_b16 v[170:171], v20 offset:55808
    s_add_u32 s96, s83, 15
    s_and_b32 s97, s96, 15
    s_lshl_b32 s98, s97, 11
    s_add_u32 s20, s98, s19
    buffer_load_dwordx4 v[152:155], v2, s[32:35], s20 offen sc1
    s_waitcnt vmcnt(3)
    s_waitcnt lgkmcnt(2)
    v_mfma_f32_32x32x16_bf16 v[128:143], v[172:175], v[156:159], v[128:143]
    ds_read_b64_tr_b16 v[164:165], v21 offset:57344
    ds_read_b64_tr_b16 v[166:167], v21 offset:57856
    s_waitcnt lgkmcnt(2)
    v_mfma_f32_32x32x16_bf16 v[112:127], v[168:171], v[156:159], v[112:127]
    ds_read_b64_tr_b16 v[160:161], v20 offset:57344
    ds_read_b64_tr_b16 v[162:163], v20 offset:57856
    buffer_load_dwordx4 v[156:159], v2, s[32:35], s20 offen offset:1024 sc1
    s_lshl_b32 s96, s21, 7
    s_add_u32 s18, s96, 65536
    buffer_load_dwordx2 v[22:23], v60, s[32:35], s18 offen sc1
    s_waitcnt vmcnt(4)
    s_waitcnt lgkmcnt(2)
    v_mfma_f32_32x32x16_bf16 v[128:143], v[164:167], v[144:147], v[128:143]
    ds_read_b64_tr_b16 v[172:173], v21 offset:59392
    ds_read_b64_tr_b16 v[174:175], v21 offset:59904
    s_waitcnt lgkmcnt(2)
    v_mfma_f32_32x32x16_bf16 v[112:127], v[160:163], v[144:147], v[112:127]
    ds_read_b64_tr_b16 v[168:169], v20 offset:59392
    ds_read_b64_tr_b16 v[170:171], v20 offset:59904
    s_waitcnt vmcnt(3)
    s_waitcnt lgkmcnt(2)
    v_mfma_f32_32x32x16_bf16 v[128:143], v[172:175], v[148:151], v[128:143]
    ds_read_b64_tr_b16 v[164:165], v21 offset:61440
    ds_read_b64_tr_b16 v[166:167], v21 offset:61952
    s_waitcnt lgkmcnt(2)
    v_mfma_f32_32x32x16_bf16 v[112:127], v[168:171], v[148:151], v[112:127]
    ds_read_b64_tr_b16 v[160:161], v20 offset:61440
    ds_read_b64_tr_b16 v[162:163], v20 offset:61952
    s_waitcnt vmcnt(2)
    s_waitcnt lgkmcnt(2)
    v_mfma_f32_32x32x16_bf16 v[128:143], v[164:167], v[152:155], v[128:143]
    ds_read_b64_tr_b16 v[172:173], v21 offset:63488
    ds_read_b64_tr_b16 v[174:175], v21 offset:64000
    s_waitcnt lgkmcnt(2)
    v_mfma_f32_32x32x16_bf16 v[112:127], v[160:163], v[152:155], v[112:127]
    ds_read_b64_tr_b16 v[168:169], v20 offset:63488
    ds_read_b64_tr_b16 v[170:171], v20 offset:64000
    s_waitcnt vmcnt(1)
    s_waitcnt lgkmcnt(2)
    v_mfma_f32_32x32x16_bf16 v[128:143], v[172:175], v[156:159], v[128:143]
    s_waitcnt lgkmcnt(0)
    v_mfma_f32_32x32x16_bf16 v[112:127], v[168:171], v[156:159], v[112:127]
    s_setprio 0
    s_lshl_b32 s13, s3, 12
    v_add_u32 v4, s13, v2
    v_xor_b32 v5, 0x4000, v4
    s_nop 5
    ds_write_b128 v4, v[128:131]
    ds_write_b128 v4, v[132:135] offset:1024
    ds_write_b128 v4, v[136:139] offset:2048
    ds_write_b128 v4, v[140:143] offset:3072
    s_lshl_b32 s96, s76, 11
    s_and_b32 s97, s3, 3
    s_lshl_b32 s98, s97, 9
    s_add_u32 s99, s96, s98
    s_add_u32 s13, s99, 131072
    v_and_b32 v6, 31, v1
    v_lshl_add_u32 v6, v6, 4, s13
    v_lshrrev_b32 v9, 5, v1
    v_lshl_add_u32 v6, v9, 3, v6
    s_lshl_b32 s96, s76, 6
    s_add_u32 s13, s96, 139008
    v_and_b32 v7, 7, v1
    v_lshl_add_u32 v7, v7, 2, s13
    v_lshrrev_b32 v9, 5, v1
    v_lshl_add_u32 v7, v9, 5, v7
    s_lshl_b32 s96, s21, 15
    s_lshl_b32 s97, s3, 8
    s_add_u32 s98, s96, s97
    s_add_u32 s19, s98, 12582912
    v_and_b32 v61, 15, v1
    v_lshlrev_b32 v61, 4, v61
    v_lshrrev_b32 v9, 4, v1
    v_lshl_add_u32 v61, v9, 11, v61
    v_mov_b32 v164, 0x3f803f80
    s_waitcnt lgkmcnt(0)
    s_barrier
    ds_read_b128 v[128:131], v5
    ds_read_b128 v[132:135], v5 offset:1024
    ds_read_b128 v[136:139], v5 offset:2048
    ds_read_b128 v[140:143], v5 offset:3072
    s_add_u32 s14, s80, 114688
    s_lshl2_add_u32 m0, s89, 67584
    s_nop 0
    buffer_load_dwordx4 v72, s[56:59], s14 offen nt lds
    s_add_u32 s14, s80, 172032
    s_lshl2_add_u32 m0, s89, 68608
    s_nop 0
    buffer_load_dwordx4 v72, s[56:59], s14 offen nt lds
    s_mov_b32 s14, s81
    s_lshl2_add_u32 m0, s89, 98304
    s_nop 0
    buffer_load_dwordx4 v73, s[60:63], s14 offen nt lds
    s_waitcnt lgkmcnt(3)
    v_pk_add_f32 v[112:113], v[112:113], v[128:129]
    v_pk_add_f32 v[114:115], v[114:115], v[130:131]
    s_waitcnt lgkmcnt(2)
    v_pk_add_f32 v[116:117], v[116:117], v[132:133]
    v_pk_add_f32 v[118:119], v[118:119], v[134:135]
    v_cvt_pk_bf16_f32 v112, 0, v112
    v_cvt_pk_bf16_f32 v113, 0, v113
    v_cvt_pk_bf16_f32 v114, 0, v114
    v_cvt_pk_bf16_f32 v115, 0, v115
    v_cvt_pk_bf16_f32 v116, 0, v116
    v_cvt_pk_bf16_f32 v117, 0, v117
    v_cvt_pk_bf16_f32 v118, 0, v118
    v_cvt_pk_bf16_f32 v119, 0, v119
    v_pk_mul_f32 v[112:113], v[112:113], v[40:41]
    v_pk_mul_f32 v[114:115], v[114:115], v[42:43]
    v_pk_mul_f32 v[116:117], v[116:117], v[44:45]
    v_pk_mul_f32 v[118:119], v[118:119], v[46:47]
    v_cvt_pk_bf16_f32 v112, 0, v112
    v_cvt_pk_bf16_f32 v113, 0, v113
    v_cvt_pk_bf16_f32 v114, 0, v114
    v_cvt_pk_bf16_f32 v115, 0, v115
    v_cvt_pk_bf16_f32 v116, 0, v116
    v_cvt_pk_bf16_f32 v117, 0, v117
    v_cvt_pk_bf16_f32 v118, 0, v118
    v_cvt_pk_bf16_f32 v119, 0, v119
    v_pk_add_f32 v[112:113], v[112:113], v[24:25]
    v_pk_add_f32 v[114:115], v[114:115], v[26:27]
    v_pk_add_f32 v[116:117], v[116:117], v[28:29]
    v_pk_add_f32 v[118:119], v[118:119], v[30:31]
    v_cvt_pk_bf16_f32 v12, v112, v113
    v_cvt_pk_bf16_f32 v13, v114, v115
    v_cvt_pk_bf16_f32 v14, v116, v117
    v_cvt_pk_bf16_f32 v15, v118, v119
    s_waitcnt lgkmcnt(1)
    v_pk_add_f32 v[120:121], v[120:121], v[136:137]
    v_pk_add_f32 v[122:123], v[122:123], v[138:139]
    s_waitcnt lgkmcnt(0)
    v_pk_add_f32 v[124:125], v[124:125], v[140:141]
    v_pk_add_f32 v[126:127], v[126:127], v[142:143]
    v_cvt_pk_bf16_f32 v120, 0, v120
    v_cvt_pk_bf16_f32 v121, 0, v121
    v_cvt_pk_bf16_f32 v122, 0, v122
    v_cvt_pk_bf16_f32 v123, 0, v123
    v_cvt_pk_bf16_f32 v124, 0, v124
    v_cvt_pk_bf16_f32 v125, 0, v125
    v_cvt_pk_bf16_f32 v126, 0, v126
    v_cvt_pk_bf16_f32 v127, 0, v127
    v_pk_mul_f32 v[120:121], v[120:121], v[48:49]
    v_pk_mul_f32 v[122:123], v[122:123], v[50:51]
    v_pk_mul_f32 v[124:125], v[124:125], v[52:53]
    v_pk_mul_f32 v[126:127], v[126:127], v[54:55]
    v_cvt_pk_bf16_f32 v120, 0, v120
    v_cvt_pk_bf16_f32 v121, 0, v121
    v_cvt_pk_bf16_f32 v122, 0, v122
    v_cvt_pk_bf16_f32 v123, 0, v123
    v_cvt_pk_bf16_f32 v124, 0, v124
    v_cvt_pk_bf16_f32 v125, 0, v125
    v_cvt_pk_bf16_f32 v126, 0, v126
    v_cvt_pk_bf16_f32 v127, 0, v127
    v_pk_add_f32 v[120:121], v[120:121], v[32:33]
    v_pk_add_f32 v[122:123], v[122:123], v[34:35]
    v_pk_add_f32 v[124:125], v[124:125], v[36:37]
    v_pk_add_f32 v[126:127], v[126:127], v[38:39]
    v_cvt_pk_bf16_f32 v16, v120, v121
    v_cvt_pk_bf16_f32 v17, v122, v123
    v_cvt_pk_bf16_f32 v18, v124, v125
    v_cvt_pk_bf16_f32 v19, v126, v127
    v_dot2_f32_bf16 v160, v12, v164, 0
    v_dot2_f32_bf16 v162, v12, v12, 0
    v_dot2_f32_bf16 v161, v12, v76, 0
    v_dot2_f32_bf16 v163, v12, v84, 0
    v_dot2_f32_bf16 v160, v13, v164, v160
    v_dot2_f32_bf16 v162, v13, v13, v162
    v_dot2_f32_bf16 v161, v13, v77, v161
    v_dot2_f32_bf16 v163, v13, v85, v163
    v_dot2_f32_bf16 v160, v14, v164, v160
    v_dot2_f32_bf16 v162, v14, v14, v162
    v_dot2_f32_bf16 v161, v14, v78, v161
    v_dot2_f32_bf16 v163, v14, v86, v163
    v_dot2_f32_bf16 v160, v15, v164, v160
    v_dot2_f32_bf16 v162, v15, v15, v162
    v_dot2_f32_bf16 v161, v15, v79, v161
    v_dot2_f32_bf16 v163, v15, v87, v163
    v_dot2_f32_bf16 v160, v16, v164, v160
    v_dot2_f32_bf16 v162, v16, v16, v162
    v_dot2_f32_bf16 v161, v16, v80, v161
    v_dot2_f32_bf16 v163, v16, v88, v163
    v_dot2_f32_bf16 v160, v17, v164, v160
    v_dot2_f32_bf16 v162, v17, v17, v162
    v_dot2_f32_bf16 v161, v17, v81, v161
    v_dot2_f32_bf16 v163, v17, v89, v163
    v_dot2_f32_bf16 v160, v18, v164, v160
    v_dot2_f32_bf16 v162, v18, v18, v162
    v_dot2_f32_bf16 v161, v18, v82, v161
    v_dot2_f32_bf16 v163, v18, v90, v163
    v_dot2_f32_bf16 v160, v19, v164, v160
    v_dot2_f32_bf16 v162, v19, v19, v162
    v_dot2_f32_bf16 v161, v19, v83, v161
    v_dot2_f32_bf16 v163, v19, v91, v163
    s_nop 0
    v_permlane32_swap_b32 v160, v162
    s_nop 0
    v_permlane32_swap_b32 v161, v163
    v_pk_add_f32 v[160:161], v[160:161], v[162:163]
    ds_write_b64 v6, v[160:161]
    ds_write_b32 v7, v56
    ds_write_b32 v7, v57 offset:128
    ds_write_b32 v7, v58 offset:256
    ds_write_b32 v7, v59 offset:384
    v_add_u32 v4, 131072, v2
    v_and_b32 v5, 7, v1
    v_lshlrev_b32 v5, 15, v5
    v_bfe_u32 v9, v1, 3, 1
    v_lshl_add_u32 v5, v9, 12, v5
    s_lshl4_add_u32 s96, s21, s12
    s_lshl_b32 s97, s96, 11
    s_add_u32 s13, s97, 12582912
    s_and_b32 s96, s12, 1
    s_lshr_b32 s97, s21, 2
    s_and_b32 s98, s21, 3
    s_lshl_b32 s99, s98, 6
    s_lshl1_add_u32 s98, s97, s99
    s_lshl_b32 s97, s98, 12
    s_lshr_b32 s99, s12, 1
    s_lshl_b32 s98, s99, 6
    s_add_u32 s99, s97, s98
    s_lshl2_add_u32 s97, s96, s99
    s_add_u32 s98, s97, 1048576
    s_add_u32 s16, s98, 1536
    s_waitcnt lgkmcnt(0)
    s_barrier
    s_cmp_lg_u32 s3, 0
    s_cbranch_scc1 L_PE
    ds_read_b128 v[128:131], v4 offset:0
    ds_read_b128 v[132:135], v4 offset:2048
    ds_read_b128 v[136:139], v4 offset:1024
    ds_read_b128 v[140:143], v4 offset:3072
    s_waitcnt lgkmcnt(2)
    v_pk_add_f32 v[128:129], v[128:129], v[132:133]
    v_pk_add_f32 v[130:131], v[130:131], v[134:135]
    v_add_f32 v129, v129, v131
    v_mov_b32 v131, s4
    s_waitcnt lgkmcnt(0)
    v_pk_add_f32 v[136:137], v[136:137], v[140:141]
    v_pk_add_f32 v[138:139], v[138:139], v[142:143]
    v_add_f32 v137, v137, v139
    v_mov_b32 v139, s4
    buffer_store_dwordx4 v[128:131], v2, s[32:35], s13 offen sc1
    buffer_store_dwordx4 v[136:139], v2, s[32:35], s13 offen offset:1024 sc1
    s_mov_b64 exec, 0xffff
    buffer_store_dword v131, v5, s[32:35], s16 offen sc1
    s_mov_b64 exec, -1
L_PE:
    s_load_dwordx2 s[24:25], s[32:33], s92 offset:1536 glc
    s_and_b32 s96, s3, 3
    s_mul_i32 s97, s96, 4608
    s_lshl_b32 s98, s76, 6
    s_add_u32 s16, s97, s98
    v_and_b32 v128, 31, v1
    v_mul_u32_u24 v128, 144, v128
    v_lshrrev_b32 v9, 5, v1
    v_lshl_add_u32 v128, v9, 5, v128
    v_add_u32 v128, s16, v128
    ds_write_b128 v128, v[12:15]
    ds_write_b128 v128, v[16:19] offset:16
    v_add_u32 v128, 139776, v128
    s_lshl3_add_u32 s96, s21, s3
    s_lshl_b32 s97, s96, 5
    s_sub_u32 s15, 4094, s97
    v_and_b32 v62, 15, v1
    v_lshlrev_b32 v62, 1, v62
    v_sub_u32 v62, s15, v62
    s_lshl_b32 s96, s3, 7
    s_add_u32 s15, s96, 135168
    v_and_b32 v8, 15, v1
    v_lshl_add_u32 v8, v8, 3, s15
    s_and_b32 s96, s3, 3
    s_lshl_b32 s97, s96, 8
    s_add_u32 s15, s97, 135168
    v_and_b32 v10, 31, v1
    v_lshl_add_u32 v10, v10, 3, s15
    v_and_b32 v11, 7, v1
    v_lshlrev_b32 v11, 3, v11
    v_add_u32 v11, 136192, v11
    s_waitcnt vmcnt(3)
    v_cmp_ne_u32 vcc, s4, v23
    s_cbranch_vccz TOK_31
POLL_32:
    buffer_load_dwordx2 v[22:23], v60, s[32:35], s18 offen sc1
    s_waitcnt vmcnt(0)
    v_cmp_ne_u32 vcc, s4, v23
    s_cbranch_vccz PDONE_33
    s_add_u32 s5, s5, 1
    s_cmp_lt_u32 s5, 300000
    s_cbranch_scc1 POLL_32
PDONE_33:
TOK_31:
    v_add_f32_dpp v22, v22, v22 quad_perm:[1,0,3,2] row_mask:0xf bank_mask:0xf
    s_nop 1
    v_add_f32_dpp v22, v22, v22 quad_perm:[2,3,0,1] row_mask:0xf bank_mask:0xf
    s_nop 1
    v_add_f32_dpp v22, v22, v22 row_half_mirror row_mask:0xf bank_mask:0xf
    s_nop 1
    v_add_f32_dpp v22, v22, v22 row_ror:8 row_mask:0xf bank_mask:0xf
    s_cmp_lg_u32 s3, 1
    s_cbranch_scc1 L_NOCT
    v_and_b32 v5, 15, v1
    v_lshlrev_b32 v5, 3, v5
    v_add_u32 v5, 139008, v5
    ds_read_b64 v[134:135], v5
    ds_read_b64 v[138:139], v5 offset:128
    ds_read_b64 v[140:141], v5 offset:384
    s_waitcnt lgkmcnt(0)
    v_lshlrev_b32 v132, 16, v134
    v_and_b32 v133, s6, v134
    v_lshlrev_b32 v134, 16, v135
    v_and_b32 v135, s6, v135
    v_lshlrev_b32 v136, 16, v138
    v_and_b32 v137, s6, v138
    v_lshlrev_b32 v138, 16, v139
    v_and_b32 v139, s6, v139
L_NOCT:
    s_cmp_lt_u32 s3, 4
    s_cbranch_scc1 L_NOST
    s_sub_u32 s96, s3, 4
    s_lshl_b32 s97, s96, 12
    s_add_u32 s13, s97, 32768
    v_add_u32 v4, s13, v2
    v_add_u32 v7, 65536, v4
    ds_write_b128 v4, v[176:179] offset:16384
    ds_write_b128 v4, v[180:183]
    ds_write_b128 v4, v[184:187] offset:17408
    ds_write_b128 v4, v[188:191] offset:1024
    ds_write_b128 v4, v[192:195] offset:18432
    ds_write_b128 v4, v[196:199] offset:2048
    ds_write_b128 v4, v[200:203] offset:19456
    ds_write_b128 v4, v[204:207] offset:3072
    ds_write_b128 v4, v[208:211] offset:49152
    ds_write_b128 v4, v[212:215] offset:32768
    ds_write_b128 v4, v[216:219] offset:50176
    ds_write_b128 v4, v[220:223] offset:33792
L_NOST:
    s_branch SCHK_29
SPOLL_28:
    s_load_dwordx2 s[24:25], s[32:33], s92 offset:1536 glc
SCHK_29:
    s_add_u32 s5, s5, 1
    s_cmp_ge_u32 s5, 300000
    s_waitcnt lgkmcnt(0)
    s_cbranch_scc1 SDONE_30
    s_cmp_lg_u32 s24, s4
    s_cbranch_scc1 SPOLL_28
    s_cmp_lg_u32 s25, s4
    s_cbranch_scc1 SPOLL_28
SDONE_30:
    s_barrier
    s_mov_b32 s13, s19
    buffer_load_dwordx4 v[108:111], v61, s[32:35], s13 offen sc1
    s_add_u32 s13, s19, 8192
    buffer_load_dwordx4 v[112:115], v61, s[32:35], s13 offen sc1
    s_add_u32 s13, s19, 16384
    buffer_load_dwordx4 v[116:119], v61, s[32:35], s13 offen sc1
    s_add_u32 s13, s19, 24576
    buffer_load_dwordx4 v[120:123], v61, s[32:35], s13 offen sc1
    v_mov_b32 v74, 0x10000
    v_mov_b32 v75, s6
    v_lshlrev_b32 v24, 16, v12
    v_and_b32 v25, s6, v12
    v_lshlrev_b32 v26, 16, v13
    v_and_b32 v27, s6, v13
    v_lshlrev_b32 v28, 16, v14
    v_and_b32 v29, s6, v14
    v_lshlrev_b32 v30, 16, v15
    v_and_b32 v31, s6, v15
    v_lshlrev_b32 v32, 16, v16
    v_and_b32 v33, s6, v16
    v_lshlrev_b32 v34, 16, v17
    v_and_b32 v35, s6, v17
    v_lshlrev_b32 v36, 16, v18
    v_and_b32 v37, s6, v18
    v_lshlrev_b32 v38, 16, v19
    v_and_b32 v39, s6, v19
    v_mul_u32_u24_dpp v76, v56, v74 row_newbcast:0 row_mask:0xf bank_mask:0xf
    v_and_b32_dpp v77, v56, v75 row_newbcast:0 row_mask:0xf bank_mask:0xf
    v_mul_u32_u24_dpp v78, v56, v74 row_newbcast:1 row_mask:0xf bank_mask:0xf
    v_and_b32_dpp v79, v56, v75 row_newbcast:1 row_mask:0xf bank_mask:0xf
    v_mul_u32_u24_dpp v80, v56, v74 row_newbcast:2 row_mask:0xf bank_mask:0xf
    v_and_b32_dpp v81, v56, v75 row_newbcast:2 row_mask:0xf bank_mask:0xf
    v_mul_u32_u24_dpp v82, v56, v74 row_newbcast:3 row_mask:0xf bank_mask:0xf
    v_and_b32_dpp v83, v56, v75 row_newbcast:3 row_mask:0xf bank_mask:0xf
    v_mul_u32_u24_dpp v84, v56, v74 row_newbcast:4 row_mask:0xf bank_mask:0xf
    v_and_b32_dpp v85, v56, v75 row_newbcast:4 row_mask:0xf bank_mask:0xf
    v_mul_u32_u24_dpp v86, v56, v74 row_newbcast:5 row_mask:0xf bank_mask:0xf
    v_and_b32_dpp v87, v56, v75 row_newbcast:5 row_mask:0xf bank_mask:0xf
    v_mul_u32_u24_dpp v88, v56, v74 row_newbcast:6 row_mask:0xf bank_mask:0xf
    v_and_b32_dpp v89, v56, v75 row_newbcast:6 row_mask:0xf bank_mask:0xf
    v_mul_u32_u24_dpp v90, v56, v74 row_newbcast:7 row_mask:0xf bank_mask:0xf
    v_and_b32_dpp v91, v56, v75 row_newbcast:7 row_mask:0xf bank_mask:0xf
    v_mul_u32_u24_dpp v92, v57, v74 row_newbcast:0 row_mask:0xf bank_mask:0xf
    v_and_b32_dpp v93, v57, v75 row_newbcast:0 row_mask:0xf bank_mask:0xf
    v_mul_u32_u24_dpp v94, v57, v74 row_newbcast:1 row_mask:0xf bank_mask:0xf
    v_and_b32_dpp v95, v57, v75 row_newbcast:1 row_mask:0xf bank_mask:0xf
    v_mul_u32_u24_dpp v96, v57, v74 row_newbcast:2 row_mask:0xf bank_mask:0xf
    v_and_b32_dpp v97, v57, v75 row_newbcast:2 row_mask:0xf bank_mask:0xf
    v_mul_u32_u24_dpp v98, v57, v74 row_newbcast:3 row_mask:0xf bank_mask:0xf
    v_and_b32_dpp v99, v57, v75 row_newbcast:3 row_mask:0xf bank_mask:0xf
    v_mul_u32_u24_dpp v100, v57, v74 row_newbcast:4 row_mask:0xf bank_mask:0xf
    v_and_b32_dpp v101, v57, v75 row_newbcast:4 row_mask:0xf bank_mask:0xf
    v_mul_u32_u24_dpp v102, v57, v74 row_newbcast:5 row_mask:0xf bank_mask:0xf
    v_and_b32_dpp v103, v57, v75 row_newbcast:5 row_mask:0xf bank_mask:0xf
    v_mul_u32_u24_dpp v104, v57, v74 row_newbcast:6 row_mask:0xf bank_mask:0xf
    v_and_b32_dpp v105, v57, v75 row_newbcast:6 row_mask:0xf bank_mask:0xf
    v_mul_u32_u24_dpp v106, v57, v74 row_newbcast:7 row_mask:0xf bank_mask:0xf
    v_and_b32_dpp v107, v57, v75 row_newbcast:7 row_mask:0xf bank_mask:0xf
    s_waitcnt vmcnt(0)
    v_bitop3_b32 v4, v111, v115, s4 bitop3:0x7e
    v_bitop3_b32 v4, v4, v119, s4 bitop3:0xf6
    v_bitop3_b32 v4, v4, v123, s4 bitop3:0xf6
    v_cmp_ne_u32 vcc, 0, v4
    s_cbranch_vccz TOK_35
POLL_36:
    s_mov_b32 s13, s19
    buffer_load_dwordx4 v[108:111], v61, s[32:35], s13 offen sc1
    s_add_u32 s13, s19, 8192
    buffer_load_dwordx4 v[112:115], v61, s[32:35], s13 offen sc1
    s_add_u32 s13, s19, 16384
    buffer_load_dwordx4 v[116:119], v61, s[32:35], s13 offen sc1
    s_add_u32 s13, s19, 24576
    buffer_load_dwordx4 v[120:123], v61, s[32:35], s13 offen sc1
    s_waitcnt vmcnt(0)
    v_bitop3_b32 v4, v111, v115, s4 bitop3:0x7e
    v_bitop3_b32 v4, v4, v119, s4 bitop3:0xf6
    v_bitop3_b32 v4, v4, v123, s4 bitop3:0xf6
    v_cmp_ne_u32 vcc, 0, v4
    s_cbranch_vccz PDONE_37
    s_add_u32 s5, s5, 1
    s_cmp_lt_u32 s5, 300000
    s_cbranch_scc1 POLL_36
PDONE_37:
TOK_35:
    s_lshl2_add_u32 s96, s74, s75
    s_lshl_b32 s97, s96, 11
    s_lshl_b32 s98, s3, 8
    s_add_u32 s99, s97, s98
    s_add_u32 s15, s99, 20971520
    v_lshlrev_b32 v61, 7, v1
    s_mov_b64 exec, 3
    buffer_load_dword v61, v61, s[32:35], s15 offen
    s_mov_b64 exec, -1
    s_add_u32 s15, s81, 4096
    s_lshl2_add_u32 m0, s89, 99328
    s_nop 0
    buffer_load_dwordx4 v73, s[60:63], s15 offen nt lds
    v_pk_add_f32 v[108:109], v[108:109], v[112:113]
    v_pk_add_f32 v[116:117], v[116:117], v[120:121]
    v_add_f32 v110, v110, v114
    v_add_f32 v118, v118, v122
    v_pk_add_f32 v[108:109], v[108:109], v[116:117]
    v_add_f32 v110, v110, v118
    v_mov_b32 v111, v109
    s_nop 0
    v_permlane32_swap_b32 v108, v110
    v_permlane32_swap_b32 v109, v111
    v_add_f32 v108, v108, v110
    v_add_f32 v109, v109, v111
    s_nop 1
    v_permlane16_swap_b32 v108, v109
    v_add_f32 v111, v108, v109
    v_add_f32 v108, v108, v109
    s_nop 1
    v_permlane16_swap_b32 v108, v111
    v_mul_f32 v110, 0x3a800000, v108
    v_mul_f32 v108, 0x3a800000, v108
    s_nop 1
    v_permlane32_swap_b32 v108, v110
    v_fma_f32 v21, -v108, v108, v110
    v_cvt_pk_bf16_f32 v20, 0, v108
    v_max_f32 v21, 0, v21
    v_cvt_pk_bf16_f32 v21, 0, v21
    v_add_f32 v21, 0x3727c5ac, v21
    v_cvt_pk_bf16_f32 v21, 0, v21
    v_sqrt_f32 v21, v21
    s_nop 0
    v_cvt_pk_bf16_f32 v21, 0, v21
    s_lshl3_add_u32 s13, s3, 136192
    v_rcp_f32 v21, v21
    v_fma_f32 v111, -v20, v22, v111
    v_mov_b32 v5, s13
    v_mul_f32 v111, v111, v21
    ds_write_b64 v8, v[20:21]
    s_movk_i32 s13, 0xfff
    v_ashrrev_i32 v108, 31, v111
    v_or_b32 v108, 0x80000000, v108
    v_xor_b32 v108, v108, v111
    v_bfi_b32 v124, s13, v62, v108
    s_nop 1
    v_min_u32_dpp v125, v124, v124 row_ror:8 row_mask:0xf bank_mask:0xf
    v_max_u32_dpp v124, v124, v124 row_ror:8 row_mask:0xf bank_mask:0xf
    s_nop 1
    v_min_u32_dpp v126, v124, v124 row_ror:4 row_mask:0xf bank_mask:0xf
    v_max_u32_dpp v125, v125, v125 row_ror:4 row_mask:0xf bank_mask:0xf
    v_max_u32_dpp v124, v124, v124 row_ror:4 row_mask:0xf bank_mask:0xf
    v_max_u32 v125, v125, v126
    s_nop 0
    v_min_u32_dpp v126, v124, v124 row_ror:2 row_mask:0xf bank_mask:0xf
    v_max_u32_dpp v125, v125, v125 row_ror:2 row_mask:0xf bank_mask:0xf
    v_max_u32_dpp v124, v124, v124 row_ror:2 row_mask:0xf bank_mask:0xf
    v_max_u32 v125, v125, v126
    s_nop 0
    v_min_u32_dpp v126, v124, v124 row_ror:1 row_mask:0xf bank_mask:0xf
    v_max_u32_dpp v125, v125, v125 row_ror:1 row_mask:0xf bank_mask:0xf
    v_max_u32_dpp v124, v124, v124 row_ror:1 row_mask:0xf bank_mask:0xf
    v_max_u32 v125, v125, v126
    ds_write_b64 v5, v[124:125]
    v_and_b32 v6, 3, v1
    v_lshlrev_b32 v6, 18, v6
    v_bfe_u32 v9, v1, 2, 2
    v_lshl_add_u32 v6, v9, 13, v6
    s_and_b32 s96, s21, 1
    s_and_b32 s97, s12, 7
    s_lshr_b32 s98, s12, 3
    s_lshl3_add_u32 s99, s97, s98
    s_lshl_b32 s97, s99, 12
    s_lshr_b32 s98, s21, 1
    s_lshl_b32 s99, s98, 6
    s_add_u32 s98, s97, s99
    s_lshl4_add_u32 s97, s96, s98
    s_add_u32 s99, s97, 1048576
    s_add_u32 s14, s99, 2560
    s_waitcnt lgkmcnt(0)
    s_barrier
    ds_read_b64 v[124:125], v11
    ds_read_b64 v[20:21], v10
    s_waitcnt lgkmcnt(1)
    v_min_u32_dpp v126, v124, v124 quad_perm:[1,0,3,2] row_mask:0xf bank_mask:0xf
    v_max_u32_dpp v125, v125, v125 quad_perm:[1,0,3,2] row_mask:0xf bank_mask:0xf
    v_max_u32_dpp v124, v124, v124 quad_perm:[1,0,3,2] row_mask:0xf bank_mask:0xf
    v_max_u32 v125, v125, v126
    s_nop 0
    v_min_u32_dpp v126, v124, v124 quad_perm:[2,3,0,1] row_mask:0xf bank_mask:0xf
    v_max_u32_dpp v125, v125, v125 quad_perm:[2,3,0,1] row_mask:0xf bank_mask:0xf
    v_max_u32_dpp v124, v124, v124 quad_perm:[2,3,0,1] row_mask:0xf bank_mask:0xf
    v_max_u32 v125, v125, v126
    s_nop 0
    v_min_u32_dpp v126, v124, v124 row_half_mirror row_mask:0xf bank_mask:0xf
    v_max_u32_dpp v125, v125, v125 row_half_mirror row_mask:0xf bank_mask:0xf
    v_max_u32_dpp v124, v124, v124 row_half_mirror row_mask:0xf bank_mask:0xf
    v_max_u32 v125, v125, v126
    v_or_b32 v126, 1, v125
    v_mov_b32 v125, s4
    v_mov_b32 v127, s4
    s_cmp_lg_u32 s3, 0
    s_cbranch_scc1 L_NOF
    s_mov_b64 exec, 0xffff
    buffer_store_dwordx4 v[124:127], v6, s[32:35], s14 offen sc1
    s_mov_b64 exec, -1
L_NOF:
    s_cmp_lg_u32 s3, 1
    s_cbranch_scc1 L_NOC
    v_and_b32 v4, 16, v1
    v_cmp_eq_u32 vcc, 0, v4
    s_nop 1
    v_cndmask_b32 v4, v126, v124, vcc
    v_not_b32 v4, v4
    v_bfe_u32 v4, v4, 1, 7
    v_lshlrev_b32 v6, 3, v4
    v_mul_u32_u24 v4, 144, v4
    v_add_u32 v6, 135168, v6
    v_and_b32 v5, 15, v1
    v_lshlrev_b32 v5, 3, v5
    v_add_u32 v4, v4, v5
    ds_read_b64 v[112:113], v6
    ds_read_b64 v[108:109], v4 offset:0
    v_and_b32 v6, 15, v1
    v_lshlrev_b32 v6, 4, v6
    v_bfe_u32 v9, v1, 4, 1
    v_lshl_add_u32 v6, v9, 14, v6
    v_lshrrev_b32 v9, 5, v1
    v_lshl_add_u32 v6, v9, 12, v6
    v_bfe_u32 v7, v1, 4, 1
    v_lshlrev_b32 v7, 14, v7
    s_lshl_b32 s96, s21, 15
    s_lshl_b32 s97, s12, 8
    s_add_u32 s98, s96, s97
    s_add_u32 s13, s98, 33554432
    s_lshl_b32 s96, s21, 15
    s_lshl3_add_u32 s97, s12, s96
    s_add_u32 s98, s97, 8192
    s_add_u32 s16, s98, 33554432
    v_mov_b32 v111, s4
    s_waitcnt lgkmcnt(0)
    v_lshlrev_b32 v116, 16, v108
    v_and_b32 v117, s6, v108
    v_lshlrev_b32 v118, 16, v109
    v_and_b32 v119, s6, v109
    v_pk_add_f32 v[116:117], v[116:117], v[112:113] op_sel_hi:[1,0] neg_lo:[0,1] neg_hi:[0,1]
    v_pk_add_f32 v[118:119], v[118:119], v[112:113] op_sel_hi:[1,0] neg_lo:[0,1] neg_hi:[0,1]
    v_cvt_pk_bf16_f32 v116, 0, v116
    v_cvt_pk_bf16_f32 v117, 0, v117
    v_cvt_pk_bf16_f32 v118, 0, v118
    v_cvt_pk_bf16_f32 v119, 0, v119
    v_pk_mul_f32 v[116:117], v[116:117], v[112:113] op_sel:[0,1]
    v_pk_mul_f32 v[118:119], v[118:119], v[112:113] op_sel:[0,1]
    v_cvt_pk_bf16_f32 v116, 0, v116
    v_cvt_pk_bf16_f32 v117, 0, v117
    v_cvt_pk_bf16_f32 v118, 0, v118
    v_cvt_pk_bf16_f32 v119, 0, v119
    v_pk_mul_f32 v[116:117], v[116:117], v[136:137]
    v_pk_mul_f32 v[118:119], v[118:119], v[138:139]
    v_cvt_pk_bf16_f32 v116, 0, v116
    v_cvt_pk_bf16_f32 v117, 0, v117
    v_cvt_pk_bf16_f32 v118, 0, v118
    v_cvt_pk_bf16_f32 v119, 0, v119
    v_pk_add_f32 v[116:117], v[116:117], v[132:133]
    v_pk_add_f32 v[118:119], v[118:119], v[134:135]
    v_mov_b32 v110, v109
    v_mov_b32 v109, s4
    s_mov_b32 exec_hi, 0
    v_cvt_pk_bf16_f32 v108, v116, v117
    v_cvt_pk_bf16_f32 v110, v118, v119
    s_mov_b32 exec_hi, -1
    v_dot2_f32_bf16 v112, v108, v140, 0
    v_mov_b32 v113, s4
    v_dot2_f32_bf16 v112, v110, v141, v112
    buffer_store_dwordx4 v[108:111], v6, s[32:35], s13 offen sc1
    s_nop 1
    v_add_f32_dpp v112, v112, v112 quad_perm:[1,0,3,2] row_mask:0xf bank_mask:0xf
    s_nop 1
    v_add_f32_dpp v112, v112, v112 quad_perm:[2,3,0,1] row_mask:0xf bank_mask:0xf
    s_nop 1
    v_add_f32_dpp v112, v112, v112 row_half_mirror row_mask:0xf bank_mask:0xf
    s_nop 1
    v_add_f32_dpp v112, v112, v112 row_ror:8 row_mask:0xf bank_mask:0xf
    s_mov_b64 exec, 0x10001
    buffer_store_dwordx2 v[112:113], v7, s[32:35], s16 offen sc1
    s_mov_b64 exec, -1
L_NOC:
    s_waitcnt lgkmcnt(0)
    s_add_u32 s13, s81, 8192
    s_lshl2_add_u32 m0, s89, 100352
    s_nop 0
    buffer_load_dwordx4 v73, s[60:63], s13 offen nt lds
    s_load_dwordx8 s[24:31], s[32:33], s92 offset:2560 glc
    v_pk_add_f32 v[40:41], v[24:25], v[20:21] op_sel_hi:[1,0] neg_lo:[0,1] neg_hi:[0,1]
    v_pk_add_f32 v[42:43], v[26:27], v[20:21] op_sel_hi:[1,0] neg_lo:[0,1] neg_hi:[0,1]
    v_pk_add_f32 v[44:45], v[28:29], v[20:21] op_sel_hi:[1,0] neg_lo:[0,1] neg_hi:[0,1]
    v_pk_add_f32 v[46:47], v[30:31], v[20:21] op_sel_hi:[1,0] neg_lo:[0,1] neg_hi:[0,1]
    v_pk_add_f32 v[48:49], v[32:33], v[20:21] op_sel_hi:[1,0] neg_lo:[0,1] neg_hi:[0,1]
    v_pk_add_f32 v[50:51], v[34:35], v[20:21] op_sel_hi:[1,0] neg_lo:[0,1] neg_hi:[0,1]
    v_pk_add_f32 v[52:53], v[36:37], v[20:21] op_sel_hi:[1,0] neg_lo:[0,1] neg_hi:[0,1]
    v_pk_add_f32 v[54:55], v[38:39], v[20:21] op_sel_hi:[1,0] neg_lo:[0,1] neg_hi:[0,1]
    v_cvt_pk_bf16_f32 v40, 0, v40
    v_cvt_pk_bf16_f32 v41, 0, v41
    v_cvt_pk_bf16_f32 v42, 0, v42
    v_cvt_pk_bf16_f32 v43, 0, v43
    v_cvt_pk_bf16_f32 v44, 0, v44
    v_cvt_pk_bf16_f32 v45, 0, v45
    v_cvt_pk_bf16_f32 v46, 0, v46
    v_cvt_pk_bf16_f32 v47, 0, v47
    v_cvt_pk_bf16_f32 v48, 0, v48
    v_cvt_pk_bf16_f32 v49, 0, v49
    v_cvt_pk_bf16_f32 v50, 0, v50
    v_cvt_pk_bf16_f32 v51, 0, v51
    v_cvt_pk_bf16_f32 v52, 0, v52
    v_cvt_pk_bf16_f32 v53, 0, v53
    v_cvt_pk_bf16_f32 v54, 0, v54
    v_cvt_pk_bf16_f32 v55, 0, v55
    v_pk_mul_f32 v[40:41], v[40:41], v[20:21] op_sel:[0,1]
    v_pk_mul_f32 v[42:43], v[42:43], v[20:21] op_sel:[0,1]
    v_pk_mul_f32 v[44:45], v[44:45], v[20:21] op_sel:[0,1]
    v_pk_mul_f32 v[46:47], v[46:47], v[20:21] op_sel:[0,1]
    v_pk_mul_f32 v[48:49], v[48:49], v[20:21] op_sel:[0,1]
    v_pk_mul_f32 v[50:51], v[50:51], v[20:21] op_sel:[0,1]
    v_pk_mul_f32 v[52:53], v[52:53], v[20:21] op_sel:[0,1]
    v_pk_mul_f32 v[54:55], v[54:55], v[20:21] op_sel:[0,1]
    v_cvt_pk_bf16_f32 v40, 0, v40
    v_cvt_pk_bf16_f32 v41, 0, v41
    v_cvt_pk_bf16_f32 v42, 0, v42
    v_cvt_pk_bf16_f32 v43, 0, v43
    v_cvt_pk_bf16_f32 v44, 0, v44
    v_cvt_pk_bf16_f32 v45, 0, v45
    v_cvt_pk_bf16_f32 v46, 0, v46
    v_cvt_pk_bf16_f32 v47, 0, v47
    v_cvt_pk_bf16_f32 v48, 0, v48
    v_cvt_pk_bf16_f32 v49, 0, v49
    v_cvt_pk_bf16_f32 v50, 0, v50
    v_cvt_pk_bf16_f32 v51, 0, v51
    v_cvt_pk_bf16_f32 v52, 0, v52
    v_cvt_pk_bf16_f32 v53, 0, v53
    v_cvt_pk_bf16_f32 v54, 0, v54
    v_cvt_pk_bf16_f32 v55, 0, v55
    v_pk_mul_f32 v[40:41], v[40:41], v[92:93]
    v_pk_mul_f32 v[42:43], v[42:43], v[94:95]
    v_pk_mul_f32 v[44:45], v[44:45], v[96:97]
    v_pk_mul_f32 v[46:47], v[46:47], v[98:99]
    v_pk_mul_f32 v[48:49], v[48:49], v[100:101]
    v_pk_mul_f32 v[50:51], v[50:51], v[102:103]
    v_pk_mul_f32 v[52:53], v[52:53], v[104:105]
    v_pk_mul_f32 v[54:55], v[54:55], v[106:107]
    v_cvt_pk_bf16_f32 v40, 0, v40
    v_cvt_pk_bf16_f32 v41, 0, v41
    v_cvt_pk_bf16_f32 v42, 0, v42
    v_cvt_pk_bf16_f32 v43, 0, v43
    v_cvt_pk_bf16_f32 v44, 0, v44
    v_cvt_pk_bf16_f32 v45, 0, v45
    v_cvt_pk_bf16_f32 v46, 0, v46
    v_cvt_pk_bf16_f32 v47, 0, v47
    v_cvt_pk_bf16_f32 v48, 0, v48
    v_cvt_pk_bf16_f32 v49, 0, v49
    v_cvt_pk_bf16_f32 v50, 0, v50
    v_cvt_pk_bf16_f32 v51, 0, v51
    v_cvt_pk_bf16_f32 v52, 0, v52
    v_cvt_pk_bf16_f32 v53, 0, v53
    v_cvt_pk_bf16_f32 v54, 0, v54
    v_cvt_pk_bf16_f32 v55, 0, v55
    v_pk_add_f32 v[40:41], v[40:41], v[76:77]
    v_pk_add_f32 v[42:43], v[42:43], v[78:79]
    v_pk_add_f32 v[44:45], v[44:45], v[80:81]
    v_pk_add_f32 v[46:47], v[46:47], v[82:83]
    v_pk_add_f32 v[48:49], v[48:49], v[84:85]
    v_pk_add_f32 v[50:51], v[50:51], v[86:87]
    v_pk_add_f32 v[52:53], v[52:53], v[88:89]
    v_pk_add_f32 v[54:55], v[54:55], v[90:91]
    v_cvt_pk_bf16_f32 v40, 0, v40
    v_cvt_pk_bf16_f32 v41, 0, v41
    v_cvt_pk_bf16_f32 v42, 0, v42
    v_cvt_pk_bf16_f32 v43, 0, v43
    v_cvt_pk_bf16_f32 v44, 0, v44
    v_cvt_pk_bf16_f32 v45, 0, v45
    v_cvt_pk_bf16_f32 v46, 0, v46
    v_cvt_pk_bf16_f32 v47, 0, v47
    v_cvt_pk_bf16_f32 v48, 0, v48
    v_cvt_pk_bf16_f32 v49, 0, v49
    v_cvt_pk_bf16_f32 v50, 0, v50
    v_cvt_pk_bf16_f32 v51, 0, v51
    v_cvt_pk_bf16_f32 v52, 0, v52
    v_cvt_pk_bf16_f32 v53, 0, v53
    v_cvt_pk_bf16_f32 v54, 0, v54
    v_cvt_pk_bf16_f32 v55, 0, v55
    s_lshr_b32 s96, s3, 2
    s_lshl_b32 s97, s96, 15
    s_and_b32 s98, s3, 3
    s_lshl_b32 s99, s98, 5
    s_add_u32 s96, s97, s99
    s_add_u32 s13, s96, 32768
    v_lshrrev_b32 v129, 4, v1
    v_lshlrev_b32 v129, 13, v129
    v_bfe_u32 v9, v1, 2, 2
    v_lshl_add_u32 v129, v9, 7, v129
    v_bfe_u32 v9, v1, 3, 2
    v_lshl_add_u32 v129, v9, 5, v129
    v_and_b32 v9, 3, v1
    v_lshl_add_u32 v129, v9, 3, v129
    v_xor_b32 v129, s13, v129
    s_lshl_b32 s13, s3, 6
    v_bfe_u32 v130, v1, 2, 1
    v_lshlrev_b32 v130, 9, v130
    v_bfe_u32 v9, v1, 3, 1
    v_lshl_add_u32 v130, v9, 12, v130
    v_lshrrev_b32 v9, 5, v1
    v_lshl_add_u32 v130, v9, 11, v130
    v_bfe_u32 v9, v1, 2, 2
    v_lshl_add_u32 v130, v9, 6, v130
    v_bfe_u32 v9, v1, 4, 1
    v_lshl_add_u32 v130, v9, 5, v130
    v_and_b32 v9, 3, v1
    v_lshl_add_u32 v130, v9, 3, v130
    v_xor_b32 v130, s13, v130
    v_add_u32 v130, 98304, v130
    v_and_b32 v131, 7, v1
    v_lshlrev_b32 v131, 4, v131
    v_lshrrev_b32 v9, 4, v1
    v_lshl_add_u32 v131, v9, 7, v131
    v_add_u32 v131, 136704, v131
    s_lshl4_add_u32 s13, s3, 136256
    v_mov_b32 v4, s13
    v_and_b32 v5, 7, v1
    v_lshlrev_b32 v5, 4, v5
    v_add_u32 v5, 136256, v5
    v_and_b32 v8, 8, v1
    v_cmp_eq_u32 s[22:23], 0, v8
    s_branch SCHK_39
SPOLL_38:
    s_load_dwordx8 s[24:31], s[32:33], s92 offset:2560 glc
SCHK_39:
    s_add_u32 s5, s5, 1
    s_cmp_ge_u32 s5, 300000
    s_waitcnt lgkmcnt(0)
    s_cbranch_scc1 SDONE_40
    s_cmp_lg_u32 s25, s4
    s_cbranch_scc1 SPOLL_38
    s_cmp_lg_u32 s27, s4
    s_cbranch_scc1 SPOLL_38
    s_cmp_lg_u32 s29, s4
    s_cbranch_scc1 SPOLL_38
    s_cmp_lg_u32 s31, s4
    s_cbranch_scc1 SPOLL_38
SDONE_40:
    s_min_u32 s25, s24, s28
    s_max_u32 s24, s24, s28
    s_max_u32 s27, s26, s30
    s_min_u32 s26, s26, s30
    s_max_u32 s28, s25, s27
    s_min_u32 s25, s25, s27
    v_mov_b32 v132, s24
    v_mov_b32 v135, s26
    v_mov_b32 v133, s28
    v_mov_b32 v134, s25
    ds_write_b128 v4, v[132:135]
    s_waitcnt lgkmcnt(0)
    s_barrier
    s_cmp_lt_u32 s3, 4
    s_cbranch_scc1 L_CSEL
    s_add_u32 s13, s81, 12288
    s_lshl2_add_u32 m0, s89, 101376
    s_nop 0
    buffer_load_dwordx4 v73, s[60:63], s13 offen nt lds
    ds_read_b64_tr_b16 v[148:149], v129
    ds_read_b64_tr_b16 v[150:151], v129 offset:512
    ds_read_b64_tr_b16 v[152:153], v129 offset:1024
    ds_read_b64_tr_b16 v[154:155], v129 offset:1536
    ds_read_b64_tr_b16 v[156:157], v129 offset:2048
    ds_read_b64_tr_b16 v[158:159], v129 offset:2560
    ds_read_b64_tr_b16 v[160:161], v129 offset:3072
    ds_read_b64_tr_b16 v[162:163], v129 offset:3584
    ds_read_b64_tr_b16 v[164:165], v129 offset:4096
    ds_read_b64_tr_b16 v[166:167], v129 offset:4608
    ds_read_b64_tr_b16 v[168:169], v129 offset:5120
    ds_read_b64_tr_b16 v[170:171], v129 offset:5632
    ds_read_b64_tr_b16 v[172:173], v129 offset:6144
    ds_read_b64_tr_b16 v[174:175], v129 offset:6656
    ds_read_b64_tr_b16 v[176:177], v129 offset:7168
    ds_read_b64_tr_b16 v[178:179], v129 offset:7680
    v_mul_u32_u24_dpp v76, v58, v74 row_newbcast:0 row_mask:0xf bank_mask:0xf
    v_and_b32_dpp v77, v58, v75 row_newbcast:0 row_mask:0xf bank_mask:0xf
    v_mul_u32_u24_dpp v78, v58, v74 row_newbcast:1 row_mask:0xf bank_mask:0xf
    v_and_b32_dpp v79, v58, v75 row_newbcast:1 row_mask:0xf bank_mask:0xf
    v_mul_u32_u24_dpp v80, v58, v74 row_newbcast:2 row_mask:0xf bank_mask:0xf
    v_and_b32_dpp v81, v58, v75 row_newbcast:2 row_mask:0xf bank_mask:0xf
    v_mul_u32_u24_dpp v82, v58, v74 row_newbcast:3 row_mask:0xf bank_mask:0xf
    v_and_b32_dpp v83, v58, v75 row_newbcast:3 row_mask:0xf bank_mask:0xf
    v_mul_u32_u24_dpp v84, v58, v74 row_newbcast:4 row_mask:0xf bank_mask:0xf
    v_and_b32_dpp v85, v58, v75 row_newbcast:4 row_mask:0xf bank_mask:0xf
    v_mul_u32_u24_dpp v86, v58, v74 row_newbcast:5 row_mask:0xf bank_mask:0xf
    v_and_b32_dpp v87, v58, v75 row_newbcast:5 row_mask:0xf bank_mask:0xf
    v_mul_u32_u24_dpp v88, v58, v74 row_newbcast:6 row_mask:0xf bank_mask:0xf
    v_and_b32_dpp v89, v58, v75 row_newbcast:6 row_mask:0xf bank_mask:0xf
    v_mul_u32_u24_dpp v90, v58, v74 row_newbcast:7 row_mask:0xf bank_mask:0xf
    v_and_b32_dpp v91, v58, v75 row_newbcast:7 row_mask:0xf bank_mask:0xf
    v_pk_mul_f32 v[40:41], v[40:41], v[76:77]
    v_pk_mul_f32 v[42:43], v[42:43], v[78:79]
    v_pk_mul_f32 v[44:45], v[44:45], v[80:81]
    v_pk_mul_f32 v[46:47], v[46:47], v[82:83]
    v_pk_mul_f32 v[48:49], v[48:49], v[84:85]
    v_pk_mul_f32 v[50:51], v[50:51], v[86:87]
    v_pk_mul_f32 v[52:53], v[52:53], v[88:89]
    v_pk_mul_f32 v[54:55], v[54:55], v[90:91]
    v_cvt_pk_bf16_f32 v40, 0, v40
    v_cvt_pk_bf16_f32 v41, 0, v41
    v_cvt_pk_bf16_f32 v42, 0, v42
    v_cvt_pk_bf16_f32 v43, 0, v43
    v_cvt_pk_bf16_f32 v44, 0, v44
    v_cvt_pk_bf16_f32 v45, 0, v45
    v_cvt_pk_bf16_f32 v46, 0, v46
    v_cvt_pk_bf16_f32 v47, 0, v47
    v_cvt_pk_bf16_f32 v48, 0, v48
    v_cvt_pk_bf16_f32 v49, 0, v49
    v_cvt_pk_bf16_f32 v50, 0, v50
    v_cvt_pk_bf16_f32 v51, 0, v51
    v_cvt_pk_bf16_f32 v52, 0, v52
    v_cvt_pk_bf16_f32 v53, 0, v53
    v_cvt_pk_bf16_f32 v54, 0, v54
    v_cvt_pk_bf16_f32 v55, 0, v55
    v_pk_add_f32 v[40:41], v[40:41], v[24:25]
    v_pk_add_f32 v[42:43], v[42:43], v[26:27]
    v_pk_add_f32 v[44:45], v[44:45], v[28:29]
    v_pk_add_f32 v[46:47], v[46:47], v[30:31]
    v_pk_add_f32 v[48:49], v[48:49], v[32:33]
    v_pk_add_f32 v[50:51], v[50:51], v[34:35]
    v_pk_add_f32 v[52:53], v[52:53], v[36:37]
    v_pk_add_f32 v[54:55], v[54:55], v[38:39]
    v_cvt_pk_bf16_f32 v64, v40, v41
    v_cvt_pk_bf16_f32 v65, v42, v43
    v_cvt_pk_bf16_f32 v66, v44, v45
    v_cvt_pk_bf16_f32 v67, v46, v47
    v_cvt_pk_bf16_f32 v68, v48, v49
    v_cvt_pk_bf16_f32 v69, v50, v51
    v_cvt_pk_bf16_f32 v70, v52, v53
    v_cvt_pk_bf16_f32 v71, v54, v55
    ds_write_b128 v128, v[64:67]
    ds_write_b128 v128, v[68:71] offset:16
    s_mul_i32 s96, s3, 2304
    s_add_u32 s16, s96, 139776
    v_lshrrev_b32 v128, 3, v1
    v_mul_u32_u24 v128, 144, v128
    v_and_b32 v9, 7, v1
    v_lshl_add_u32 v128, v9, 4, v128
    v_add_u32 v128, s16, v128
    s_branch L_CSELD
L_CSEL:
    ds_read_b128 v[132:135], v5
    s_lshl_b32 s96, s3, 9
    s_add_u32 s13, s96, 136704
    v_add_u32 v6, s13, v63
    s_lshl2_add_u32 s13, s3, 136384
    v_mov_b32 v7, s13
    s_waitcnt lgkmcnt(0)
    v_max_u32_dpp v136, v135, v132 quad_perm:[1,0,3,2] row_mask:0xf bank_mask:0xf
    v_max_u32_dpp v137, v134, v133 quad_perm:[1,0,3,2] row_mask:0xf bank_mask:0xf
    v_max_u32_dpp v138, v133, v134 quad_perm:[1,0,3,2] row_mask:0xf bank_mask:0xf
    v_max_u32_dpp v139, v132, v135 quad_perm:[1,0,3,2] row_mask:0xf bank_mask:0xf
    v_max_u32 v140, v136, v138
    v_max_u32 v141, v137, v139
    v_min_u32 v142, v136, v138
    v_min_u32 v143, v137, v139
    v_max_u32 v132, v140, v141
    v_min_u32 v133, v140, v141
    v_max_u32 v134, v142, v143
    v_min_u32 v135, v142, v143
    s_nop 1
    v_max_u32_dpp v136, v135, v132 quad_perm:[2,3,0,1] row_mask:0xf bank_mask:0xf
    v_max_u32_dpp v137, v134, v133 quad_perm:[2,3,0,1] row_mask:0xf bank_mask:0xf
    v_max_u32_dpp v138, v133, v134 quad_perm:[2,3,0,1] row_mask:0xf bank_mask:0xf
    v_max_u32_dpp v139, v132, v135 quad_perm:[2,3,0,1] row_mask:0xf bank_mask:0xf
    v_max_u32 v140, v136, v138
    v_max_u32 v141, v137, v139
    v_min_u32 v142, v136, v138
    v_min_u32 v143, v137, v139
    v_max_u32 v132, v140, v141
    v_min_u32 v133, v140, v141
    v_max_u32 v134, v142, v143
    v_min_u32 v135, v142, v143
    s_nop 1
    v_max_u32_dpp v136, v135, v132 row_half_mirror row_mask:0xf bank_mask:0xf
    v_max_u32_dpp v137, v134, v133 row_half_mirror row_mask:0xf bank_mask:0xf
    v_max_u32_dpp v138, v133, v134 row_half_mirror row_mask:0xf bank_mask:0xf
    v_max_u32_dpp v139, v132, v135 row_half_mirror row_mask:0xf bank_mask:0xf
    v_readfirstlane_b32 s24, v136
    v_readfirstlane_b32 s25, v137
    v_readfirstlane_b32 s26, v138
    v_readfirstlane_b32 s27, v139
    s_bitcmp1_b32 s3, 0
    s_cselect_b32 s24, s25, s24
    s_cselect_b32 s26, s27, s26
    s_bitcmp1_b32 s3, 1
    s_cselect_b32 s24, s26, s24
    s_and_b32 s15, s24, 4095
    s_lshr_b32 s96, s15, 8
    s_sub_u32 s97, 15, s96
    s_and_b32 s98, s15, 1
    s_lshl1_add_u32 s99, s97, s98
    s_lshl_b32 s96, s99, 14
    s_add_u32 s13, s96, 33554432
    s_lshl_b32 s96, s75, 10
    s_add_u32 s14, s96, s13
    s_add_u32 s13, s13, 8192
    v_and_b32 v10, 15, v1
    v_lshlrev_b32 v10, 3, v10
    buffer_load_dwordx2 v[136:137], v10, s[32:35], s13 offen sc1
    buffer_load_dwordx4 v[132:135], v2, s[32:35], s14 offen sc1
    s_add_u32 s16, s81, 12288
    s_lshl2_add_u32 m0, s89, 101376
    s_nop 0
    buffer_load_dwordx4 v73, s[60:63], s16 offen nt lds
    ds_read_b64_tr_b16 v[148:149], v129
    ds_read_b64_tr_b16 v[150:151], v129 offset:512
    ds_read_b64_tr_b16 v[152:153], v129 offset:1024
    ds_read_b64_tr_b16 v[154:155], v129 offset:1536
    ds_read_b64_tr_b16 v[156:157], v129 offset:2048
    ds_read_b64_tr_b16 v[158:159], v129 offset:2560
    ds_read_b64_tr_b16 v[160:161], v129 offset:3072
    ds_read_b64_tr_b16 v[162:163], v129 offset:3584
    ds_read_b64_tr_b16 v[164:165], v129 offset:4096
    ds_read_b64_tr_b16 v[166:167], v129 offset:4608
    ds_read_b64_tr_b16 v[168:169], v129 offset:5120
    ds_read_b64_tr_b16 v[170:171], v129 offset:5632
    ds_read_b64_tr_b16 v[172:173], v129 offset:6144
    ds_read_b64_tr_b16 v[174:175], v129 offset:6656
    ds_read_b64_tr_b16 v[176:177], v129 offset:7168
    ds_read_b64_tr_b16 v[178:179], v129 offset:7680
    v_mul_u32_u24_dpp v76, v58, v74 row_newbcast:0 row_mask:0xf bank_mask:0xf
    v_and_b32_dpp v77, v58, v75 row_newbcast:0 row_mask:0xf bank_mask:0xf
    v_mul_u32_u24_dpp v78, v58, v74 row_newbcast:1 row_mask:0xf bank_mask:0xf
    v_and_b32_dpp v79, v58, v75 row_newbcast:1 row_mask:0xf bank_mask:0xf
    v_mul_u32_u24_dpp v80, v58, v74 row_newbcast:2 row_mask:0xf bank_mask:0xf
    v_and_b32_dpp v81, v58, v75 row_newbcast:2 row_mask:0xf bank_mask:0xf
    v_mul_u32_u24_dpp v82, v58, v74 row_newbcast:3 row_mask:0xf bank_mask:0xf
    v_and_b32_dpp v83, v58, v75 row_newbcast:3 row_mask:0xf bank_mask:0xf
    v_mul_u32_u24_dpp v84, v58, v74 row_newbcast:4 row_mask:0xf bank_mask:0xf
    v_and_b32_dpp v85, v58, v75 row_newbcast:4 row_mask:0xf bank_mask:0xf
    v_mul_u32_u24_dpp v86, v58, v74 row_newbcast:5 row_mask:0xf bank_mask:0xf
    v_and_b32_dpp v87, v58, v75 row_newbcast:5 row_mask:0xf bank_mask:0xf
    v_mul_u32_u24_dpp v88, v58, v74 row_newbcast:6 row_mask:0xf bank_mask:0xf
    v_and_b32_dpp v89, v58, v75 row_newbcast:6 row_mask:0xf bank_mask:0xf
    v_mul_u32_u24_dpp v90, v58, v74 row_newbcast:7 row_mask:0xf bank_mask:0xf
    v_and_b32_dpp v91, v58, v75 row_newbcast:7 row_mask:0xf bank_mask:0xf
    v_pk_mul_f32 v[40:41], v[40:41], v[76:77]
    v_pk_mul_f32 v[42:43], v[42:43], v[78:79]
    v_pk_mul_f32 v[44:45], v[44:45], v[80:81]
    v_pk_mul_f32 v[46:47], v[46:47], v[82:83]
    v_pk_mul_f32 v[48:49], v[48:49], v[84:85]
    v_pk_mul_f32 v[50:51], v[50:51], v[86:87]
    v_pk_mul_f32 v[52:53], v[52:53], v[88:89]
    v_pk_mul_f32 v[54:55], v[54:55], v[90:91]
    v_cvt_pk_bf16_f32 v40, 0, v40
    v_cvt_pk_bf16_f32 v41, 0, v41
    v_cvt_pk_bf16_f32 v42, 0, v42
    v_cvt_pk_bf16_f32 v43, 0, v43
    v_cvt_pk_bf16_f32 v44, 0, v44
    v_cvt_pk_bf16_f32 v45, 0, v45
    v_cvt_pk_bf16_f32 v46, 0, v46
    v_cvt_pk_bf16_f32 v47, 0, v47
    v_cvt_pk_bf16_f32 v48, 0, v48
    v_cvt_pk_bf16_f32 v49, 0, v49
    v_cvt_pk_bf16_f32 v50, 0, v50
    v_cvt_pk_bf16_f32 v51, 0, v51
    v_cvt_pk_bf16_f32 v52, 0, v52
    v_cvt_pk_bf16_f32 v53, 0, v53
    v_cvt_pk_bf16_f32 v54, 0, v54
    v_cvt_pk_bf16_f32 v55, 0, v55
    v_pk_add_f32 v[40:41], v[40:41], v[24:25]
    v_pk_add_f32 v[42:43], v[42:43], v[26:27]
    v_pk_add_f32 v[44:45], v[44:45], v[28:29]
    v_pk_add_f32 v[46:47], v[46:47], v[30:31]
    v_pk_add_f32 v[48:49], v[48:49], v[32:33]
    v_pk_add_f32 v[50:51], v[50:51], v[34:35]
    v_pk_add_f32 v[52:53], v[52:53], v[36:37]
    v_pk_add_f32 v[54:55], v[54:55], v[38:39]
    v_cvt_pk_bf16_f32 v64, v40, v41
    v_cvt_pk_bf16_f32 v65, v42, v43
    v_cvt_pk_bf16_f32 v66, v44, v45
    v_cvt_pk_bf16_f32 v67, v46, v47
    v_cvt_pk_bf16_f32 v68, v48, v49
    v_cvt_pk_bf16_f32 v69, v50, v51
    v_cvt_pk_bf16_f32 v70, v52, v53
    v_cvt_pk_bf16_f32 v71, v54, v55
    ds_write_b128 v128, v[64:67]
    ds_write_b128 v128, v[68:71] offset:16
    s_mul_i32 s96, s3, 2304
    s_add_u32 s16, s96, 139776
    v_lshrrev_b32 v128, 3, v1
    v_mul_u32_u24 v128, 144, v128
    v_and_b32 v9, 7, v1
    v_lshl_add_u32 v128, v9, 4, v128
    v_add_u32 v128, s16, v128
    s_lshl2_add_u32 s15, s15, s3
    s_waitcnt vmcnt(1)
    v_bitop3_b32 v8, v133, v135, s4 bitop3:0x7e
    v_bitop3_b32 v8, v8, v137, s4 bitop3:0xf6
    v_cmp_ne_u32 vcc, 0, v8
    s_cbranch_vccz TOK_42
POLL_43:
    buffer_load_dwordx2 v[136:137], v10, s[32:35], s13 offen sc1
    buffer_load_dwordx4 v[132:135], v2, s[32:35], s14 offen sc1
    s_waitcnt vmcnt(0)
    v_bitop3_b32 v8, v133, v135, s4 bitop3:0x7e
    v_bitop3_b32 v8, v8, v137, s4 bitop3:0xf6
    v_cmp_ne_u32 vcc, 0, v8
    s_cbranch_vccz PDONE_44
    s_add_u32 s5, s5, 1
    s_cmp_lt_u32 s5, 300000
    s_cbranch_scc1 POLL_43
PDONE_44:
TOK_42:
    ds_write2_b32 v6, v132, v134 offset0:0 offset1:1
    v_add_f32_dpp v136, v136, v136 quad_perm:[1,0,3,2] row_mask:0xf bank_mask:0xf
    s_nop 1
    v_add_f32_dpp v136, v136, v136 quad_perm:[2,3,0,1] row_mask:0xf bank_mask:0xf
    s_nop 1
    v_add_f32_dpp v136, v136, v136 row_half_mirror row_mask:0xf bank_mask:0xf
    s_nop 1
    v_add_f32_dpp v136, v136, v136 row_ror:8 row_mask:0xf bank_mask:0xf
    v_cvt_pk_bf16_f32 v136, 0, v136
    v_ashrrev_i32 v137, 31, v136
    v_or_b32 v137, 0x80000000, v137
    v_xor_b32 v136, v136, v137
    v_and_b32 v136, s6, v136
    v_or_b32 v136, s15, v136
    ds_write_b32 v7, v136
L_CSELD:
    v_mov_b32 v4, 136384
    v_and_b32 v8, 15, v1
    v_lshlrev_b32 v8, 4, v8
    v_lshrrev_b32 v9, 5, v1
    v_lshl_add_u32 v8, v9, 3, v8
    s_lshl_b32 s96, s74, 13
    s_add_u32 s14, s96, 20971520
    s_lshl3_add_u32 s96, s75, s3
    s_lshl_b32 s97, s96, 8
    s_add_u32 s20, s97, s14
    s_waitcnt lgkmcnt(0)
    s_barrier
    ds_read_b128 v[132:135], v4
    s_waitcnt lgkmcnt(0)
    v_max_u32 v136, v132, v133
    v_max_u32 v137, v134, v135
    v_min_u32 v138, v132, v133
    v_min_u32 v139, v134, v135
    v_min_u32 v133, v136, v137
    v_max_u32 v132, v136, v137
    v_max3_u32 v133, v133, v138, v139
    v_cndmask_b32 v4, v133, v132, s[22:23]
    v_readfirstlane_b32 s68, v132
    v_and_b32 v4, 3, v4
    v_readfirstlane_b32 s69, v133
    v_lshl_add_u32 v4, v4, 9, v131
    ds_read_b128 v[136:139], v4
    ds_read_b128 v[64:67], v128
    ds_read_b128 v[68:71], v128 offset:1152
    s_bfe_u32 s70, s68, 720899
    s_bfe_u32 s71, s69, 720899
    s_sub_u32 s70, 2047, s70
    s_sub_u32 s71, 2047, s71
    s_waitcnt lgkmcnt(2)
    v_mfma_f32_16x16x32_bf16 v[196:199], v[136:139], v[148:151], 0
    v_mfma_f32_16x16x32_bf16 v[200:203], v[136:139], v[152:155], 0
    v_mfma_f32_16x16x32_bf16 v[204:207], v[136:139], v[156:159], 0
    v_mfma_f32_16x16x32_bf16 v[208:211], v[136:139], v[160:163], 0
    v_mfma_f32_16x16x32_bf16 v[212:215], v[136:139], v[164:167], 0
    v_mfma_f32_16x16x32_bf16 v[216:219], v[136:139], v[168:171], 0
    v_mfma_f32_16x16x32_bf16 v[220:223], v[136:139], v[172:175], 0
    v_mfma_f32_16x16x32_bf16 v[224:227], v[136:139], v[176:179], 0
    s_nop 1
    v_add_f32 v132, v196, v201
    s_nop 0
    v_add_f32 v133, v206, v211
    s_nop 0
    v_add_f32 v134, v212, v217
    s_nop 0
    v_add_f32 v135, v222, v227
    v_add_f32 v132, v132, v133
    v_add_f32 v134, v134, v135
    v_mov_b32 v133, s4
    s_nop 0
    v_permlane16_swap_b32 v134, v135
    s_cmp_ge_u32 s9, 28
    s_cbranch_scc1 L_NOHP
    v_add_f32 v132, v132, v135
    s_mov_b32 exec_lo, 0xffff
    s_mov_b32 exec_hi, 0xffff
    s_cmp_lg_u32 s93, 0
    s_cbranch_scc1 LOC_45
    buffer_store_dwordx2 v[132:133], v8, s[32:35], s20 offen sc1
    s_branch LOCD_46
LOC_45:
    buffer_store_dwordx2 v[132:133], v8, s[32:35], s20 offen
LOCD_46:
    s_mov_b64 exec, -1
L_NOHP:
    v_mov_b32 v228, v132
    v_mov_b32 v229, v133
    v_add_u32 v230, s20, v8
    s_waitcnt lgkmcnt(0)
    s_bitcmp1_b32 s21, 2
    s_cselect_b32 s17, s71, s70
    s_cselect_b32 s18, s69, s68
    s_cmp_lg_u32 s3, 7
    s_cbranch_scc1 L_NOFZ
    s_cmp_lg_u32 s2, 0
    s_cbranch_scc1 L_NONON
    v_mov_b32 v6, s4
    s_mov_b64 exec, 1
    buffer_store_dword v6, v3, s[32:35], 0 offen sc1
    s_mov_b64 exec, -1
L_NONON:
    s_lshr_b32 s96, s21, 3
    s_and_b32 s97, s21, 1
    s_lshl1_add_u32 s19, s96, s97
    s_lshr_b32 s96, s21, 2
    s_lshl_b32 s97, s96, 1
    s_lshl3_add_u32 s98, s12, s97
    s_and_b32 s99, s21, 1
    s_add_u32 s96, s98, s99
    s_mul_i32 s97, s96, 7168
    s_add_u32 s20, s97, 22020096
    s_lshl_b32 s96, s17, 11
    s_lshl_b32 s97, s12, 7
    s_add_u32 s98, s96, s97
    s_lshl_b32 s99, s19, 5
    s_add_u32 s82, s98, s99
    v_and_b32 v10, 7, v1
    v_lshlrev_b32 v10, 2, v10
    s_lshl_b32 s96, s19, 5
    s_add_u32 s13, s96, 139264
    v_add_u32 v5, s13, v10
    ds_read_b32 v234, v5
    s_lshr_b32 s96, s17, 7
    s_bfe_u32 s97, s18, 65538
    s_lshl1_add_u32 s98, s96, s97
    s_lshl_b32 s99, s98, 14
    s_lshl_b32 s96, s12, 8
    s_add_u32 s97, s99, s96
    s_lshl_b32 s98, s19, 6
    s_add_u32 s99, s97, s98
    s_add_u32 s68, s99, 33554432
    s_add_u32 s69, s68, 4096
    v_and_b32 v11, 7, v1
    v_lshlrev_b32 v11, 3, v11
    buffer_load_dwordx2 v[20:21], v11, s[32:35], s68 offen sc1
    buffer_load_dwordx2 v[232:233], v11, s[32:35], s69 offen sc1
    s_and_b32 s13, s18, s6
    s_ashr_i32 s15, s13, 31
    s_andn2_b32 s15, 0x7fff0000, s15
    s_or_b32 s15, s15, 0x80000000
    s_xor_b32 s13, s13, s15
    v_mov_b32 v235, s13
    v_mul_f32 v235, s7, v235
    v_exp_f32 v235, -v235
    s_nop 0
    v_add_f32 v235, 1.0, v235
    v_rcp_f32 v235, v235
    s_nop 0
    v_cvt_pk_bf16_f32 v235, 0, v235
L_NOFZ:
    s_cmp_lt_u32 s9, 28
    s_cbranch_scc1 L_HSEC
    s_branch L_GSEC
L_HSEC:
    s_cmp_lt_u32 s3, 4
    s_cbranch_scc1 L_HW
    s_branch L_NOH
L_HW:
    s_lshl_b32 s96, s3, 8
    s_add_u32 s13, s96, s14
    v_lshrrev_b32 v4, 4, v1
    v_lshlrev_b32 v4, 11, v4
    v_and_b32 v9, 15, v1
    v_lshl_add_u32 v4, v9, 4, v4
    s_lshl_b32 s96, s3, 5
    s_add_u32 s15, s96, 138752
    v_lshrrev_b32 v5, 5, v1
    v_lshl_add_u32 v5, v5, 7, s15
    v_bfe_u32 v9, v1, 2, 1
    v_lshl_add_u32 v5, v9, 4, v5
    v_bfe_u32 v9, v1, 1, 1
    v_lshl_add_u32 v5, v9, 3, v5
    v_bfe_u32 v9, v1, 3, 1
    v_lshl_add_u32 v5, v9, 2, v5
    v_and_b32 v9, 1, v1
    v_lshl_add_u32 v5, v9, 1, v5
    s_cmp_lg_u32 s93, 0
    s_cbranch_scc1 L_HLOC
SPOLL_47:
    s_load_dword s24, s[32:33], s13 offset:1276 glc
    s_load_dword s25, s[32:33], s13 offset:3324 glc
    s_load_dword s26, s[32:33], s13 offset:5372 glc
    s_load_dword s27, s[32:33], s13 offset:7420 glc
SCHK_48:
    s_add_u32 s5, s5, 1
    s_cmp_ge_u32 s5, 300000
    s_waitcnt lgkmcnt(0)
    s_cbranch_scc1 SDONE_49
    s_cmp_lg_u32 s24, s4
    s_cbranch_scc1 SPOLL_47
    s_cmp_lg_u32 s25, s4
    s_cbranch_scc1 SPOLL_47
    s_cmp_lg_u32 s26, s4
    s_cbranch_scc1 SPOLL_47
    s_cmp_lg_u32 s27, s4
    s_cbranch_scc1 SPOLL_47
SDONE_49:
L_HLOC:
    buffer_load_dwordx4 v[196:199], v4, s[32:35], s13 offen sc1
    buffer_load_dwordx4 v[200:203], v4, s[32:35], s13 offen offset:1024 sc1
    s_waitcnt vmcnt(0)
    v_bitop3_b32 v6, v197, v199, s4 bitop3:0x7e
    v_bitop3_b32 v6, v6, v201, s4 bitop3:0xf6
    v_bitop3_b32 v6, v6, v203, s4 bitop3:0xf6
    v_cmp_ne_u32 vcc, 0, v6
    s_cbranch_vccz TOK_51
POLL_52:
    buffer_load_dwordx4 v[196:199], v4, s[32:35], s13 offen sc1
    buffer_load_dwordx4 v[200:203], v4, s[32:35], s13 offen offset:1024 sc1
    s_waitcnt vmcnt(0)
    v_bitop3_b32 v6, v197, v199, s4 bitop3:0x7e
    v_bitop3_b32 v6, v6, v201, s4 bitop3:0xf6
    v_bitop3_b32 v6, v6, v203, s4 bitop3:0xf6
    v_cmp_ne_u32 vcc, 0, v6
    s_cbranch_vccz PDONE_53
    s_add_u32 s5, s5, 1
    s_cmp_lt_u32 s5, 300000
    s_cbranch_scc1 POLL_52
PDONE_53:
TOK_51:
    v_permlane32_swap_b32 v196, v198
    v_permlane32_swap_b32 v200, v202
    v_add_f32 v196, v196, v198
    v_add_f32 v200, v200, v202
    v_mov_b32 v198, v196
    v_mov_b32 v202, v200
    s_nop 0
    v_permlane16_swap_b32 v196, v198
    v_permlane16_swap_b32 v200, v202
    v_add_f32 v196, v196, v198
    v_add_f32 v200, v200, v202
    v_cvt_pk_bf16_f32 v196, 0, v196
    v_cvt_pk_bf16_f32 v200, 0, v200
    v_mul_f32 v6, s7, v196
    v_exp_f32 v6, -v6
    s_nop 0
    v_add_f32 v6, 1.0, v6
    v_rcp_f32 v6, v6
    s_nop 0
    v_mul_f32 v196, v196, v6
    v_cvt_pk_bf16_f32 v196, 0, v196
    v_mul_f32 v196, v196, v200
    v_cvt_pk_bf16_f32 v196, v196, v196
    ds_write_b16 v5, v196
L_NOH:
    v_bfe_u32 v4, v1, 2, 1
    v_lshlrev_b32 v4, 7, v4
    v_lshrrev_b32 v9, 5, v1
    v_lshl_add_u32 v4, v9, 4, v4
    v_add_u32 v4, 138752, v4
    v_lshrrev_b32 v5, 4, v1
    v_mul_u32_u24 v5, 7168, v5
    v_and_b32 v9, 15, v1
    v_lshl_add_u32 v5, v9, 3, v5
    v_and_b32 v6, 1, v1
    v_lshlrev_b32 v6, 18, v6
    v_bfe_u32 v9, v1, 1, 1
    v_lshl_add_u32 v6, v9, 13, v6
    s_lshl3_add_u32 s96, s75, s3
    s_mul_i32 s97, s96, 28672
    s_lshl_b32 s98, s74, 7
    s_add_u32 s99, s97, s98
    s_add_u32 s13, s99, 22020096
    s_lshr_b32 s96, s9, 2
    s_and_b32 s97, s75, 1
    s_lshr_b32 s98, s3, 1
    s_lshl2_add_u32 s99, s97, s98
    s_and_b32 s97, s3, 1
    s_lshl_b32 s98, s97, 2
    s_lshl3_add_u32 s97, s99, s98
    s_lshr_b32 s99, s75, 1
    s_add_u32 s98, s97, s99
    s_lshl_b32 s97, s98, 12
    s_lshl_b32 s99, s8, 6
    s_add_u32 s98, s97, s99
    s_lshl2_add_u32 s97, s96, s98
    s_add_u32 s99, s97, 1048576
    s_add_u32 s14, s99, 3072
    s_waitcnt vmcnt(0)
    s_waitcnt lgkmcnt(0)
    s_barrier
    ds_read_b128 v[196:199], v4
    ds_read_b64_tr_b16 v[180:181], v130
    ds_read_b64_tr_b16 v[182:183], v130 offset:1024
    ds_read_b128 v[200:203], v4 offset:32
    ds_read_b64_tr_b16 v[184:185], v130 offset:8192
    ds_read_b64_tr_b16 v[186:187], v130 offset:9216
    ds_read_b128 v[204:207], v4 offset:64
    ds_read_b64_tr_b16 v[188:189], v130 offset:16384
    ds_read_b64_tr_b16 v[190:191], v130 offset:17408
    ds_read_b128 v[208:211], v4 offset:96
    ds_read_b64_tr_b16 v[192:193], v130 offset:24576
    ds_read_b64_tr_b16 v[194:195], v130 offset:25600
    s_waitcnt lgkmcnt(9)
    v_mfma_f32_32x32x16_bf16 v[212:227], v[196:199], v[180:183], 0
    s_waitcnt lgkmcnt(6)
    v_mfma_f32_32x32x16_bf16 v[212:227], v[200:203], v[184:187], v[212:227]
    s_waitcnt lgkmcnt(3)
    v_mfma_f32_32x32x16_bf16 v[212:227], v[204:207], v[188:191], v[212:227]
    s_waitcnt lgkmcnt(0)
    v_mfma_f32_32x32x16_bf16 v[212:227], v[208:211], v[192:195], v[212:227]
    s_nop 11
    v_mov_b32 v213, s4
    buffer_store_dwordx2 v[212:213], v5, s[32:35], s13 offen sc1
    s_mov_b64 exec, 15
    buffer_store_dword v213, v6, s[32:35], s14 offen sc1
    s_mov_b64 exec, -1
    s_mov_b32 exec_lo, 0xffff
    s_mov_b32 exec_hi, 0xffff
    buffer_store_dwordx2 v[228:229], v230, s[32:35], 0 offen sc1
    s_mov_b64 exec, -1
    s_waitcnt lgkmcnt(0)
L_GSEC:
    s_lshl_b32 s96, s21, 7
    s_lshl4_add_u32 s13, s3, s96
    v_lshrrev_b32 v22, 3, v1
    v_lshl_add_u32 v22, v22, 0, s13
    s_lshl_b32 s96, s13, 11
    s_lshl_b32 s97, s12, 7
    s_add_u32 s15, s96, s97
    s_add_u32 s16, s15, 16384
    v_lshrrev_b32 v23, 3, v1
    v_lshlrev_b32 v23, 11, v23
    v_and_b32 v9, 7, v1
    v_lshl_add_u32 v23, v9, 4, v23
    v_cmp_ne_u32 vcc, s70, v22
    v_cmp_ne_u32 s[22:23], s71, v22
    s_nop 0
    s_and_b64 exec, vcc, s[22:23]
    buffer_store_dwordx4 v[64:67], v23, s[64:67], s15 offen sc1
    s_mov_b64 exec, -1
    v_add_u32 v22, 8, v22
    v_cmp_ne_u32 vcc, s70, v22
    v_cmp_ne_u32 s[22:23], s71, v22
    s_nop 0
    s_and_b64 exec, vcc, s[22:23]
    buffer_store_dwordx4 v[68:71], v23, s[64:67], s16 offen sc1
    s_mov_b64 exec, -1
    s_cmp_ge_u32 s9, 16
    s_cbranch_scc1 L_FIN
SPOLL_54:
    s_load_dwordx8 s[24:31], s[32:33], s92 offset:3072 glc
SCHK_55:
    s_add_u32 s5, s5, 1
    s_cmp_ge_u32 s5, 300000
    s_waitcnt lgkmcnt(0)
    s_cbranch_scc1 SDONE_56
    s_cmp_lg_u32 s24, s4
    s_cbranch_scc1 SPOLL_54
    s_cmp_lg_u32 s25, s4
    s_cbranch_scc1 SPOLL_54
    s_cmp_lg_u32 s26, s4
    s_cbranch_scc1 SPOLL_54
    s_cmp_lg_u32 s27, s4
    s_cbranch_scc1 SPOLL_54
    s_cmp_lg_u32 s28, s4
    s_cbranch_scc1 SPOLL_54
    s_cmp_lg_u32 s29, s4
    s_cbranch_scc1 SPOLL_54
    s_cmp_lg_u32 s30, s4
    s_cbranch_scc1 SPOLL_54
SDONE_56:
    s_barrier
    s_cmp_lg_u32 s3, 7
    s_cbranch_scc1 L_FIN
    s_add_u32 s13, s20, 4096
POLL_57:
    buffer_load_dwordx4 v[196:199], v2, s[32:35], s20 offen sc1
    buffer_load_dwordx4 v[200:203], v2, s[32:35], s20 offen offset:1024 sc1
    buffer_load_dwordx4 v[204:207], v2, s[32:35], s20 offen offset:2048 sc1
    buffer_load_dwordx4 v[208:211], v2, s[32:35], s20 offen offset:3072 sc1
    buffer_load_dwordx4 v[132:135], v2, s[32:35], s13 offen sc1
    buffer_load_dwordx4 v[136:139], v2, s[32:35], s13 offen offset:1024 sc1
    buffer_load_dwordx4 v[140:143], v2, s[32:35], s13 offen offset:2048 sc1
    s_waitcnt vmcnt(0)
    v_bitop3_b32 v4, v197, v199, s4 bitop3:0x7e
    v_bitop3_b32 v4, v4, v201, s4 bitop3:0xf6
    v_bitop3_b32 v4, v4, v203, s4 bitop3:0xf6
    v_bitop3_b32 v4, v4, v205, s4 bitop3:0xf6
    v_bitop3_b32 v4, v4, v207, s4 bitop3:0xf6
    v_bitop3_b32 v4, v4, v209, s4 bitop3:0xf6
    v_bitop3_b32 v4, v4, v211, s4 bitop3:0xf6
    v_bitop3_b32 v4, v4, v133, s4 bitop3:0xf6
    v_bitop3_b32 v4, v4, v135, s4 bitop3:0xf6
    v_bitop3_b32 v4, v4, v137, s4 bitop3:0xf6
    v_bitop3_b32 v4, v4, v139, s4 bitop3:0xf6
    v_bitop3_b32 v4, v4, v141, s4 bitop3:0xf6
    v_bitop3_b32 v4, v4, v143, s4 bitop3:0xf6
    v_cmp_ne_u32 vcc, 0, v4
    s_cbranch_vccz PDONE_58
    s_add_u32 s5, s5, 1
    s_cmp_lt_u32 s5, 300000
    s_cbranch_scc1 POLL_57
PDONE_58:
    v_bitop3_b32 v4, v21, v233, s4 bitop3:0x7e
    v_cmp_ne_u32 vcc, 0, v4
    s_cbranch_vccz TOK_59
POLL_60:
    buffer_load_dwordx2 v[20:21], v11, s[32:35], s68 offen sc1
    buffer_load_dwordx2 v[232:233], v11, s[32:35], s69 offen sc1
    s_waitcnt vmcnt(0)
    v_bitop3_b32 v4, v21, v233, s4 bitop3:0x7e
    v_cmp_ne_u32 vcc, 0, v4
    s_cbranch_vccz PDONE_61
    s_add_u32 s5, s5, 1
    s_cmp_lt_u32 s5, 300000
    s_cbranch_scc1 POLL_60
PDONE_61:
TOK_59:
    v_add_f32 v196, v196, v200
    v_add_f32 v198, v198, v202
    v_add_f32 v196, v196, v204
    v_add_f32 v198, v198, v206
    v_add_f32 v196, v196, v208
    v_add_f32 v198, v198, v210
    v_add_f32 v196, v196, v132
    v_add_f32 v198, v198, v134
    v_add_f32 v196, v196, v136
    v_add_f32 v198, v198, v138
    v_add_f32 v196, v196, v140
    v_add_f32 v198, v198, v142
    v_mov_b32 v197, v198
    v_add_f32_dpp v196, v196, v196 row_ror:8 row_mask:0xf bank_mask:0xf
    s_nop 0
    v_add_f32_dpp v197, v197, v197 row_ror:8 row_mask:0xf bank_mask:0xf
    v_mov_b32 v198, v196
    v_mov_b32 v199, v197
    s_nop 0
    v_permlane16_swap_b32 v196, v198
    v_permlane16_swap_b32 v197, v199
    v_pk_add_f32 v[196:197], v[196:197], v[198:199]
    v_mov_b32 v198, v196
    v_mov_b32 v199, v197
    s_nop 0
    v_permlane32_swap_b32 v196, v198
    v_permlane32_swap_b32 v197, v199
    v_pk_add_f32 v[196:197], v[196:197], v[198:199]
    v_cvt_pk_bf16_f32 v196, 0, v196
    v_cvt_pk_bf16_f32 v197, 0, v197
    v_pk_mul_f32 v[196:197], v[196:197], v[234:235] op_sel:[0,1]
    v_lshlrev_b32 v4, 16, v20
    v_and_b32 v5, s6, v20
    v_cvt_pk_bf16_f32 v196, 0, v196
    v_cvt_pk_bf16_f32 v197, 0, v197
    v_pk_add_f32 v[196:197], v[196:197], v[4:5]
    v_lshlrev_b32 v4, 16, v234
    v_and_b32 v5, s6, v234
    v_cvt_pk_bf16_f32 v196, 0, v196
    v_cvt_pk_bf16_f32 v197, 0, v197
    v_pk_mul_f32 v[196:197], v[196:197], v[4:5]
    v_lshlrev_b32 v4, 16, v232
    v_and_b32 v5, s6, v232
    v_cvt_pk_bf16_f32 v196, 0, v196
    v_cvt_pk_bf16_f32 v197, 0, v197
    v_pk_add_f32 v[196:197], v[196:197], v[4:5]
    v_cvt_pk_bf16_f32 v196, v196, v197
    s_mov_b64 exec, 0xff
    buffer_store_dword v196, v10, s[64:67], s82 offen sc1
    s_mov_b64 exec, -1
L_FIN:
L_END:
    s_endpgm
.p2align 10
.fill 768, 4, 0xbf800000
.section .rodata,"a"
.p2align 6
.amdhsa_kernel adaLN_cond__linear_kernel_hedgehog__moe_arch_mod__prompt_kernel
  .amdhsa_next_free_vgpr 256
  .amdhsa_next_free_sgpr 102
  .amdhsa_accum_offset 256
  .amdhsa_group_segment_fixed_size 0
  .amdhsa_kernarg_size 112
  .amdhsa_user_sgpr_count 2
  .amdhsa_user_sgpr_kernarg_segment_ptr 1
  .amdhsa_system_sgpr_workgroup_id_x 1
  .amdhsa_float_denorm_mode_32 3
  .amdhsa_float_denorm_mode_16_64 3
.end_amdhsa_kernel
```

```asm
; @launch grid=(256,1,1) block=(512,1,1) lds=163840
.amdgcn_target "amdgcn-amd-amdhsa--gfx950"
.text
.globl adaLN_cond__linear_kernel_hedgehog__moe_arch_mod__prompt_kernel
.p2align 8
.type adaLN_cond__linear_kernel_hedgehog__moe_arch_mod__prompt_kernel,@function
adaLN_cond__linear_kernel_hedgehog__moe_arch_mod__prompt_kernel:
    s_load_dwordx16 s[68:83], s[0:1], 0
    s_load_dwordx8 s[84:91], s[0:1], 64
    s_load_dwordx2 s[32:33], s[0:1], 104
    s_load_dwordx2 s[30:31], s[0:1], 96
    s_cmp_ge_u32 s2, 256
    s_cbranch_scc1 L_END
    v_lshrrev_b32 v4, 6, v0
    v_and_b32 v1, 63, v0
    v_mov_b32 v3, 0
    v_readfirstlane_b32 s3, v4
    v_lshlrev_b32 v2, 4, v1
    s_and_b32 s8, s2, 7
    s_lshr_b32 s9, s2, 3
    s_lshl2_add_u32 s96, s8, s3
    s_lshl_b32 s15, s96, 6
    s_mul_i32 s96, s15, 6144
    s_xor_b32 s97, s9, 1
    s_lshl_b32 s98, s97, 7
    s_add_u32 s13, s96, s98
    v_lshrrev_b32 v60, 3, v1
    v_mul_u32_u24 v60, 49152, v60
    v_and_b32 v9, 7, v1
    v_lshl_add_u32 v60, v9, 4, v60
    v_lshrrev_b32 v61, 3, v1
    v_lshl_add_u32 v61, v61, 3, s15
    s_lshl_b32 s96, s8, 5
    s_add_u32 s97, s96, s9
    s_lshl2_add_u32 s98, s97, s3
    s_sub_u32 s99, s98, 4
    s_lshl_b32 s16, s99, 12
    s_mov_b32 s50, 12582912
    s_mov_b32 s51, 0x20000
    s_mov_b32 s38, 4194304
    s_mov_b32 s39, 0x20000
    s_mov_b32 s34, 268435456
    s_mov_b32 s35, 0x20000
    s_getreg_b32 s94, hwreg(HW_REG_XCC_ID, 0, 3)
    s_getpc_b64 s[22:23]
    s_mul_i32 s96, s9, 7
    s_add_u32 s97, s96, s3
    s_lshl_b32 s19, s97, 7
    v_lshrrev_b32 v10, 5, v1
    v_mul_u32_u24 v10, 28672, v10
    v_add_u32 v10, s19, v10
    v_min_u32 v10, 44032, v10
    s_cmp_ge_u32 s3, 4
    s_waitcnt lgkmcnt(0)
    s_mov_b64 s[48:49], s[88:89]
    s_mov_b64 s[36:37], s[68:69]
    s_load_dword s4, s[32:33], 0
    s_cbranch_scc1 L_FS
    global_load_dwordx2 v[96:97], v61, s[86:87]
    buffer_load_dwordx4 v[80:83], v60, s[48:51], s13 offen nt
    s_add_u32 s13, s13, 12288
    buffer_load_dwordx4 v[84:87], v60, s[48:51], s13 offen nt
    s_add_u32 s13, s13, 12288
    buffer_load_dwordx4 v[88:91], v60, s[48:51], s13 offen nt
    s_add_u32 s13, s13, 12288
    buffer_load_dwordx4 v[92:95], v60, s[48:51], s13 offen nt
    s_barrier
    s_barrier
    s_and_b32 s22, s22, 0xfffffc00
    global_load_dword v78, v10, s[22:23]
    s_mov_b32 s42, 6291456
    s_mov_b32 s43, 0x20000
    s_mov_b32 s46, 2097152
    s_mov_b32 s47, 0x20000
    s_mov_b32 s54, 7340032
    s_mov_b32 s55, 0x20000
    s_mov_b32 s58, 7340032
    s_mov_b32 s59, 0x20000
    s_mov_b32 s62, 7340032
    s_mov_b32 s63, 0x20000
    s_mov_b32 s66, 4194304
    s_mov_b32 s67, 0x20000
    s_mov_b64 s[40:41], s[70:71]
    s_mov_b64 s[44:45], s[74:75]
    s_mov_b64 s[52:53], s[80:81]
    s_mov_b64 s[56:57], s[82:83]
    s_mov_b64 s[60:61], s[84:85]
    s_mov_b64 s[64:65], s[90:91]
    s_mov_b32 s5, 0
    s_mov_b32 s6, 0xffff0000
    s_mov_b32 s7, 0x3fb8aa3b
    s_lshr_b32 s76, s3, 2
    v_bfe_u32 v6, v1, 4, 1
    v_lshlrev_b32 v6, 6, v6
    v_and_b32 v62, 7, v1
    v_lshlrev_b32 v62, 4, v62
    v_xor_b32 v62, v62, v6
    v_lshrrev_b32 v6, 3, v1
    v_mul_u32_u24 v6, 6144, v6
    v_add_u32 v62, v62, v6
    v_lshlrev_b32 v63, 3, v1
    v_add_u32 v64, 149760, v2
    s_and_b32 s96, s3, 3
    s_lshl2_add_u32 s13, s96, 149760
    v_lshrrev_b32 v65, 4, v1
    v_lshl_add_u32 v65, v65, 5, s13
    v_and_b32 v9, 7, v1
    v_lshl_add_u32 v65, v9, 7, v65
    v_bfe_u32 v9, v1, 3, 1
    v_lshl_add_u32 v65, v9, 4, v65
    s_and_b32 s96, s8, 6
    s_and_b32 s97, s8, 1
    s_lshr_b32 s98, s9, 4
    s_lshl1_add_u32 s99, s97, s98
    s_lshl_b32 s97, s99, 6
    s_add_u32 s98, s96, s97
    s_lshl3_add_u32 s99, s3, s98
    s_lshl_b32 s96, s99, 10
    s_and_b32 s97, s9, 15
    s_lshl_b32 s98, s97, 6
    s_add_u32 s99, s96, s98
    s_add_u32 s14, s99, 262144
    s_xor_b32 s96, s9, 1
    s_and_b32 s97, s96, 15
    s_lshl4_add_u32 s98, s3, s97
    s_lshr_b32 s99, s9, 4
    s_lshl1_add_u32 s96, s98, s99
    s_lshl3_add_u32 s97, s96, s8
    s_lshl_b32 s98, s97, 9
    s_add_u32 s13, s98, 524288
    s_lshr_b32 s96, s9, 4
    s_xor_b32 s97, s9, 1
    s_and_b32 s98, s97, 7
    s_lshl_b32 s99, s3, 1
    s_lshl3_add_u32 s97, s98, s99
    s_bfe_u32 s98, s9, 65539
    s_add_u32 s99, s97, s98
    s_lshl_b32 s97, s99, 9
    s_lshl_b32 s98, s8, 6
    s_add_u32 s99, s97, s98
    s_lshl2_add_u32 s97, s96, s99
    s_add_u32 s15, s97, 2097152
    v_and_b32 v10, 3, v1
    v_lshlrev_b32 v10, 15, v10
    s_waitcnt vmcnt(5)
    v_lshlrev_b32 v98, 16, v97
    v_and_b32 v99, s6, v97
    v_and_b32 v97, s6, v96
    v_lshlrev_b32 v96, 16, v96
    v_mul_f32 v4, s7, v96
    v_exp_f32 v4, -v4
    s_nop 0
    v_add_f32 v4, 1.0, v4
    v_rcp_f32 v4, v4
    s_nop 0
    v_mul_f32 v96, v96, v4
    v_cvt_pk_bf16_f32 v96, 0, v96
    v_mul_f32 v5, s7, v97
    v_exp_f32 v5, -v5
    s_nop 0
    v_add_f32 v5, 1.0, v5
    v_rcp_f32 v5, v5
    s_nop 0
    v_mul_f32 v97, v97, v5
    v_cvt_pk_bf16_f32 v97, 0, v97
    v_mul_f32 v4, s7, v98
    v_exp_f32 v4, -v4
    s_nop 0
    v_add_f32 v4, 1.0, v4
    v_rcp_f32 v4, v4
    s_nop 0
    v_mul_f32 v98, v98, v4
    v_cvt_pk_bf16_f32 v98, 0, v98
    v_mul_f32 v5, s7, v99
    v_exp_f32 v5, -v5
    s_nop 0
    v_add_f32 v5, 1.0, v5
    v_rcp_f32 v5, v5
    s_nop 0
    v_mul_f32 v99, v99, v5
    v_cvt_pk_bf16_f32 v99, 0, v99
    s_waitcnt vmcnt(4)
    v_lshlrev_b32 v4, 16, v80
    v_and_b32 v5, s6, v80
    v_pk_mul_f32 v[20:21], v[4:5], v[96:97] op_sel:[0,0] op_sel_hi:[1,0]
    v_lshlrev_b32 v6, 16, v81
    v_and_b32 v7, s6, v81
    v_pk_mul_f32 v[22:23], v[6:7], v[96:97] op_sel:[0,0] op_sel_hi:[1,0]
    v_lshlrev_b32 v4, 16, v82
    v_and_b32 v5, s6, v82
    v_pk_mul_f32 v[24:25], v[4:5], v[96:97] op_sel:[0,0] op_sel_hi:[1,0]
    v_lshlrev_b32 v6, 16, v83
    v_and_b32 v7, s6, v83
    v_pk_mul_f32 v[26:27], v[6:7], v[96:97] op_sel:[0,0] op_sel_hi:[1,0]
    s_waitcnt vmcnt(3)
    v_lshlrev_b32 v4, 16, v84
    v_and_b32 v5, s6, v84
    v_pk_fma_f32 v[20:21], v[4:5], v[96:97], v[20:21] op_sel:[0,1,0] op_sel_hi:[1,1,1]
    v_lshlrev_b32 v6, 16, v85
    v_and_b32 v7, s6, v85
    v_pk_fma_f32 v[22:23], v[6:7], v[96:97], v[22:23] op_sel:[0,1,0] op_sel_hi:[1,1,1]
    v_lshlrev_b32 v4, 16, v86
    v_and_b32 v5, s6, v86
    v_pk_fma_f32 v[24:25], v[4:5], v[96:97], v[24:25] op_sel:[0,1,0] op_sel_hi:[1,1,1]
    v_lshlrev_b32 v6, 16, v87
    v_and_b32 v7, s6, v87
    v_pk_fma_f32 v[26:27], v[6:7], v[96:97], v[26:27] op_sel:[0,1,0] op_sel_hi:[1,1,1]
    s_waitcnt vmcnt(2)
    v_lshlrev_b32 v4, 16, v88
    v_and_b32 v5, s6, v88
    v_pk_fma_f32 v[20:21], v[4:5], v[98:99], v[20:21] op_sel:[0,0,0] op_sel_hi:[1,0,1]
    v_lshlrev_b32 v6, 16, v89
    v_and_b32 v7, s6, v89
    v_pk_fma_f32 v[22:23], v[6:7], v[98:99], v[22:23] op_sel:[0,0,0] op_sel_hi:[1,0,1]
    v_lshlrev_b32 v4, 16, v90
    v_and_b32 v5, s6, v90
    v_pk_fma_f32 v[24:25], v[4:5], v[98:99], v[24:25] op_sel:[0,0,0] op_sel_hi:[1,0,1]
    v_lshlrev_b32 v6, 16, v91
    v_and_b32 v7, s6, v91
    v_pk_fma_f32 v[26:27], v[6:7], v[98:99], v[26:27] op_sel:[0,0,0] op_sel_hi:[1,0,1]
    s_waitcnt vmcnt(1)
    v_lshlrev_b32 v4, 16, v92
    v_and_b32 v5, s6, v92
    v_pk_fma_f32 v[20:21], v[4:5], v[98:99], v[20:21] op_sel:[0,1,0] op_sel_hi:[1,1,1]
    v_lshlrev_b32 v6, 16, v93
    v_and_b32 v7, s6, v93
    v_pk_fma_f32 v[22:23], v[6:7], v[98:99], v[22:23] op_sel:[0,1,0] op_sel_hi:[1,1,1]
    v_lshlrev_b32 v4, 16, v94
    v_and_b32 v5, s6, v94
    v_pk_fma_f32 v[24:25], v[4:5], v[98:99], v[24:25] op_sel:[0,1,0] op_sel_hi:[1,1,1]
    v_lshlrev_b32 v6, 16, v95
    v_and_b32 v7, s6, v95
    v_pk_fma_f32 v[26:27], v[6:7], v[98:99], v[26:27] op_sel:[0,1,0] op_sel_hi:[1,1,1]
    v_permlane32_swap_b32 v20, v24
    v_permlane32_swap_b32 v21, v25
    v_permlane32_swap_b32 v22, v26
    v_permlane32_swap_b32 v23, v27
    v_add_f32 v20, v20, v24
    v_add_f32 v21, v21, v25
    v_add_f32 v22, v22, v26
    v_add_f32 v23, v23, v27
    s_nop 0
    v_permlane16_swap_b32 v20, v22
    v_permlane16_swap_b32 v21, v23
    v_add_f32 v20, v20, v22
    v_add_f32 v21, v21, v23
    s_nop 0
    v_add_f32_dpp v20, v20, v20 row_ror:8 row_mask:0xf bank_mask:0xf
    v_add_f32_dpp v21, v21, v21 row_ror:8 row_mask:0xf bank_mask:0xf
    s_nop 1
    v_mov_b32_dpp v20, v21 quad_perm:[0,1,2,3] row_mask:0xf bank_mask:0xc
    ds_write_b32 v65, v20
    s_waitcnt lgkmcnt(0)
    s_barrier
    ds_read_b128 v[20:23], v64 offset:0
    s_mul_i32 s4, s4, 0x9e3779b1
    s_add_u32 s4, s4, 0x7f4a7c15
    s_waitcnt lgkmcnt(0)
    v_pk_add_f32 v[20:21], v[20:21], v[22:23]
    v_add_f32 v20, v20, v21
    v_mov_b32 v21, s4
    buffer_store_dwordx2 v[20:21], v63, s[32:35], s13 offen sc1
    s_mov_b64 exec, 15
    buffer_store_dword v21, v10, s[32:35], s15 offen sc1
    s_mov_b64 exec, -1
    s_lshl2_add_u32 s96, s2, s3
    s_mul_i32 s13, s96, 6144
    s_branch L_FJ
L_FS:
    s_barrier
    buffer_load_dwordx4 v[80:83], v2, s[36:39], s16 offen
    buffer_load_dwordx4 v[84:87], v2, s[36:39], s16 offen offset:1024
    buffer_load_dwordx4 v[88:91], v2, s[36:39], s16 offen offset:2048
    buffer_load_dwordx4 v[92:95], v2, s[36:39], s16 offen offset:3072
    s_lshl2_add_u32 s96, s2, s3
    s_sub_u32 s97, s96, 4
    s_lshl_b32 s98, s97, 7
    s_add_u32 s17, s98, 2097152
    s_load_dword s24, s[32:33], s17 offset:0 glc
    s_load_dword s25, s[32:33], s17 offset:64 glc
    s_lshl_b32 s96, s2, 5
    s_add_u32 s97, s96, s3
    s_sub_u32 s98, s97, 4
    s_lshl_b32 s99, s98, 7
    s_add_u32 s17, s99, 1048576
    s_load_dword s24, s[32:33], s17 offset:0 glc
    s_load_dword s25, s[32:33], s17 offset:64 glc
    s_lshl_b32 s19, s94, 5
    v_mov_b32 v78, 1
    v_mov_b32 v79, s19
    s_barrier
    s_cmp_lg_u32 s3, 7
    s_cbranch_scc1 L_NOTK
    s_mov_b64 exec, 1
    global_atomic_add v78, v79, v78, s[30:31] sc0 sc1
    s_mov_b64 exec, -1
    s_branch L_TK0
L_NOTK:
    s_and_b32 s22, s22, 0xfffffc00
    global_load_dword v78, v10, s[22:23]
L_TK0:
    s_mov_b32 s42, 6291456
    s_mov_b32 s43, 0x20000
    s_mov_b32 s46, 2097152
    s_mov_b32 s47, 0x20000
    s_mov_b32 s54, 7340032
    s_mov_b32 s55, 0x20000
    s_mov_b32 s58, 7340032
    s_mov_b32 s59, 0x20000
    s_mov_b32 s62, 7340032
    s_mov_b32 s63, 0x20000
    s_mov_b32 s66, 4194304
    s_mov_b32 s67, 0x20000
    s_mov_b64 s[40:41], s[70:71]
    s_mov_b64 s[44:45], s[74:75]
    s_mov_b64 s[52:53], s[80:81]
    s_mov_b64 s[56:57], s[82:83]
    s_mov_b64 s[60:61], s[84:85]
    s_mov_b64 s[64:65], s[90:91]
    s_mov_b32 s5, 0
    s_mov_b32 s6, 0xffff0000
    s_mov_b32 s7, 0x3fb8aa3b
    s_lshr_b32 s76, s3, 2
    v_bfe_u32 v6, v1, 4, 1
    v_lshlrev_b32 v6, 6, v6
    v_and_b32 v62, 7, v1
    v_lshlrev_b32 v62, 4, v62
    v_xor_b32 v62, v62, v6
    v_lshrrev_b32 v6, 3, v1
    v_mul_u32_u24 v6, 6144, v6
    v_add_u32 v62, v62, v6
    v_lshlrev_b32 v63, 3, v1
    v_add_u32 v64, 149760, v2
    s_and_b32 s96, s3, 3
    s_lshl2_add_u32 s13, s96, 149760
    v_lshrrev_b32 v65, 4, v1
    v_lshl_add_u32 v65, v65, 5, s13
    v_and_b32 v9, 7, v1
    v_lshl_add_u32 v65, v9, 7, v65
    v_bfe_u32 v9, v1, 3, 1
    v_lshl_add_u32 v65, v9, 4, v65
    s_and_b32 s96, s8, 6
    s_and_b32 s97, s8, 1
    s_lshr_b32 s98, s9, 4
    s_lshl1_add_u32 s99, s97, s98
    s_lshl_b32 s97, s99, 6
    s_add_u32 s98, s96, s97
    s_lshl3_add_u32 s99, s3, s98
    s_lshl_b32 s96, s99, 10
    s_and_b32 s97, s9, 15
    s_lshl_b32 s98, s97, 6
    s_add_u32 s99, s96, s98
    s_add_u32 s14, s99, 262144
    s_sub_u32 s96, s3, 4
    s_lshl4_add_u32 s13, s96, 151808
    v_lshrrev_b32 v10, 5, v1
    v_lshl_add_u32 v10, v10, 3, s13
    s_barrier
    s_waitcnt vmcnt(1)
    s_waitcnt lgkmcnt(0)
    s_mul_i32 s4, s4, 0x9e3779b1
    s_add_u32 s4, s4, 0x7f4a7c15
    v_mov_b32 v104, 0x3f803f80
    v_dot2_f32_bf16 v100, v80, v104, 0
    v_dot2_f32_bf16 v102, v80, v80, 0
    v_dot2_f32_bf16 v101, v88, v104, 0
    v_dot2_f32_bf16 v103, v88, v88, 0
    v_dot2_f32_bf16 v100, v81, v104, v100
    v_dot2_f32_bf16 v102, v81, v81, v102
    v_dot2_f32_bf16 v101, v89, v104, v101
    v_dot2_f32_bf16 v103, v89, v89, v103
    v_dot2_f32_bf16 v100, v82, v104, v100
    v_dot2_f32_bf16 v102, v82, v82, v102
    v_dot2_f32_bf16 v101, v90, v104, v101
    v_dot2_f32_bf16 v103, v90, v90, v103
    v_dot2_f32_bf16 v100, v83, v104, v100
    v_dot2_f32_bf16 v102, v83, v83, v102
    v_dot2_f32_bf16 v101, v91, v104, v101
    v_dot2_f32_bf16 v103, v91, v91, v103
    v_dot2_f32_bf16 v100, v84, v104, v100
    v_dot2_f32_bf16 v102, v84, v84, v102
    v_dot2_f32_bf16 v101, v92, v104, v101
    v_dot2_f32_bf16 v103, v92, v92, v103
    v_dot2_f32_bf16 v100, v85, v104, v100
    v_dot2_f32_bf16 v102, v85, v85, v102
    v_dot2_f32_bf16 v101, v93, v104, v101
    v_dot2_f32_bf16 v103, v93, v93, v103
    v_dot2_f32_bf16 v100, v86, v104, v100
    v_dot2_f32_bf16 v102, v86, v86, v102
    v_dot2_f32_bf16 v101, v94, v104, v101
    v_dot2_f32_bf16 v103, v94, v94, v103
    v_dot2_f32_bf16 v100, v87, v104, v100
    v_dot2_f32_bf16 v102, v87, v87, v102
    v_dot2_f32_bf16 v101, v95, v104, v101
    v_dot2_f32_bf16 v103, v95, v95, v103
    s_nop 1
    v_permlane32_swap_b32 v100, v101
    v_permlane32_swap_b32 v102, v103
    v_add_f32 v100, v100, v101
    v_add_f32 v102, v102, v103
    s_nop 1
    v_permlane16_swap_b32 v100, v102
    v_add_f32 v100, v100, v102
    s_nop 1
    v_add_f32_dpp v100, v100, v100 quad_perm:[1,0,3,2] row_mask:0xf bank_mask:0xf
    s_nop 1
    v_add_f32_dpp v100, v100, v100 quad_perm:[2,3,0,1] row_mask:0xf bank_mask:0xf
    s_nop 1
    v_add_f32_dpp v100, v100, v100 row_half_mirror row_mask:0xf bank_mask:0xf
    s_nop 1
    v_add_f32_dpp v100, v100, v100 row_ror:8 row_mask:0xf bank_mask:0xf
    v_mul_f32 v102, 0x3a800000, v100
    v_mul_f32 v100, 0x3a800000, v100
    s_nop 1
    v_permlane16_swap_b32 v100, v102
    v_fma_f32 v117, -v100, v100, v102
    v_cvt_pk_bf16_f32 v116, 0, v100
    v_max_f32 v117, 0, v117
    v_cvt_pk_bf16_f32 v117, 0, v117
    v_add_f32 v117, 0x3727c5ac, v117
    v_cvt_pk_bf16_f32 v117, 0, v117
    v_sqrt_f32 v117, v117
    s_nop 0
    v_cvt_pk_bf16_f32 v117, 0, v117
    v_lshrrev_b32 v116, 16, v116
    v_or_b32 v116, v116, v117
    v_mov_b32 v117, s4
    ds_write_b64 v10, v[116:117]
L_FJ:
    v_and_b32 v5, 3, v1
    v_lshlrev_b32 v5, 4, v5
    v_add_u32 v5, 151808, v5
    v_and_b32 v4, 3, v1
    v_lshlrev_b32 v4, 4, v4
    v_bfe_u32 v9, v1, 2, 1
    v_lshl_add_u32 v4, v9, 10, v4
    v_and_b32 v10, 31, v1
    v_lshlrev_b32 v10, 11, v10
    v_lshrrev_b32 v9, 5, v1
    v_lshl_add_u32 v10, v9, 5, v10
    v_and_b32 v6, 1, v1
    v_lshlrev_b32 v6, 9, v6
    s_and_b32 s96, s9, 1
    s_and_b32 s97, s8, 6
    s_and_b32 s98, s8, 1
    s_lshr_b32 s99, s9, 4
    s_lshl1_add_u32 s98, s98, s99
    s_lshl_b32 s99, s98, 6
    s_add_u32 s98, s97, s99
    s_lshl3_add_u32 s97, s3, s98
    s_lshl_b32 s99, s97, 9
    s_bfe_u32 s98, s9, 196609
    s_lshl_b32 s97, s98, 6
    s_add_u32 s98, s99, s97
    s_lshl2_add_u32 s99, s96, s98
    s_add_u32 s97, s99, 8
    s_add_u32 s15, s97, 2097152
    s_waitcnt lgkmcnt(0)
    s_barrier
    ds_read_b128 v[116:119], v5
    s_waitcnt lgkmcnt(0)
    s_mov_b64 exec, 0xff
    buffer_store_dwordx4 v[116:119], v4, s[32:35], s14 offen sc1
    s_mov_b64 exec, 3
    buffer_store_dword v117, v6, s[32:35], s15 offen sc1
    s_mov_b64 exec, -1
    s_cmp_lg_u32 s3, 7
    s_cbranch_scc1 L_NOTK2
    s_mov_b32 s13, 0
    s_waitcnt vmcnt(2)
L_TK:
    v_readfirstlane_b32 s15, v78
    s_nop 0
    s_cmp_lt_u32 s15, 32
    s_cbranch_scc1 L_TKOK
    v_mov_b32 v78, s4
    s_mov_b64 exec, 1
    buffer_store_dword v78, v3, s[32:35], 0 offen offset:256 sc1
    s_mov_b64 exec, -1
    s_add_u32 s13, s13, 1
    s_cmp_lt_u32 s13, 8
    s_cbranch_scc0 L_TKNO
    s_add_u32 s94, s94, 1
    s_and_b32 s94, s94, 7
    s_lshl_b32 s19, s94, 5
    v_mov_b32 v78, 1
    v_mov_b32 v79, s19
    s_mov_b64 exec, 1
    global_atomic_add v78, v79, v78, s[30:31] sc0 sc1
    s_mov_b64 exec, -1
    s_waitcnt vmcnt(0)
    s_branch L_TK
L_TKNO:
    s_and_b32 s94, s2, 7
    s_lshr_b32 s15, s2, 3
L_TKOK:
    s_lshl3_add_u32 s15, s15, s94
    v_mov_b32 v78, s15
    ds_write_b32 v5, v78 offset:64
L_NOTK2:
    s_waitcnt lgkmcnt(0)
    s_barrier
    ds_read_b32 v120, v5 offset:64
    s_waitcnt lgkmcnt(0)
    v_readfirstlane_b32 s2, v120
    s_nop 0
    s_and_b32 s8, s2, 7
    s_lshr_b32 s9, s2, 3
    s_and_b32 s96, s8, 1
    s_and_b32 s97, s9, 7
    s_lshl3_add_u32 s12, s96, s97
    s_lshr_b32 s96, s8, 1
    s_lshr_b32 s97, s9, 3
    s_lshl2_add_u32 s21, s96, s97
    s_and_b32 s96, s3, 3
    s_lshl2_add_u32 s94, s21, s96
    s_lshl1_add_u32 s95, s12, s76
    s_lshl_b32 s96, s94, 16
    s_lshl_b32 s97, s95, 6
    s_add_u32 s18, s96, s97
    buffer_load_dwordx4 v[12:15], v10, s[36:39], s18 offen
    buffer_load_dwordx4 v[16:19], v10, s[36:39], s18 offen offset:16
    s_lshr_b32 s96, s8, 1
    s_lshl4_add_u32 s97, s96, s12
    s_lshl4_add_u32 s98, s97, s3
    s_lshl_b32 s99, s98, 9
    s_add_u32 s13, s99, 524288
    s_lshl3_add_u32 s96, s2, s3
    s_lshl_b32 s97, s96, 6
    s_add_u32 s15, s97, 2097152
    s_and_b32 s96, s3, 3
    s_lshl2_add_u32 s97, s2, s96
    s_lshl_b32 s98, s97, 8
    s_add_u32 s14, s98, 262144
    s_load_dwordx4 s[24:27], s[32:33], s15 offset:0 glc
    s_and_b32 s96, s8, 4
    s_lshr_b32 s97, s9, 2
    s_lshl1_add_u32 s10, s96, s97
    s_and_b32 s96, s8, 3
    s_and_b32 s97, s9, 3
    s_xor_b32 s98, s97, 2
    s_lshl2_add_u32 s11, s96, s98
    s_and_b32 s85, s9, 12
    s_lshl_b32 s96, s2, 6
    s_add_u32 s97, s96, s3
    s_lshl_b32 s98, s97, 6
    s_add_u32 s92, s98, 1048576
    s_lshr_b32 s96, s9, 4
    s_xor_b32 s77, s76, s96
    s_lshr_b32 s96, s9, 3
    s_xor_b32 s97, s96, s9
    s_and_b32 s98, s97, 1
    s_lshl_b32 s83, s98, 3
    s_mul_i32 s96, s8, 7
    s_lshr_b32 s97, s9, 2
    s_add_u32 s74, s96, s97
    s_and_b32 s75, s9, 3
    v_and_b32 v8, 31, v1
    v_lshlrev_b32 v8, 3, v8
    v_and_b32 v4, 31, v1
    v_lshlrev_b32 v4, 4, v4
    v_lshrrev_b32 v9, 5, v1
    v_lshl_add_u32 v4, v9, 12, v4
    s_lshl2_add_u32 s16, s3, 152320
    v_lshl_add_u32 v5, v1, 6, s16
    s_lshl_b32 s96, s76, 10
    s_add_u32 s16, s96, 152320
    v_and_b32 v6, 15, v1
    v_lshl_add_u32 v6, v6, 5, s16
    v_lshrrev_b32 v9, 5, v1
    v_lshl_add_u32 v6, v9, 9, v6
    s_branch SCHK_2
SPOLL_1:
    s_load_dwordx4 s[24:27], s[32:33], s15 offset:0 glc
SCHK_2:
    s_add_u32 s5, s5, 1
    s_cmp_ge_u32 s5, 300000
    s_waitcnt lgkmcnt(0)
    s_cbranch_scc1 SDONE_3
    s_cmp_lg_u32 s24, s4
    s_cbranch_scc1 SPOLL_1
    s_cmp_lg_u32 s25, s4
    s_cbranch_scc1 SPOLL_1
    s_cmp_lg_u32 s26, s4
    s_cbranch_scc1 SPOLL_1
    s_cmp_lg_u32 s27, s4
    s_cbranch_scc1 SPOLL_1
SDONE_3:
    s_barrier
    buffer_load_dwordx4 v[120:123], v4, s[32:35], s13 offen sc1
    buffer_load_dwordx2 v[116:117], v8, s[32:35], s14 offen sc1
    s_lshl_b32 s96, s11, 12
    s_lshl_b32 s97, s3, 9
    s_add_u32 s16, s96, s97
    v_add_u32 v10, s16, v2
    s_lshl_b32 s96, s3, 9
    s_add_u32 m0, s96, 156416
    s_mov_b32 exec_hi, 0
    global_load_lds_dwordx4 v10, s[72:73]
    s_mov_b32 exec_hi, -1
    s_lshr_b32 s96, s8, 2
    s_lshr_b32 s97, s9, 4
    s_lshl1_add_u32 s20, s96, s97
    s_add_u32 s96, s20, s85
    s_and_b32 s97, s96, 15
    s_lshl3_add_u32 s98, s97, s3
    s_mul_i32 s99, s98, 49152
    s_lshl_b32 s96, s11, 7
    s_add_u32 s82, s99, s96
    s_mul_i32 s96, s20, 24960
    s_lshr_b32 s97, s3, 1
    s_mul_i32 s98, s97, 2080
    s_add_u32 s99, s96, s98
    s_and_b32 s97, s3, 1
    s_mul_i32 s96, s97, 1056
    s_add_u32 s20, s99, s96
    s_mov_b32 m0, s20
    s_nop 0
    buffer_load_dwordx4 v62, s[40:43], s82 offen lds
    s_add_u32 s82, s82, 2048
    s_add_u32 m0, s20, 8320
    s_nop 0
    buffer_load_dwordx4 v62, s[40:43], s82 offen lds
    s_add_u32 s82, s82, 2048
    s_add_u32 m0, s20, 16640
    s_nop 0
    buffer_load_dwordx4 v62, s[40:43], s82 offen lds
    s_waitcnt vmcnt(5)
    v_bitop3_b32 v7, v121, v123, s4 bitop3:0x7e
    v_cmp_ne_u32 vcc, 0, v7
    s_cbranch_vccz TOK_5
POLL_6:
    buffer_load_dwordx4 v[120:123], v4, s[32:35], s13 offen sc1
    s_waitcnt vmcnt(0)
    v_bitop3_b32 v7, v121, v123, s4 bitop3:0x7e
    v_cmp_ne_u32 vcc, 0, v7
    s_cbranch_vccz PDONE_7
    s_add_u32 s5, s5, 1
    s_cmp_lt_u32 s5, 300000
    s_cbranch_scc1 POLL_6
PDONE_7:
TOK_5:
    ds_write2_b32 v5, v120, v122 offset0:0 offset1:8
    v_lshlrev_b32 v100, 16, v12
    v_and_b32 v101, s6, v12
    v_lshlrev_b32 v102, 16, v13
    v_and_b32 v103, s6, v13
    v_lshlrev_b32 v104, 16, v14
    v_and_b32 v105, s6, v14
    v_lshlrev_b32 v106, 16, v15
    v_and_b32 v107, s6, v15
    v_lshlrev_b32 v108, 16, v16
    v_and_b32 v109, s6, v16
    v_lshlrev_b32 v110, 16, v17
    v_and_b32 v111, s6, v17
    v_lshlrev_b32 v112, 16, v18
    v_and_b32 v113, s6, v18
    v_lshlrev_b32 v114, 16, v19
    v_and_b32 v115, s6, v19
    s_waitcnt lgkmcnt(0)
    s_barrier
    ds_read_b128 v[88:91], v6 offset:2048
    ds_read_b128 v[92:95], v6 offset:2064
    ds_read_b128 v[80:83], v6
    ds_read_b128 v[84:87], v6 offset:16
    s_waitcnt vmcnt(4)
    v_cmp_ne_u32 vcc, s4, v117
    s_cbranch_vccz TOK_8
POLL_9:
    buffer_load_dwordx2 v[116:117], v8, s[32:35], s14 offen sc1
    s_waitcnt vmcnt(0)
    v_cmp_ne_u32 vcc, s4, v117
    s_cbranch_vccz PDONE_10
    s_add_u32 s5, s5, 1
    s_cmp_lt_u32 s5, 300000
    s_cbranch_scc1 POLL_9
PDONE_10:
TOK_8:
    v_lshlrev_b32 v117, 16, v116
    v_and_b32 v116, s6, v116
    v_rcp_f32 v116, v116
    s_nop 0
    v_pk_add_f32 v[100:101], v[100:101], v[116:117] op_sel:[0,1] neg_lo:[0,1] neg_hi:[0,1]
    v_pk_add_f32 v[102:103], v[102:103], v[116:117] op_sel:[0,1] neg_lo:[0,1] neg_hi:[0,1]
    v_pk_add_f32 v[104:105], v[104:105], v[116:117] op_sel:[0,1] neg_lo:[0,1] neg_hi:[0,1]
    v_pk_add_f32 v[106:107], v[106:107], v[116:117] op_sel:[0,1] neg_lo:[0,1] neg_hi:[0,1]
    v_pk_add_f32 v[108:109], v[108:109], v[116:117] op_sel:[0,1] neg_lo:[0,1] neg_hi:[0,1]
    v_pk_add_f32 v[110:111], v[110:111], v[116:117] op_sel:[0,1] neg_lo:[0,1] neg_hi:[0,1]
    v_pk_add_f32 v[112:113], v[112:113], v[116:117] op_sel:[0,1] neg_lo:[0,1] neg_hi:[0,1]
    v_pk_add_f32 v[114:115], v[114:115], v[116:117] op_sel:[0,1] neg_lo:[0,1] neg_hi:[0,1]
    s_lshl4_add_u32 s96, s21, s12
    s_and_b32 s97, s3, 3
    s_lshl2_add_u32 s98, s96, s97
    s_lshl1_add_u32 s99, s98, s76
    s_lshl_b32 s96, s99, 11
    s_add_u32 s13, s96, 4194304
    v_and_b32 v8, 15, v1
    v_lshlrev_b32 v8, 4, v8
    v_bfe_u32 v9, v1, 4, 1
    v_lshl_add_u32 v8, v9, 10, v8
    v_lshrrev_b32 v9, 5, v1
    v_lshl_add_u32 v8, v9, 9, v8
    s_waitcnt lgkmcnt(2)
    v_pk_add_f32 v[88:89], v[88:89], v[90:91]
    v_pk_add_f32 v[92:93], v[92:93], v[94:95]
    v_pk_add_f32 v[88:89], v[88:89], v[92:93]
    v_add_f32 v88, v88, v89
    v_cvt_pk_bf16_f32 v88, 0, v88
    s_waitcnt lgkmcnt(0)
    v_pk_add_f32 v[80:81], v[80:81], v[82:83]
    v_pk_add_f32 v[84:85], v[84:85], v[86:87]
    v_pk_add_f32 v[80:81], v[80:81], v[84:85]
    v_add_f32 v80, v80, v81
    v_add_f32 v88, 1.0, v88
    v_cvt_pk_bf16_f32 v88, 0, v88
    v_cvt_pk_bf16_f32 v80, 0, v80
    v_cvt_pk_bf16_f32 v100, 0, v100
    v_cvt_pk_bf16_f32 v101, 0, v101
    v_cvt_pk_bf16_f32 v102, 0, v102
    v_cvt_pk_bf16_f32 v103, 0, v103
    v_cvt_pk_bf16_f32 v104, 0, v104
    v_cvt_pk_bf16_f32 v105, 0, v105
    v_cvt_pk_bf16_f32 v106, 0, v106
    v_cvt_pk_bf16_f32 v107, 0, v107
    v_pk_mul_f32 v[100:101], v[100:101], v[116:117] op_sel_hi:[1,0]
    v_pk_mul_f32 v[102:103], v[102:103], v[116:117] op_sel_hi:[1,0]
    v_pk_mul_f32 v[104:105], v[104:105], v[116:117] op_sel_hi:[1,0]
    v_pk_mul_f32 v[106:107], v[106:107], v[116:117] op_sel_hi:[1,0]
    v_cvt_pk_bf16_f32 v100, 0, v100
    v_cvt_pk_bf16_f32 v101, 0, v101
    v_cvt_pk_bf16_f32 v102, 0, v102
    v_cvt_pk_bf16_f32 v103, 0, v103
    v_cvt_pk_bf16_f32 v104, 0, v104
    v_cvt_pk_bf16_f32 v105, 0, v105
    v_cvt_pk_bf16_f32 v106, 0, v106
    v_cvt_pk_bf16_f32 v107, 0, v107
    v_mul_f32_dpp v100, v88, v100 row_newbcast:0 row_mask:0xf bank_mask:0xf
    v_mul_f32_dpp v101, v88, v101 row_newbcast:1 row_mask:0xf bank_mask:0xf
    v_mul_f32_dpp v102, v88, v102 row_newbcast:2 row_mask:0xf bank_mask:0xf
    v_mul_f32_dpp v103, v88, v103 row_newbcast:3 row_mask:0xf bank_mask:0xf
    v_mul_f32_dpp v104, v88, v104 row_newbcast:4 row_mask:0xf bank_mask:0xf
    v_mul_f32_dpp v105, v88, v105 row_newbcast:5 row_mask:0xf bank_mask:0xf
    v_mul_f32_dpp v106, v88, v106 row_newbcast:6 row_mask:0xf bank_mask:0xf
    v_mul_f32_dpp v107, v88, v107 row_newbcast:7 row_mask:0xf bank_mask:0xf
    v_cvt_pk_bf16_f32 v100, 0, v100
    v_cvt_pk_bf16_f32 v101, 0, v101
    v_cvt_pk_bf16_f32 v102, 0, v102
    v_cvt_pk_bf16_f32 v103, 0, v103
    v_cvt_pk_bf16_f32 v104, 0, v104
    v_cvt_pk_bf16_f32 v105, 0, v105
    v_cvt_pk_bf16_f32 v106, 0, v106
    v_cvt_pk_bf16_f32 v107, 0, v107
    v_add_f32_dpp v100, v80, v100 row_newbcast:0 row_mask:0xf bank_mask:0xf
    v_add_f32_dpp v101, v80, v101 row_newbcast:1 row_mask:0xf bank_mask:0xf
    v_add_f32_dpp v102, v80, v102 row_newbcast:2 row_mask:0xf bank_mask:0xf
    v_add_f32_dpp v103, v80, v103 row_newbcast:3 row_mask:0xf bank_mask:0xf
    v_add_f32_dpp v104, v80, v104 row_newbcast:4 row_mask:0xf bank_mask:0xf
    v_add_f32_dpp v105, v80, v105 row_newbcast:5 row_mask:0xf bank_mask:0xf
    v_add_f32_dpp v106, v80, v106 row_newbcast:6 row_mask:0xf bank_mask:0xf
    v_add_f32_dpp v107, v80, v107 row_newbcast:7 row_mask:0xf bank_mask:0xf
    v_cvt_pk_bf16_f32 v124, v100, v101
    v_cvt_pk_bf16_f32 v125, v102, v103
    v_cvt_pk_bf16_f32 v126, v104, v105
    v_cvt_pk_bf16_f32 v127, v106, v107
    buffer_store_dwordx4 v[124:127], v8, s[32:35], s13 offen sc1
    v_cvt_pk_bf16_f32 v108, 0, v108
    v_cvt_pk_bf16_f32 v109, 0, v109
    v_cvt_pk_bf16_f32 v110, 0, v110
    v_cvt_pk_bf16_f32 v111, 0, v111
    v_cvt_pk_bf16_f32 v112, 0, v112
    v_cvt_pk_bf16_f32 v113, 0, v113
    v_cvt_pk_bf16_f32 v114, 0, v114
    v_cvt_pk_bf16_f32 v115, 0, v115
    v_pk_mul_f32 v[108:109], v[108:109], v[116:117] op_sel_hi:[1,0]
    v_pk_mul_f32 v[110:111], v[110:111], v[116:117] op_sel_hi:[1,0]
    v_pk_mul_f32 v[112:113], v[112:113], v[116:117] op_sel_hi:[1,0]
    v_pk_mul_f32 v[114:115], v[114:115], v[116:117] op_sel_hi:[1,0]
    v_cvt_pk_bf16_f32 v108, 0, v108
    v_cvt_pk_bf16_f32 v109, 0, v109
    v_cvt_pk_bf16_f32 v110, 0, v110
    v_cvt_pk_bf16_f32 v111, 0, v111
    v_cvt_pk_bf16_f32 v112, 0, v112
    v_cvt_pk_bf16_f32 v113, 0, v113
    v_cvt_pk_bf16_f32 v114, 0, v114
    v_cvt_pk_bf16_f32 v115, 0, v115
    v_mul_f32_dpp v108, v88, v108 row_newbcast:8 row_mask:0xf bank_mask:0xf
    v_mul_f32_dpp v109, v88, v109 row_newbcast:9 row_mask:0xf bank_mask:0xf
    v_mul_f32_dpp v110, v88, v110 row_newbcast:10 row_mask:0xf bank_mask:0xf
    v_mul_f32_dpp v111, v88, v111 row_newbcast:11 row_mask:0xf bank_mask:0xf
    v_mul_f32_dpp v112, v88, v112 row_newbcast:12 row_mask:0xf bank_mask:0xf
    v_mul_f32_dpp v113, v88, v113 row_newbcast:13 row_mask:0xf bank_mask:0xf
    v_mul_f32_dpp v114, v88, v114 row_newbcast:14 row_mask:0xf bank_mask:0xf
    v_mul_f32_dpp v115, v88, v115 row_newbcast:15 row_mask:0xf bank_mask:0xf
    v_cvt_pk_bf16_f32 v108, 0, v108
    v_cvt_pk_bf16_f32 v109, 0, v109
    v_cvt_pk_bf16_f32 v110, 0, v110
    v_cvt_pk_bf16_f32 v111, 0, v111
    v_cvt_pk_bf16_f32 v112, 0, v112
    v_cvt_pk_bf16_f32 v113, 0, v113
    v_cvt_pk_bf16_f32 v114, 0, v114
    v_cvt_pk_bf16_f32 v115, 0, v115
    v_add_f32_dpp v108, v80, v108 row_newbcast:8 row_mask:0xf bank_mask:0xf
    v_add_f32_dpp v109, v80, v109 row_newbcast:9 row_mask:0xf bank_mask:0xf
    v_add_f32_dpp v110, v80, v110 row_newbcast:10 row_mask:0xf bank_mask:0xf
    v_add_f32_dpp v111, v80, v111 row_newbcast:11 row_mask:0xf bank_mask:0xf
    v_add_f32_dpp v112, v80, v112 row_newbcast:12 row_mask:0xf bank_mask:0xf
    v_add_f32_dpp v113, v80, v113 row_newbcast:13 row_mask:0xf bank_mask:0xf
    v_add_f32_dpp v114, v80, v114 row_newbcast:14 row_mask:0xf bank_mask:0xf
    v_add_f32_dpp v115, v80, v115 row_newbcast:15 row_mask:0xf bank_mask:0xf
    v_cvt_pk_bf16_f32 v128, v108, v109
    v_cvt_pk_bf16_f32 v129, v110, v111
    v_cvt_pk_bf16_f32 v130, v112, v113
    v_cvt_pk_bf16_f32 v131, v114, v115
    buffer_store_dwordx4 v[128:131], v8, s[32:35], s13 offen offset:256 sc1
    v_lshrrev_b32 v66, 5, v1
    v_mul_u32_u24 v66, 2080, v66
    v_bfe_u32 v9, v1, 2, 2
    v_lshl_add_u32 v66, v9, 7, v66
    v_bfe_u32 v9, v1, 3, 1
    v_lshl_add_u32 v66, v9, 6, v66
    v_and_b32 v9, 3, v1
    v_lshl_add_u32 v66, v9, 3, v66
    v_bfe_u32 v67, v1, 4, 1
    v_mul_u32_u24 v67, 1056, v67
    v_bfe_u32 v68, v1, 3, 1
    v_lshlrev_b32 v68, 7, v68
    v_add_u32 v66, v66, v67
    v_sub_u32 v67, v66, v68
    v_add_u32 v67, 64, v67
    v_add_u32 v68, 49920, v66
    v_add_u32 v69, 49920, v67
    v_add_u32 v70, 99840, v66
    v_add_u32 v71, 99840, v67
    s_lshl_b32 s96, s76, 11
    s_add_u32 s14, s96, 156416
    v_bfe_u32 v4, v1, 2, 2
    v_lshl_add_u32 v4, v4, 6, s14
    v_bfe_u32 v9, v1, 4, 1
    v_lshl_add_u32 v4, v9, 5, v4
    v_and_b32 v9, 3, v1
    v_lshl_add_u32 v4, v9, 3, v4
    v_lshrrev_b32 v9, 5, v1
    v_lshl_add_u32 v4, v9, 9, v4
    v_and_b32 v5, 3, v1
    v_lshlrev_b32 v5, 15, v5
    v_bfe_u32 v9, v1, 2, 2
    v_lshl_add_u32 v5, v9, 12, v5
    s_and_b32 s96, s12, 1
    s_lshr_b32 s97, s21, 3
    s_and_b32 s98, s21, 7
    s_lshl_b32 s99, s98, 5
    s_lshl2_add_u32 s98, s97, s99
    s_lshl_b32 s97, s98, 12
    s_lshr_b32 s99, s12, 1
    s_lshl_b32 s98, s99, 6
    s_add_u32 s99, s97, s98
    s_lshl2_add_u32 s97, s96, s99
    s_add_u32 s13, s97, 1048576
    v_bfe_u32 v6, v1, 4, 1
    v_lshlrev_b32 v6, 6, v6
    v_lshrrev_b32 v9, 5, v1
    v_lshl_add_u32 v6, v9, 4, v6
    v_and_b32 v74, 7, v1
    v_lshlrev_b32 v74, 4, v74
    v_xor_b32 v74, v74, v6
    v_lshrrev_b32 v6, 3, v1
    v_lshlrev_b32 v6, 11, v6
    v_add_u32 v74, v74, v6
    s_and_b32 s96, s3, 2
    s_lshl_b32 s14, s96, 5
    v_bfe_u32 v6, v1, 4, 1
    v_lshl_add_u32 v6, v6, 5, s14
    v_and_b32 v72, 7, v1
    v_lshlrev_b32 v72, 4, v72
    v_xor_b32 v72, v72, v6
    v_lshrrev_b32 v6, 3, v1
    v_mul_u32_u24 v6, 7168, v6
    v_add_u32 v72, v72, v6
    s_and_b32 s96, s3, 1
    s_lshl_b32 s14, s96, 7
    v_lshrrev_b32 v6, 5, v1
    v_lshl_add_u32 v6, v6, 6, s14
    v_and_b32 v73, 31, v1
    v_lshlrev_b32 v73, 4, v73
    v_lshrrev_b32 v9, 5, v1
    v_lshl_add_u32 v73, v9, 11, v73
    v_xor_b32 v73, v73, v6
    s_lshl3_add_u32 s96, s75, s3
    s_mul_i32 s97, s96, 229376
    s_lshl_b32 s98, s74, 7
    s_add_u32 s80, s97, s98
    s_lshl3_add_u32 s96, s74, s3
    s_lshl_b32 s97, s96, 14
    s_lshl_b32 s98, s75, 9
    s_add_u32 s81, s97, s98
    s_cmp_ge_u32 s9, 28
    s_cselect_b32 s54, 0, s54
    s_cselect_b32 s58, 0, s58
    s_cselect_b32 s62, 0, s62
    s_waitcnt vmcnt(0)
    s_barrier
    s_cmp_lg_u32 s3, 0
    s_cbranch_scc1 L_PB
    v_mov_b32 v6, s4
    s_mov_b32 exec_hi, 0
    s_mov_b32 exec_lo, 65535
    buffer_store_dword v6, v5, s[32:35], s13 offen sc1
    s_mov_b64 exec, -1
L_PB:
    s_lshr_b32 s96, s8, 2
    s_lshr_b32 s97, s9, 4
    s_lshl1_add_u32 s20, s96, s97
    s_cmp_le_u32 s20, 0
    s_cselect_b32 s20, 1, 0
    s_add_u32 s96, s20, s85
    s_and_b32 s97, s96, 15
    s_lshl3_add_u32 s98, s97, s3
    s_mul_i32 s99, s98, 49152
    s_lshl_b32 s96, s11, 7
    s_add_u32 s82, s99, s96
    s_mul_i32 s96, s20, 24960
    s_lshr_b32 s97, s3, 1
    s_mul_i32 s98, s97, 2080
    s_add_u32 s99, s96, s98
    s_and_b32 s97, s3, 1
    s_mul_i32 s96, s97, 1056
    s_add_u32 s20, s99, s96
    s_mov_b32 m0, s20
    s_nop 0
    buffer_load_dwordx4 v62, s[40:43], s82 offen lds
    s_add_u32 s82, s82, 2048
    s_add_u32 m0, s20, 8320
    s_nop 0
    buffer_load_dwordx4 v62, s[40:43], s82 offen lds
    s_add_u32 s82, s82, 2048
    s_add_u32 m0, s20, 16640
    s_nop 0
    buffer_load_dwordx4 v62, s[40:43], s82 offen lds
    ds_read_b64_tr_b16 v[28:29], v4
    ds_read_b64_tr_b16 v[30:31], v4 offset:256
    ds_read_b64_tr_b16 v[32:33], v4 offset:1024
    ds_read_b64_tr_b16 v[34:35], v4 offset:1280
    s_lshl_b32 s96, s10, 6
    s_add_u32 s97, s96, s3
    s_lshl_b32 s98, s97, 12
    s_add_u32 s15, s98, 4194304
    s_and_b32 s96, s3, 3
    s_lshl_b32 s97, s96, 12
    s_add_u32 s13, s97, 147456
    v_add_u32 v76, s13, v2
    v_and_b32 v77, 15, v1
    v_lshl_add_u32 v77, v77, 4, s13
    v_lshrrev_b32 v9, 5, v1
    v_lshl_add_u32 v77, v9, 9, v77
    v_bfe_u32 v9, v1, 4, 1
    v_lshl_add_u32 v77, v9, 3, v77
    s_and_b32 s96, s3, 3
    s_lshl_b32 s97, s96, 10
    s_add_u32 s13, s97, 32768
    v_and_b32 v78, 15, v1
    v_lshl_add_u32 v78, v78, 5, s13
    v_lshrrev_b32 v9, 4, v1
    v_lshl_add_u32 v78, v9, 3, v78
    s_and_b32 s96, s3, 3
    s_lshl_b32 s97, s96, 10
    s_lshl_b32 s98, s76, 14
    s_add_u32 s13, s97, s98
    v_and_b32 v75, 31, v1
    v_lshl_add_u32 v75, v75, 5, s13
    v_lshrrev_b32 v9, 5, v1
    v_lshl_add_u32 v75, v9, 4, v75
    s_lshl2_add_u32 s96, s83, s3
    s_lshl_b32 s84, s96, 14
    s_lshr_b32 s96, s9, 4
    s_lshl_b32 s97, s96, 20
    s_lshl_b32 s98, s12, 7
    s_add_u32 s88, s97, s98
    s_lshl_b32 s89, s3, 10
    s_load_dwordx2 s[24:25], s[32:33], s92 offset:0 glc
    s_lshr_b32 s96, s8, 2
    s_lshr_b32 s97, s9, 4
    s_lshl1_add_u32 s20, s96, s97
    s_cmp_le_u32 s20, 1
    s_cselect_b32 s20, 2, 1
    s_add_u32 s96, s20, s85
    s_and_b32 s97, s96, 15
    s_lshl3_add_u32 s98, s97, s3
    s_mul_i32 s99, s98, 49152
    s_lshl_b32 s96, s11, 7
    s_add_u32 s82, s99, s96
    s_mul_i32 s96, s20, 24960
    s_lshr_b32 s97, s3, 1
    s_mul_i32 s98, s97, 2080
    s_add_u32 s99, s96, s98
    s_and_b32 s97, s3, 1
    s_mul_i32 s96, s97, 1056
    s_add_u32 s20, s99, s96
    s_mov_b32 m0, s20
    s_nop 0
    buffer_load_dwordx4 v62, s[40:43], s82 offen lds
    s_add_u32 s82, s82, 2048
    s_add_u32 m0, s20, 8320
    s_nop 0
    buffer_load_dwordx4 v62, s[40:43], s82 offen lds
    s_add_u32 s82, s82, 2048
    s_add_u32 m0, s20, 16640
    s_nop 0
    buffer_load_dwordx4 v62, s[40:43], s82 offen lds
    s_branch SCHK_12
SPOLL_11:
    s_load_dwordx2 s[24:25], s[32:33], s92 offset:0 glc
SCHK_12:
    s_add_u32 s5, s5, 1
    s_cmp_ge_u32 s5, 300000
    s_waitcnt lgkmcnt(0)
    s_cbranch_scc1 SDONE_13
    s_cmp_lg_u32 s24, s4
    s_cbranch_scc1 SPOLL_11
    s_cmp_lg_u32 s25, s4
    s_cbranch_scc1 SPOLL_11
SDONE_13:
    s_waitcnt vmcnt(3)
    s_barrier
    s_cmp_ge_u32 s3, 4
    s_cbranch_scc1 L_HELP
    s_setprio 2
    s_and_b32 s96, s85, 15
    s_lshl_b32 s97, s96, 14
    s_add_u32 s16, s97, s15
    buffer_load_dwordx4 v[176:179], v2, s[32:35], s16 offen sc1
    buffer_load_dwordx4 v[180:183], v2, s[32:35], s16 offen offset:1024 sc1
    ds_read_b64_tr_b16 v[224:225], v67 offset:8320
    ds_read_b64_tr_b16 v[226:227], v67 offset:8832
    ds_read_b64_tr_b16 v[228:229], v67 offset:8352
    ds_read_b64_tr_b16 v[230:231], v67 offset:8864
    ds_read_b64_tr_b16 v[232:233], v66 offset:8320
    ds_read_b64_tr_b16 v[234:235], v66 offset:8832
    ds_read_b64_tr_b16 v[236:237], v66 offset:8352
    ds_read_b64_tr_b16 v[238:239], v66 offset:8864
    ds_read_b64_tr_b16 v[240:241], v66
    ds_read_b64_tr_b16 v[242:243], v66 offset:512
    ds_read_b64_tr_b16 v[244:245], v66 offset:32
    ds_read_b64_tr_b16 v[246:247], v66 offset:544
    buffer_load_dwordx4 v[184:187], v2, s[32:35], s16 offen offset:2048 sc1
    buffer_load_dwordx4 v[188:191], v2, s[32:35], s16 offen offset:3072 sc1
    s_waitcnt lgkmcnt(8)
    s_waitcnt vmcnt(3)
    v_mfma_f32_16x16x32_bf16 v[128:131], v[224:227], v[176:179], 0
    ds_read_b64_tr_b16 v[248:249], v67
    s_waitcnt vmcnt(2)
    v_mfma_f32_16x16x32_bf16 v[132:135], v[224:227], v[180:183], 0
    ds_read_b64_tr_b16 v[250:251], v67 offset:512
    s_add_u32 s96, s85, 1
    s_and_b32 s97, s96, 15
    s_lshl_b32 s98, s97, 14
    s_add_u32 s16, s98, s15
    buffer_load_dwordx4 v[192:195], v2, s[32:35], s16 offen sc1
    v_mfma_f32_16x16x32_bf16 v[136:139], v[228:231], v[176:179], 0
    ds_read_b64_tr_b16 v[224:225], v67 offset:32
    v_mfma_f32_16x16x32_bf16 v[140:143], v[228:231], v[180:183], 0
    ds_read_b64_tr_b16 v[226:227], v67 offset:544
    s_waitcnt lgkmcnt(8)
    v_mfma_f32_16x16x32_bf16 v[112:115], v[232:235], v[176:179], 0
    ds_read_b64_tr_b16 v[228:229], v66 offset:16640
    v_mfma_f32_16x16x32_bf16 v[116:119], v[232:235], v[180:183], 0
    ds_read_b64_tr_b16 v[230:231], v66 offset:17152
    v_mfma_f32_16x16x32_bf16 v[120:123], v[236:239], v[176:179], 0
    ds_read_b64_tr_b16 v[232:233], v66 offset:16672
    v_mfma_f32_16x16x32_bf16 v[124:127], v[236:239], v[180:183], 0
    ds_read_b64_tr_b16 v[234:235], v66 offset:17184
    buffer_load_dwordx4 v[196:199], v2, s[32:35], s16 offen offset:1024 sc1
    s_waitcnt lgkmcnt(8)
    v_mfma_f32_16x16x32_bf16 v[80:83], v[240:243], v[176:179], 0
    ds_read_b64_tr_b16 v[236:237], v67 offset:16640
    v_mfma_f32_16x16x32_bf16 v[84:87], v[240:243], v[180:183], 0
    ds_read_b64_tr_b16 v[238:239], v67 offset:17152
    v_mfma_f32_16x16x32_bf16 v[88:91], v[244:247], v[176:179], 0
    ds_read_b64_tr_b16 v[240:241], v67 offset:16672
    v_mfma_f32_16x16x32_bf16 v[92:95], v[244:247], v[180:183], 0
    ds_read_b64_tr_b16 v[242:243], v67 offset:17184
    s_waitcnt lgkmcnt(8)
    v_mfma_f32_16x16x32_bf16 v[96:99], v[248:251], v[176:179], 0
    ds_read_b64_tr_b16 v[244:245], v67 offset:12480
    v_mfma_f32_16x16x32_bf16 v[100:103], v[248:251], v[180:183], 0
    ds_read_b64_tr_b16 v[246:247], v67 offset:12992
    buffer_load_dwordx4 v[200:203], v2, s[32:35], s16 offen offset:2048 sc1
    v_mfma_f32_16x16x32_bf16 v[104:107], v[224:227], v[176:179], 0
    ds_read_b64_tr_b16 v[248:249], v67 offset:12512
    v_mfma_f32_16x16x32_bf16 v[108:111], v[224:227], v[180:183], 0
    ds_read_b64_tr_b16 v[250:251], v67 offset:13024
    s_waitcnt lgkmcnt(8)
    v_mfma_f32_16x16x32_bf16 v[144:147], v[228:231], v[176:179], 0
    ds_read_b64_tr_b16 v[224:225], v66 offset:12480
    v_mfma_f32_16x16x32_bf16 v[148:151], v[228:231], v[180:183], 0
    ds_read_b64_tr_b16 v[226:227], v66 offset:12992
    v_mfma_f32_16x16x32_bf16 v[152:155], v[232:235], v[176:179], 0
    ds_read_b64_tr_b16 v[228:229], v66 offset:12512
    v_mfma_f32_16x16x32_bf16 v[156:159], v[232:235], v[180:183], 0
    ds_read_b64_tr_b16 v[230:231], v66 offset:13024
    buffer_load_dwordx4 v[204:207], v2, s[32:35], s16 offen offset:3072 sc1
    s_waitcnt lgkmcnt(8)
    v_mfma_f32_16x16x32_bf16 v[160:163], v[236:239], v[176:179], 0
    ds_read_b64_tr_b16 v[232:233], v66 offset:4160
    v_mfma_f32_16x16x32_bf16 v[164:167], v[236:239], v[180:183], 0
    ds_read_b64_tr_b16 v[234:235], v66 offset:4672
    v_mfma_f32_16x16x32_bf16 v[168:171], v[240:243], v[176:179], 0
    ds_read_b64_tr_b16 v[236:237], v66 offset:4192
    v_mfma_f32_16x16x32_bf16 v[172:175], v[240:243], v[180:183], 0
    ds_read_b64_tr_b16 v[238:239], v66 offset:4704
    s_waitcnt lgkmcnt(8)
    s_waitcnt vmcnt(5)
    v_mfma_f32_16x16x32_bf16 v[128:131], v[244:247], v[184:187], v[128:131]
    ds_read_b64_tr_b16 v[240:241], v67 offset:4160
    s_waitcnt vmcnt(4)
    v_mfma_f32_16x16x32_bf16 v[132:135], v[244:247], v[188:191], v[132:135]
    ds_read_b64_tr_b16 v[242:243], v67 offset:4672
    s_add_u32 s96, s85, 2
    s_and_b32 s97, s96, 15
    s_lshl_b32 s98, s97, 14
    s_add_u32 s16, s98, s15
    buffer_load_dwordx4 v[208:211], v2, s[32:35], s16 offen sc1
    v_mfma_f32_16x16x32_bf16 v[136:139], v[248:251], v[184:187], v[136:139]
    ds_read_b64_tr_b16 v[244:245], v67 offset:4192
    v_mfma_f32_16x16x32_bf16 v[140:143], v[248:251], v[188:191], v[140:143]
    ds_read_b64_tr_b16 v[246:247], v67 offset:4704
    s_waitcnt lgkmcnt(8)
    v_mfma_f32_16x16x32_bf16 v[112:115], v[224:227], v[184:187], v[112:115]
    ds_read_b64_tr_b16 v[248:249], v66 offset:20800
    v_mfma_f32_16x16x32_bf16 v[116:119], v[224:227], v[188:191], v[116:119]
    ds_read_b64_tr_b16 v[250:251], v66 offset:21312
    v_mfma_f32_16x16x32_bf16 v[120:123], v[228:231], v[184:187], v[120:123]
    ds_read_b64_tr_b16 v[224:225], v66 offset:20832
    v_mfma_f32_16x16x32_bf16 v[124:127], v[228:231], v[188:191], v[124:127]
    ds_read_b64_tr_b16 v[226:227], v66 offset:21344
    buffer_load_dwordx4 v[212:215], v2, s[32:35], s16 offen offset:1024 sc1
    s_waitcnt lgkmcnt(8)
    v_mfma_f32_16x16x32_bf16 v[80:83], v[232:235], v[184:187], v[80:83]
    ds_read_b64_tr_b16 v[228:229], v67 offset:20800
    v_mfma_f32_16x16x32_bf16 v[84:87], v[232:235], v[188:191], v[84:87]
    ds_read_b64_tr_b16 v[230:231], v67 offset:21312
    v_mfma_f32_16x16x32_bf16 v[88:91], v[236:239], v[184:187], v[88:91]
    ds_read_b64_tr_b16 v[232:233], v67 offset:20832
    v_mfma_f32_16x16x32_bf16 v[92:95], v[236:239], v[188:191], v[92:95]
    ds_read_b64_tr_b16 v[234:235], v67 offset:21344
    s_waitcnt lgkmcnt(8)
    v_mfma_f32_16x16x32_bf16 v[96:99], v[240:243], v[184:187], v[96:99]
    s_barrier
    ds_read_b64_tr_b16 v[236:237], v67 offset:33280
    v_mfma_f32_16x16x32_bf16 v[100:103], v[240:243], v[188:191], v[100:103]
    ds_read_b64_tr_b16 v[238:239], v67 offset:33792
    buffer_load_dwordx4 v[216:219], v2, s[32:35], s16 offen offset:2048 sc1
    v_mfma_f32_16x16x32_bf16 v[104:107], v[244:247], v[184:187], v[104:107]
    ds_read_b64_tr_b16 v[240:241], v67 offset:33312
    v_mfma_f32_16x16x32_bf16 v[108:111], v[244:247], v[188:191], v[108:111]
    ds_read_b64_tr_b16 v[242:243], v67 offset:33824
    s_waitcnt lgkmcnt(8)
    v_mfma_f32_16x16x32_bf16 v[144:147], v[248:251], v[184:187], v[144:147]
    ds_read_b64_tr_b16 v[244:245], v66 offset:33280
    v_mfma_f32_16x16x32_bf16 v[148:151], v[248:251], v[188:191], v[148:151]
    ds_read_b64_tr_b16 v[246:247], v66 offset:33792
    v_mfma_f32_16x16x32_bf16 v[152:155], v[224:227], v[184:187], v[152:155]
    ds_read_b64_tr_b16 v[248:249], v66 offset:33312
    v_mfma_f32_16x16x32_bf16 v[156:159], v[224:227], v[188:191], v[156:159]
    ds_read_b64_tr_b16 v[250:251], v66 offset:33824
    buffer_load_dwordx4 v[220:223], v2, s[32:35], s16 offen offset:3072 sc1
    s_waitcnt lgkmcnt(8)
    v_mfma_f32_16x16x32_bf16 v[160:163], v[228:231], v[184:187], v[160:163]
    ds_read_b64_tr_b16 v[224:225], v66 offset:24960
    v_mfma_f32_16x16x32_bf16 v[164:167], v[228:231], v[188:191], v[164:167]
    ds_read_b64_tr_b16 v[226:227], v66 offset:25472
    v_mfma_f32_16x16x32_bf16 v[168:171], v[232:235], v[184:187], v[168:171]
    ds_read_b64_tr_b16 v[228:229], v66 offset:24992
    v_mfma_f32_16x16x32_bf16 v[172:175], v[232:235], v[188:191], v[172:175]
    ds_read_b64_tr_b16 v[230:231], v66 offset:25504
    s_waitcnt lgkmcnt(8)
    s_waitcnt vmcnt(7)
    v_mfma_f32_16x16x32_bf16 v[128:131], v[236:239], v[192:195], v[128:131]
    ds_read_b64_tr_b16 v[232:233], v67 offset:24960
    s_waitcnt vmcnt(6)
    v_mfma_f32_16x16x32_bf16 v[132:135], v[236:239], v[196:199], v[132:135]
    ds_read_b64_tr_b16 v[234:235], v67 offset:25472
    s_add_u32 s96, s85, 3
    s_and_b32 s97, s96, 15
    s_lshl_b32 s98, s97, 14
    s_add_u32 s16, s98, s15
    buffer_load_dwordx4 v[176:179], v2, s[32:35], s16 offen sc1
    v_mfma_f32_16x16x32_bf16 v[136:139], v[240:243], v[192:195], v[136:139]
    ds_read_b64_tr_b16 v[236:237], v67 offset:24992
    v_mfma_f32_16x16x32_bf16 v[140:143], v[240:243], v[196:199], v[140:143]
    ds_read_b64_tr_b16 v[238:239], v67 offset:25504
    s_waitcnt lgkmcnt(8)
    v_mfma_f32_16x16x32_bf16 v[112:115], v[244:247], v[192:195], v[112:115]
    ds_read_b64_tr_b16 v[240:241], v66 offset:41600
    v_mfma_f32_16x16x32_bf16 v[116:119], v[244:247], v[196:199], v[116:119]
    ds_read_b64_tr_b16 v[242:243], v66 offset:42112
    v_mfma_f32_16x16x32_bf16 v[120:123], v[248:251], v[192:195], v[120:123]
    ds_read_b64_tr_b16 v[244:245], v66 offset:41632
    v_mfma_f32_16x16x32_bf16 v[124:127], v[248:251], v[196:199], v[124:127]
    ds_read_b64_tr_b16 v[246:247], v66 offset:42144
    buffer_load_dwordx4 v[180:183], v2, s[32:35], s16 offen offset:1024 sc1
    s_waitcnt lgkmcnt(8)
    v_mfma_f32_16x16x32_bf16 v[80:83], v[224:227], v[192:195], v[80:83]
    ds_read_b64_tr_b16 v[248:249], v67 offset:41600
    v_mfma_f32_16x16x32_bf16 v[84:87], v[224:227], v[196:199], v[84:87]
    ds_read_b64_tr_b16 v[250:251], v67 offset:42112
    v_mfma_f32_16x16x32_bf16 v[88:91], v[228:231], v[192:195], v[88:91]
    ds_read_b64_tr_b16 v[224:225], v67 offset:41632
    v_mfma_f32_16x16x32_bf16 v[92:95], v[228:231], v[196:199], v[92:95]
    ds_read_b64_tr_b16 v[226:227], v67 offset:42144
    s_waitcnt lgkmcnt(8)
    v_mfma_f32_16x16x32_bf16 v[96:99], v[232:235], v[192:195], v[96:99]
    ds_read_b64_tr_b16 v[228:229], v67 offset:37440
    v_mfma_f32_16x16x32_bf16 v[100:103], v[232:235], v[196:199], v[100:103]
    ds_read_b64_tr_b16 v[230:231], v67 offset:37952
    buffer_load_dwordx4 v[184:187], v2, s[32:35], s16 offen offset:2048 sc1
    v_mfma_f32_16x16x32_bf16 v[104:107], v[236:239], v[192:195], v[104:107]
    ds_read_b64_tr_b16 v[232:233], v67 offset:37472
    v_mfma_f32_16x16x32_bf16 v[108:111], v[236:239], v[196:199], v[108:111]
    ds_read_b64_tr_b16 v[234:235], v67 offset:37984
    s_waitcnt lgkmcnt(8)
    v_mfma_f32_16x16x32_bf16 v[144:147], v[240:243], v[192:195], v[144:147]
    ds_read_b64_tr_b16 v[236:237], v66 offset:37440
    v_mfma_f32_16x16x32_bf16 v[148:151], v[240:243], v[196:199], v[148:151]
    ds_read_b64_tr_b16 v[238:239], v66 offset:37952
    v_mfma_f32_16x16x32_bf16 v[152:155], v[244:247], v[192:195], v[152:155]
    ds_read_b64_tr_b16 v[240:241], v66 offset:37472
    v_mfma_f32_16x16x32_bf16 v[156:159], v[244:247], v[196:199], v[156:159]
    ds_read_b64_tr_b16 v[242:243], v66 offset:37984
    buffer_load_dwordx4 v[188:191], v2, s[32:35], s16 offen offset:3072 sc1
    s_waitcnt lgkmcnt(8)
    v_mfma_f32_16x16x32_bf16 v[160:163], v[248:251], v[192:195], v[160:163]
    ds_read_b64_tr_b16 v[244:245], v66 offset:29120
    v_mfma_f32_16x16x32_bf16 v[164:167], v[248:251], v[196:199], v[164:167]
    ds_read_b64_tr_b16 v[246:247], v66 offset:29632
    v_mfma_f32_16x16x32_bf16 v[168:171], v[224:227], v[192:195], v[168:171]
    ds_read_b64_tr_b16 v[248:249], v66 offset:29152
    v_mfma_f32_16x16x32_bf16 v[172:175], v[224:227], v[196:199], v[172:175]
    ds_read_b64_tr_b16 v[250:251], v66 offset:29664
    s_waitcnt lgkmcnt(8)
    s_waitcnt vmcnt(9)
    v_mfma_f32_16x16x32_bf16 v[128:131], v[228:231], v[200:203], v[128:131]
    ds_read_b64_tr_b16 v[224:225], v67 offset:29120
    s_waitcnt vmcnt(8)
    v_mfma_f32_16x16x32_bf16 v[132:135], v[228:231], v[204:207], v[132:135]
    ds_read_b64_tr_b16 v[226:227], v67 offset:29632
    s_add_u32 s96, s85, 4
    s_and_b32 s97, s96, 15
    s_lshl_b32 s98, s97, 14
    s_add_u32 s16, s98, s15
    buffer_load_dwordx4 v[192:195], v2, s[32:35], s16 offen sc1
    v_mfma_f32_16x16x32_bf16 v[136:139], v[232:235], v[200:203], v[136:139]
    ds_read_b64_tr_b16 v[228:229], v67 offset:29152
    v_mfma_f32_16x16x32_bf16 v[140:143], v[232:235], v[204:207], v[140:143]
    ds_read_b64_tr_b16 v[230:231], v67 offset:29664
    s_waitcnt lgkmcnt(8)
    v_mfma_f32_16x16x32_bf16 v[112:115], v[236:239], v[200:203], v[112:115]
    ds_read_b64_tr_b16 v[232:233], v66 offset:45760
    v_mfma_f32_16x16x32_bf16 v[116:119], v[236:239], v[204:207], v[116:119]
    ds_read_b64_tr_b16 v[234:235], v66 offset:46272
    v_mfma_f32_16x16x32_bf16 v[120:123], v[240:243], v[200:203], v[120:123]
    ds_read_b64_tr_b16 v[236:237], v66 offset:45792
    v_mfma_f32_16x16x32_bf16 v[124:127], v[240:243], v[204:207], v[124:127]
    ds_read_b64_tr_b16 v[238:239], v66 offset:46304
    buffer_load_dwordx4 v[196:199], v2, s[32:35], s16 offen offset:1024 sc1
    s_waitcnt lgkmcnt(8)
    v_mfma_f32_16x16x32_bf16 v[80:83], v[244:247], v[200:203], v[80:83]
    ds_read_b64_tr_b16 v[240:241], v67 offset:45760
    v_mfma_f32_16x16x32_bf16 v[84:87], v[244:247], v[204:207], v[84:87]
    ds_read_b64_tr_b16 v[242:243], v67 offset:46272
    v_mfma_f32_16x16x32_bf16 v[88:91], v[248:251], v[200:203], v[88:91]
    ds_read_b64_tr_b16 v[244:245], v67 offset:45792
    v_mfma_f32_16x16x32_bf16 v[92:95], v[248:251], v[204:207], v[92:95]
    ds_read_b64_tr_b16 v[246:247], v67 offset:46304
    s_waitcnt lgkmcnt(8)
    v_mfma_f32_16x16x32_bf16 v[96:99], v[224:227], v[200:203], v[96:99]
    s_barrier
    ds_read_b64_tr_b16 v[248:249], v69 offset:8320
    v_mfma_f32_16x16x32_bf16 v[100:103], v[224:227], v[204:207], v[100:103]
    ds_read_b64_tr_b16 v[250:251], v69 offset:8832
    v_mfma_f32_16x16x32_bf16 v[104:107], v[228:231], v[200:203], v[104:107]
    ds_read_b64_tr_b16 v[224:225], v69 offset:8352
    v_mfma_f32_16x16x32_bf16 v[108:111], v[228:231], v[204:207], v[108:111]
    ds_read_b64_tr_b16 v[226:227], v69 offset:8864
    s_waitcnt lgkmcnt(8)
    v_mfma_f32_16x16x32_bf16 v[144:147], v[232:235], v[200:203], v[144:147]
    ds_read_b64_tr_b16 v[228:229], v68 offset:8320
    v_mfma_f32_16x16x32_bf16 v[148:151], v[232:235], v[204:207], v[148:151]
    ds_read_b64_tr_b16 v[230:231], v68 offset:8832
    v_mfma_f32_16x16x32_bf16 v[152:155], v[236:239], v[200:203], v[152:155]
    ds_read_b64_tr_b16 v[232:233], v68 offset:8352
    v_mfma_f32_16x16x32_bf16 v[156:159], v[236:239], v[204:207], v[156:159]
    ds_read_b64_tr_b16 v[234:235], v68 offset:8864
    s_waitcnt lgkmcnt(8)
    v_mfma_f32_16x16x32_bf16 v[160:163], v[240:243], v[200:203], v[160:163]
    ds_read_b64_tr_b16 v[236:237], v68
    v_mfma_f32_16x16x32_bf16 v[164:167], v[240:243], v[204:207], v[164:167]
    ds_read_b64_tr_b16 v[238:239], v68 offset:512
    v_mfma_f32_16x16x32_bf16 v[168:171], v[244:247], v[200:203], v[168:171]
    ds_read_b64_tr_b16 v[240:241], v68 offset:32
    v_mfma_f32_16x16x32_bf16 v[172:175], v[244:247], v[204:207], v[172:175]
    ds_read_b64_tr_b16 v[242:243], v68 offset:544
    s_waitcnt lgkmcnt(8)
    s_waitcnt vmcnt(9)
    v_mfma_f32_16x16x32_bf16 v[128:131], v[248:251], v[208:211], v[128:131]
    ds_read_b64_tr_b16 v[244:245], v69
    s_waitcnt vmcnt(8)
    v_mfma_f32_16x16x32_bf16 v[132:135], v[248:251], v[212:215], v[132:135]
    ds_read_b64_tr_b16 v[246:247], v69 offset:512
    buffer_load_dwordx4 v[200:203], v2, s[32:35], s16 offen offset:2048 sc1
    v_mfma_f32_16x16x32_bf16 v[136:139], v[224:227], v[208:211], v[136:139]
    ds_read_b64_tr_b16 v[248:249], v69 offset:32
    v_mfma_f32_16x16x32_bf16 v[140:143], v[224:227], v[212:215], v[140:143]
    ds_read_b64_tr_b16 v[250:251], v69 offset:544
    s_waitcnt lgkmcnt(8)
    v_mfma_f32_16x16x32_bf16 v[112:115], v[228:231], v[208:211], v[112:115]
    ds_read_b64_tr_b16 v[224:225], v68 offset:16640
    v_mfma_f32_16x16x32_bf16 v[116:119], v[228:231], v[212:215], v[116:119]
    ds_read_b64_tr_b16 v[226:227], v68 offset:17152
    v_mfma_f32_16x16x32_bf16 v[120:123], v[232:235], v[208:211], v[120:123]
    ds_read_b64_tr_b16 v[228:229], v68 offset:16672
    v_mfma_f32_16x16x32_bf16 v[124:127], v[232:235], v[212:215], v[124:127]
    ds_read_b64_tr_b16 v[230:231], v68 offset:17184
    buffer_load_dwordx4 v[204:207], v2, s[32:35], s16 offen offset:3072 sc1
    s_waitcnt lgkmcnt(8)
    v_mfma_f32_16x16x32_bf16 v[80:83], v[236:239], v[208:211], v[80:83]
    ds_read_b64_tr_b16 v[232:233], v69 offset:16640
    v_mfma_f32_16x16x32_bf16 v[84:87], v[236:239], v[212:215], v[84:87]
    ds_read_b64_tr_b16 v[234:235], v69 offset:17152
    v_mfma_f32_16x16x32_bf16 v[88:91], v[240:243], v[208:211], v[88:91]
    ds_read_b64_tr_b16 v[236:237], v69 offset:16672
    v_mfma_f32_16x16x32_bf16 v[92:95], v[240:243], v[212:215], v[92:95]
    ds_read_b64_tr_b16 v[238:239], v69 offset:17184
    s_waitcnt lgkmcnt(8)
    v_mfma_f32_16x16x32_bf16 v[96:99], v[244:247], v[208:211], v[96:99]
    ds_read_b64_tr_b16 v[240:241], v69 offset:12480
    v_mfma_f32_16x16x32_bf16 v[100:103], v[244:247], v[212:215], v[100:103]
    ds_read_b64_tr_b16 v[242:243], v69 offset:12992
    v_mfma_f32_16x16x32_bf16 v[104:107], v[248:251], v[208:211], v[104:107]
    ds_read_b64_tr_b16 v[244:245], v69 offset:12512
    v_mfma_f32_16x16x32_bf16 v[108:111], v[248:251], v[212:215], v[108:111]
    ds_read_b64_tr_b16 v[246:247], v69 offset:13024
    s_waitcnt lgkmcnt(8)
    v_mfma_f32_16x16x32_bf16 v[144:147], v[224:227], v[208:211], v[144:147]
    ds_read_b64_tr_b16 v[248:249], v68 offset:12480
    v_mfma_f32_16x16x32_bf16 v[148:151], v[224:227], v[212:215], v[148:151]
    ds_read_b64_tr_b16 v[250:251], v68 offset:12992
    v_mfma_f32_16x16x32_bf16 v[152:155], v[228:231], v[208:211], v[152:155]
    ds_read_b64_tr_b16 v[224:225], v68 offset:12512
    v_mfma_f32_16x16x32_bf16 v[156:159], v[228:231], v[212:215], v[156:159]
    ds_read_b64_tr_b16 v[226:227], v68 offset:13024
    s_waitcnt lgkmcnt(8)
    v_mfma_f32_16x16x32_bf16 v[160:163], v[232:235], v[208:211], v[160:163]
    ds_read_b64_tr_b16 v[228:229], v68 offset:4160
    v_mfma_f32_16x16x32_bf16 v[164:167], v[232:235], v[212:215], v[164:167]
    ds_read_b64_tr_b16 v[230:231], v68 offset:4672
    v_mfma_f32_16x16x32_bf16 v[168:171], v[236:239], v[208:211], v[168:171]
    ds_read_b64_tr_b16 v[232:233], v68 offset:4192
    v_mfma_f32_16x16x32_bf16 v[172:175], v[236:239], v[212:215], v[172:175]
    ds_read_b64_tr_b16 v[234:235], v68 offset:4704
    s_waitcnt lgkmcnt(8)
    s_waitcnt vmcnt(9)
    v_mfma_f32_16x16x32_bf16 v[128:131], v[240:243], v[216:219], v[128:131]
    ds_read_b64_tr_b16 v[236:237], v69 offset:4160
    s_waitcnt vmcnt(8)
    v_mfma_f32_16x16x32_bf16 v[132:135], v[240:243], v[220:223], v[132:135]
    ds_read_b64_tr_b16 v[238:239], v69 offset:4672
    s_add_u32 s96, s85, 5
    s_and_b32 s97, s96, 15
    s_lshl_b32 s98, s97, 14
    s_add_u32 s16, s98, s15
    buffer_load_dwordx4 v[208:211], v2, s[32:35], s16 offen sc1
    v_mfma_f32_16x16x32_bf16 v[136:139], v[244:247], v[216:219], v[136:139]
    ds_read_b64_tr_b16 v[240:241], v69 offset:4192
    v_mfma_f32_16x16x32_bf16 v[140:143], v[244:247], v[220:223], v[140:143]
    ds_read_b64_tr_b16 v[242:243], v69 offset:4704
    s_waitcnt lgkmcnt(8)
    v_mfma_f32_16x16x32_bf16 v[112:115], v[248:251], v[216:219], v[112:115]
    ds_read_b64_tr_b16 v[244:245], v68 offset:20800
    v_mfma_f32_16x16x32_bf16 v[116:119], v[248:251], v[220:223], v[116:119]
    ds_read_b64_tr_b16 v[246:247], v68 offset:21312
    v_mfma_f32_16x16x32_bf16 v[120:123], v[224:227], v[216:219], v[120:123]
    ds_read_b64_tr_b16 v[248:249], v68 offset:20832
    v_mfma_f32_16x16x32_bf16 v[124:127], v[224:227], v[220:223], v[124:127]
    ds_read_b64_tr_b16 v[250:251], v68 offset:21344
    buffer_load_dwordx4 v[212:215], v2, s[32:35], s16 offen offset:1024 sc1
    s_waitcnt lgkmcnt(8)
    v_mfma_f32_16x16x32_bf16 v[80:83], v[228:231], v[216:219], v[80:83]
    ds_read_b64_tr_b16 v[224:225], v69 offset:20800
    v_mfma_f32_16x16x32_bf16 v[84:87], v[228:231], v[220:223], v[84:87]
    ds_read_b64_tr_b16 v[226:227], v69 offset:21312
    v_mfma_f32_16x16x32_bf16 v[88:91], v[232:235], v[216:219], v[88:91]
    ds_read_b64_tr_b16 v[228:229], v69 offset:20832
    v_mfma_f32_16x16x32_bf16 v[92:95], v[232:235], v[220:223], v[92:95]
    ds_read_b64_tr_b16 v[230:231], v69 offset:21344
    s_waitcnt lgkmcnt(8)
    v_mfma_f32_16x16x32_bf16 v[96:99], v[236:239], v[216:219], v[96:99]
    s_barrier
    ds_read_b64_tr_b16 v[232:233], v69 offset:33280
    v_mfma_f32_16x16x32_bf16 v[100:103], v[236:239], v[220:223], v[100:103]
    ds_read_b64_tr_b16 v[234:235], v69 offset:33792
    v_mfma_f32_16x16x32_bf16 v[104:107], v[240:243], v[216:219], v[104:107]
    ds_read_b64_tr_b16 v[236:237], v69 offset:33312
    v_mfma_f32_16x16x32_bf16 v[108:111], v[240:243], v[220:223], v[108:111]
    ds_read_b64_tr_b16 v[238:239], v69 offset:33824
    s_waitcnt lgkmcnt(8)
    v_mfma_f32_16x16x32_bf16 v[144:147], v[244:247], v[216:219], v[144:147]
    ds_read_b64_tr_b16 v[240:241], v68 offset:33280
    v_mfma_f32_16x16x32_bf16 v[148:151], v[244:247], v[220:223], v[148:151]
    ds_read_b64_tr_b16 v[242:243], v68 offset:33792
    v_mfma_f32_16x16x32_bf16 v[152:155], v[248:251], v[216:219], v[152:155]
    ds_read_b64_tr_b16 v[244:245], v68 offset:33312
    v_mfma_f32_16x16x32_bf16 v[156:159], v[248:251], v[220:223], v[156:159]
    ds_read_b64_tr_b16 v[246:247], v68 offset:33824
    s_waitcnt lgkmcnt(8)
    v_mfma_f32_16x16x32_bf16 v[160:163], v[224:227], v[216:219], v[160:163]
    ds_read_b64_tr_b16 v[248:249], v68 offset:24960
    v_mfma_f32_16x16x32_bf16 v[164:167], v[224:227], v[220:223], v[164:167]
    ds_read_b64_tr_b16 v[250:251], v68 offset:25472
    v_mfma_f32_16x16x32_bf16 v[168:171], v[228:231], v[216:219], v[168:171]
    ds_read_b64_tr_b16 v[224:225], v68 offset:24992
    v_mfma_f32_16x16x32_bf16 v[172:175], v[228:231], v[220:223], v[172:175]
    ds_read_b64_tr_b16 v[226:227], v68 offset:25504
    s_waitcnt lgkmcnt(8)
    s_waitcnt vmcnt(9)
    v_mfma_f32_16x16x32_bf16 v[128:131], v[232:235], v[176:179], v[128:131]
    ds_read_b64_tr_b16 v[228:229], v69 offset:24960
    s_waitcnt vmcnt(8)
    v_mfma_f32_16x16x32_bf16 v[132:135], v[232:235], v[180:183], v[132:135]
    ds_read_b64_tr_b16 v[230:231], v69 offset:25472
    buffer_load_dwordx4 v[216:219], v2, s[32:35], s16 offen offset:2048 sc1
    v_mfma_f32_16x16x32_bf16 v[136:139], v[236:239], v[176:179], v[136:139]
    ds_read_b64_tr_b16 v[232:233], v69 offset:24992
    v_mfma_f32_16x16x32_bf16 v[140:143], v[236:239], v[180:183], v[140:143]
    ds_read_b64_tr_b16 v[234:235], v69 offset:25504
    s_waitcnt lgkmcnt(8)
    v_mfma_f32_16x16x32_bf16 v[112:115], v[240:243], v[176:179], v[112:115]
    ds_read_b64_tr_b16 v[236:237], v68 offset:41600
    v_mfma_f32_16x16x32_bf16 v[116:119], v[240:243], v[180:183], v[116:119]
    ds_read_b64_tr_b16 v[238:239], v68 offset:42112
    v_mfma_f32_16x16x32_bf16 v[120:123], v[244:247], v[176:179], v[120:123]
    ds_read_b64_tr_b16 v[240:241], v68 offset:41632
    v_mfma_f32_16x16x32_bf16 v[124:127], v[244:247], v[180:183], v[124:127]
    ds_read_b64_tr_b16 v[242:243], v68 offset:42144
    buffer_load_dwordx4 v[220:223], v2, s[32:35], s16 offen offset:3072 sc1
    s_waitcnt lgkmcnt(8)
    v_mfma_f32_16x16x32_bf16 v[80:83], v[248:251], v[176:179], v[80:83]
    ds_read_b64_tr_b16 v[244:245], v69 offset:41600
    v_mfma_f32_16x16x32_bf16 v[84:87], v[248:251], v[180:183], v[84:87]
    ds_read_b64_tr_b16 v[246:247], v69 offset:42112
    v_mfma_f32_16x16x32_bf16 v[88:91], v[224:227], v[176:179], v[88:91]
    ds_read_b64_tr_b16 v[248:249], v69 offset:41632
    v_mfma_f32_16x16x32_bf16 v[92:95], v[224:227], v[180:183], v[92:95]
    ds_read_b64_tr_b16 v[250:251], v69 offset:42144
    s_waitcnt lgkmcnt(8)
    v_mfma_f32_16x16x32_bf16 v[96:99], v[228:231], v[176:179], v[96:99]
    ds_read_b64_tr_b16 v[224:225], v69 offset:37440
    v_mfma_f32_16x16x32_bf16 v[100:103], v[228:231], v[180:183], v[100:103]
    ds_read_b64_tr_b16 v[226:227], v69 offset:37952
    v_mfma_f32_16x16x32_bf16 v[104:107], v[232:235], v[176:179], v[104:107]
    ds_read_b64_tr_b16 v[228:229], v69 offset:37472
    v_mfma_f32_16x16x32_bf16 v[108:111], v[232:235], v[180:183], v[108:111]
    ds_read_b64_tr_b16 v[230:231], v69 offset:37984
    s_waitcnt lgkmcnt(8)
    v_mfma_f32_16x16x32_bf16 v[144:147], v[236:239], v[176:179], v[144:147]
    ds_read_b64_tr_b16 v[232:233], v68 offset:37440
    v_mfma_f32_16x16x32_bf16 v[148:151], v[236:239], v[180:183], v[148:151]
    ds_read_b64_tr_b16 v[234:235], v68 offset:37952
    v_mfma_f32_16x16x32_bf16 v[152:155], v[240:243], v[176:179], v[152:155]
    ds_read_b64_tr_b16 v[236:237], v68 offset:37472
    v_mfma_f32_16x16x32_bf16 v[156:159], v[240:243], v[180:183], v[156:159]
    ds_read_b64_tr_b16 v[238:239], v68 offset:37984
    s_waitcnt lgkmcnt(8)
    v_mfma_f32_16x16x32_bf16 v[160:163], v[244:247], v[176:179], v[160:163]
    ds_read_b64_tr_b16 v[240:241], v68 offset:29120
    v_mfma_f32_16x16x32_bf16 v[164:167], v[244:247], v[180:183], v[164:167]
    ds_read_b64_tr_b16 v[242:243], v68 offset:29632
    v_mfma_f32_16x16x32_bf16 v[168:171], v[248:251], v[176:179], v[168:171]
    ds_read_b64_tr_b16 v[244:245], v68 offset:29152
    v_mfma_f32_16x16x32_bf16 v[172:175], v[248:251], v[180:183], v[172:175]
    ds_read_b64_tr_b16 v[246:247], v68 offset:29664
    s_waitcnt lgkmcnt(8)
    s_waitcnt vmcnt(9)
    v_mfma_f32_16x16x32_bf16 v[128:131], v[224:227], v[184:187], v[128:131]
    ds_read_b64_tr_b16 v[248:249], v69 offset:29120
    s_waitcnt vmcnt(8)
    v_mfma_f32_16x16x32_bf16 v[132:135], v[224:227], v[188:191], v[132:135]
    ds_read_b64_tr_b16 v[250:251], v69 offset:29632
    s_add_u32 s96, s85, 6
    s_and_b32 s97, s96, 15
    s_lshl_b32 s98, s97, 14
    s_add_u32 s16, s98, s15
    buffer_load_dwordx4 v[176:179], v2, s[32:35], s16 offen sc1
    v_mfma_f32_16x16x32_bf16 v[136:139], v[228:231], v[184:187], v[136:139]
    ds_read_b64_tr_b16 v[224:225], v69 offset:29152
    v_mfma_f32_16x16x32_bf16 v[140:143], v[228:231], v[188:191], v[140:143]
    ds_read_b64_tr_b16 v[226:227], v69 offset:29664
    s_waitcnt lgkmcnt(8)
    v_mfma_f32_16x16x32_bf16 v[112:115], v[232:235], v[184:187], v[112:115]
    ds_read_b64_tr_b16 v[228:229], v68 offset:45760
    v_mfma_f32_16x16x32_bf16 v[116:119], v[232:235], v[188:191], v[116:119]
    ds_read_b64_tr_b16 v[230:231], v68 offset:46272
    v_mfma_f32_16x16x32_bf16 v[120:123], v[236:239], v[184:187], v[120:123]
    ds_read_b64_tr_b16 v[232:233], v68 offset:45792
    v_mfma_f32_16x16x32_bf16 v[124:127], v[236:239], v[188:191], v[124:127]
    ds_read_b64_tr_b16 v[234:235], v68 offset:46304
    buffer_load_dwordx4 v[180:183], v2, s[32:35], s16 offen offset:1024 sc1
    s_waitcnt lgkmcnt(8)
    v_mfma_f32_16x16x32_bf16 v[80:83], v[240:243], v[184:187], v[80:83]
    ds_read_b64_tr_b16 v[236:237], v69 offset:45760
    v_mfma_f32_16x16x32_bf16 v[84:87], v[240:243], v[188:191], v[84:87]
    ds_read_b64_tr_b16 v[238:239], v69 offset:46272
    v_mfma_f32_16x16x32_bf16 v[88:91], v[244:247], v[184:187], v[88:91]
    ds_read_b64_tr_b16 v[240:241], v69 offset:45792
    v_mfma_f32_16x16x32_bf16 v[92:95], v[244:247], v[188:191], v[92:95]
    ds_read_b64_tr_b16 v[242:243], v69 offset:46304
    s_waitcnt lgkmcnt(8)
    v_mfma_f32_16x16x32_bf16 v[96:99], v[248:251], v[184:187], v[96:99]
    s_barrier
    ds_read_b64_tr_b16 v[244:245], v71 offset:8320
    v_mfma_f32_16x16x32_bf16 v[100:103], v[248:251], v[188:191], v[100:103]
    ds_read_b64_tr_b16 v[246:247], v71 offset:8832
    v_mfma_f32_16x16x32_bf16 v[104:107], v[224:227], v[184:187], v[104:107]
    ds_read_b64_tr_b16 v[248:249], v71 offset:8352
    v_mfma_f32_16x16x32_bf16 v[108:111], v[224:227], v[188:191], v[108:111]
    ds_read_b64_tr_b16 v[250:251], v71 offset:8864
    s_waitcnt lgkmcnt(8)
    v_mfma_f32_16x16x32_bf16 v[144:147], v[228:231], v[184:187], v[144:147]
    ds_read_b64_tr_b16 v[224:225], v70 offset:8320
    v_mfma_f32_16x16x32_bf16 v[148:151], v[228:231], v[188:191], v[148:151]
    ds_read_b64_tr_b16 v[226:227], v70 offset:8832
    v_mfma_f32_16x16x32_bf16 v[152:155], v[232:235], v[184:187], v[152:155]
    ds_read_b64_tr_b16 v[228:229], v70 offset:8352
    v_mfma_f32_16x16x32_bf16 v[156:159], v[232:235], v[188:191], v[156:159]
    ds_read_b64_tr_b16 v[230:231], v70 offset:8864
    s_waitcnt lgkmcnt(8)
    v_mfma_f32_16x16x32_bf16 v[160:163], v[236:239], v[184:187], v[160:163]
    ds_read_b64_tr_b16 v[232:233], v70
    v_mfma_f32_16x16x32_bf16 v[164:167], v[236:239], v[188:191], v[164:167]
    ds_read_b64_tr_b16 v[234:235], v70 offset:512
    v_mfma_f32_16x16x32_bf16 v[168:171], v[240:243], v[184:187], v[168:171]
    ds_read_b64_tr_b16 v[236:237], v70 offset:32
    v_mfma_f32_16x16x32_bf16 v[172:175], v[240:243], v[188:191], v[172:175]
    ds_read_b64_tr_b16 v[238:239], v70 offset:544
    s_waitcnt lgkmcnt(8)
    s_waitcnt vmcnt(9)
    v_mfma_f32_16x16x32_bf16 v[128:131], v[244:247], v[192:195], v[128:131]
    ds_read_b64_tr_b16 v[240:241], v71
    s_waitcnt vmcnt(8)
    v_mfma_f32_16x16x32_bf16 v[132:135], v[244:247], v[196:199], v[132:135]
    ds_read_b64_tr_b16 v[242:243], v71 offset:512
    buffer_load_dwordx4 v[184:187], v2, s[32:35], s16 offen offset:2048 sc1
    v_mfma_f32_16x16x32_bf16 v[136:139], v[248:251], v[192:195], v[136:139]
    ds_read_b64_tr_b16 v[244:245], v71 offset:32
    v_mfma_f32_16x16x32_bf16 v[140:143], v[248:251], v[196:199], v[140:143]
    ds_read_b64_tr_b16 v[246:247], v71 offset:544
    s_waitcnt lgkmcnt(8)
    v_mfma_f32_16x16x32_bf16 v[112:115], v[224:227], v[192:195], v[112:115]
    ds_read_b64_tr_b16 v[248:249], v70 offset:16640
    v_mfma_f32_16x16x32_bf16 v[116:119], v[224:227], v[196:199], v[116:119]
    ds_read_b64_tr_b16 v[250:251], v70 offset:17152
    v_mfma_f32_16x16x32_bf16 v[120:123], v[228:231], v[192:195], v[120:123]
    ds_read_b64_tr_b16 v[224:225], v70 offset:16672
    v_mfma_f32_16x16x32_bf16 v[124:127], v[228:231], v[196:199], v[124:127]
    ds_read_b64_tr_b16 v[226:227], v70 offset:17184
    buffer_load_dwordx4 v[188:191], v2, s[32:35], s16 offen offset:3072 sc1
    s_waitcnt lgkmcnt(8)
    v_mfma_f32_16x16x32_bf16 v[80:83], v[232:235], v[192:195], v[80:83]
    ds_read_b64_tr_b16 v[228:229], v71 offset:16640
    v_mfma_f32_16x16x32_bf16 v[84:87], v[232:235], v[196:199], v[84:87]
    ds_read_b64_tr_b16 v[230:231], v71 offset:17152
    v_mfma_f32_16x16x32_bf16 v[88:91], v[236:239], v[192:195], v[88:91]
    ds_read_b64_tr_b16 v[232:233], v71 offset:16672
    v_mfma_f32_16x16x32_bf16 v[92:95], v[236:239], v[196:199], v[92:95]
    ds_read_b64_tr_b16 v[234:235], v71 offset:17184
    s_waitcnt lgkmcnt(8)
    v_mfma_f32_16x16x32_bf16 v[96:99], v[240:243], v[192:195], v[96:99]
    ds_read_b64_tr_b16 v[236:237], v71 offset:12480
    v_mfma_f32_16x16x32_bf16 v[100:103], v[240:243], v[196:199], v[100:103]
    ds_read_b64_tr_b16 v[238:239], v71 offset:12992
    v_mfma_f32_16x16x32_bf16 v[104:107], v[244:247], v[192:195], v[104:107]
    ds_read_b64_tr_b16 v[240:241], v71 offset:12512
    v_mfma_f32_16x16x32_bf16 v[108:111], v[244:247], v[196:199], v[108:111]
    ds_read_b64_tr_b16 v[242:243], v71 offset:13024
    s_waitcnt lgkmcnt(8)
    v_mfma_f32_16x16x32_bf16 v[144:147], v[248:251], v[192:195], v[144:147]
    ds_read_b64_tr_b16 v[244:245], v70 offset:12480
    v_mfma_f32_16x16x32_bf16 v[148:151], v[248:251], v[196:199], v[148:151]
    ds_read_b64_tr_b16 v[246:247], v70 offset:12992
    v_mfma_f32_16x16x32_bf16 v[152:155], v[224:227], v[192:195], v[152:155]
    ds_read_b64_tr_b16 v[248:249], v70 offset:12512
    v_mfma_f32_16x16x32_bf16 v[156:159], v[224:227], v[196:199], v[156:159]
    ds_read_b64_tr_b16 v[250:251], v70 offset:13024
    s_waitcnt lgkmcnt(8)
    v_mfma_f32_16x16x32_bf16 v[160:163], v[228:231], v[192:195], v[160:163]
    ds_read_b64_tr_b16 v[224:225], v70 offset:4160
    v_mfma_f32_16x16x32_bf16 v[164:167], v[228:231], v[196:199], v[164:167]
    ds_read_b64_tr_b16 v[226:227], v70 offset:4672
    v_mfma_f32_16x16x32_bf16 v[168:171], v[232:235], v[192:195], v[168:171]
    ds_read_b64_tr_b16 v[228:229], v70 offset:4192
    v_mfma_f32_16x16x32_bf16 v[172:175], v[232:235], v[196:199], v[172:175]
    ds_read_b64_tr_b16 v[230:231], v70 offset:4704
    s_waitcnt lgkmcnt(8)
    s_waitcnt vmcnt(9)
    v_mfma_f32_16x16x32_bf16 v[128:131], v[236:239], v[200:203], v[128:131]
    ds_read_b64_tr_b16 v[232:233], v71 offset:4160
    s_waitcnt vmcnt(8)
    v_mfma_f32_16x16x32_bf16 v[132:135], v[236:239], v[204:207], v[132:135]
    ds_read_b64_tr_b16 v[234:235], v71 offset:4672
    s_add_u32 s96, s85, 7
    s_and_b32 s97, s96, 15
    s_lshl_b32 s98, s97, 14
    s_add_u32 s16, s98, s15
    buffer_load_dwordx4 v[192:195], v2, s[32:35], s16 offen sc1
    v_mfma_f32_16x16x32_bf16 v[136:139], v[240:243], v[200:203], v[136:139]
    ds_read_b64_tr_b16 v[236:237], v71 offset:4192
    v_mfma_f32_16x16x32_bf16 v[140:143], v[240:243], v[204:207], v[140:143]
    ds_read_b64_tr_b16 v[238:239], v71 offset:4704
    s_waitcnt lgkmcnt(8)
    v_mfma_f32_16x16x32_bf16 v[112:115], v[244:247], v[200:203], v[112:115]
    ds_read_b64_tr_b16 v[240:241], v70 offset:20800
    v_mfma_f32_16x16x32_bf16 v[116:119], v[244:247], v[204:207], v[116:119]
    ds_read_b64_tr_b16 v[242:243], v70 offset:21312
    v_mfma_f32_16x16x32_bf16 v[120:123], v[248:251], v[200:203], v[120:123]
    ds_read_b64_tr_b16 v[244:245], v70 offset:20832
    v_mfma_f32_16x16x32_bf16 v[124:127], v[248:251], v[204:207], v[124:127]
    ds_read_b64_tr_b16 v[246:247], v70 offset:21344
    buffer_load_dwordx4 v[196:199], v2, s[32:35], s16 offen offset:1024 sc1
    s_waitcnt lgkmcnt(8)
    v_mfma_f32_16x16x32_bf16 v[80:83], v[224:227], v[200:203], v[80:83]
    ds_read_b64_tr_b16 v[248:249], v71 offset:20800
    v_mfma_f32_16x16x32_bf16 v[84:87], v[224:227], v[204:207], v[84:87]
    ds_read_b64_tr_b16 v[250:251], v71 offset:21312
    v_mfma_f32_16x16x32_bf16 v[88:91], v[228:231], v[200:203], v[88:91]
    ds_read_b64_tr_b16 v[224:225], v71 offset:20832
    v_mfma_f32_16x16x32_bf16 v[92:95], v[228:231], v[204:207], v[92:95]
    ds_read_b64_tr_b16 v[226:227], v71 offset:21344
    s_waitcnt lgkmcnt(8)
    v_mfma_f32_16x16x32_bf16 v[96:99], v[232:235], v[200:203], v[96:99]
    s_barrier
    ds_read_b64_tr_b16 v[228:229], v71 offset:33280
    v_mfma_f32_16x16x32_bf16 v[100:103], v[232:235], v[204:207], v[100:103]
    ds_read_b64_tr_b16 v[230:231], v71 offset:33792
    v_mfma_f32_16x16x32_bf16 v[104:107], v[236:239], v[200:203], v[104:107]
    ds_read_b64_tr_b16 v[232:233], v71 offset:33312
    v_mfma_f32_16x16x32_bf16 v[108:111], v[236:239], v[204:207], v[108:111]
    ds_read_b64_tr_b16 v[234:235], v71 offset:33824
    s_waitcnt lgkmcnt(8)
    v_mfma_f32_16x16x32_bf16 v[144:147], v[240:243], v[200:203], v[144:147]
    ds_read_b64_tr_b16 v[236:237], v70 offset:33280
    v_mfma_f32_16x16x32_bf16 v[148:151], v[240:243], v[204:207], v[148:151]
    ds_read_b64_tr_b16 v[238:239], v70 offset:33792
    v_mfma_f32_16x16x32_bf16 v[152:155], v[244:247], v[200:203], v[152:155]
    ds_read_b64_tr_b16 v[240:241], v70 offset:33312
    v_mfma_f32_16x16x32_bf16 v[156:159], v[244:247], v[204:207], v[156:159]
    ds_read_b64_tr_b16 v[242:243], v70 offset:33824
    s_waitcnt lgkmcnt(8)
    v_mfma_f32_16x16x32_bf16 v[160:163], v[248:251], v[200:203], v[160:163]
    ds_read_b64_tr_b16 v[244:245], v70 offset:24960
    v_mfma_f32_16x16x32_bf16 v[164:167], v[248:251], v[204:207], v[164:167]
    ds_read_b64_tr_b16 v[246:247], v70 offset:25472
    v_mfma_f32_16x16x32_bf16 v[168:171], v[224:227], v[200:203], v[168:171]
    ds_read_b64_tr_b16 v[248:249], v70 offset:24992
    v_mfma_f32_16x16x32_bf16 v[172:175], v[224:227], v[204:207], v[172:175]
    ds_read_b64_tr_b16 v[250:251], v70 offset:25504
    s_waitcnt lgkmcnt(8)
    s_waitcnt vmcnt(9)
    v_mfma_f32_16x16x32_bf16 v[128:131], v[228:231], v[208:211], v[128:131]
    ds_read_b64_tr_b16 v[224:225], v71 offset:24960
    s_waitcnt vmcnt(8)
    v_mfma_f32_16x16x32_bf16 v[132:135], v[228:231], v[212:215], v[132:135]
    ds_read_b64_tr_b16 v[226:227], v71 offset:25472
    buffer_load_dwordx4 v[200:203], v2, s[32:35], s16 offen offset:2048 sc1
    v_mfma_f32_16x16x32_bf16 v[136:139], v[232:235], v[208:211], v[136:139]
    ds_read_b64_tr_b16 v[228:229], v71 offset:24992
    v_mfma_f32_16x16x32_bf16 v[140:143], v[232:235], v[212:215], v[140:143]
    ds_read_b64_tr_b16 v[230:231], v71 offset:25504
    s_waitcnt lgkmcnt(8)
    v_mfma_f32_16x16x32_bf16 v[112:115], v[236:239], v[208:211], v[112:115]
    ds_read_b64_tr_b16 v[232:233], v70 offset:41600
    v_mfma_f32_16x16x32_bf16 v[116:119], v[236:239], v[212:215], v[116:119]
    ds_read_b64_tr_b16 v[234:235], v70 offset:42112
    v_mfma_f32_16x16x32_bf16 v[120:123], v[240:243], v[208:211], v[120:123]
    ds_read_b64_tr_b16 v[236:237], v70 offset:41632
    v_mfma_f32_16x16x32_bf16 v[124:127], v[240:243], v[212:215], v[124:127]
    ds_read_b64_tr_b16 v[238:239], v70 offset:42144
    buffer_load_dwordx4 v[204:207], v2, s[32:35], s16 offen offset:3072 sc1
    s_waitcnt lgkmcnt(8)
    v_mfma_f32_16x16x32_bf16 v[80:83], v[244:247], v[208:211], v[80:83]
    ds_read_b64_tr_b16 v[240:241], v71 offset:41600
    v_mfma_f32_16x16x32_bf16 v[84:87], v[244:247], v[212:215], v[84:87]
    ds_read_b64_tr_b16 v[242:243], v71 offset:42112
    v_mfma_f32_16x16x32_bf16 v[88:91], v[248:251], v[208:211], v[88:91]
    ds_read_b64_tr_b16 v[244:245], v71 offset:41632
    v_mfma_f32_16x16x32_bf16 v[92:95], v[248:251], v[212:215], v[92:95]
    ds_read_b64_tr_b16 v[246:247], v71 offset:42144
    s_waitcnt lgkmcnt(8)
    v_mfma_f32_16x16x32_bf16 v[96:99], v[224:227], v[208:211], v[96:99]
    ds_read_b64_tr_b16 v[248:249], v71 offset:37440
    v_mfma_f32_16x16x32_bf16 v[100:103], v[224:227], v[212:215], v[100:103]
    ds_read_b64_tr_b16 v[250:251], v71 offset:37952
    v_mfma_f32_16x16x32_bf16 v[104:107], v[228:231], v[208:211], v[104:107]
    ds_read_b64_tr_b16 v[224:225], v71 offset:37472
    v_mfma_f32_16x16x32_bf16 v[108:111], v[228:231], v[212:215], v[108:111]
    ds_read_b64_tr_b16 v[226:227], v71 offset:37984
    s_waitcnt lgkmcnt(8)
    v_mfma_f32_16x16x32_bf16 v[144:147], v[232:235], v[208:211], v[144:147]
    ds_read_b64_tr_b16 v[228:229], v70 offset:37440
    v_mfma_f32_16x16x32_bf16 v[148:151], v[232:235], v[212:215], v[148:151]
    ds_read_b64_tr_b16 v[230:231], v70 offset:37952
    v_mfma_f32_16x16x32_bf16 v[152:155], v[236:239], v[208:211], v[152:155]
    ds_read_b64_tr_b16 v[232:233], v70 offset:37472
    v_mfma_f32_16x16x32_bf16 v[156:159], v[236:239], v[212:215], v[156:159]
    ds_read_b64_tr_b16 v[234:235], v70 offset:37984
    s_waitcnt lgkmcnt(8)
    v_mfma_f32_16x16x32_bf16 v[160:163], v[240:243], v[208:211], v[160:163]
    ds_read_b64_tr_b16 v[236:237], v70 offset:29120
    v_mfma_f32_16x16x32_bf16 v[164:167], v[240:243], v[212:215], v[164:167]
    ds_read_b64_tr_b16 v[238:239], v70 offset:29632
    v_mfma_f32_16x16x32_bf16 v[168:171], v[244:247], v[208:211], v[168:171]
    ds_read_b64_tr_b16 v[240:241], v70 offset:29152
    v_mfma_f32_16x16x32_bf16 v[172:175], v[244:247], v[212:215], v[172:175]
    ds_read_b64_tr_b16 v[242:243], v70 offset:29664
    s_waitcnt lgkmcnt(8)
    s_waitcnt vmcnt(9)
    v_mfma_f32_16x16x32_bf16 v[128:131], v[248:251], v[216:219], v[128:131]
    ds_read_b64_tr_b16 v[244:245], v71 offset:29120
    s_waitcnt vmcnt(8)
    v_mfma_f32_16x16x32_bf16 v[132:135], v[248:251], v[220:223], v[132:135]
    ds_read_b64_tr_b16 v[246:247], v71 offset:29632
    s_add_u32 s96, s85, 8
    s_and_b32 s97, s96, 15
    s_lshl_b32 s98, s97, 14
    s_add_u32 s16, s98, s15
    buffer_load_dwordx4 v[208:211], v2, s[32:35], s16 offen sc1
    v_mfma_f32_16x16x32_bf16 v[136:139], v[224:227], v[216:219], v[136:139]
    ds_read_b64_tr_b16 v[248:249], v71 offset:29152
    v_mfma_f32_16x16x32_bf16 v[140:143], v[224:227], v[220:223], v[140:143]
    ds_read_b64_tr_b16 v[250:251], v71 offset:29664
    s_waitcnt lgkmcnt(8)
    v_mfma_f32_16x16x32_bf16 v[112:115], v[228:231], v[216:219], v[112:115]
    ds_read_b64_tr_b16 v[224:225], v70 offset:45760
    v_mfma_f32_16x16x32_bf16 v[116:119], v[228:231], v[220:223], v[116:119]
    ds_read_b64_tr_b16 v[226:227], v70 offset:46272
    v_mfma_f32_16x16x32_bf16 v[120:123], v[232:235], v[216:219], v[120:123]
    ds_read_b64_tr_b16 v[228:229], v70 offset:45792
    v_mfma_f32_16x16x32_bf16 v[124:127], v[232:235], v[220:223], v[124:127]
    ds_read_b64_tr_b16 v[230:231], v70 offset:46304
    buffer_load_dwordx4 v[212:215], v2, s[32:35], s16 offen offset:1024 sc1
    s_waitcnt lgkmcnt(8)
    v_mfma_f32_16x16x32_bf16 v[80:83], v[236:239], v[216:219], v[80:83]
    ds_read_b64_tr_b16 v[232:233], v71 offset:45760
    v_mfma_f32_16x16x32_bf16 v[84:87], v[236:239], v[220:223], v[84:87]
    ds_read_b64_tr_b16 v[234:235], v71 offset:46272
    v_mfma_f32_16x16x32_bf16 v[88:91], v[240:243], v[216:219], v[88:91]
    ds_read_b64_tr_b16 v[236:237], v71 offset:45792
    v_mfma_f32_16x16x32_bf16 v[92:95], v[240:243], v[220:223], v[92:95]
    ds_read_b64_tr_b16 v[238:239], v71 offset:46304
    s_waitcnt lgkmcnt(8)
    v_mfma_f32_16x16x32_bf16 v[96:99], v[244:247], v[216:219], v[96:99]
    s_barrier
    ds_read_b64_tr_b16 v[240:241], v67 offset:8320
    v_mfma_f32_16x16x32_bf16 v[100:103], v[244:247], v[220:223], v[100:103]
    ds_read_b64_tr_b16 v[242:243], v67 offset:8832
    v_mfma_f32_16x16x32_bf16 v[104:107], v[248:251], v[216:219], v[104:107]
    ds_read_b64_tr_b16 v[244:245], v67 offset:8352
    v_mfma_f32_16x16x32_bf16 v[108:111], v[248:251], v[220:223], v[108:111]
    ds_read_b64_tr_b16 v[246:247], v67 offset:8864
    s_waitcnt lgkmcnt(8)
    v_mfma_f32_16x16x32_bf16 v[144:147], v[224:227], v[216:219], v[144:147]
    ds_read_b64_tr_b16 v[248:249], v66 offset:8320
    v_mfma_f32_16x16x32_bf16 v[148:151], v[224:227], v[220:223], v[148:151]
    ds_read_b64_tr_b16 v[250:251], v66 offset:8832
    v_mfma_f32_16x16x32_bf16 v[152:155], v[228:231], v[216:219], v[152:155]
    ds_read_b64_tr_b16 v[224:225], v66 offset:8352
    v_mfma_f32_16x16x32_bf16 v[156:159], v[228:231], v[220:223], v[156:159]
    ds_read_b64_tr_b16 v[226:227], v66 offset:8864
    s_waitcnt lgkmcnt(8)
    v_mfma_f32_16x16x32_bf16 v[160:163], v[232:235], v[216:219], v[160:163]
    ds_read_b64_tr_b16 v[228:229], v66
    v_mfma_f32_16x16x32_bf16 v[164:167], v[232:235], v[220:223], v[164:167]
    ds_read_b64_tr_b16 v[230:231], v66 offset:512
    v_mfma_f32_16x16x32_bf16 v[168:171], v[236:239], v[216:219], v[168:171]
    ds_read_b64_tr_b16 v[232:233], v66 offset:32
    v_mfma_f32_16x16x32_bf16 v[172:175], v[236:239], v[220:223], v[172:175]
    ds_read_b64_tr_b16 v[234:235], v66 offset:544
    s_waitcnt lgkmcnt(8)
    s_waitcnt vmcnt(9)
    v_mfma_f32_16x16x32_bf16 v[128:131], v[240:243], v[176:179], v[128:131]
    ds_read_b64_tr_b16 v[236:237], v67
    s_waitcnt vmcnt(8)
    v_mfma_f32_16x16x32_bf16 v[132:135], v[240:243], v[180:183], v[132:135]
    ds_read_b64_tr_b16 v[238:239], v67 offset:512
    buffer_load_dwordx4 v[216:219], v2, s[32:35], s16 offen offset:2048 sc1
    v_mfma_f32_16x16x32_bf16 v[136:139], v[244:247], v[176:179], v[136:139]
    ds_read_b64_tr_b16 v[240:241], v67 offset:32
    v_mfma_f32_16x16x32_bf16 v[140:143], v[244:247], v[180:183], v[140:143]
    ds_read_b64_tr_b16 v[242:243], v67 offset:544
    s_waitcnt lgkmcnt(8)
    v_mfma_f32_16x16x32_bf16 v[112:115], v[248:251], v[176:179], v[112:115]
    ds_read_b64_tr_b16 v[244:245], v66 offset:16640
    v_mfma_f32_16x16x32_bf16 v[116:119], v[248:251], v[180:183], v[116:119]
    ds_read_b64_tr_b16 v[246:247], v66 offset:17152
    v_mfma_f32_16x16x32_bf16 v[120:123], v[224:227], v[176:179], v[120:123]
    ds_read_b64_tr_b16 v[248:249], v66 offset:16672
    v_mfma_f32_16x16x32_bf16 v[124:127], v[224:227], v[180:183], v[124:127]
    ds_read_b64_tr_b16 v[250:251], v66 offset:17184
    buffer_load_dwordx4 v[220:223], v2, s[32:35], s16 offen offset:3072 sc1
    s_waitcnt lgkmcnt(8)
    v_mfma_f32_16x16x32_bf16 v[80:83], v[228:231], v[176:179], v[80:83]
    ds_read_b64_tr_b16 v[224:225], v67 offset:16640
    v_mfma_f32_16x16x32_bf16 v[84:87], v[228:231], v[180:183], v[84:87]
    ds_read_b64_tr_b16 v[226:227], v67 offset:17152
    v_mfma_f32_16x16x32_bf16 v[88:91], v[232:235], v[176:179], v[88:91]
    ds_read_b64_tr_b16 v[228:229], v67 offset:16672
    v_mfma_f32_16x16x32_bf16 v[92:95], v[232:235], v[180:183], v[92:95]
    ds_read_b64_tr_b16 v[230:231], v67 offset:17184
    s_waitcnt lgkmcnt(8)
    v_mfma_f32_16x16x32_bf16 v[96:99], v[236:239], v[176:179], v[96:99]
    ds_read_b64_tr_b16 v[232:233], v67 offset:12480
    v_mfma_f32_16x16x32_bf16 v[100:103], v[236:239], v[180:183], v[100:103]
    ds_read_b64_tr_b16 v[234:235], v67 offset:12992
    v_mfma_f32_16x16x32_bf16 v[104:107], v[240:243], v[176:179], v[104:107]
    ds_read_b64_tr_b16 v[236:237], v67 offset:12512
    v_mfma_f32_16x16x32_bf16 v[108:111], v[240:243], v[180:183], v[108:111]
    ds_read_b64_tr_b16 v[238:239], v67 offset:13024
    s_waitcnt lgkmcnt(8)
    v_mfma_f32_16x16x32_bf16 v[144:147], v[244:247], v[176:179], v[144:147]
    ds_read_b64_tr_b16 v[240:241], v66 offset:12480
    v_mfma_f32_16x16x32_bf16 v[148:151], v[244:247], v[180:183], v[148:151]
    ds_read_b64_tr_b16 v[242:243], v66 offset:12992
    v_mfma_f32_16x16x32_bf16 v[152:155], v[248:251], v[176:179], v[152:155]
    ds_read_b64_tr_b16 v[244:245], v66 offset:12512
    v_mfma_f32_16x16x32_bf16 v[156:159], v[248:251], v[180:183], v[156:159]
    ds_read_b64_tr_b16 v[246:247], v66 offset:13024
    s_waitcnt lgkmcnt(8)
    v_mfma_f32_16x16x32_bf16 v[160:163], v[224:227], v[176:179], v[160:163]
    ds_read_b64_tr_b16 v[248:249], v66 offset:4160
    v_mfma_f32_16x16x32_bf16 v[164:167], v[224:227], v[180:183], v[164:167]
    ds_read_b64_tr_b16 v[250:251], v66 offset:4672
    v_mfma_f32_16x16x32_bf16 v[168:171], v[228:231], v[176:179], v[168:171]
    ds_read_b64_tr_b16 v[224:225], v66 offset:4192
    v_mfma_f32_16x16x32_bf16 v[172:175], v[228:231], v[180:183], v[172:175]
    ds_read_b64_tr_b16 v[226:227], v66 offset:4704
    s_waitcnt lgkmcnt(8)
    s_waitcnt vmcnt(9)
    v_mfma_f32_16x16x32_bf16 v[128:131], v[232:235], v[184:187], v[128:131]
    ds_read_b64_tr_b16 v[228:229], v67 offset:4160
    s_waitcnt vmcnt(8)
    v_mfma_f32_16x16x32_bf16 v[132:135], v[232:235], v[188:191], v[132:135]
    ds_read_b64_tr_b16 v[230:231], v67 offset:4672
    s_add_u32 s96, s85, 9
    s_and_b32 s97, s96, 15
    s_lshl_b32 s98, s97, 14
    s_add_u32 s16, s98, s15
    buffer_load_dwordx4 v[176:179], v2, s[32:35], s16 offen sc1
    v_mfma_f32_16x16x32_bf16 v[136:139], v[236:239], v[184:187], v[136:139]
    ds_read_b64_tr_b16 v[232:233], v67 offset:4192
    v_mfma_f32_16x16x32_bf16 v[140:143], v[236:239], v[188:191], v[140:143]
    ds_read_b64_tr_b16 v[234:235], v67 offset:4704
    s_waitcnt lgkmcnt(8)
    v_mfma_f32_16x16x32_bf16 v[112:115], v[240:243], v[184:187], v[112:115]
    ds_read_b64_tr_b16 v[236:237], v66 offset:20800
    v_mfma_f32_16x16x32_bf16 v[116:119], v[240:243], v[188:191], v[116:119]
    ds_read_b64_tr_b16 v[238:239], v66 offset:21312
    v_mfma_f32_16x16x32_bf16 v[120:123], v[244:247], v[184:187], v[120:123]
    ds_read_b64_tr_b16 v[240:241], v66 offset:20832
    v_mfma_f32_16x16x32_bf16 v[124:127], v[244:247], v[188:191], v[124:127]
    ds_read_b64_tr_b16 v[242:243], v66 offset:21344
    buffer_load_dwordx4 v[180:183], v2, s[32:35], s16 offen offset:1024 sc1
    s_waitcnt lgkmcnt(8)
    v_mfma_f32_16x16x32_bf16 v[80:83], v[248:251], v[184:187], v[80:83]
    ds_read_b64_tr_b16 v[244:245], v67 offset:20800
    v_mfma_f32_16x16x32_bf16 v[84:87], v[248:251], v[188:191], v[84:87]
    ds_read_b64_tr_b16 v[246:247], v67 offset:21312
    v_mfma_f32_16x16x32_bf16 v[88:91], v[224:227], v[184:187], v[88:91]
    ds_read_b64_tr_b16 v[248:249], v67 offset:20832
    v_mfma_f32_16x16x32_bf16 v[92:95], v[224:227], v[188:191], v[92:95]
    ds_read_b64_tr_b16 v[250:251], v67 offset:21344
    s_waitcnt lgkmcnt(8)
    v_mfma_f32_16x16x32_bf16 v[96:99], v[228:231], v[184:187], v[96:99]
    s_barrier
    ds_read_b64_tr_b16 v[224:225], v67 offset:33280
    v_mfma_f32_16x16x32_bf16 v[100:103], v[228:231], v[188:191], v[100:103]
    ds_read_b64_tr_b16 v[226:227], v67 offset:33792
    v_mfma_f32_16x16x32_bf16 v[104:107], v[232:235], v[184:187], v[104:107]
    ds_read_b64_tr_b16 v[228:229], v67 offset:33312
    v_mfma_f32_16x16x32_bf16 v[108:111], v[232:235], v[188:191], v[108:111]
    ds_read_b64_tr_b16 v[230:231], v67 offset:33824
    s_waitcnt lgkmcnt(8)
    v_mfma_f32_16x16x32_bf16 v[144:147], v[236:239], v[184:187], v[144:147]
    ds_read_b64_tr_b16 v[232:233], v66 offset:33280
    v_mfma_f32_16x16x32_bf16 v[148:151], v[236:239], v[188:191], v[148:151]
    ds_read_b64_tr_b16 v[234:235], v66 offset:33792
    v_mfma_f32_16x16x32_bf16 v[152:155], v[240:243], v[184:187], v[152:155]
    ds_read_b64_tr_b16 v[236:237], v66 offset:33312
    v_mfma_f32_16x16x32_bf16 v[156:159], v[240:243], v[188:191], v[156:159]
    ds_read_b64_tr_b16 v[238:239], v66 offset:33824
    s_waitcnt lgkmcnt(8)
    v_mfma_f32_16x16x32_bf16 v[160:163], v[244:247], v[184:187], v[160:163]
    ds_read_b64_tr_b16 v[240:241], v66 offset:24960
    v_mfma_f32_16x16x32_bf16 v[164:167], v[244:247], v[188:191], v[164:167]
    ds_read_b64_tr_b16 v[242:243], v66 offset:25472
    v_mfma_f32_16x16x32_bf16 v[168:171], v[248:251], v[184:187], v[168:171]
    ds_read_b64_tr_b16 v[244:245], v66 offset:24992
    v_mfma_f32_16x16x32_bf16 v[172:175], v[248:251], v[188:191], v[172:175]
    ds_read_b64_tr_b16 v[246:247], v66 offset:25504
    s_waitcnt lgkmcnt(8)
    s_waitcnt vmcnt(9)
    v_mfma_f32_16x16x32_bf16 v[128:131], v[224:227], v[192:195], v[128:131]
    ds_read_b64_tr_b16 v[248:249], v67 offset:24960
    s_waitcnt vmcnt(8)
    v_mfma_f32_16x16x32_bf16 v[132:135], v[224:227], v[196:199], v[132:135]
    ds_read_b64_tr_b16 v[250:251], v67 offset:25472
    buffer_load_dwordx4 v[184:187], v2, s[32:35], s16 offen offset:2048 sc1
    v_mfma_f32_16x16x32_bf16 v[136:139], v[228:231], v[192:195], v[136:139]
    ds_read_b64_tr_b16 v[224:225], v67 offset:24992
    v_mfma_f32_16x16x32_bf16 v[140:143], v[228:231], v[196:199], v[140:143]
    ds_read_b64_tr_b16 v[226:227], v67 offset:25504
    s_waitcnt lgkmcnt(8)
    v_mfma_f32_16x16x32_bf16 v[112:115], v[232:235], v[192:195], v[112:115]
    ds_read_b64_tr_b16 v[228:229], v66 offset:41600
    v_mfma_f32_16x16x32_bf16 v[116:119], v[232:235], v[196:199], v[116:119]
    ds_read_b64_tr_b16 v[230:231], v66 offset:42112
    v_mfma_f32_16x16x32_bf16 v[120:123], v[236:239], v[192:195], v[120:123]
    ds_read_b64_tr_b16 v[232:233], v66 offset:41632
    v_mfma_f32_16x16x32_bf16 v[124:127], v[236:239], v[196:199], v[124:127]
    ds_read_b64_tr_b16 v[234:235], v66 offset:42144
    buffer_load_dwordx4 v[188:191], v2, s[32:35], s16 offen offset:3072 sc1
    s_waitcnt lgkmcnt(8)
    v_mfma_f32_16x16x32_bf16 v[80:83], v[240:243], v[192:195], v[80:83]
    ds_read_b64_tr_b16 v[236:237], v67 offset:41600
    v_mfma_f32_16x16x32_bf16 v[84:87], v[240:243], v[196:199], v[84:87]
    ds_read_b64_tr_b16 v[238:239], v67 offset:42112
    v_mfma_f32_16x16x32_bf16 v[88:91], v[244:247], v[192:195], v[88:91]
    ds_read_b64_tr_b16 v[240:241], v67 offset:41632
    v_mfma_f32_16x16x32_bf16 v[92:95], v[244:247], v[196:199], v[92:95]
    ds_read_b64_tr_b16 v[242:243], v67 offset:42144
    s_waitcnt lgkmcnt(8)
    v_mfma_f32_16x16x32_bf16 v[96:99], v[248:251], v[192:195], v[96:99]
    ds_read_b64_tr_b16 v[244:245], v67 offset:37440
    v_mfma_f32_16x16x32_bf16 v[100:103], v[248:251], v[196:199], v[100:103]
    ds_read_b64_tr_b16 v[246:247], v67 offset:37952
    v_mfma_f32_16x16x32_bf16 v[104:107], v[224:227], v[192:195], v[104:107]
    ds_read_b64_tr_b16 v[248:249], v67 offset:37472
    v_mfma_f32_16x16x32_bf16 v[108:111], v[224:227], v[196:199], v[108:111]
    ds_read_b64_tr_b16 v[250:251], v67 offset:37984
    s_waitcnt lgkmcnt(8)
    v_mfma_f32_16x16x32_bf16 v[144:147], v[228:231], v[192:195], v[144:147]
    ds_read_b64_tr_b16 v[224:225], v66 offset:37440
    v_mfma_f32_16x16x32_bf16 v[148:151], v[228:231], v[196:199], v[148:151]
    ds_read_b64_tr_b16 v[226:227], v66 offset:37952
    v_mfma_f32_16x16x32_bf16 v[152:155], v[232:235], v[192:195], v[152:155]
    ds_read_b64_tr_b16 v[228:229], v66 offset:37472
    v_mfma_f32_16x16x32_bf16 v[156:159], v[232:235], v[196:199], v[156:159]
    ds_read_b64_tr_b16 v[230:231], v66 offset:37984
    s_waitcnt lgkmcnt(8)
    v_mfma_f32_16x16x32_bf16 v[160:163], v[236:239], v[192:195], v[160:163]
    ds_read_b64_tr_b16 v[232:233], v66 offset:29120
    v_mfma_f32_16x16x32_bf16 v[164:167], v[236:239], v[196:199], v[164:167]
    ds_read_b64_tr_b16 v[234:235], v66 offset:29632
    v_mfma_f32_16x16x32_bf16 v[168:171], v[240:243], v[192:195], v[168:171]
    ds_read_b64_tr_b16 v[236:237], v66 offset:29152
    v_mfma_f32_16x16x32_bf16 v[172:175], v[240:243], v[196:199], v[172:175]
    ds_read_b64_tr_b16 v[238:239], v66 offset:29664
    s_waitcnt lgkmcnt(8)
    s_waitcnt vmcnt(9)
    v_mfma_f32_16x16x32_bf16 v[128:131], v[244:247], v[200:203], v[128:131]
    ds_read_b64_tr_b16 v[240:241], v67 offset:29120
    s_waitcnt vmcnt(8)
    v_mfma_f32_16x16x32_bf16 v[132:135], v[244:247], v[204:207], v[132:135]
    ds_read_b64_tr_b16 v[242:243], v67 offset:29632
    s_add_u32 s96, s85, 10
    s_and_b32 s97, s96, 15
    s_lshl_b32 s98, s97, 14
    s_add_u32 s16, s98, s15
    buffer_load_dwordx4 v[192:195], v2, s[32:35], s16 offen sc1
    v_mfma_f32_16x16x32_bf16 v[136:139], v[248:251], v[200:203], v[136:139]
    ds_read_b64_tr_b16 v[244:245], v67 offset:29152
    v_mfma_f32_16x16x32_bf16 v[140:143], v[248:251], v[204:207], v[140:143]
    ds_read_b64_tr_b16 v[246:247], v67 offset:29664
    s_waitcnt lgkmcnt(8)
    v_mfma_f32_16x16x32_bf16 v[112:115], v[224:227], v[200:203], v[112:115]
    ds_read_b64_tr_b16 v[248:249], v66 offset:45760
    v_mfma_f32_16x16x32_bf16 v[116:119], v[224:227], v[204:207], v[116:119]
    ds_read_b64_tr_b16 v[250:251], v66 offset:46272
    v_mfma_f32_16x16x32_bf16 v[120:123], v[228:231], v[200:203], v[120:123]
    ds_read_b64_tr_b16 v[224:225], v66 offset:45792
    v_mfma_f32_16x16x32_bf16 v[124:127], v[228:231], v[204:207], v[124:127]
    ds_read_b64_tr_b16 v[226:227], v66 offset:46304
    buffer_load_dwordx4 v[196:199], v2, s[32:35], s16 offen offset:1024 sc1
    s_waitcnt lgkmcnt(8)
    v_mfma_f32_16x16x32_bf16 v[80:83], v[232:235], v[200:203], v[80:83]
    ds_read_b64_tr_b16 v[228:229], v67 offset:45760
    v_mfma_f32_16x16x32_bf16 v[84:87], v[232:235], v[204:207], v[84:87]
    ds_read_b64_tr_b16 v[230:231], v67 offset:46272
    v_mfma_f32_16x16x32_bf16 v[88:91], v[236:239], v[200:203], v[88:91]
    ds_read_b64_tr_b16 v[232:233], v67 offset:45792
    v_mfma_f32_16x16x32_bf16 v[92:95], v[236:239], v[204:207], v[92:95]
    ds_read_b64_tr_b16 v[234:235], v67 offset:46304
    s_waitcnt lgkmcnt(8)
    v_mfma_f32_16x16x32_bf16 v[96:99], v[240:243], v[200:203], v[96:99]
    s_barrier
    ds_read_b64_tr_b16 v[236:237], v69 offset:8320
    v_mfma_f32_16x16x32_bf16 v[100:103], v[240:243], v[204:207], v[100:103]
    ds_read_b64_tr_b16 v[238:239], v69 offset:8832
    v_mfma_f32_16x16x32_bf16 v[104:107], v[244:247], v[200:203], v[104:107]
    ds_read_b64_tr_b16 v[240:241], v69 offset:8352
    v_mfma_f32_16x16x32_bf16 v[108:111], v[244:247], v[204:207], v[108:111]
    ds_read_b64_tr_b16 v[242:243], v69 offset:8864
    s_waitcnt lgkmcnt(8)
    v_mfma_f32_16x16x32_bf16 v[144:147], v[248:251], v[200:203], v[144:147]
    ds_read_b64_tr_b16 v[244:245], v68 offset:8320
    v_mfma_f32_16x16x32_bf16 v[148:151], v[248:251], v[204:207], v[148:151]
    ds_read_b64_tr_b16 v[246:247], v68 offset:8832
    v_mfma_f32_16x16x32_bf16 v[152:155], v[224:227], v[200:203], v[152:155]
    ds_read_b64_tr_b16 v[248:249], v68 offset:8352
    v_mfma_f32_16x16x32_bf16 v[156:159], v[224:227], v[204:207], v[156:159]
    ds_read_b64_tr_b16 v[250:251], v68 offset:8864
    s_waitcnt lgkmcnt(8)
    v_mfma_f32_16x16x32_bf16 v[160:163], v[228:231], v[200:203], v[160:163]
    ds_read_b64_tr_b16 v[224:225], v68
    v_mfma_f32_16x16x32_bf16 v[164:167], v[228:231], v[204:207], v[164:167]
    ds_read_b64_tr_b16 v[226:227], v68 offset:512
    v_mfma_f32_16x16x32_bf16 v[168:171], v[232:235], v[200:203], v[168:171]
    ds_read_b64_tr_b16 v[228:229], v68 offset:32
    v_mfma_f32_16x16x32_bf16 v[172:175], v[232:235], v[204:207], v[172:175]
    ds_read_b64_tr_b16 v[230:231], v68 offset:544
    s_waitcnt lgkmcnt(8)
    s_waitcnt vmcnt(9)
    v_mfma_f32_16x16x32_bf16 v[128:131], v[236:239], v[208:211], v[128:131]
    ds_read_b64_tr_b16 v[232:233], v69
    s_waitcnt vmcnt(8)
    v_mfma_f32_16x16x32_bf16 v[132:135], v[236:239], v[212:215], v[132:135]
    ds_read_b64_tr_b16 v[234:235], v69 offset:512
    buffer_load_dwordx4 v[200:203], v2, s[32:35], s16 offen offset:2048 sc1
    v_mfma_f32_16x16x32_bf16 v[136:139], v[240:243], v[208:211], v[136:139]
    ds_read_b64_tr_b16 v[236:237], v69 offset:32
    v_mfma_f32_16x16x32_bf16 v[140:143], v[240:243], v[212:215], v[140:143]
    ds_read_b64_tr_b16 v[238:239], v69 offset:544
    s_waitcnt lgkmcnt(8)
    v_mfma_f32_16x16x32_bf16 v[112:115], v[244:247], v[208:211], v[112:115]
    ds_read_b64_tr_b16 v[240:241], v68 offset:16640
    v_mfma_f32_16x16x32_bf16 v[116:119], v[244:247], v[212:215], v[116:119]
    ds_read_b64_tr_b16 v[242:243], v68 offset:17152
    v_mfma_f32_16x16x32_bf16 v[120:123], v[248:251], v[208:211], v[120:123]
    ds_read_b64_tr_b16 v[244:245], v68 offset:16672
    v_mfma_f32_16x16x32_bf16 v[124:127], v[248:251], v[212:215], v[124:127]
    ds_read_b64_tr_b16 v[246:247], v68 offset:17184
    buffer_load_dwordx4 v[204:207], v2, s[32:35], s16 offen offset:3072 sc1
    s_waitcnt lgkmcnt(8)
    v_mfma_f32_16x16x32_bf16 v[80:83], v[224:227], v[208:211], v[80:83]
    ds_read_b64_tr_b16 v[248:249], v69 offset:16640
    v_mfma_f32_16x16x32_bf16 v[84:87], v[224:227], v[212:215], v[84:87]
    ds_read_b64_tr_b16 v[250:251], v69 offset:17152
    v_mfma_f32_16x16x32_bf16 v[88:91], v[228:231], v[208:211], v[88:91]
    ds_read_b64_tr_b16 v[224:225], v69 offset:16672
    v_mfma_f32_16x16x32_bf16 v[92:95], v[228:231], v[212:215], v[92:95]
    ds_read_b64_tr_b16 v[226:227], v69 offset:17184
    s_waitcnt lgkmcnt(8)
    v_mfma_f32_16x16x32_bf16 v[96:99], v[232:235], v[208:211], v[96:99]
    ds_read_b64_tr_b16 v[228:229], v69 offset:12480
    v_mfma_f32_16x16x32_bf16 v[100:103], v[232:235], v[212:215], v[100:103]
    ds_read_b64_tr_b16 v[230:231], v69 offset:12992
    v_mfma_f32_16x16x32_bf16 v[104:107], v[236:239], v[208:211], v[104:107]
    ds_read_b64_tr_b16 v[232:233], v69 offset:12512
    v_mfma_f32_16x16x32_bf16 v[108:111], v[236:239], v[212:215], v[108:111]
    ds_read_b64_tr_b16 v[234:235], v69 offset:13024
    s_waitcnt lgkmcnt(8)
    v_mfma_f32_16x16x32_bf16 v[144:147], v[240:243], v[208:211], v[144:147]
    ds_read_b64_tr_b16 v[236:237], v68 offset:12480
    v_mfma_f32_16x16x32_bf16 v[148:151], v[240:243], v[212:215], v[148:151]
    ds_read_b64_tr_b16 v[238:239], v68 offset:12992
    v_mfma_f32_16x16x32_bf16 v[152:155], v[244:247], v[208:211], v[152:155]
    ds_read_b64_tr_b16 v[240:241], v68 offset:12512
    v_mfma_f32_16x16x32_bf16 v[156:159], v[244:247], v[212:215], v[156:159]
    ds_read_b64_tr_b16 v[242:243], v68 offset:13024
    s_waitcnt lgkmcnt(8)
    v_mfma_f32_16x16x32_bf16 v[160:163], v[248:251], v[208:211], v[160:163]
    ds_read_b64_tr_b16 v[244:245], v68 offset:4160
    v_mfma_f32_16x16x32_bf16 v[164:167], v[248:251], v[212:215], v[164:167]
    ds_read_b64_tr_b16 v[246:247], v68 offset:4672
    v_mfma_f32_16x16x32_bf16 v[168:171], v[224:227], v[208:211], v[168:171]
    ds_read_b64_tr_b16 v[248:249], v68 offset:4192
    v_mfma_f32_16x16x32_bf16 v[172:175], v[224:227], v[212:215], v[172:175]
    ds_read_b64_tr_b16 v[250:251], v68 offset:4704
    s_waitcnt lgkmcnt(8)
    s_waitcnt vmcnt(9)
    v_mfma_f32_16x16x32_bf16 v[128:131], v[228:231], v[216:219], v[128:131]
    ds_read_b64_tr_b16 v[224:225], v69 offset:4160
    s_waitcnt vmcnt(8)
    v_mfma_f32_16x16x32_bf16 v[132:135], v[228:231], v[220:223], v[132:135]
    ds_read_b64_tr_b16 v[226:227], v69 offset:4672
    s_add_u32 s96, s85, 11
    s_and_b32 s97, s96, 15
    s_lshl_b32 s98, s97, 14
    s_add_u32 s16, s98, s15
    buffer_load_dwordx4 v[208:211], v2, s[32:35], s16 offen sc1
    v_mfma_f32_16x16x32_bf16 v[136:139], v[232:235], v[216:219], v[136:139]
    ds_read_b64_tr_b16 v[228:229], v69 offset:4192
    v_mfma_f32_16x16x32_bf16 v[140:143], v[232:235], v[220:223], v[140:143]
    ds_read_b64_tr_b16 v[230:231], v69 offset:4704
    s_waitcnt lgkmcnt(8)
    v_mfma_f32_16x16x32_bf16 v[112:115], v[236:239], v[216:219], v[112:115]
    ds_read_b64_tr_b16 v[232:233], v68 offset:20800
    v_mfma_f32_16x16x32_bf16 v[116:119], v[236:239], v[220:223], v[116:119]
    ds_read_b64_tr_b16 v[234:235], v68 offset:21312
    v_mfma_f32_16x16x32_bf16 v[120:123], v[240:243], v[216:219], v[120:123]
    ds_read_b64_tr_b16 v[236:237], v68 offset:20832
    v_mfma_f32_16x16x32_bf16 v[124:127], v[240:243], v[220:223], v[124:127]
    ds_read_b64_tr_b16 v[238:239], v68 offset:21344
    buffer_load_dwordx4 v[212:215], v2, s[32:35], s16 offen offset:1024 sc1
    s_waitcnt lgkmcnt(8)
    v_mfma_f32_16x16x32_bf16 v[80:83], v[244:247], v[216:219], v[80:83]
    ds_read_b64_tr_b16 v[240:241], v69 offset:20800
    v_mfma_f32_16x16x32_bf16 v[84:87], v[244:247], v[220:223], v[84:87]
    ds_read_b64_tr_b16 v[242:243], v69 offset:21312
    v_mfma_f32_16x16x32_bf16 v[88:91], v[248:251], v[216:219], v[88:91]
    ds_read_b64_tr_b16 v[244:245], v69 offset:20832
    v_mfma_f32_16x16x32_bf16 v[92:95], v[248:251], v[220:223], v[92:95]
    ds_read_b64_tr_b16 v[246:247], v69 offset:21344
    s_waitcnt lgkmcnt(8)
    v_mfma_f32_16x16x32_bf16 v[96:99], v[224:227], v[216:219], v[96:99]
    s_barrier
    ds_read_b64_tr_b16 v[248:249], v69 offset:33280
    v_mfma_f32_16x16x32_bf16 v[100:103], v[224:227], v[220:223], v[100:103]
    ds_read_b64_tr_b16 v[250:251], v69 offset:33792
    v_mfma_f32_16x16x32_bf16 v[104:107], v[228:231], v[216:219], v[104:107]
    ds_read_b64_tr_b16 v[224:225], v69 offset:33312
    v_mfma_f32_16x16x32_bf16 v[108:111], v[228:231], v[220:223], v[108:111]
    ds_read_b64_tr_b16 v[226:227], v69 offset:33824
    s_waitcnt lgkmcnt(8)
    v_mfma_f32_16x16x32_bf16 v[144:147], v[232:235], v[216:219], v[144:147]
    ds_read_b64_tr_b16 v[228:229], v68 offset:33280
    v_mfma_f32_16x16x32_bf16 v[148:151], v[232:235], v[220:223], v[148:151]
    ds_read_b64_tr_b16 v[230:231], v68 offset:33792
    v_mfma_f32_16x16x32_bf16 v[152:155], v[236:239], v[216:219], v[152:155]
    ds_read_b64_tr_b16 v[232:233], v68 offset:33312
    v_mfma_f32_16x16x32_bf16 v[156:159], v[236:239], v[220:223], v[156:159]
    ds_read_b64_tr_b16 v[234:235], v68 offset:33824
    s_waitcnt lgkmcnt(8)
    v_mfma_f32_16x16x32_bf16 v[160:163], v[240:243], v[216:219], v[160:163]
    ds_read_b64_tr_b16 v[236:237], v68 offset:24960
    v_mfma_f32_16x16x32_bf16 v[164:167], v[240:243], v[220:223], v[164:167]
    ds_read_b64_tr_b16 v[238:239], v68 offset:25472
    v_mfma_f32_16x16x32_bf16 v[168:171], v[244:247], v[216:219], v[168:171]
    ds_read_b64_tr_b16 v[240:241], v68 offset:24992
    v_mfma_f32_16x16x32_bf16 v[172:175], v[244:247], v[220:223], v[172:175]
    ds_read_b64_tr_b16 v[242:243], v68 offset:25504
    s_waitcnt lgkmcnt(8)
    s_waitcnt vmcnt(9)
    v_mfma_f32_16x16x32_bf16 v[128:131], v[248:251], v[176:179], v[128:131]
    ds_read_b64_tr_b16 v[244:245], v69 offset:24960
    s_waitcnt vmcnt(8)
    v_mfma_f32_16x16x32_bf16 v[132:135], v[248:251], v[180:183], v[132:135]
    ds_read_b64_tr_b16 v[246:247], v69 offset:25472
    buffer_load_dwordx4 v[216:219], v2, s[32:35], s16 offen offset:2048 sc1
    v_mfma_f32_16x16x32_bf16 v[136:139], v[224:227], v[176:179], v[136:139]
    ds_read_b64_tr_b16 v[248:249], v69 offset:24992
    v_mfma_f32_16x16x32_bf16 v[140:143], v[224:227], v[180:183], v[140:143]
    ds_read_b64_tr_b16 v[250:251], v69 offset:25504
    s_waitcnt lgkmcnt(8)
    v_mfma_f32_16x16x32_bf16 v[112:115], v[228:231], v[176:179], v[112:115]
    ds_read_b64_tr_b16 v[224:225], v68 offset:41600
    v_mfma_f32_16x16x32_bf16 v[116:119], v[228:231], v[180:183], v[116:119]
    ds_read_b64_tr_b16 v[226:227], v68 offset:42112
    v_mfma_f32_16x16x32_bf16 v[120:123], v[232:235], v[176:179], v[120:123]
    ds_read_b64_tr_b16 v[228:229], v68 offset:41632
    v_mfma_f32_16x16x32_bf16 v[124:127], v[232:235], v[180:183], v[124:127]
    ds_read_b64_tr_b16 v[230:231], v68 offset:42144
    buffer_load_dwordx4 v[220:223], v2, s[32:35], s16 offen offset:3072 sc1
    s_waitcnt lgkmcnt(8)
    v_mfma_f32_16x16x32_bf16 v[80:83], v[236:239], v[176:179], v[80:83]
    ds_read_b64_tr_b16 v[232:233], v69 offset:41600
    v_mfma_f32_16x16x32_bf16 v[84:87], v[236:239], v[180:183], v[84:87]
    ds_read_b64_tr_b16 v[234:235], v69 offset:42112
    v_mfma_f32_16x16x32_bf16 v[88:91], v[240:243], v[176:179], v[88:91]
    ds_read_b64_tr_b16 v[236:237], v69 offset:41632
    v_mfma_f32_16x16x32_bf16 v[92:95], v[240:243], v[180:183], v[92:95]
    ds_read_b64_tr_b16 v[238:239], v69 offset:42144
    s_waitcnt lgkmcnt(8)
    v_mfma_f32_16x16x32_bf16 v[96:99], v[244:247], v[176:179], v[96:99]
    ds_read_b64_tr_b16 v[240:241], v69 offset:37440
    v_mfma_f32_16x16x32_bf16 v[100:103], v[244:247], v[180:183], v[100:103]
    ds_read_b64_tr_b16 v[242:243], v69 offset:37952
    v_mfma_f32_16x16x32_bf16 v[104:107], v[248:251], v[176:179], v[104:107]
    ds_read_b64_tr_b16 v[244:245], v69 offset:37472
    v_mfma_f32_16x16x32_bf16 v[108:111], v[248:251], v[180:183], v[108:111]
    ds_read_b64_tr_b16 v[246:247], v69 offset:37984
    s_waitcnt lgkmcnt(8)
    v_mfma_f32_16x16x32_bf16 v[144:147], v[224:227], v[176:179], v[144:147]
    ds_read_b64_tr_b16 v[248:249], v68 offset:37440
    v_mfma_f32_16x16x32_bf16 v[148:151], v[224:227], v[180:183], v[148:151]
    ds_read_b64_tr_b16 v[250:251], v68 offset:37952
    v_mfma_f32_16x16x32_bf16 v[152:155], v[228:231], v[176:179], v[152:155]
    ds_read_b64_tr_b16 v[224:225], v68 offset:37472
    v_mfma_f32_16x16x32_bf16 v[156:159], v[228:231], v[180:183], v[156:159]
    ds_read_b64_tr_b16 v[226:227], v68 offset:37984
    s_waitcnt lgkmcnt(8)
    v_mfma_f32_16x16x32_bf16 v[160:163], v[232:235], v[176:179], v[160:163]
    ds_read_b64_tr_b16 v[228:229], v68 offset:29120
    v_mfma_f32_16x16x32_bf16 v[164:167], v[232:235], v[180:183], v[164:167]
    ds_read_b64_tr_b16 v[230:231], v68 offset:29632
    v_mfma_f32_16x16x32_bf16 v[168:171], v[236:239], v[176:179], v[168:171]
    ds_read_b64_tr_b16 v[232:233], v68 offset:29152
    v_mfma_f32_16x16x32_bf16 v[172:175], v[236:239], v[180:183], v[172:175]
    ds_read_b64_tr_b16 v[234:235], v68 offset:29664
    s_waitcnt lgkmcnt(8)
    s_waitcnt vmcnt(9)
    v_mfma_f32_16x16x32_bf16 v[128:131], v[240:243], v[184:187], v[128:131]
    ds_read_b64_tr_b16 v[236:237], v69 offset:29120
    s_waitcnt vmcnt(8)
    v_mfma_f32_16x16x32_bf16 v[132:135], v[240:243], v[188:191], v[132:135]
    ds_read_b64_tr_b16 v[238:239], v69 offset:29632
    s_add_u32 s96, s85, 12
    s_and_b32 s97, s96, 15
    s_lshl_b32 s98, s97, 14
    s_add_u32 s16, s98, s15
    buffer_load_dwordx4 v[176:179], v2, s[32:35], s16 offen sc1
    v_mfma_f32_16x16x32_bf16 v[136:139], v[244:247], v[184:187], v[136:139]
    ds_read_b64_tr_b16 v[240:241], v69 offset:29152
    v_mfma_f32_16x16x32_bf16 v[140:143], v[244:247], v[188:191], v[140:143]
    ds_read_b64_tr_b16 v[242:243], v69 offset:29664
    s_waitcnt lgkmcnt(8)
    v_mfma_f32_16x16x32_bf16 v[112:115], v[248:251], v[184:187], v[112:115]
    ds_read_b64_tr_b16 v[244:245], v68 offset:45760
    v_mfma_f32_16x16x32_bf16 v[116:119], v[248:251], v[188:191], v[116:119]
    ds_read_b64_tr_b16 v[246:247], v68 offset:46272
    v_mfma_f32_16x16x32_bf16 v[120:123], v[224:227], v[184:187], v[120:123]
    ds_read_b64_tr_b16 v[248:249], v68 offset:45792
    v_mfma_f32_16x16x32_bf16 v[124:127], v[224:227], v[188:191], v[124:127]
    ds_read_b64_tr_b16 v[250:251], v68 offset:46304
    buffer_load_dwordx4 v[180:183], v2, s[32:35], s16 offen offset:1024 sc1
    s_waitcnt lgkmcnt(8)
    v_mfma_f32_16x16x32_bf16 v[80:83], v[228:231], v[184:187], v[80:83]
    ds_read_b64_tr_b16 v[224:225], v69 offset:45760
    v_mfma_f32_16x16x32_bf16 v[84:87], v[228:231], v[188:191], v[84:87]
    ds_read_b64_tr_b16 v[226:227], v69 offset:46272
    v_mfma_f32_16x16x32_bf16 v[88:91], v[232:235], v[184:187], v[88:91]
    ds_read_b64_tr_b16 v[228:229], v69 offset:45792
    v_mfma_f32_16x16x32_bf16 v[92:95], v[232:235], v[188:191], v[92:95]
    ds_read_b64_tr_b16 v[230:231], v69 offset:46304
    s_waitcnt lgkmcnt(8)
    v_mfma_f32_16x16x32_bf16 v[96:99], v[236:239], v[184:187], v[96:99]
    s_barrier
    ds_read_b64_tr_b16 v[232:233], v71 offset:8320
    v_mfma_f32_16x16x32_bf16 v[100:103], v[236:239], v[188:191], v[100:103]
    ds_read_b64_tr_b16 v[234:235], v71 offset:8832
    v_mfma_f32_16x16x32_bf16 v[104:107], v[240:243], v[184:187], v[104:107]
    ds_read_b64_tr_b16 v[236:237], v71 offset:8352
    v_mfma_f32_16x16x32_bf16 v[108:111], v[240:243], v[188:191], v[108:111]
    ds_read_b64_tr_b16 v[238:239], v71 offset:8864
    s_waitcnt lgkmcnt(8)
    v_mfma_f32_16x16x32_bf16 v[144:147], v[244:247], v[184:187], v[144:147]
    ds_read_b64_tr_b16 v[240:241], v70 offset:8320
    v_mfma_f32_16x16x32_bf16 v[148:151], v[244:247], v[188:191], v[148:151]
    ds_read_b64_tr_b16 v[242:243], v70 offset:8832
    v_mfma_f32_16x16x32_bf16 v[152:155], v[248:251], v[184:187], v[152:155]
    ds_read_b64_tr_b16 v[244:245], v70 offset:8352
    v_mfma_f32_16x16x32_bf16 v[156:159], v[248:251], v[188:191], v[156:159]
    ds_read_b64_tr_b16 v[246:247], v70 offset:8864
    s_waitcnt lgkmcnt(8)
    v_mfma_f32_16x16x32_bf16 v[160:163], v[224:227], v[184:187], v[160:163]
    ds_read_b64_tr_b16 v[248:249], v70
    v_mfma_f32_16x16x32_bf16 v[164:167], v[224:227], v[188:191], v[164:167]
    ds_read_b64_tr_b16 v[250:251], v70 offset:512
    v_mfma_f32_16x16x32_bf16 v[168:171], v[228:231], v[184:187], v[168:171]
    ds_read_b64_tr_b16 v[224:225], v70 offset:32
    v_mfma_f32_16x16x32_bf16 v[172:175], v[228:231], v[188:191], v[172:175]
    ds_read_b64_tr_b16 v[226:227], v70 offset:544
    s_waitcnt lgkmcnt(8)
    s_waitcnt vmcnt(9)
    v_mfma_f32_16x16x32_bf16 v[128:131], v[232:235], v[192:195], v[128:131]
    ds_read_b64_tr_b16 v[228:229], v71
    s_waitcnt vmcnt(8)
    v_mfma_f32_16x16x32_bf16 v[132:135], v[232:235], v[196:199], v[132:135]
    ds_read_b64_tr_b16 v[230:231], v71 offset:512
    buffer_load_dwordx4 v[184:187], v2, s[32:35], s16 offen offset:2048 sc1
    v_mfma_f32_16x16x32_bf16 v[136:139], v[236:239], v[192:195], v[136:139]
    ds_read_b64_tr_b16 v[232:233], v71 offset:32
    v_mfma_f32_16x16x32_bf16 v[140:143], v[236:239], v[196:199], v[140:143]
    ds_read_b64_tr_b16 v[234:235], v71 offset:544
    s_waitcnt lgkmcnt(8)
    v_mfma_f32_16x16x32_bf16 v[112:115], v[240:243], v[192:195], v[112:115]
    ds_read_b64_tr_b16 v[236:237], v70 offset:16640
    v_mfma_f32_16x16x32_bf16 v[116:119], v[240:243], v[196:199], v[116:119]
    ds_read_b64_tr_b16 v[238:239], v70 offset:17152
    v_mfma_f32_16x16x32_bf16 v[120:123], v[244:247], v[192:195], v[120:123]
    ds_read_b64_tr_b16 v[240:241], v70 offset:16672
    v_mfma_f32_16x16x32_bf16 v[124:127], v[244:247], v[196:199], v[124:127]
    ds_read_b64_tr_b16 v[242:243], v70 offset:17184
    buffer_load_dwordx4 v[188:191], v2, s[32:35], s16 offen offset:3072 sc1
    s_waitcnt lgkmcnt(8)
    v_mfma_f32_16x16x32_bf16 v[80:83], v[248:251], v[192:195], v[80:83]
    ds_read_b64_tr_b16 v[244:245], v71 offset:16640
    v_mfma_f32_16x16x32_bf16 v[84:87], v[248:251], v[196:199], v[84:87]
    ds_read_b64_tr_b16 v[246:247], v71 offset:17152
    v_mfma_f32_16x16x32_bf16 v[88:91], v[224:227], v[192:195], v[88:91]
    ds_read_b64_tr_b16 v[248:249], v71 offset:16672
    v_mfma_f32_16x16x32_bf16 v[92:95], v[224:227], v[196:199], v[92:95]
    ds_read_b64_tr_b16 v[250:251], v71 offset:17184
    s_waitcnt lgkmcnt(8)
    v_mfma_f32_16x16x32_bf16 v[96:99], v[228:231], v[192:195], v[96:99]
    ds_read_b64_tr_b16 v[224:225], v71 offset:12480
    v_mfma_f32_16x16x32_bf16 v[100:103], v[228:231], v[196:199], v[100:103]
    ds_read_b64_tr_b16 v[226:227], v71 offset:12992
    v_mfma_f32_16x16x32_bf16 v[104:107], v[232:235], v[192:195], v[104:107]
    ds_read_b64_tr_b16 v[228:229], v71 offset:12512
    v_mfma_f32_16x16x32_bf16 v[108:111], v[232:235], v[196:199], v[108:111]
    ds_read_b64_tr_b16 v[230:231], v71 offset:13024
    s_waitcnt lgkmcnt(8)
    v_mfma_f32_16x16x32_bf16 v[144:147], v[236:239], v[192:195], v[144:147]
    ds_read_b64_tr_b16 v[232:233], v70 offset:12480
    v_mfma_f32_16x16x32_bf16 v[148:151], v[236:239], v[196:199], v[148:151]
    ds_read_b64_tr_b16 v[234:235], v70 offset:12992
    v_mfma_f32_16x16x32_bf16 v[152:155], v[240:243], v[192:195], v[152:155]
    ds_read_b64_tr_b16 v[236:237], v70 offset:12512
    v_mfma_f32_16x16x32_bf16 v[156:159], v[240:243], v[196:199], v[156:159]
    ds_read_b64_tr_b16 v[238:239], v70 offset:13024
    s_waitcnt lgkmcnt(8)
    v_mfma_f32_16x16x32_bf16 v[160:163], v[244:247], v[192:195], v[160:163]
    ds_read_b64_tr_b16 v[240:241], v70 offset:4160
    v_mfma_f32_16x16x32_bf16 v[164:167], v[244:247], v[196:199], v[164:167]
    ds_read_b64_tr_b16 v[242:243], v70 offset:4672
    v_mfma_f32_16x16x32_bf16 v[168:171], v[248:251], v[192:195], v[168:171]
    ds_read_b64_tr_b16 v[244:245], v70 offset:4192
    v_mfma_f32_16x16x32_bf16 v[172:175], v[248:251], v[196:199], v[172:175]
    ds_read_b64_tr_b16 v[246:247], v70 offset:4704
    s_waitcnt lgkmcnt(8)
    s_waitcnt vmcnt(9)
    v_mfma_f32_16x16x32_bf16 v[128:131], v[224:227], v[200:203], v[128:131]
    ds_read_b64_tr_b16 v[248:249], v71 offset:4160
    s_waitcnt vmcnt(8)
    v_mfma_f32_16x16x32_bf16 v[132:135], v[224:227], v[204:207], v[132:135]
    ds_read_b64_tr_b16 v[250:251], v71 offset:4672
    s_add_u32 s96, s85, 13
    s_and_b32 s97, s96, 15
    s_lshl_b32 s98, s97, 14
    s_add_u32 s16, s98, s15
    buffer_load_dwordx4 v[192:195], v2, s[32:35], s16 offen sc1
    v_mfma_f32_16x16x32_bf16 v[136:139], v[228:231], v[200:203], v[136:139]
    ds_read_b64_tr_b16 v[224:225], v71 offset:4192
    v_mfma_f32_16x16x32_bf16 v[140:143], v[228:231], v[204:207], v[140:143]
    ds_read_b64_tr_b16 v[226:227], v71 offset:4704
    s_waitcnt lgkmcnt(8)
    v_mfma_f32_16x16x32_bf16 v[112:115], v[232:235], v[200:203], v[112:115]
    ds_read_b64_tr_b16 v[228:229], v70 offset:20800
    v_mfma_f32_16x16x32_bf16 v[116:119], v[232:235], v[204:207], v[116:119]
    ds_read_b64_tr_b16 v[230:231], v70 offset:21312
    v_mfma_f32_16x16x32_bf16 v[120:123], v[236:239], v[200:203], v[120:123]
    ds_read_b64_tr_b16 v[232:233], v70 offset:20832
    v_mfma_f32_16x16x32_bf16 v[124:127], v[236:239], v[204:207], v[124:127]
    ds_read_b64_tr_b16 v[234:235], v70 offset:21344
    buffer_load_dwordx4 v[196:199], v2, s[32:35], s16 offen offset:1024 sc1
    s_waitcnt lgkmcnt(8)
    v_mfma_f32_16x16x32_bf16 v[80:83], v[240:243], v[200:203], v[80:83]
    ds_read_b64_tr_b16 v[236:237], v71 offset:20800
    v_mfma_f32_16x16x32_bf16 v[84:87], v[240:243], v[204:207], v[84:87]
    ds_read_b64_tr_b16 v[238:239], v71 offset:21312
    v_mfma_f32_16x16x32_bf16 v[88:91], v[244:247], v[200:203], v[88:91]
    ds_read_b64_tr_b16 v[240:241], v71 offset:20832
    v_mfma_f32_16x16x32_bf16 v[92:95], v[244:247], v[204:207], v[92:95]
    ds_read_b64_tr_b16 v[242:243], v71 offset:21344
    s_waitcnt lgkmcnt(8)
    v_mfma_f32_16x16x32_bf16 v[96:99], v[248:251], v[200:203], v[96:99]
    s_barrier
    ds_read_b64_tr_b16 v[244:245], v71 offset:33280
    v_mfma_f32_16x16x32_bf16 v[100:103], v[248:251], v[204:207], v[100:103]
    ds_read_b64_tr_b16 v[246:247], v71 offset:33792
    v_mfma_f32_16x16x32_bf16 v[104:107], v[224:227], v[200:203], v[104:107]
    ds_read_b64_tr_b16 v[248:249], v71 offset:33312
    v_mfma_f32_16x16x32_bf16 v[108:111], v[224:227], v[204:207], v[108:111]
    ds_read_b64_tr_b16 v[250:251], v71 offset:33824
    s_waitcnt lgkmcnt(8)
    v_mfma_f32_16x16x32_bf16 v[144:147], v[228:231], v[200:203], v[144:147]
    ds_read_b64_tr_b16 v[224:225], v70 offset:33280
    v_mfma_f32_16x16x32_bf16 v[148:151], v[228:231], v[204:207], v[148:151]
    ds_read_b64_tr_b16 v[226:227], v70 offset:33792
    v_mfma_f32_16x16x32_bf16 v[152:155], v[232:235], v[200:203], v[152:155]
    ds_read_b64_tr_b16 v[228:229], v70 offset:33312
    v_mfma_f32_16x16x32_bf16 v[156:159], v[232:235], v[204:207], v[156:159]
    ds_read_b64_tr_b16 v[230:231], v70 offset:33824
    s_waitcnt lgkmcnt(8)
    v_mfma_f32_16x16x32_bf16 v[160:163], v[236:239], v[200:203], v[160:163]
    ds_read_b64_tr_b16 v[232:233], v70 offset:24960
    v_mfma_f32_16x16x32_bf16 v[164:167], v[236:239], v[204:207], v[164:167]
    ds_read_b64_tr_b16 v[234:235], v70 offset:25472
    v_mfma_f32_16x16x32_bf16 v[168:171], v[240:243], v[200:203], v[168:171]
    ds_read_b64_tr_b16 v[236:237], v70 offset:24992
    v_mfma_f32_16x16x32_bf16 v[172:175], v[240:243], v[204:207], v[172:175]
    ds_read_b64_tr_b16 v[238:239], v70 offset:25504
    s_waitcnt lgkmcnt(8)
    s_waitcnt vmcnt(9)
    v_mfma_f32_16x16x32_bf16 v[128:131], v[244:247], v[208:211], v[128:131]
    ds_read_b64_tr_b16 v[240:241], v71 offset:24960
    s_waitcnt vmcnt(8)
    v_mfma_f32_16x16x32_bf16 v[132:135], v[244:247], v[212:215], v[132:135]
    ds_read_b64_tr_b16 v[242:243], v71 offset:25472
    buffer_load_dwordx4 v[200:203], v2, s[32:35], s16 offen offset:2048 sc1
    v_mfma_f32_16x16x32_bf16 v[136:139], v[248:251], v[208:211], v[136:139]
    ds_read_b64_tr_b16 v[244:245], v71 offset:24992
    v_mfma_f32_16x16x32_bf16 v[140:143], v[248:251], v[212:215], v[140:143]
    ds_read_b64_tr_b16 v[246:247], v71 offset:25504
    s_waitcnt lgkmcnt(8)
    v_mfma_f32_16x16x32_bf16 v[112:115], v[224:227], v[208:211], v[112:115]
    ds_read_b64_tr_b16 v[248:249], v70 offset:41600
    v_mfma_f32_16x16x32_bf16 v[116:119], v[224:227], v[212:215], v[116:119]
    ds_read_b64_tr_b16 v[250:251], v70 offset:42112
    v_mfma_f32_16x16x32_bf16 v[120:123], v[228:231], v[208:211], v[120:123]
    ds_read_b64_tr_b16 v[224:225], v70 offset:41632
    v_mfma_f32_16x16x32_bf16 v[124:127], v[228:231], v[212:215], v[124:127]
    ds_read_b64_tr_b16 v[226:227], v70 offset:42144
    buffer_load_dwordx4 v[204:207], v2, s[32:35], s16 offen offset:3072 sc1
    s_waitcnt lgkmcnt(8)
    v_mfma_f32_16x16x32_bf16 v[80:83], v[232:235], v[208:211], v[80:83]
    ds_read_b64_tr_b16 v[228:229], v71 offset:41600
    v_mfma_f32_16x16x32_bf16 v[84:87], v[232:235], v[212:215], v[84:87]
    ds_read_b64_tr_b16 v[230:231], v71 offset:42112
    v_mfma_f32_16x16x32_bf16 v[88:91], v[236:239], v[208:211], v[88:91]
    ds_read_b64_tr_b16 v[232:233], v71 offset:41632
    v_mfma_f32_16x16x32_bf16 v[92:95], v[236:239], v[212:215], v[92:95]
    ds_read_b64_tr_b16 v[234:235], v71 offset:42144
    s_waitcnt lgkmcnt(8)
    v_mfma_f32_16x16x32_bf16 v[96:99], v[240:243], v[208:211], v[96:99]
    ds_read_b64_tr_b16 v[236:237], v71 offset:37440
    v_mfma_f32_16x16x32_bf16 v[100:103], v[240:243], v[212:215], v[100:103]
    ds_read_b64_tr_b16 v[238:239], v71 offset:37952
    v_mfma_f32_16x16x32_bf16 v[104:107], v[244:247], v[208:211], v[104:107]
    ds_read_b64_tr_b16 v[240:241], v71 offset:37472
    v_mfma_f32_16x16x32_bf16 v[108:111], v[244:247], v[212:215], v[108:111]
    ds_read_b64_tr_b16 v[242:243], v71 offset:37984
    s_waitcnt lgkmcnt(8)
    v_mfma_f32_16x16x32_bf16 v[144:147], v[248:251], v[208:211], v[144:147]
    ds_read_b64_tr_b16 v[244:245], v70 offset:37440
    v_mfma_f32_16x16x32_bf16 v[148:151], v[248:251], v[212:215], v[148:151]
    ds_read_b64_tr_b16 v[246:247], v70 offset:37952
    v_mfma_f32_16x16x32_bf16 v[152:155], v[224:227], v[208:211], v[152:155]
    ds_read_b64_tr_b16 v[248:249], v70 offset:37472
    v_mfma_f32_16x16x32_bf16 v[156:159], v[224:227], v[212:215], v[156:159]
    ds_read_b64_tr_b16 v[250:251], v70 offset:37984
    s_waitcnt lgkmcnt(8)
    v_mfma_f32_16x16x32_bf16 v[160:163], v[228:231], v[208:211], v[160:163]
    ds_read_b64_tr_b16 v[224:225], v70 offset:29120
    v_mfma_f32_16x16x32_bf16 v[164:167], v[228:231], v[212:215], v[164:167]
    ds_read_b64_tr_b16 v[226:227], v70 offset:29632
    v_mfma_f32_16x16x32_bf16 v[168:171], v[232:235], v[208:211], v[168:171]
    ds_read_b64_tr_b16 v[228:229], v70 offset:29152
    v_mfma_f32_16x16x32_bf16 v[172:175], v[232:235], v[212:215], v[172:175]
    ds_read_b64_tr_b16 v[230:231], v70 offset:29664
    s_waitcnt lgkmcnt(8)
    s_waitcnt vmcnt(9)
    v_mfma_f32_16x16x32_bf16 v[128:131], v[236:239], v[216:219], v[128:131]
    ds_read_b64_tr_b16 v[232:233], v71 offset:29120
    s_waitcnt vmcnt(8)
    v_mfma_f32_16x16x32_bf16 v[132:135], v[236:239], v[220:223], v[132:135]
    ds_read_b64_tr_b16 v[234:235], v71 offset:29632
    s_add_u32 s96, s85, 14
    s_and_b32 s97, s96, 15
    s_lshl_b32 s98, s97, 14
    s_add_u32 s16, s98, s15
    buffer_load_dwordx4 v[208:211], v2, s[32:35], s16 offen sc1
    v_mfma_f32_16x16x32_bf16 v[136:139], v[240:243], v[216:219], v[136:139]
    ds_read_b64_tr_b16 v[236:237], v71 offset:29152
    v_mfma_f32_16x16x32_bf16 v[140:143], v[240:243], v[220:223], v[140:143]
    ds_read_b64_tr_b16 v[238:239], v71 offset:29664
    s_waitcnt lgkmcnt(8)
    v_mfma_f32_16x16x32_bf16 v[112:115], v[244:247], v[216:219], v[112:115]
    ds_read_b64_tr_b16 v[240:241], v70 offset:45760
    v_mfma_f32_16x16x32_bf16 v[116:119], v[244:247], v[220:223], v[116:119]
    ds_read_b64_tr_b16 v[242:243], v70 offset:46272
    v_mfma_f32_16x16x32_bf16 v[120:123], v[248:251], v[216:219], v[120:123]
    ds_read_b64_tr_b16 v[244:245], v70 offset:45792
    v_mfma_f32_16x16x32_bf16 v[124:127], v[248:251], v[220:223], v[124:127]
    ds_read_b64_tr_b16 v[246:247], v70 offset:46304
    buffer_load_dwordx4 v[212:215], v2, s[32:35], s16 offen offset:1024 sc1
    s_waitcnt lgkmcnt(8)
    v_mfma_f32_16x16x32_bf16 v[80:83], v[224:227], v[216:219], v[80:83]
    ds_read_b64_tr_b16 v[248:249], v71 offset:45760
    v_mfma_f32_16x16x32_bf16 v[84:87], v[224:227], v[220:223], v[84:87]
    ds_read_b64_tr_b16 v[250:251], v71 offset:46272
    v_mfma_f32_16x16x32_bf16 v[88:91], v[228:231], v[216:219], v[88:91]
    ds_read_b64_tr_b16 v[224:225], v71 offset:45792
    v_mfma_f32_16x16x32_bf16 v[92:95], v[228:231], v[220:223], v[92:95]
    ds_read_b64_tr_b16 v[226:227], v71 offset:46304
    s_waitcnt lgkmcnt(8)
    v_mfma_f32_16x16x32_bf16 v[96:99], v[232:235], v[216:219], v[96:99]
    s_barrier
    ds_read_b64_tr_b16 v[228:229], v67 offset:8320
    v_mfma_f32_16x16x32_bf16 v[100:103], v[232:235], v[220:223], v[100:103]
    ds_read_b64_tr_b16 v[230:231], v67 offset:8832
    v_mfma_f32_16x16x32_bf16 v[104:107], v[236:239], v[216:219], v[104:107]
    ds_read_b64_tr_b16 v[232:233], v67 offset:8352
    v_mfma_f32_16x16x32_bf16 v[108:111], v[236:239], v[220:223], v[108:111]
    ds_read_b64_tr_b16 v[234:235], v67 offset:8864
    s_waitcnt lgkmcnt(8)
    v_mfma_f32_16x16x32_bf16 v[144:147], v[240:243], v[216:219], v[144:147]
    ds_read_b64_tr_b16 v[236:237], v66 offset:8320
    v_mfma_f32_16x16x32_bf16 v[148:151], v[240:243], v[220:223], v[148:151]
    ds_read_b64_tr_b16 v[238:239], v66 offset:8832
    v_mfma_f32_16x16x32_bf16 v[152:155], v[244:247], v[216:219], v[152:155]
    ds_read_b64_tr_b16 v[240:241], v66 offset:8352
    v_mfma_f32_16x16x32_bf16 v[156:159], v[244:247], v[220:223], v[156:159]
    ds_read_b64_tr_b16 v[242:243], v66 offset:8864
    s_waitcnt lgkmcnt(8)
    v_mfma_f32_16x16x32_bf16 v[160:163], v[248:251], v[216:219], v[160:163]
    ds_read_b64_tr_b16 v[244:245], v66
    v_mfma_f32_16x16x32_bf16 v[164:167], v[248:251], v[220:223], v[164:167]
    ds_read_b64_tr_b16 v[246:247], v66 offset:512
    v_mfma_f32_16x16x32_bf16 v[168:171], v[224:227], v[216:219], v[168:171]
    ds_read_b64_tr_b16 v[248:249], v66 offset:32
    v_mfma_f32_16x16x32_bf16 v[172:175], v[224:227], v[220:223], v[172:175]
    ds_read_b64_tr_b16 v[250:251], v66 offset:544
    s_waitcnt lgkmcnt(8)
    s_waitcnt vmcnt(9)
    v_mfma_f32_16x16x32_bf16 v[128:131], v[228:231], v[176:179], v[128:131]
    ds_read_b64_tr_b16 v[224:225], v67
    s_waitcnt vmcnt(8)
    v_mfma_f32_16x16x32_bf16 v[132:135], v[228:231], v[180:183], v[132:135]
    ds_read_b64_tr_b16 v[226:227], v67 offset:512
    buffer_load_dwordx4 v[216:219], v2, s[32:35], s16 offen offset:2048 sc1
    v_mfma_f32_16x16x32_bf16 v[136:139], v[232:235], v[176:179], v[136:139]
    ds_read_b64_tr_b16 v[228:229], v67 offset:32
    v_mfma_f32_16x16x32_bf16 v[140:143], v[232:235], v[180:183], v[140:143]
    ds_read_b64_tr_b16 v[230:231], v67 offset:544
    s_waitcnt lgkmcnt(8)
    v_mfma_f32_16x16x32_bf16 v[112:115], v[236:239], v[176:179], v[112:115]
    ds_read_b64_tr_b16 v[232:233], v66 offset:16640
    v_mfma_f32_16x16x32_bf16 v[116:119], v[236:239], v[180:183], v[116:119]
    ds_read_b64_tr_b16 v[234:235], v66 offset:17152
    v_mfma_f32_16x16x32_bf16 v[120:123], v[240:243], v[176:179], v[120:123]
    ds_read_b64_tr_b16 v[236:237], v66 offset:16672
    v_mfma_f32_16x16x32_bf16 v[124:127], v[240:243], v[180:183], v[124:127]
    ds_read_b64_tr_b16 v[238:239], v66 offset:17184
    buffer_load_dwordx4 v[220:223], v2, s[32:35], s16 offen offset:3072 sc1
    s_waitcnt lgkmcnt(8)
    v_mfma_f32_16x16x32_bf16 v[80:83], v[244:247], v[176:179], v[80:83]
    ds_read_b64_tr_b16 v[240:241], v67 offset:16640
    v_mfma_f32_16x16x32_bf16 v[84:87], v[244:247], v[180:183], v[84:87]
    ds_read_b64_tr_b16 v[242:243], v67 offset:17152
    v_mfma_f32_16x16x32_bf16 v[88:91], v[248:251], v[176:179], v[88:91]
    ds_read_b64_tr_b16 v[244:245], v67 offset:16672
    v_mfma_f32_16x16x32_bf16 v[92:95], v[248:251], v[180:183], v[92:95]
    ds_read_b64_tr_b16 v[246:247], v67 offset:17184
    s_waitcnt lgkmcnt(8)
    v_mfma_f32_16x16x32_bf16 v[96:99], v[224:227], v[176:179], v[96:99]
    ds_read_b64_tr_b16 v[248:249], v67 offset:12480
    v_mfma_f32_16x16x32_bf16 v[100:103], v[224:227], v[180:183], v[100:103]
    ds_read_b64_tr_b16 v[250:251], v67 offset:12992
    v_mfma_f32_16x16x32_bf16 v[104:107], v[228:231], v[176:179], v[104:107]
    ds_read_b64_tr_b16 v[224:225], v67 offset:12512
    v_mfma_f32_16x16x32_bf16 v[108:111], v[228:231], v[180:183], v[108:111]
    ds_read_b64_tr_b16 v[226:227], v67 offset:13024
    s_waitcnt lgkmcnt(8)
    v_mfma_f32_16x16x32_bf16 v[144:147], v[232:235], v[176:179], v[144:147]
    ds_read_b64_tr_b16 v[228:229], v66 offset:12480
    v_mfma_f32_16x16x32_bf16 v[148:151], v[232:235], v[180:183], v[148:151]
    ds_read_b64_tr_b16 v[230:231], v66 offset:12992
    v_mfma_f32_16x16x32_bf16 v[152:155], v[236:239], v[176:179], v[152:155]
    ds_read_b64_tr_b16 v[232:233], v66 offset:12512
    v_mfma_f32_16x16x32_bf16 v[156:159], v[236:239], v[180:183], v[156:159]
    ds_read_b64_tr_b16 v[234:235], v66 offset:13024
    s_waitcnt lgkmcnt(8)
    v_mfma_f32_16x16x32_bf16 v[160:163], v[240:243], v[176:179], v[160:163]
    ds_read_b64_tr_b16 v[236:237], v66 offset:4160
    v_mfma_f32_16x16x32_bf16 v[164:167], v[240:243], v[180:183], v[164:167]
    ds_read_b64_tr_b16 v[238:239], v66 offset:4672
    v_mfma_f32_16x16x32_bf16 v[168:171], v[244:247], v[176:179], v[168:171]
    ds_read_b64_tr_b16 v[240:241], v66 offset:4192
    v_mfma_f32_16x16x32_bf16 v[172:175], v[244:247], v[180:183], v[172:175]
    ds_read_b64_tr_b16 v[242:243], v66 offset:4704
    s_waitcnt lgkmcnt(8)
    s_waitcnt vmcnt(9)
    v_mfma_f32_16x16x32_bf16 v[128:131], v[248:251], v[184:187], v[128:131]
    ds_read_b64_tr_b16 v[244:245], v67 offset:4160
    s_waitcnt vmcnt(8)
    v_mfma_f32_16x16x32_bf16 v[132:135], v[248:251], v[188:191], v[132:135]
    ds_read_b64_tr_b16 v[246:247], v67 offset:4672
    s_add_u32 s96, s85, 15
    s_and_b32 s97, s96, 15
    s_lshl_b32 s98, s97, 14
    s_add_u32 s16, s98, s15
    buffer_load_dwordx4 v[176:179], v2, s[32:35], s16 offen sc1
    v_mfma_f32_16x16x32_bf16 v[136:139], v[224:227], v[184:187], v[136:139]
    ds_read_b64_tr_b16 v[248:249], v67 offset:4192
    v_mfma_f32_16x16x32_bf16 v[140:143], v[224:227], v[188:191], v[140:143]
    ds_read_b64_tr_b16 v[250:251], v67 offset:4704
    s_waitcnt lgkmcnt(8)
    v_mfma_f32_16x16x32_bf16 v[112:115], v[228:231], v[184:187], v[112:115]
    ds_read_b64_tr_b16 v[224:225], v66 offset:20800
    v_mfma_f32_16x16x32_bf16 v[116:119], v[228:231], v[188:191], v[116:119]
    ds_read_b64_tr_b16 v[226:227], v66 offset:21312
    v_mfma_f32_16x16x32_bf16 v[120:123], v[232:235], v[184:187], v[120:123]
    ds_read_b64_tr_b16 v[228:229], v66 offset:20832
    v_mfma_f32_16x16x32_bf16 v[124:127], v[232:235], v[188:191], v[124:127]
    ds_read_b64_tr_b16 v[230:231], v66 offset:21344
    buffer_load_dwordx4 v[180:183], v2, s[32:35], s16 offen offset:1024 sc1
    s_waitcnt lgkmcnt(8)
    v_mfma_f32_16x16x32_bf16 v[80:83], v[236:239], v[184:187], v[80:83]
    ds_read_b64_tr_b16 v[232:233], v67 offset:20800
    v_mfma_f32_16x16x32_bf16 v[84:87], v[236:239], v[188:191], v[84:87]
    ds_read_b64_tr_b16 v[234:235], v67 offset:21312
    v_mfma_f32_16x16x32_bf16 v[88:91], v[240:243], v[184:187], v[88:91]
    ds_read_b64_tr_b16 v[236:237], v67 offset:20832
    v_mfma_f32_16x16x32_bf16 v[92:95], v[240:243], v[188:191], v[92:95]
    ds_read_b64_tr_b16 v[238:239], v67 offset:21344
    s_waitcnt lgkmcnt(8)
    v_mfma_f32_16x16x32_bf16 v[96:99], v[244:247], v[184:187], v[96:99]
    s_barrier
    ds_read_b64_tr_b16 v[240:241], v67 offset:33280
    v_mfma_f32_16x16x32_bf16 v[100:103], v[244:247], v[188:191], v[100:103]
    ds_read_b64_tr_b16 v[242:243], v67 offset:33792
    v_mfma_f32_16x16x32_bf16 v[104:107], v[248:251], v[184:187], v[104:107]
    ds_read_b64_tr_b16 v[244:245], v67 offset:33312
    v_mfma_f32_16x16x32_bf16 v[108:111], v[248:251], v[188:191], v[108:111]
    ds_read_b64_tr_b16 v[246:247], v67 offset:33824
    s_waitcnt lgkmcnt(8)
    v_mfma_f32_16x16x32_bf16 v[144:147], v[224:227], v[184:187], v[144:147]
    ds_read_b64_tr_b16 v[248:249], v66 offset:33280
    v_mfma_f32_16x16x32_bf16 v[148:151], v[224:227], v[188:191], v[148:151]
    ds_read_b64_tr_b16 v[250:251], v66 offset:33792
    v_mfma_f32_16x16x32_bf16 v[152:155], v[228:231], v[184:187], v[152:155]
    ds_read_b64_tr_b16 v[224:225], v66 offset:33312
    v_mfma_f32_16x16x32_bf16 v[156:159], v[228:231], v[188:191], v[156:159]
    ds_read_b64_tr_b16 v[226:227], v66 offset:33824
    s_waitcnt lgkmcnt(8)
    v_mfma_f32_16x16x32_bf16 v[160:163], v[232:235], v[184:187], v[160:163]
    ds_read_b64_tr_b16 v[228:229], v66 offset:24960
    v_mfma_f32_16x16x32_bf16 v[164:167], v[232:235], v[188:191], v[164:167]
    ds_read_b64_tr_b16 v[230:231], v66 offset:25472
    v_mfma_f32_16x16x32_bf16 v[168:171], v[236:239], v[184:187], v[168:171]
    ds_read_b64_tr_b16 v[232:233], v66 offset:24992
    v_mfma_f32_16x16x32_bf16 v[172:175], v[236:239], v[188:191], v[172:175]
    ds_read_b64_tr_b16 v[234:235], v66 offset:25504
    s_waitcnt lgkmcnt(8)
    s_waitcnt vmcnt(9)
    v_mfma_f32_16x16x32_bf16 v[128:131], v[240:243], v[192:195], v[128:131]
    ds_read_b64_tr_b16 v[236:237], v67 offset:24960
    s_waitcnt vmcnt(8)
    v_mfma_f32_16x16x32_bf16 v[132:135], v[240:243], v[196:199], v[132:135]
    ds_read_b64_tr_b16 v[238:239], v67 offset:25472
    buffer_load_dwordx4 v[184:187], v2, s[32:35], s16 offen offset:2048 sc1
    v_mfma_f32_16x16x32_bf16 v[136:139], v[244:247], v[192:195], v[136:139]
    ds_read_b64_tr_b16 v[240:241], v67 offset:24992
    v_mfma_f32_16x16x32_bf16 v[140:143], v[244:247], v[196:199], v[140:143]
    ds_read_b64_tr_b16 v[242:243], v67 offset:25504
    s_waitcnt lgkmcnt(8)
    v_mfma_f32_16x16x32_bf16 v[112:115], v[248:251], v[192:195], v[112:115]
    ds_read_b64_tr_b16 v[244:245], v66 offset:41600
    v_mfma_f32_16x16x32_bf16 v[116:119], v[248:251], v[196:199], v[116:119]
    ds_read_b64_tr_b16 v[246:247], v66 offset:42112
    v_mfma_f32_16x16x32_bf16 v[120:123], v[224:227], v[192:195], v[120:123]
    ds_read_b64_tr_b16 v[248:249], v66 offset:41632
    v_mfma_f32_16x16x32_bf16 v[124:127], v[224:227], v[196:199], v[124:127]
    ds_read_b64_tr_b16 v[250:251], v66 offset:42144
    buffer_load_dwordx4 v[188:191], v2, s[32:35], s16 offen offset:3072 sc1
    s_barrier
    s_waitcnt lgkmcnt(8)
    v_mfma_f32_16x16x32_bf16 v[80:83], v[228:231], v[192:195], v[80:83]
    ds_read_b64_tr_b16 v[224:225], v67 offset:41600
    v_mfma_f32_16x16x32_bf16 v[84:87], v[228:231], v[196:199], v[84:87]
    ds_read_b64_tr_b16 v[226:227], v67 offset:42112
    v_mfma_f32_16x16x32_bf16 v[88:91], v[232:235], v[192:195], v[88:91]
    ds_read_b64_tr_b16 v[228:229], v67 offset:41632
    v_mfma_f32_16x16x32_bf16 v[92:95], v[232:235], v[196:199], v[92:95]
    ds_read_b64_tr_b16 v[230:231], v67 offset:42144
    s_waitcnt lgkmcnt(8)
    v_mfma_f32_16x16x32_bf16 v[96:99], v[236:239], v[192:195], v[96:99]
    ds_read_b64_tr_b16 v[232:233], v67 offset:37440
    v_mfma_f32_16x16x32_bf16 v[100:103], v[236:239], v[196:199], v[100:103]
    ds_read_b64_tr_b16 v[234:235], v67 offset:37952
    v_mfma_f32_16x16x32_bf16 v[104:107], v[240:243], v[192:195], v[104:107]
    ds_read_b64_tr_b16 v[236:237], v67 offset:37472
    v_mfma_f32_16x16x32_bf16 v[108:111], v[240:243], v[196:199], v[108:111]
    ds_read_b64_tr_b16 v[238:239], v67 offset:37984
    s_waitcnt lgkmcnt(8)
    v_mfma_f32_16x16x32_bf16 v[144:147], v[244:247], v[192:195], v[144:147]
    ds_read_b64_tr_b16 v[240:241], v66 offset:37440
    v_mfma_f32_16x16x32_bf16 v[148:151], v[244:247], v[196:199], v[148:151]
    ds_read_b64_tr_b16 v[242:243], v66 offset:37952
    v_mfma_f32_16x16x32_bf16 v[152:155], v[248:251], v[192:195], v[152:155]
    ds_read_b64_tr_b16 v[244:245], v66 offset:37472
    v_mfma_f32_16x16x32_bf16 v[156:159], v[248:251], v[196:199], v[156:159]
    ds_read_b64_tr_b16 v[246:247], v66 offset:37984
    s_waitcnt lgkmcnt(8)
    v_mfma_f32_16x16x32_bf16 v[160:163], v[224:227], v[192:195], v[160:163]
    ds_read_b64_tr_b16 v[248:249], v66 offset:29120
    v_mfma_f32_16x16x32_bf16 v[164:167], v[224:227], v[196:199], v[164:167]
    ds_read_b64_tr_b16 v[250:251], v66 offset:29632
    v_mfma_f32_16x16x32_bf16 v[168:171], v[228:231], v[192:195], v[168:171]
    ds_read_b64_tr_b16 v[224:225], v66 offset:29152
    v_mfma_f32_16x16x32_bf16 v[172:175], v[228:231], v[196:199], v[172:175]
    ds_read_b64_tr_b16 v[226:227], v66 offset:29664
    s_waitcnt lgkmcnt(8)
    s_waitcnt vmcnt(9)
    v_mfma_f32_16x16x32_bf16 v[128:131], v[232:235], v[200:203], v[128:131]
    ds_read_b64_tr_b16 v[228:229], v67 offset:29120
    s_waitcnt vmcnt(8)
    v_mfma_f32_16x16x32_bf16 v[132:135], v[232:235], v[204:207], v[132:135]
    ds_read_b64_tr_b16 v[230:231], v67 offset:29632
    v_mfma_f32_16x16x32_bf16 v[136:139], v[236:239], v[200:203], v[136:139]
    ds_read_b64_tr_b16 v[232:233], v67 offset:29152
    v_mfma_f32_16x16x32_bf16 v[140:143], v[236:239], v[204:207], v[140:143]
    ds_read_b64_tr_b16 v[234:235], v67 offset:29664
    s_waitcnt lgkmcnt(8)
    v_mfma_f32_16x16x32_bf16 v[112:115], v[240:243], v[200:203], v[112:115]
    ds_read_b64_tr_b16 v[236:237], v66 offset:45760
    v_mfma_f32_16x16x32_bf16 v[116:119], v[240:243], v[204:207], v[116:119]
    ds_read_b64_tr_b16 v[238:239], v66 offset:46272
    v_mfma_f32_16x16x32_bf16 v[120:123], v[244:247], v[200:203], v[120:123]
    ds_read_b64_tr_b16 v[240:241], v66 offset:45792
    v_mfma_f32_16x16x32_bf16 v[124:127], v[244:247], v[204:207], v[124:127]
    ds_read_b64_tr_b16 v[242:243], v66 offset:46304
    s_waitcnt lgkmcnt(8)
    v_mfma_f32_16x16x32_bf16 v[80:83], v[248:251], v[200:203], v[80:83]
    ds_read_b64_tr_b16 v[244:245], v67 offset:45760
    v_mfma_f32_16x16x32_bf16 v[84:87], v[248:251], v[204:207], v[84:87]
    ds_read_b64_tr_b16 v[246:247], v67 offset:46272
    v_mfma_f32_16x16x32_bf16 v[88:91], v[224:227], v[200:203], v[88:91]
    ds_read_b64_tr_b16 v[248:249], v67 offset:45792
    v_mfma_f32_16x16x32_bf16 v[92:95], v[224:227], v[204:207], v[92:95]
    ds_read_b64_tr_b16 v[250:251], v67 offset:46304
    s_waitcnt lgkmcnt(8)
    v_mfma_f32_16x16x32_bf16 v[96:99], v[228:231], v[200:203], v[96:99]
    ds_read_b64_tr_b16 v[224:225], v69 offset:8320
    v_mfma_f32_16x16x32_bf16 v[100:103], v[228:231], v[204:207], v[100:103]
    ds_read_b64_tr_b16 v[226:227], v69 offset:8832
    v_mfma_f32_16x16x32_bf16 v[104:107], v[232:235], v[200:203], v[104:107]
    ds_read_b64_tr_b16 v[228:229], v69 offset:8352
    v_mfma_f32_16x16x32_bf16 v[108:111], v[232:235], v[204:207], v[108:111]
    ds_read_b64_tr_b16 v[230:231], v69 offset:8864
    s_waitcnt lgkmcnt(8)
    v_mfma_f32_16x16x32_bf16 v[144:147], v[236:239], v[200:203], v[144:147]
    ds_read_b64_tr_b16 v[232:233], v68 offset:8320
    v_mfma_f32_16x16x32_bf16 v[148:151], v[236:239], v[204:207], v[148:151]
    ds_read_b64_tr_b16 v[234:235], v68 offset:8832
    v_mfma_f32_16x16x32_bf16 v[152:155], v[240:243], v[200:203], v[152:155]
    ds_read_b64_tr_b16 v[236:237], v68 offset:8352
    v_mfma_f32_16x16x32_bf16 v[156:159], v[240:243], v[204:207], v[156:159]
    ds_read_b64_tr_b16 v[238:239], v68 offset:8864
    s_waitcnt lgkmcnt(8)
    v_mfma_f32_16x16x32_bf16 v[160:163], v[244:247], v[200:203], v[160:163]
    ds_read_b64_tr_b16 v[240:241], v68
    v_mfma_f32_16x16x32_bf16 v[164:167], v[244:247], v[204:207], v[164:167]
    ds_read_b64_tr_b16 v[242:243], v68 offset:512
    v_mfma_f32_16x16x32_bf16 v[168:171], v[248:251], v[200:203], v[168:171]
    ds_read_b64_tr_b16 v[244:245], v68 offset:32
    v_mfma_f32_16x16x32_bf16 v[172:175], v[248:251], v[204:207], v[172:175]
    ds_read_b64_tr_b16 v[246:247], v68 offset:544
    s_waitcnt lgkmcnt(8)
    s_waitcnt vmcnt(7)
    v_mfma_f32_16x16x32_bf16 v[128:131], v[224:227], v[208:211], v[128:131]
    ds_read_b64_tr_b16 v[248:249], v69
    s_waitcnt vmcnt(6)
    v_mfma_f32_16x16x32_bf16 v[132:135], v[224:227], v[212:215], v[132:135]
    ds_read_b64_tr_b16 v[250:251], v69 offset:512
    v_mfma_f32_16x16x32_bf16 v[136:139], v[228:231], v[208:211], v[136:139]
    ds_read_b64_tr_b16 v[224:225], v69 offset:32
    v_mfma_f32_16x16x32_bf16 v[140:143], v[228:231], v[212:215], v[140:143]
    ds_read_b64_tr_b16 v[226:227], v69 offset:544
    s_waitcnt lgkmcnt(8)
    v_mfma_f32_16x16x32_bf16 v[112:115], v[232:235], v[208:211], v[112:115]
    ds_read_b64_tr_b16 v[228:229], v68 offset:16640
    v_mfma_f32_16x16x32_bf16 v[116:119], v[232:235], v[212:215], v[116:119]
    ds_read_b64_tr_b16 v[230:231], v68 offset:17152
    v_mfma_f32_16x16x32_bf16 v[120:123], v[236:239], v[208:211], v[120:123]
    ds_read_b64_tr_b16 v[232:233], v68 offset:16672
    v_mfma_f32_16x16x32_bf16 v[124:127], v[236:239], v[212:215], v[124:127]
    ds_read_b64_tr_b16 v[234:235], v68 offset:17184
    s_waitcnt lgkmcnt(8)
    v_mfma_f32_16x16x32_bf16 v[80:83], v[240:243], v[208:211], v[80:83]
    ds_read_b64_tr_b16 v[236:237], v69 offset:16640
    v_mfma_f32_16x16x32_bf16 v[84:87], v[240:243], v[212:215], v[84:87]
    ds_read_b64_tr_b16 v[238:239], v69 offset:17152
    v_mfma_f32_16x16x32_bf16 v[88:91], v[244:247], v[208:211], v[88:91]
    ds_read_b64_tr_b16 v[240:241], v69 offset:16672
    v_mfma_f32_16x16x32_bf16 v[92:95], v[244:247], v[212:215], v[92:95]
    ds_read_b64_tr_b16 v[242:243], v69 offset:17184
    s_waitcnt lgkmcnt(8)
    v_mfma_f32_16x16x32_bf16 v[96:99], v[248:251], v[208:211], v[96:99]
    ds_read_b64_tr_b16 v[244:245], v69 offset:12480
    v_mfma_f32_16x16x32_bf16 v[100:103], v[248:251], v[212:215], v[100:103]
    ds_read_b64_tr_b16 v[246:247], v69 offset:12992
    v_mfma_f32_16x16x32_bf16 v[104:107], v[224:227], v[208:211], v[104:107]
    ds_read_b64_tr_b16 v[248:249], v69 offset:12512
    v_mfma_f32_16x16x32_bf16 v[108:111], v[224:227], v[212:215], v[108:111]
    ds_read_b64_tr_b16 v[250:251], v69 offset:13024
    s_waitcnt lgkmcnt(8)
    v_mfma_f32_16x16x32_bf16 v[144:147], v[228:231], v[208:211], v[144:147]
    ds_read_b64_tr_b16 v[224:225], v68 offset:12480
    v_mfma_f32_16x16x32_bf16 v[148:151], v[228:231], v[212:215], v[148:151]
    ds_read_b64_tr_b16 v[226:227], v68 offset:12992
    v_mfma_f32_16x16x32_bf16 v[152:155], v[232:235], v[208:211], v[152:155]
    ds_read_b64_tr_b16 v[228:229], v68 offset:12512
    v_mfma_f32_16x16x32_bf16 v[156:159], v[232:235], v[212:215], v[156:159]
    ds_read_b64_tr_b16 v[230:231], v68 offset:13024
    s_waitcnt lgkmcnt(8)
    v_mfma_f32_16x16x32_bf16 v[160:163], v[236:239], v[208:211], v[160:163]
    ds_read_b64_tr_b16 v[232:233], v68 offset:4160
    v_mfma_f32_16x16x32_bf16 v[164:167], v[236:239], v[212:215], v[164:167]
    ds_read_b64_tr_b16 v[234:235], v68 offset:4672
    v_mfma_f32_16x16x32_bf16 v[168:171], v[240:243], v[208:211], v[168:171]
    ds_read_b64_tr_b16 v[236:237], v68 offset:4192
    v_mfma_f32_16x16x32_bf16 v[172:175], v[240:243], v[212:215], v[172:175]
    ds_read_b64_tr_b16 v[238:239], v68 offset:4704
    s_waitcnt lgkmcnt(8)
    s_waitcnt vmcnt(5)
    v_mfma_f32_16x16x32_bf16 v[128:131], v[244:247], v[216:219], v[128:131]
    ds_read_b64_tr_b16 v[240:241], v69 offset:4160
    s_waitcnt vmcnt(4)
    v_mfma_f32_16x16x32_bf16 v[132:135], v[244:247], v[220:223], v[132:135]
    ds_read_b64_tr_b16 v[242:243], v69 offset:4672
    v_mfma_f32_16x16x32_bf16 v[136:139], v[248:251], v[216:219], v[136:139]
    ds_read_b64_tr_b16 v[244:245], v69 offset:4192
    v_mfma_f32_16x16x32_bf16 v[140:143], v[248:251], v[220:223], v[140:143]
    ds_read_b64_tr_b16 v[246:247], v69 offset:4704
    s_waitcnt lgkmcnt(8)
    v_mfma_f32_16x16x32_bf16 v[112:115], v[224:227], v[216:219], v[112:115]
    ds_read_b64_tr_b16 v[248:249], v68 offset:20800
    v_mfma_f32_16x16x32_bf16 v[116:119], v[224:227], v[220:223], v[116:119]
    ds_read_b64_tr_b16 v[250:251], v68 offset:21312
    v_mfma_f32_16x16x32_bf16 v[120:123], v[228:231], v[216:219], v[120:123]
    ds_read_b64_tr_b16 v[224:225], v68 offset:20832
    v_mfma_f32_16x16x32_bf16 v[124:127], v[228:231], v[220:223], v[124:127]
    ds_read_b64_tr_b16 v[226:227], v68 offset:21344
    s_waitcnt lgkmcnt(8)
    v_mfma_f32_16x16x32_bf16 v[80:83], v[232:235], v[216:219], v[80:83]
    ds_read_b64_tr_b16 v[228:229], v69 offset:20800
    v_mfma_f32_16x16x32_bf16 v[84:87], v[232:235], v[220:223], v[84:87]
    ds_read_b64_tr_b16 v[230:231], v69 offset:21312
    v_mfma_f32_16x16x32_bf16 v[88:91], v[236:239], v[216:219], v[88:91]
    ds_read_b64_tr_b16 v[232:233], v69 offset:20832
    v_mfma_f32_16x16x32_bf16 v[92:95], v[236:239], v[220:223], v[92:95]
    ds_read_b64_tr_b16 v[234:235], v69 offset:21344
    s_waitcnt lgkmcnt(8)
    v_mfma_f32_16x16x32_bf16 v[96:99], v[240:243], v[216:219], v[96:99]
    ds_read_b64_tr_b16 v[236:237], v69 offset:33280
    v_mfma_f32_16x16x32_bf16 v[100:103], v[240:243], v[220:223], v[100:103]
    ds_read_b64_tr_b16 v[238:239], v69 offset:33792
    v_mfma_f32_16x16x32_bf16 v[104:107], v[244:247], v[216:219], v[104:107]
    ds_read_b64_tr_b16 v[240:241], v69 offset:33312
    v_mfma_f32_16x16x32_bf16 v[108:111], v[244:247], v[220:223], v[108:111]
    ds_read_b64_tr_b16 v[242:243], v69 offset:33824
    s_waitcnt lgkmcnt(8)
    v_mfma_f32_16x16x32_bf16 v[144:147], v[248:251], v[216:219], v[144:147]
    ds_read_b64_tr_b16 v[244:245], v68 offset:33280
    v_mfma_f32_16x16x32_bf16 v[148:151], v[248:251], v[220:223], v[148:151]
    ds_read_b64_tr_b16 v[246:247], v68 offset:33792
    v_mfma_f32_16x16x32_bf16 v[152:155], v[224:227], v[216:219], v[152:155]
    ds_read_b64_tr_b16 v[248:249], v68 offset:33312
    v_mfma_f32_16x16x32_bf16 v[156:159], v[224:227], v[220:223], v[156:159]
    ds_read_b64_tr_b16 v[250:251], v68 offset:33824
    s_waitcnt lgkmcnt(8)
    v_mfma_f32_16x16x32_bf16 v[160:163], v[228:231], v[216:219], v[160:163]
    ds_read_b64_tr_b16 v[224:225], v68 offset:24960
    v_mfma_f32_16x16x32_bf16 v[164:167], v[228:231], v[220:223], v[164:167]
    ds_read_b64_tr_b16 v[226:227], v68 offset:25472
    v_mfma_f32_16x16x32_bf16 v[168:171], v[232:235], v[216:219], v[168:171]
    ds_read_b64_tr_b16 v[228:229], v68 offset:24992
    v_mfma_f32_16x16x32_bf16 v[172:175], v[232:235], v[220:223], v[172:175]
    ds_read_b64_tr_b16 v[230:231], v68 offset:25504
    s_waitcnt lgkmcnt(8)
    s_waitcnt vmcnt(3)
    v_mfma_f32_16x16x32_bf16 v[128:131], v[236:239], v[176:179], v[128:131]
    ds_read_b64_tr_b16 v[232:233], v69 offset:24960
    s_waitcnt vmcnt(2)
    v_mfma_f32_16x16x32_bf16 v[132:135], v[236:239], v[180:183], v[132:135]
    ds_read_b64_tr_b16 v[234:235], v69 offset:25472
    v_mfma_f32_16x16x32_bf16 v[136:139], v[240:243], v[176:179], v[136:139]
    ds_read_b64_tr_b16 v[236:237], v69 offset:24992
    v_mfma_f32_16x16x32_bf16 v[140:143], v[240:243], v[180:183], v[140:143]
    ds_read_b64_tr_b16 v[238:239], v69 offset:25504
    s_waitcnt lgkmcnt(8)
    v_mfma_f32_16x16x32_bf16 v[112:115], v[244:247], v[176:179], v[112:115]
    ds_read_b64_tr_b16 v[240:241], v68 offset:41600
    v_mfma_f32_16x16x32_bf16 v[116:119], v[244:247], v[180:183], v[116:119]
    ds_read_b64_tr_b16 v[242:243], v68 offset:42112
    v_mfma_f32_16x16x32_bf16 v[120:123], v[248:251], v[176:179], v[120:123]
    ds_read_b64_tr_b16 v[244:245], v68 offset:41632
    v_mfma_f32_16x16x32_bf16 v[124:127], v[248:251], v[180:183], v[124:127]
    ds_read_b64_tr_b16 v[246:247], v68 offset:42144
    s_waitcnt lgkmcnt(8)
    v_mfma_f32_16x16x32_bf16 v[80:83], v[224:227], v[176:179], v[80:83]
    ds_read_b64_tr_b16 v[248:249], v69 offset:41600
    v_mfma_f32_16x16x32_bf16 v[84:87], v[224:227], v[180:183], v[84:87]
    ds_read_b64_tr_b16 v[250:251], v69 offset:42112
    v_mfma_f32_16x16x32_bf16 v[88:91], v[228:231], v[176:179], v[88:91]
    ds_read_b64_tr_b16 v[224:225], v69 offset:41632
    v_mfma_f32_16x16x32_bf16 v[92:95], v[228:231], v[180:183], v[92:95]
    ds_read_b64_tr_b16 v[226:227], v69 offset:42144
    s_waitcnt lgkmcnt(8)
    v_mfma_f32_16x16x32_bf16 v[96:99], v[232:235], v[176:179], v[96:99]
    ds_read_b64_tr_b16 v[228:229], v69 offset:37440
    v_mfma_f32_16x16x32_bf16 v[100:103], v[232:235], v[180:183], v[100:103]
    ds_read_b64_tr_b16 v[230:231], v69 offset:37952
    v_mfma_f32_16x16x32_bf16 v[104:107], v[236:239], v[176:179], v[104:107]
    ds_read_b64_tr_b16 v[232:233], v69 offset:37472
    v_mfma_f32_16x16x32_bf16 v[108:111], v[236:239], v[180:183], v[108:111]
    ds_read_b64_tr_b16 v[234:235], v69 offset:37984
    s_waitcnt lgkmcnt(8)
    v_mfma_f32_16x16x32_bf16 v[144:147], v[240:243], v[176:179], v[144:147]
    ds_read_b64_tr_b16 v[236:237], v68 offset:37440
    v_mfma_f32_16x16x32_bf16 v[148:151], v[240:243], v[180:183], v[148:151]
    ds_read_b64_tr_b16 v[238:239], v68 offset:37952
    v_mfma_f32_16x16x32_bf16 v[152:155], v[244:247], v[176:179], v[152:155]
    ds_read_b64_tr_b16 v[240:241], v68 offset:37472
    v_mfma_f32_16x16x32_bf16 v[156:159], v[244:247], v[180:183], v[156:159]
    ds_read_b64_tr_b16 v[242:243], v68 offset:37984
    s_waitcnt lgkmcnt(8)
    v_mfma_f32_16x16x32_bf16 v[160:163], v[248:251], v[176:179], v[160:163]
    ds_read_b64_tr_b16 v[244:245], v68 offset:29120
    v_mfma_f32_16x16x32_bf16 v[164:167], v[248:251], v[180:183], v[164:167]
    ds_read_b64_tr_b16 v[246:247], v68 offset:29632
    v_mfma_f32_16x16x32_bf16 v[168:171], v[224:227], v[176:179], v[168:171]
    ds_read_b64_tr_b16 v[248:249], v68 offset:29152
    v_mfma_f32_16x16x32_bf16 v[172:175], v[224:227], v[180:183], v[172:175]
    ds_read_b64_tr_b16 v[250:251], v68 offset:29664
    s_waitcnt lgkmcnt(8)
    s_waitcnt vmcnt(1)
    v_mfma_f32_16x16x32_bf16 v[128:131], v[228:231], v[184:187], v[128:131]
    ds_read_b64_tr_b16 v[224:225], v69 offset:29120
    s_waitcnt vmcnt(0)
    v_mfma_f32_16x16x32_bf16 v[132:135], v[228:231], v[188:191], v[132:135]
    ds_read_b64_tr_b16 v[226:227], v69 offset:29632
    v_mfma_f32_16x16x32_bf16 v[136:139], v[232:235], v[184:187], v[136:139]
    ds_read_b64_tr_b16 v[228:229], v69 offset:29152
    v_mfma_f32_16x16x32_bf16 v[140:143], v[232:235], v[188:191], v[140:143]
    ds_read_b64_tr_b16 v[230:231], v69 offset:29664
    s_waitcnt lgkmcnt(8)
    v_mfma_f32_16x16x32_bf16 v[112:115], v[236:239], v[184:187], v[112:115]
    ds_read_b64_tr_b16 v[232:233], v68 offset:45760
    v_mfma_f32_16x16x32_bf16 v[116:119], v[236:239], v[188:191], v[116:119]
    ds_read_b64_tr_b16 v[234:235], v68 offset:46272
    v_mfma_f32_16x16x32_bf16 v[120:123], v[240:243], v[184:187], v[120:123]
    ds_read_b64_tr_b16 v[236:237], v68 offset:45792
    v_mfma_f32_16x16x32_bf16 v[124:127], v[240:243], v[188:191], v[124:127]
    ds_read_b64_tr_b16 v[238:239], v68 offset:46304
    s_waitcnt lgkmcnt(8)
    v_mfma_f32_16x16x32_bf16 v[80:83], v[244:247], v[184:187], v[80:83]
    ds_read_b64_tr_b16 v[240:241], v69 offset:45760
    v_mfma_f32_16x16x32_bf16 v[84:87], v[244:247], v[188:191], v[84:87]
    ds_read_b64_tr_b16 v[242:243], v69 offset:46272
    v_mfma_f32_16x16x32_bf16 v[88:91], v[248:251], v[184:187], v[88:91]
    ds_read_b64_tr_b16 v[244:245], v69 offset:45792
    v_mfma_f32_16x16x32_bf16 v[92:95], v[248:251], v[188:191], v[92:95]
    ds_read_b64_tr_b16 v[246:247], v69 offset:46304
    s_waitcnt lgkmcnt(8)
    v_mfma_f32_16x16x32_bf16 v[96:99], v[224:227], v[184:187], v[96:99]
    v_mfma_f32_16x16x32_bf16 v[100:103], v[224:227], v[188:191], v[100:103]
    v_mfma_f32_16x16x32_bf16 v[104:107], v[228:231], v[184:187], v[104:107]
    v_mfma_f32_16x16x32_bf16 v[108:111], v[228:231], v[188:191], v[108:111]
    s_waitcnt lgkmcnt(4)
    v_mfma_f32_16x16x32_bf16 v[144:147], v[232:235], v[184:187], v[144:147]
    v_mfma_f32_16x16x32_bf16 v[148:151], v[232:235], v[188:191], v[148:151]
    v_mfma_f32_16x16x32_bf16 v[152:155], v[236:239], v[184:187], v[152:155]
    v_mfma_f32_16x16x32_bf16 v[156:159], v[236:239], v[188:191], v[156:159]
    s_waitcnt lgkmcnt(0)
    v_mfma_f32_16x16x32_bf16 v[160:163], v[240:243], v[184:187], v[160:163]
    v_mfma_f32_16x16x32_bf16 v[164:167], v[240:243], v[188:191], v[164:167]
    v_mfma_f32_16x16x32_bf16 v[168:171], v[244:247], v[184:187], v[168:171]
    v_mfma_f32_16x16x32_bf16 v[172:175], v[244:247], v[188:191], v[172:175]
    v_cvt_pk_bf16_f32 v52, v128, v129
    v_cvt_pk_bf16_f32 v53, v130, v131
    v_cvt_pk_bf16_f32 v54, v132, v133
    v_cvt_pk_bf16_f32 v55, v134, v135
    v_cvt_pk_bf16_f32 v56, v136, v137
    v_cvt_pk_bf16_f32 v57, v138, v139
    v_cvt_pk_bf16_f32 v58, v140, v141
    v_cvt_pk_bf16_f32 v59, v142, v143
    ds_write_b64 v77, v[52:53]
    ds_write_b64 v77, v[54:55] offset:256
    ds_write_b64 v77, v[56:57] offset:1024
    ds_write_b64 v77, v[58:59] offset:1280
    v_cvt_pk_bf16_f32 v36, v112, v113
    v_cvt_pk_bf16_f32 v37, v114, v115
    v_cvt_pk_bf16_f32 v38, v116, v117
    v_cvt_pk_bf16_f32 v39, v118, v119
    v_cvt_pk_bf16_f32 v40, v120, v121
    v_cvt_pk_bf16_f32 v41, v122, v123
    v_cvt_pk_bf16_f32 v42, v124, v125
    v_cvt_pk_bf16_f32 v43, v126, v127
    v_permlane16_swap_b32 v36, v38
    v_permlane16_swap_b32 v37, v39
    v_permlane16_swap_b32 v40, v42
    v_permlane16_swap_b32 v41, v43
    s_waitcnt lgkmcnt(0)
    s_barrier
    s_setprio 0
    v_mfma_f32_32x32x16_bf16 v[112:127], v[28:31], v[36:39], 0
    v_mfma_f32_32x32x16_bf16 v[112:127], v[32:35], v[40:43], v[112:127]
    v_cvt_pk_bf16_f32 v52, v144, v145
    v_cvt_pk_bf16_f32 v53, v146, v147
    v_cvt_pk_bf16_f32 v54, v148, v149
    v_cvt_pk_bf16_f32 v55, v150, v151
    v_cvt_pk_bf16_f32 v56, v152, v153
    v_cvt_pk_bf16_f32 v57, v154, v155
    v_cvt_pk_bf16_f32 v58, v156, v157
    v_cvt_pk_bf16_f32 v59, v158, v159
    ds_write_b64 v78, v[52:53]
    ds_write_b64 v78, v[54:55] offset:512
    ds_write_b64 v78, v[56:57] offset:4096
    ds_write_b64 v78, v[58:59] offset:4608
    v_cvt_pk_bf16_f32 v44, v160, v161
    v_cvt_pk_bf16_f32 v45, v162, v163
    v_cvt_pk_bf16_f32 v46, v164, v165
    v_cvt_pk_bf16_f32 v47, v166, v167
    v_cvt_pk_bf16_f32 v48, v168, v169
    v_cvt_pk_bf16_f32 v49, v170, v171
    v_cvt_pk_bf16_f32 v50, v172, v173
    v_cvt_pk_bf16_f32 v51, v174, v175
    ds_write_b64 v78, v[44:45] offset:8192
    ds_write_b64 v78, v[46:47] offset:8704
    ds_write_b64 v78, v[48:49] offset:12288
    ds_write_b64 v78, v[50:51] offset:12800
    v_cvt_pk_bf16_f32 v36, v96, v97
    v_cvt_pk_bf16_f32 v37, v98, v99
    v_cvt_pk_bf16_f32 v38, v100, v101
    v_cvt_pk_bf16_f32 v39, v102, v103
    v_cvt_pk_bf16_f32 v40, v104, v105
    v_cvt_pk_bf16_f32 v41, v106, v107
    v_cvt_pk_bf16_f32 v42, v108, v109
    v_cvt_pk_bf16_f32 v43, v110, v111
    ds_write_b64 v77, v[36:37] offset:2048
    ds_write_b64 v77, v[38:39] offset:2304
    ds_write_b64 v77, v[40:41] offset:3072
    ds_write_b64 v77, v[42:43] offset:3328
    v_cvt_pk_bf16_f32 v44, v80, v81
    v_cvt_pk_bf16_f32 v45, v82, v83
    v_cvt_pk_bf16_f32 v46, v84, v85
    v_cvt_pk_bf16_f32 v47, v86, v87
    v_cvt_pk_bf16_f32 v48, v88, v89
    v_cvt_pk_bf16_f32 v49, v90, v91
    v_cvt_pk_bf16_f32 v50, v92, v93
    v_cvt_pk_bf16_f32 v51, v94, v95
    v_permlane16_swap_b32 v44, v46
    v_permlane16_swap_b32 v45, v47
    v_permlane16_swap_b32 v48, v50
    v_permlane16_swap_b32 v49, v51
    s_branch L_JOIN
L_HELP:
    s_lshr_b32 s96, s8, 2
    s_lshr_b32 s97, s9, 4
    s_lshl1_add_u32 s20, s96, s97
    s_cmp_le_u32 s20, 2
    s_cselect_b32 s20, 3, 2
    s_add_u32 s96, s20, s85
    s_and_b32 s97, s96, 15
    s_lshl3_add_u32 s98, s97, s3
    s_sub_u32 s99, s98, 4
    s_mul_i32 s96, s99, 49152
    s_lshl_b32 s97, s11, 7
    s_add_u32 s82, s96, s97
    s_mul_i32 s96, s20, 24960
    s_sub_u32 s97, s3, 4
    s_lshr_b32 s98, s97, 1
    s_mul_i32 s99, s98, 2080
    s_add_u32 s97, s96, s99
    s_sub_u32 s98, s3, 4
    s_and_b32 s96, s98, 1
    s_mul_i32 s99, s96, 1056
    s_add_u32 s20, s97, s99
    s_mov_b32 m0, s20
    s_nop 0
    buffer_load_dwordx4 v62, s[40:43], s82 offen lds
    s_add_u32 s82, s82, 2048
    s_add_u32 m0, s20, 8320
    s_nop 0
    buffer_load_dwordx4 v62, s[40:43], s82 offen lds
    s_add_u32 s82, s82, 2048
    s_add_u32 m0, s20, 16640
    s_nop 0
    buffer_load_dwordx4 v62, s[40:43], s82 offen lds
    s_lshr_b32 s96, s8, 2
    s_lshr_b32 s97, s9, 4
    s_lshl1_add_u32 s20, s96, s97
    s_cmp_le_u32 s20, 2
    s_cselect_b32 s20, 3, 2
    s_add_u32 s96, s20, s85
    s_and_b32 s97, s96, 15
    s_lshl3_add_u32 s98, s97, s3
    s_mul_i32 s99, s98, 49152
    s_lshl_b32 s96, s11, 7
    s_add_u32 s82, s99, s96
    s_mul_i32 s96, s20, 24960
    s_lshr_b32 s97, s3, 1
    s_mul_i32 s98, s97, 2080
    s_add_u32 s99, s96, s98
    s_and_b32 s97, s3, 1
    s_mul_i32 s96, s97, 1056
    s_add_u32 s20, s99, s96
    s_mov_b32 m0, s20
    s_nop 0
    buffer_load_dwordx4 v62, s[40:43], s82 offen lds
    s_add_u32 s82, s82, 2048
    s_add_u32 m0, s20, 8320
    s_nop 0
    buffer_load_dwordx4 v62, s[40:43], s82 offen lds
    s_add_u32 s82, s82, 2048
    s_add_u32 m0, s20, 16640
    s_nop 0
    buffer_load_dwordx4 v62, s[40:43], s82 offen lds
    s_add_u32 s96, s85, 4
    s_and_b32 s97, s96, 15
    s_lshl3_add_u32 s98, s97, s3
    s_sub_u32 s99, s98, 4
    s_mul_i32 s96, s99, 49152
    s_lshl_b32 s97, s11, 7
    s_add_u32 s82, s96, s97
    s_sub_u32 s96, s3, 4
    s_lshr_b32 s97, s96, 1
    s_mul_i32 s98, s97, 2080
    s_sub_u32 s99, s3, 4
    s_and_b32 s96, s99, 1
    s_mul_i32 s97, s96, 1056
    s_add_u32 s99, s98, s97
    s_add_u32 s20, s99, 99840
    s_mov_b32 m0, s20
    s_nop 0
    buffer_load_dwordx4 v62, s[40:43], s82 offen lds
    s_add_u32 s82, s82, 2048
    s_add_u32 m0, s20, 8320
    s_nop 0
    buffer_load_dwordx4 v62, s[40:43], s82 offen lds
    s_add_u32 s82, s82, 2048
    s_add_u32 m0, s20, 16640
    s_nop 0
    buffer_load_dwordx4 v62, s[40:43], s82 offen lds
    s_add_u32 s96, s85, 4
    s_and_b32 s97, s96, 15
    s_lshl3_add_u32 s98, s97, s3
    s_mul_i32 s99, s98, 49152
    s_lshl_b32 s96, s11, 7
    s_add_u32 s82, s99, s96
    s_lshr_b32 s96, s3, 1
    s_mul_i32 s97, s96, 2080
    s_and_b32 s98, s3, 1
    s_mul_i32 s99, s98, 1056
    s_add_u32 s96, s97, s99
    s_add_u32 s20, s96, 99840
    s_mov_b32 m0, s20
    s_nop 0
    buffer_load_dwordx4 v62, s[40:43], s82 offen lds
    s_add_u32 s82, s82, 2048
    s_add_u32 m0, s20, 8320
    s_nop 0
    buffer_load_dwordx4 v62, s[40:43], s82 offen lds
    s_add_u32 s82, s82, 2048
    s_add_u32 m0, s20, 16640
    s_nop 0
    buffer_load_dwordx4 v62, s[40:43], s82 offen lds
    s_add_u32 s96, s85, 5
    s_and_b32 s97, s96, 15
    s_lshl3_add_u32 s98, s97, s3
    s_sub_u32 s99, s98, 4
    s_mul_i32 s96, s99, 49152
    s_lshl_b32 s97, s11, 7
    s_add_u32 s82, s96, s97
    s_sub_u32 s96, s3, 4
    s_lshr_b32 s97, s96, 1
    s_mul_i32 s98, s97, 2080
    s_sub_u32 s99, s3, 4
    s_and_b32 s96, s99, 1
    s_mul_i32 s97, s96, 1056
    s_add_u32 s99, s98, s97
    s_add_u32 s20, s99, 124800
    s_mov_b32 m0, s20
    s_nop 0
    buffer_load_dwordx4 v62, s[40:43], s82 offen lds
    s_add_u32 s82, s82, 2048
    s_add_u32 m0, s20, 8320
    s_nop 0
    buffer_load_dwordx4 v62, s[40:43], s82 offen lds
    s_add_u32 s82, s82, 2048
    s_add_u32 m0, s20, 16640
    s_nop 0
    buffer_load_dwordx4 v62, s[40:43], s82 offen lds
    s_add_u32 s96, s85, 5
    s_and_b32 s97, s96, 15
    s_lshl3_add_u32 s98, s97, s3
    s_mul_i32 s99, s98, 49152
    s_lshl_b32 s96, s11, 7
    s_add_u32 s82, s99, s96
    s_lshr_b32 s96, s3, 1
    s_mul_i32 s97, s96, 2080
    s_and_b32 s98, s3, 1
    s_mul_i32 s99, s98, 1056
    s_add_u32 s96, s97, s99
    s_add_u32 s20, s96, 124800
    s_mov_b32 m0, s20
    s_nop 0
    buffer_load_dwordx4 v62, s[40:43], s82 offen lds
    s_add_u32 s82, s82, 2048
    s_add_u32 m0, s20, 8320
    s_nop 0
    buffer_load_dwordx4 v62, s[40:43], s82 offen lds
    s_add_u32 s82, s82, 2048
    s_add_u32 m0, s20, 16640
    s_nop 0
    buffer_load_dwordx4 v62, s[40:43], s82 offen lds
    s_and_b32 s96, s8, 3
    s_lshl2_add_u32 s97, s96, s3
    s_sub_u32 s98, s97, 4
    s_lshl_b32 s13, s98, 7
    v_lshrrev_b32 v61, 3, v1
    v_lshl_add_u32 v61, v61, 4, s13
    v_lshrrev_b32 v60, 3, v1
    v_mul_u32_u24 v60, 98304, v60
    v_and_b32 v9, 7, v1
    v_lshl_add_u32 v60, v9, 4, v60
    s_mul_i32 s96, s13, 6144
    s_lshr_b32 s97, s8, 2
    s_lshl1_add_u32 s98, s9, s97
    s_lshl_b32 s99, s98, 7
    s_add_u32 s97, s96, s99
    s_add_u32 s17, s97, 4096
    global_load_dwordx4 v[120:123], v61, s[86:87]
    s_waitcnt vmcnt(19)
    s_barrier
    buffer_load_dwordx4 v[80:83], v60, s[48:51], s17 offen nt
    s_add_u32 s17, s17, 12288
    buffer_load_dwordx4 v[84:87], v60, s[48:51], s17 offen nt
    s_add_u32 s17, s17, 12288
    s_waitcnt lgkmcnt(0)
    s_load_dword s24, s[32:33], s92 offset:512 glc
    s_load_dword s25, s[32:33], s92 offset:256 glc
    s_load_dword s26, s[32:33], s92 offset:1024 glc
    s_load_dword s27, s[32:33], s92 offset:768 glc
    s_waitcnt vmcnt(15)
    s_barrier
    s_add_u32 s96, s85, 6
    s_and_b32 s97, s96, 15
    s_lshl3_add_u32 s98, s97, s3
    s_sub_u32 s99, s98, 4
    s_mul_i32 s96, s99, 49152
    s_lshl_b32 s97, s11, 7
    s_add_u32 s82, s96, s97
    s_sub_u32 s96, s3, 4
    s_lshr_b32 s97, s96, 1
    s_mul_i32 s98, s97, 2080
    s_sub_u32 s99, s3, 4
    s_and_b32 s96, s99, 1
    s_mul_i32 s97, s96, 1056
    s_add_u32 s20, s98, s97
    s_mov_b32 m0, s20
    s_nop 0
    buffer_load_dwordx4 v62, s[40:43], s82 offen lds
    s_add_u32 s82, s82, 2048
    s_add_u32 m0, s20, 8320
    s_nop 0
    buffer_load_dwordx4 v62, s[40:43], s82 offen lds
    s_add_u32 s82, s82, 2048
    s_add_u32 m0, s20, 16640
    s_nop 0
    buffer_load_dwordx4 v62, s[40:43], s82 offen lds
    s_add_u32 s96, s85, 6
    s_and_b32 s97, s96, 15
    s_lshl3_add_u32 s98, s97, s3
    s_mul_i32 s99, s98, 49152
    s_lshl_b32 s96, s11, 7
    s_add_u32 s82, s99, s96
    s_lshr_b32 s96, s3, 1
    s_mul_i32 s97, s96, 2080
    s_and_b32 s98, s3, 1
    s_mul_i32 s99, s98, 1056
    s_add_u32 s20, s97, s99
    s_mov_b32 m0, s20
    s_nop 0
    buffer_load_dwordx4 v62, s[40:43], s82 offen lds
    s_add_u32 s82, s82, 2048
    s_add_u32 m0, s20, 8320
    s_nop 0
    buffer_load_dwordx4 v62, s[40:43], s82 offen lds
    s_add_u32 s82, s82, 2048
    s_add_u32 m0, s20, 16640
    s_nop 0
    buffer_load_dwordx4 v62, s[40:43], s82 offen lds
    s_waitcnt vmcnt(8)
    v_lshlrev_b32 v112, 16, v120
    v_mul_f32 v4, s7, v112
    v_exp_f32 v4, -v4
    s_nop 0
    v_add_f32 v4, 1.0, v4
    v_rcp_f32 v4, v4
    s_nop 0
    v_mul_f32 v112, v112, v4
    v_cvt_pk_bf16_f32 v112, 0, v112
    v_and_b32 v113, s6, v120
    v_mul_f32 v5, s7, v113
    v_exp_f32 v5, -v5
    s_nop 0
    v_add_f32 v5, 1.0, v5
    v_rcp_f32 v5, v5
    s_nop 0
    v_mul_f32 v113, v113, v5
    v_cvt_pk_bf16_f32 v113, 0, v113
    v_lshlrev_b32 v114, 16, v121
    v_mul_f32 v4, s7, v114
    v_exp_f32 v4, -v4
    s_nop 0
    v_add_f32 v4, 1.0, v4
    v_rcp_f32 v4, v4
    s_nop 0
    v_mul_f32 v114, v114, v4
    v_cvt_pk_bf16_f32 v114, 0, v114
    v_and_b32 v115, s6, v121
    v_mul_f32 v5, s7, v115
    v_exp_f32 v5, -v5
    s_nop 0
    v_add_f32 v5, 1.0, v5
    v_rcp_f32 v5, v5
    s_nop 0
    v_mul_f32 v115, v115, v5
    v_cvt_pk_bf16_f32 v115, 0, v115
    s_barrier
    s_add_u32 s96, s85, 7
    s_and_b32 s97, s96, 15
    s_lshl3_add_u32 s98, s97, s3
    s_sub_u32 s99, s98, 4
    s_mul_i32 s96, s99, 49152
    s_lshl_b32 s97, s11, 7
    s_add_u32 s82, s96, s97
    s_sub_u32 s96, s3, 4
    s_lshr_b32 s97, s96, 1
    s_mul_i32 s98, s97, 2080
    s_sub_u32 s99, s3, 4
    s_and_b32 s96, s99, 1
    s_mul_i32 s97, s96, 1056
    s_add_u32 s99, s98, s97
    s_add_u32 s20, s99, 24960
    s_mov_b32 m0, s20
    s_nop 0
    buffer_load_dwordx4 v62, s[40:43], s82 offen lds
    s_add_u32 s82, s82, 2048
    s_add_u32 m0, s20, 8320
    s_nop 0
    buffer_load_dwordx4 v62, s[40:43], s82 offen lds
    s_add_u32 s82, s82, 2048
    s_add_u32 m0, s20, 16640
    s_nop 0
    buffer_load_dwordx4 v62, s[40:43], s82 offen lds
    s_add_u32 s96, s85, 7
    s_and_b32 s97, s96, 15
    s_lshl3_add_u32 s98, s97, s3
    s_mul_i32 s99, s98, 49152
    s_lshl_b32 s96, s11, 7
    s_add_u32 s82, s99, s96
    s_lshr_b32 s96, s3, 1
    s_mul_i32 s97, s96, 2080
    s_and_b32 s98, s3, 1
    s_mul_i32 s99, s98, 1056
    s_add_u32 s96, s97, s99
    s_add_u32 s20, s96, 24960
    s_mov_b32 m0, s20
    s_nop 0
    buffer_load_dwordx4 v62, s[40:43], s82 offen lds
    s_add_u32 s82, s82, 2048
    s_add_u32 m0, s20, 8320
    s_nop 0
    buffer_load_dwordx4 v62, s[40:43], s82 offen lds
    s_add_u32 s82, s82, 2048
    s_add_u32 m0, s20, 16640
    s_nop 0
    buffer_load_dwordx4 v62, s[40:43], s82 offen lds
    buffer_load_dwordx4 v[88:91], v60, s[48:51], s17 offen nt
    s_add_u32 s17, s17, 12288
    buffer_load_dwordx4 v[92:95], v60, s[48:51], s17 offen nt
    s_add_u32 s17, s17, 12288
    v_lshlrev_b32 v116, 16, v122
    v_mul_f32 v4, s7, v116
    v_exp_f32 v4, -v4
    s_nop 0
    v_add_f32 v4, 1.0, v4
    v_rcp_f32 v4, v4
    s_nop 0
    v_mul_f32 v116, v116, v4
    v_cvt_pk_bf16_f32 v116, 0, v116
    v_and_b32 v117, s6, v122
    v_mul_f32 v5, s7, v117
    v_exp_f32 v5, -v5
    s_nop 0
    v_add_f32 v5, 1.0, v5
    v_rcp_f32 v5, v5
    s_nop 0
    v_mul_f32 v117, v117, v5
    v_cvt_pk_bf16_f32 v117, 0, v117
    v_lshlrev_b32 v118, 16, v123
    v_mul_f32 v4, s7, v118
    v_exp_f32 v4, -v4
    s_nop 0
    v_add_f32 v4, 1.0, v4
    v_rcp_f32 v4, v4
    s_nop 0
    v_mul_f32 v118, v118, v4
    v_cvt_pk_bf16_f32 v118, 0, v118
    v_and_b32 v119, s6, v123
    v_mul_f32 v5, s7, v119
    v_exp_f32 v5, -v5
    s_nop 0
    v_add_f32 v5, 1.0, v5
    v_rcp_f32 v5, v5
    s_nop 0
    v_mul_f32 v119, v119, v5
    v_cvt_pk_bf16_f32 v119, 0, v119
    s_barrier
    s_add_u32 s96, s85, 8
    s_and_b32 s97, s96, 15
    s_lshl3_add_u32 s98, s97, s3
    s_sub_u32 s99, s98, 4
    s_mul_i32 s96, s99, 49152
    s_lshl_b32 s97, s11, 7
    s_add_u32 s82, s96, s97
    s_sub_u32 s96, s3, 4
    s_lshr_b32 s97, s96, 1
    s_mul_i32 s98, s97, 2080
    s_sub_u32 s99, s3, 4
    s_and_b32 s96, s99, 1
    s_mul_i32 s97, s96, 1056
    s_add_u32 s99, s98, s97
    s_add_u32 s20, s99, 49920
    s_mov_b32 m0, s20
    s_nop 0
    buffer_load_dwordx4 v62, s[40:43], s82 offen lds
    s_add_u32 s82, s82, 2048
    s_add_u32 m0, s20, 8320
    s_nop 0
    buffer_load_dwordx4 v62, s[40:43], s82 offen lds
    s_add_u32 s82, s82, 2048
    s_add_u32 m0, s20, 16640
    s_nop 0
    buffer_load_dwordx4 v62, s[40:43], s82 offen lds
    s_add_u32 s96, s85, 8
    s_and_b32 s97, s96, 15
    s_lshl3_add_u32 s98, s97, s3
    s_mul_i32 s99, s98, 49152
    s_lshl_b32 s96, s11, 7
    s_add_u32 s82, s99, s96
    s_lshr_b32 s96, s3, 1
    s_mul_i32 s97, s96, 2080
    s_and_b32 s98, s3, 1
    s_mul_i32 s99, s98, 1056
    s_add_u32 s96, s97, s99
    s_add_u32 s20, s96, 49920
    s_mov_b32 m0, s20
    s_nop 0
    buffer_load_dwordx4 v62, s[40:43], s82 offen lds
    s_add_u32 s82, s82, 2048
    s_add_u32 m0, s20, 8320
    s_nop 0
    buffer_load_dwordx4 v62, s[40:43], s82 offen lds
    s_add_u32 s82, s82, 2048
    s_add_u32 m0, s20, 16640
    s_nop 0
    buffer_load_dwordx4 v62, s[40:43], s82 offen lds
    s_waitcnt lgkmcnt(0)
    s_load_dword s24, s[32:33], s92 offset:1536 glc
    s_load_dword s25, s[32:33], s92 offset:1280 glc
    s_load_dword s26, s[32:33], s92 offset:2048 glc
    s_load_dword s27, s[32:33], s92 offset:1792 glc
    s_barrier
    s_add_u32 s96, s85, 9
    s_and_b32 s97, s96, 15
    s_lshl3_add_u32 s98, s97, s3
    s_sub_u32 s99, s98, 4
    s_mul_i32 s96, s99, 49152
    s_lshl_b32 s97, s11, 7
    s_add_u32 s82, s96, s97
    s_sub_u32 s96, s3, 4
    s_lshr_b32 s97, s96, 1
    s_mul_i32 s98, s97, 2080
    s_sub_u32 s99, s3, 4
    s_and_b32 s96, s99, 1
    s_mul_i32 s97, s96, 1056
    s_add_u32 s99, s98, s97
    s_add_u32 s20, s99, 74880
    s_mov_b32 m0, s20
    s_nop 0
    buffer_load_dwordx4 v62, s[40:43], s82 offen lds
    s_add_u32 s82, s82, 2048
    s_add_u32 m0, s20, 8320
    s_nop 0
    buffer_load_dwordx4 v62, s[40:43], s82 offen lds
    s_add_u32 s82, s82, 2048
    s_add_u32 m0, s20, 16640
    s_nop 0
    buffer_load_dwordx4 v62, s[40:43], s82 offen lds
    s_add_u32 s96, s85, 9
    s_and_b32 s97, s96, 15
    s_lshl3_add_u32 s98, s97, s3
    s_mul_i32 s99, s98, 49152
    s_lshl_b32 s96, s11, 7
    s_add_u32 s82, s99, s96
    s_lshr_b32 s96, s3, 1
    s_mul_i32 s97, s96, 2080
    s_and_b32 s98, s3, 1
    s_mul_i32 s99, s98, 1056
    s_add_u32 s96, s97, s99
    s_add_u32 s20, s96, 74880
    s_mov_b32 m0, s20
    s_nop 0
    buffer_load_dwordx4 v62, s[40:43], s82 offen lds
    s_add_u32 s82, s82, 2048
    s_add_u32 m0, s20, 8320
    s_nop 0
    buffer_load_dwordx4 v62, s[40:43], s82 offen lds
    s_add_u32 s82, s82, 2048
    s_add_u32 m0, s20, 16640
    s_nop 0
    buffer_load_dwordx4 v62, s[40:43], s82 offen lds
    buffer_load_dwordx4 v[96:99], v60, s[48:51], s17 offen nt
    s_add_u32 s17, s17, 12288
    buffer_load_dwordx4 v[100:103], v60, s[48:51], s17 offen nt
    s_add_u32 s17, s17, 12288
    s_waitcnt vmcnt(29)
    v_lshlrev_b32 v4, 16, v80
    v_and_b32 v5, s6, v80
    v_mul_f32 v20, v4, v112
    v_mul_f32 v21, v5, v112
    v_lshlrev_b32 v6, 16, v81
    v_and_b32 v7, s6, v81
    v_mul_f32 v22, v6, v112
    v_mul_f32 v23, v7, v112
    v_lshlrev_b32 v4, 16, v82
    v_and_b32 v5, s6, v82
    v_mul_f32 v24, v4, v112
    v_mul_f32 v25, v5, v112
    v_lshlrev_b32 v6, 16, v83
    v_and_b32 v7, s6, v83
    v_mul_f32 v26, v6, v112
    v_mul_f32 v27, v7, v112
    s_waitcnt vmcnt(28)
    v_lshlrev_b32 v4, 16, v84
    v_and_b32 v5, s6, v84
    v_fmac_f32 v20, v4, v113
    v_fmac_f32 v21, v5, v113
    v_lshlrev_b32 v6, 16, v85
    v_and_b32 v7, s6, v85
    v_fmac_f32 v22, v6, v113
    v_fmac_f32 v23, v7, v113
    v_lshlrev_b32 v4, 16, v86
    v_and_b32 v5, s6, v86
    v_fmac_f32 v24, v4, v113
    v_fmac_f32 v25, v5, v113
    v_lshlrev_b32 v6, 16, v87
    v_and_b32 v7, s6, v87
    v_fmac_f32 v26, v6, v113
    v_fmac_f32 v27, v7, v113
    s_waitcnt vmcnt(22)
    s_barrier
    s_add_u32 s96, s85, 10
    s_and_b32 s97, s96, 15
    s_lshl3_add_u32 s98, s97, s3
    s_sub_u32 s99, s98, 4
    s_mul_i32 s96, s99, 49152
    s_lshl_b32 s97, s11, 7
    s_add_u32 s82, s96, s97
    s_sub_u32 s96, s3, 4
    s_lshr_b32 s97, s96, 1
    s_mul_i32 s98, s97, 2080
    s_sub_u32 s99, s3, 4
    s_and_b32 s96, s99, 1
    s_mul_i32 s97, s96, 1056
    s_add_u32 s99, s98, s97
    s_add_u32 s20, s99, 99840
    s_mov_b32 m0, s20
    s_nop 0
    buffer_load_dwordx4 v62, s[40:43], s82 offen lds
    s_add_u32 s82, s82, 2048
    s_add_u32 m0, s20, 8320
    s_nop 0
    buffer_load_dwordx4 v62, s[40:43], s82 offen lds
    s_add_u32 s82, s82, 2048
    s_add_u32 m0, s20, 16640
    s_nop 0
    buffer_load_dwordx4 v62, s[40:43], s82 offen lds
    s_add_u32 s96, s85, 10
    s_and_b32 s97, s96, 15
    s_lshl3_add_u32 s98, s97, s3
    s_mul_i32 s99, s98, 49152
    s_lshl_b32 s96, s11, 7
    s_add_u32 s82, s99, s96
    s_lshr_b32 s96, s3, 1
    s_mul_i32 s97, s96, 2080
    s_and_b32 s98, s3, 1
    s_mul_i32 s99, s98, 1056
    s_add_u32 s96, s97, s99
    s_add_u32 s20, s96, 99840
    s_mov_b32 m0, s20
    s_nop 0
    buffer_load_dwordx4 v62, s[40:43], s82 offen lds
    s_add_u32 s82, s82, 2048
    s_add_u32 m0, s20, 8320
    s_nop 0
    buffer_load_dwordx4 v62, s[40:43], s82 offen lds
    s_add_u32 s82, s82, 2048
    s_add_u32 m0, s20, 16640
    s_nop 0
    buffer_load_dwordx4 v62, s[40:43], s82 offen lds
    s_waitcnt vmcnt(22)
    s_barrier
    s_add_u32 s96, s85, 11
    s_and_b32 s97, s96, 15
    s_lshl3_add_u32 s98, s97, s3
    s_sub_u32 s99, s98, 4
    s_mul_i32 s96, s99, 49152
    s_lshl_b32 s97, s11, 7
    s_add_u32 s82, s96, s97
    s_sub_u32 s96, s3, 4
    s_lshr_b32 s97, s96, 1
    s_mul_i32 s98, s97, 2080
    s_sub_u32 s99, s3, 4
    s_and_b32 s96, s99, 1
    s_mul_i32 s97, s96, 1056
    s_add_u32 s99, s98, s97
    s_add_u32 s20, s99, 124800
    s_mov_b32 m0, s20
    s_nop 0
    buffer_load_dwordx4 v62, s[40:43], s82 offen lds
    s_add_u32 s82, s82, 2048
    s_add_u32 m0, s20, 8320
    s_nop 0
    buffer_load_dwordx4 v62, s[40:43], s82 offen lds
    s_add_u32 s82, s82, 2048
    s_add_u32 m0, s20, 16640
    s_nop 0
    buffer_load_dwordx4 v62, s[40:43], s82 offen lds
    s_add_u32 s96, s85, 11
    s_and_b32 s97, s96, 15
    s_lshl3_add_u32 s98, s97, s3
    s_mul_i32 s99, s98, 49152
    s_lshl_b32 s96, s11, 7
    s_add_u32 s82, s99, s96
    s_lshr_b32 s96, s3, 1
    s_mul_i32 s97, s96, 2080
    s_and_b32 s98, s3, 1
    s_mul_i32 s99, s98, 1056
    s_add_u32 s96, s97, s99
    s_add_u32 s20, s96, 124800
    s_mov_b32 m0, s20
    s_nop 0
    buffer_load_dwordx4 v62, s[40:43], s82 offen lds
    s_add_u32 s82, s82, 2048
    s_add_u32 m0, s20, 8320
    s_nop 0
    buffer_load_dwordx4 v62, s[40:43], s82 offen lds
    s_add_u32 s82, s82, 2048
    s_add_u32 m0, s20, 16640
    s_nop 0
    buffer_load_dwordx4 v62, s[40:43], s82 offen lds
    buffer_load_dwordx4 v[104:107], v60, s[48:51], s17 offen nt
    s_add_u32 s17, s17, 12288
    buffer_load_dwordx4 v[108:111], v60, s[48:51], s17 offen nt
    s_lshl2_add_u32 s96, s74, s75
    s_lshl_b32 s97, s96, 11
    s_and_b32 s98, s3, 1
    s_lshl_b32 s99, s98, 10
    s_add_u32 s96, s97, s99
    s_add_u32 s13, s96, 20971520
    s_lshl4_add_u32 s96, s21, s12
    s_lshl_b32 s97, s96, 11
    s_and_b32 s98, s3, 1
    s_lshl_b32 s99, s98, 10
    s_add_u32 s96, s97, s99
    s_add_u32 s14, s96, 12582912
    buffer_load_dwordx4 v[124:127], v2, s[32:35], s13 offen
    s_waitcnt vmcnt(30)
    v_lshlrev_b32 v4, 16, v88
    v_and_b32 v5, s6, v88
    v_fmac_f32 v20, v4, v114
    v_fmac_f32 v21, v5, v114
    v_lshlrev_b32 v6, 16, v89
    v_and_b32 v7, s6, v89
    v_fmac_f32 v22, v6, v114
    v_fmac_f32 v23, v7, v114
    v_lshlrev_b32 v4, 16, v90
    v_and_b32 v5, s6, v90
    v_fmac_f32 v24, v4, v114
    v_fmac_f32 v25, v5, v114
    v_lshlrev_b32 v6, 16, v91
    v_and_b32 v7, s6, v91
    v_fmac_f32 v26, v6, v114
    v_fmac_f32 v27, v7, v114
    s_waitcnt vmcnt(29)
    v_lshlrev_b32 v4, 16, v92
    v_and_b32 v5, s6, v92
    v_fmac_f32 v20, v4, v115
    v_fmac_f32 v21, v5, v115
    v_lshlrev_b32 v6, 16, v93
    v_and_b32 v7, s6, v93
    v_fmac_f32 v22, v6, v115
    v_fmac_f32 v23, v7, v115
    v_lshlrev_b32 v4, 16, v94
    v_and_b32 v5, s6, v94
    v_fmac_f32 v24, v4, v115
    v_fmac_f32 v25, v5, v115
    v_lshlrev_b32 v6, 16, v95
    v_and_b32 v7, s6, v95
    v_fmac_f32 v26, v6, v115
    v_fmac_f32 v27, v7, v115
    s_waitcnt lgkmcnt(0)
    s_load_dword s24, s[32:33], s92 offset:2560 glc
    s_load_dword s25, s[32:33], s92 offset:2304 glc
    s_load_dword s26, s[32:33], s92 offset:3072 glc
    s_load_dword s27, s[32:33], s92 offset:2816 glc
    s_load_dword s28, s[32:33], s92 offset:3584 glc
    s_load_dword s29, s[32:33], s92 offset:3328 glc
    s_waitcnt vmcnt(23)
    s_barrier
    s_add_u32 s96, s85, 12
    s_and_b32 s97, s96, 15
    s_lshl3_add_u32 s98, s97, s3
    s_sub_u32 s99, s98, 4
    s_mul_i32 s96, s99, 49152
    s_lshl_b32 s97, s11, 7
    s_add_u32 s82, s96, s97
    s_sub_u32 s96, s3, 4
    s_lshr_b32 s97, s96, 1
    s_mul_i32 s98, s97, 2080
    s_sub_u32 s99, s3, 4
    s_and_b32 s96, s99, 1
    s_mul_i32 s97, s96, 1056
    s_add_u32 s20, s98, s97
    s_mov_b32 m0, s20
    s_nop 0
    buffer_load_dwordx4 v62, s[40:43], s82 offen lds
    s_add_u32 s82, s82, 2048
    s_add_u32 m0, s20, 8320
    s_nop 0
    buffer_load_dwordx4 v62, s[40:43], s82 offen lds
    s_add_u32 s82, s82, 2048
    s_add_u32 m0, s20, 16640
    s_nop 0
    buffer_load_dwordx4 v62, s[40:43], s82 offen lds
    s_add_u32 s96, s85, 12
    s_and_b32 s97, s96, 15
    s_lshl3_add_u32 s98, s97, s3
    s_mul_i32 s99, s98, 49152
    s_lshl_b32 s96, s11, 7
    s_add_u32 s82, s99, s96
    s_lshr_b32 s96, s3, 1
    s_mul_i32 s97, s96, 2080
    s_and_b32 s98, s3, 1
    s_mul_i32 s99, s98, 1056
    s_add_u32 s20, s97, s99
    s_mov_b32 m0, s20
    s_nop 0
    buffer_load_dwordx4 v62, s[40:43], s82 offen lds
    s_add_u32 s82, s82, 2048
    s_add_u32 m0, s20, 8320
    s_nop 0
    buffer_load_dwordx4 v62, s[40:43], s82 offen lds
    s_add_u32 s82, s82, 2048
    s_add_u32 m0, s20, 16640
    s_nop 0
    buffer_load_dwordx4 v62, s[40:43], s82 offen lds
    s_waitcnt vmcnt(23)
    s_barrier
    s_add_u32 s96, s85, 13
    s_and_b32 s97, s96, 15
    s_lshl3_add_u32 s98, s97, s3
    s_sub_u32 s99, s98, 4
    s_mul_i32 s96, s99, 49152
    s_lshl_b32 s97, s11, 7
    s_add_u32 s82, s96, s97
    s_sub_u32 s96, s3, 4
    s_lshr_b32 s97, s96, 1
    s_mul_i32 s98, s97, 2080
    s_sub_u32 s99, s3, 4
    s_and_b32 s96, s99, 1
    s_mul_i32 s97, s96, 1056
    s_add_u32 s99, s98, s97
    s_add_u32 s20, s99, 24960
    s_mov_b32 m0, s20
    s_nop 0
    buffer_load_dwordx4 v62, s[40:43], s82 offen lds
    s_add_u32 s82, s82, 2048
    s_add_u32 m0, s20, 8320
    s_nop 0
    buffer_load_dwordx4 v62, s[40:43], s82 offen lds
    s_add_u32 s82, s82, 2048
    s_add_u32 m0, s20, 16640
    s_nop 0
    buffer_load_dwordx4 v62, s[40:43], s82 offen lds
    s_add_u32 s96, s85, 13
    s_and_b32 s97, s96, 15
    s_lshl3_add_u32 s98, s97, s3
    s_mul_i32 s99, s98, 49152
    s_lshl_b32 s96, s11, 7
    s_add_u32 s82, s99, s96
    s_lshr_b32 s96, s3, 1
    s_mul_i32 s97, s96, 2080
    s_and_b32 s98, s3, 1
    s_mul_i32 s99, s98, 1056
    s_add_u32 s96, s97, s99
    s_add_u32 s20, s96, 24960
    s_mov_b32 m0, s20
    s_nop 0
    buffer_load_dwordx4 v62, s[40:43], s82 offen lds
    s_add_u32 s82, s82, 2048
    s_add_u32 m0, s20, 8320
    s_nop 0
    buffer_load_dwordx4 v62, s[40:43], s82 offen lds
    s_add_u32 s82, s82, 2048
    s_add_u32 m0, s20, 16640
    s_nop 0
    buffer_load_dwordx4 v62, s[40:43], s82 offen lds
    s_waitcnt vmcnt(28)
    v_lshlrev_b32 v4, 16, v96
    v_and_b32 v5, s6, v96
    v_fmac_f32 v20, v4, v116
    v_fmac_f32 v21, v5, v116
    v_lshlrev_b32 v6, 16, v97
    v_and_b32 v7, s6, v97
    v_fmac_f32 v22, v6, v116
    v_fmac_f32 v23, v7, v116
    v_lshlrev_b32 v4, 16, v98
    v_and_b32 v5, s6, v98
    v_fmac_f32 v24, v4, v116
    v_fmac_f32 v25, v5, v116
    v_lshlrev_b32 v6, 16, v99
    v_and_b32 v7, s6, v99
    v_fmac_f32 v26, v6, v116
    v_fmac_f32 v27, v7, v116
    s_waitcnt vmcnt(27)
    v_lshlrev_b32 v4, 16, v100
    v_and_b32 v5, s6, v100
    v_fmac_f32 v20, v4, v117
    v_fmac_f32 v21, v5, v117
    v_lshlrev_b32 v6, 16, v101
    v_and_b32 v7, s6, v101
    v_fmac_f32 v22, v6, v117
    v_fmac_f32 v23, v7, v117
    v_lshlrev_b32 v4, 16, v102
    v_and_b32 v5, s6, v102
    v_fmac_f32 v24, v4, v117
    v_fmac_f32 v25, v5, v117
    v_lshlrev_b32 v6, 16, v103
    v_and_b32 v7, s6, v103
    v_fmac_f32 v26, v6, v117
    v_fmac_f32 v27, v7, v117
    s_waitcnt vmcnt(21)
    s_barrier
    s_add_u32 s96, s85, 14
    s_and_b32 s97, s96, 15
    s_lshl3_add_u32 s98, s97, s3
    s_sub_u32 s99, s98, 4
    s_mul_i32 s96, s99, 49152
    s_lshl_b32 s97, s11, 7
    s_add_u32 s82, s96, s97
    s_sub_u32 s96, s3, 4
    s_lshr_b32 s97, s96, 1
    s_mul_i32 s98, s97, 2080
    s_sub_u32 s99, s3, 4
    s_and_b32 s96, s99, 1
    s_mul_i32 s97, s96, 1056
    s_add_u32 s99, s98, s97
    s_add_u32 s20, s99, 49920
    s_mov_b32 m0, s20
    s_nop 0
    buffer_load_dwordx4 v62, s[40:43], s82 offen lds
    s_add_u32 s82, s82, 2048
    s_add_u32 m0, s20, 8320
    s_nop 0
    buffer_load_dwordx4 v62, s[40:43], s82 offen lds
    s_add_u32 s82, s82, 2048
    s_add_u32 m0, s20, 16640
    s_nop 0
    buffer_load_dwordx4 v62, s[40:43], s82 offen lds
    s_add_u32 s96, s85, 14
    s_and_b32 s97, s96, 15
    s_lshl3_add_u32 s98, s97, s3
    s_mul_i32 s99, s98, 49152
    s_lshl_b32 s96, s11, 7
    s_add_u32 s82, s99, s96
    s_lshr_b32 s96, s3, 1
    s_mul_i32 s97, s96, 2080
    s_and_b32 s98, s3, 1
    s_mul_i32 s99, s98, 1056
    s_add_u32 s96, s97, s99
    s_add_u32 s20, s96, 49920
    s_mov_b32 m0, s20
    s_nop 0
    buffer_load_dwordx4 v62, s[40:43], s82 offen lds
    s_add_u32 s82, s82, 2048
    s_add_u32 m0, s20, 8320
    s_nop 0
    buffer_load_dwordx4 v62, s[40:43], s82 offen lds
    s_add_u32 s82, s82, 2048
    s_add_u32 m0, s20, 16640
    s_nop 0
    buffer_load_dwordx4 v62, s[40:43], s82 offen lds
    s_waitcnt vmcnt(20)
    v_lshlrev_b32 v4, 16, v104
    v_and_b32 v5, s6, v104
    v_fmac_f32 v20, v4, v118
    v_fmac_f32 v21, v5, v118
    v_lshlrev_b32 v6, 16, v105
    v_and_b32 v7, s6, v105
    v_fmac_f32 v22, v6, v118
    v_fmac_f32 v23, v7, v118
    v_lshlrev_b32 v4, 16, v106
    v_and_b32 v5, s6, v106
    v_fmac_f32 v24, v4, v118
    v_fmac_f32 v25, v5, v118
    v_lshlrev_b32 v6, 16, v107
    v_and_b32 v7, s6, v107
    v_fmac_f32 v26, v6, v118
    v_fmac_f32 v27, v7, v118
    s_waitcnt vmcnt(19)
    v_lshlrev_b32 v4, 16, v108
    v_and_b32 v5, s6, v108
    v_fmac_f32 v20, v4, v119
    v_fmac_f32 v21, v5, v119
    v_lshlrev_b32 v6, 16, v109
    v_and_b32 v7, s6, v109
    v_fmac_f32 v22, v6, v119
    v_fmac_f32 v23, v7, v119
    v_lshlrev_b32 v4, 16, v110
    v_and_b32 v5, s6, v110
    v_fmac_f32 v24, v4, v119
    v_fmac_f32 v25, v5, v119
    v_lshlrev_b32 v6, 16, v111
    v_and_b32 v7, s6, v111
    v_fmac_f32 v26, v6, v119
    v_fmac_f32 v27, v7, v119
    s_barrier
    s_add_u32 s96, s85, 15
    s_and_b32 s97, s96, 15
    s_lshl3_add_u32 s98, s97, s3
    s_sub_u32 s99, s98, 4
    s_mul_i32 s96, s99, 49152
    s_lshl_b32 s97, s11, 7
    s_add_u32 s82, s96, s97
    s_sub_u32 s96, s3, 4
    s_lshr_b32 s97, s96, 1
    s_mul_i32 s98, s97, 2080
    s_sub_u32 s99, s3, 4
    s_and_b32 s96, s99, 1
    s_mul_i32 s97, s96, 1056
    s_add_u32 s99, s98, s97
    s_add_u32 s20, s99, 74880
    s_mov_b32 m0, s20
    s_nop 0
    buffer_load_dwordx4 v62, s[40:43], s82 offen lds
    s_add_u32 s82, s82, 2048
    s_add_u32 m0, s20, 8320
    s_nop 0
    buffer_load_dwordx4 v62, s[40:43], s82 offen lds
    s_add_u32 s82, s82, 2048
    s_add_u32 m0, s20, 16640
    s_nop 0
    buffer_load_dwordx4 v62, s[40:43], s82 offen lds
    s_add_u32 s96, s85, 15
    s_and_b32 s97, s96, 15
    s_lshl3_add_u32 s98, s97, s3
    s_mul_i32 s99, s98, 49152
    s_lshl_b32 s96, s11, 7
    s_add_u32 s82, s99, s96
    s_lshr_b32 s96, s3, 1
    s_mul_i32 s97, s96, 2080
    s_and_b32 s98, s3, 1
    s_mul_i32 s99, s98, 1056
    s_add_u32 s96, s97, s99
    s_add_u32 s20, s96, 74880
    s_mov_b32 m0, s20
    s_nop 0
    buffer_load_dwordx4 v62, s[40:43], s82 offen lds
    s_add_u32 s82, s82, 2048
    s_add_u32 m0, s20, 8320
    s_nop 0
    buffer_load_dwordx4 v62, s[40:43], s82 offen lds
    s_add_u32 s82, s82, 2048
    s_add_u32 m0, s20, 16640
    s_nop 0
    buffer_load_dwordx4 v62, s[40:43], s82 offen lds
    v_permlane32_swap_b32 v20, v24
    v_permlane32_swap_b32 v21, v25
    v_permlane32_swap_b32 v22, v26
    v_permlane32_swap_b32 v23, v27
    v_add_f32 v20, v20, v24
    v_add_f32 v21, v21, v25
    v_add_f32 v22, v22, v26
    v_add_f32 v23, v23, v27
    s_nop 0
    v_permlane16_swap_b32 v20, v22
    v_permlane16_swap_b32 v21, v23
    v_add_f32 v20, v20, v22
    v_add_f32 v21, v21, v23
    s_nop 0
    v_add_f32_dpp v20, v20, v20 row_ror:8 row_mask:0xf bank_mask:0xf
    v_add_f32_dpp v21, v21, v21 row_ror:8 row_mask:0xf bank_mask:0xf
    s_nop 1
    v_mov_b32_dpp v20, v21 quad_perm:[0,1,2,3] row_mask:0xf bank_mask:0xc
    ds_write_b32 v65, v20 offset:1024
    s_waitcnt lgkmcnt(0)
    s_waitcnt vmcnt(18)
    s_barrier
    s_cmp_lg_u32 s3, 4
    s_cbranch_scc1 L_M2F
    ds_read_b128 v[20:23], v64 offset:1024
    s_lshr_b32 s96, s8, 2
    s_lshl1_add_u32 s97, s9, s96
    s_and_b32 s98, s8, 3
    s_lshl2_add_u32 s99, s97, s98
    s_lshl_b32 s96, s99, 9
    s_add_u32 s13, s96, 131072
    s_waitcnt lgkmcnt(0)
    v_add_f32 v20, v20, v21
    v_add_f32 v22, v22, v23
    v_mov_b32 v21, s4
    v_add_f32 v20, v20, v22
    buffer_store_dwordx2 v[20:21], v63, s[32:35], s13 offen sc1
L_M2F:
    s_waitcnt vmcnt(12)
    s_waitcnt vmcnt(6)
    s_waitcnt vmcnt(0)
    s_barrier
    s_barrier
    s_add_u32 s96, s84, 1114112
    s_and_b32 s97, s96, 1048575
    s_xor_b32 s98, s88, 1048576
    s_add_u32 s13, s97, s98
    s_add_u32 m0, s89, 102400
    s_nop 0
    buffer_load_dwordx4 v74, s[44:47], s13 offen lds
    s_add_u32 s96, s84, 1179648
    s_and_b32 s97, s96, 1048575
    s_xor_b32 s98, s88, 1048576
    s_add_u32 s13, s97, s98
    s_add_u32 m0, s89, 106496
    s_nop 0
    buffer_load_dwordx4 v74, s[44:47], s13 offen lds
    s_add_u32 s96, s84, 1245184
    s_and_b32 s97, s96, 1048575
    s_xor_b32 s98, s88, 1048576
    s_add_u32 s13, s97, s98
    s_add_u32 m0, s89, 110592
    s_nop 0
    buffer_load_dwordx4 v74, s[44:47], s13 offen lds
    s_add_u32 s96, s84, 1310720
    s_and_b32 s97, s96, 1048575
    s_xor_b32 s98, s88, 1048576
    s_add_u32 s13, s97, s98
    s_add_u32 m0, s89, 114688
    s_nop 0
    buffer_load_dwordx4 v74, s[44:47], s13 offen lds
    s_add_u32 s96, s84, 1376256
    s_and_b32 s97, s96, 1048575
    s_xor_b32 s98, s88, 1048576
    s_add_u32 s13, s97, s98
    s_add_u32 m0, s89, 118784
    s_nop 0
    buffer_load_dwordx4 v74, s[44:47], s13 offen lds
    s_add_u32 s96, s84, 1441792
    s_and_b32 s97, s96, 1048575
    s_xor_b32 s98, s88, 1048576
    s_add_u32 s13, s97, s98
    s_add_u32 m0, s89, 122880
    s_nop 0
    buffer_load_dwordx4 v74, s[44:47], s13 offen lds
    s_add_u32 s96, s84, 1507328
    s_and_b32 s97, s96, 1048575
    s_xor_b32 s98, s88, 1048576
    s_add_u32 s13, s97, s98
    s_add_u32 m0, s89, 126976
    s_nop 0
    buffer_load_dwordx4 v74, s[44:47], s13 offen lds
    s_add_u32 s96, s84, 1572864
    s_and_b32 s97, s96, 1048575
    s_xor_b32 s98, s88, 1048576
    s_add_u32 s13, s97, s98
    s_add_u32 m0, s89, 131072
    s_nop 0
    buffer_load_dwordx4 v74, s[44:47], s13 offen lds
    s_mov_b32 s13, s80
    buffer_load_dwordx4 v[176:179], v72, s[52:55], s13 offen nt
    s_add_u32 s13, s80, 4294049792
    buffer_load_dwordx4 v[180:183], v72, s[52:55], s13 offen nt
    s_add_u32 s13, s80, 57344
    buffer_load_dwordx4 v[184:187], v72, s[52:55], s13 offen nt
    s_add_u32 s13, s80, 4294107136
    buffer_load_dwordx4 v[188:191], v72, s[52:55], s13 offen nt
    s_add_u32 s13, s80, 114688
    buffer_load_dwordx4 v[192:195], v72, s[52:55], s13 offen nt
    s_add_u32 s13, s80, 4294164480
    buffer_load_dwordx4 v[196:199], v72, s[52:55], s13 offen nt
    s_add_u32 s13, s80, 172032
    buffer_load_dwordx4 v[200:203], v72, s[52:55], s13 offen nt
    s_add_u32 s13, s80, 4294221824
    buffer_load_dwordx4 v[204:207], v72, s[52:55], s13 offen nt
    s_waitcnt lgkmcnt(0)
    s_barrier
    ds_read_b128 v[36:39], v76
    ds_read_b128 v[40:43], v76 offset:1024
    s_waitcnt lgkmcnt(0)
    v_mfma_f32_32x32x16_bf16 v[112:127], v[28:31], v[36:39], 0
    v_mfma_f32_32x32x16_bf16 v[112:127], v[32:35], v[40:43], v[112:127]
    s_mov_b32 s13, s80
    buffer_load_dwordx4 v[208:211], v72, s[56:59], s13 offen nt
    s_add_u32 s13, s80, 4294049792
    buffer_load_dwordx4 v[212:215], v72, s[56:59], s13 offen nt
    s_add_u32 s13, s80, 57344
    buffer_load_dwordx4 v[216:219], v72, s[56:59], s13 offen nt
    s_add_u32 s13, s80, 4294107136
    buffer_load_dwordx4 v[220:223], v72, s[56:59], s13 offen nt
L_JOIN:
    s_nop 3
    v_cvt_pk_bf16_f32 v112, 0, v112
    v_cvt_pk_bf16_f32 v113, 0, v113
    v_cvt_pk_bf16_f32 v114, 0, v114
    v_cvt_pk_bf16_f32 v115, 0, v115
    v_cvt_pk_bf16_f32 v116, 0, v116
    v_cvt_pk_bf16_f32 v117, 0, v117
    v_cvt_pk_bf16_f32 v118, 0, v118
    v_cvt_pk_bf16_f32 v119, 0, v119
    v_cvt_pk_bf16_f32 v120, 0, v120
    v_cvt_pk_bf16_f32 v121, 0, v121
    v_cvt_pk_bf16_f32 v122, 0, v122
    v_cvt_pk_bf16_f32 v123, 0, v123
    v_cvt_pk_bf16_f32 v124, 0, v124
    v_cvt_pk_bf16_f32 v125, 0, v125
    v_cvt_pk_bf16_f32 v126, 0, v126
    v_cvt_pk_bf16_f32 v127, 0, v127
    v_max3_f32 v4, v112, v113, v114
    v_min3_f32 v5, v112, v113, v114
    v_max3_f32 v4, v4, v115, v116
    v_min3_f32 v5, v5, v115, v116
    v_max3_f32 v4, v4, v117, v118
    v_min3_f32 v5, v5, v117, v118
    v_max3_f32 v4, v4, v119, v120
    v_min3_f32 v5, v5, v119, v120
    v_max3_f32 v4, v4, v121, v122
    v_min3_f32 v5, v5, v121, v122
    v_max3_f32 v4, v4, v123, v124
    v_min3_f32 v5, v5, v123, v124
    v_max3_f32 v4, v4, v125, v126
    v_min3_f32 v5, v5, v125, v126
    v_max_f32 v6, v4, v127
    v_min_f32 v7, v5, v127
    v_max_f32 v4, v4, v127
    v_min_f32 v5, v5, v127
    s_nop 0
    v_permlane32_swap_b32 v4, v6
    v_permlane32_swap_b32 v5, v7
    v_max_f32 v4, v4, v6
    v_min_f32 v5, v5, v7
    v_pk_mul_f32 v[4:5], v[4:5], s[6:7] op_sel:[0,1]
    v_pk_fma_f32 v[128:129], v[112:113], s[6:7], v[4:5] op_sel:[0,1,0] op_sel_hi:[1,1,0] neg_lo:[0,0,1] neg_hi:[0,0,1]
    v_pk_fma_f32 v[112:113], v[112:113], s[6:7], v[4:5] op_sel:[0,1,1] neg_lo:[1,0,0] neg_hi:[1,0,0]
    v_pk_fma_f32 v[130:131], v[114:115], s[6:7], v[4:5] op_sel:[0,1,0] op_sel_hi:[1,1,0] neg_lo:[0,0,1] neg_hi:[0,0,1]
    v_pk_fma_f32 v[114:115], v[114:115], s[6:7], v[4:5] op_sel:[0,1,1] neg_lo:[1,0,0] neg_hi:[1,0,0]
    v_pk_fma_f32 v[132:133], v[116:117], s[6:7], v[4:5] op_sel:[0,1,0] op_sel_hi:[1,1,0] neg_lo:[0,0,1] neg_hi:[0,0,1]
    v_pk_fma_f32 v[116:117], v[116:117], s[6:7], v[4:5] op_sel:[0,1,1] neg_lo:[1,0,0] neg_hi:[1,0,0]
    v_pk_fma_f32 v[134:135], v[118:119], s[6:7], v[4:5] op_sel:[0,1,0] op_sel_hi:[1,1,0] neg_lo:[0,0,1] neg_hi:[0,0,1]
    v_pk_fma_f32 v[118:119], v[118:119], s[6:7], v[4:5] op_sel:[0,1,1] neg_lo:[1,0,0] neg_hi:[1,0,0]
    v_pk_fma_f32 v[136:137], v[120:121], s[6:7], v[4:5] op_sel:[0,1,0] op_sel_hi:[1,1,0] neg_lo:[0,0,1] neg_hi:[0,0,1]
    v_pk_fma_f32 v[120:121], v[120:121], s[6:7], v[4:5] op_sel:[0,1,1] neg_lo:[1,0,0] neg_hi:[1,0,0]
    v_pk_fma_f32 v[138:139], v[122:123], s[6:7], v[4:5] op_sel:[0,1,0] op_sel_hi:[1,1,0] neg_lo:[0,0,1] neg_hi:[0,0,1]
    v_pk_fma_f32 v[122:123], v[122:123], s[6:7], v[4:5] op_sel:[0,1,1] neg_lo:[1,0,0] neg_hi:[1,0,0]
    v_pk_fma_f32 v[140:141], v[124:125], s[6:7], v[4:5] op_sel:[0,1,0] op_sel_hi:[1,1,0] neg_lo:[0,0,1] neg_hi:[0,0,1]
    v_pk_fma_f32 v[124:125], v[124:125], s[6:7], v[4:5] op_sel:[0,1,1] neg_lo:[1,0,0] neg_hi:[1,0,0]
    v_pk_fma_f32 v[142:143], v[126:127], s[6:7], v[4:5] op_sel:[0,1,0] op_sel_hi:[1,1,0] neg_lo:[0,0,1] neg_hi:[0,0,1]
    v_pk_fma_f32 v[126:127], v[126:127], s[6:7], v[4:5] op_sel:[0,1,1] neg_lo:[1,0,0] neg_hi:[1,0,0]
    v_exp_f32 v128, v128
    v_exp_f32 v112, v112
    v_exp_f32 v129, v129
    v_exp_f32 v113, v113
    v_exp_f32 v130, v130
    v_exp_f32 v114, v114
    v_exp_f32 v131, v131
    v_exp_f32 v115, v115
    v_exp_f32 v132, v132
    v_exp_f32 v116, v116
    v_exp_f32 v133, v133
    v_exp_f32 v117, v117
    v_exp_f32 v134, v134
    v_exp_f32 v118, v118
    v_exp_f32 v135, v135
    v_exp_f32 v119, v119
    v_exp_f32 v136, v136
    v_exp_f32 v120, v120
    v_exp_f32 v137, v137
    v_exp_f32 v121, v121
    v_exp_f32 v138, v138
    v_exp_f32 v122, v122
    v_exp_f32 v139, v139
    v_exp_f32 v123, v123
    v_exp_f32 v140, v140
    v_exp_f32 v124, v124
    v_exp_f32 v141, v141
    v_exp_f32 v125, v125
    v_exp_f32 v142, v142
    v_exp_f32 v126, v126
    v_exp_f32 v143, v143
    v_exp_f32 v127, v127
    v_pk_add_f32 v[8:9], v[128:129], v[130:131]
    v_pk_add_f32 v[10:11], v[112:113], v[114:115]
    v_pk_add_f32 v[8:9], v[8:9], v[132:133]
    v_pk_add_f32 v[10:11], v[10:11], v[116:117]
    v_pk_add_f32 v[8:9], v[8:9], v[134:135]
    v_pk_add_f32 v[10:11], v[10:11], v[118:119]
    v_pk_add_f32 v[8:9], v[8:9], v[136:137]
    v_pk_add_f32 v[10:11], v[10:11], v[120:121]
    v_pk_add_f32 v[8:9], v[8:9], v[138:139]
    v_pk_add_f32 v[10:11], v[10:11], v[122:123]
    v_pk_add_f32 v[8:9], v[8:9], v[140:141]
    v_pk_add_f32 v[10:11], v[10:11], v[124:125]
    v_pk_add_f32 v[8:9], v[8:9], v[142:143]
    v_pk_add_f32 v[10:11], v[10:11], v[126:127]
    v_add_f32 v6, v8, v9
    v_add_f32 v7, v10, v11
    v_add_f32 v4, v8, v9
    v_add_f32 v5, v10, v11
    s_nop 0
    v_permlane32_swap_b32 v4, v6
    v_permlane32_swap_b32 v5, v7
    v_pk_add_f32 v[4:5], v[4:5], v[6:7]
    v_rcp_f32 v4, v4
    v_rcp_f32 v5, v5
    s_nop 0
    v_pk_mul_f32 v[128:129], v[128:129], v[4:5] op_sel_hi:[1,0]
    v_pk_mul_f32 v[112:113], v[112:113], v[4:5] op_sel:[0,1]
    v_pk_mul_f32 v[130:131], v[130:131], v[4:5] op_sel_hi:[1,0]
    v_pk_mul_f32 v[114:115], v[114:115], v[4:5] op_sel:[0,1]
    v_pk_mul_f32 v[132:133], v[132:133], v[4:5] op_sel_hi:[1,0]
    v_pk_mul_f32 v[116:117], v[116:117], v[4:5] op_sel:[0,1]
    v_pk_mul_f32 v[134:135], v[134:135], v[4:5] op_sel_hi:[1,0]
    v_pk_mul_f32 v[118:119], v[118:119], v[4:5] op_sel:[0,1]
    v_pk_mul_f32 v[136:137], v[136:137], v[4:5] op_sel_hi:[1,0]
    v_pk_mul_f32 v[120:121], v[120:121], v[4:5] op_sel:[0,1]
    v_pk_mul_f32 v[138:139], v[138:139], v[4:5] op_sel_hi:[1,0]
    v_pk_mul_f32 v[122:123], v[122:123], v[4:5] op_sel:[0,1]
    v_pk_mul_f32 v[140:141], v[140:141], v[4:5] op_sel_hi:[1,0]
    v_pk_mul_f32 v[124:125], v[124:125], v[4:5] op_sel:[0,1]
    v_pk_mul_f32 v[142:143], v[142:143], v[4:5] op_sel_hi:[1,0]
    v_pk_mul_f32 v[126:127], v[126:127], v[4:5] op_sel:[0,1]
    v_cvt_pk_bf16_f32 v80, v128, v129
    v_cvt_pk_bf16_f32 v88, v112, v113
    v_cvt_pk_bf16_f32 v81, v130, v131
    v_cvt_pk_bf16_f32 v89, v114, v115
    v_cvt_pk_bf16_f32 v82, v132, v133
    v_cvt_pk_bf16_f32 v90, v116, v117
    v_cvt_pk_bf16_f32 v83, v134, v135
    v_cvt_pk_bf16_f32 v91, v118, v119
    v_cvt_pk_bf16_f32 v84, v136, v137
    v_cvt_pk_bf16_f32 v92, v120, v121
    v_cvt_pk_bf16_f32 v85, v138, v139
    v_cvt_pk_bf16_f32 v93, v122, v123
    v_cvt_pk_bf16_f32 v86, v140, v141
    v_cvt_pk_bf16_f32 v94, v124, v125
    v_cvt_pk_bf16_f32 v87, v142, v143
    v_cvt_pk_bf16_f32 v95, v126, v127
    ds_write_b128 v75, v[80:83]
    ds_write_b128 v75, v[84:87] offset:4096
    ds_write_b128 v75, v[88:91] offset:8192
    ds_write_b128 v75, v[92:95] offset:12288
    s_lshl_b32 s13, s3, 12
    v_add_u32 v20, s13, v63
    s_lshl_b32 s96, s76, 13
    s_add_u32 s13, s96, 32768
    v_add_u32 v21, s13, v63
    v_mov_b32 v36, 0x3f803f80
    v_mov_b32 v37, 0x3f803f80
    v_mov_b32 v38, 0x3f803f80
    v_mov_b32 v39, 0x3f803f80
    s_lshl3_add_u32 s96, s11, s3
    s_lshl_b32 s97, s96, 5
    s_add_u32 s98, s97, s10
    s_lshl_b32 s99, s98, 10
    s_add_u32 s13, s99, 25165824
    s_add_u32 s15, s13, 16384
    s_lshl3_add_u32 s96, s11, s3
    s_lshl_b32 s97, s96, 10
    s_add_u32 s16, s97, 21495808
    s_lshl_b32 s96, s10, 6
    s_add_u32 s14, s96, s16
    s_waitcnt lgkmcnt(0)
    s_barrier
    ds_read_b64_tr_b16 v[128:129], v20
    ds_read_b64_tr_b16 v[130:131], v20 offset:512
    ds_read_b64_tr_b16 v[144:145], v21
    ds_read_b64_tr_b16 v[146:147], v21 offset:512
    ds_read_b64_tr_b16 v[148:149], v21 offset:4096
    ds_read_b64_tr_b16 v[150:151], v21 offset:4608
    ds_read_b64_tr_b16 v[132:133], v20 offset:1024
    ds_read_b64_tr_b16 v[134:135], v20 offset:1536
    ds_read_b64_tr_b16 v[152:153], v21 offset:1024
    ds_read_b64_tr_b16 v[154:155], v21 offset:1536
    ds_read_b64_tr_b16 v[156:157], v21 offset:5120
    ds_read_b64_tr_b16 v[158:159], v21 offset:5632
    ds_read_b64_tr_b16 v[136:137], v20 offset:2048
    ds_read_b64_tr_b16 v[138:139], v20 offset:2560
    ds_read_b64_tr_b16 v[160:161], v21 offset:2048
    ds_read_b64_tr_b16 v[162:163], v21 offset:2560
    ds_read_b64_tr_b16 v[164:165], v21 offset:6144
    ds_read_b64_tr_b16 v[166:167], v21 offset:6656
    s_waitcnt lgkmcnt(12)
    v_mfma_f32_16x16x32_bf16 v[52:55], v[128:131], v[144:147], 0
    v_mfma_f32_16x16x32_bf16 v[56:59], v[128:131], v[148:151], 0
    v_mfma_f32_16x16x32_bf16 v[40:43], v[128:131], v[36:39], 0
    ds_read_b64_tr_b16 v[140:141], v20 offset:3072
    ds_read_b64_tr_b16 v[142:143], v20 offset:3584
    ds_read_b64_tr_b16 v[168:169], v21 offset:3072
    ds_read_b64_tr_b16 v[170:171], v21 offset:3584
    ds_read_b64_tr_b16 v[172:173], v21 offset:7168
    ds_read_b64_tr_b16 v[174:175], v21 offset:7680
    s_waitcnt lgkmcnt(12)
    v_mfma_f32_16x16x32_bf16 v[52:55], v[132:135], v[152:155], v[52:55]
    v_mfma_f32_16x16x32_bf16 v[56:59], v[132:135], v[156:159], v[56:59]
    v_mfma_f32_16x16x32_bf16 v[40:43], v[132:135], v[36:39], v[40:43]
    v_and_b32 v75, 7, v1
    v_lshlrev_b32 v75, 17, v75
    v_bfe_u32 v9, v1, 3, 1
    v_lshl_add_u32 v75, v9, 14, v75
    s_and_b32 s96, s10, 1
    s_and_b32 s97, s2, 27
    s_lshl_b32 s98, s97, 12
    s_lshr_b32 s99, s10, 1
    s_lshl_b32 s97, s99, 6
    s_add_u32 s99, s98, s97
    s_lshl2_add_u32 s98, s96, s99
    s_add_u32 s97, s98, 1048576
    s_add_u32 s17, s97, 512
    s_waitcnt lgkmcnt(6)
    v_mfma_f32_16x16x32_bf16 v[52:55], v[136:139], v[160:163], v[52:55]
    v_mfma_f32_16x16x32_bf16 v[56:59], v[136:139], v[164:167], v[56:59]
    v_mfma_f32_16x16x32_bf16 v[40:43], v[136:139], v[36:39], v[40:43]
    s_waitcnt lgkmcnt(0)
    v_mfma_f32_16x16x32_bf16 v[52:55], v[140:143], v[168:171], v[52:55]
    v_mfma_f32_16x16x32_bf16 v[56:59], v[140:143], v[172:175], v[56:59]
    v_mfma_f32_16x16x32_bf16 v[40:43], v[140:143], v[36:39], v[40:43]
    s_cmp_lt_u32 s3, 4
    s_cbranch_scc1 L_NOQX
    ds_read_b128 v[44:47], v76 offset:2048
    ds_read_b128 v[48:51], v76 offset:3072
L_NOQX:
    s_nop 3
    buffer_store_dwordx4 v[52:55], v2, s[32:35], s13 offen sc1
    buffer_store_dwordx4 v[56:59], v2, s[32:35], s15 offen sc1
    s_mov_b32 exec_lo, 0x00010001
    s_mov_b32 exec_hi, 0x00010001
    buffer_store_dwordx4 v[40:43], v1, s[32:35], s14 offen sc1
    s_mov_b64 exec, -1
    s_waitcnt lgkmcnt(0)
    v_mfma_f32_32x32x16_bf16 v[112:127], v[28:31], v[44:47], 0
    v_mfma_f32_32x32x16_bf16 v[112:127], v[32:35], v[48:51], v[112:127]
    v_lshrrev_b32 v22, 3, v1
    v_lshlrev_b32 v22, 10, v22
    v_and_b32 v9, 7, v1
    v_lshl_add_u32 v22, v9, 4, v22
    v_and_b32 v76, 7, v1
    v_lshlrev_b32 v76, 4, v76
    v_lshrrev_b32 v9, 5, v1
    v_lshl_add_u32 v76, v9, 3, v76
    s_nop 3
    v_cvt_pk_bf16_f32 v112, 0, v112
    v_cvt_pk_bf16_f32 v113, 0, v113
    v_cvt_pk_bf16_f32 v114, 0, v114
    v_cvt_pk_bf16_f32 v115, 0, v115
    v_cvt_pk_bf16_f32 v116, 0, v116
    v_cvt_pk_bf16_f32 v117, 0, v117
    v_cvt_pk_bf16_f32 v118, 0, v118
    v_cvt_pk_bf16_f32 v119, 0, v119
    v_cvt_pk_bf16_f32 v120, 0, v120
    v_cvt_pk_bf16_f32 v121, 0, v121
    v_cvt_pk_bf16_f32 v122, 0, v122
    v_cvt_pk_bf16_f32 v123, 0, v123
    v_cvt_pk_bf16_f32 v124, 0, v124
    v_cvt_pk_bf16_f32 v125, 0, v125
    v_cvt_pk_bf16_f32 v126, 0, v126
    v_cvt_pk_bf16_f32 v127, 0, v127
    v_max3_f32 v52, v112, v113, v114
    v_min3_f32 v53, v112, v113, v114
    v_max3_f32 v52, v52, v115, v116
    v_min3_f32 v53, v53, v115, v116
    v_max3_f32 v52, v52, v117, v118
    v_min3_f32 v53, v53, v117, v118
    v_max3_f32 v52, v52, v119, v120
    v_min3_f32 v53, v53, v119, v120
    v_max3_f32 v52, v52, v121, v122
    v_min3_f32 v53, v53, v121, v122
    v_max3_f32 v52, v52, v123, v124
    v_min3_f32 v53, v53, v123, v124
    v_max3_f32 v52, v52, v125, v126
    v_min3_f32 v53, v53, v125, v126
    v_max_f32 v54, v52, v127
    v_min_f32 v55, v53, v127
    v_max_f32 v52, v52, v127
    v_min_f32 v53, v53, v127
    s_nop 0
    v_permlane32_swap_b32 v52, v54
    v_permlane32_swap_b32 v53, v55
    v_max_f32 v52, v52, v54
    v_min_f32 v53, v53, v55
    v_pk_mul_f32 v[52:53], v[52:53], s[6:7] op_sel:[0,1]
    v_pk_fma_f32 v[128:129], v[112:113], s[6:7], v[52:53] op_sel:[0,1,0] op_sel_hi:[1,1,0] neg_lo:[0,0,1] neg_hi:[0,0,1]
    v_pk_fma_f32 v[112:113], v[112:113], s[6:7], v[52:53] op_sel:[0,1,1] neg_lo:[1,0,0] neg_hi:[1,0,0]
    v_pk_fma_f32 v[130:131], v[114:115], s[6:7], v[52:53] op_sel:[0,1,0] op_sel_hi:[1,1,0] neg_lo:[0,0,1] neg_hi:[0,0,1]
    v_pk_fma_f32 v[114:115], v[114:115], s[6:7], v[52:53] op_sel:[0,1,1] neg_lo:[1,0,0] neg_hi:[1,0,0]
    v_pk_fma_f32 v[132:133], v[116:117], s[6:7], v[52:53] op_sel:[0,1,0] op_sel_hi:[1,1,0] neg_lo:[0,0,1] neg_hi:[0,0,1]
    v_pk_fma_f32 v[116:117], v[116:117], s[6:7], v[52:53] op_sel:[0,1,1] neg_lo:[1,0,0] neg_hi:[1,0,0]
    v_pk_fma_f32 v[134:135], v[118:119], s[6:7], v[52:53] op_sel:[0,1,0] op_sel_hi:[1,1,0] neg_lo:[0,0,1] neg_hi:[0,0,1]
    v_pk_fma_f32 v[118:119], v[118:119], s[6:7], v[52:53] op_sel:[0,1,1] neg_lo:[1,0,0] neg_hi:[1,0,0]
    v_pk_fma_f32 v[136:137], v[120:121], s[6:7], v[52:53] op_sel:[0,1,0] op_sel_hi:[1,1,0] neg_lo:[0,0,1] neg_hi:[0,0,1]
    v_pk_fma_f32 v[120:121], v[120:121], s[6:7], v[52:53] op_sel:[0,1,1] neg_lo:[1,0,0] neg_hi:[1,0,0]
    v_pk_fma_f32 v[138:139], v[122:123], s[6:7], v[52:53] op_sel:[0,1,0] op_sel_hi:[1,1,0] neg_lo:[0,0,1] neg_hi:[0,0,1]
    v_pk_fma_f32 v[122:123], v[122:123], s[6:7], v[52:53] op_sel:[0,1,1] neg_lo:[1,0,0] neg_hi:[1,0,0]
    v_pk_fma_f32 v[140:141], v[124:125], s[6:7], v[52:53] op_sel:[0,1,0] op_sel_hi:[1,1,0] neg_lo:[0,0,1] neg_hi:[0,0,1]
    v_pk_fma_f32 v[124:125], v[124:125], s[6:7], v[52:53] op_sel:[0,1,1] neg_lo:[1,0,0] neg_hi:[1,0,0]
    v_pk_fma_f32 v[142:143], v[126:127], s[6:7], v[52:53] op_sel:[0,1,0] op_sel_hi:[1,1,0] neg_lo:[0,0,1] neg_hi:[0,0,1]
    v_pk_fma_f32 v[126:127], v[126:127], s[6:7], v[52:53] op_sel:[0,1,1] neg_lo:[1,0,0] neg_hi:[1,0,0]
    v_exp_f32 v128, v128
    v_exp_f32 v112, v112
    v_exp_f32 v129, v129
    s_waitcnt vmcnt(0)
    s_barrier
    s_cmp_lg_u32 s3, 0
    s_cbranch_scc1 L_PC
    v_mov_b32 v21, s4
    s_mov_b32 exec_hi, 0
    s_mov_b32 exec_lo, 65535
    buffer_store_dword v21, v75, s[32:35], s17 offen sc1
    s_mov_b64 exec, -1
L_PC:
    s_lshl4_add_u32 s96, s11, s10
    s_lshl_b32 s97, s96, 14
    s_lshl_b32 s98, s3, 7
    s_add_u32 s99, s97, s98
    s_add_u32 s13, s99, 25165824
    s_lshl4_add_u32 s96, s11, s10
    s_lshl_b32 s97, s96, 10
    s_lshl_b32 s98, s3, 7
    s_add_u32 s99, s97, s98
    s_add_u32 s15, s99, 29360128
    s_add_u32 s17, s17, 3072
    s_load_dwordx2 s[24:25], s[32:33], s92 offset:512 glc
    s_add_u32 s96, s84, 262144
    s_and_b32 s97, s96, 1048575
    s_add_u32 s19, s97, s88
    s_add_u32 m0, s89, 49152
    s_nop 0
    buffer_load_dwordx4 v74, s[44:47], s19 offen lds
    v_exp_f32 v113, v113
    v_exp_f32 v130, v130
    v_exp_f32 v114, v114
    v_exp_f32 v131, v131
    v_exp_f32 v115, v115
    v_exp_f32 v132, v132
    v_exp_f32 v116, v116
    v_exp_f32 v133, v133
    v_exp_f32 v117, v117
    v_exp_f32 v134, v134
    s_add_u32 s96, s84, 393216
    s_and_b32 s97, s96, 1048575
    s_add_u32 s19, s97, s88
    s_add_u32 m0, s89, 57344
    s_nop 0
    buffer_load_dwordx4 v74, s[44:47], s19 offen lds
    v_exp_f32 v118, v118
    v_exp_f32 v135, v135
    v_exp_f32 v119, v119
    v_exp_f32 v136, v136
    v_exp_f32 v120, v120
    v_exp_f32 v137, v137
    v_exp_f32 v121, v121
    v_exp_f32 v138, v138
    v_exp_f32 v122, v122
    s_add_u32 s96, s84, 524288
    s_and_b32 s97, s96, 1048575
    s_add_u32 s19, s97, s88
    s_add_u32 m0, s89, 65536
    s_nop 0
    buffer_load_dwordx4 v74, s[44:47], s19 offen lds
    v_exp_f32 v139, v139
    v_exp_f32 v123, v123
    v_exp_f32 v140, v140
    v_exp_f32 v124, v124
    v_exp_f32 v141, v141
    v_exp_f32 v125, v125
    v_exp_f32 v142, v142
    v_exp_f32 v126, v126
    v_exp_f32 v143, v143
    v_exp_f32 v127, v127
    s_add_u32 s96, s84, 655360
    s_and_b32 s97, s96, 1048575
    s_add_u32 s19, s97, s88
    s_add_u32 m0, s89, 73728
    s_nop 0
    buffer_load_dwordx4 v74, s[44:47], s19 offen lds
    v_pk_add_f32 v[56:57], v[128:129], v[130:131]
    v_pk_add_f32 v[58:59], v[112:113], v[114:115]
    v_pk_add_f32 v[56:57], v[56:57], v[132:133]
    v_pk_add_f32 v[58:59], v[58:59], v[116:117]
    v_pk_add_f32 v[56:57], v[56:57], v[134:135]
    v_pk_add_f32 v[58:59], v[58:59], v[118:119]
    v_pk_add_f32 v[56:57], v[56:57], v[136:137]
    v_pk_add_f32 v[58:59], v[58:59], v[120:121]
    v_pk_add_f32 v[56:57], v[56:57], v[138:139]
    s_add_u32 s96, s84, 786432
    s_and_b32 s97, s96, 1048575
    s_add_u32 s19, s97, s88
    s_add_u32 m0, s89, 81920
    s_nop 0
    buffer_load_dwordx4 v74, s[44:47], s19 offen lds
    v_pk_add_f32 v[58:59], v[58:59], v[122:123]
    v_pk_add_f32 v[56:57], v[56:57], v[140:141]
    v_pk_add_f32 v[58:59], v[58:59], v[124:125]
    v_pk_add_f32 v[56:57], v[56:57], v[142:143]
    v_pk_add_f32 v[58:59], v[58:59], v[126:127]
    v_add_f32 v54, v56, v57
    v_add_f32 v55, v58, v59
    v_add_f32 v52, v56, v57
    v_add_f32 v53, v58, v59
    s_nop 0
    v_permlane32_swap_b32 v52, v54
    s_add_u32 s96, s84, 917504
    s_and_b32 s97, s96, 1048575
    s_add_u32 s19, s97, s88
    s_add_u32 m0, s89, 90112
    s_nop 0
    buffer_load_dwordx4 v74, s[44:47], s19 offen lds
    v_permlane32_swap_b32 v53, v55
    v_pk_add_f32 v[52:53], v[52:53], v[54:55]
    v_rcp_f32 v52, v52
    v_rcp_f32 v53, v53
    s_nop 0
    v_pk_mul_f32 v[128:129], v[128:129], v[52:53] op_sel_hi:[1,0]
    v_pk_mul_f32 v[112:113], v[112:113], v[52:53] op_sel:[0,1]
    v_pk_mul_f32 v[130:131], v[130:131], v[52:53] op_sel_hi:[1,0]
    v_pk_mul_f32 v[114:115], v[114:115], v[52:53] op_sel:[0,1]
    v_pk_mul_f32 v[132:133], v[132:133], v[52:53] op_sel_hi:[1,0]
    s_branch SCHK_15
SPOLL_14:
    s_load_dwordx2 s[24:25], s[32:33], s92 offset:512 glc
SCHK_15:
    s_add_u32 s5, s5, 1
    s_cmp_ge_u32 s5, 300000
    s_waitcnt lgkmcnt(0)
    s_cbranch_scc1 SDONE_16
    s_cmp_lg_u32 s24, s4
    s_cbranch_scc1 SPOLL_14
    s_cmp_lg_u32 s25, s4
    s_cbranch_scc1 SPOLL_14
SDONE_16:
    s_barrier
    s_add_u32 s18, s13, 8192
    buffer_load_dwordx4 v[144:147], v22, s[32:35], s13 offen sc1
    buffer_load_dwordx4 v[148:151], v22, s[32:35], s18 offen sc1
    buffer_load_dwordx4 v[160:163], v2, s[32:35], s16 offen sc1
    s_lshl_b32 s96, s3, 5
    s_add_u32 s14, s96, 8192
    v_and_b32 v6, 3, v1
    v_lshl_add_u32 v6, v6, 3, s14
    v_lshrrev_b32 v9, 5, v1
    v_lshl_add_u32 v6, v9, 2, v6
    s_lshl_b32 s14, s3, 10
    v_and_b32 v5, 15, v1
    v_lshl_add_u32 v5, v5, 4, s14
    v_lshrrev_b32 v9, 5, v1
    v_lshl_add_u32 v5, v9, 9, v5
    v_bfe_u32 v9, v1, 4, 1
    v_lshl_add_u32 v5, v9, 3, v5
    s_lshl_b32 s96, s76, 7
    s_add_u32 s14, s96, 8192
    v_lshrrev_b32 v7, 5, v1
    v_lshl_add_u32 v7, v7, 4, s14
    s_lshl_b32 s14, s76, 12
    v_add_u32 v20, s14, v2
    v_pk_mul_f32 v[116:117], v[116:117], v[52:53] op_sel:[0,1]
    v_pk_mul_f32 v[134:135], v[134:135], v[52:53] op_sel_hi:[1,0]
    v_pk_mul_f32 v[118:119], v[118:119], v[52:53] op_sel:[0,1]
    v_pk_mul_f32 v[136:137], v[136:137], v[52:53] op_sel_hi:[1,0]
    v_pk_mul_f32 v[120:121], v[120:121], v[52:53] op_sel:[0,1]
    v_pk_mul_f32 v[138:139], v[138:139], v[52:53] op_sel_hi:[1,0]
    v_pk_mul_f32 v[122:123], v[122:123], v[52:53] op_sel:[0,1]
    v_pk_mul_f32 v[140:141], v[140:141], v[52:53] op_sel_hi:[1,0]
    v_pk_mul_f32 v[124:125], v[124:125], v[52:53] op_sel:[0,1]
    v_pk_mul_f32 v[142:143], v[142:143], v[52:53] op_sel_hi:[1,0]
    v_pk_mul_f32 v[126:127], v[126:127], v[52:53] op_sel:[0,1]
    v_cvt_pk_bf16_f32 v80, v128, v129
    v_cvt_pk_bf16_f32 v88, v112, v113
    v_cvt_pk_bf16_f32 v81, v130, v131
    v_cvt_pk_bf16_f32 v89, v114, v115
    v_cvt_pk_bf16_f32 v82, v132, v133
    v_cvt_pk_bf16_f32 v90, v116, v117
    v_cvt_pk_bf16_f32 v83, v134, v135
    v_cvt_pk_bf16_f32 v91, v118, v119
    v_cvt_pk_bf16_f32 v84, v136, v137
    v_cvt_pk_bf16_f32 v92, v120, v121
    v_cvt_pk_bf16_f32 v85, v138, v139
    v_cvt_pk_bf16_f32 v93, v122, v123
    v_cvt_pk_bf16_f32 v86, v140, v141
    v_cvt_pk_bf16_f32 v94, v124, v125
    v_cvt_pk_bf16_f32 v87, v142, v143
    v_cvt_pk_bf16_f32 v95, v126, v127
    s_waitcnt vmcnt(1)
    v_pk_add_f32 v[144:145], v[144:145], v[148:149]
    v_pk_add_f32 v[146:147], v[146:147], v[150:151]
    s_nop 1
    v_permlane32_swap_b32 v144, v146
    v_permlane32_swap_b32 v145, v147
    v_pk_add_f32 v[144:145], v[144:145], v[146:147]
    s_nop 1
    v_add_f32_dpp v144, v144, v144 row_ror:8 row_mask:0xf bank_mask:0xf
    v_add_f32_dpp v145, v145, v145 row_ror:8 row_mask:0xf bank_mask:0xf
    v_mov_b32 v146, v144
    v_mov_b32 v147, v145
    s_nop 0
    v_permlane16_swap_b32 v144, v146
    v_permlane16_swap_b32 v145, v147
    v_pk_add_f32 v[144:145], v[144:145], v[146:147]
    v_cvt_pk_bf16_f32 v144, v144, v145
    v_mov_b32 v145, s4
    s_mov_b32 exec_lo, 0xff
    s_mov_b32 exec_hi, 0xff
    buffer_store_dwordx2 v[144:145], v76, s[32:35], s15 offen sc1
    s_mov_b64 exec, -1
    s_barrier
    s_cmp_lg_u32 s3, 0
    s_cbranch_scc1 L_PC2
    v_mov_b32 v21, s4
    s_mov_b32 exec_hi, 0
    s_mov_b32 exec_lo, 65535
    buffer_store_dword v21, v75, s[32:35], s17 offen sc1
    s_mov_b64 exec, -1
L_PC2:
    s_waitcnt vmcnt(1)
    s_add_u32 s96, s84, 1048576
    s_and_b32 s97, s96, 1048575
    s_xor_b32 s98, s88, 1048576
    s_add_u32 s19, s97, s98
    s_add_u32 m0, s89, 98304
    s_nop 0
    buffer_load_dwordx4 v74, s[44:47], s19 offen lds
    v_permlane32_swap_b32 v160, v162
    v_permlane32_swap_b32 v161, v163
    v_pk_add_f32 v[160:161], v[160:161], v[162:163]
    s_nop 1
    v_add_f32_dpp v160, v160, v160 row_ror:4 row_mask:0xf bank_mask:0xf
    v_add_f32_dpp v161, v161, v161 row_ror:4 row_mask:0xf bank_mask:0xf
    s_nop 0
    v_add_f32_dpp v160, v160, v160 row_ror:8 row_mask:0xf bank_mask:0xf
    v_add_f32_dpp v161, v161, v161 row_ror:8 row_mask:0xf bank_mask:0xf
    s_add_u32 s96, s84, 1703936
    s_and_b32 s97, s96, 1048575
    s_xor_b32 s98, s88, 1048576
    s_add_u32 s19, s97, s98
    s_add_u32 m0, s89, 139264
    s_nop 0
    buffer_load_dwordx4 v74, s[44:47], s19 offen lds
    v_mov_b32 v162, v160
    v_mov_b32 v163, v161
    s_nop 0
    v_permlane16_swap_b32 v160, v162
    v_permlane16_swap_b32 v161, v163
    v_pk_add_f32 v[160:161], v[160:161], v[162:163]
    v_cvt_pk_bf16_f32 v160, v160, v161
    ds_write_b32 v6, v160
    s_waitcnt lgkmcnt(0)
    s_barrier
    ds_read_b128 v[160:163], v7
    ds_read_b128 v[164:167], v7 offset:32
    ds_read_b128 v[168:171], v7 offset:64
    ds_read_b128 v[172:175], v7 offset:96
    s_waitcnt lgkmcnt(0)
    s_lshl3_add_u32 s96, s11, s3
    s_lshl_b32 s97, s96, 11
    s_add_u32 s13, s97, 29360128
    s_load_dwordx2 s[24:25], s[32:33], s92 offset:3584 glc
    v_mfma_f32_32x32x16_bf16 v[128:143], v[160:163], v[80:83], 0
    v_mfma_f32_32x32x16_bf16 v[128:143], v[164:167], v[84:87], v[128:143]
    v_mfma_f32_32x32x16_bf16 v[128:143], v[168:171], v[88:91], v[128:143]
    v_mfma_f32_32x32x16_bf16 v[128:143], v[172:175], v[92:95], v[128:143]
    s_nop 11
    v_cvt_pk_bf16_f32 v128, 0, v128
    v_add_f32 v128, 0x358637bd, v128
    v_cvt_pk_bf16_f32 v128, 0, v128
    v_rcp_f32 v128, v128
    s_branch SCHK_18
SPOLL_17:
    s_load_dwordx2 s[24:25], s[32:33], s92 offset:3584 glc
SCHK_18:
    s_add_u32 s5, s5, 1
    s_cmp_ge_u32 s5, 300000
    s_waitcnt lgkmcnt(0)
    s_cbranch_scc1 SDONE_19
    s_cmp_lg_u32 s24, s4
    s_cbranch_scc1 SPOLL_17
    s_cmp_lg_u32 s25, s4
    s_cbranch_scc1 SPOLL_17
SDONE_19:
POLL_20:
    buffer_load_dwordx4 v[152:155], v2, s[32:35], s13 offen sc1
    buffer_load_dwordx4 v[156:159], v2, s[32:35], s13 offen offset:1024 sc1
    s_waitcnt vmcnt(0)
    v_bitop3_b32 v4, v153, v155, s4 bitop3:0x7e
    v_bitop3_b32 v4, v4, v157, s4 bitop3:0xf6
    v_bitop3_b32 v4, v4, v159, s4 bitop3:0xf6
    v_cmp_ne_u32 vcc, 0, v4
    s_cbranch_vccz PDONE_21
    s_add_u32 s5, s5, 1
    s_cmp_lt_u32 s5, 300000
    s_cbranch_scc1 POLL_20
PDONE_21:
    ds_write2_b32 v5, v152, v154 offset0:0 offset1:1
    ds_write2_b32 v5, v156, v158 offset0:64 offset1:65
    s_waitcnt lgkmcnt(0)
    s_barrier
    ds_read_b128 v[144:147], v20
    ds_read_b128 v[148:151], v20 offset:1024
    ds_read_b128 v[152:155], v20 offset:2048
    ds_read_b128 v[156:159], v20 offset:3072
    v_and_b32 v23, 31, v1
    v_lshlrev_b32 v23, 4, v23
    v_lshrrev_b32 v9, 5, v1
    v_lshl_add_u32 v23, v9, 9, v23
    s_and_b32 s96, s3, 3
    s_lshl4_add_u32 s97, s96, s12
    s_lshl_b32 s98, s97, 11
    s_add_u32 s18, s98, 131072
    s_lshl_b32 s13, s12, 7
    v_and_b32 v4, 31, v1
    v_lshl_add_u32 v4, v4, 2, s13
    global_load_dword v104, v4, s[78:79]
    buffer_load_dword v105, v3, s[32:35], 0 offen offset:256 sc1
    buffer_load_dwordx4 v[96:99], v23, s[32:35], s18 offen sc1
    buffer_load_dwordx4 v[100:103], v23, s[32:35], s18 offen offset:1024 sc1
    s_and_b32 s96, s3, 3
    s_lshl2_add_u32 s97, s10, s96
    s_lshl4_add_u32 s98, s97, s11
    s_lshl1_add_u32 s99, s98, s76
    s_lshl_b32 s96, s99, 11
    s_add_u32 s13, s96, 8388608
    v_and_b32 v8, 15, v1
    v_lshlrev_b32 v8, 4, v8
    v_bfe_u32 v9, v1, 4, 1
    v_lshl_add_u32 v8, v9, 10, v8
    v_lshrrev_b32 v9, 5, v1
    v_lshl_add_u32 v8, v9, 8, v8
    s_waitcnt lgkmcnt(3)
    v_mfma_f32_32x32x16_bf16 v[112:127], v[144:147], v[80:83], 0
    s_waitcnt lgkmcnt(2)
    v_mfma_f32_32x32x16_bf16 v[112:127], v[148:151], v[84:87], v[112:127]
    s_waitcnt lgkmcnt(1)
    v_mfma_f32_32x32x16_bf16 v[112:127], v[152:155], v[88:91], v[112:127]
    s_waitcnt lgkmcnt(0)
    v_mfma_f32_32x32x16_bf16 v[112:127], v[156:159], v[92:95], v[112:127]
    s_nop 11
    v_cvt_pk_bf16_f32 v112, 0, v112
    v_cvt_pk_bf16_f32 v113, 0, v113
    v_cvt_pk_bf16_f32 v114, 0, v114
    v_cvt_pk_bf16_f32 v115, 0, v115
    v_cvt_pk_bf16_f32 v116, 0, v116
    v_cvt_pk_bf16_f32 v117, 0, v117
    v_cvt_pk_bf16_f32 v118, 0, v118
    v_cvt_pk_bf16_f32 v119, 0, v119
    v_pk_mul_f32 v[112:113], v[112:113], v[128:129] op_sel_hi:[1,0]
    v_pk_mul_f32 v[114:115], v[114:115], v[128:129] op_sel_hi:[1,0]
    v_pk_mul_f32 v[116:117], v[116:117], v[128:129] op_sel_hi:[1,0]
    v_pk_mul_f32 v[118:119], v[118:119], v[128:129] op_sel_hi:[1,0]
    v_cvt_pk_bf16_f32 v44, v112, v113
    v_cvt_pk_bf16_f32 v45, v114, v115
    v_cvt_pk_bf16_f32 v46, v116, v117
    v_cvt_pk_bf16_f32 v47, v118, v119
    buffer_store_dwordx4 v[44:47], v8, s[32:35], s13 offen sc1
    v_cvt_pk_bf16_f32 v120, 0, v120
    v_cvt_pk_bf16_f32 v121, 0, v121
    v_cvt_pk_bf16_f32 v122, 0, v122
    v_cvt_pk_bf16_f32 v123, 0, v123
    v_cvt_pk_bf16_f32 v124, 0, v124
    v_cvt_pk_bf16_f32 v125, 0, v125
    v_cvt_pk_bf16_f32 v126, 0, v126
    v_cvt_pk_bf16_f32 v127, 0, v127
    v_pk_mul_f32 v[120:121], v[120:121], v[128:129] op_sel_hi:[1,0]
    v_pk_mul_f32 v[122:123], v[122:123], v[128:129] op_sel_hi:[1,0]
    v_pk_mul_f32 v[124:125], v[124:125], v[128:129] op_sel_hi:[1,0]
    v_pk_mul_f32 v[126:127], v[126:127], v[128:129] op_sel_hi:[1,0]
    v_cvt_pk_bf16_f32 v48, v120, v121
    v_cvt_pk_bf16_f32 v49, v122, v123
    v_cvt_pk_bf16_f32 v50, v124, v125
    v_cvt_pk_bf16_f32 v51, v126, v127
    buffer_store_dwordx4 v[48:51], v8, s[32:35], s13 offen offset:512 sc1
    s_mul_i32 s96, s76, 65600
    s_add_u32 s17, s96, 32768
    v_lshrrev_b32 v24, 5, v1
    v_lshlrev_b32 v24, 11, v24
    v_bfe_u32 v9, v1, 4, 1
    v_lshl_add_u32 v24, v9, 9, v24
    v_bfe_u32 v9, v1, 2, 2
    v_lshl_add_u32 v24, v9, 7, v24
    v_bfe_u32 v9, v1, 3, 1
    v_lshl_add_u32 v24, v9, 6, v24
    v_bfe_u32 v9, v1, 1, 1
    v_lshl_add_u32 v24, v9, 5, v24
    v_bfe_u32 v9, v1, 4, 1
    v_lshl_add_u32 v24, v9, 4, v24
    v_and_b32 v9, 1, v1
    v_lshl_add_u32 v24, v9, 3, v24
    v_xor_b32 v24, s17, v24
    v_xor_b32 v25, 16, v24
    v_xor_b32 v26, 64, v24
    v_xor_b32 v27, 80, v24
    v_and_b32 v5, 7, v1
    v_lshlrev_b32 v5, 15, v5
    v_bfe_u32 v9, v1, 3, 1
    v_lshl_add_u32 v5, v9, 12, v5
    s_and_b32 s96, s11, 1
    s_lshr_b32 s97, s10, 2
    s_and_b32 s98, s10, 3
    s_lshl_b32 s99, s98, 6
    s_lshl1_add_u32 s98, s97, s99
    s_lshl_b32 s97, s98, 12
    s_lshr_b32 s99, s11, 1
    s_lshl_b32 s98, s99, 6
    s_add_u32 s99, s97, s98
    s_lshl2_add_u32 s97, s96, s99
    s_add_u32 s98, s97, 1048576
    s_add_u32 s15, s98, 1024
    v_lshlrev_b32 v28, 16, v12
    v_and_b32 v29, s6, v12
    v_lshlrev_b32 v30, 16, v13
    v_and_b32 v31, s6, v13
    v_lshlrev_b32 v32, 16, v14
    v_and_b32 v33, s6, v14
    v_lshlrev_b32 v34, 16, v15
    v_and_b32 v35, s6, v15
    v_lshlrev_b32 v36, 16, v16
    v_and_b32 v37, s6, v16
    v_lshlrev_b32 v38, 16, v17
    v_and_b32 v39, s6, v17
    v_lshlrev_b32 v40, 16, v18
    v_and_b32 v41, s6, v18
    v_lshlrev_b32 v42, 16, v19
    v_and_b32 v43, s6, v19
    s_lshl1_add_u32 s96, s94, s77
    s_lshl_b32 s97, s96, 15
    s_add_u32 s19, s97, 8388608
    s_waitcnt vmcnt(0)
    s_barrier
    s_cmp_lg_u32 s3, 0
    s_cbranch_scc1 L_PD
    v_mov_b32 v6, s4
    s_mov_b32 exec_hi, 0
    s_mov_b32 exec_lo, 65535
    buffer_store_dword v6, v5, s[32:35], s15 offen sc1
    s_mov_b64 exec, -1
L_PD:
    s_add_u32 s96, s84, 1835008
    s_and_b32 s97, s96, 1048575
    s_xor_b32 s98, s88, 1048576
    s_add_u32 s13, s97, s98
    s_add_u32 m0, s89, 147456
    s_nop 0
    buffer_load_dwordx4 v74, s[44:47], s13 offen lds
    s_add_u32 s96, s84, 1966080
    s_and_b32 s97, s96, 1048575
    s_xor_b32 s98, s88, 1048576
    s_add_u32 s13, s97, s98
    s_add_u32 m0, s89, 155648
    s_nop 0
    buffer_load_dwordx4 v74, s[44:47], s13 offen lds
    s_and_b32 s96, s84, 1048575
    s_add_u32 s13, s96, s88
    s_add_u32 m0, s89, 32768
    s_nop 0
    buffer_load_dwordx4 v74, s[44:47], s13 offen lds
    s_add_u32 s96, s84, 131072
    s_and_b32 s97, s96, 1048575
    s_add_u32 s13, s97, s88
    s_add_u32 m0, s89, 40960
    s_nop 0
    buffer_load_dwordx4 v74, s[44:47], s13 offen lds
    v_bitop3_b32 v4, v97, v99, s4 bitop3:0x7e
    v_bitop3_b32 v4, v4, v101, s4 bitop3:0xf6
    v_bitop3_b32 v4, v4, v103, s4 bitop3:0xf6
    v_cmp_ne_u32 vcc, 0, v4
    s_cbranch_vccz TOK_22
POLL_23:
    buffer_load_dwordx4 v[96:99], v23, s[32:35], s18 offen sc1
    buffer_load_dwordx4 v[100:103], v23, s[32:35], s18 offen offset:1024 sc1
    s_waitcnt vmcnt(0)
    v_bitop3_b32 v4, v97, v99, s4 bitop3:0x7e
    v_bitop3_b32 v4, v4, v101, s4 bitop3:0xf6
    v_bitop3_b32 v4, v4, v103, s4 bitop3:0xf6
    v_cmp_ne_u32 vcc, 0, v4
    s_cbranch_vccz PDONE_24
    s_add_u32 s5, s5, 1
    s_cmp_lt_u32 s5, 300000
    s_cbranch_scc1 POLL_23
PDONE_24:
TOK_22:
    v_cmp_eq_u32 vcc, s4, v105
    s_nop 0
    s_cmp_eq_u32 vcc_lo, 0
    s_cselect_b32 s93, 1, 0
    s_and_b32 s96, s3, 3
    s_lshl_b32 s97, s96, 7
    s_add_u32 s13, s97, 12288
    v_and_b32 v4, 31, v1
    v_lshl_add_u32 v4, v4, 2, s13
    s_and_b32 s14, s3, 3
    v_add_f32 v96, v96, v100
    v_add_f32 v97, v98, v102
    v_mov_b32 v98, v96
    v_mov_b32 v99, v97
    s_cmp_eq_u32 s14, 2
    s_cselect_b32 s15, 1.0, 0
    v_permlane32_swap_b32 v96, v98
    v_permlane32_swap_b32 v97, v99
    v_pk_add_f32 v[96:97], v[96:97], v[98:99]
    v_cvt_pk_bf16_f32 v96, 0, v96
    v_cvt_pk_bf16_f32 v97, 0, v97
    v_add_f32 v96, s15, v96
    v_add_f32 v97, s15, v97
    v_cvt_pk_bf16_f32 v98, v96, v97
    ds_write_b32 v4, v98
    s_cbranch_scc0 L_NOG
    v_lshlrev_b32 v96, 16, v98
    v_and_b32 v97, s6, v98
    v_lshlrev_b32 v100, 16, v104
    v_and_b32 v101, s6, v104
    v_pk_mul_f32 v[100:101], v[100:101], v[96:97]
    v_cvt_pk_bf16_f32 v102, v100, v101
    v_lshlrev_b32 v96, 16, v102
    v_and_b32 v97, s6, v102
    v_pk_add_f32 v[96:97], v[100:101], v[96:97] neg_lo:[0,1] neg_hi:[0,1]
    v_cvt_pk_bf16_f32 v103, v96, v97
    v_add_f32 v96, v100, v101
    ds_write2_b32 v4, v102, v103 offset0:64 offset1:96
    ds_write_b32 v4, v104 offset:512
    v_add_f32_dpp v96, v96, v96 quad_perm:[1,0,3,2] row_mask:0xf bank_mask:0xf
    s_nop 1
    v_add_f32_dpp v96, v96, v96 quad_perm:[2,3,0,1] row_mask:0xf bank_mask:0xf
    s_nop 1
    v_add_f32_dpp v96, v96, v96 row_half_mirror row_mask:0xf bank_mask:0xf
    s_nop 1
    v_add_f32_dpp v96, v96, v96 row_ror:8 row_mask:0xf bank_mask:0xf
    s_lshl4_add_u32 s96, s21, s12
    s_lshl3_add_u32 s13, s96, 65536
    v_mov_b32 v98, v96
    v_mov_b32 v97, s4
    s_nop 0
    v_permlane16_swap_b32 v96, v98
    v_add_f32 v96, v96, v98
    s_mov_b64 exec, 1
    buffer_store_dwordx2 v[96:97], v3, s[32:35], s13 offen sc1
    s_mov_b64 exec, -1
L_NOG:
    s_lshl_b32 s96, s76, 6
    s_add_u32 s13, s96, 12288
    v_lshrrev_b32 v7, 5, v1
    v_lshl_add_u32 v7, v7, 5, s13
    v_and_b32 v8, 7, v1
    v_lshlrev_b32 v8, 2, v8
    v_add_u32 v8, v8, v7
    s_waitcnt lgkmcnt(0)
    s_barrier
    ds_read_b128 v[96:99], v7
    ds_read_b128 v[76:79], v7 offset:512
    ds_read_b128 v[84:87], v7 offset:640
    ds_read_b128 v[100:103], v7 offset:16
    ds_read_b128 v[80:83], v7 offset:528
    ds_read_b128 v[88:91], v7 offset:656
    ds_read_b32 v20, v8 offset:128
    ds_read_b32 v21, v8 offset:256
    ds_read_b32 v22, v8 offset:384
    ds_read_b32 v23, v8 offset:768
    s_waitcnt lgkmcnt(0)
    s_load_dwordx2 s[24:25], s[32:33], s92 offset:1024 glc
    v_lshlrev_b32 v44, 16, v96
    v_and_b32 v45, s6, v96
    v_lshlrev_b32 v46, 16, v97
    v_and_b32 v47, s6, v97
    v_lshlrev_b32 v48, 16, v98
    v_and_b32 v49, s6, v98
    v_lshlrev_b32 v50, 16, v99
    v_and_b32 v51, s6, v99
    v_lshlrev_b32 v52, 16, v100
    v_and_b32 v53, s6, v100
    v_lshlrev_b32 v54, 16, v101
    v_and_b32 v55, s6, v101
    v_lshlrev_b32 v56, 16, v102
    v_and_b32 v57, s6, v102
    v_lshlrev_b32 v58, 16, v103
    v_and_b32 v59, s6, v103
    v_and_b32 v62, 15, v1
    v_lshlrev_b32 v62, 3, v62
    s_waitcnt vmcnt(0)
    s_branch SCHK_26
SPOLL_25:
    s_load_dwordx2 s[24:25], s[32:33], s92 offset:1024 glc
SCHK_26:
    s_add_u32 s5, s5, 1
    s_cmp_ge_u32 s5, 300000
    s_waitcnt lgkmcnt(0)
    s_cbranch_scc1 SDONE_27
    s_cmp_lg_u32 s24, s4
    s_cbranch_scc1 SPOLL_25
    s_cmp_lg_u32 s25, s4
    s_cbranch_scc1 SPOLL_25
SDONE_27:
    s_barrier
    s_cmp_lt_u32 s3, 4
    s_cbranch_scc1 L_P2
    s_setprio 1
L_P2:
    s_lshl_b32 s96, s21, 7
    s_add_u32 s18, s96, 65536
    s_and_b32 s96, s83, 15
    s_lshl_b32 s97, s96, 11
    s_add_u32 s20, s97, s19
    buffer_load_dwordx4 v[144:147], v2, s[32:35], s20 offen sc1
    buffer_load_dwordx4 v[148:151], v2, s[32:35], s20 offen offset:1024 sc1
    ds_read_b64_tr_b16 v[224:225], v26
    ds_read_b64_tr_b16 v[226:227], v26 offset:1024
    ds_read_b64_tr_b16 v[228:229], v27
    ds_read_b64_tr_b16 v[230:231], v27 offset:1024
    ds_read_b64_tr_b16 v[232:233], v24
    ds_read_b64_tr_b16 v[234:235], v24 offset:1024
    ds_read_b64_tr_b16 v[236:237], v25
    ds_read_b64_tr_b16 v[238:239], v25 offset:1024
    s_add_u32 s96, s83, 1
    s_and_b32 s97, s96, 15
    s_lshl_b32 s98, s97, 11
    s_add_u32 s20, s98, s19
    buffer_load_dwordx4 v[152:155], v2, s[32:35], s20 offen sc1
    buffer_load_dwordx4 v[156:159], v2, s[32:35], s20 offen offset:1024 sc1
    s_waitcnt lgkmcnt(6)
    s_waitcnt vmcnt(3)
    v_mfma_f32_16x16x32_bf16 v[128:131], v[224:227], v[144:147], 0
    ds_read_b64_tr_b16 v[240:241], v26 offset:4096
    s_waitcnt vmcnt(2)
    v_mfma_f32_16x16x32_bf16 v[132:135], v[224:227], v[148:151], 0
    ds_read_b64_tr_b16 v[242:243], v26 offset:5120
    s_waitcnt lgkmcnt(6)
    v_mfma_f32_16x16x32_bf16 v[136:139], v[228:231], v[144:147], 0
    ds_read_b64_tr_b16 v[224:225], v27 offset:4096
    v_mfma_f32_16x16x32_bf16 v[140:143], v[228:231], v[148:151], 0
    ds_read_b64_tr_b16 v[226:227], v27 offset:5120
    s_waitcnt lgkmcnt(6)
    v_mfma_f32_16x16x32_bf16 v[112:115], v[232:235], v[144:147], 0
    ds_read_b64_tr_b16 v[228:229], v24 offset:4096
    v_mfma_f32_16x16x32_bf16 v[116:119], v[232:235], v[148:151], 0
    ds_read_b64_tr_b16 v[230:231], v24 offset:5120
    s_waitcnt lgkmcnt(6)
    v_mfma_f32_16x16x32_bf16 v[120:123], v[236:239], v[144:147], 0
    ds_read_b64_tr_b16 v[232:233], v25 offset:4096
    v_mfma_f32_16x16x32_bf16 v[124:127], v[236:239], v[148:151], 0
    ds_read_b64_tr_b16 v[234:235], v25 offset:5120
    s_add_u32 s96, s83, 2
    s_and_b32 s97, s96, 15
    s_lshl_b32 s98, s97, 11
    s_add_u32 s20, s98, s19
    buffer_load_dwordx4 v[144:147], v2, s[32:35], s20 offen sc1
    buffer_load_dwordx4 v[148:151], v2, s[32:35], s20 offen offset:1024 sc1
    s_waitcnt lgkmcnt(6)
    s_waitcnt vmcnt(3)
    v_mfma_f32_16x16x32_bf16 v[128:131], v[240:243], v[152:155], v[128:131]
    ds_read_b64_tr_b16 v[236:237], v26 offset:8192
    s_waitcnt vmcnt(2)
    v_mfma_f32_16x16x32_bf16 v[132:135], v[240:243], v[156:159], v[132:135]
    ds_read_b64_tr_b16 v[238:239], v26 offset:9216
    s_waitcnt lgkmcnt(6)
    v_mfma_f32_16x16x32_bf16 v[136:139], v[224:227], v[152:155], v[136:139]
    ds_read_b64_tr_b16 v[240:241], v27 offset:8192
    v_mfma_f32_16x16x32_bf16 v[140:143], v[224:227], v[156:159], v[140:143]
    ds_read_b64_tr_b16 v[242:243], v27 offset:9216
    s_waitcnt lgkmcnt(6)
    v_mfma_f32_16x16x32_bf16 v[112:115], v[228:231], v[152:155], v[112:115]
    ds_read_b64_tr_b16 v[224:225], v24 offset:8192
    v_mfma_f32_16x16x32_bf16 v[116:119], v[228:231], v[156:159], v[116:119]
    ds_read_b64_tr_b16 v[226:227], v24 offset:9216
    s_waitcnt lgkmcnt(6)
    v_mfma_f32_16x16x32_bf16 v[120:123], v[232:235], v[152:155], v[120:123]
    ds_read_b64_tr_b16 v[228:229], v25 offset:8192
    v_mfma_f32_16x16x32_bf16 v[124:127], v[232:235], v[156:159], v[124:127]
    ds_read_b64_tr_b16 v[230:231], v25 offset:9216
    s_add_u32 s96, s83, 3
    s_and_b32 s97, s96, 15
    s_lshl_b32 s98, s97, 11
    s_add_u32 s20, s98, s19
    buffer_load_dwordx4 v[152:155], v2, s[32:35], s20 offen sc1
    buffer_load_dwordx4 v[156:159], v2, s[32:35], s20 offen offset:1024 sc1
    s_waitcnt lgkmcnt(6)
    s_waitcnt vmcnt(3)
    v_mfma_f32_16x16x32_bf16 v[128:131], v[236:239], v[144:147], v[128:131]
    ds_read_b64_tr_b16 v[232:233], v26 offset:12288
    s_waitcnt vmcnt(2)
    v_mfma_f32_16x16x32_bf16 v[132:135], v[236:239], v[148:151], v[132:135]
    ds_read_b64_tr_b16 v[234:235], v26 offset:13312
    s_waitcnt lgkmcnt(6)
    v_mfma_f32_16x16x32_bf16 v[136:139], v[240:243], v[144:147], v[136:139]
    ds_read_b64_tr_b16 v[236:237], v27 offset:12288
    v_mfma_f32_16x16x32_bf16 v[140:143], v[240:243], v[148:151], v[140:143]
    ds_read_b64_tr_b16 v[238:239], v27 offset:13312
    s_waitcnt lgkmcnt(6)
    v_mfma_f32_16x16x32_bf16 v[112:115], v[224:227], v[144:147], v[112:115]
    ds_read_b64_tr_b16 v[240:241], v24 offset:12288
    v_mfma_f32_16x16x32_bf16 v[116:119], v[224:227], v[148:151], v[116:119]
    ds_read_b64_tr_b16 v[242:243], v24 offset:13312
    s_waitcnt lgkmcnt(6)
    v_mfma_f32_16x16x32_bf16 v[120:123], v[228:231], v[144:147], v[120:123]
    ds_read_b64_tr_b16 v[224:225], v25 offset:12288
    v_mfma_f32_16x16x32_bf16 v[124:127], v[228:231], v[148:151], v[124:127]
    ds_read_b64_tr_b16 v[226:227], v25 offset:13312
    s_add_u32 s96, s83, 4
    s_and_b32 s97, s96, 15
    s_lshl_b32 s98, s97, 11
    s_add_u32 s20, s98, s19
    buffer_load_dwordx4 v[144:147], v2, s[32:35], s20 offen sc1
    buffer_load_dwordx4 v[148:151], v2, s[32:35], s20 offen offset:1024 sc1
    s_waitcnt lgkmcnt(6)
    s_waitcnt vmcnt(3)
    v_mfma_f32_16x16x32_bf16 v[128:131], v[232:235], v[152:155], v[128:131]
    ds_read_b64_tr_b16 v[228:229], v26 offset:16384
    s_waitcnt vmcnt(2)
    v_mfma_f32_16x16x32_bf16 v[132:135], v[232:235], v[156:159], v[132:135]
    ds_read_b64_tr_b16 v[230:231], v26 offset:17408
    s_waitcnt lgkmcnt(6)
    v_mfma_f32_16x16x32_bf16 v[136:139], v[236:239], v[152:155], v[136:139]
    ds_read_b64_tr_b16 v[232:233], v27 offset:16384
    v_mfma_f32_16x16x32_bf16 v[140:143], v[236:239], v[156:159], v[140:143]
    ds_read_b64_tr_b16 v[234:235], v27 offset:17408
    s_waitcnt lgkmcnt(6)
    v_mfma_f32_16x16x32_bf16 v[112:115], v[240:243], v[152:155], v[112:115]
    ds_read_b64_tr_b16 v[236:237], v24 offset:16384
    v_mfma_f32_16x16x32_bf16 v[116:119], v[240:243], v[156:159], v[116:119]
    ds_read_b64_tr_b16 v[238:239], v24 offset:17408
    s_waitcnt lgkmcnt(6)
    v_mfma_f32_16x16x32_bf16 v[120:123], v[224:227], v[152:155], v[120:123]
    ds_read_b64_tr_b16 v[240:241], v25 offset:16384
    v_mfma_f32_16x16x32_bf16 v[124:127], v[224:227], v[156:159], v[124:127]
    ds_read_b64_tr_b16 v[242:243], v25 offset:17408
    s_add_u32 s96, s83, 5
    s_and_b32 s97, s96, 15
    s_lshl_b32 s98, s97, 11
    s_add_u32 s20, s98, s19
    buffer_load_dwordx4 v[152:155], v2, s[32:35], s20 offen sc1
    buffer_load_dwordx4 v[156:159], v2, s[32:35], s20 offen offset:1024 sc1
    s_waitcnt lgkmcnt(6)
    s_waitcnt vmcnt(3)
    v_mfma_f32_16x16x32_bf16 v[128:131], v[228:231], v[144:147], v[128:131]
    ds_read_b64_tr_b16 v[224:225], v26 offset:20480
    s_waitcnt vmcnt(2)
    v_mfma_f32_16x16x32_bf16 v[132:135], v[228:231], v[148:151], v[132:135]
    ds_read_b64_tr_b16 v[226:227], v26 offset:21504
    s_setprio 0
    s_waitcnt lgkmcnt(6)
    v_mfma_f32_16x16x32_bf16 v[136:139], v[232:235], v[144:147], v[136:139]
    ds_read_b64_tr_b16 v[228:229], v27 offset:20480
    v_mfma_f32_16x16x32_bf16 v[140:143], v[232:235], v[148:151], v[140:143]
    ds_read_b64_tr_b16 v[230:231], v27 offset:21504
    s_waitcnt lgkmcnt(6)
    v_mfma_f32_16x16x32_bf16 v[112:115], v[236:239], v[144:147], v[112:115]
    ds_read_b64_tr_b16 v[232:233], v24 offset:20480
    v_mfma_f32_16x16x32_bf16 v[116:119], v[236:239], v[148:151], v[116:119]
    ds_read_b64_tr_b16 v[234:235], v24 offset:21504
    s_waitcnt lgkmcnt(6)
    v_mfma_f32_16x16x32_bf16 v[120:123], v[240:243], v[144:147], v[120:123]
    ds_read_b64_tr_b16 v[236:237], v25 offset:20480
    v_mfma_f32_16x16x32_bf16 v[124:127], v[240:243], v[148:151], v[124:127]
    ds_read_b64_tr_b16 v[238:239], v25 offset:21504
    s_add_u32 s96, s83, 6
    s_and_b32 s97, s96, 15
    s_lshl_b32 s98, s97, 11
    s_add_u32 s20, s98, s19
    buffer_load_dwordx4 v[144:147], v2, s[32:35], s20 offen sc1
    buffer_load_dwordx4 v[148:151], v2, s[32:35], s20 offen offset:1024 sc1
    s_waitcnt lgkmcnt(6)
    s_waitcnt vmcnt(3)
    v_mfma_f32_16x16x32_bf16 v[128:131], v[224:227], v[152:155], v[128:131]
    ds_read_b64_tr_b16 v[240:241], v26 offset:24576
    s_waitcnt vmcnt(2)
    v_mfma_f32_16x16x32_bf16 v[132:135], v[224:227], v[156:159], v[132:135]
    ds_read_b64_tr_b16 v[242:243], v26 offset:25600
    s_waitcnt lgkmcnt(6)
    v_mfma_f32_16x16x32_bf16 v[136:139], v[228:231], v[152:155], v[136:139]
    ds_read_b64_tr_b16 v[224:225], v27 offset:24576
    v_mfma_f32_16x16x32_bf16 v[140:143], v[228:231], v[156:159], v[140:143]
    ds_read_b64_tr_b16 v[226:227], v27 offset:25600
    s_waitcnt lgkmcnt(6)
    v_mfma_f32_16x16x32_bf16 v[112:115], v[232:235], v[152:155], v[112:115]
    ds_read_b64_tr_b16 v[228:229], v24 offset:24576
    v_mfma_f32_16x16x32_bf16 v[116:119], v[232:235], v[156:159], v[116:119]
    ds_read_b64_tr_b16 v[230:231], v24 offset:25600
    s_waitcnt lgkmcnt(6)
    v_mfma_f32_16x16x32_bf16 v[120:123], v[236:239], v[152:155], v[120:123]
    ds_read_b64_tr_b16 v[232:233], v25 offset:24576
    v_mfma_f32_16x16x32_bf16 v[124:127], v[236:239], v[156:159], v[124:127]
    ds_read_b64_tr_b16 v[234:235], v25 offset:25600
    s_add_u32 s96, s83, 7
    s_and_b32 s97, s96, 15
    s_lshl_b32 s98, s97, 11
    s_add_u32 s20, s98, s19
    buffer_load_dwordx4 v[152:155], v2, s[32:35], s20 offen sc1
    buffer_load_dwordx4 v[156:159], v2, s[32:35], s20 offen offset:1024 sc1
    s_waitcnt lgkmcnt(6)
    s_waitcnt vmcnt(3)
    v_mfma_f32_16x16x32_bf16 v[128:131], v[240:243], v[144:147], v[128:131]
    ds_read_b64_tr_b16 v[236:237], v26 offset:28672
    s_waitcnt vmcnt(2)
    v_mfma_f32_16x16x32_bf16 v[132:135], v[240:243], v[148:151], v[132:135]
    ds_read_b64_tr_b16 v[238:239], v26 offset:29696
    s_waitcnt lgkmcnt(6)
    v_mfma_f32_16x16x32_bf16 v[136:139], v[224:227], v[144:147], v[136:139]
    ds_read_b64_tr_b16 v[240:241], v27 offset:28672
    v_mfma_f32_16x16x32_bf16 v[140:143], v[224:227], v[148:151], v[140:143]
    ds_read_b64_tr_b16 v[242:243], v27 offset:29696
    s_waitcnt lgkmcnt(6)
    v_mfma_f32_16x16x32_bf16 v[112:115], v[228:231], v[144:147], v[112:115]
    ds_read_b64_tr_b16 v[224:225], v24 offset:28672
    v_mfma_f32_16x16x32_bf16 v[116:119], v[228:231], v[148:151], v[116:119]
    ds_read_b64_tr_b16 v[226:227], v24 offset:29696
    s_waitcnt lgkmcnt(6)
    v_mfma_f32_16x16x32_bf16 v[120:123], v[232:235], v[144:147], v[120:123]
    ds_read_b64_tr_b16 v[228:229], v25 offset:28672
    v_mfma_f32_16x16x32_bf16 v[124:127], v[232:235], v[148:151], v[124:127]
    ds_read_b64_tr_b16 v[230:231], v25 offset:29696
    s_add_u32 s96, s83, 8
    s_and_b32 s97, s96, 15
    s_lshl_b32 s98, s97, 11
    s_add_u32 s20, s98, s19
    buffer_load_dwordx4 v[144:147], v2, s[32:35], s20 offen sc1
    buffer_load_dwordx4 v[148:151], v2, s[32:35], s20 offen offset:1024 sc1
    s_waitcnt lgkmcnt(6)
    s_waitcnt vmcnt(3)
    v_mfma_f32_16x16x32_bf16 v[128:131], v[236:239], v[152:155], v[128:131]
    ds_read_b64_tr_b16 v[232:233], v26 offset:32768
    s_waitcnt vmcnt(2)
    v_mfma_f32_16x16x32_bf16 v[132:135], v[236:239], v[156:159], v[132:135]
    ds_read_b64_tr_b16 v[234:235], v26 offset:33792
    s_waitcnt lgkmcnt(6)
    v_mfma_f32_16x16x32_bf16 v[136:139], v[240:243], v[152:155], v[136:139]
    ds_read_b64_tr_b16 v[236:237], v27 offset:32768
    v_mfma_f32_16x16x32_bf16 v[140:143], v[240:243], v[156:159], v[140:143]
    ds_read_b64_tr_b16 v[238:239], v27 offset:33792
    s_waitcnt lgkmcnt(6)
    v_mfma_f32_16x16x32_bf16 v[112:115], v[224:227], v[152:155], v[112:115]
    ds_read_b64_tr_b16 v[240:241], v24 offset:32768
    v_mfma_f32_16x16x32_bf16 v[116:119], v[224:227], v[156:159], v[116:119]
    ds_read_b64_tr_b16 v[242:243], v24 offset:33792
    s_waitcnt lgkmcnt(6)
    v_mfma_f32_16x16x32_bf16 v[120:123], v[228:231], v[152:155], v[120:123]
    ds_read_b64_tr_b16 v[224:225], v25 offset:32768
    v_mfma_f32_16x16x32_bf16 v[124:127], v[228:231], v[156:159], v[124:127]
    ds_read_b64_tr_b16 v[226:227], v25 offset:33792
    s_add_u32 s96, s83, 9
    s_and_b32 s97, s96, 15
    s_lshl_b32 s98, s97, 11
    s_add_u32 s20, s98, s19
    buffer_load_dwordx4 v[152:155], v2, s[32:35], s20 offen sc1
    buffer_load_dwordx4 v[156:159], v2, s[32:35], s20 offen offset:1024 sc1
    s_waitcnt lgkmcnt(6)
    s_waitcnt vmcnt(3)
    v_mfma_f32_16x16x32_bf16 v[128:131], v[232:235], v[144:147], v[128:131]
    ds_read_b64_tr_b16 v[228:229], v26 offset:36864
    s_waitcnt vmcnt(2)
    v_mfma_f32_16x16x32_bf16 v[132:135], v[232:235], v[148:151], v[132:135]
    ds_read_b64_tr_b16 v[230:231], v26 offset:37888
    s_waitcnt lgkmcnt(6)
    v_mfma_f32_16x16x32_bf16 v[136:139], v[236:239], v[144:147], v[136:139]
    ds_read_b64_tr_b16 v[232:233], v27 offset:36864
    v_mfma_f32_16x16x32_bf16 v[140:143], v[236:239], v[148:151], v[140:143]
    ds_read_b64_tr_b16 v[234:235], v27 offset:37888
    s_waitcnt lgkmcnt(6)
    v_mfma_f32_16x16x32_bf16 v[112:115], v[240:243], v[144:147], v[112:115]
    ds_read_b64_tr_b16 v[236:237], v24 offset:36864
    v_mfma_f32_16x16x32_bf16 v[116:119], v[240:243], v[148:151], v[116:119]
    ds_read_b64_tr_b16 v[238:239], v24 offset:37888
    s_waitcnt lgkmcnt(6)
    v_mfma_f32_16x16x32_bf16 v[120:123], v[224:227], v[144:147], v[120:123]
    ds_read_b64_tr_b16 v[240:241], v25 offset:36864
    v_mfma_f32_16x16x32_bf16 v[124:127], v[224:227], v[148:151], v[124:127]
    ds_read_b64_tr_b16 v[242:243], v25 offset:37888
    s_add_u32 s96, s83, 10
    s_and_b32 s97, s96, 15
    s_lshl_b32 s98, s97, 11
    s_add_u32 s20, s98, s19
    buffer_load_dwordx4 v[144:147], v2, s[32:35], s20 offen sc1
    buffer_load_dwordx4 v[148:151], v2, s[32:35], s20 offen offset:1024 sc1
    s_waitcnt lgkmcnt(6)
    s_waitcnt vmcnt(3)
    v_mfma_f32_16x16x32_bf16 v[128:131], v[228:231], v[152:155], v[128:131]
    ds_read_b64_tr_b16 v[224:225], v26 offset:40960
    s_waitcnt vmcnt(2)
    v_mfma_f32_16x16x32_bf16 v[132:135], v[228:231], v[156:159], v[132:135]
    ds_read_b64_tr_b16 v[226:227], v26 offset:41984
    s_waitcnt lgkmcnt(6)
    v_mfma_f32_16x16x32_bf16 v[136:139], v[232:235], v[152:155], v[136:139]
    ds_read_b64_tr_b16 v[228:229], v27 offset:40960
    v_mfma_f32_16x16x32_bf16 v[140:143], v[232:235], v[156:159], v[140:143]
    ds_read_b64_tr_b16 v[230:231], v27 offset:41984
    s_waitcnt lgkmcnt(6)
    v_mfma_f32_16x16x32_bf16 v[112:115], v[236:239], v[152:155], v[112:115]
    ds_read_b64_tr_b16 v[232:233], v24 offset:40960
    v_mfma_f32_16x16x32_bf16 v[116:119], v[236:239], v[156:159], v[116:119]
    ds_read_b64_tr_b16 v[234:235], v24 offset:41984
    s_waitcnt lgkmcnt(6)
    v_mfma_f32_16x16x32_bf16 v[120:123], v[240:243], v[152:155], v[120:123]
    ds_read_b64_tr_b16 v[236:237], v25 offset:40960
    v_mfma_f32_16x16x32_bf16 v[124:127], v[240:243], v[156:159], v[124:127]
    ds_read_b64_tr_b16 v[238:239], v25 offset:41984
    s_add_u32 s96, s83, 11
    s_and_b32 s97, s96, 15
    s_lshl_b32 s98, s97, 11
    s_add_u32 s20, s98, s19
    buffer_load_dwordx4 v[152:155], v2, s[32:35], s20 offen sc1
    buffer_load_dwordx4 v[156:159], v2, s[32:35], s20 offen offset:1024 sc1
    s_waitcnt lgkmcnt(6)
    s_waitcnt vmcnt(3)
    v_mfma_f32_16x16x32_bf16 v[128:131], v[224:227], v[144:147], v[128:131]
    ds_read_b64_tr_b16 v[240:241], v26 offset:45056
    s_waitcnt vmcnt(2)
    v_mfma_f32_16x16x32_bf16 v[132:135], v[224:227], v[148:151], v[132:135]
    ds_read_b64_tr_b16 v[242:243], v26 offset:46080
    s_waitcnt lgkmcnt(6)
    v_mfma_f32_16x16x32_bf16 v[136:139], v[228:231], v[144:147], v[136:139]
    ds_read_b64_tr_b16 v[224:225], v27 offset:45056
    v_mfma_f32_16x16x32_bf16 v[140:143], v[228:231], v[148:151], v[140:143]
    ds_read_b64_tr_b16 v[226:227], v27 offset:46080
    s_waitcnt lgkmcnt(6)
    v_mfma_f32_16x16x32_bf16 v[112:115], v[232:235], v[144:147], v[112:115]
    ds_read_b64_tr_b16 v[228:229], v24 offset:45056
    v_mfma_f32_16x16x32_bf16 v[116:119], v[232:235], v[148:151], v[116:119]
    ds_read_b64_tr_b16 v[230:231], v24 offset:46080
    s_waitcnt lgkmcnt(6)
    v_mfma_f32_16x16x32_bf16 v[120:123], v[236:239], v[144:147], v[120:123]
    ds_read_b64_tr_b16 v[232:233], v25 offset:45056
    v_mfma_f32_16x16x32_bf16 v[124:127], v[236:239], v[148:151], v[124:127]
    ds_read_b64_tr_b16 v[234:235], v25 offset:46080
    s_add_u32 s96, s83, 12
    s_and_b32 s97, s96, 15
    s_lshl_b32 s98, s97, 11
    s_add_u32 s20, s98, s19
    buffer_load_dwordx4 v[144:147], v2, s[32:35], s20 offen sc1
    buffer_load_dwordx4 v[148:151], v2, s[32:35], s20 offen offset:1024 sc1
    s_waitcnt lgkmcnt(6)
    s_waitcnt vmcnt(3)
    v_mfma_f32_16x16x32_bf16 v[128:131], v[240:243], v[152:155], v[128:131]
    ds_read_b64_tr_b16 v[236:237], v26 offset:49152
    s_waitcnt vmcnt(2)
    v_mfma_f32_16x16x32_bf16 v[132:135], v[240:243], v[156:159], v[132:135]
    ds_read_b64_tr_b16 v[238:239], v26 offset:50176
    s_waitcnt lgkmcnt(6)
    v_mfma_f32_16x16x32_bf16 v[136:139], v[224:227], v[152:155], v[136:139]
    ds_read_b64_tr_b16 v[240:241], v27 offset:49152
    v_mfma_f32_16x16x32_bf16 v[140:143], v[224:227], v[156:159], v[140:143]
    ds_read_b64_tr_b16 v[242:243], v27 offset:50176
    s_waitcnt lgkmcnt(6)
    v_mfma_f32_16x16x32_bf16 v[112:115], v[228:231], v[152:155], v[112:115]
    ds_read_b64_tr_b16 v[224:225], v24 offset:49152
    v_mfma_f32_16x16x32_bf16 v[116:119], v[228:231], v[156:159], v[116:119]
    ds_read_b64_tr_b16 v[226:227], v24 offset:50176
    s_waitcnt lgkmcnt(6)
    v_mfma_f32_16x16x32_bf16 v[120:123], v[232:235], v[152:155], v[120:123]
    ds_read_b64_tr_b16 v[228:229], v25 offset:49152
    v_mfma_f32_16x16x32_bf16 v[124:127], v[232:235], v[156:159], v[124:127]
    ds_read_b64_tr_b16 v[230:231], v25 offset:50176
    s_add_u32 s96, s83, 13
    s_and_b32 s97, s96, 15
    s_lshl_b32 s98, s97, 11
    s_add_u32 s20, s98, s19
    buffer_load_dwordx4 v[152:155], v2, s[32:35], s20 offen sc1
    buffer_load_dwordx4 v[156:159], v2, s[32:35], s20 offen offset:1024 sc1
    s_waitcnt lgkmcnt(6)
    s_waitcnt vmcnt(3)
    v_mfma_f32_16x16x32_bf16 v[128:131], v[236:239], v[144:147], v[128:131]
    ds_read_b64_tr_b16 v[232:233], v26 offset:53248
    s_waitcnt vmcnt(2)
    v_mfma_f32_16x16x32_bf16 v[132:135], v[236:239], v[148:151], v[132:135]
    ds_read_b64_tr_b16 v[234:235], v26 offset:54272
    s_waitcnt lgkmcnt(6)
    v_mfma_f32_16x16x32_bf16 v[136:139], v[240:243], v[144:147], v[136:139]
    ds_read_b64_tr_b16 v[236:237], v27 offset:53248
    v_mfma_f32_16x16x32_bf16 v[140:143], v[240:243], v[148:151], v[140:143]
    ds_read_b64_tr_b16 v[238:239], v27 offset:54272
    s_waitcnt lgkmcnt(6)
    v_mfma_f32_16x16x32_bf16 v[112:115], v[224:227], v[144:147], v[112:115]
    ds_read_b64_tr_b16 v[240:241], v24 offset:53248
    v_mfma_f32_16x16x32_bf16 v[116:119], v[224:227], v[148:151], v[116:119]
    ds_read_b64_tr_b16 v[242:243], v24 offset:54272
    s_waitcnt lgkmcnt(6)
    v_mfma_f32_16x16x32_bf16 v[120:123], v[228:231], v[144:147], v[120:123]
    ds_read_b64_tr_b16 v[224:225], v25 offset:53248
    v_mfma_f32_16x16x32_bf16 v[124:127], v[228:231], v[148:151], v[124:127]
    ds_read_b64_tr_b16 v[226:227], v25 offset:54272
    s_add_u32 s96, s83, 14
    s_and_b32 s97, s96, 15
    s_lshl_b32 s98, s97, 11
    s_add_u32 s20, s98, s19
    buffer_load_dwordx4 v[144:147], v2, s[32:35], s20 offen sc1
    buffer_load_dwordx4 v[148:151], v2, s[32:35], s20 offen offset:1024 sc1
    s_waitcnt lgkmcnt(6)
    s_waitcnt vmcnt(3)
    v_mfma_f32_16x16x32_bf16 v[128:131], v[232:235], v[152:155], v[128:131]
    ds_read_b64_tr_b16 v[228:229], v26 offset:57344
    s_waitcnt vmcnt(2)
    v_mfma_f32_16x16x32_bf16 v[132:135], v[232:235], v[156:159], v[132:135]
    ds_read_b64_tr_b16 v[230:231], v26 offset:58368
    s_waitcnt lgkmcnt(6)
    v_mfma_f32_16x16x32_bf16 v[136:139], v[236:239], v[152:155], v[136:139]
    ds_read_b64_tr_b16 v[232:233], v27 offset:57344
    v_mfma_f32_16x16x32_bf16 v[140:143], v[236:239], v[156:159], v[140:143]
    ds_read_b64_tr_b16 v[234:235], v27 offset:58368
    s_waitcnt lgkmcnt(6)
    v_mfma_f32_16x16x32_bf16 v[112:115], v[240:243], v[152:155], v[112:115]
    ds_read_b64_tr_b16 v[236:237], v24 offset:57344
    v_mfma_f32_16x16x32_bf16 v[116:119], v[240:243], v[156:159], v[116:119]
    ds_read_b64_tr_b16 v[238:239], v24 offset:58368
    s_waitcnt lgkmcnt(6)
    v_mfma_f32_16x16x32_bf16 v[120:123], v[224:227], v[152:155], v[120:123]
    ds_read_b64_tr_b16 v[240:241], v25 offset:57344
    v_mfma_f32_16x16x32_bf16 v[124:127], v[224:227], v[156:159], v[124:127]
    ds_read_b64_tr_b16 v[242:243], v25 offset:58368
    s_add_u32 s96, s83, 15
    s_and_b32 s97, s96, 15
    s_lshl_b32 s98, s97, 11
    s_add_u32 s20, s98, s19
    buffer_load_dwordx4 v[152:155], v2, s[32:35], s20 offen sc1
    buffer_load_dwordx4 v[156:159], v2, s[32:35], s20 offen offset:1024 sc1
    buffer_load_dwordx2 v[60:61], v62, s[32:35], s18 offen sc1
    s_waitcnt lgkmcnt(6)
    s_waitcnt vmcnt(4)
    v_mfma_f32_16x16x32_bf16 v[128:131], v[228:231], v[144:147], v[128:131]
    ds_read_b64_tr_b16 v[224:225], v26 offset:61440
    s_waitcnt vmcnt(3)
    v_mfma_f32_16x16x32_bf16 v[132:135], v[228:231], v[148:151], v[132:135]
    ds_read_b64_tr_b16 v[226:227], v26 offset:62464
    s_waitcnt lgkmcnt(6)
    v_mfma_f32_16x16x32_bf16 v[136:139], v[232:235], v[144:147], v[136:139]
    ds_read_b64_tr_b16 v[228:229], v27 offset:61440
    v_mfma_f32_16x16x32_bf16 v[140:143], v[232:235], v[148:151], v[140:143]
    ds_read_b64_tr_b16 v[230:231], v27 offset:62464
    s_waitcnt lgkmcnt(6)
    v_mfma_f32_16x16x32_bf16 v[112:115], v[236:239], v[144:147], v[112:115]
    ds_read_b64_tr_b16 v[232:233], v24 offset:61440
    v_mfma_f32_16x16x32_bf16 v[116:119], v[236:239], v[148:151], v[116:119]
    ds_read_b64_tr_b16 v[234:235], v24 offset:62464
    s_waitcnt lgkmcnt(6)
    v_mfma_f32_16x16x32_bf16 v[120:123], v[240:243], v[144:147], v[120:123]
    ds_read_b64_tr_b16 v[236:237], v25 offset:61440
    v_mfma_f32_16x16x32_bf16 v[124:127], v[240:243], v[148:151], v[124:127]
    ds_read_b64_tr_b16 v[238:239], v25 offset:62464
    s_waitcnt lgkmcnt(6)
    s_waitcnt vmcnt(2)
    v_mfma_f32_16x16x32_bf16 v[128:131], v[224:227], v[152:155], v[128:131]
    s_waitcnt vmcnt(1)
    v_mfma_f32_16x16x32_bf16 v[132:135], v[224:227], v[156:159], v[132:135]
    s_waitcnt lgkmcnt(4)
    v_mfma_f32_16x16x32_bf16 v[136:139], v[228:231], v[152:155], v[136:139]
    v_mfma_f32_16x16x32_bf16 v[140:143], v[228:231], v[156:159], v[140:143]
    s_waitcnt lgkmcnt(2)
    v_mfma_f32_16x16x32_bf16 v[112:115], v[232:235], v[152:155], v[112:115]
    v_mfma_f32_16x16x32_bf16 v[116:119], v[232:235], v[156:159], v[116:119]
    s_waitcnt lgkmcnt(0)
    v_mfma_f32_16x16x32_bf16 v[120:123], v[236:239], v[152:155], v[120:123]
    v_mfma_f32_16x16x32_bf16 v[124:127], v[236:239], v[156:159], v[124:127]
    s_setprio 0
    s_lshl_b32 s13, s3, 12
    v_add_u32 v4, s13, v2
    v_xor_b32 v5, 0x4000, v4
    ds_write_b128 v4, v[128:131]
    ds_write_b128 v4, v[132:135] offset:1024
    ds_write_b128 v4, v[136:139] offset:2048
    ds_write_b128 v4, v[140:143] offset:3072
    s_lshl_b32 s96, s76, 11
    s_and_b32 s97, s3, 3
    s_lshl_b32 s98, s97, 9
    s_add_u32 s99, s96, s98
    s_add_u32 s13, s99, 131072
    v_and_b32 v6, 31, v1
    v_lshl_add_u32 v6, v6, 4, s13
    v_lshrrev_b32 v9, 5, v1
    v_lshl_add_u32 v6, v9, 3, v6
    s_lshl_b32 s96, s76, 6
    s_add_u32 s13, s96, 139008
    v_and_b32 v7, 7, v1
    v_lshl_add_u32 v7, v7, 2, s13
    v_lshrrev_b32 v9, 5, v1
    v_lshl_add_u32 v7, v9, 5, v7
    s_lshl_b32 s96, s21, 15
    s_lshl_b32 s97, s3, 8
    s_add_u32 s98, s96, s97
    s_add_u32 s19, s98, 12582912
    v_and_b32 v64, 15, v1
    v_lshlrev_b32 v64, 4, v64
    v_lshrrev_b32 v9, 4, v1
    v_lshl_add_u32 v64, v9, 11, v64
    v_mov_b32 v228, 0x3f803f80
    s_waitcnt lgkmcnt(0)
    s_barrier
    ds_read_b128 v[128:131], v5
    ds_read_b128 v[132:135], v5 offset:1024
    ds_read_b128 v[136:139], v5 offset:2048
    ds_read_b128 v[140:143], v5 offset:3072
    s_add_u32 s14, s80, 114688
    s_lshl2_add_u32 m0, s89, 67584
    s_nop 0
    buffer_load_dwordx4 v72, s[56:59], s14 offen nt lds
    s_add_u32 s14, s80, 172032
    s_lshl2_add_u32 m0, s89, 68608
    s_nop 0
    buffer_load_dwordx4 v72, s[56:59], s14 offen nt lds
    s_mov_b32 s14, s81
    s_lshl2_add_u32 m0, s89, 98304
    s_nop 0
    buffer_load_dwordx4 v73, s[60:63], s14 offen nt lds
    s_waitcnt lgkmcnt(3)
    v_pk_add_f32 v[112:113], v[112:113], v[128:129]
    v_pk_add_f32 v[114:115], v[114:115], v[130:131]
    s_waitcnt lgkmcnt(2)
    v_pk_add_f32 v[116:117], v[116:117], v[132:133]
    v_pk_add_f32 v[118:119], v[118:119], v[134:135]
    s_nop 0
    v_permlane16_swap_b32 v112, v116
    v_permlane16_swap_b32 v113, v117
    v_permlane16_swap_b32 v114, v118
    v_permlane16_swap_b32 v115, v119
    v_cvt_pk_bf16_f32 v112, 0, v112
    v_cvt_pk_bf16_f32 v113, 0, v113
    v_cvt_pk_bf16_f32 v114, 0, v114
    v_cvt_pk_bf16_f32 v115, 0, v115
    v_cvt_pk_bf16_f32 v116, 0, v116
    v_cvt_pk_bf16_f32 v117, 0, v117
    v_cvt_pk_bf16_f32 v118, 0, v118
    v_cvt_pk_bf16_f32 v119, 0, v119
    v_pk_mul_f32 v[112:113], v[112:113], v[44:45]
    v_pk_mul_f32 v[114:115], v[114:115], v[46:47]
    v_pk_mul_f32 v[116:117], v[116:117], v[48:49]
    v_pk_mul_f32 v[118:119], v[118:119], v[50:51]
    v_cvt_pk_bf16_f32 v112, 0, v112
    v_cvt_pk_bf16_f32 v113, 0, v113
    v_cvt_pk_bf16_f32 v114, 0, v114
    v_cvt_pk_bf16_f32 v115, 0, v115
    v_cvt_pk_bf16_f32 v116, 0, v116
    v_cvt_pk_bf16_f32 v117, 0, v117
    v_cvt_pk_bf16_f32 v118, 0, v118
    v_cvt_pk_bf16_f32 v119, 0, v119
    v_pk_add_f32 v[112:113], v[112:113], v[28:29]
    v_pk_add_f32 v[114:115], v[114:115], v[30:31]
    v_pk_add_f32 v[116:117], v[116:117], v[32:33]
    v_pk_add_f32 v[118:119], v[118:119], v[34:35]
    v_cvt_pk_bf16_f32 v12, v112, v113
    v_cvt_pk_bf16_f32 v13, v114, v115
    v_cvt_pk_bf16_f32 v14, v116, v117
    v_cvt_pk_bf16_f32 v15, v118, v119
    s_waitcnt lgkmcnt(1)
    v_pk_add_f32 v[120:121], v[120:121], v[136:137]
    v_pk_add_f32 v[122:123], v[122:123], v[138:139]
    s_waitcnt lgkmcnt(0)
    v_pk_add_f32 v[124:125], v[124:125], v[140:141]
    v_pk_add_f32 v[126:127], v[126:127], v[142:143]
    s_nop 0
    v_permlane16_swap_b32 v120, v124
    v_permlane16_swap_b32 v121, v125
    v_permlane16_swap_b32 v122, v126
    v_permlane16_swap_b32 v123, v127
    v_cvt_pk_bf16_f32 v120, 0, v120
    v_cvt_pk_bf16_f32 v121, 0, v121
    v_cvt_pk_bf16_f32 v122, 0, v122
    v_cvt_pk_bf16_f32 v123, 0, v123
    v_cvt_pk_bf16_f32 v124, 0, v124
    v_cvt_pk_bf16_f32 v125, 0, v125
    v_cvt_pk_bf16_f32 v126, 0, v126
    v_cvt_pk_bf16_f32 v127, 0, v127
    v_pk_mul_f32 v[120:121], v[120:121], v[52:53]
    v_pk_mul_f32 v[122:123], v[122:123], v[54:55]
    v_pk_mul_f32 v[124:125], v[124:125], v[56:57]
    v_pk_mul_f32 v[126:127], v[126:127], v[58:59]
    v_cvt_pk_bf16_f32 v120, 0, v120
    v_cvt_pk_bf16_f32 v121, 0, v121
    v_cvt_pk_bf16_f32 v122, 0, v122
    v_cvt_pk_bf16_f32 v123, 0, v123
    v_cvt_pk_bf16_f32 v124, 0, v124
    v_cvt_pk_bf16_f32 v125, 0, v125
    v_cvt_pk_bf16_f32 v126, 0, v126
    v_cvt_pk_bf16_f32 v127, 0, v127
    v_pk_add_f32 v[120:121], v[120:121], v[36:37]
    v_pk_add_f32 v[122:123], v[122:123], v[38:39]
    v_pk_add_f32 v[124:125], v[124:125], v[40:41]
    v_pk_add_f32 v[126:127], v[126:127], v[42:43]
    v_cvt_pk_bf16_f32 v16, v120, v121
    v_cvt_pk_bf16_f32 v17, v122, v123
    v_cvt_pk_bf16_f32 v18, v124, v125
    v_cvt_pk_bf16_f32 v19, v126, v127
    v_dot2_f32_bf16 v224, v12, v228, 0
    v_dot2_f32_bf16 v226, v12, v12, 0
    v_dot2_f32_bf16 v225, v12, v76, 0
    v_dot2_f32_bf16 v227, v12, v84, 0
    v_dot2_f32_bf16 v224, v13, v228, v224
    v_dot2_f32_bf16 v226, v13, v13, v226
    v_dot2_f32_bf16 v225, v13, v77, v225
    v_dot2_f32_bf16 v227, v13, v85, v227
    v_dot2_f32_bf16 v224, v14, v228, v224
    v_dot2_f32_bf16 v226, v14, v14, v226
    v_dot2_f32_bf16 v225, v14, v78, v225
    v_dot2_f32_bf16 v227, v14, v86, v227
    v_dot2_f32_bf16 v224, v15, v228, v224
    v_dot2_f32_bf16 v226, v15, v15, v226
    v_dot2_f32_bf16 v225, v15, v79, v225
    v_dot2_f32_bf16 v227, v15, v87, v227
    v_dot2_f32_bf16 v224, v16, v228, v224
    v_dot2_f32_bf16 v226, v16, v16, v226
    v_dot2_f32_bf16 v225, v16, v80, v225
    v_dot2_f32_bf16 v227, v16, v88, v227
    v_dot2_f32_bf16 v224, v17, v228, v224
    v_dot2_f32_bf16 v226, v17, v17, v226
    v_dot2_f32_bf16 v225, v17, v81, v225
    v_dot2_f32_bf16 v227, v17, v89, v227
    v_dot2_f32_bf16 v224, v18, v228, v224
    v_dot2_f32_bf16 v226, v18, v18, v226
    v_dot2_f32_bf16 v225, v18, v82, v225
    v_dot2_f32_bf16 v227, v18, v90, v227
    v_dot2_f32_bf16 v224, v19, v228, v224
    v_dot2_f32_bf16 v226, v19, v19, v226
    v_dot2_f32_bf16 v225, v19, v83, v225
    v_dot2_f32_bf16 v227, v19, v91, v227
    s_nop 0
    v_permlane32_swap_b32 v224, v226
    s_nop 0
    v_permlane32_swap_b32 v225, v227
    v_pk_add_f32 v[224:225], v[224:225], v[226:227]
    ds_write_b64 v6, v[224:225]
    ds_write_b32 v7, v20
    ds_write_b32 v7, v21 offset:128
    ds_write_b32 v7, v22 offset:256
    ds_write_b32 v7, v23 offset:384
    v_add_u32 v4, 131072, v2
    v_and_b32 v5, 7, v1
    v_lshlrev_b32 v5, 15, v5
    v_bfe_u32 v9, v1, 3, 1
    v_lshl_add_u32 v5, v9, 12, v5
    s_lshl4_add_u32 s96, s21, s12
    s_lshl_b32 s97, s96, 11
    s_add_u32 s13, s97, 12582912
    s_and_b32 s96, s12, 1
    s_lshr_b32 s97, s21, 2
    s_and_b32 s98, s21, 3
    s_lshl_b32 s99, s98, 6
    s_lshl1_add_u32 s98, s97, s99
    s_lshl_b32 s97, s98, 12
    s_lshr_b32 s99, s12, 1
    s_lshl_b32 s98, s99, 6
    s_add_u32 s99, s97, s98
    s_lshl2_add_u32 s97, s96, s99
    s_add_u32 s98, s97, 1048576
    s_add_u32 s16, s98, 1536
    s_waitcnt lgkmcnt(0)
    s_barrier
    s_cmp_lg_u32 s3, 0
    s_cbranch_scc1 L_PE
    ds_read_b128 v[128:131], v4 offset:0
    ds_read_b128 v[132:135], v4 offset:2048
    ds_read_b128 v[136:139], v4 offset:1024
    ds_read_b128 v[140:143], v4 offset:3072
    s_waitcnt lgkmcnt(2)
    v_pk_add_f32 v[128:129], v[128:129], v[132:133]
    v_pk_add_f32 v[130:131], v[130:131], v[134:135]
    v_add_f32 v129, v129, v131
    v_mov_b32 v131, s4
    s_waitcnt lgkmcnt(0)
    v_pk_add_f32 v[136:137], v[136:137], v[140:141]
    v_pk_add_f32 v[138:139], v[138:139], v[142:143]
    v_add_f32 v137, v137, v139
    v_mov_b32 v139, s4
    buffer_store_dwordx4 v[128:131], v2, s[32:35], s13 offen sc1
    buffer_store_dwordx4 v[136:139], v2, s[32:35], s13 offen offset:1024 sc1
    s_mov_b64 exec, 0xffff
    buffer_store_dword v131, v5, s[32:35], s16 offen sc1
    s_mov_b64 exec, -1
L_PE:
    s_load_dwordx2 s[24:25], s[32:33], s92 offset:1536 glc
    s_and_b32 s96, s3, 3
    s_mul_i32 s97, s96, 4608
    s_lshl_b32 s98, s76, 6
    s_add_u32 s16, s97, s98
    v_and_b32 v66, 31, v1
    v_mul_u32_u24 v66, 144, v66
    v_lshrrev_b32 v9, 5, v1
    v_lshl_add_u32 v66, v9, 5, v66
    v_add_u32 v66, s16, v66
    ds_write_b128 v66, v[12:15]
    ds_write_b128 v66, v[16:19] offset:16
    v_add_u32 v66, 139776, v66
    s_lshl3_add_u32 s96, s21, s3
    s_lshl_b32 s97, s96, 5
    s_sub_u32 s15, 4094, s97
    v_and_b32 v65, 15, v1
    v_lshlrev_b32 v65, 1, v65
    v_sub_u32 v65, s15, v65
    s_lshl_b32 s96, s3, 7
    s_add_u32 s15, s96, 135168
    v_and_b32 v8, 15, v1
    v_lshl_add_u32 v8, v8, 3, s15
    s_and_b32 s96, s3, 3
    s_lshl_b32 s97, s96, 8
    s_add_u32 s15, s97, 135168
    v_and_b32 v10, 31, v1
    v_lshl_add_u32 v10, v10, 3, s15
    v_and_b32 v11, 7, v1
    v_lshlrev_b32 v11, 3, v11
    v_add_u32 v11, 136192, v11
    s_waitcnt vmcnt(3)
    v_cmp_ne_u32 vcc, s4, v61
    s_cbranch_vccz TOK_31
POLL_32:
    buffer_load_dwordx2 v[60:61], v62, s[32:35], s18 offen sc1
    s_waitcnt vmcnt(0)
    v_cmp_ne_u32 vcc, s4, v61
    s_cbranch_vccz PDONE_33
    s_add_u32 s5, s5, 1
    s_cmp_lt_u32 s5, 300000
    s_cbranch_scc1 POLL_32
PDONE_33:
TOK_31:
    v_add_f32_dpp v60, v60, v60 quad_perm:[1,0,3,2] row_mask:0xf bank_mask:0xf
    s_nop 1
    v_add_f32_dpp v60, v60, v60 quad_perm:[2,3,0,1] row_mask:0xf bank_mask:0xf
    s_nop 1
    v_add_f32_dpp v60, v60, v60 row_half_mirror row_mask:0xf bank_mask:0xf
    s_nop 1
    v_add_f32_dpp v60, v60, v60 row_ror:8 row_mask:0xf bank_mask:0xf
    s_cmp_lg_u32 s3, 1
    s_cbranch_scc1 L_NOCT
    v_and_b32 v5, 15, v1
    v_lshlrev_b32 v5, 3, v5
    v_add_u32 v5, 139008, v5
    ds_read_b64 v[134:135], v5
    ds_read_b64 v[138:139], v5 offset:128
    ds_read_b64 v[140:141], v5 offset:384
    s_waitcnt lgkmcnt(0)
    v_lshlrev_b32 v132, 16, v134
    v_and_b32 v133, s6, v134
    v_lshlrev_b32 v134, 16, v135
    v_and_b32 v135, s6, v135
    v_lshlrev_b32 v136, 16, v138
    v_and_b32 v137, s6, v138
    v_lshlrev_b32 v138, 16, v139
    v_and_b32 v139, s6, v139
L_NOCT:
    s_cmp_lt_u32 s3, 4
    s_cbranch_scc1 L_NOST
    s_sub_u32 s96, s3, 4
    s_lshl_b32 s97, s96, 12
    s_add_u32 s13, s97, 32768
    v_add_u32 v4, s13, v2
    v_add_u32 v7, 65536, v4
    ds_write_b128 v4, v[176:179] offset:16384
    ds_write_b128 v4, v[180:183]
    ds_write_b128 v4, v[184:187] offset:17408
    ds_write_b128 v4, v[188:191] offset:1024
    ds_write_b128 v4, v[192:195] offset:18432
    ds_write_b128 v4, v[196:199] offset:2048
    ds_write_b128 v4, v[200:203] offset:19456
    ds_write_b128 v4, v[204:207] offset:3072
    ds_write_b128 v4, v[208:211] offset:49152
    ds_write_b128 v4, v[212:215] offset:32768
    ds_write_b128 v4, v[216:219] offset:50176
    ds_write_b128 v4, v[220:223] offset:33792
L_NOST:
    s_branch SCHK_29
SPOLL_28:
    s_load_dwordx2 s[24:25], s[32:33], s92 offset:1536 glc
SCHK_29:
    s_add_u32 s5, s5, 1
    s_cmp_ge_u32 s5, 300000
    s_waitcnt lgkmcnt(0)
    s_cbranch_scc1 SDONE_30
    s_cmp_lg_u32 s24, s4
    s_cbranch_scc1 SPOLL_28
    s_cmp_lg_u32 s25, s4
    s_cbranch_scc1 SPOLL_28
SDONE_30:
    s_barrier
    s_mov_b32 s13, s19
    buffer_load_dwordx4 v[108:111], v64, s[32:35], s13 offen sc1
    s_add_u32 s13, s19, 8192
    buffer_load_dwordx4 v[112:115], v64, s[32:35], s13 offen sc1
    s_add_u32 s13, s19, 16384
    buffer_load_dwordx4 v[116:119], v64, s[32:35], s13 offen sc1
    s_add_u32 s13, s19, 24576
    buffer_load_dwordx4 v[120:123], v64, s[32:35], s13 offen sc1
    v_mov_b32 v58, 0x10000
    v_mov_b32 v59, s6
    v_lshlrev_b32 v24, 16, v12
    v_and_b32 v25, s6, v12
    v_lshlrev_b32 v26, 16, v13
    v_and_b32 v27, s6, v13
    v_lshlrev_b32 v28, 16, v14
    v_and_b32 v29, s6, v14
    v_lshlrev_b32 v30, 16, v15
    v_and_b32 v31, s6, v15
    v_lshlrev_b32 v32, 16, v16
    v_and_b32 v33, s6, v16
    v_lshlrev_b32 v34, 16, v17
    v_and_b32 v35, s6, v17
    v_lshlrev_b32 v36, 16, v18
    v_and_b32 v37, s6, v18
    v_lshlrev_b32 v38, 16, v19
    v_and_b32 v39, s6, v19
    v_mul_u32_u24_dpp v76, v20, v58 row_newbcast:0 row_mask:0xf bank_mask:0xf
    v_and_b32_dpp v77, v20, v59 row_newbcast:0 row_mask:0xf bank_mask:0xf
    v_mul_u32_u24_dpp v78, v20, v58 row_newbcast:1 row_mask:0xf bank_mask:0xf
    v_and_b32_dpp v79, v20, v59 row_newbcast:1 row_mask:0xf bank_mask:0xf
    v_mul_u32_u24_dpp v80, v20, v58 row_newbcast:2 row_mask:0xf bank_mask:0xf
    v_and_b32_dpp v81, v20, v59 row_newbcast:2 row_mask:0xf bank_mask:0xf
    v_mul_u32_u24_dpp v82, v20, v58 row_newbcast:3 row_mask:0xf bank_mask:0xf
    v_and_b32_dpp v83, v20, v59 row_newbcast:3 row_mask:0xf bank_mask:0xf
    v_mul_u32_u24_dpp v84, v20, v58 row_newbcast:4 row_mask:0xf bank_mask:0xf
    v_and_b32_dpp v85, v20, v59 row_newbcast:4 row_mask:0xf bank_mask:0xf
    v_mul_u32_u24_dpp v86, v20, v58 row_newbcast:5 row_mask:0xf bank_mask:0xf
    v_and_b32_dpp v87, v20, v59 row_newbcast:5 row_mask:0xf bank_mask:0xf
    v_mul_u32_u24_dpp v88, v20, v58 row_newbcast:6 row_mask:0xf bank_mask:0xf
    v_and_b32_dpp v89, v20, v59 row_newbcast:6 row_mask:0xf bank_mask:0xf
    v_mul_u32_u24_dpp v90, v20, v58 row_newbcast:7 row_mask:0xf bank_mask:0xf
    v_and_b32_dpp v91, v20, v59 row_newbcast:7 row_mask:0xf bank_mask:0xf
    v_mul_u32_u24_dpp v92, v21, v58 row_newbcast:0 row_mask:0xf bank_mask:0xf
    v_and_b32_dpp v93, v21, v59 row_newbcast:0 row_mask:0xf bank_mask:0xf
    v_mul_u32_u24_dpp v94, v21, v58 row_newbcast:1 row_mask:0xf bank_mask:0xf
    v_and_b32_dpp v95, v21, v59 row_newbcast:1 row_mask:0xf bank_mask:0xf
    v_mul_u32_u24_dpp v96, v21, v58 row_newbcast:2 row_mask:0xf bank_mask:0xf
    v_and_b32_dpp v97, v21, v59 row_newbcast:2 row_mask:0xf bank_mask:0xf
    v_mul_u32_u24_dpp v98, v21, v58 row_newbcast:3 row_mask:0xf bank_mask:0xf
    v_and_b32_dpp v99, v21, v59 row_newbcast:3 row_mask:0xf bank_mask:0xf
    v_mul_u32_u24_dpp v100, v21, v58 row_newbcast:4 row_mask:0xf bank_mask:0xf
    v_and_b32_dpp v101, v21, v59 row_newbcast:4 row_mask:0xf bank_mask:0xf
    v_mul_u32_u24_dpp v102, v21, v58 row_newbcast:5 row_mask:0xf bank_mask:0xf
    v_and_b32_dpp v103, v21, v59 row_newbcast:5 row_mask:0xf bank_mask:0xf
    v_mul_u32_u24_dpp v104, v21, v58 row_newbcast:6 row_mask:0xf bank_mask:0xf
    v_and_b32_dpp v105, v21, v59 row_newbcast:6 row_mask:0xf bank_mask:0xf
    v_mul_u32_u24_dpp v106, v21, v58 row_newbcast:7 row_mask:0xf bank_mask:0xf
    v_and_b32_dpp v107, v21, v59 row_newbcast:7 row_mask:0xf bank_mask:0xf
    s_waitcnt vmcnt(0)
    v_bitop3_b32 v4, v111, v115, s4 bitop3:0x7e
    v_bitop3_b32 v4, v4, v119, s4 bitop3:0xf6
    v_bitop3_b32 v4, v4, v123, s4 bitop3:0xf6
    v_cmp_ne_u32 vcc, 0, v4
    s_cbranch_vccz TOK_35
POLL_36:
    s_mov_b32 s13, s19
    buffer_load_dwordx4 v[108:111], v64, s[32:35], s13 offen sc1
    s_add_u32 s13, s19, 8192
    buffer_load_dwordx4 v[112:115], v64, s[32:35], s13 offen sc1
    s_add_u32 s13, s19, 16384
    buffer_load_dwordx4 v[116:119], v64, s[32:35], s13 offen sc1
    s_add_u32 s13, s19, 24576
    buffer_load_dwordx4 v[120:123], v64, s[32:35], s13 offen sc1
    s_waitcnt vmcnt(0)
    v_bitop3_b32 v4, v111, v115, s4 bitop3:0x7e
    v_bitop3_b32 v4, v4, v119, s4 bitop3:0xf6
    v_bitop3_b32 v4, v4, v123, s4 bitop3:0xf6
    v_cmp_ne_u32 vcc, 0, v4
    s_cbranch_vccz PDONE_37
    s_add_u32 s5, s5, 1
    s_cmp_lt_u32 s5, 300000
    s_cbranch_scc1 POLL_36
PDONE_37:
TOK_35:
    s_lshl2_add_u32 s96, s74, s75
    s_lshl_b32 s97, s96, 11
    s_lshl_b32 s98, s3, 8
    s_add_u32 s99, s97, s98
    s_add_u32 s15, s99, 20971520
    v_lshlrev_b32 v64, 7, v1
    s_mov_b64 exec, 3
    buffer_load_dword v64, v64, s[32:35], s15 offen
    s_mov_b64 exec, -1
    s_add_u32 s15, s81, 4096
    s_lshl2_add_u32 m0, s89, 99328
    s_nop 0
    buffer_load_dwordx4 v73, s[60:63], s15 offen nt lds
    v_pk_add_f32 v[108:109], v[108:109], v[112:113]
    v_pk_add_f32 v[116:117], v[116:117], v[120:121]
    v_add_f32 v110, v110, v114
    v_add_f32 v118, v118, v122
    v_pk_add_f32 v[108:109], v[108:109], v[116:117]
    v_add_f32 v110, v110, v118
    v_mov_b32 v111, v109
    s_nop 0
    v_permlane32_swap_b32 v108, v110
    v_permlane32_swap_b32 v109, v111
    v_add_f32 v108, v108, v110
    v_add_f32 v109, v109, v111
    s_nop 1
    v_permlane16_swap_b32 v108, v109
    v_add_f32 v111, v108, v109
    v_add_f32 v108, v108, v109
    s_nop 1
    v_permlane16_swap_b32 v108, v111
    v_mul_f32 v110, 0x3a800000, v108
    v_mul_f32 v108, 0x3a800000, v108
    s_nop 1
    v_permlane32_swap_b32 v108, v110
    v_fma_f32 v57, -v108, v108, v110
    v_cvt_pk_bf16_f32 v56, 0, v108
    v_max_f32 v57, 0, v57
    v_cvt_pk_bf16_f32 v57, 0, v57
    v_add_f32 v57, 0x3727c5ac, v57
    v_cvt_pk_bf16_f32 v57, 0, v57
    v_sqrt_f32 v57, v57
    s_nop 0
    v_cvt_pk_bf16_f32 v57, 0, v57
    s_lshl3_add_u32 s13, s3, 136192
    v_rcp_f32 v57, v57
    v_fma_f32 v111, -v56, v60, v111
    v_mov_b32 v5, s13
    v_mul_f32 v111, v111, v57
    ds_write_b64 v8, v[56:57]
    s_movk_i32 s13, 0xfff
    v_ashrrev_i32 v108, 31, v111
    v_or_b32 v108, 0x80000000, v108
    v_xor_b32 v108, v108, v111
    v_bfi_b32 v68, s13, v65, v108
    s_nop 1
    v_min_u32_dpp v69, v68, v68 row_ror:8 row_mask:0xf bank_mask:0xf
    v_max_u32_dpp v68, v68, v68 row_ror:8 row_mask:0xf bank_mask:0xf
    s_nop 1
    v_min_u32_dpp v70, v68, v68 row_ror:4 row_mask:0xf bank_mask:0xf
    v_max_u32_dpp v69, v69, v69 row_ror:4 row_mask:0xf bank_mask:0xf
    v_max_u32_dpp v68, v68, v68 row_ror:4 row_mask:0xf bank_mask:0xf
    v_max_u32 v69, v69, v70
    s_nop 0
    v_min_u32_dpp v70, v68, v68 row_ror:2 row_mask:0xf bank_mask:0xf
    v_max_u32_dpp v69, v69, v69 row_ror:2 row_mask:0xf bank_mask:0xf
    v_max_u32_dpp v68, v68, v68 row_ror:2 row_mask:0xf bank_mask:0xf
    v_max_u32 v69, v69, v70
    s_nop 0
    v_min_u32_dpp v70, v68, v68 row_ror:1 row_mask:0xf bank_mask:0xf
    v_max_u32_dpp v69, v69, v69 row_ror:1 row_mask:0xf bank_mask:0xf
    v_max_u32_dpp v68, v68, v68 row_ror:1 row_mask:0xf bank_mask:0xf
    v_max_u32 v69, v69, v70
    ds_write_b64 v5, v[68:69]
    v_and_b32 v6, 3, v1
    v_lshlrev_b32 v6, 18, v6
    v_bfe_u32 v9, v1, 2, 2
    v_lshl_add_u32 v6, v9, 13, v6
    s_and_b32 s96, s21, 1
    s_and_b32 s97, s12, 7
    s_lshr_b32 s98, s12, 3
    s_lshl3_add_u32 s99, s97, s98
    s_lshl_b32 s97, s99, 12
    s_lshr_b32 s98, s21, 1
    s_lshl_b32 s99, s98, 6
    s_add_u32 s98, s97, s99
    s_lshl4_add_u32 s97, s96, s98
    s_add_u32 s99, s97, 1048576
    s_add_u32 s14, s99, 2560
    s_waitcnt lgkmcnt(0)
    s_barrier
    ds_read_b64 v[68:69], v11
    ds_read_b64 v[56:57], v10
    s_waitcnt lgkmcnt(1)
    v_min_u32_dpp v70, v68, v68 quad_perm:[1,0,3,2] row_mask:0xf bank_mask:0xf
    v_max_u32_dpp v69, v69, v69 quad_perm:[1,0,3,2] row_mask:0xf bank_mask:0xf
    v_max_u32_dpp v68, v68, v68 quad_perm:[1,0,3,2] row_mask:0xf bank_mask:0xf
    v_max_u32 v69, v69, v70
    s_nop 0
    v_min_u32_dpp v70, v68, v68 quad_perm:[2,3,0,1] row_mask:0xf bank_mask:0xf
    v_max_u32_dpp v69, v69, v69 quad_perm:[2,3,0,1] row_mask:0xf bank_mask:0xf
    v_max_u32_dpp v68, v68, v68 quad_perm:[2,3,0,1] row_mask:0xf bank_mask:0xf
    v_max_u32 v69, v69, v70
    s_nop 0
    v_min_u32_dpp v70, v68, v68 row_half_mirror row_mask:0xf bank_mask:0xf
    v_max_u32_dpp v69, v69, v69 row_half_mirror row_mask:0xf bank_mask:0xf
    v_max_u32_dpp v68, v68, v68 row_half_mirror row_mask:0xf bank_mask:0xf
    v_max_u32 v69, v69, v70
    v_or_b32 v70, 1, v69
    v_mov_b32 v69, s4
    v_mov_b32 v71, s4
    s_cmp_lg_u32 s3, 0
    s_cbranch_scc1 L_NOF
    s_mov_b64 exec, 0xffff
    buffer_store_dwordx4 v[68:71], v6, s[32:35], s14 offen sc1
    s_mov_b64 exec, -1
L_NOF:
    s_cmp_lg_u32 s3, 1
    s_cbranch_scc1 L_NOC
    v_and_b32 v4, 16, v1
    v_cmp_eq_u32 vcc, 0, v4
    s_nop 1
    v_cndmask_b32 v4, v70, v68, vcc
    v_not_b32 v4, v4
    v_bfe_u32 v4, v4, 1, 7
    v_lshlrev_b32 v6, 3, v4
    v_mul_u32_u24 v4, 144, v4
    v_add_u32 v6, 135168, v6
    v_and_b32 v5, 15, v1
    v_lshlrev_b32 v5, 3, v5
    v_add_u32 v4, v4, v5
    ds_read_b64 v[112:113], v6
    ds_read_b64 v[108:109], v4 offset:0
    v_and_b32 v6, 15, v1
    v_lshlrev_b32 v6, 4, v6
    v_bfe_u32 v9, v1, 4, 1
    v_lshl_add_u32 v6, v9, 14, v6
    v_lshrrev_b32 v9, 5, v1
    v_lshl_add_u32 v6, v9, 12, v6
    v_bfe_u32 v7, v1, 4, 1
    v_lshlrev_b32 v7, 14, v7
    s_lshl_b32 s96, s21, 15
    s_lshl_b32 s97, s12, 8
    s_add_u32 s98, s96, s97
    s_add_u32 s13, s98, 33554432
    s_lshl_b32 s96, s21, 15
    s_lshl3_add_u32 s97, s12, s96
    s_add_u32 s98, s97, 8192
    s_add_u32 s16, s98, 33554432
    v_mov_b32 v111, s4
    s_waitcnt lgkmcnt(0)
    v_lshlrev_b32 v116, 16, v108
    v_and_b32 v117, s6, v108
    v_lshlrev_b32 v118, 16, v109
    v_and_b32 v119, s6, v109
    v_pk_add_f32 v[116:117], v[116:117], v[112:113] op_sel_hi:[1,0] neg_lo:[0,1] neg_hi:[0,1]
    v_pk_add_f32 v[118:119], v[118:119], v[112:113] op_sel_hi:[1,0] neg_lo:[0,1] neg_hi:[0,1]
    v_cvt_pk_bf16_f32 v116, 0, v116
    v_cvt_pk_bf16_f32 v117, 0, v117
    v_cvt_pk_bf16_f32 v118, 0, v118
    v_cvt_pk_bf16_f32 v119, 0, v119
    v_pk_mul_f32 v[116:117], v[116:117], v[112:113] op_sel:[0,1]
    v_pk_mul_f32 v[118:119], v[118:119], v[112:113] op_sel:[0,1]
    v_cvt_pk_bf16_f32 v116, 0, v116
    v_cvt_pk_bf16_f32 v117, 0, v117
    v_cvt_pk_bf16_f32 v118, 0, v118
    v_cvt_pk_bf16_f32 v119, 0, v119
    v_pk_mul_f32 v[116:117], v[116:117], v[136:137]
    v_pk_mul_f32 v[118:119], v[118:119], v[138:139]
    v_cvt_pk_bf16_f32 v116, 0, v116
    v_cvt_pk_bf16_f32 v117, 0, v117
    v_cvt_pk_bf16_f32 v118, 0, v118
    v_cvt_pk_bf16_f32 v119, 0, v119
    v_pk_add_f32 v[116:117], v[116:117], v[132:133]
    v_pk_add_f32 v[118:119], v[118:119], v[134:135]
    v_mov_b32 v110, v109
    v_mov_b32 v109, s4
    s_mov_b32 exec_hi, 0
    v_cvt_pk_bf16_f32 v108, v116, v117
    v_cvt_pk_bf16_f32 v110, v118, v119
    s_mov_b32 exec_hi, -1
    v_dot2_f32_bf16 v112, v108, v140, 0
    v_mov_b32 v113, s4
    v_dot2_f32_bf16 v112, v110, v141, v112
    buffer_store_dwordx4 v[108:111], v6, s[32:35], s13 offen sc1
    s_nop 1
    v_add_f32_dpp v112, v112, v112 quad_perm:[1,0,3,2] row_mask:0xf bank_mask:0xf
    s_nop 1
    v_add_f32_dpp v112, v112, v112 quad_perm:[2,3,0,1] row_mask:0xf bank_mask:0xf
    s_nop 1
    v_add_f32_dpp v112, v112, v112 row_half_mirror row_mask:0xf bank_mask:0xf
    s_nop 1
    v_add_f32_dpp v112, v112, v112 row_ror:8 row_mask:0xf bank_mask:0xf
    s_mov_b64 exec, 0x10001
    buffer_store_dwordx2 v[112:113], v7, s[32:35], s16 offen sc1
    s_mov_b64 exec, -1
L_NOC:
    s_waitcnt lgkmcnt(0)
    s_add_u32 s13, s81, 8192
    s_lshl2_add_u32 m0, s89, 100352
    s_nop 0
    buffer_load_dwordx4 v73, s[60:63], s13 offen nt lds
    s_load_dwordx8 s[24:31], s[32:33], s92 offset:2560 glc
    v_pk_add_f32 v[40:41], v[24:25], v[56:57] op_sel_hi:[1,0] neg_lo:[0,1] neg_hi:[0,1]
    v_pk_add_f32 v[42:43], v[26:27], v[56:57] op_sel_hi:[1,0] neg_lo:[0,1] neg_hi:[0,1]
    v_pk_add_f32 v[44:45], v[28:29], v[56:57] op_sel_hi:[1,0] neg_lo:[0,1] neg_hi:[0,1]
    v_pk_add_f32 v[46:47], v[30:31], v[56:57] op_sel_hi:[1,0] neg_lo:[0,1] neg_hi:[0,1]
    v_pk_add_f32 v[48:49], v[32:33], v[56:57] op_sel_hi:[1,0] neg_lo:[0,1] neg_hi:[0,1]
    v_pk_add_f32 v[50:51], v[34:35], v[56:57] op_sel_hi:[1,0] neg_lo:[0,1] neg_hi:[0,1]
    v_pk_add_f32 v[52:53], v[36:37], v[56:57] op_sel_hi:[1,0] neg_lo:[0,1] neg_hi:[0,1]
    v_pk_add_f32 v[54:55], v[38:39], v[56:57] op_sel_hi:[1,0] neg_lo:[0,1] neg_hi:[0,1]
    v_cvt_pk_bf16_f32 v40, 0, v40
    v_cvt_pk_bf16_f32 v41, 0, v41
    v_cvt_pk_bf16_f32 v42, 0, v42
    v_cvt_pk_bf16_f32 v43, 0, v43
    v_cvt_pk_bf16_f32 v44, 0, v44
    v_cvt_pk_bf16_f32 v45, 0, v45
    v_cvt_pk_bf16_f32 v46, 0, v46
    v_cvt_pk_bf16_f32 v47, 0, v47
    v_cvt_pk_bf16_f32 v48, 0, v48
    v_cvt_pk_bf16_f32 v49, 0, v49
    v_cvt_pk_bf16_f32 v50, 0, v50
    v_cvt_pk_bf16_f32 v51, 0, v51
    v_cvt_pk_bf16_f32 v52, 0, v52
    v_cvt_pk_bf16_f32 v53, 0, v53
    v_cvt_pk_bf16_f32 v54, 0, v54
    v_cvt_pk_bf16_f32 v55, 0, v55
    v_pk_mul_f32 v[40:41], v[40:41], v[56:57] op_sel:[0,1]
    v_pk_mul_f32 v[42:43], v[42:43], v[56:57] op_sel:[0,1]
    v_pk_mul_f32 v[44:45], v[44:45], v[56:57] op_sel:[0,1]
    v_pk_mul_f32 v[46:47], v[46:47], v[56:57] op_sel:[0,1]
    v_pk_mul_f32 v[48:49], v[48:49], v[56:57] op_sel:[0,1]
    v_pk_mul_f32 v[50:51], v[50:51], v[56:57] op_sel:[0,1]
    v_pk_mul_f32 v[52:53], v[52:53], v[56:57] op_sel:[0,1]
    v_pk_mul_f32 v[54:55], v[54:55], v[56:57] op_sel:[0,1]
    v_cvt_pk_bf16_f32 v40, 0, v40
    v_cvt_pk_bf16_f32 v41, 0, v41
    v_cvt_pk_bf16_f32 v42, 0, v42
    v_cvt_pk_bf16_f32 v43, 0, v43
    v_cvt_pk_bf16_f32 v44, 0, v44
    v_cvt_pk_bf16_f32 v45, 0, v45
    v_cvt_pk_bf16_f32 v46, 0, v46
    v_cvt_pk_bf16_f32 v47, 0, v47
    v_cvt_pk_bf16_f32 v48, 0, v48
    v_cvt_pk_bf16_f32 v49, 0, v49
    v_cvt_pk_bf16_f32 v50, 0, v50
    v_cvt_pk_bf16_f32 v51, 0, v51
    v_cvt_pk_bf16_f32 v52, 0, v52
    v_cvt_pk_bf16_f32 v53, 0, v53
    v_cvt_pk_bf16_f32 v54, 0, v54
    v_cvt_pk_bf16_f32 v55, 0, v55
    v_pk_mul_f32 v[40:41], v[40:41], v[92:93]
    v_pk_mul_f32 v[42:43], v[42:43], v[94:95]
    v_pk_mul_f32 v[44:45], v[44:45], v[96:97]
    v_pk_mul_f32 v[46:47], v[46:47], v[98:99]
    v_pk_mul_f32 v[48:49], v[48:49], v[100:101]
    v_pk_mul_f32 v[50:51], v[50:51], v[102:103]
    v_pk_mul_f32 v[52:53], v[52:53], v[104:105]
    v_pk_mul_f32 v[54:55], v[54:55], v[106:107]
    v_cvt_pk_bf16_f32 v40, 0, v40
    v_cvt_pk_bf16_f32 v41, 0, v41
    v_cvt_pk_bf16_f32 v42, 0, v42
    v_cvt_pk_bf16_f32 v43, 0, v43
    v_cvt_pk_bf16_f32 v44, 0, v44
    v_cvt_pk_bf16_f32 v45, 0, v45
    v_cvt_pk_bf16_f32 v46, 0, v46
    v_cvt_pk_bf16_f32 v47, 0, v47
    v_cvt_pk_bf16_f32 v48, 0, v48
    v_cvt_pk_bf16_f32 v49, 0, v49
    v_cvt_pk_bf16_f32 v50, 0, v50
    v_cvt_pk_bf16_f32 v51, 0, v51
    v_cvt_pk_bf16_f32 v52, 0, v52
    v_cvt_pk_bf16_f32 v53, 0, v53
    v_cvt_pk_bf16_f32 v54, 0, v54
    v_cvt_pk_bf16_f32 v55, 0, v55
    v_pk_add_f32 v[40:41], v[40:41], v[76:77]
    v_pk_add_f32 v[42:43], v[42:43], v[78:79]
    v_pk_add_f32 v[44:45], v[44:45], v[80:81]
    v_pk_add_f32 v[46:47], v[46:47], v[82:83]
    v_pk_add_f32 v[48:49], v[48:49], v[84:85]
    v_pk_add_f32 v[50:51], v[50:51], v[86:87]
    v_pk_add_f32 v[52:53], v[52:53], v[88:89]
    v_pk_add_f32 v[54:55], v[54:55], v[90:91]
    v_cvt_pk_bf16_f32 v40, 0, v40
    v_cvt_pk_bf16_f32 v41, 0, v41
    v_cvt_pk_bf16_f32 v42, 0, v42
    v_cvt_pk_bf16_f32 v43, 0, v43
    v_cvt_pk_bf16_f32 v44, 0, v44
    v_cvt_pk_bf16_f32 v45, 0, v45
    v_cvt_pk_bf16_f32 v46, 0, v46
    v_cvt_pk_bf16_f32 v47, 0, v47
    v_cvt_pk_bf16_f32 v48, 0, v48
    v_cvt_pk_bf16_f32 v49, 0, v49
    v_cvt_pk_bf16_f32 v50, 0, v50
    v_cvt_pk_bf16_f32 v51, 0, v51
    v_cvt_pk_bf16_f32 v52, 0, v52
    v_cvt_pk_bf16_f32 v53, 0, v53
    v_cvt_pk_bf16_f32 v54, 0, v54
    v_cvt_pk_bf16_f32 v55, 0, v55
    s_lshr_b32 s96, s3, 2
    s_lshl_b32 s97, s96, 15
    s_and_b32 s98, s3, 3
    s_lshl_b32 s99, s98, 5
    s_add_u32 s96, s97, s99
    s_add_u32 s13, s96, 32768
    v_lshrrev_b32 v67, 4, v1
    v_lshlrev_b32 v67, 13, v67
    v_bfe_u32 v9, v1, 2, 2
    v_lshl_add_u32 v67, v9, 7, v67
    v_bfe_u32 v9, v1, 3, 2
    v_lshl_add_u32 v67, v9, 5, v67
    v_and_b32 v9, 3, v1
    v_lshl_add_u32 v67, v9, 3, v67
    v_xor_b32 v67, s13, v67
    s_lshl_b32 s13, s3, 6
    v_bfe_u32 v74, v1, 2, 1
    v_lshlrev_b32 v74, 9, v74
    v_bfe_u32 v9, v1, 3, 1
    v_lshl_add_u32 v74, v9, 12, v74
    v_lshrrev_b32 v9, 5, v1
    v_lshl_add_u32 v74, v9, 11, v74
    v_bfe_u32 v9, v1, 2, 2
    v_lshl_add_u32 v74, v9, 6, v74
    v_bfe_u32 v9, v1, 4, 1
    v_lshl_add_u32 v74, v9, 5, v74
    v_and_b32 v9, 3, v1
    v_lshl_add_u32 v74, v9, 3, v74
    v_xor_b32 v74, s13, v74
    v_add_u32 v74, 98304, v74
    v_and_b32 v75, 7, v1
    v_lshlrev_b32 v75, 4, v75
    v_lshrrev_b32 v9, 4, v1
    v_lshl_add_u32 v75, v9, 7, v75
    v_add_u32 v75, 136704, v75
    s_lshl4_add_u32 s13, s3, 136256
    v_mov_b32 v4, s13
    v_and_b32 v5, 7, v1
    v_lshlrev_b32 v5, 4, v5
    v_add_u32 v5, 136256, v5
    v_and_b32 v8, 8, v1
    v_cmp_eq_u32 s[22:23], 0, v8
    s_branch SCHK_39
SPOLL_38:
    s_load_dwordx8 s[24:31], s[32:33], s92 offset:2560 glc
SCHK_39:
    s_add_u32 s5, s5, 1
    s_cmp_ge_u32 s5, 300000
    s_waitcnt lgkmcnt(0)
    s_cbranch_scc1 SDONE_40
    s_cmp_lg_u32 s25, s4
    s_cbranch_scc1 SPOLL_38
    s_cmp_lg_u32 s27, s4
    s_cbranch_scc1 SPOLL_38
    s_cmp_lg_u32 s29, s4
    s_cbranch_scc1 SPOLL_38
    s_cmp_lg_u32 s31, s4
    s_cbranch_scc1 SPOLL_38
SDONE_40:
    s_min_u32 s25, s24, s28
    s_max_u32 s24, s24, s28
    s_max_u32 s27, s26, s30
    s_min_u32 s26, s26, s30
    s_max_u32 s28, s25, s27
    s_min_u32 s25, s25, s27
    v_mov_b32 v132, s24
    v_mov_b32 v135, s26
    v_mov_b32 v133, s28
    v_mov_b32 v134, s25
    ds_write_b128 v4, v[132:135]
    s_waitcnt lgkmcnt(0)
    s_barrier
    s_cmp_lt_u32 s3, 4
    s_cbranch_scc1 L_CSEL
    s_add_u32 s13, s81, 12288
    s_lshl2_add_u32 m0, s89, 101376
    s_nop 0
    buffer_load_dwordx4 v73, s[60:63], s13 offen nt lds
    ds_read_b64_tr_b16 v[148:149], v67
    ds_read_b64_tr_b16 v[150:151], v67 offset:512
    ds_read_b64_tr_b16 v[152:153], v67 offset:1024
    ds_read_b64_tr_b16 v[154:155], v67 offset:1536
    ds_read_b64_tr_b16 v[156:157], v67 offset:2048
    ds_read_b64_tr_b16 v[158:159], v67 offset:2560
    ds_read_b64_tr_b16 v[160:161], v67 offset:3072
    ds_read_b64_tr_b16 v[162:163], v67 offset:3584
    ds_read_b64_tr_b16 v[164:165], v67 offset:4096
    ds_read_b64_tr_b16 v[166:167], v67 offset:4608
    ds_read_b64_tr_b16 v[168:169], v67 offset:5120
    ds_read_b64_tr_b16 v[170:171], v67 offset:5632
    ds_read_b64_tr_b16 v[172:173], v67 offset:6144
    ds_read_b64_tr_b16 v[174:175], v67 offset:6656
    ds_read_b64_tr_b16 v[176:177], v67 offset:7168
    ds_read_b64_tr_b16 v[178:179], v67 offset:7680
    v_mul_u32_u24_dpp v76, v22, v58 row_newbcast:0 row_mask:0xf bank_mask:0xf
    v_and_b32_dpp v77, v22, v59 row_newbcast:0 row_mask:0xf bank_mask:0xf
    v_mul_u32_u24_dpp v78, v22, v58 row_newbcast:1 row_mask:0xf bank_mask:0xf
    v_and_b32_dpp v79, v22, v59 row_newbcast:1 row_mask:0xf bank_mask:0xf
    v_mul_u32_u24_dpp v80, v22, v58 row_newbcast:2 row_mask:0xf bank_mask:0xf
    v_and_b32_dpp v81, v22, v59 row_newbcast:2 row_mask:0xf bank_mask:0xf
    v_mul_u32_u24_dpp v82, v22, v58 row_newbcast:3 row_mask:0xf bank_mask:0xf
    v_and_b32_dpp v83, v22, v59 row_newbcast:3 row_mask:0xf bank_mask:0xf
    v_mul_u32_u24_dpp v84, v22, v58 row_newbcast:4 row_mask:0xf bank_mask:0xf
    v_and_b32_dpp v85, v22, v59 row_newbcast:4 row_mask:0xf bank_mask:0xf
    v_mul_u32_u24_dpp v86, v22, v58 row_newbcast:5 row_mask:0xf bank_mask:0xf
    v_and_b32_dpp v87, v22, v59 row_newbcast:5 row_mask:0xf bank_mask:0xf
    v_mul_u32_u24_dpp v88, v22, v58 row_newbcast:6 row_mask:0xf bank_mask:0xf
    v_and_b32_dpp v89, v22, v59 row_newbcast:6 row_mask:0xf bank_mask:0xf
    v_mul_u32_u24_dpp v90, v22, v58 row_newbcast:7 row_mask:0xf bank_mask:0xf
    v_and_b32_dpp v91, v22, v59 row_newbcast:7 row_mask:0xf bank_mask:0xf
    v_pk_mul_f32 v[40:41], v[40:41], v[76:77]
    v_pk_mul_f32 v[42:43], v[42:43], v[78:79]
    v_pk_mul_f32 v[44:45], v[44:45], v[80:81]
    v_pk_mul_f32 v[46:47], v[46:47], v[82:83]
    v_pk_mul_f32 v[48:49], v[48:49], v[84:85]
    v_pk_mul_f32 v[50:51], v[50:51], v[86:87]
    v_pk_mul_f32 v[52:53], v[52:53], v[88:89]
    v_pk_mul_f32 v[54:55], v[54:55], v[90:91]
    v_cvt_pk_bf16_f32 v40, 0, v40
    v_cvt_pk_bf16_f32 v41, 0, v41
    v_cvt_pk_bf16_f32 v42, 0, v42
    v_cvt_pk_bf16_f32 v43, 0, v43
    v_cvt_pk_bf16_f32 v44, 0, v44
    v_cvt_pk_bf16_f32 v45, 0, v45
    v_cvt_pk_bf16_f32 v46, 0, v46
    v_cvt_pk_bf16_f32 v47, 0, v47
    v_cvt_pk_bf16_f32 v48, 0, v48
    v_cvt_pk_bf16_f32 v49, 0, v49
    v_cvt_pk_bf16_f32 v50, 0, v50
    v_cvt_pk_bf16_f32 v51, 0, v51
    v_cvt_pk_bf16_f32 v52, 0, v52
    v_cvt_pk_bf16_f32 v53, 0, v53
    v_cvt_pk_bf16_f32 v54, 0, v54
    v_cvt_pk_bf16_f32 v55, 0, v55
    v_pk_add_f32 v[40:41], v[40:41], v[24:25]
    v_pk_add_f32 v[42:43], v[42:43], v[26:27]
    v_pk_add_f32 v[44:45], v[44:45], v[28:29]
    v_pk_add_f32 v[46:47], v[46:47], v[30:31]
    v_pk_add_f32 v[48:49], v[48:49], v[32:33]
    v_pk_add_f32 v[50:51], v[50:51], v[34:35]
    v_pk_add_f32 v[52:53], v[52:53], v[36:37]
    v_pk_add_f32 v[54:55], v[54:55], v[38:39]
    v_cvt_pk_bf16_f32 v124, v40, v41
    v_cvt_pk_bf16_f32 v125, v42, v43
    v_cvt_pk_bf16_f32 v126, v44, v45
    v_cvt_pk_bf16_f32 v127, v46, v47
    v_cvt_pk_bf16_f32 v128, v48, v49
    v_cvt_pk_bf16_f32 v129, v50, v51
    v_cvt_pk_bf16_f32 v130, v52, v53
    v_cvt_pk_bf16_f32 v131, v54, v55
    ds_write_b128 v66, v[124:127]
    ds_write_b128 v66, v[128:131] offset:16
    s_mul_i32 s96, s3, 2304
    s_add_u32 s16, s96, 139776
    v_lshrrev_b32 v66, 3, v1
    v_mul_u32_u24 v66, 144, v66
    v_and_b32 v9, 7, v1
    v_lshl_add_u32 v66, v9, 4, v66
    v_add_u32 v66, s16, v66
    s_branch L_CSELD
L_CSEL:
    ds_read_b128 v[132:135], v5
    s_lshl_b32 s96, s3, 9
    s_add_u32 s13, s96, 136704
    v_add_u32 v6, s13, v63
    s_lshl2_add_u32 s13, s3, 136384
    v_mov_b32 v7, s13
    s_waitcnt lgkmcnt(0)
    v_max_u32_dpp v136, v135, v132 quad_perm:[1,0,3,2] row_mask:0xf bank_mask:0xf
    v_max_u32_dpp v137, v134, v133 quad_perm:[1,0,3,2] row_mask:0xf bank_mask:0xf
    v_max_u32_dpp v138, v133, v134 quad_perm:[1,0,3,2] row_mask:0xf bank_mask:0xf
    v_max_u32_dpp v139, v132, v135 quad_perm:[1,0,3,2] row_mask:0xf bank_mask:0xf
    v_max_u32 v140, v136, v138
    v_max_u32 v141, v137, v139
    v_min_u32 v142, v136, v138
    v_min_u32 v143, v137, v139
    v_max_u32 v132, v140, v141
    v_min_u32 v133, v140, v141
    v_max_u32 v134, v142, v143
    v_min_u32 v135, v142, v143
    s_nop 1
    v_max_u32_dpp v136, v135, v132 quad_perm:[2,3,0,1] row_mask:0xf bank_mask:0xf
    v_max_u32_dpp v137, v134, v133 quad_perm:[2,3,0,1] row_mask:0xf bank_mask:0xf
    v_max_u32_dpp v138, v133, v134 quad_perm:[2,3,0,1] row_mask:0xf bank_mask:0xf
    v_max_u32_dpp v139, v132, v135 quad_perm:[2,3,0,1] row_mask:0xf bank_mask:0xf
    v_max_u32 v140, v136, v138
    v_max_u32 v141, v137, v139
    v_min_u32 v142, v136, v138
    v_min_u32 v143, v137, v139
    v_max_u32 v132, v140, v141
    v_min_u32 v133, v140, v141
    v_max_u32 v134, v142, v143
    v_min_u32 v135, v142, v143
    s_nop 1
    v_max_u32_dpp v136, v135, v132 row_half_mirror row_mask:0xf bank_mask:0xf
    v_max_u32_dpp v137, v134, v133 row_half_mirror row_mask:0xf bank_mask:0xf
    v_max_u32_dpp v138, v133, v134 row_half_mirror row_mask:0xf bank_mask:0xf
    v_max_u32_dpp v139, v132, v135 row_half_mirror row_mask:0xf bank_mask:0xf
    v_readfirstlane_b32 s24, v136
    v_readfirstlane_b32 s25, v137
    v_readfirstlane_b32 s26, v138
    v_readfirstlane_b32 s27, v139
    s_bitcmp1_b32 s3, 0
    s_cselect_b32 s24, s25, s24
    s_cselect_b32 s26, s27, s26
    s_bitcmp1_b32 s3, 1
    s_cselect_b32 s24, s26, s24
    s_and_b32 s15, s24, 4095
    s_lshr_b32 s96, s15, 8
    s_sub_u32 s97, 15, s96
    s_and_b32 s98, s15, 1
    s_lshl1_add_u32 s99, s97, s98
    s_lshl_b32 s96, s99, 14
    s_add_u32 s13, s96, 33554432
    s_lshl_b32 s96, s75, 10
    s_add_u32 s14, s96, s13
    s_add_u32 s13, s13, 8192
    v_and_b32 v10, 15, v1
    v_lshlrev_b32 v10, 3, v10
    buffer_load_dwordx2 v[136:137], v10, s[32:35], s13 offen sc1
    buffer_load_dwordx4 v[132:135], v2, s[32:35], s14 offen sc1
    s_add_u32 s16, s81, 12288
    s_lshl2_add_u32 m0, s89, 101376
    s_nop 0
    buffer_load_dwordx4 v73, s[60:63], s16 offen nt lds
    ds_read_b64_tr_b16 v[148:149], v67
    ds_read_b64_tr_b16 v[150:151], v67 offset:512
    ds_read_b64_tr_b16 v[152:153], v67 offset:1024
    ds_read_b64_tr_b16 v[154:155], v67 offset:1536
    ds_read_b64_tr_b16 v[156:157], v67 offset:2048
    ds_read_b64_tr_b16 v[158:159], v67 offset:2560
    ds_read_b64_tr_b16 v[160:161], v67 offset:3072
    ds_read_b64_tr_b16 v[162:163], v67 offset:3584
    ds_read_b64_tr_b16 v[164:165], v67 offset:4096
    ds_read_b64_tr_b16 v[166:167], v67 offset:4608
    ds_read_b64_tr_b16 v[168:169], v67 offset:5120
    ds_read_b64_tr_b16 v[170:171], v67 offset:5632
    ds_read_b64_tr_b16 v[172:173], v67 offset:6144
    ds_read_b64_tr_b16 v[174:175], v67 offset:6656
    ds_read_b64_tr_b16 v[176:177], v67 offset:7168
    ds_read_b64_tr_b16 v[178:179], v67 offset:7680
    v_mul_u32_u24_dpp v76, v22, v58 row_newbcast:0 row_mask:0xf bank_mask:0xf
    v_and_b32_dpp v77, v22, v59 row_newbcast:0 row_mask:0xf bank_mask:0xf
    v_mul_u32_u24_dpp v78, v22, v58 row_newbcast:1 row_mask:0xf bank_mask:0xf
    v_and_b32_dpp v79, v22, v59 row_newbcast:1 row_mask:0xf bank_mask:0xf
    v_mul_u32_u24_dpp v80, v22, v58 row_newbcast:2 row_mask:0xf bank_mask:0xf
    v_and_b32_dpp v81, v22, v59 row_newbcast:2 row_mask:0xf bank_mask:0xf
    v_mul_u32_u24_dpp v82, v22, v58 row_newbcast:3 row_mask:0xf bank_mask:0xf
    v_and_b32_dpp v83, v22, v59 row_newbcast:3 row_mask:0xf bank_mask:0xf
    v_mul_u32_u24_dpp v84, v22, v58 row_newbcast:4 row_mask:0xf bank_mask:0xf
    v_and_b32_dpp v85, v22, v59 row_newbcast:4 row_mask:0xf bank_mask:0xf
    v_mul_u32_u24_dpp v86, v22, v58 row_newbcast:5 row_mask:0xf bank_mask:0xf
    v_and_b32_dpp v87, v22, v59 row_newbcast:5 row_mask:0xf bank_mask:0xf
    v_mul_u32_u24_dpp v88, v22, v58 row_newbcast:6 row_mask:0xf bank_mask:0xf
    v_and_b32_dpp v89, v22, v59 row_newbcast:6 row_mask:0xf bank_mask:0xf
    v_mul_u32_u24_dpp v90, v22, v58 row_newbcast:7 row_mask:0xf bank_mask:0xf
    v_and_b32_dpp v91, v22, v59 row_newbcast:7 row_mask:0xf bank_mask:0xf
    v_pk_mul_f32 v[40:41], v[40:41], v[76:77]
    v_pk_mul_f32 v[42:43], v[42:43], v[78:79]
    v_pk_mul_f32 v[44:45], v[44:45], v[80:81]
    v_pk_mul_f32 v[46:47], v[46:47], v[82:83]
    v_pk_mul_f32 v[48:49], v[48:49], v[84:85]
    v_pk_mul_f32 v[50:51], v[50:51], v[86:87]
    v_pk_mul_f32 v[52:53], v[52:53], v[88:89]
    v_pk_mul_f32 v[54:55], v[54:55], v[90:91]
    v_cvt_pk_bf16_f32 v40, 0, v40
    v_cvt_pk_bf16_f32 v41, 0, v41
    v_cvt_pk_bf16_f32 v42, 0, v42
    v_cvt_pk_bf16_f32 v43, 0, v43
    v_cvt_pk_bf16_f32 v44, 0, v44
    v_cvt_pk_bf16_f32 v45, 0, v45
    v_cvt_pk_bf16_f32 v46, 0, v46
    v_cvt_pk_bf16_f32 v47, 0, v47
    v_cvt_pk_bf16_f32 v48, 0, v48
    v_cvt_pk_bf16_f32 v49, 0, v49
    v_cvt_pk_bf16_f32 v50, 0, v50
    v_cvt_pk_bf16_f32 v51, 0, v51
    v_cvt_pk_bf16_f32 v52, 0, v52
    v_cvt_pk_bf16_f32 v53, 0, v53
    v_cvt_pk_bf16_f32 v54, 0, v54
    v_cvt_pk_bf16_f32 v55, 0, v55
    v_pk_add_f32 v[40:41], v[40:41], v[24:25]
    v_pk_add_f32 v[42:43], v[42:43], v[26:27]
    v_pk_add_f32 v[44:45], v[44:45], v[28:29]
    v_pk_add_f32 v[46:47], v[46:47], v[30:31]
    v_pk_add_f32 v[48:49], v[48:49], v[32:33]
    v_pk_add_f32 v[50:51], v[50:51], v[34:35]
    v_pk_add_f32 v[52:53], v[52:53], v[36:37]
    v_pk_add_f32 v[54:55], v[54:55], v[38:39]
    v_cvt_pk_bf16_f32 v124, v40, v41
    v_cvt_pk_bf16_f32 v125, v42, v43
    v_cvt_pk_bf16_f32 v126, v44, v45
    v_cvt_pk_bf16_f32 v127, v46, v47
    v_cvt_pk_bf16_f32 v128, v48, v49
    v_cvt_pk_bf16_f32 v129, v50, v51
    v_cvt_pk_bf16_f32 v130, v52, v53
    v_cvt_pk_bf16_f32 v131, v54, v55
    ds_write_b128 v66, v[124:127]
    ds_write_b128 v66, v[128:131] offset:16
    s_mul_i32 s96, s3, 2304
    s_add_u32 s16, s96, 139776
    v_lshrrev_b32 v66, 3, v1
    v_mul_u32_u24 v66, 144, v66
    v_and_b32 v9, 7, v1
    v_lshl_add_u32 v66, v9, 4, v66
    v_add_u32 v66, s16, v66
    s_lshl2_add_u32 s15, s15, s3
    s_waitcnt vmcnt(1)
    v_bitop3_b32 v8, v133, v135, s4 bitop3:0x7e
    v_bitop3_b32 v8, v8, v137, s4 bitop3:0xf6
    v_cmp_ne_u32 vcc, 0, v8
    s_cbranch_vccz TOK_42
POLL_43:
    buffer_load_dwordx2 v[136:137], v10, s[32:35], s13 offen sc1
    buffer_load_dwordx4 v[132:135], v2, s[32:35], s14 offen sc1
    s_waitcnt vmcnt(0)
    v_bitop3_b32 v8, v133, v135, s4 bitop3:0x7e
    v_bitop3_b32 v8, v8, v137, s4 bitop3:0xf6
    v_cmp_ne_u32 vcc, 0, v8
    s_cbranch_vccz PDONE_44
    s_add_u32 s5, s5, 1
    s_cmp_lt_u32 s5, 300000
    s_cbranch_scc1 POLL_43
PDONE_44:
TOK_42:
    ds_write2_b32 v6, v132, v134 offset0:0 offset1:1
    v_add_f32_dpp v136, v136, v136 quad_perm:[1,0,3,2] row_mask:0xf bank_mask:0xf
    s_nop 1
    v_add_f32_dpp v136, v136, v136 quad_perm:[2,3,0,1] row_mask:0xf bank_mask:0xf
    s_nop 1
    v_add_f32_dpp v136, v136, v136 row_half_mirror row_mask:0xf bank_mask:0xf
    s_nop 1
    v_add_f32_dpp v136, v136, v136 row_ror:8 row_mask:0xf bank_mask:0xf
    v_cvt_pk_bf16_f32 v136, 0, v136
    v_ashrrev_i32 v137, 31, v136
    v_or_b32 v137, 0x80000000, v137
    v_xor_b32 v136, v136, v137
    v_and_b32 v136, s6, v136
    v_or_b32 v136, s15, v136
    ds_write_b32 v7, v136
L_CSELD:
    v_mov_b32 v4, 136384
    v_and_b32 v8, 15, v1
    v_lshlrev_b32 v8, 4, v8
    v_lshrrev_b32 v9, 5, v1
    v_lshl_add_u32 v8, v9, 3, v8
    s_lshl_b32 s96, s74, 13
    s_add_u32 s14, s96, 20971520
    s_lshl3_add_u32 s96, s75, s3
    s_lshl_b32 s97, s96, 8
    s_add_u32 s20, s97, s14
    s_waitcnt lgkmcnt(0)
    s_barrier
    ds_read_b128 v[132:135], v4
    s_waitcnt lgkmcnt(0)
    v_max_u32 v136, v132, v133
    v_max_u32 v137, v134, v135
    v_min_u32 v138, v132, v133
    v_min_u32 v139, v134, v135
    v_min_u32 v133, v136, v137
    v_max_u32 v132, v136, v137
    v_max3_u32 v133, v133, v138, v139
    v_cndmask_b32 v4, v133, v132, s[22:23]
    v_readfirstlane_b32 s68, v132
    v_and_b32 v4, 3, v4
    v_readfirstlane_b32 s69, v133
    v_lshl_add_u32 v4, v4, 9, v75
    ds_read_b128 v[136:139], v4
    ds_read_b128 v[124:127], v66
    ds_read_b128 v[128:131], v66 offset:1152
    s_bfe_u32 s70, s68, 720899
    s_bfe_u32 s71, s69, 720899
    s_sub_u32 s70, 2047, s70
    s_sub_u32 s71, 2047, s71
    s_waitcnt lgkmcnt(2)
    v_mfma_f32_16x16x32_bf16 v[196:199], v[136:139], v[148:151], 0
    v_mfma_f32_16x16x32_bf16 v[200:203], v[136:139], v[152:155], 0
    v_mfma_f32_16x16x32_bf16 v[204:207], v[136:139], v[156:159], 0
    v_mfma_f32_16x16x32_bf16 v[208:211], v[136:139], v[160:163], 0
    v_mfma_f32_16x16x32_bf16 v[212:215], v[136:139], v[164:167], 0
    v_mfma_f32_16x16x32_bf16 v[216:219], v[136:139], v[168:171], 0
    v_mfma_f32_16x16x32_bf16 v[220:223], v[136:139], v[172:175], 0
    v_mfma_f32_16x16x32_bf16 v[224:227], v[136:139], v[176:179], 0
    s_nop 1
    v_add_f32 v132, v196, v201
    s_nop 0
    v_add_f32 v133, v206, v211
    s_nop 0
    v_add_f32 v134, v212, v217
    s_nop 0
    v_add_f32 v135, v222, v227
    v_add_f32 v132, v132, v133
    v_add_f32 v134, v134, v135
    v_mov_b32 v133, s4
    s_nop 0
    v_permlane16_swap_b32 v134, v135
    s_cmp_ge_u32 s9, 28
    s_cbranch_scc1 L_NOHP
    v_add_f32 v132, v132, v135
    s_mov_b32 exec_lo, 0xffff
    s_mov_b32 exec_hi, 0xffff
    s_cmp_lg_u32 s93, 0
    s_cbranch_scc1 LOC_45
    buffer_store_dwordx2 v[132:133], v8, s[32:35], s20 offen sc1
    s_branch LOCD_46
LOC_45:
    buffer_store_dwordx2 v[132:133], v8, s[32:35], s20 offen
LOCD_46:
    s_mov_b64 exec, -1
L_NOHP:
    v_mov_b32 v228, v132
    v_mov_b32 v229, v133
    v_add_u32 v230, s20, v8
    s_waitcnt lgkmcnt(0)
    s_bitcmp1_b32 s21, 2
    s_cselect_b32 s17, s71, s70
    s_cselect_b32 s18, s69, s68
    s_cmp_lg_u32 s3, 7
    s_cbranch_scc1 L_NOFZ
    s_cmp_lg_u32 s2, 0
    s_cbranch_scc1 L_NONON
    v_mov_b32 v6, s4
    s_mov_b64 exec, 1
    buffer_store_dword v6, v3, s[32:35], 0 offen sc1
    s_mov_b64 exec, -1
L_NONON:
    s_lshr_b32 s96, s21, 3
    s_and_b32 s97, s21, 1
    s_lshl1_add_u32 s19, s96, s97
    s_lshr_b32 s96, s21, 2
    s_lshl_b32 s97, s96, 1
    s_lshl3_add_u32 s98, s12, s97
    s_and_b32 s99, s21, 1
    s_add_u32 s96, s98, s99
    s_mul_i32 s97, s96, 7168
    s_add_u32 s20, s97, 22020096
    s_lshl_b32 s96, s17, 11
    s_lshl_b32 s97, s12, 7
    s_add_u32 s98, s96, s97
    s_lshl_b32 s99, s19, 5
    s_add_u32 s82, s98, s99
    v_and_b32 v10, 7, v1
    v_lshlrev_b32 v10, 2, v10
    s_lshl_b32 s96, s19, 5
    s_add_u32 s13, s96, 139264
    v_add_u32 v5, s13, v10
    ds_read_b32 v234, v5
    s_lshr_b32 s96, s17, 7
    s_bfe_u32 s97, s18, 65538
    s_lshl1_add_u32 s98, s96, s97
    s_lshl_b32 s99, s98, 14
    s_lshl_b32 s96, s12, 8
    s_add_u32 s97, s99, s96
    s_lshl_b32 s98, s19, 6
    s_add_u32 s99, s97, s98
    s_add_u32 s68, s99, 33554432
    s_add_u32 s69, s68, 4096
    v_and_b32 v11, 7, v1
    v_lshlrev_b32 v11, 3, v11
    buffer_load_dwordx2 v[56:57], v11, s[32:35], s68 offen sc1
    buffer_load_dwordx2 v[232:233], v11, s[32:35], s69 offen sc1
    s_and_b32 s13, s18, s6
    s_ashr_i32 s15, s13, 31
    s_andn2_b32 s15, 0x7fff0000, s15
    s_or_b32 s15, s15, 0x80000000
    s_xor_b32 s13, s13, s15
    v_mov_b32 v235, s13
    v_mul_f32 v235, s7, v235
    v_exp_f32 v235, -v235
    s_nop 0
    v_add_f32 v235, 1.0, v235
    v_rcp_f32 v235, v235
    s_nop 0
    v_cvt_pk_bf16_f32 v235, 0, v235
L_NOFZ:
    s_cmp_lt_u32 s9, 28
    s_cbranch_scc1 L_HSEC
    s_branch L_GSEC
L_HSEC:
    s_cmp_lt_u32 s3, 4
    s_cbranch_scc1 L_HW
    s_branch L_NOH
L_HW:
    s_lshl_b32 s96, s3, 8
    s_add_u32 s13, s96, s14
    v_lshrrev_b32 v4, 4, v1
    v_lshlrev_b32 v4, 11, v4
    v_and_b32 v9, 15, v1
    v_lshl_add_u32 v4, v9, 4, v4
    s_lshl_b32 s96, s3, 5
    s_add_u32 s15, s96, 138752
    v_lshrrev_b32 v5, 5, v1
    v_lshl_add_u32 v5, v5, 7, s15
    v_bfe_u32 v9, v1, 2, 1
    v_lshl_add_u32 v5, v9, 4, v5
    v_bfe_u32 v9, v1, 1, 1
    v_lshl_add_u32 v5, v9, 3, v5
    v_bfe_u32 v9, v1, 3, 1
    v_lshl_add_u32 v5, v9, 2, v5
    v_and_b32 v9, 1, v1
    v_lshl_add_u32 v5, v9, 1, v5
    s_cmp_lg_u32 s93, 0
    s_cbranch_scc1 L_HLOC
SPOLL_47:
    s_load_dword s24, s[32:33], s13 offset:1276 glc
    s_load_dword s25, s[32:33], s13 offset:3324 glc
    s_load_dword s26, s[32:33], s13 offset:5372 glc
    s_load_dword s27, s[32:33], s13 offset:7420 glc
SCHK_48:
    s_add_u32 s5, s5, 1
    s_cmp_ge_u32 s5, 300000
    s_waitcnt lgkmcnt(0)
    s_cbranch_scc1 SDONE_49
    s_cmp_lg_u32 s24, s4
    s_cbranch_scc1 SPOLL_47
    s_cmp_lg_u32 s25, s4
    s_cbranch_scc1 SPOLL_47
    s_cmp_lg_u32 s26, s4
    s_cbranch_scc1 SPOLL_47
    s_cmp_lg_u32 s27, s4
    s_cbranch_scc1 SPOLL_47
SDONE_49:
L_HLOC:
    buffer_load_dwordx4 v[196:199], v4, s[32:35], s13 offen sc1
    buffer_load_dwordx4 v[200:203], v4, s[32:35], s13 offen offset:1024 sc1
    s_waitcnt vmcnt(0)
    v_bitop3_b32 v6, v197, v199, s4 bitop3:0x7e
    v_bitop3_b32 v6, v6, v201, s4 bitop3:0xf6
    v_bitop3_b32 v6, v6, v203, s4 bitop3:0xf6
    v_cmp_ne_u32 vcc, 0, v6
    s_cbranch_vccz TOK_51
POLL_52:
    buffer_load_dwordx4 v[196:199], v4, s[32:35], s13 offen sc1
    buffer_load_dwordx4 v[200:203], v4, s[32:35], s13 offen offset:1024 sc1
    s_waitcnt vmcnt(0)
    v_bitop3_b32 v6, v197, v199, s4 bitop3:0x7e
    v_bitop3_b32 v6, v6, v201, s4 bitop3:0xf6
    v_bitop3_b32 v6, v6, v203, s4 bitop3:0xf6
    v_cmp_ne_u32 vcc, 0, v6
    s_cbranch_vccz PDONE_53
    s_add_u32 s5, s5, 1
    s_cmp_lt_u32 s5, 300000
    s_cbranch_scc1 POLL_52
PDONE_53:
TOK_51:
    v_permlane32_swap_b32 v196, v198
    v_permlane32_swap_b32 v200, v202
    v_add_f32 v196, v196, v198
    v_add_f32 v200, v200, v202
    v_mov_b32 v198, v196
    v_mov_b32 v202, v200
    s_nop 0
    v_permlane16_swap_b32 v196, v198
    v_permlane16_swap_b32 v200, v202
    v_add_f32 v196, v196, v198
    v_add_f32 v200, v200, v202
    v_cvt_pk_bf16_f32 v196, 0, v196
    v_cvt_pk_bf16_f32 v200, 0, v200
    v_mul_f32 v6, s7, v196
    v_exp_f32 v6, -v6
    s_nop 0
    v_add_f32 v6, 1.0, v6
    v_rcp_f32 v6, v6
    s_nop 0
    v_mul_f32 v196, v196, v6
    v_cvt_pk_bf16_f32 v196, 0, v196
    v_mul_f32 v196, v196, v200
    v_cvt_pk_bf16_f32 v196, v196, v196
    ds_write_b16 v5, v196
L_NOH:
    v_bfe_u32 v4, v1, 2, 1
    v_lshlrev_b32 v4, 7, v4
    v_lshrrev_b32 v9, 5, v1
    v_lshl_add_u32 v4, v9, 4, v4
    v_add_u32 v4, 138752, v4
    v_lshrrev_b32 v5, 4, v1
    v_mul_u32_u24 v5, 7168, v5
    v_and_b32 v9, 15, v1
    v_lshl_add_u32 v5, v9, 3, v5
    v_and_b32 v6, 1, v1
    v_lshlrev_b32 v6, 18, v6
    v_bfe_u32 v9, v1, 1, 1
    v_lshl_add_u32 v6, v9, 13, v6
    s_lshl3_add_u32 s96, s75, s3
    s_mul_i32 s97, s96, 28672
    s_lshl_b32 s98, s74, 7
    s_add_u32 s99, s97, s98
    s_add_u32 s13, s99, 22020096
    s_lshr_b32 s96, s9, 2
    s_and_b32 s97, s75, 1
    s_lshr_b32 s98, s3, 1
    s_lshl2_add_u32 s99, s97, s98
    s_and_b32 s97, s3, 1
    s_lshl_b32 s98, s97, 2
    s_lshl3_add_u32 s97, s99, s98
    s_lshr_b32 s99, s75, 1
    s_add_u32 s98, s97, s99
    s_lshl_b32 s97, s98, 12
    s_lshl_b32 s99, s8, 6
    s_add_u32 s98, s97, s99
    s_lshl2_add_u32 s97, s96, s98
    s_add_u32 s99, s97, 1048576
    s_add_u32 s14, s99, 3072
    s_waitcnt vmcnt(0)
    s_waitcnt lgkmcnt(0)
    s_barrier
    ds_read_b128 v[196:199], v4
    ds_read_b64_tr_b16 v[180:181], v74
    ds_read_b64_tr_b16 v[182:183], v74 offset:1024
    ds_read_b128 v[200:203], v4 offset:32
    ds_read_b64_tr_b16 v[184:185], v74 offset:8192
    ds_read_b64_tr_b16 v[186:187], v74 offset:9216
    ds_read_b128 v[204:207], v4 offset:64
    ds_read_b64_tr_b16 v[188:189], v74 offset:16384
    ds_read_b64_tr_b16 v[190:191], v74 offset:17408
    ds_read_b128 v[208:211], v4 offset:96
    ds_read_b64_tr_b16 v[192:193], v74 offset:24576
    ds_read_b64_tr_b16 v[194:195], v74 offset:25600
    s_waitcnt lgkmcnt(9)
    v_mfma_f32_32x32x16_bf16 v[212:227], v[196:199], v[180:183], 0
    s_waitcnt lgkmcnt(6)
    v_mfma_f32_32x32x16_bf16 v[212:227], v[200:203], v[184:187], v[212:227]
    s_waitcnt lgkmcnt(3)
    v_mfma_f32_32x32x16_bf16 v[212:227], v[204:207], v[188:191], v[212:227]
    s_waitcnt lgkmcnt(0)
    v_mfma_f32_32x32x16_bf16 v[212:227], v[208:211], v[192:195], v[212:227]
    s_nop 11
    v_mov_b32 v213, s4
    buffer_store_dwordx2 v[212:213], v5, s[32:35], s13 offen sc1
    s_mov_b64 exec, 15
    buffer_store_dword v213, v6, s[32:35], s14 offen sc1
    s_mov_b64 exec, -1
    s_waitcnt lgkmcnt(0)
L_GSEC:
    s_lshl_b32 s96, s21, 7
    s_lshl4_add_u32 s13, s3, s96
    v_lshrrev_b32 v60, 3, v1
    v_lshl_add_u32 v60, v60, 0, s13
    s_lshl_b32 s96, s13, 11
    s_lshl_b32 s97, s12, 7
    s_add_u32 s15, s96, s97
    s_add_u32 s16, s15, 16384
    v_lshrrev_b32 v61, 3, v1
    v_lshlrev_b32 v61, 11, v61
    v_and_b32 v9, 7, v1
    v_lshl_add_u32 v61, v9, 4, v61
    v_cmp_ne_u32 vcc, s70, v60
    v_cmp_ne_u32 s[22:23], s71, v60
    s_nop 0
    s_and_b64 exec, vcc, s[22:23]
    buffer_store_dwordx4 v[124:127], v61, s[64:67], s15 offen sc1
    s_mov_b64 exec, -1
    v_add_u32 v60, 8, v60
    v_cmp_ne_u32 vcc, s70, v60
    v_cmp_ne_u32 s[22:23], s71, v60
    s_nop 0
    s_and_b64 exec, vcc, s[22:23]
    buffer_store_dwordx4 v[128:131], v61, s[64:67], s16 offen sc1
    s_mov_b64 exec, -1
    s_cmp_lt_u32 s9, 16
    s_cbranch_scc1 L_GF
    s_cmp_ge_u32 s9, 28
    s_cbranch_scc1 L_FIN
    s_waitcnt vmcnt(0)
    s_mov_b32 exec_lo, 0xffff
    s_mov_b32 exec_hi, 0xffff
    buffer_store_dwordx2 v[228:229], v230, s[32:35], 0 offen sc1
    s_mov_b64 exec, -1
    s_branch L_FIN
L_GF:
SPOLL_54:
    s_load_dwordx8 s[24:31], s[32:33], s92 offset:3072 glc
SCHK_55:
    s_add_u32 s5, s5, 1
    s_cmp_ge_u32 s5, 300000
    s_waitcnt lgkmcnt(0)
    s_cbranch_scc1 SDONE_56
    s_cmp_lg_u32 s24, s4
    s_cbranch_scc1 SPOLL_54
    s_cmp_lg_u32 s25, s4
    s_cbranch_scc1 SPOLL_54
    s_cmp_lg_u32 s26, s4
    s_cbranch_scc1 SPOLL_54
    s_cmp_lg_u32 s27, s4
    s_cbranch_scc1 SPOLL_54
    s_cmp_lg_u32 s28, s4
    s_cbranch_scc1 SPOLL_54
    s_cmp_lg_u32 s29, s4
    s_cbranch_scc1 SPOLL_54
    s_cmp_lg_u32 s30, s4
    s_cbranch_scc1 SPOLL_54
SDONE_56:
    s_barrier
    s_mov_b32 exec_lo, 0xffff
    s_mov_b32 exec_hi, 0xffff
    buffer_store_dwordx2 v[228:229], v230, s[32:35], 0 offen sc1
    s_mov_b64 exec, -1
    s_cmp_lg_u32 s3, 7
    s_cbranch_scc1 L_FIN
    s_add_u32 s13, s20, 4096
POLL_57:
    buffer_load_dwordx4 v[196:199], v2, s[32:35], s20 offen sc1
    buffer_load_dwordx4 v[200:203], v2, s[32:35], s20 offen offset:1024 sc1
    buffer_load_dwordx4 v[204:207], v2, s[32:35], s20 offen offset:2048 sc1
    buffer_load_dwordx4 v[208:211], v2, s[32:35], s20 offen offset:3072 sc1
    buffer_load_dwordx4 v[132:135], v2, s[32:35], s13 offen sc1
    buffer_load_dwordx4 v[136:139], v2, s[32:35], s13 offen offset:1024 sc1
    buffer_load_dwordx4 v[140:143], v2, s[32:35], s13 offen offset:2048 sc1
    s_waitcnt vmcnt(0)
    v_bitop3_b32 v4, v197, v199, s4 bitop3:0x7e
    v_bitop3_b32 v4, v4, v201, s4 bitop3:0xf6
    v_bitop3_b32 v4, v4, v203, s4 bitop3:0xf6
    v_bitop3_b32 v4, v4, v205, s4 bitop3:0xf6
    v_bitop3_b32 v4, v4, v207, s4 bitop3:0xf6
    v_bitop3_b32 v4, v4, v209, s4 bitop3:0xf6
    v_bitop3_b32 v4, v4, v211, s4 bitop3:0xf6
    v_bitop3_b32 v4, v4, v133, s4 bitop3:0xf6
    v_bitop3_b32 v4, v4, v135, s4 bitop3:0xf6
    v_bitop3_b32 v4, v4, v137, s4 bitop3:0xf6
    v_bitop3_b32 v4, v4, v139, s4 bitop3:0xf6
    v_bitop3_b32 v4, v4, v141, s4 bitop3:0xf6
    v_bitop3_b32 v4, v4, v143, s4 bitop3:0xf6
    v_cmp_ne_u32 vcc, 0, v4
    s_cbranch_vccz PDONE_58
    s_add_u32 s5, s5, 1
    s_cmp_lt_u32 s5, 300000
    s_cbranch_scc1 POLL_57
PDONE_58:
    v_bitop3_b32 v4, v57, v233, s4 bitop3:0x7e
    v_cmp_ne_u32 vcc, 0, v4
    s_cbranch_vccz TOK_59
POLL_60:
    buffer_load_dwordx2 v[56:57], v11, s[32:35], s68 offen sc1
    buffer_load_dwordx2 v[232:233], v11, s[32:35], s69 offen sc1
    s_waitcnt vmcnt(0)
    v_bitop3_b32 v4, v57, v233, s4 bitop3:0x7e
    v_cmp_ne_u32 vcc, 0, v4
    s_cbranch_vccz PDONE_61
    s_add_u32 s5, s5, 1
    s_cmp_lt_u32 s5, 300000
    s_cbranch_scc1 POLL_60
PDONE_61:
TOK_59:
    v_add_f32 v196, v196, v200
    v_add_f32 v198, v198, v202
    v_add_f32 v196, v196, v204
    v_add_f32 v198, v198, v206
    v_add_f32 v196, v196, v208
    v_add_f32 v198, v198, v210
    v_add_f32 v196, v196, v132
    v_add_f32 v198, v198, v134
    v_add_f32 v196, v196, v136
    v_add_f32 v198, v198, v138
    v_add_f32 v196, v196, v140
    v_add_f32 v198, v198, v142
    v_mov_b32 v197, v198
    v_add_f32_dpp v196, v196, v196 row_ror:8 row_mask:0xf bank_mask:0xf
    s_nop 0
    v_add_f32_dpp v197, v197, v197 row_ror:8 row_mask:0xf bank_mask:0xf
    v_mov_b32 v198, v196
    v_mov_b32 v199, v197
    s_nop 0
    v_permlane16_swap_b32 v196, v198
    v_permlane16_swap_b32 v197, v199
    v_pk_add_f32 v[196:197], v[196:197], v[198:199]
    v_mov_b32 v198, v196
    v_mov_b32 v199, v197
    s_nop 0
    v_permlane32_swap_b32 v196, v198
    v_permlane32_swap_b32 v197, v199
    v_pk_add_f32 v[196:197], v[196:197], v[198:199]
    v_cvt_pk_bf16_f32 v196, 0, v196
    v_cvt_pk_bf16_f32 v197, 0, v197
    v_pk_mul_f32 v[196:197], v[196:197], v[234:235] op_sel:[0,1]
    v_lshlrev_b32 v4, 16, v56
    v_and_b32 v5, s6, v56
    v_cvt_pk_bf16_f32 v196, 0, v196
    v_cvt_pk_bf16_f32 v197, 0, v197
    v_pk_add_f32 v[196:197], v[196:197], v[4:5]
    v_lshlrev_b32 v4, 16, v234
    v_and_b32 v5, s6, v234
    v_cvt_pk_bf16_f32 v196, 0, v196
    v_cvt_pk_bf16_f32 v197, 0, v197
    v_pk_mul_f32 v[196:197], v[196:197], v[4:5]
    v_lshlrev_b32 v4, 16, v232
    v_and_b32 v5, s6, v232
    v_cvt_pk_bf16_f32 v196, 0, v196
    v_cvt_pk_bf16_f32 v197, 0, v197
    v_pk_add_f32 v[196:197], v[196:197], v[4:5]
    v_cvt_pk_bf16_f32 v196, v196, v197
    s_mov_b64 exec, 0xff
    buffer_store_dword v196, v10, s[64:67], s82 offen sc1
    s_mov_b64 exec, -1
L_FIN:
L_END:
    s_endpgm
.p2align 10
.fill 768, 4, 0xbf800000
.section .rodata,"a"
.p2align 6
.amdhsa_kernel adaLN_cond__linear_kernel_hedgehog__moe_arch_mod__prompt_kernel
  .amdhsa_next_free_vgpr 256
  .amdhsa_next_free_sgpr 102
  .amdhsa_accum_offset 256
  .amdhsa_group_segment_fixed_size 0
  .amdhsa_kernarg_size 112
  .amdhsa_user_sgpr_count 2
  .amdhsa_user_sgpr_kernarg_segment_ptr 1
  .amdhsa_system_sgpr_workgroup_id_x 1
  .amdhsa_float_denorm_mode_32 3
  .amdhsa_float_denorm_mode_16_64 3
.end_amdhsa_kernel
```

```asm
; @launch grid=(256,1,1) block=(512,1,1) lds=163840
.amdgcn_target "amdgcn-amd-amdhsa--gfx950"
.text
.globl adaLN_cond__linear_kernel_hedgehog__moe_arch_mod__prompt_kernel
.p2align 8
.type adaLN_cond__linear_kernel_hedgehog__moe_arch_mod__prompt_kernel,@function
adaLN_cond__linear_kernel_hedgehog__moe_arch_mod__prompt_kernel:
    s_load_dwordx16 s[68:83], s[0:1], 0
    s_load_dwordx8 s[84:91], s[0:1], 64
    s_load_dwordx2 s[32:33], s[0:1], 104
    s_load_dwordx2 s[30:31], s[0:1], 96
    s_cmp_ge_u32 s2, 256
    s_cbranch_scc1 L_END
    v_lshrrev_b32 v4, 6, v0
    v_and_b32 v1, 63, v0
    v_mov_b32 v3, 0
    v_readfirstlane_b32 s3, v4
    v_lshlrev_b32 v2, 4, v1
    s_and_b32 s8, s2, 7
    s_lshr_b32 s9, s2, 3
    s_lshl2_add_u32 s96, s8, s3
    s_lshl_b32 s15, s96, 6
    s_mul_i32 s96, s15, 6144
    s_xor_b32 s97, s9, 1
    s_lshl_b32 s98, s97, 7
    s_add_u32 s13, s96, s98
    v_lshrrev_b32 v60, 3, v1
    v_mul_u32_u24 v60, 49152, v60
    v_and_b32 v9, 7, v1
    v_lshl_add_u32 v60, v9, 4, v60
    v_lshrrev_b32 v61, 3, v1
    v_lshl_add_u32 v61, v61, 3, s15
    s_lshl_b32 s96, s8, 5
    s_add_u32 s97, s96, s9
    s_lshl2_add_u32 s98, s97, s3
    s_sub_u32 s99, s98, 4
    s_lshl_b32 s16, s99, 12
    s_mov_b32 s50, 12582912
    s_mov_b32 s51, 0x20000
    s_mov_b32 s38, 4194304
    s_mov_b32 s39, 0x20000
    s_mov_b32 s34, 268435456
    s_mov_b32 s35, 0x20000
    s_getreg_b32 s94, hwreg(HW_REG_XCC_ID, 0, 3)
    s_getpc_b64 s[22:23]
    s_mul_i32 s96, s9, 7
    s_add_u32 s97, s96, s3
    s_lshl_b32 s19, s97, 7
    v_lshrrev_b32 v10, 5, v1
    v_mul_u32_u24 v10, 28672, v10
    v_add_u32 v10, s19, v10
    v_min_u32 v10, 44032, v10
    s_cmp_ge_u32 s3, 4
    s_waitcnt lgkmcnt(0)
    s_mov_b64 s[48:49], s[88:89]
    s_mov_b64 s[36:37], s[68:69]
    s_load_dword s4, s[32:33], 0
    s_cbranch_scc1 L_FS
    global_load_dwordx2 v[96:97], v61, s[86:87]
    buffer_load_dwordx4 v[80:83], v60, s[48:51], s13 offen nt
    s_add_u32 s13, s13, 12288
    buffer_load_dwordx4 v[84:87], v60, s[48:51], s13 offen nt
    s_add_u32 s13, s13, 12288
    buffer_load_dwordx4 v[88:91], v60, s[48:51], s13 offen nt
    s_add_u32 s13, s13, 12288
    buffer_load_dwordx4 v[92:95], v60, s[48:51], s13 offen nt
    s_barrier
    s_barrier
    s_and_b32 s22, s22, 0xfffffc00
    global_load_dword v78, v10, s[22:23]
    s_mov_b32 s42, 6291456
    s_mov_b32 s43, 0x20000
    s_mov_b32 s46, 2097152
    s_mov_b32 s47, 0x20000
    s_mov_b32 s54, 7340032
    s_mov_b32 s55, 0x20000
    s_mov_b32 s58, 7340032
    s_mov_b32 s59, 0x20000
    s_mov_b32 s62, 7340032
    s_mov_b32 s63, 0x20000
    s_mov_b32 s66, 4194304
    s_mov_b32 s67, 0x20000
    s_mov_b64 s[40:41], s[70:71]
    s_mov_b64 s[44:45], s[74:75]
    s_mov_b64 s[52:53], s[80:81]
    s_mov_b64 s[56:57], s[82:83]
    s_mov_b64 s[60:61], s[84:85]
    s_mov_b64 s[64:65], s[90:91]
    s_mov_b32 s5, 0
    s_mov_b32 s6, 0xffff0000
    s_mov_b32 s7, 0x3fb8aa3b
    s_lshr_b32 s76, s3, 2
    v_bfe_u32 v6, v1, 4, 1
    v_lshlrev_b32 v6, 6, v6
    v_and_b32 v62, 7, v1
    v_lshlrev_b32 v62, 4, v62
    v_xor_b32 v62, v62, v6
    v_lshrrev_b32 v6, 3, v1
    v_mul_u32_u24 v6, 6144, v6
    v_add_u32 v62, v62, v6
    v_lshlrev_b32 v63, 3, v1
    v_add_u32 v64, 149760, v2
    s_and_b32 s96, s3, 3
    s_lshl2_add_u32 s13, s96, 149760
    v_lshrrev_b32 v65, 4, v1
    v_lshl_add_u32 v65, v65, 5, s13
    v_and_b32 v9, 7, v1
    v_lshl_add_u32 v65, v9, 7, v65
    v_bfe_u32 v9, v1, 3, 1
    v_lshl_add_u32 v65, v9, 4, v65
    s_and_b32 s96, s8, 6
    s_and_b32 s97, s8, 1
    s_lshr_b32 s98, s9, 4
    s_lshl1_add_u32 s99, s97, s98
    s_lshl_b32 s97, s99, 6
    s_add_u32 s98, s96, s97
    s_lshl3_add_u32 s99, s3, s98
    s_lshl_b32 s96, s99, 10
    s_and_b32 s97, s9, 15
    s_lshl_b32 s98, s97, 6
    s_add_u32 s99, s96, s98
    s_add_u32 s14, s99, 262144
    s_xor_b32 s96, s9, 1
    s_and_b32 s97, s96, 15
    s_lshl4_add_u32 s98, s3, s97
    s_lshr_b32 s99, s9, 4
    s_lshl1_add_u32 s96, s98, s99
    s_lshl3_add_u32 s97, s96, s8
    s_lshl_b32 s98, s97, 9
    s_add_u32 s13, s98, 524288
    s_lshr_b32 s96, s9, 4
    s_xor_b32 s97, s9, 1
    s_and_b32 s98, s97, 7
    s_lshl_b32 s99, s3, 1
    s_lshl3_add_u32 s97, s98, s99
    s_bfe_u32 s98, s9, 65539
    s_add_u32 s99, s97, s98
    s_lshl_b32 s97, s99, 9
    s_lshl_b32 s98, s8, 6
    s_add_u32 s99, s97, s98
    s_lshl2_add_u32 s97, s96, s99
    s_add_u32 s15, s97, 2097152
    v_and_b32 v10, 3, v1
    v_lshlrev_b32 v10, 15, v10
    s_waitcnt vmcnt(5)
    v_lshlrev_b32 v98, 16, v97
    v_and_b32 v99, s6, v97
    v_and_b32 v97, s6, v96
    v_lshlrev_b32 v96, 16, v96
    v_mul_f32 v4, s7, v96
    v_exp_f32 v4, -v4
    s_nop 0
    v_add_f32 v4, 1.0, v4
    v_rcp_f32 v4, v4
    s_nop 0
    v_mul_f32 v96, v96, v4
    v_cvt_pk_bf16_f32 v96, 0, v96
    v_mul_f32 v5, s7, v97
    v_exp_f32 v5, -v5
    s_nop 0
    v_add_f32 v5, 1.0, v5
    v_rcp_f32 v5, v5
    s_nop 0
    v_mul_f32 v97, v97, v5
    v_cvt_pk_bf16_f32 v97, 0, v97
    v_mul_f32 v4, s7, v98
    v_exp_f32 v4, -v4
    s_nop 0
    v_add_f32 v4, 1.0, v4
    v_rcp_f32 v4, v4
    s_nop 0
    v_mul_f32 v98, v98, v4
    v_cvt_pk_bf16_f32 v98, 0, v98
    v_mul_f32 v5, s7, v99
    v_exp_f32 v5, -v5
    s_nop 0
    v_add_f32 v5, 1.0, v5
    v_rcp_f32 v5, v5
    s_nop 0
    v_mul_f32 v99, v99, v5
    v_cvt_pk_bf16_f32 v99, 0, v99
    s_waitcnt vmcnt(4)
    v_lshlrev_b32 v4, 16, v80
    v_and_b32 v5, s6, v80
    v_pk_mul_f32 v[20:21], v[4:5], v[96:97] op_sel:[0,0] op_sel_hi:[1,0]
    v_lshlrev_b32 v6, 16, v81
    v_and_b32 v7, s6, v81
    v_pk_mul_f32 v[22:23], v[6:7], v[96:97] op_sel:[0,0] op_sel_hi:[1,0]
    v_lshlrev_b32 v4, 16, v82
    v_and_b32 v5, s6, v82
    v_pk_mul_f32 v[24:25], v[4:5], v[96:97] op_sel:[0,0] op_sel_hi:[1,0]
    v_lshlrev_b32 v6, 16, v83
    v_and_b32 v7, s6, v83
    v_pk_mul_f32 v[26:27], v[6:7], v[96:97] op_sel:[0,0] op_sel_hi:[1,0]
    s_waitcnt vmcnt(3)
    v_lshlrev_b32 v4, 16, v84
    v_and_b32 v5, s6, v84
    v_pk_fma_f32 v[20:21], v[4:5], v[96:97], v[20:21] op_sel:[0,1,0] op_sel_hi:[1,1,1]
    v_lshlrev_b32 v6, 16, v85
    v_and_b32 v7, s6, v85
    v_pk_fma_f32 v[22:23], v[6:7], v[96:97], v[22:23] op_sel:[0,1,0] op_sel_hi:[1,1,1]
    v_lshlrev_b32 v4, 16, v86
    v_and_b32 v5, s6, v86
    v_pk_fma_f32 v[24:25], v[4:5], v[96:97], v[24:25] op_sel:[0,1,0] op_sel_hi:[1,1,1]
    v_lshlrev_b32 v6, 16, v87
    v_and_b32 v7, s6, v87
    v_pk_fma_f32 v[26:27], v[6:7], v[96:97], v[26:27] op_sel:[0,1,0] op_sel_hi:[1,1,1]
    s_waitcnt vmcnt(2)
    v_lshlrev_b32 v4, 16, v88
    v_and_b32 v5, s6, v88
    v_pk_fma_f32 v[20:21], v[4:5], v[98:99], v[20:21] op_sel:[0,0,0] op_sel_hi:[1,0,1]
    v_lshlrev_b32 v6, 16, v89
    v_and_b32 v7, s6, v89
    v_pk_fma_f32 v[22:23], v[6:7], v[98:99], v[22:23] op_sel:[0,0,0] op_sel_hi:[1,0,1]
    v_lshlrev_b32 v4, 16, v90
    v_and_b32 v5, s6, v90
    v_pk_fma_f32 v[24:25], v[4:5], v[98:99], v[24:25] op_sel:[0,0,0] op_sel_hi:[1,0,1]
    v_lshlrev_b32 v6, 16, v91
    v_and_b32 v7, s6, v91
    v_pk_fma_f32 v[26:27], v[6:7], v[98:99], v[26:27] op_sel:[0,0,0] op_sel_hi:[1,0,1]
    s_waitcnt vmcnt(1)
    v_lshlrev_b32 v4, 16, v92
    v_and_b32 v5, s6, v92
    v_pk_fma_f32 v[20:21], v[4:5], v[98:99], v[20:21] op_sel:[0,1,0] op_sel_hi:[1,1,1]
    v_lshlrev_b32 v6, 16, v93
    v_and_b32 v7, s6, v93
    v_pk_fma_f32 v[22:23], v[6:7], v[98:99], v[22:23] op_sel:[0,1,0] op_sel_hi:[1,1,1]
    v_lshlrev_b32 v4, 16, v94
    v_and_b32 v5, s6, v94
    v_pk_fma_f32 v[24:25], v[4:5], v[98:99], v[24:25] op_sel:[0,1,0] op_sel_hi:[1,1,1]
    v_lshlrev_b32 v6, 16, v95
    v_and_b32 v7, s6, v95
    v_pk_fma_f32 v[26:27], v[6:7], v[98:99], v[26:27] op_sel:[0,1,0] op_sel_hi:[1,1,1]
    v_permlane32_swap_b32 v20, v24
    v_permlane32_swap_b32 v21, v25
    v_permlane32_swap_b32 v22, v26
    v_permlane32_swap_b32 v23, v27
    v_add_f32 v20, v20, v24
    v_add_f32 v21, v21, v25
    v_add_f32 v22, v22, v26
    v_add_f32 v23, v23, v27
    s_nop 0
    v_permlane16_swap_b32 v20, v22
    v_permlane16_swap_b32 v21, v23
    v_add_f32 v20, v20, v22
    v_add_f32 v21, v21, v23
    s_nop 0
    v_add_f32_dpp v20, v20, v20 row_ror:8 row_mask:0xf bank_mask:0xf
    v_add_f32_dpp v21, v21, v21 row_ror:8 row_mask:0xf bank_mask:0xf
    s_nop 1
    v_mov_b32_dpp v20, v21 quad_perm:[0,1,2,3] row_mask:0xf bank_mask:0xc
    ds_write_b32 v65, v20
    s_waitcnt lgkmcnt(0)
    s_barrier
    ds_read_b128 v[20:23], v64 offset:0
    s_mul_i32 s4, s4, 0x9e3779b1
    s_add_u32 s4, s4, 0x7f4a7c15
    s_waitcnt lgkmcnt(0)
    v_pk_add_f32 v[20:21], v[20:21], v[22:23]
    v_add_f32 v20, v20, v21
    v_mov_b32 v21, s4
    buffer_store_dwordx2 v[20:21], v63, s[32:35], s13 offen sc1
    s_mov_b64 exec, 15
    buffer_store_dword v21, v10, s[32:35], s15 offen sc1
    s_mov_b64 exec, -1
    s_lshl2_add_u32 s96, s2, s3
    s_mul_i32 s13, s96, 6144
    s_branch L_FJ
L_FS:
    s_barrier
    buffer_load_dwordx4 v[80:83], v2, s[36:39], s16 offen
    buffer_load_dwordx4 v[84:87], v2, s[36:39], s16 offen offset:1024
    buffer_load_dwordx4 v[88:91], v2, s[36:39], s16 offen offset:2048
    buffer_load_dwordx4 v[92:95], v2, s[36:39], s16 offen offset:3072
    s_lshl2_add_u32 s96, s2, s3
    s_sub_u32 s97, s96, 4
    s_lshl_b32 s98, s97, 7
    s_add_u32 s17, s98, 2097152
    s_load_dword s24, s[32:33], s17 offset:0 glc
    s_load_dword s25, s[32:33], s17 offset:64 glc
    s_lshl_b32 s96, s2, 5
    s_add_u32 s97, s96, s3
    s_sub_u32 s98, s97, 4
    s_lshl_b32 s99, s98, 7
    s_add_u32 s17, s99, 1048576
    s_load_dword s24, s[32:33], s17 offset:0 glc
    s_load_dword s25, s[32:33], s17 offset:64 glc
    s_lshl_b32 s19, s94, 5
    v_mov_b32 v78, 1
    v_mov_b32 v79, s19
    s_barrier
    s_cmp_lg_u32 s3, 7
    s_cbranch_scc1 L_NOTK
    s_mov_b64 exec, 1
    global_atomic_add v78, v79, v78, s[30:31] sc0 sc1
    s_mov_b64 exec, -1
    s_branch L_TK0
L_NOTK:
    s_and_b32 s22, s22, 0xfffffc00
    global_load_dword v78, v10, s[22:23]
L_TK0:
    s_mov_b32 s42, 6291456
    s_mov_b32 s43, 0x20000
    s_mov_b32 s46, 2097152
    s_mov_b32 s47, 0x20000
    s_mov_b32 s54, 7340032
    s_mov_b32 s55, 0x20000
    s_mov_b32 s58, 7340032
    s_mov_b32 s59, 0x20000
    s_mov_b32 s62, 7340032
    s_mov_b32 s63, 0x20000
    s_mov_b32 s66, 4194304
    s_mov_b32 s67, 0x20000
    s_mov_b64 s[40:41], s[70:71]
    s_mov_b64 s[44:45], s[74:75]
    s_mov_b64 s[52:53], s[80:81]
    s_mov_b64 s[56:57], s[82:83]
    s_mov_b64 s[60:61], s[84:85]
    s_mov_b64 s[64:65], s[90:91]
    s_mov_b32 s5, 0
    s_mov_b32 s6, 0xffff0000
    s_mov_b32 s7, 0x3fb8aa3b
    s_lshr_b32 s76, s3, 2
    v_bfe_u32 v6, v1, 4, 1
    v_lshlrev_b32 v6, 6, v6
    v_and_b32 v62, 7, v1
    v_lshlrev_b32 v62, 4, v62
    v_xor_b32 v62, v62, v6
    v_lshrrev_b32 v6, 3, v1
    v_mul_u32_u24 v6, 6144, v6
    v_add_u32 v62, v62, v6
    v_lshlrev_b32 v63, 3, v1
    v_add_u32 v64, 149760, v2
    s_and_b32 s96, s3, 3
    s_lshl2_add_u32 s13, s96, 149760
    v_lshrrev_b32 v65, 4, v1
    v_lshl_add_u32 v65, v65, 5, s13
    v_and_b32 v9, 7, v1
    v_lshl_add_u32 v65, v9, 7, v65
    v_bfe_u32 v9, v1, 3, 1
    v_lshl_add_u32 v65, v9, 4, v65
    s_and_b32 s96, s8, 6
    s_and_b32 s97, s8, 1
    s_lshr_b32 s98, s9, 4
    s_lshl1_add_u32 s99, s97, s98
    s_lshl_b32 s97, s99, 6
    s_add_u32 s98, s96, s97
    s_lshl3_add_u32 s99, s3, s98
    s_lshl_b32 s96, s99, 10
    s_and_b32 s97, s9, 15
    s_lshl_b32 s98, s97, 6
    s_add_u32 s99, s96, s98
    s_add_u32 s14, s99, 262144
    s_sub_u32 s96, s3, 4
    s_lshl4_add_u32 s13, s96, 151808
    v_lshrrev_b32 v10, 5, v1
    v_lshl_add_u32 v10, v10, 3, s13
    s_barrier
    s_waitcnt vmcnt(1)
    s_waitcnt lgkmcnt(0)
    s_mul_i32 s4, s4, 0x9e3779b1
    s_add_u32 s4, s4, 0x7f4a7c15
    v_mov_b32 v104, 0x3f803f80
    v_dot2_f32_bf16 v100, v80, v104, 0
    v_dot2_f32_bf16 v102, v80, v80, 0
    v_dot2_f32_bf16 v101, v88, v104, 0
    v_dot2_f32_bf16 v103, v88, v88, 0
    v_dot2_f32_bf16 v100, v81, v104, v100
    v_dot2_f32_bf16 v102, v81, v81, v102
    v_dot2_f32_bf16 v101, v89, v104, v101
    v_dot2_f32_bf16 v103, v89, v89, v103
    v_dot2_f32_bf16 v100, v82, v104, v100
    v_dot2_f32_bf16 v102, v82, v82, v102
    v_dot2_f32_bf16 v101, v90, v104, v101
    v_dot2_f32_bf16 v103, v90, v90, v103
    v_dot2_f32_bf16 v100, v83, v104, v100
    v_dot2_f32_bf16 v102, v83, v83, v102
    v_dot2_f32_bf16 v101, v91, v104, v101
    v_dot2_f32_bf16 v103, v91, v91, v103
    v_dot2_f32_bf16 v100, v84, v104, v100
    v_dot2_f32_bf16 v102, v84, v84, v102
    v_dot2_f32_bf16 v101, v92, v104, v101
    v_dot2_f32_bf16 v103, v92, v92, v103
    v_dot2_f32_bf16 v100, v85, v104, v100
    v_dot2_f32_bf16 v102, v85, v85, v102
    v_dot2_f32_bf16 v101, v93, v104, v101
    v_dot2_f32_bf16 v103, v93, v93, v103
    v_dot2_f32_bf16 v100, v86, v104, v100
    v_dot2_f32_bf16 v102, v86, v86, v102
    v_dot2_f32_bf16 v101, v94, v104, v101
    v_dot2_f32_bf16 v103, v94, v94, v103
    v_dot2_f32_bf16 v100, v87, v104, v100
    v_dot2_f32_bf16 v102, v87, v87, v102
    v_dot2_f32_bf16 v101, v95, v104, v101
    v_dot2_f32_bf16 v103, v95, v95, v103
    s_nop 1
    v_permlane32_swap_b32 v100, v101
    v_permlane32_swap_b32 v102, v103
    v_add_f32 v100, v100, v101
    v_add_f32 v102, v102, v103
    s_nop 1
    v_permlane16_swap_b32 v100, v102
    v_add_f32 v100, v100, v102
    s_nop 1
    v_add_f32_dpp v100, v100, v100 quad_perm:[1,0,3,2] row_mask:0xf bank_mask:0xf
    s_nop 1
    v_add_f32_dpp v100, v100, v100 quad_perm:[2,3,0,1] row_mask:0xf bank_mask:0xf
    s_nop 1
    v_add_f32_dpp v100, v100, v100 row_half_mirror row_mask:0xf bank_mask:0xf
    s_nop 1
    v_add_f32_dpp v100, v100, v100 row_ror:8 row_mask:0xf bank_mask:0xf
    v_mul_f32 v102, 0x3a800000, v100
    v_mul_f32 v100, 0x3a800000, v100
    s_nop 1
    v_permlane16_swap_b32 v100, v102
    v_fma_f32 v117, -v100, v100, v102
    v_cvt_pk_bf16_f32 v116, 0, v100
    v_max_f32 v117, 0, v117
    v_cvt_pk_bf16_f32 v117, 0, v117
    v_add_f32 v117, 0x3727c5ac, v117
    v_cvt_pk_bf16_f32 v117, 0, v117
    v_sqrt_f32 v117, v117
    s_nop 0
    v_cvt_pk_bf16_f32 v117, 0, v117
    v_lshrrev_b32 v116, 16, v116
    v_or_b32 v116, v116, v117
    v_mov_b32 v117, s4
    ds_write_b64 v10, v[116:117]
L_FJ:
    v_and_b32 v5, 3, v1
    v_lshlrev_b32 v5, 4, v5
    v_add_u32 v5, 151808, v5
    v_and_b32 v4, 3, v1
    v_lshlrev_b32 v4, 4, v4
    v_bfe_u32 v9, v1, 2, 1
    v_lshl_add_u32 v4, v9, 10, v4
    v_and_b32 v10, 31, v1
    v_lshlrev_b32 v10, 11, v10
    v_lshrrev_b32 v9, 5, v1
    v_lshl_add_u32 v10, v9, 5, v10
    v_and_b32 v6, 1, v1
    v_lshlrev_b32 v6, 9, v6
    s_and_b32 s96, s9, 1
    s_and_b32 s97, s8, 6
    s_and_b32 s98, s8, 1
    s_lshr_b32 s99, s9, 4
    s_lshl1_add_u32 s98, s98, s99
    s_lshl_b32 s99, s98, 6
    s_add_u32 s98, s97, s99
    s_lshl3_add_u32 s97, s3, s98
    s_lshl_b32 s99, s97, 9
    s_bfe_u32 s98, s9, 196609
    s_lshl_b32 s97, s98, 6
    s_add_u32 s98, s99, s97
    s_lshl2_add_u32 s99, s96, s98
    s_add_u32 s97, s99, 8
    s_add_u32 s15, s97, 2097152
    s_waitcnt lgkmcnt(0)
    s_barrier
    ds_read_b128 v[116:119], v5
    s_waitcnt lgkmcnt(0)
    s_mov_b64 exec, 0xff
    buffer_store_dwordx4 v[116:119], v4, s[32:35], s14 offen sc1
    s_mov_b64 exec, 3
    buffer_store_dword v117, v6, s[32:35], s15 offen sc1
    s_mov_b64 exec, -1
    s_cmp_lg_u32 s3, 7
    s_cbranch_scc1 L_NOTK2
    s_mov_b32 s13, 0
    s_waitcnt vmcnt(2)
L_TK:
    v_readfirstlane_b32 s15, v78
    s_nop 0
    s_cmp_lt_u32 s15, 32
    s_cbranch_scc1 L_TKOK
    v_mov_b32 v78, s4
    s_mov_b64 exec, 1
    buffer_store_dword v78, v3, s[32:35], 0 offen offset:256 sc1
    s_mov_b64 exec, -1
    s_add_u32 s13, s13, 1
    s_cmp_lt_u32 s13, 8
    s_cbranch_scc0 L_TKNO
    s_add_u32 s94, s94, 1
    s_and_b32 s94, s94, 7
    s_lshl_b32 s19, s94, 5
    v_mov_b32 v78, 1
    v_mov_b32 v79, s19
    s_mov_b64 exec, 1
    global_atomic_add v78, v79, v78, s[30:31] sc0 sc1
    s_mov_b64 exec, -1
    s_waitcnt vmcnt(0)
    s_branch L_TK
L_TKNO:
    s_and_b32 s94, s2, 7
    s_lshr_b32 s15, s2, 3
L_TKOK:
    s_lshl3_add_u32 s15, s15, s94
    v_mov_b32 v78, s15
    ds_write_b32 v5, v78 offset:64
L_NOTK2:
    s_waitcnt lgkmcnt(0)
    s_barrier
    ds_read_b32 v120, v5 offset:64
    s_waitcnt lgkmcnt(0)
    v_readfirstlane_b32 s2, v120
    s_nop 0
    s_and_b32 s8, s2, 7
    s_lshr_b32 s9, s2, 3
    s_and_b32 s96, s8, 1
    s_and_b32 s97, s9, 7
    s_lshl3_add_u32 s12, s96, s97
    s_lshr_b32 s96, s8, 1
    s_lshr_b32 s97, s9, 3
    s_lshl2_add_u32 s21, s96, s97
    s_and_b32 s96, s3, 3
    s_lshl2_add_u32 s94, s21, s96
    s_lshl1_add_u32 s95, s12, s76
    s_lshl_b32 s96, s94, 16
    s_lshl_b32 s97, s95, 6
    s_add_u32 s18, s96, s97
    buffer_load_dwordx4 v[12:15], v10, s[36:39], s18 offen
    buffer_load_dwordx4 v[16:19], v10, s[36:39], s18 offen offset:16
    s_lshr_b32 s96, s8, 1
    s_lshl4_add_u32 s97, s96, s12
    s_lshl4_add_u32 s98, s97, s3
    s_lshl_b32 s99, s98, 9
    s_add_u32 s13, s99, 524288
    s_lshl3_add_u32 s96, s2, s3
    s_lshl_b32 s97, s96, 6
    s_add_u32 s15, s97, 2097152
    s_and_b32 s96, s3, 3
    s_lshl2_add_u32 s97, s2, s96
    s_lshl_b32 s98, s97, 8
    s_add_u32 s14, s98, 262144
    s_load_dwordx4 s[24:27], s[32:33], s15 offset:0 glc
    s_and_b32 s10, s9, 15
    s_lshr_b32 s96, s8, 2
    s_and_b32 s97, s8, 1
    s_lshl1_add_u32 s98, s96, s97
    s_and_b32 s99, s8, 2
    s_lshl2_add_u32 s96, s98, s99
    s_lshr_b32 s97, s9, 4
    s_add_u32 s11, s96, s97
    s_and_b32 s85, s9, 12
    s_lshl_b32 s96, s2, 6
    s_add_u32 s97, s96, s3
    s_lshl_b32 s98, s97, 6
    s_add_u32 s92, s98, 1048576
    s_lshr_b32 s96, s9, 4
    s_xor_b32 s77, s76, s96
    s_lshr_b32 s96, s9, 3
    s_xor_b32 s97, s96, s9
    s_and_b32 s98, s97, 1
    s_lshl_b32 s83, s98, 2
    s_mul_i32 s96, s8, 7
    s_lshr_b32 s97, s9, 2
    s_add_u32 s74, s96, s97
    s_and_b32 s75, s9, 3
    v_and_b32 v8, 31, v1
    v_lshlrev_b32 v8, 3, v8
    v_and_b32 v4, 31, v1
    v_lshlrev_b32 v4, 4, v4
    v_lshrrev_b32 v9, 5, v1
    v_lshl_add_u32 v4, v9, 12, v4
    s_lshl2_add_u32 s16, s3, 152320
    v_lshl_add_u32 v5, v1, 6, s16
    s_lshl_b32 s96, s76, 10
    s_add_u32 s16, s96, 152320
    v_and_b32 v6, 15, v1
    v_lshl_add_u32 v6, v6, 5, s16
    v_lshrrev_b32 v9, 5, v1
    v_lshl_add_u32 v6, v9, 9, v6
    s_branch SCHK_2
SPOLL_1:
    s_load_dwordx4 s[24:27], s[32:33], s15 offset:0 glc
SCHK_2:
    s_add_u32 s5, s5, 1
    s_cmp_ge_u32 s5, 300000
    s_waitcnt lgkmcnt(0)
    s_cbranch_scc1 SDONE_3
    s_cmp_lg_u32 s24, s4
    s_cbranch_scc1 SPOLL_1
    s_cmp_lg_u32 s25, s4
    s_cbranch_scc1 SPOLL_1
    s_cmp_lg_u32 s26, s4
    s_cbranch_scc1 SPOLL_1
    s_cmp_lg_u32 s27, s4
    s_cbranch_scc1 SPOLL_1
SDONE_3:
    s_barrier
    buffer_load_dwordx4 v[120:123], v4, s[32:35], s13 offen sc1
    buffer_load_dwordx2 v[116:117], v8, s[32:35], s14 offen sc1
    s_lshl_b32 s96, s11, 12
    s_lshl_b32 s97, s3, 9
    s_add_u32 s16, s96, s97
    v_add_u32 v10, s16, v2
    s_lshl_b32 s96, s3, 9
    s_add_u32 m0, s96, 156416
    s_mov_b32 exec_hi, 0
    global_load_lds_dwordx4 v10, s[72:73]
    s_mov_b32 exec_hi, -1
    s_and_b32 s20, s9, 3
    s_add_u32 s96, s20, s85
    s_and_b32 s97, s96, 15
    s_lshl3_add_u32 s98, s97, s3
    s_mul_i32 s99, s98, 49152
    s_lshl_b32 s96, s11, 7
    s_add_u32 s82, s99, s96
    s_mul_i32 s96, s20, 24960
    s_lshr_b32 s97, s3, 1
    s_mul_i32 s98, s97, 2080
    s_add_u32 s99, s96, s98
    s_and_b32 s97, s3, 1
    s_mul_i32 s96, s97, 1056
    s_add_u32 s20, s99, s96
    s_mov_b32 m0, s20
    s_nop 0
    buffer_load_dwordx4 v62, s[40:43], s82 offen lds
    s_add_u32 s82, s82, 2048
    s_add_u32 m0, s20, 8320
    s_nop 0
    buffer_load_dwordx4 v62, s[40:43], s82 offen lds
    s_add_u32 s82, s82, 2048
    s_add_u32 m0, s20, 16640
    s_nop 0
    buffer_load_dwordx4 v62, s[40:43], s82 offen lds
    s_waitcnt vmcnt(5)
    v_bitop3_b32 v7, v121, v123, s4 bitop3:0x7e
    v_cmp_ne_u32 vcc, 0, v7
    s_cbranch_vccz TOK_5
POLL_6:
    buffer_load_dwordx4 v[120:123], v4, s[32:35], s13 offen sc1
    s_waitcnt vmcnt(0)
    v_bitop3_b32 v7, v121, v123, s4 bitop3:0x7e
    v_cmp_ne_u32 vcc, 0, v7
    s_cbranch_vccz PDONE_7
    s_add_u32 s5, s5, 1
    s_cmp_lt_u32 s5, 300000
    s_cbranch_scc1 POLL_6
PDONE_7:
TOK_5:
    ds_write2_b32 v5, v120, v122 offset0:0 offset1:8
    v_lshlrev_b32 v100, 16, v12
    v_and_b32 v101, s6, v12
    v_lshlrev_b32 v102, 16, v13
    v_and_b32 v103, s6, v13
    v_lshlrev_b32 v104, 16, v14
    v_and_b32 v105, s6, v14
    v_lshlrev_b32 v106, 16, v15
    v_and_b32 v107, s6, v15
    v_lshlrev_b32 v108, 16, v16
    v_and_b32 v109, s6, v16
    v_lshlrev_b32 v110, 16, v17
    v_and_b32 v111, s6, v17
    v_lshlrev_b32 v112, 16, v18
    v_and_b32 v113, s6, v18
    v_lshlrev_b32 v114, 16, v19
    v_and_b32 v115, s6, v19
    s_waitcnt lgkmcnt(0)
    s_barrier
    ds_read_b128 v[88:91], v6 offset:2048
    ds_read_b128 v[92:95], v6 offset:2064
    ds_read_b128 v[80:83], v6
    ds_read_b128 v[84:87], v6 offset:16
    s_waitcnt vmcnt(4)
    v_cmp_ne_u32 vcc, s4, v117
    s_cbranch_vccz TOK_8
POLL_9:
    buffer_load_dwordx2 v[116:117], v8, s[32:35], s14 offen sc1
    s_waitcnt vmcnt(0)
    v_cmp_ne_u32 vcc, s4, v117
    s_cbranch_vccz PDONE_10
    s_add_u32 s5, s5, 1
    s_cmp_lt_u32 s5, 300000
    s_cbranch_scc1 POLL_9
PDONE_10:
TOK_8:
    v_lshlrev_b32 v117, 16, v116
    v_and_b32 v116, s6, v116
    v_rcp_f32 v116, v116
    s_nop 0
    v_pk_add_f32 v[100:101], v[100:101], v[116:117] op_sel:[0,1] neg_lo:[0,1] neg_hi:[0,1]
    v_pk_add_f32 v[102:103], v[102:103], v[116:117] op_sel:[0,1] neg_lo:[0,1] neg_hi:[0,1]
    v_pk_add_f32 v[104:105], v[104:105], v[116:117] op_sel:[0,1] neg_lo:[0,1] neg_hi:[0,1]
    v_pk_add_f32 v[106:107], v[106:107], v[116:117] op_sel:[0,1] neg_lo:[0,1] neg_hi:[0,1]
    v_pk_add_f32 v[108:109], v[108:109], v[116:117] op_sel:[0,1] neg_lo:[0,1] neg_hi:[0,1]
    v_pk_add_f32 v[110:111], v[110:111], v[116:117] op_sel:[0,1] neg_lo:[0,1] neg_hi:[0,1]
    v_pk_add_f32 v[112:113], v[112:113], v[116:117] op_sel:[0,1] neg_lo:[0,1] neg_hi:[0,1]
    v_pk_add_f32 v[114:115], v[114:115], v[116:117] op_sel:[0,1] neg_lo:[0,1] neg_hi:[0,1]
    s_lshl4_add_u32 s96, s21, s12
    s_and_b32 s97, s3, 3
    s_lshl2_add_u32 s98, s96, s97
    s_lshl1_add_u32 s99, s98, s76
    s_lshl_b32 s96, s99, 11
    s_add_u32 s13, s96, 4194304
    v_and_b32 v8, 15, v1
    v_lshlrev_b32 v8, 4, v8
    v_bfe_u32 v9, v1, 4, 1
    v_lshl_add_u32 v8, v9, 10, v8
    v_lshrrev_b32 v9, 5, v1
    v_lshl_add_u32 v8, v9, 9, v8
    s_waitcnt lgkmcnt(2)
    v_pk_add_f32 v[88:89], v[88:89], v[90:91]
    v_pk_add_f32 v[92:93], v[92:93], v[94:95]
    v_pk_add_f32 v[88:89], v[88:89], v[92:93]
    v_add_f32 v88, v88, v89
    v_cvt_pk_bf16_f32 v88, 0, v88
    s_waitcnt lgkmcnt(0)
    v_pk_add_f32 v[80:81], v[80:81], v[82:83]
    v_pk_add_f32 v[84:85], v[84:85], v[86:87]
    v_pk_add_f32 v[80:81], v[80:81], v[84:85]
    v_add_f32 v80, v80, v81
    v_add_f32 v88, 1.0, v88
    v_cvt_pk_bf16_f32 v88, 0, v88
    v_cvt_pk_bf16_f32 v80, 0, v80
    v_cvt_pk_bf16_f32 v100, 0, v100
    v_cvt_pk_bf16_f32 v101, 0, v101
    v_cvt_pk_bf16_f32 v102, 0, v102
    v_cvt_pk_bf16_f32 v103, 0, v103
    v_cvt_pk_bf16_f32 v104, 0, v104
    v_cvt_pk_bf16_f32 v105, 0, v105
    v_cvt_pk_bf16_f32 v106, 0, v106
    v_cvt_pk_bf16_f32 v107, 0, v107
    v_pk_mul_f32 v[100:101], v[100:101], v[116:117] op_sel_hi:[1,0]
    v_pk_mul_f32 v[102:103], v[102:103], v[116:117] op_sel_hi:[1,0]
    v_pk_mul_f32 v[104:105], v[104:105], v[116:117] op_sel_hi:[1,0]
    v_pk_mul_f32 v[106:107], v[106:107], v[116:117] op_sel_hi:[1,0]
    v_cvt_pk_bf16_f32 v100, 0, v100
    v_cvt_pk_bf16_f32 v101, 0, v101
    v_cvt_pk_bf16_f32 v102, 0, v102
    v_cvt_pk_bf16_f32 v103, 0, v103
    v_cvt_pk_bf16_f32 v104, 0, v104
    v_cvt_pk_bf16_f32 v105, 0, v105
    v_cvt_pk_bf16_f32 v106, 0, v106
    v_cvt_pk_bf16_f32 v107, 0, v107
    v_mul_f32_dpp v100, v88, v100 row_newbcast:0 row_mask:0xf bank_mask:0xf
    v_mul_f32_dpp v101, v88, v101 row_newbcast:1 row_mask:0xf bank_mask:0xf
    v_mul_f32_dpp v102, v88, v102 row_newbcast:2 row_mask:0xf bank_mask:0xf
    v_mul_f32_dpp v103, v88, v103 row_newbcast:3 row_mask:0xf bank_mask:0xf
    v_mul_f32_dpp v104, v88, v104 row_newbcast:4 row_mask:0xf bank_mask:0xf
    v_mul_f32_dpp v105, v88, v105 row_newbcast:5 row_mask:0xf bank_mask:0xf
    v_mul_f32_dpp v106, v88, v106 row_newbcast:6 row_mask:0xf bank_mask:0xf
    v_mul_f32_dpp v107, v88, v107 row_newbcast:7 row_mask:0xf bank_mask:0xf
    v_cvt_pk_bf16_f32 v100, 0, v100
    v_cvt_pk_bf16_f32 v101, 0, v101
    v_cvt_pk_bf16_f32 v102, 0, v102
    v_cvt_pk_bf16_f32 v103, 0, v103
    v_cvt_pk_bf16_f32 v104, 0, v104
    v_cvt_pk_bf16_f32 v105, 0, v105
    v_cvt_pk_bf16_f32 v106, 0, v106
    v_cvt_pk_bf16_f32 v107, 0, v107
    v_add_f32_dpp v100, v80, v100 row_newbcast:0 row_mask:0xf bank_mask:0xf
    v_add_f32_dpp v101, v80, v101 row_newbcast:1 row_mask:0xf bank_mask:0xf
    v_add_f32_dpp v102, v80, v102 row_newbcast:2 row_mask:0xf bank_mask:0xf
    v_add_f32_dpp v103, v80, v103 row_newbcast:3 row_mask:0xf bank_mask:0xf
    v_add_f32_dpp v104, v80, v104 row_newbcast:4 row_mask:0xf bank_mask:0xf
    v_add_f32_dpp v105, v80, v105 row_newbcast:5 row_mask:0xf bank_mask:0xf
    v_add_f32_dpp v106, v80, v106 row_newbcast:6 row_mask:0xf bank_mask:0xf
    v_add_f32_dpp v107, v80, v107 row_newbcast:7 row_mask:0xf bank_mask:0xf
    v_cvt_pk_bf16_f32 v124, v100, v101
    v_cvt_pk_bf16_f32 v125, v102, v103
    v_cvt_pk_bf16_f32 v126, v104, v105
    v_cvt_pk_bf16_f32 v127, v106, v107
    buffer_store_dwordx4 v[124:127], v8, s[32:35], s13 offen sc1
    v_cvt_pk_bf16_f32 v108, 0, v108
    v_cvt_pk_bf16_f32 v109, 0, v109
    v_cvt_pk_bf16_f32 v110, 0, v110
    v_cvt_pk_bf16_f32 v111, 0, v111
    v_cvt_pk_bf16_f32 v112, 0, v112
    v_cvt_pk_bf16_f32 v113, 0, v113
    v_cvt_pk_bf16_f32 v114, 0, v114
    v_cvt_pk_bf16_f32 v115, 0, v115
    v_pk_mul_f32 v[108:109], v[108:109], v[116:117] op_sel_hi:[1,0]
    v_pk_mul_f32 v[110:111], v[110:111], v[116:117] op_sel_hi:[1,0]
    v_pk_mul_f32 v[112:113], v[112:113], v[116:117] op_sel_hi:[1,0]
    v_pk_mul_f32 v[114:115], v[114:115], v[116:117] op_sel_hi:[1,0]
    v_cvt_pk_bf16_f32 v108, 0, v108
    v_cvt_pk_bf16_f32 v109, 0, v109
    v_cvt_pk_bf16_f32 v110, 0, v110
    v_cvt_pk_bf16_f32 v111, 0, v111
    v_cvt_pk_bf16_f32 v112, 0, v112
    v_cvt_pk_bf16_f32 v113, 0, v113
    v_cvt_pk_bf16_f32 v114, 0, v114
    v_cvt_pk_bf16_f32 v115, 0, v115
    v_mul_f32_dpp v108, v88, v108 row_newbcast:8 row_mask:0xf bank_mask:0xf
    v_mul_f32_dpp v109, v88, v109 row_newbcast:9 row_mask:0xf bank_mask:0xf
    v_mul_f32_dpp v110, v88, v110 row_newbcast:10 row_mask:0xf bank_mask:0xf
    v_mul_f32_dpp v111, v88, v111 row_newbcast:11 row_mask:0xf bank_mask:0xf
    v_mul_f32_dpp v112, v88, v112 row_newbcast:12 row_mask:0xf bank_mask:0xf
    v_mul_f32_dpp v113, v88, v113 row_newbcast:13 row_mask:0xf bank_mask:0xf
    v_mul_f32_dpp v114, v88, v114 row_newbcast:14 row_mask:0xf bank_mask:0xf
    v_mul_f32_dpp v115, v88, v115 row_newbcast:15 row_mask:0xf bank_mask:0xf
    v_cvt_pk_bf16_f32 v108, 0, v108
    v_cvt_pk_bf16_f32 v109, 0, v109
    v_cvt_pk_bf16_f32 v110, 0, v110
    v_cvt_pk_bf16_f32 v111, 0, v111
    v_cvt_pk_bf16_f32 v112, 0, v112
    v_cvt_pk_bf16_f32 v113, 0, v113
    v_cvt_pk_bf16_f32 v114, 0, v114
    v_cvt_pk_bf16_f32 v115, 0, v115
    v_add_f32_dpp v108, v80, v108 row_newbcast:8 row_mask:0xf bank_mask:0xf
    v_add_f32_dpp v109, v80, v109 row_newbcast:9 row_mask:0xf bank_mask:0xf
    v_add_f32_dpp v110, v80, v110 row_newbcast:10 row_mask:0xf bank_mask:0xf
    v_add_f32_dpp v111, v80, v111 row_newbcast:11 row_mask:0xf bank_mask:0xf
    v_add_f32_dpp v112, v80, v112 row_newbcast:12 row_mask:0xf bank_mask:0xf
    v_add_f32_dpp v113, v80, v113 row_newbcast:13 row_mask:0xf bank_mask:0xf
    v_add_f32_dpp v114, v80, v114 row_newbcast:14 row_mask:0xf bank_mask:0xf
    v_add_f32_dpp v115, v80, v115 row_newbcast:15 row_mask:0xf bank_mask:0xf
    v_cvt_pk_bf16_f32 v128, v108, v109
    v_cvt_pk_bf16_f32 v129, v110, v111
    v_cvt_pk_bf16_f32 v130, v112, v113
    v_cvt_pk_bf16_f32 v131, v114, v115
    buffer_store_dwordx4 v[128:131], v8, s[32:35], s13 offen offset:256 sc1
    v_lshrrev_b32 v66, 5, v1
    v_mul_u32_u24 v66, 2080, v66
    v_bfe_u32 v9, v1, 2, 2
    v_lshl_add_u32 v66, v9, 7, v66
    v_bfe_u32 v9, v1, 3, 1
    v_lshl_add_u32 v66, v9, 6, v66
    v_and_b32 v9, 3, v1
    v_lshl_add_u32 v66, v9, 3, v66
    v_bfe_u32 v67, v1, 4, 1
    v_mul_u32_u24 v67, 1056, v67
    v_bfe_u32 v68, v1, 3, 1
    v_lshlrev_b32 v68, 7, v68
    v_add_u32 v66, v66, v67
    v_sub_u32 v67, v66, v68
    v_add_u32 v67, 64, v67
    v_add_u32 v68, 49920, v66
    v_add_u32 v69, 49920, v67
    v_add_u32 v70, 99840, v66
    v_add_u32 v71, 99840, v67
    s_lshl_b32 s96, s76, 11
    s_add_u32 s14, s96, 156416
    v_bfe_u32 v4, v1, 2, 2
    v_lshl_add_u32 v4, v4, 6, s14
    v_bfe_u32 v9, v1, 4, 1
    v_lshl_add_u32 v4, v9, 5, v4
    v_and_b32 v9, 3, v1
    v_lshl_add_u32 v4, v9, 3, v4
    v_lshrrev_b32 v9, 5, v1
    v_lshl_add_u32 v4, v9, 9, v4
    v_and_b32 v5, 7, v1
    v_lshlrev_b32 v5, 12, v5
    v_bfe_u32 v9, v1, 3, 1
    v_lshl_add_u32 v5, v9, 19, v5
    s_and_b32 s96, s12, 1
    s_lshl_b32 s97, s21, 15
    s_lshr_b32 s98, s12, 1
    s_lshl_b32 s99, s98, 6
    s_add_u32 s98, s97, s99
    s_lshl2_add_u32 s97, s96, s98
    s_add_u32 s13, s97, 1048576
    v_bfe_u32 v6, v1, 4, 1
    v_lshlrev_b32 v6, 6, v6
    v_lshrrev_b32 v9, 5, v1
    v_lshl_add_u32 v6, v9, 4, v6
    v_and_b32 v74, 7, v1
    v_lshlrev_b32 v74, 4, v74
    v_xor_b32 v74, v74, v6
    v_lshrrev_b32 v6, 3, v1
    v_lshlrev_b32 v6, 11, v6
    v_add_u32 v74, v74, v6
    s_and_b32 s96, s3, 2
    s_lshl_b32 s14, s96, 5
    v_bfe_u32 v6, v1, 4, 1
    v_lshl_add_u32 v6, v6, 5, s14
    v_and_b32 v72, 7, v1
    v_lshlrev_b32 v72, 4, v72
    v_xor_b32 v72, v72, v6
    v_lshrrev_b32 v6, 3, v1
    v_mul_u32_u24 v6, 7168, v6
    v_add_u32 v72, v72, v6
    s_and_b32 s96, s3, 1
    s_lshl_b32 s14, s96, 7
    v_lshrrev_b32 v6, 5, v1
    v_lshl_add_u32 v6, v6, 6, s14
    v_and_b32 v73, 31, v1
    v_lshlrev_b32 v73, 4, v73
    v_lshrrev_b32 v9, 5, v1
    v_lshl_add_u32 v73, v9, 11, v73
    v_xor_b32 v73, v73, v6
    s_lshl3_add_u32 s96, s75, s3
    s_mul_i32 s97, s96, 229376
    s_lshl_b32 s98, s74, 7
    s_add_u32 s80, s97, s98
    s_lshl3_add_u32 s96, s74, s3
    s_lshl_b32 s97, s96, 14
    s_lshl_b32 s98, s75, 9
    s_add_u32 s81, s97, s98
    s_cmp_ge_u32 s9, 28
    s_cselect_b32 s54, 0, s54
    s_cselect_b32 s58, 0, s58
    s_cselect_b32 s62, 0, s62
    s_waitcnt vmcnt(0)
    s_barrier
    s_cmp_lg_u32 s3, 0
    s_cbranch_scc1 L_PB
    v_mov_b32 v6, s4
    s_mov_b32 exec_hi, 0
    s_mov_b32 exec_lo, 65535
    buffer_store_dword v6, v5, s[32:35], s13 offen sc1
    s_mov_b64 exec, -1
L_PB:
    s_and_b32 s20, s9, 3
    s_cmp_le_u32 s20, 0
    s_cselect_b32 s20, 1, 0
    s_add_u32 s96, s20, s85
    s_and_b32 s97, s96, 15
    s_lshl3_add_u32 s98, s97, s3
    s_mul_i32 s99, s98, 49152
    s_lshl_b32 s96, s11, 7
    s_add_u32 s82, s99, s96
    s_mul_i32 s96, s20, 24960
    s_lshr_b32 s97, s3, 1
    s_mul_i32 s98, s97, 2080
    s_add_u32 s99, s96, s98
    s_and_b32 s97, s3, 1
    s_mul_i32 s96, s97, 1056
    s_add_u32 s20, s99, s96
    s_mov_b32 m0, s20
    s_nop 0
    buffer_load_dwordx4 v62, s[40:43], s82 offen lds
    s_add_u32 s82, s82, 2048
    s_add_u32 m0, s20, 8320
    s_nop 0
    buffer_load_dwordx4 v62, s[40:43], s82 offen lds
    s_add_u32 s82, s82, 2048
    s_add_u32 m0, s20, 16640
    s_nop 0
    buffer_load_dwordx4 v62, s[40:43], s82 offen lds
    s_and_b32 s20, s9, 3
    s_cmp_le_u32 s20, 1
    s_cselect_b32 s20, 2, 1
    s_add_u32 s96, s20, s85
    s_and_b32 s97, s96, 15
    s_lshl3_add_u32 s98, s97, s3
    s_mul_i32 s99, s98, 49152
    s_lshl_b32 s96, s11, 7
    s_add_u32 s82, s99, s96
    s_mul_i32 s96, s20, 24960
    s_lshr_b32 s97, s3, 1
    s_mul_i32 s98, s97, 2080
    s_add_u32 s99, s96, s98
    s_and_b32 s97, s3, 1
    s_mul_i32 s96, s97, 1056
    s_add_u32 s20, s99, s96
    s_mov_b32 m0, s20
    s_nop 0
    buffer_load_dwordx4 v62, s[40:43], s82 offen lds
    s_add_u32 s82, s82, 2048
    s_add_u32 m0, s20, 8320
    s_nop 0
    buffer_load_dwordx4 v62, s[40:43], s82 offen lds
    s_add_u32 s82, s82, 2048
    s_add_u32 m0, s20, 16640
    s_nop 0
    buffer_load_dwordx4 v62, s[40:43], s82 offen lds
    ds_read_b64_tr_b16 v[28:29], v4
    ds_read_b64_tr_b16 v[30:31], v4 offset:256
    ds_read_b64_tr_b16 v[32:33], v4 offset:1024
    ds_read_b64_tr_b16 v[34:35], v4 offset:1280
    s_lshl_b32 s96, s10, 6
    s_add_u32 s97, s96, s3
    s_lshl_b32 s98, s97, 12
    s_add_u32 s15, s98, 4194304
    s_and_b32 s96, s3, 3
    s_lshl_b32 s97, s96, 12
    s_add_u32 s13, s97, 147456
    v_add_u32 v76, s13, v2
    v_and_b32 v77, 15, v1
    v_lshl_add_u32 v77, v77, 4, s13
    v_lshrrev_b32 v9, 5, v1
    v_lshl_add_u32 v77, v9, 9, v77
    v_bfe_u32 v9, v1, 4, 1
    v_lshl_add_u32 v77, v9, 3, v77
    s_and_b32 s96, s3, 3
    s_lshl_b32 s97, s96, 10
    s_add_u32 s13, s97, 32768
    v_and_b32 v78, 15, v1
    v_lshl_add_u32 v78, v78, 5, s13
    v_lshrrev_b32 v9, 4, v1
    v_lshl_add_u32 v78, v9, 3, v78
    s_and_b32 s96, s3, 3
    s_lshl_b32 s97, s96, 10
    s_lshl_b32 s98, s76, 14
    s_add_u32 s13, s97, s98
    v_and_b32 v75, 31, v1
    v_lshl_add_u32 v75, v75, 5, s13
    v_lshrrev_b32 v9, 5, v1
    v_lshl_add_u32 v75, v9, 4, v75
    s_lshl_b32 s84, s3, 14
    s_lshr_b32 s96, s9, 4
    s_lshl_b32 s97, s96, 20
    s_lshl_b32 s98, s12, 7
    s_add_u32 s88, s97, s98
    s_lshl_b32 s89, s3, 10
    s_load_dwordx2 s[24:25], s[32:33], s92 offset:0 glc
    s_and_b32 s20, s9, 3
    s_cmp_le_u32 s20, 2
    s_cselect_b32 s20, 3, 2
    s_add_u32 s96, s20, s85
    s_and_b32 s97, s96, 15
    s_lshl3_add_u32 s98, s97, s3
    s_mul_i32 s99, s98, 49152
    s_lshl_b32 s96, s11, 7
    s_add_u32 s82, s99, s96
    s_mul_i32 s96, s20, 24960
    s_lshr_b32 s97, s3, 1
    s_mul_i32 s98, s97, 2080
    s_add_u32 s99, s96, s98
    s_and_b32 s97, s3, 1
    s_mul_i32 s96, s97, 1056
    s_add_u32 s20, s99, s96
    s_mov_b32 m0, s20
    s_nop 0
    buffer_load_dwordx4 v62, s[40:43], s82 offen lds
    s_add_u32 s82, s82, 2048
    s_add_u32 m0, s20, 8320
    s_nop 0
    buffer_load_dwordx4 v62, s[40:43], s82 offen lds
    s_add_u32 s82, s82, 2048
    s_add_u32 m0, s20, 16640
    s_nop 0
    buffer_load_dwordx4 v62, s[40:43], s82 offen lds
    s_add_u32 s96, s85, 4
    s_and_b32 s97, s96, 15
    s_lshl3_add_u32 s98, s97, s3
    s_mul_i32 s99, s98, 49152
    s_lshl_b32 s96, s11, 7
    s_add_u32 s82, s99, s96
    s_lshr_b32 s96, s3, 1
    s_mul_i32 s97, s96, 2080
    s_and_b32 s98, s3, 1
    s_mul_i32 s99, s98, 1056
    s_add_u32 s96, s97, s99
    s_add_u32 s20, s96, 99840
    s_mov_b32 m0, s20
    s_nop 0
    buffer_load_dwordx4 v62, s[40:43], s82 offen lds
    s_add_u32 s82, s82, 2048
    s_add_u32 m0, s20, 8320
    s_nop 0
    buffer_load_dwordx4 v62, s[40:43], s82 offen lds
    s_add_u32 s82, s82, 2048
    s_add_u32 m0, s20, 16640
    s_nop 0
    buffer_load_dwordx4 v62, s[40:43], s82 offen lds
    s_branch SCHK_12
SPOLL_11:
    s_load_dwordx2 s[24:25], s[32:33], s92 offset:0 glc
SCHK_12:
    s_add_u32 s5, s5, 1
    s_cmp_ge_u32 s5, 300000
    s_waitcnt lgkmcnt(0)
    s_cbranch_scc1 SDONE_13
    s_cmp_lg_u32 s24, s4
    s_cbranch_scc1 SPOLL_11
    s_cmp_lg_u32 s25, s4
    s_cbranch_scc1 SPOLL_11
SDONE_13:
    s_waitcnt vmcnt(9)
    s_barrier
    s_cmp_ge_u32 s3, 4
    s_cbranch_scc1 L_HELP
    s_setprio 2
    s_and_b32 s96, s85, 15
    s_lshl_b32 s97, s96, 14
    s_add_u32 s16, s97, s15
    buffer_load_dwordx4 v[176:179], v2, s[32:35], s16 offen sc1
    buffer_load_dwordx4 v[180:183], v2, s[32:35], s16 offen offset:1024 sc1
    ds_read_b64_tr_b16 v[224:225], v67 offset:8320
    ds_read_b64_tr_b16 v[226:227], v67 offset:8832
    ds_read_b64_tr_b16 v[228:229], v67 offset:8352
    ds_read_b64_tr_b16 v[230:231], v67 offset:8864
    ds_read_b64_tr_b16 v[232:233], v66 offset:8320
    ds_read_b64_tr_b16 v[234:235], v66 offset:8832
    ds_read_b64_tr_b16 v[236:237], v66 offset:8352
    ds_read_b64_tr_b16 v[238:239], v66 offset:8864
    ds_read_b64_tr_b16 v[240:241], v66
    ds_read_b64_tr_b16 v[242:243], v66 offset:512
    ds_read_b64_tr_b16 v[244:245], v66 offset:32
    ds_read_b64_tr_b16 v[246:247], v66 offset:544
    buffer_load_dwordx4 v[184:187], v2, s[32:35], s16 offen offset:2048 sc1
    buffer_load_dwordx4 v[188:191], v2, s[32:35], s16 offen offset:3072 sc1
    s_waitcnt lgkmcnt(8)
    s_waitcnt vmcnt(3)
    v_mfma_f32_16x16x32_bf16 v[128:131], v[224:227], v[176:179], 0
    ds_read_b64_tr_b16 v[248:249], v67
    s_waitcnt vmcnt(2)
    v_mfma_f32_16x16x32_bf16 v[132:135], v[224:227], v[180:183], 0
    ds_read_b64_tr_b16 v[250:251], v67 offset:512
    s_add_u32 s96, s85, 1
    s_and_b32 s97, s96, 15
    s_lshl_b32 s98, s97, 14
    s_add_u32 s16, s98, s15
    buffer_load_dwordx4 v[192:195], v2, s[32:35], s16 offen sc1
    v_mfma_f32_16x16x32_bf16 v[136:139], v[228:231], v[176:179], 0
    ds_read_b64_tr_b16 v[224:225], v67 offset:32
    v_mfma_f32_16x16x32_bf16 v[140:143], v[228:231], v[180:183], 0
    ds_read_b64_tr_b16 v[226:227], v67 offset:544
    s_waitcnt lgkmcnt(8)
    v_mfma_f32_16x16x32_bf16 v[112:115], v[232:235], v[176:179], 0
    ds_read_b64_tr_b16 v[228:229], v66 offset:16640
    v_mfma_f32_16x16x32_bf16 v[116:119], v[232:235], v[180:183], 0
    ds_read_b64_tr_b16 v[230:231], v66 offset:17152
    v_mfma_f32_16x16x32_bf16 v[120:123], v[236:239], v[176:179], 0
    ds_read_b64_tr_b16 v[232:233], v66 offset:16672
    v_mfma_f32_16x16x32_bf16 v[124:127], v[236:239], v[180:183], 0
    ds_read_b64_tr_b16 v[234:235], v66 offset:17184
    buffer_load_dwordx4 v[196:199], v2, s[32:35], s16 offen offset:1024 sc1
    s_waitcnt lgkmcnt(8)
    v_mfma_f32_16x16x32_bf16 v[80:83], v[240:243], v[176:179], 0
    ds_read_b64_tr_b16 v[236:237], v67 offset:16640
    v_mfma_f32_16x16x32_bf16 v[84:87], v[240:243], v[180:183], 0
    ds_read_b64_tr_b16 v[238:239], v67 offset:17152
    v_mfma_f32_16x16x32_bf16 v[88:91], v[244:247], v[176:179], 0
    ds_read_b64_tr_b16 v[240:241], v67 offset:16672
    v_mfma_f32_16x16x32_bf16 v[92:95], v[244:247], v[180:183], 0
    ds_read_b64_tr_b16 v[242:243], v67 offset:17184
    s_waitcnt lgkmcnt(8)
    v_mfma_f32_16x16x32_bf16 v[96:99], v[248:251], v[176:179], 0
    ds_read_b64_tr_b16 v[244:245], v67 offset:12480
    v_mfma_f32_16x16x32_bf16 v[100:103], v[248:251], v[180:183], 0
    ds_read_b64_tr_b16 v[246:247], v67 offset:12992
    buffer_load_dwordx4 v[200:203], v2, s[32:35], s16 offen offset:2048 sc1
    v_mfma_f32_16x16x32_bf16 v[104:107], v[224:227], v[176:179], 0
    ds_read_b64_tr_b16 v[248:249], v67 offset:12512
    v_mfma_f32_16x16x32_bf16 v[108:111], v[224:227], v[180:183], 0
    ds_read_b64_tr_b16 v[250:251], v67 offset:13024
    s_waitcnt lgkmcnt(8)
    v_mfma_f32_16x16x32_bf16 v[144:147], v[228:231], v[176:179], 0
    ds_read_b64_tr_b16 v[224:225], v66 offset:12480
    v_mfma_f32_16x16x32_bf16 v[148:151], v[228:231], v[180:183], 0
    ds_read_b64_tr_b16 v[226:227], v66 offset:12992
    v_mfma_f32_16x16x32_bf16 v[152:155], v[232:235], v[176:179], 0
    ds_read_b64_tr_b16 v[228:229], v66 offset:12512
    v_mfma_f32_16x16x32_bf16 v[156:159], v[232:235], v[180:183], 0
    ds_read_b64_tr_b16 v[230:231], v66 offset:13024
    buffer_load_dwordx4 v[204:207], v2, s[32:35], s16 offen offset:3072 sc1
    s_waitcnt lgkmcnt(8)
    v_mfma_f32_16x16x32_bf16 v[160:163], v[236:239], v[176:179], 0
    ds_read_b64_tr_b16 v[232:233], v66 offset:4160
    v_mfma_f32_16x16x32_bf16 v[164:167], v[236:239], v[180:183], 0
    ds_read_b64_tr_b16 v[234:235], v66 offset:4672
    v_mfma_f32_16x16x32_bf16 v[168:171], v[240:243], v[176:179], 0
    ds_read_b64_tr_b16 v[236:237], v66 offset:4192
    v_mfma_f32_16x16x32_bf16 v[172:175], v[240:243], v[180:183], 0
    ds_read_b64_tr_b16 v[238:239], v66 offset:4704
    s_waitcnt lgkmcnt(8)
    s_waitcnt vmcnt(5)
    v_mfma_f32_16x16x32_bf16 v[128:131], v[244:247], v[184:187], v[128:131]
    ds_read_b64_tr_b16 v[240:241], v67 offset:4160
    s_waitcnt vmcnt(4)
    v_mfma_f32_16x16x32_bf16 v[132:135], v[244:247], v[188:191], v[132:135]
    ds_read_b64_tr_b16 v[242:243], v67 offset:4672
    s_add_u32 s96, s85, 2
    s_and_b32 s97, s96, 15
    s_lshl_b32 s98, s97, 14
    s_add_u32 s16, s98, s15
    buffer_load_dwordx4 v[208:211], v2, s[32:35], s16 offen sc1
    v_mfma_f32_16x16x32_bf16 v[136:139], v[248:251], v[184:187], v[136:139]
    ds_read_b64_tr_b16 v[244:245], v67 offset:4192
    v_mfma_f32_16x16x32_bf16 v[140:143], v[248:251], v[188:191], v[140:143]
    ds_read_b64_tr_b16 v[246:247], v67 offset:4704
    s_waitcnt lgkmcnt(8)
    v_mfma_f32_16x16x32_bf16 v[112:115], v[224:227], v[184:187], v[112:115]
    ds_read_b64_tr_b16 v[248:249], v66 offset:20800
    v_mfma_f32_16x16x32_bf16 v[116:119], v[224:227], v[188:191], v[116:119]
    ds_read_b64_tr_b16 v[250:251], v66 offset:21312
    v_mfma_f32_16x16x32_bf16 v[120:123], v[228:231], v[184:187], v[120:123]
    ds_read_b64_tr_b16 v[224:225], v66 offset:20832
    v_mfma_f32_16x16x32_bf16 v[124:127], v[228:231], v[188:191], v[124:127]
    ds_read_b64_tr_b16 v[226:227], v66 offset:21344
    buffer_load_dwordx4 v[212:215], v2, s[32:35], s16 offen offset:1024 sc1
    s_waitcnt lgkmcnt(8)
    v_mfma_f32_16x16x32_bf16 v[80:83], v[232:235], v[184:187], v[80:83]
    ds_read_b64_tr_b16 v[228:229], v67 offset:20800
    v_mfma_f32_16x16x32_bf16 v[84:87], v[232:235], v[188:191], v[84:87]
    ds_read_b64_tr_b16 v[230:231], v67 offset:21312
    v_mfma_f32_16x16x32_bf16 v[88:91], v[236:239], v[184:187], v[88:91]
    ds_read_b64_tr_b16 v[232:233], v67 offset:20832
    v_mfma_f32_16x16x32_bf16 v[92:95], v[236:239], v[188:191], v[92:95]
    ds_read_b64_tr_b16 v[234:235], v67 offset:21344
    s_waitcnt lgkmcnt(8)
    v_mfma_f32_16x16x32_bf16 v[96:99], v[240:243], v[184:187], v[96:99]
    s_barrier
    ds_read_b64_tr_b16 v[236:237], v67 offset:33280
    v_mfma_f32_16x16x32_bf16 v[100:103], v[240:243], v[188:191], v[100:103]
    ds_read_b64_tr_b16 v[238:239], v67 offset:33792
    buffer_load_dwordx4 v[216:219], v2, s[32:35], s16 offen offset:2048 sc1
    v_mfma_f32_16x16x32_bf16 v[104:107], v[244:247], v[184:187], v[104:107]
    ds_read_b64_tr_b16 v[240:241], v67 offset:33312
    v_mfma_f32_16x16x32_bf16 v[108:111], v[244:247], v[188:191], v[108:111]
    ds_read_b64_tr_b16 v[242:243], v67 offset:33824
    s_waitcnt lgkmcnt(8)
    v_mfma_f32_16x16x32_bf16 v[144:147], v[248:251], v[184:187], v[144:147]
    ds_read_b64_tr_b16 v[244:245], v66 offset:33280
    v_mfma_f32_16x16x32_bf16 v[148:151], v[248:251], v[188:191], v[148:151]
    ds_read_b64_tr_b16 v[246:247], v66 offset:33792
    v_mfma_f32_16x16x32_bf16 v[152:155], v[224:227], v[184:187], v[152:155]
    ds_read_b64_tr_b16 v[248:249], v66 offset:33312
    v_mfma_f32_16x16x32_bf16 v[156:159], v[224:227], v[188:191], v[156:159]
    ds_read_b64_tr_b16 v[250:251], v66 offset:33824
    buffer_load_dwordx4 v[220:223], v2, s[32:35], s16 offen offset:3072 sc1
    s_waitcnt lgkmcnt(8)
    v_mfma_f32_16x16x32_bf16 v[160:163], v[228:231], v[184:187], v[160:163]
    ds_read_b64_tr_b16 v[224:225], v66 offset:24960
    v_mfma_f32_16x16x32_bf16 v[164:167], v[228:231], v[188:191], v[164:167]
    ds_read_b64_tr_b16 v[226:227], v66 offset:25472
    v_mfma_f32_16x16x32_bf16 v[168:171], v[232:235], v[184:187], v[168:171]
    ds_read_b64_tr_b16 v[228:229], v66 offset:24992
    v_mfma_f32_16x16x32_bf16 v[172:175], v[232:235], v[188:191], v[172:175]
    ds_read_b64_tr_b16 v[230:231], v66 offset:25504
    s_waitcnt lgkmcnt(8)
    s_waitcnt vmcnt(7)
    v_mfma_f32_16x16x32_bf16 v[128:131], v[236:239], v[192:195], v[128:131]
    ds_read_b64_tr_b16 v[232:233], v67 offset:24960
    s_waitcnt vmcnt(6)
    v_mfma_f32_16x16x32_bf16 v[132:135], v[236:239], v[196:199], v[132:135]
    ds_read_b64_tr_b16 v[234:235], v67 offset:25472
    s_add_u32 s96, s85, 3
    s_and_b32 s97, s96, 15
    s_lshl_b32 s98, s97, 14
    s_add_u32 s16, s98, s15
    buffer_load_dwordx4 v[176:179], v2, s[32:35], s16 offen sc1
    v_mfma_f32_16x16x32_bf16 v[136:139], v[240:243], v[192:195], v[136:139]
    ds_read_b64_tr_b16 v[236:237], v67 offset:24992
    v_mfma_f32_16x16x32_bf16 v[140:143], v[240:243], v[196:199], v[140:143]
    ds_read_b64_tr_b16 v[238:239], v67 offset:25504
    s_waitcnt lgkmcnt(8)
    v_mfma_f32_16x16x32_bf16 v[112:115], v[244:247], v[192:195], v[112:115]
    ds_read_b64_tr_b16 v[240:241], v66 offset:41600
    v_mfma_f32_16x16x32_bf16 v[116:119], v[244:247], v[196:199], v[116:119]
    ds_read_b64_tr_b16 v[242:243], v66 offset:42112
    v_mfma_f32_16x16x32_bf16 v[120:123], v[248:251], v[192:195], v[120:123]
    ds_read_b64_tr_b16 v[244:245], v66 offset:41632
    v_mfma_f32_16x16x32_bf16 v[124:127], v[248:251], v[196:199], v[124:127]
    ds_read_b64_tr_b16 v[246:247], v66 offset:42144
    buffer_load_dwordx4 v[180:183], v2, s[32:35], s16 offen offset:1024 sc1
    s_waitcnt lgkmcnt(8)
    v_mfma_f32_16x16x32_bf16 v[80:83], v[224:227], v[192:195], v[80:83]
    ds_read_b64_tr_b16 v[248:249], v67 offset:41600
    v_mfma_f32_16x16x32_bf16 v[84:87], v[224:227], v[196:199], v[84:87]
    ds_read_b64_tr_b16 v[250:251], v67 offset:42112
    v_mfma_f32_16x16x32_bf16 v[88:91], v[228:231], v[192:195], v[88:91]
    ds_read_b64_tr_b16 v[224:225], v67 offset:41632
    v_mfma_f32_16x16x32_bf16 v[92:95], v[228:231], v[196:199], v[92:95]
    ds_read_b64_tr_b16 v[226:227], v67 offset:42144
    s_waitcnt lgkmcnt(8)
    v_mfma_f32_16x16x32_bf16 v[96:99], v[232:235], v[192:195], v[96:99]
    ds_read_b64_tr_b16 v[228:229], v67 offset:37440
    v_mfma_f32_16x16x32_bf16 v[100:103], v[232:235], v[196:199], v[100:103]
    ds_read_b64_tr_b16 v[230:231], v67 offset:37952
    buffer_load_dwordx4 v[184:187], v2, s[32:35], s16 offen offset:2048 sc1
    v_mfma_f32_16x16x32_bf16 v[104:107], v[236:239], v[192:195], v[104:107]
    ds_read_b64_tr_b16 v[232:233], v67 offset:37472
    v_mfma_f32_16x16x32_bf16 v[108:111], v[236:239], v[196:199], v[108:111]
    ds_read_b64_tr_b16 v[234:235], v67 offset:37984
    s_waitcnt lgkmcnt(8)
    v_mfma_f32_16x16x32_bf16 v[144:147], v[240:243], v[192:195], v[144:147]
    ds_read_b64_tr_b16 v[236:237], v66 offset:37440
    v_mfma_f32_16x16x32_bf16 v[148:151], v[240:243], v[196:199], v[148:151]
    ds_read_b64_tr_b16 v[238:239], v66 offset:37952
    v_mfma_f32_16x16x32_bf16 v[152:155], v[244:247], v[192:195], v[152:155]
    ds_read_b64_tr_b16 v[240:241], v66 offset:37472
    v_mfma_f32_16x16x32_bf16 v[156:159], v[244:247], v[196:199], v[156:159]
    ds_read_b64_tr_b16 v[242:243], v66 offset:37984
    buffer_load_dwordx4 v[188:191], v2, s[32:35], s16 offen offset:3072 sc1
    s_waitcnt lgkmcnt(8)
    v_mfma_f32_16x16x32_bf16 v[160:163], v[248:251], v[192:195], v[160:163]
    ds_read_b64_tr_b16 v[244:245], v66 offset:29120
    v_mfma_f32_16x16x32_bf16 v[164:167], v[248:251], v[196:199], v[164:167]
    ds_read_b64_tr_b16 v[246:247], v66 offset:29632
    v_mfma_f32_16x16x32_bf16 v[168:171], v[224:227], v[192:195], v[168:171]
    ds_read_b64_tr_b16 v[248:249], v66 offset:29152
    v_mfma_f32_16x16x32_bf16 v[172:175], v[224:227], v[196:199], v[172:175]
    ds_read_b64_tr_b16 v[250:251], v66 offset:29664
    s_waitcnt lgkmcnt(8)
    s_waitcnt vmcnt(9)
    v_mfma_f32_16x16x32_bf16 v[128:131], v[228:231], v[200:203], v[128:131]
    ds_read_b64_tr_b16 v[224:225], v67 offset:29120
    s_waitcnt vmcnt(8)
    v_mfma_f32_16x16x32_bf16 v[132:135], v[228:231], v[204:207], v[132:135]
    ds_read_b64_tr_b16 v[226:227], v67 offset:29632
    s_add_u32 s96, s85, 4
    s_and_b32 s97, s96, 15
    s_lshl_b32 s98, s97, 14
    s_add_u32 s16, s98, s15
    buffer_load_dwordx4 v[192:195], v2, s[32:35], s16 offen sc1
    v_mfma_f32_16x16x32_bf16 v[136:139], v[232:235], v[200:203], v[136:139]
    ds_read_b64_tr_b16 v[228:229], v67 offset:29152
    v_mfma_f32_16x16x32_bf16 v[140:143], v[232:235], v[204:207], v[140:143]
    ds_read_b64_tr_b16 v[230:231], v67 offset:29664
    s_waitcnt lgkmcnt(8)
    v_mfma_f32_16x16x32_bf16 v[112:115], v[236:239], v[200:203], v[112:115]
    ds_read_b64_tr_b16 v[232:233], v66 offset:45760
    v_mfma_f32_16x16x32_bf16 v[116:119], v[236:239], v[204:207], v[116:119]
    ds_read_b64_tr_b16 v[234:235], v66 offset:46272
    v_mfma_f32_16x16x32_bf16 v[120:123], v[240:243], v[200:203], v[120:123]
    ds_read_b64_tr_b16 v[236:237], v66 offset:45792
    v_mfma_f32_16x16x32_bf16 v[124:127], v[240:243], v[204:207], v[124:127]
    ds_read_b64_tr_b16 v[238:239], v66 offset:46304
    buffer_load_dwordx4 v[196:199], v2, s[32:35], s16 offen offset:1024 sc1
    s_waitcnt lgkmcnt(8)
    v_mfma_f32_16x16x32_bf16 v[80:83], v[244:247], v[200:203], v[80:83]
    ds_read_b64_tr_b16 v[240:241], v67 offset:45760
    v_mfma_f32_16x16x32_bf16 v[84:87], v[244:247], v[204:207], v[84:87]
    ds_read_b64_tr_b16 v[242:243], v67 offset:46272
    v_mfma_f32_16x16x32_bf16 v[88:91], v[248:251], v[200:203], v[88:91]
    ds_read_b64_tr_b16 v[244:245], v67 offset:45792
    v_mfma_f32_16x16x32_bf16 v[92:95], v[248:251], v[204:207], v[92:95]
    ds_read_b64_tr_b16 v[246:247], v67 offset:46304
    s_waitcnt lgkmcnt(8)
    v_mfma_f32_16x16x32_bf16 v[96:99], v[224:227], v[200:203], v[96:99]
    s_barrier
    ds_read_b64_tr_b16 v[248:249], v69 offset:8320
    v_mfma_f32_16x16x32_bf16 v[100:103], v[224:227], v[204:207], v[100:103]
    ds_read_b64_tr_b16 v[250:251], v69 offset:8832
    v_mfma_f32_16x16x32_bf16 v[104:107], v[228:231], v[200:203], v[104:107]
    ds_read_b64_tr_b16 v[224:225], v69 offset:8352
    v_mfma_f32_16x16x32_bf16 v[108:111], v[228:231], v[204:207], v[108:111]
    ds_read_b64_tr_b16 v[226:227], v69 offset:8864
    s_waitcnt lgkmcnt(8)
    v_mfma_f32_16x16x32_bf16 v[144:147], v[232:235], v[200:203], v[144:147]
    ds_read_b64_tr_b16 v[228:229], v68 offset:8320
    v_mfma_f32_16x16x32_bf16 v[148:151], v[232:235], v[204:207], v[148:151]
    ds_read_b64_tr_b16 v[230:231], v68 offset:8832
    v_mfma_f32_16x16x32_bf16 v[152:155], v[236:239], v[200:203], v[152:155]
    ds_read_b64_tr_b16 v[232:233], v68 offset:8352
    v_mfma_f32_16x16x32_bf16 v[156:159], v[236:239], v[204:207], v[156:159]
    ds_read_b64_tr_b16 v[234:235], v68 offset:8864
    s_waitcnt lgkmcnt(8)
    v_mfma_f32_16x16x32_bf16 v[160:163], v[240:243], v[200:203], v[160:163]
    ds_read_b64_tr_b16 v[236:237], v68
    v_mfma_f32_16x16x32_bf16 v[164:167], v[240:243], v[204:207], v[164:167]
    ds_read_b64_tr_b16 v[238:239], v68 offset:512
    v_mfma_f32_16x16x32_bf16 v[168:171], v[244:247], v[200:203], v[168:171]
    ds_read_b64_tr_b16 v[240:241], v68 offset:32
    v_mfma_f32_16x16x32_bf16 v[172:175], v[244:247], v[204:207], v[172:175]
    ds_read_b64_tr_b16 v[242:243], v68 offset:544
    s_waitcnt lgkmcnt(8)
    s_waitcnt vmcnt(9)
    v_mfma_f32_16x16x32_bf16 v[128:131], v[248:251], v[208:211], v[128:131]
    ds_read_b64_tr_b16 v[244:245], v69
    s_waitcnt vmcnt(8)
    v_mfma_f32_16x16x32_bf16 v[132:135], v[248:251], v[212:215], v[132:135]
    ds_read_b64_tr_b16 v[246:247], v69 offset:512
    buffer_load_dwordx4 v[200:203], v2, s[32:35], s16 offen offset:2048 sc1
    v_mfma_f32_16x16x32_bf16 v[136:139], v[224:227], v[208:211], v[136:139]
    ds_read_b64_tr_b16 v[248:249], v69 offset:32
    v_mfma_f32_16x16x32_bf16 v[140:143], v[224:227], v[212:215], v[140:143]
    ds_read_b64_tr_b16 v[250:251], v69 offset:544
    s_waitcnt lgkmcnt(8)
    v_mfma_f32_16x16x32_bf16 v[112:115], v[228:231], v[208:211], v[112:115]
    ds_read_b64_tr_b16 v[224:225], v68 offset:16640
    v_mfma_f32_16x16x32_bf16 v[116:119], v[228:231], v[212:215], v[116:119]
    ds_read_b64_tr_b16 v[226:227], v68 offset:17152
    v_mfma_f32_16x16x32_bf16 v[120:123], v[232:235], v[208:211], v[120:123]
    ds_read_b64_tr_b16 v[228:229], v68 offset:16672
    v_mfma_f32_16x16x32_bf16 v[124:127], v[232:235], v[212:215], v[124:127]
    ds_read_b64_tr_b16 v[230:231], v68 offset:17184
    buffer_load_dwordx4 v[204:207], v2, s[32:35], s16 offen offset:3072 sc1
    s_waitcnt lgkmcnt(8)
    v_mfma_f32_16x16x32_bf16 v[80:83], v[236:239], v[208:211], v[80:83]
    ds_read_b64_tr_b16 v[232:233], v69 offset:16640
    v_mfma_f32_16x16x32_bf16 v[84:87], v[236:239], v[212:215], v[84:87]
    ds_read_b64_tr_b16 v[234:235], v69 offset:17152
    v_mfma_f32_16x16x32_bf16 v[88:91], v[240:243], v[208:211], v[88:91]
    ds_read_b64_tr_b16 v[236:237], v69 offset:16672
    v_mfma_f32_16x16x32_bf16 v[92:95], v[240:243], v[212:215], v[92:95]
    ds_read_b64_tr_b16 v[238:239], v69 offset:17184
    s_waitcnt lgkmcnt(8)
    v_mfma_f32_16x16x32_bf16 v[96:99], v[244:247], v[208:211], v[96:99]
    ds_read_b64_tr_b16 v[240:241], v69 offset:12480
    v_mfma_f32_16x16x32_bf16 v[100:103], v[244:247], v[212:215], v[100:103]
    ds_read_b64_tr_b16 v[242:243], v69 offset:12992
    v_mfma_f32_16x16x32_bf16 v[104:107], v[248:251], v[208:211], v[104:107]
    ds_read_b64_tr_b16 v[244:245], v69 offset:12512
    v_mfma_f32_16x16x32_bf16 v[108:111], v[248:251], v[212:215], v[108:111]
    ds_read_b64_tr_b16 v[246:247], v69 offset:13024
    s_waitcnt lgkmcnt(8)
    v_mfma_f32_16x16x32_bf16 v[144:147], v[224:227], v[208:211], v[144:147]
    ds_read_b64_tr_b16 v[248:249], v68 offset:12480
    v_mfma_f32_16x16x32_bf16 v[148:151], v[224:227], v[212:215], v[148:151]
    ds_read_b64_tr_b16 v[250:251], v68 offset:12992
    v_mfma_f32_16x16x32_bf16 v[152:155], v[228:231], v[208:211], v[152:155]
    ds_read_b64_tr_b16 v[224:225], v68 offset:12512
    v_mfma_f32_16x16x32_bf16 v[156:159], v[228:231], v[212:215], v[156:159]
    ds_read_b64_tr_b16 v[226:227], v68 offset:13024
    s_waitcnt lgkmcnt(8)
    v_mfma_f32_16x16x32_bf16 v[160:163], v[232:235], v[208:211], v[160:163]
    ds_read_b64_tr_b16 v[228:229], v68 offset:4160
    v_mfma_f32_16x16x32_bf16 v[164:167], v[232:235], v[212:215], v[164:167]
    ds_read_b64_tr_b16 v[230:231], v68 offset:4672
    v_mfma_f32_16x16x32_bf16 v[168:171], v[236:239], v[208:211], v[168:171]
    ds_read_b64_tr_b16 v[232:233], v68 offset:4192
    v_mfma_f32_16x16x32_bf16 v[172:175], v[236:239], v[212:215], v[172:175]
    ds_read_b64_tr_b16 v[234:235], v68 offset:4704
    s_waitcnt lgkmcnt(8)
    s_waitcnt vmcnt(9)
    v_mfma_f32_16x16x32_bf16 v[128:131], v[240:243], v[216:219], v[128:131]
    ds_read_b64_tr_b16 v[236:237], v69 offset:4160
    s_waitcnt vmcnt(8)
    v_mfma_f32_16x16x32_bf16 v[132:135], v[240:243], v[220:223], v[132:135]
    ds_read_b64_tr_b16 v[238:239], v69 offset:4672
    s_add_u32 s96, s85, 5
    s_and_b32 s97, s96, 15
    s_lshl_b32 s98, s97, 14
    s_add_u32 s16, s98, s15
    buffer_load_dwordx4 v[208:211], v2, s[32:35], s16 offen sc1
    v_mfma_f32_16x16x32_bf16 v[136:139], v[244:247], v[216:219], v[136:139]
    ds_read_b64_tr_b16 v[240:241], v69 offset:4192
    v_mfma_f32_16x16x32_bf16 v[140:143], v[244:247], v[220:223], v[140:143]
    ds_read_b64_tr_b16 v[242:243], v69 offset:4704
    s_waitcnt lgkmcnt(8)
    v_mfma_f32_16x16x32_bf16 v[112:115], v[248:251], v[216:219], v[112:115]
    ds_read_b64_tr_b16 v[244:245], v68 offset:20800
    v_mfma_f32_16x16x32_bf16 v[116:119], v[248:251], v[220:223], v[116:119]
    ds_read_b64_tr_b16 v[246:247], v68 offset:21312
    v_mfma_f32_16x16x32_bf16 v[120:123], v[224:227], v[216:219], v[120:123]
    ds_read_b64_tr_b16 v[248:249], v68 offset:20832
    v_mfma_f32_16x16x32_bf16 v[124:127], v[224:227], v[220:223], v[124:127]
    ds_read_b64_tr_b16 v[250:251], v68 offset:21344
    buffer_load_dwordx4 v[212:215], v2, s[32:35], s16 offen offset:1024 sc1
    s_waitcnt lgkmcnt(8)
    v_mfma_f32_16x16x32_bf16 v[80:83], v[228:231], v[216:219], v[80:83]
    ds_read_b64_tr_b16 v[224:225], v69 offset:20800
    v_mfma_f32_16x16x32_bf16 v[84:87], v[228:231], v[220:223], v[84:87]
    ds_read_b64_tr_b16 v[226:227], v69 offset:21312
    v_mfma_f32_16x16x32_bf16 v[88:91], v[232:235], v[216:219], v[88:91]
    ds_read_b64_tr_b16 v[228:229], v69 offset:20832
    v_mfma_f32_16x16x32_bf16 v[92:95], v[232:235], v[220:223], v[92:95]
    ds_read_b64_tr_b16 v[230:231], v69 offset:21344
    s_waitcnt lgkmcnt(8)
    v_mfma_f32_16x16x32_bf16 v[96:99], v[236:239], v[216:219], v[96:99]
    s_barrier
    ds_read_b64_tr_b16 v[232:233], v69 offset:33280
    v_mfma_f32_16x16x32_bf16 v[100:103], v[236:239], v[220:223], v[100:103]
    ds_read_b64_tr_b16 v[234:235], v69 offset:33792
    v_mfma_f32_16x16x32_bf16 v[104:107], v[240:243], v[216:219], v[104:107]
    ds_read_b64_tr_b16 v[236:237], v69 offset:33312
    v_mfma_f32_16x16x32_bf16 v[108:111], v[240:243], v[220:223], v[108:111]
    ds_read_b64_tr_b16 v[238:239], v69 offset:33824
    s_waitcnt lgkmcnt(8)
    v_mfma_f32_16x16x32_bf16 v[144:147], v[244:247], v[216:219], v[144:147]
    ds_read_b64_tr_b16 v[240:241], v68 offset:33280
    v_mfma_f32_16x16x32_bf16 v[148:151], v[244:247], v[220:223], v[148:151]
    ds_read_b64_tr_b16 v[242:243], v68 offset:33792
    v_mfma_f32_16x16x32_bf16 v[152:155], v[248:251], v[216:219], v[152:155]
    ds_read_b64_tr_b16 v[244:245], v68 offset:33312
    v_mfma_f32_16x16x32_bf16 v[156:159], v[248:251], v[220:223], v[156:159]
    ds_read_b64_tr_b16 v[246:247], v68 offset:33824
    s_waitcnt lgkmcnt(8)
    v_mfma_f32_16x16x32_bf16 v[160:163], v[224:227], v[216:219], v[160:163]
    ds_read_b64_tr_b16 v[248:249], v68 offset:24960
    v_mfma_f32_16x16x32_bf16 v[164:167], v[224:227], v[220:223], v[164:167]
    ds_read_b64_tr_b16 v[250:251], v68 offset:25472
    v_mfma_f32_16x16x32_bf16 v[168:171], v[228:231], v[216:219], v[168:171]
    ds_read_b64_tr_b16 v[224:225], v68 offset:24992
    v_mfma_f32_16x16x32_bf16 v[172:175], v[228:231], v[220:223], v[172:175]
    ds_read_b64_tr_b16 v[226:227], v68 offset:25504
    s_waitcnt lgkmcnt(8)
    s_waitcnt vmcnt(9)
    v_mfma_f32_16x16x32_bf16 v[128:131], v[232:235], v[176:179], v[128:131]
    ds_read_b64_tr_b16 v[228:229], v69 offset:24960
    s_waitcnt vmcnt(8)
    v_mfma_f32_16x16x32_bf16 v[132:135], v[232:235], v[180:183], v[132:135]
    ds_read_b64_tr_b16 v[230:231], v69 offset:25472
    buffer_load_dwordx4 v[216:219], v2, s[32:35], s16 offen offset:2048 sc1
    v_mfma_f32_16x16x32_bf16 v[136:139], v[236:239], v[176:179], v[136:139]
    ds_read_b64_tr_b16 v[232:233], v69 offset:24992
    v_mfma_f32_16x16x32_bf16 v[140:143], v[236:239], v[180:183], v[140:143]
    ds_read_b64_tr_b16 v[234:235], v69 offset:25504
    s_waitcnt lgkmcnt(8)
    v_mfma_f32_16x16x32_bf16 v[112:115], v[240:243], v[176:179], v[112:115]
    ds_read_b64_tr_b16 v[236:237], v68 offset:41600
    v_mfma_f32_16x16x32_bf16 v[116:119], v[240:243], v[180:183], v[116:119]
    ds_read_b64_tr_b16 v[238:239], v68 offset:42112
    v_mfma_f32_16x16x32_bf16 v[120:123], v[244:247], v[176:179], v[120:123]
    ds_read_b64_tr_b16 v[240:241], v68 offset:41632
    v_mfma_f32_16x16x32_bf16 v[124:127], v[244:247], v[180:183], v[124:127]
    ds_read_b64_tr_b16 v[242:243], v68 offset:42144
    buffer_load_dwordx4 v[220:223], v2, s[32:35], s16 offen offset:3072 sc1
    s_waitcnt lgkmcnt(8)
    v_mfma_f32_16x16x32_bf16 v[80:83], v[248:251], v[176:179], v[80:83]
    ds_read_b64_tr_b16 v[244:245], v69 offset:41600
    v_mfma_f32_16x16x32_bf16 v[84:87], v[248:251], v[180:183], v[84:87]
    ds_read_b64_tr_b16 v[246:247], v69 offset:42112
    v_mfma_f32_16x16x32_bf16 v[88:91], v[224:227], v[176:179], v[88:91]
    ds_read_b64_tr_b16 v[248:249], v69 offset:41632
    v_mfma_f32_16x16x32_bf16 v[92:95], v[224:227], v[180:183], v[92:95]
    ds_read_b64_tr_b16 v[250:251], v69 offset:42144
    s_waitcnt lgkmcnt(8)
    v_mfma_f32_16x16x32_bf16 v[96:99], v[228:231], v[176:179], v[96:99]
    ds_read_b64_tr_b16 v[224:225], v69 offset:37440
    v_mfma_f32_16x16x32_bf16 v[100:103], v[228:231], v[180:183], v[100:103]
    ds_read_b64_tr_b16 v[226:227], v69 offset:37952
    v_mfma_f32_16x16x32_bf16 v[104:107], v[232:235], v[176:179], v[104:107]
    ds_read_b64_tr_b16 v[228:229], v69 offset:37472
    v_mfma_f32_16x16x32_bf16 v[108:111], v[232:235], v[180:183], v[108:111]
    ds_read_b64_tr_b16 v[230:231], v69 offset:37984
    s_waitcnt lgkmcnt(8)
    v_mfma_f32_16x16x32_bf16 v[144:147], v[236:239], v[176:179], v[144:147]
    ds_read_b64_tr_b16 v[232:233], v68 offset:37440
    v_mfma_f32_16x16x32_bf16 v[148:151], v[236:239], v[180:183], v[148:151]
    ds_read_b64_tr_b16 v[234:235], v68 offset:37952
    v_mfma_f32_16x16x32_bf16 v[152:155], v[240:243], v[176:179], v[152:155]
    ds_read_b64_tr_b16 v[236:237], v68 offset:37472
    v_mfma_f32_16x16x32_bf16 v[156:159], v[240:243], v[180:183], v[156:159]
    ds_read_b64_tr_b16 v[238:239], v68 offset:37984
    s_waitcnt lgkmcnt(8)
    v_mfma_f32_16x16x32_bf16 v[160:163], v[244:247], v[176:179], v[160:163]
    ds_read_b64_tr_b16 v[240:241], v68 offset:29120
    v_mfma_f32_16x16x32_bf16 v[164:167], v[244:247], v[180:183], v[164:167]
    ds_read_b64_tr_b16 v[242:243], v68 offset:29632
    v_mfma_f32_16x16x32_bf16 v[168:171], v[248:251], v[176:179], v[168:171]
    ds_read_b64_tr_b16 v[244:245], v68 offset:29152
    v_mfma_f32_16x16x32_bf16 v[172:175], v[248:251], v[180:183], v[172:175]
    ds_read_b64_tr_b16 v[246:247], v68 offset:29664
    s_waitcnt lgkmcnt(8)
    s_waitcnt vmcnt(9)
    v_mfma_f32_16x16x32_bf16 v[128:131], v[224:227], v[184:187], v[128:131]
    ds_read_b64_tr_b16 v[248:249], v69 offset:29120
    s_waitcnt vmcnt(8)
    v_mfma_f32_16x16x32_bf16 v[132:135], v[224:227], v[188:191], v[132:135]
    ds_read_b64_tr_b16 v[250:251], v69 offset:29632
    s_add_u32 s96, s85, 6
    s_and_b32 s97, s96, 15
    s_lshl_b32 s98, s97, 14
    s_add_u32 s16, s98, s15
    buffer_load_dwordx4 v[176:179], v2, s[32:35], s16 offen sc1
    v_mfma_f32_16x16x32_bf16 v[136:139], v[228:231], v[184:187], v[136:139]
    ds_read_b64_tr_b16 v[224:225], v69 offset:29152
    v_mfma_f32_16x16x32_bf16 v[140:143], v[228:231], v[188:191], v[140:143]
    ds_read_b64_tr_b16 v[226:227], v69 offset:29664
    s_waitcnt lgkmcnt(8)
    v_mfma_f32_16x16x32_bf16 v[112:115], v[232:235], v[184:187], v[112:115]
    ds_read_b64_tr_b16 v[228:229], v68 offset:45760
    v_mfma_f32_16x16x32_bf16 v[116:119], v[232:235], v[188:191], v[116:119]
    ds_read_b64_tr_b16 v[230:231], v68 offset:46272
    v_mfma_f32_16x16x32_bf16 v[120:123], v[236:239], v[184:187], v[120:123]
    ds_read_b64_tr_b16 v[232:233], v68 offset:45792
    v_mfma_f32_16x16x32_bf16 v[124:127], v[236:239], v[188:191], v[124:127]
    ds_read_b64_tr_b16 v[234:235], v68 offset:46304
    buffer_load_dwordx4 v[180:183], v2, s[32:35], s16 offen offset:1024 sc1
    s_waitcnt lgkmcnt(8)
    v_mfma_f32_16x16x32_bf16 v[80:83], v[240:243], v[184:187], v[80:83]
    ds_read_b64_tr_b16 v[236:237], v69 offset:45760
    v_mfma_f32_16x16x32_bf16 v[84:87], v[240:243], v[188:191], v[84:87]
    ds_read_b64_tr_b16 v[238:239], v69 offset:46272
    v_mfma_f32_16x16x32_bf16 v[88:91], v[244:247], v[184:187], v[88:91]
    ds_read_b64_tr_b16 v[240:241], v69 offset:45792
    v_mfma_f32_16x16x32_bf16 v[92:95], v[244:247], v[188:191], v[92:95]
    ds_read_b64_tr_b16 v[242:243], v69 offset:46304
    s_waitcnt lgkmcnt(8)
    v_mfma_f32_16x16x32_bf16 v[96:99], v[248:251], v[184:187], v[96:99]
    s_barrier
    ds_read_b64_tr_b16 v[244:245], v71 offset:8320
    v_mfma_f32_16x16x32_bf16 v[100:103], v[248:251], v[188:191], v[100:103]
    ds_read_b64_tr_b16 v[246:247], v71 offset:8832
    v_mfma_f32_16x16x32_bf16 v[104:107], v[224:227], v[184:187], v[104:107]
    ds_read_b64_tr_b16 v[248:249], v71 offset:8352
    v_mfma_f32_16x16x32_bf16 v[108:111], v[224:227], v[188:191], v[108:111]
    ds_read_b64_tr_b16 v[250:251], v71 offset:8864
    s_waitcnt lgkmcnt(8)
    v_mfma_f32_16x16x32_bf16 v[144:147], v[228:231], v[184:187], v[144:147]
    ds_read_b64_tr_b16 v[224:225], v70 offset:8320
    v_mfma_f32_16x16x32_bf16 v[148:151], v[228:231], v[188:191], v[148:151]
    ds_read_b64_tr_b16 v[226:227], v70 offset:8832
    v_mfma_f32_16x16x32_bf16 v[152:155], v[232:235], v[184:187], v[152:155]
    ds_read_b64_tr_b16 v[228:229], v70 offset:8352
    v_mfma_f32_16x16x32_bf16 v[156:159], v[232:235], v[188:191], v[156:159]
    ds_read_b64_tr_b16 v[230:231], v70 offset:8864
    s_waitcnt lgkmcnt(8)
    v_mfma_f32_16x16x32_bf16 v[160:163], v[236:239], v[184:187], v[160:163]
    ds_read_b64_tr_b16 v[232:233], v70
    v_mfma_f32_16x16x32_bf16 v[164:167], v[236:239], v[188:191], v[164:167]
    ds_read_b64_tr_b16 v[234:235], v70 offset:512
    v_mfma_f32_16x16x32_bf16 v[168:171], v[240:243], v[184:187], v[168:171]
    ds_read_b64_tr_b16 v[236:237], v70 offset:32
    v_mfma_f32_16x16x32_bf16 v[172:175], v[240:243], v[188:191], v[172:175]
    ds_read_b64_tr_b16 v[238:239], v70 offset:544
    s_waitcnt lgkmcnt(8)
    s_waitcnt vmcnt(9)
    v_mfma_f32_16x16x32_bf16 v[128:131], v[244:247], v[192:195], v[128:131]
    ds_read_b64_tr_b16 v[240:241], v71
    s_waitcnt vmcnt(8)
    v_mfma_f32_16x16x32_bf16 v[132:135], v[244:247], v[196:199], v[132:135]
    ds_read_b64_tr_b16 v[242:243], v71 offset:512
    buffer_load_dwordx4 v[184:187], v2, s[32:35], s16 offen offset:2048 sc1
    v_mfma_f32_16x16x32_bf16 v[136:139], v[248:251], v[192:195], v[136:139]
    ds_read_b64_tr_b16 v[244:245], v71 offset:32
    v_mfma_f32_16x16x32_bf16 v[140:143], v[248:251], v[196:199], v[140:143]
    ds_read_b64_tr_b16 v[246:247], v71 offset:544
    s_waitcnt lgkmcnt(8)
    v_mfma_f32_16x16x32_bf16 v[112:115], v[224:227], v[192:195], v[112:115]
    ds_read_b64_tr_b16 v[248:249], v70 offset:16640
    v_mfma_f32_16x16x32_bf16 v[116:119], v[224:227], v[196:199], v[116:119]
    ds_read_b64_tr_b16 v[250:251], v70 offset:17152
    v_mfma_f32_16x16x32_bf16 v[120:123], v[228:231], v[192:195], v[120:123]
    ds_read_b64_tr_b16 v[224:225], v70 offset:16672
    v_mfma_f32_16x16x32_bf16 v[124:127], v[228:231], v[196:199], v[124:127]
    ds_read_b64_tr_b16 v[226:227], v70 offset:17184
    buffer_load_dwordx4 v[188:191], v2, s[32:35], s16 offen offset:3072 sc1
    s_waitcnt lgkmcnt(8)
    v_mfma_f32_16x16x32_bf16 v[80:83], v[232:235], v[192:195], v[80:83]
    ds_read_b64_tr_b16 v[228:229], v71 offset:16640
    v_mfma_f32_16x16x32_bf16 v[84:87], v[232:235], v[196:199], v[84:87]
    ds_read_b64_tr_b16 v[230:231], v71 offset:17152
    v_mfma_f32_16x16x32_bf16 v[88:91], v[236:239], v[192:195], v[88:91]
    ds_read_b64_tr_b16 v[232:233], v71 offset:16672
    v_mfma_f32_16x16x32_bf16 v[92:95], v[236:239], v[196:199], v[92:95]
    ds_read_b64_tr_b16 v[234:235], v71 offset:17184
    s_waitcnt lgkmcnt(8)
    v_mfma_f32_16x16x32_bf16 v[96:99], v[240:243], v[192:195], v[96:99]
    ds_read_b64_tr_b16 v[236:237], v71 offset:12480
    v_mfma_f32_16x16x32_bf16 v[100:103], v[240:243], v[196:199], v[100:103]
    ds_read_b64_tr_b16 v[238:239], v71 offset:12992
    v_mfma_f32_16x16x32_bf16 v[104:107], v[244:247], v[192:195], v[104:107]
    ds_read_b64_tr_b16 v[240:241], v71 offset:12512
    v_mfma_f32_16x16x32_bf16 v[108:111], v[244:247], v[196:199], v[108:111]
    ds_read_b64_tr_b16 v[242:243], v71 offset:13024
    s_waitcnt lgkmcnt(8)
    v_mfma_f32_16x16x32_bf16 v[144:147], v[248:251], v[192:195], v[144:147]
    ds_read_b64_tr_b16 v[244:245], v70 offset:12480
    v_mfma_f32_16x16x32_bf16 v[148:151], v[248:251], v[196:199], v[148:151]
    ds_read_b64_tr_b16 v[246:247], v70 offset:12992
    v_mfma_f32_16x16x32_bf16 v[152:155], v[224:227], v[192:195], v[152:155]
    ds_read_b64_tr_b16 v[248:249], v70 offset:12512
    v_mfma_f32_16x16x32_bf16 v[156:159], v[224:227], v[196:199], v[156:159]
    ds_read_b64_tr_b16 v[250:251], v70 offset:13024
    s_waitcnt lgkmcnt(8)
    v_mfma_f32_16x16x32_bf16 v[160:163], v[228:231], v[192:195], v[160:163]
    ds_read_b64_tr_b16 v[224:225], v70 offset:4160
    v_mfma_f32_16x16x32_bf16 v[164:167], v[228:231], v[196:199], v[164:167]
    ds_read_b64_tr_b16 v[226:227], v70 offset:4672
    v_mfma_f32_16x16x32_bf16 v[168:171], v[232:235], v[192:195], v[168:171]
    ds_read_b64_tr_b16 v[228:229], v70 offset:4192
    v_mfma_f32_16x16x32_bf16 v[172:175], v[232:235], v[196:199], v[172:175]
    ds_read_b64_tr_b16 v[230:231], v70 offset:4704
    s_waitcnt lgkmcnt(8)
    s_waitcnt vmcnt(9)
    v_mfma_f32_16x16x32_bf16 v[128:131], v[236:239], v[200:203], v[128:131]
    ds_read_b64_tr_b16 v[232:233], v71 offset:4160
    s_waitcnt vmcnt(8)
    v_mfma_f32_16x16x32_bf16 v[132:135], v[236:239], v[204:207], v[132:135]
    ds_read_b64_tr_b16 v[234:235], v71 offset:4672
    s_add_u32 s96, s85, 7
    s_and_b32 s97, s96, 15
    s_lshl_b32 s98, s97, 14
    s_add_u32 s16, s98, s15
    buffer_load_dwordx4 v[192:195], v2, s[32:35], s16 offen sc1
    v_mfma_f32_16x16x32_bf16 v[136:139], v[240:243], v[200:203], v[136:139]
    ds_read_b64_tr_b16 v[236:237], v71 offset:4192
    v_mfma_f32_16x16x32_bf16 v[140:143], v[240:243], v[204:207], v[140:143]
    ds_read_b64_tr_b16 v[238:239], v71 offset:4704
    s_waitcnt lgkmcnt(8)
    v_mfma_f32_16x16x32_bf16 v[112:115], v[244:247], v[200:203], v[112:115]
    ds_read_b64_tr_b16 v[240:241], v70 offset:20800
    v_mfma_f32_16x16x32_bf16 v[116:119], v[244:247], v[204:207], v[116:119]
    ds_read_b64_tr_b16 v[242:243], v70 offset:21312
    v_mfma_f32_16x16x32_bf16 v[120:123], v[248:251], v[200:203], v[120:123]
    ds_read_b64_tr_b16 v[244:245], v70 offset:20832
    v_mfma_f32_16x16x32_bf16 v[124:127], v[248:251], v[204:207], v[124:127]
    ds_read_b64_tr_b16 v[246:247], v70 offset:21344
    buffer_load_dwordx4 v[196:199], v2, s[32:35], s16 offen offset:1024 sc1
    s_waitcnt lgkmcnt(8)
    v_mfma_f32_16x16x32_bf16 v[80:83], v[224:227], v[200:203], v[80:83]
    ds_read_b64_tr_b16 v[248:249], v71 offset:20800
    v_mfma_f32_16x16x32_bf16 v[84:87], v[224:227], v[204:207], v[84:87]
    ds_read_b64_tr_b16 v[250:251], v71 offset:21312
    v_mfma_f32_16x16x32_bf16 v[88:91], v[228:231], v[200:203], v[88:91]
    ds_read_b64_tr_b16 v[224:225], v71 offset:20832
    v_mfma_f32_16x16x32_bf16 v[92:95], v[228:231], v[204:207], v[92:95]
    ds_read_b64_tr_b16 v[226:227], v71 offset:21344
    s_waitcnt lgkmcnt(8)
    v_mfma_f32_16x16x32_bf16 v[96:99], v[232:235], v[200:203], v[96:99]
    s_barrier
    ds_read_b64_tr_b16 v[228:229], v71 offset:33280
    v_mfma_f32_16x16x32_bf16 v[100:103], v[232:235], v[204:207], v[100:103]
    ds_read_b64_tr_b16 v[230:231], v71 offset:33792
    v_mfma_f32_16x16x32_bf16 v[104:107], v[236:239], v[200:203], v[104:107]
    ds_read_b64_tr_b16 v[232:233], v71 offset:33312
    v_mfma_f32_16x16x32_bf16 v[108:111], v[236:239], v[204:207], v[108:111]
    ds_read_b64_tr_b16 v[234:235], v71 offset:33824
    s_waitcnt lgkmcnt(8)
    v_mfma_f32_16x16x32_bf16 v[144:147], v[240:243], v[200:203], v[144:147]
    ds_read_b64_tr_b16 v[236:237], v70 offset:33280
    v_mfma_f32_16x16x32_bf16 v[148:151], v[240:243], v[204:207], v[148:151]
    ds_read_b64_tr_b16 v[238:239], v70 offset:33792
    v_mfma_f32_16x16x32_bf16 v[152:155], v[244:247], v[200:203], v[152:155]
    ds_read_b64_tr_b16 v[240:241], v70 offset:33312
    v_mfma_f32_16x16x32_bf16 v[156:159], v[244:247], v[204:207], v[156:159]
    ds_read_b64_tr_b16 v[242:243], v70 offset:33824
    s_waitcnt lgkmcnt(8)
    v_mfma_f32_16x16x32_bf16 v[160:163], v[248:251], v[200:203], v[160:163]
    ds_read_b64_tr_b16 v[244:245], v70 offset:24960
    v_mfma_f32_16x16x32_bf16 v[164:167], v[248:251], v[204:207], v[164:167]
    ds_read_b64_tr_b16 v[246:247], v70 offset:25472
    v_mfma_f32_16x16x32_bf16 v[168:171], v[224:227], v[200:203], v[168:171]
    ds_read_b64_tr_b16 v[248:249], v70 offset:24992
    v_mfma_f32_16x16x32_bf16 v[172:175], v[224:227], v[204:207], v[172:175]
    ds_read_b64_tr_b16 v[250:251], v70 offset:25504
    s_waitcnt lgkmcnt(8)
    s_waitcnt vmcnt(9)
    v_mfma_f32_16x16x32_bf16 v[128:131], v[228:231], v[208:211], v[128:131]
    ds_read_b64_tr_b16 v[224:225], v71 offset:24960
    s_waitcnt vmcnt(8)
    v_mfma_f32_16x16x32_bf16 v[132:135], v[228:231], v[212:215], v[132:135]
    ds_read_b64_tr_b16 v[226:227], v71 offset:25472
    buffer_load_dwordx4 v[200:203], v2, s[32:35], s16 offen offset:2048 sc1
    v_mfma_f32_16x16x32_bf16 v[136:139], v[232:235], v[208:211], v[136:139]
    ds_read_b64_tr_b16 v[228:229], v71 offset:24992
    v_mfma_f32_16x16x32_bf16 v[140:143], v[232:235], v[212:215], v[140:143]
    ds_read_b64_tr_b16 v[230:231], v71 offset:25504
    s_waitcnt lgkmcnt(8)
    v_mfma_f32_16x16x32_bf16 v[112:115], v[236:239], v[208:211], v[112:115]
    ds_read_b64_tr_b16 v[232:233], v70 offset:41600
    v_mfma_f32_16x16x32_bf16 v[116:119], v[236:239], v[212:215], v[116:119]
    ds_read_b64_tr_b16 v[234:235], v70 offset:42112
    v_mfma_f32_16x16x32_bf16 v[120:123], v[240:243], v[208:211], v[120:123]
    ds_read_b64_tr_b16 v[236:237], v70 offset:41632
    v_mfma_f32_16x16x32_bf16 v[124:127], v[240:243], v[212:215], v[124:127]
    ds_read_b64_tr_b16 v[238:239], v70 offset:42144
    buffer_load_dwordx4 v[204:207], v2, s[32:35], s16 offen offset:3072 sc1
    s_waitcnt lgkmcnt(8)
    v_mfma_f32_16x16x32_bf16 v[80:83], v[244:247], v[208:211], v[80:83]
    ds_read_b64_tr_b16 v[240:241], v71 offset:41600
    v_mfma_f32_16x16x32_bf16 v[84:87], v[244:247], v[212:215], v[84:87]
    ds_read_b64_tr_b16 v[242:243], v71 offset:42112
    v_mfma_f32_16x16x32_bf16 v[88:91], v[248:251], v[208:211], v[88:91]
    ds_read_b64_tr_b16 v[244:245], v71 offset:41632
    v_mfma_f32_16x16x32_bf16 v[92:95], v[248:251], v[212:215], v[92:95]
    ds_read_b64_tr_b16 v[246:247], v71 offset:42144
    s_waitcnt lgkmcnt(8)
    v_mfma_f32_16x16x32_bf16 v[96:99], v[224:227], v[208:211], v[96:99]
    ds_read_b64_tr_b16 v[248:249], v71 offset:37440
    v_mfma_f32_16x16x32_bf16 v[100:103], v[224:227], v[212:215], v[100:103]
    ds_read_b64_tr_b16 v[250:251], v71 offset:37952
    v_mfma_f32_16x16x32_bf16 v[104:107], v[228:231], v[208:211], v[104:107]
    ds_read_b64_tr_b16 v[224:225], v71 offset:37472
    v_mfma_f32_16x16x32_bf16 v[108:111], v[228:231], v[212:215], v[108:111]
    ds_read_b64_tr_b16 v[226:227], v71 offset:37984
    s_waitcnt lgkmcnt(8)
    v_mfma_f32_16x16x32_bf16 v[144:147], v[232:235], v[208:211], v[144:147]
    ds_read_b64_tr_b16 v[228:229], v70 offset:37440
    v_mfma_f32_16x16x32_bf16 v[148:151], v[232:235], v[212:215], v[148:151]
    ds_read_b64_tr_b16 v[230:231], v70 offset:37952
    v_mfma_f32_16x16x32_bf16 v[152:155], v[236:239], v[208:211], v[152:155]
    ds_read_b64_tr_b16 v[232:233], v70 offset:37472
    v_mfma_f32_16x16x32_bf16 v[156:159], v[236:239], v[212:215], v[156:159]
    ds_read_b64_tr_b16 v[234:235], v70 offset:37984
    s_waitcnt lgkmcnt(8)
    v_mfma_f32_16x16x32_bf16 v[160:163], v[240:243], v[208:211], v[160:163]
    ds_read_b64_tr_b16 v[236:237], v70 offset:29120
    v_mfma_f32_16x16x32_bf16 v[164:167], v[240:243], v[212:215], v[164:167]
    ds_read_b64_tr_b16 v[238:239], v70 offset:29632
    v_mfma_f32_16x16x32_bf16 v[168:171], v[244:247], v[208:211], v[168:171]
    ds_read_b64_tr_b16 v[240:241], v70 offset:29152
    v_mfma_f32_16x16x32_bf16 v[172:175], v[244:247], v[212:215], v[172:175]
    ds_read_b64_tr_b16 v[242:243], v70 offset:29664
    s_waitcnt lgkmcnt(8)
    s_waitcnt vmcnt(9)
    v_mfma_f32_16x16x32_bf16 v[128:131], v[248:251], v[216:219], v[128:131]
    ds_read_b64_tr_b16 v[244:245], v71 offset:29120
    s_waitcnt vmcnt(8)
    v_mfma_f32_16x16x32_bf16 v[132:135], v[248:251], v[220:223], v[132:135]
    ds_read_b64_tr_b16 v[246:247], v71 offset:29632
    s_add_u32 s96, s85, 8
    s_and_b32 s97, s96, 15
    s_lshl_b32 s98, s97, 14
    s_add_u32 s16, s98, s15
    buffer_load_dwordx4 v[208:211], v2, s[32:35], s16 offen sc1
    v_mfma_f32_16x16x32_bf16 v[136:139], v[224:227], v[216:219], v[136:139]
    ds_read_b64_tr_b16 v[248:249], v71 offset:29152
    v_mfma_f32_16x16x32_bf16 v[140:143], v[224:227], v[220:223], v[140:143]
    ds_read_b64_tr_b16 v[250:251], v71 offset:29664
    s_waitcnt lgkmcnt(8)
    v_mfma_f32_16x16x32_bf16 v[112:115], v[228:231], v[216:219], v[112:115]
    ds_read_b64_tr_b16 v[224:225], v70 offset:45760
    v_mfma_f32_16x16x32_bf16 v[116:119], v[228:231], v[220:223], v[116:119]
    ds_read_b64_tr_b16 v[226:227], v70 offset:46272
    v_mfma_f32_16x16x32_bf16 v[120:123], v[232:235], v[216:219], v[120:123]
    ds_read_b64_tr_b16 v[228:229], v70 offset:45792
    v_mfma_f32_16x16x32_bf16 v[124:127], v[232:235], v[220:223], v[124:127]
    ds_read_b64_tr_b16 v[230:231], v70 offset:46304
    buffer_load_dwordx4 v[212:215], v2, s[32:35], s16 offen offset:1024 sc1
    s_waitcnt lgkmcnt(8)
    v_mfma_f32_16x16x32_bf16 v[80:83], v[236:239], v[216:219], v[80:83]
    ds_read_b64_tr_b16 v[232:233], v71 offset:45760
    v_mfma_f32_16x16x32_bf16 v[84:87], v[236:239], v[220:223], v[84:87]
    ds_read_b64_tr_b16 v[234:235], v71 offset:46272
    v_mfma_f32_16x16x32_bf16 v[88:91], v[240:243], v[216:219], v[88:91]
    ds_read_b64_tr_b16 v[236:237], v71 offset:45792
    v_mfma_f32_16x16x32_bf16 v[92:95], v[240:243], v[220:223], v[92:95]
    ds_read_b64_tr_b16 v[238:239], v71 offset:46304
    s_waitcnt lgkmcnt(8)
    v_mfma_f32_16x16x32_bf16 v[96:99], v[244:247], v[216:219], v[96:99]
    s_barrier
    ds_read_b64_tr_b16 v[240:241], v67 offset:8320
    v_mfma_f32_16x16x32_bf16 v[100:103], v[244:247], v[220:223], v[100:103]
    ds_read_b64_tr_b16 v[242:243], v67 offset:8832
    v_mfma_f32_16x16x32_bf16 v[104:107], v[248:251], v[216:219], v[104:107]
    ds_read_b64_tr_b16 v[244:245], v67 offset:8352
    v_mfma_f32_16x16x32_bf16 v[108:111], v[248:251], v[220:223], v[108:111]
    ds_read_b64_tr_b16 v[246:247], v67 offset:8864
    s_waitcnt lgkmcnt(8)
    v_mfma_f32_16x16x32_bf16 v[144:147], v[224:227], v[216:219], v[144:147]
    ds_read_b64_tr_b16 v[248:249], v66 offset:8320
    v_mfma_f32_16x16x32_bf16 v[148:151], v[224:227], v[220:223], v[148:151]
    ds_read_b64_tr_b16 v[250:251], v66 offset:8832
    v_mfma_f32_16x16x32_bf16 v[152:155], v[228:231], v[216:219], v[152:155]
    ds_read_b64_tr_b16 v[224:225], v66 offset:8352
    v_mfma_f32_16x16x32_bf16 v[156:159], v[228:231], v[220:223], v[156:159]
    ds_read_b64_tr_b16 v[226:227], v66 offset:8864
    s_waitcnt lgkmcnt(8)
    v_mfma_f32_16x16x32_bf16 v[160:163], v[232:235], v[216:219], v[160:163]
    ds_read_b64_tr_b16 v[228:229], v66
    v_mfma_f32_16x16x32_bf16 v[164:167], v[232:235], v[220:223], v[164:167]
    ds_read_b64_tr_b16 v[230:231], v66 offset:512
    v_mfma_f32_16x16x32_bf16 v[168:171], v[236:239], v[216:219], v[168:171]
    ds_read_b64_tr_b16 v[232:233], v66 offset:32
    v_mfma_f32_16x16x32_bf16 v[172:175], v[236:239], v[220:223], v[172:175]
    ds_read_b64_tr_b16 v[234:235], v66 offset:544
    s_waitcnt lgkmcnt(8)
    s_waitcnt vmcnt(9)
    v_mfma_f32_16x16x32_bf16 v[128:131], v[240:243], v[176:179], v[128:131]
    ds_read_b64_tr_b16 v[236:237], v67
    s_waitcnt vmcnt(8)
    v_mfma_f32_16x16x32_bf16 v[132:135], v[240:243], v[180:183], v[132:135]
    ds_read_b64_tr_b16 v[238:239], v67 offset:512
    buffer_load_dwordx4 v[216:219], v2, s[32:35], s16 offen offset:2048 sc1
    v_mfma_f32_16x16x32_bf16 v[136:139], v[244:247], v[176:179], v[136:139]
    ds_read_b64_tr_b16 v[240:241], v67 offset:32
    v_mfma_f32_16x16x32_bf16 v[140:143], v[244:247], v[180:183], v[140:143]
    ds_read_b64_tr_b16 v[242:243], v67 offset:544
    s_waitcnt lgkmcnt(8)
    v_mfma_f32_16x16x32_bf16 v[112:115], v[248:251], v[176:179], v[112:115]
    ds_read_b64_tr_b16 v[244:245], v66 offset:16640
    v_mfma_f32_16x16x32_bf16 v[116:119], v[248:251], v[180:183], v[116:119]
    ds_read_b64_tr_b16 v[246:247], v66 offset:17152
    v_mfma_f32_16x16x32_bf16 v[120:123], v[224:227], v[176:179], v[120:123]
    ds_read_b64_tr_b16 v[248:249], v66 offset:16672
    v_mfma_f32_16x16x32_bf16 v[124:127], v[224:227], v[180:183], v[124:127]
    ds_read_b64_tr_b16 v[250:251], v66 offset:17184
    buffer_load_dwordx4 v[220:223], v2, s[32:35], s16 offen offset:3072 sc1
    s_waitcnt lgkmcnt(8)
    v_mfma_f32_16x16x32_bf16 v[80:83], v[228:231], v[176:179], v[80:83]
    ds_read_b64_tr_b16 v[224:225], v67 offset:16640
    v_mfma_f32_16x16x32_bf16 v[84:87], v[228:231], v[180:183], v[84:87]
    ds_read_b64_tr_b16 v[226:227], v67 offset:17152
    v_mfma_f32_16x16x32_bf16 v[88:91], v[232:235], v[176:179], v[88:91]
    ds_read_b64_tr_b16 v[228:229], v67 offset:16672
    v_mfma_f32_16x16x32_bf16 v[92:95], v[232:235], v[180:183], v[92:95]
    ds_read_b64_tr_b16 v[230:231], v67 offset:17184
    s_waitcnt lgkmcnt(8)
    v_mfma_f32_16x16x32_bf16 v[96:99], v[236:239], v[176:179], v[96:99]
    ds_read_b64_tr_b16 v[232:233], v67 offset:12480
    v_mfma_f32_16x16x32_bf16 v[100:103], v[236:239], v[180:183], v[100:103]
    ds_read_b64_tr_b16 v[234:235], v67 offset:12992
    v_mfma_f32_16x16x32_bf16 v[104:107], v[240:243], v[176:179], v[104:107]
    ds_read_b64_tr_b16 v[236:237], v67 offset:12512
    v_mfma_f32_16x16x32_bf16 v[108:111], v[240:243], v[180:183], v[108:111]
    ds_read_b64_tr_b16 v[238:239], v67 offset:13024
    s_waitcnt lgkmcnt(8)
    v_mfma_f32_16x16x32_bf16 v[144:147], v[244:247], v[176:179], v[144:147]
    ds_read_b64_tr_b16 v[240:241], v66 offset:12480
    v_mfma_f32_16x16x32_bf16 v[148:151], v[244:247], v[180:183], v[148:151]
    ds_read_b64_tr_b16 v[242:243], v66 offset:12992
    v_mfma_f32_16x16x32_bf16 v[152:155], v[248:251], v[176:179], v[152:155]
    ds_read_b64_tr_b16 v[244:245], v66 offset:12512
    v_mfma_f32_16x16x32_bf16 v[156:159], v[248:251], v[180:183], v[156:159]
    ds_read_b64_tr_b16 v[246:247], v66 offset:13024
    s_waitcnt lgkmcnt(8)
    v_mfma_f32_16x16x32_bf16 v[160:163], v[224:227], v[176:179], v[160:163]
    ds_read_b64_tr_b16 v[248:249], v66 offset:4160
    v_mfma_f32_16x16x32_bf16 v[164:167], v[224:227], v[180:183], v[164:167]
    ds_read_b64_tr_b16 v[250:251], v66 offset:4672
    v_mfma_f32_16x16x32_bf16 v[168:171], v[228:231], v[176:179], v[168:171]
    ds_read_b64_tr_b16 v[224:225], v66 offset:4192
    v_mfma_f32_16x16x32_bf16 v[172:175], v[228:231], v[180:183], v[172:175]
    ds_read_b64_tr_b16 v[226:227], v66 offset:4704
    s_waitcnt lgkmcnt(8)
    s_waitcnt vmcnt(9)
    v_mfma_f32_16x16x32_bf16 v[128:131], v[232:235], v[184:187], v[128:131]
    ds_read_b64_tr_b16 v[228:229], v67 offset:4160
    s_waitcnt vmcnt(8)
    v_mfma_f32_16x16x32_bf16 v[132:135], v[232:235], v[188:191], v[132:135]
    ds_read_b64_tr_b16 v[230:231], v67 offset:4672
    s_add_u32 s96, s85, 9
    s_and_b32 s97, s96, 15
    s_lshl_b32 s98, s97, 14
    s_add_u32 s16, s98, s15
    buffer_load_dwordx4 v[176:179], v2, s[32:35], s16 offen sc1
    v_mfma_f32_16x16x32_bf16 v[136:139], v[236:239], v[184:187], v[136:139]
    ds_read_b64_tr_b16 v[232:233], v67 offset:4192
    v_mfma_f32_16x16x32_bf16 v[140:143], v[236:239], v[188:191], v[140:143]
    ds_read_b64_tr_b16 v[234:235], v67 offset:4704
    s_waitcnt lgkmcnt(8)
    v_mfma_f32_16x16x32_bf16 v[112:115], v[240:243], v[184:187], v[112:115]
    ds_read_b64_tr_b16 v[236:237], v66 offset:20800
    v_mfma_f32_16x16x32_bf16 v[116:119], v[240:243], v[188:191], v[116:119]
    ds_read_b64_tr_b16 v[238:239], v66 offset:21312
    v_mfma_f32_16x16x32_bf16 v[120:123], v[244:247], v[184:187], v[120:123]
    ds_read_b64_tr_b16 v[240:241], v66 offset:20832
    v_mfma_f32_16x16x32_bf16 v[124:127], v[244:247], v[188:191], v[124:127]
    ds_read_b64_tr_b16 v[242:243], v66 offset:21344
    buffer_load_dwordx4 v[180:183], v2, s[32:35], s16 offen offset:1024 sc1
    s_waitcnt lgkmcnt(8)
    v_mfma_f32_16x16x32_bf16 v[80:83], v[248:251], v[184:187], v[80:83]
    ds_read_b64_tr_b16 v[244:245], v67 offset:20800
    v_mfma_f32_16x16x32_bf16 v[84:87], v[248:251], v[188:191], v[84:87]
    ds_read_b64_tr_b16 v[246:247], v67 offset:21312
    v_mfma_f32_16x16x32_bf16 v[88:91], v[224:227], v[184:187], v[88:91]
    ds_read_b64_tr_b16 v[248:249], v67 offset:20832
    v_mfma_f32_16x16x32_bf16 v[92:95], v[224:227], v[188:191], v[92:95]
    ds_read_b64_tr_b16 v[250:251], v67 offset:21344
    s_waitcnt lgkmcnt(8)
    v_mfma_f32_16x16x32_bf16 v[96:99], v[228:231], v[184:187], v[96:99]
    s_barrier
    ds_read_b64_tr_b16 v[224:225], v67 offset:33280
    v_mfma_f32_16x16x32_bf16 v[100:103], v[228:231], v[188:191], v[100:103]
    ds_read_b64_tr_b16 v[226:227], v67 offset:33792
    v_mfma_f32_16x16x32_bf16 v[104:107], v[232:235], v[184:187], v[104:107]
    ds_read_b64_tr_b16 v[228:229], v67 offset:33312
    v_mfma_f32_16x16x32_bf16 v[108:111], v[232:235], v[188:191], v[108:111]
    ds_read_b64_tr_b16 v[230:231], v67 offset:33824
    s_waitcnt lgkmcnt(8)
    v_mfma_f32_16x16x32_bf16 v[144:147], v[236:239], v[184:187], v[144:147]
    ds_read_b64_tr_b16 v[232:233], v66 offset:33280
    v_mfma_f32_16x16x32_bf16 v[148:151], v[236:239], v[188:191], v[148:151]
    ds_read_b64_tr_b16 v[234:235], v66 offset:33792
    v_mfma_f32_16x16x32_bf16 v[152:155], v[240:243], v[184:187], v[152:155]
    ds_read_b64_tr_b16 v[236:237], v66 offset:33312
    v_mfma_f32_16x16x32_bf16 v[156:159], v[240:243], v[188:191], v[156:159]
    ds_read_b64_tr_b16 v[238:239], v66 offset:33824
    s_waitcnt lgkmcnt(8)
    v_mfma_f32_16x16x32_bf16 v[160:163], v[244:247], v[184:187], v[160:163]
    ds_read_b64_tr_b16 v[240:241], v66 offset:24960
    v_mfma_f32_16x16x32_bf16 v[164:167], v[244:247], v[188:191], v[164:167]
    ds_read_b64_tr_b16 v[242:243], v66 offset:25472
    v_mfma_f32_16x16x32_bf16 v[168:171], v[248:251], v[184:187], v[168:171]
    ds_read_b64_tr_b16 v[244:245], v66 offset:24992
    v_mfma_f32_16x16x32_bf16 v[172:175], v[248:251], v[188:191], v[172:175]
    ds_read_b64_tr_b16 v[246:247], v66 offset:25504
    s_waitcnt lgkmcnt(8)
    s_waitcnt vmcnt(9)
    v_mfma_f32_16x16x32_bf16 v[128:131], v[224:227], v[192:195], v[128:131]
    ds_read_b64_tr_b16 v[248:249], v67 offset:24960
    s_waitcnt vmcnt(8)
    v_mfma_f32_16x16x32_bf16 v[132:135], v[224:227], v[196:199], v[132:135]
    ds_read_b64_tr_b16 v[250:251], v67 offset:25472
    buffer_load_dwordx4 v[184:187], v2, s[32:35], s16 offen offset:2048 sc1
    v_mfma_f32_16x16x32_bf16 v[136:139], v[228:231], v[192:195], v[136:139]
    ds_read_b64_tr_b16 v[224:225], v67 offset:24992
    v_mfma_f32_16x16x32_bf16 v[140:143], v[228:231], v[196:199], v[140:143]
    ds_read_b64_tr_b16 v[226:227], v67 offset:25504
    s_waitcnt lgkmcnt(8)
    v_mfma_f32_16x16x32_bf16 v[112:115], v[232:235], v[192:195], v[112:115]
    ds_read_b64_tr_b16 v[228:229], v66 offset:41600
    v_mfma_f32_16x16x32_bf16 v[116:119], v[232:235], v[196:199], v[116:119]
    ds_read_b64_tr_b16 v[230:231], v66 offset:42112
    v_mfma_f32_16x16x32_bf16 v[120:123], v[236:239], v[192:195], v[120:123]
    ds_read_b64_tr_b16 v[232:233], v66 offset:41632
    v_mfma_f32_16x16x32_bf16 v[124:127], v[236:239], v[196:199], v[124:127]
    ds_read_b64_tr_b16 v[234:235], v66 offset:42144
    buffer_load_dwordx4 v[188:191], v2, s[32:35], s16 offen offset:3072 sc1
    s_waitcnt lgkmcnt(8)
    v_mfma_f32_16x16x32_bf16 v[80:83], v[240:243], v[192:195], v[80:83]
    ds_read_b64_tr_b16 v[236:237], v67 offset:41600
    v_mfma_f32_16x16x32_bf16 v[84:87], v[240:243], v[196:199], v[84:87]
    ds_read_b64_tr_b16 v[238:239], v67 offset:42112
    v_mfma_f32_16x16x32_bf16 v[88:91], v[244:247], v[192:195], v[88:91]
    ds_read_b64_tr_b16 v[240:241], v67 offset:41632
    v_mfma_f32_16x16x32_bf16 v[92:95], v[244:247], v[196:199], v[92:95]
    ds_read_b64_tr_b16 v[242:243], v67 offset:42144
    s_waitcnt lgkmcnt(8)
    v_mfma_f32_16x16x32_bf16 v[96:99], v[248:251], v[192:195], v[96:99]
    ds_read_b64_tr_b16 v[244:245], v67 offset:37440
    v_mfma_f32_16x16x32_bf16 v[100:103], v[248:251], v[196:199], v[100:103]
    ds_read_b64_tr_b16 v[246:247], v67 offset:37952
    v_mfma_f32_16x16x32_bf16 v[104:107], v[224:227], v[192:195], v[104:107]
    ds_read_b64_tr_b16 v[248:249], v67 offset:37472
    v_mfma_f32_16x16x32_bf16 v[108:111], v[224:227], v[196:199], v[108:111]
    ds_read_b64_tr_b16 v[250:251], v67 offset:37984
    s_waitcnt lgkmcnt(8)
    v_mfma_f32_16x16x32_bf16 v[144:147], v[228:231], v[192:195], v[144:147]
    ds_read_b64_tr_b16 v[224:225], v66 offset:37440
    v_mfma_f32_16x16x32_bf16 v[148:151], v[228:231], v[196:199], v[148:151]
    ds_read_b64_tr_b16 v[226:227], v66 offset:37952
    v_mfma_f32_16x16x32_bf16 v[152:155], v[232:235], v[192:195], v[152:155]
    ds_read_b64_tr_b16 v[228:229], v66 offset:37472
    v_mfma_f32_16x16x32_bf16 v[156:159], v[232:235], v[196:199], v[156:159]
    ds_read_b64_tr_b16 v[230:231], v66 offset:37984
    s_waitcnt lgkmcnt(8)
    v_mfma_f32_16x16x32_bf16 v[160:163], v[236:239], v[192:195], v[160:163]
    ds_read_b64_tr_b16 v[232:233], v66 offset:29120
    v_mfma_f32_16x16x32_bf16 v[164:167], v[236:239], v[196:199], v[164:167]
    ds_read_b64_tr_b16 v[234:235], v66 offset:29632
    v_mfma_f32_16x16x32_bf16 v[168:171], v[240:243], v[192:195], v[168:171]
    ds_read_b64_tr_b16 v[236:237], v66 offset:29152
    v_mfma_f32_16x16x32_bf16 v[172:175], v[240:243], v[196:199], v[172:175]
    ds_read_b64_tr_b16 v[238:239], v66 offset:29664
    s_waitcnt lgkmcnt(8)
    s_waitcnt vmcnt(9)
    v_mfma_f32_16x16x32_bf16 v[128:131], v[244:247], v[200:203], v[128:131]
    ds_read_b64_tr_b16 v[240:241], v67 offset:29120
    s_waitcnt vmcnt(8)
    v_mfma_f32_16x16x32_bf16 v[132:135], v[244:247], v[204:207], v[132:135]
    ds_read_b64_tr_b16 v[242:243], v67 offset:29632
    s_add_u32 s96, s85, 10
    s_and_b32 s97, s96, 15
    s_lshl_b32 s98, s97, 14
    s_add_u32 s16, s98, s15
    buffer_load_dwordx4 v[192:195], v2, s[32:35], s16 offen sc1
    v_mfma_f32_16x16x32_bf16 v[136:139], v[248:251], v[200:203], v[136:139]
    ds_read_b64_tr_b16 v[244:245], v67 offset:29152
    v_mfma_f32_16x16x32_bf16 v[140:143], v[248:251], v[204:207], v[140:143]
    ds_read_b64_tr_b16 v[246:247], v67 offset:29664
    s_waitcnt lgkmcnt(8)
    v_mfma_f32_16x16x32_bf16 v[112:115], v[224:227], v[200:203], v[112:115]
    ds_read_b64_tr_b16 v[248:249], v66 offset:45760
    v_mfma_f32_16x16x32_bf16 v[116:119], v[224:227], v[204:207], v[116:119]
    ds_read_b64_tr_b16 v[250:251], v66 offset:46272
    v_mfma_f32_16x16x32_bf16 v[120:123], v[228:231], v[200:203], v[120:123]
    ds_read_b64_tr_b16 v[224:225], v66 offset:45792
    v_mfma_f32_16x16x32_bf16 v[124:127], v[228:231], v[204:207], v[124:127]
    ds_read_b64_tr_b16 v[226:227], v66 offset:46304
    buffer_load_dwordx4 v[196:199], v2, s[32:35], s16 offen offset:1024 sc1
    s_waitcnt lgkmcnt(8)
    v_mfma_f32_16x16x32_bf16 v[80:83], v[232:235], v[200:203], v[80:83]
    ds_read_b64_tr_b16 v[228:229], v67 offset:45760
    v_mfma_f32_16x16x32_bf16 v[84:87], v[232:235], v[204:207], v[84:87]
    ds_read_b64_tr_b16 v[230:231], v67 offset:46272
    v_mfma_f32_16x16x32_bf16 v[88:91], v[236:239], v[200:203], v[88:91]
    ds_read_b64_tr_b16 v[232:233], v67 offset:45792
    v_mfma_f32_16x16x32_bf16 v[92:95], v[236:239], v[204:207], v[92:95]
    ds_read_b64_tr_b16 v[234:235], v67 offset:46304
    s_waitcnt lgkmcnt(8)
    v_mfma_f32_16x16x32_bf16 v[96:99], v[240:243], v[200:203], v[96:99]
    s_barrier
    ds_read_b64_tr_b16 v[236:237], v69 offset:8320
    v_mfma_f32_16x16x32_bf16 v[100:103], v[240:243], v[204:207], v[100:103]
    ds_read_b64_tr_b16 v[238:239], v69 offset:8832
    v_mfma_f32_16x16x32_bf16 v[104:107], v[244:247], v[200:203], v[104:107]
    ds_read_b64_tr_b16 v[240:241], v69 offset:8352
    v_mfma_f32_16x16x32_bf16 v[108:111], v[244:247], v[204:207], v[108:111]
    ds_read_b64_tr_b16 v[242:243], v69 offset:8864
    s_waitcnt lgkmcnt(8)
    v_mfma_f32_16x16x32_bf16 v[144:147], v[248:251], v[200:203], v[144:147]
    ds_read_b64_tr_b16 v[244:245], v68 offset:8320
    v_mfma_f32_16x16x32_bf16 v[148:151], v[248:251], v[204:207], v[148:151]
    ds_read_b64_tr_b16 v[246:247], v68 offset:8832
    v_mfma_f32_16x16x32_bf16 v[152:155], v[224:227], v[200:203], v[152:155]
    ds_read_b64_tr_b16 v[248:249], v68 offset:8352
    v_mfma_f32_16x16x32_bf16 v[156:159], v[224:227], v[204:207], v[156:159]
    ds_read_b64_tr_b16 v[250:251], v68 offset:8864
    s_waitcnt lgkmcnt(8)
    v_mfma_f32_16x16x32_bf16 v[160:163], v[228:231], v[200:203], v[160:163]
    ds_read_b64_tr_b16 v[224:225], v68
    v_mfma_f32_16x16x32_bf16 v[164:167], v[228:231], v[204:207], v[164:167]
    ds_read_b64_tr_b16 v[226:227], v68 offset:512
    v_mfma_f32_16x16x32_bf16 v[168:171], v[232:235], v[200:203], v[168:171]
    ds_read_b64_tr_b16 v[228:229], v68 offset:32
    v_mfma_f32_16x16x32_bf16 v[172:175], v[232:235], v[204:207], v[172:175]
    ds_read_b64_tr_b16 v[230:231], v68 offset:544
    s_waitcnt lgkmcnt(8)
    s_waitcnt vmcnt(9)
    v_mfma_f32_16x16x32_bf16 v[128:131], v[236:239], v[208:211], v[128:131]
    ds_read_b64_tr_b16 v[232:233], v69
    s_waitcnt vmcnt(8)
    v_mfma_f32_16x16x32_bf16 v[132:135], v[236:239], v[212:215], v[132:135]
    ds_read_b64_tr_b16 v[234:235], v69 offset:512
    buffer_load_dwordx4 v[200:203], v2, s[32:35], s16 offen offset:2048 sc1
    v_mfma_f32_16x16x32_bf16 v[136:139], v[240:243], v[208:211], v[136:139]
    ds_read_b64_tr_b16 v[236:237], v69 offset:32
    v_mfma_f32_16x16x32_bf16 v[140:143], v[240:243], v[212:215], v[140:143]
    ds_read_b64_tr_b16 v[238:239], v69 offset:544
    s_waitcnt lgkmcnt(8)
    v_mfma_f32_16x16x32_bf16 v[112:115], v[244:247], v[208:211], v[112:115]
    ds_read_b64_tr_b16 v[240:241], v68 offset:16640
    v_mfma_f32_16x16x32_bf16 v[116:119], v[244:247], v[212:215], v[116:119]
    ds_read_b64_tr_b16 v[242:243], v68 offset:17152
    v_mfma_f32_16x16x32_bf16 v[120:123], v[248:251], v[208:211], v[120:123]
    ds_read_b64_tr_b16 v[244:245], v68 offset:16672
    v_mfma_f32_16x16x32_bf16 v[124:127], v[248:251], v[212:215], v[124:127]
    ds_read_b64_tr_b16 v[246:247], v68 offset:17184
    buffer_load_dwordx4 v[204:207], v2, s[32:35], s16 offen offset:3072 sc1
    s_waitcnt lgkmcnt(8)
    v_mfma_f32_16x16x32_bf16 v[80:83], v[224:227], v[208:211], v[80:83]
    ds_read_b64_tr_b16 v[248:249], v69 offset:16640
    v_mfma_f32_16x16x32_bf16 v[84:87], v[224:227], v[212:215], v[84:87]
    ds_read_b64_tr_b16 v[250:251], v69 offset:17152
    v_mfma_f32_16x16x32_bf16 v[88:91], v[228:231], v[208:211], v[88:91]
    ds_read_b64_tr_b16 v[224:225], v69 offset:16672
    v_mfma_f32_16x16x32_bf16 v[92:95], v[228:231], v[212:215], v[92:95]
    ds_read_b64_tr_b16 v[226:227], v69 offset:17184
    s_waitcnt lgkmcnt(8)
    v_mfma_f32_16x16x32_bf16 v[96:99], v[232:235], v[208:211], v[96:99]
    ds_read_b64_tr_b16 v[228:229], v69 offset:12480
    v_mfma_f32_16x16x32_bf16 v[100:103], v[232:235], v[212:215], v[100:103]
    ds_read_b64_tr_b16 v[230:231], v69 offset:12992
    v_mfma_f32_16x16x32_bf16 v[104:107], v[236:239], v[208:211], v[104:107]
    ds_read_b64_tr_b16 v[232:233], v69 offset:12512
    v_mfma_f32_16x16x32_bf16 v[108:111], v[236:239], v[212:215], v[108:111]
    ds_read_b64_tr_b16 v[234:235], v69 offset:13024
    s_waitcnt lgkmcnt(8)
    v_mfma_f32_16x16x32_bf16 v[144:147], v[240:243], v[208:211], v[144:147]
    ds_read_b64_tr_b16 v[236:237], v68 offset:12480
    v_mfma_f32_16x16x32_bf16 v[148:151], v[240:243], v[212:215], v[148:151]
    ds_read_b64_tr_b16 v[238:239], v68 offset:12992
    v_mfma_f32_16x16x32_bf16 v[152:155], v[244:247], v[208:211], v[152:155]
    ds_read_b64_tr_b16 v[240:241], v68 offset:12512
    v_mfma_f32_16x16x32_bf16 v[156:159], v[244:247], v[212:215], v[156:159]
    ds_read_b64_tr_b16 v[242:243], v68 offset:13024
    s_waitcnt lgkmcnt(8)
    v_mfma_f32_16x16x32_bf16 v[160:163], v[248:251], v[208:211], v[160:163]
    ds_read_b64_tr_b16 v[244:245], v68 offset:4160
    v_mfma_f32_16x16x32_bf16 v[164:167], v[248:251], v[212:215], v[164:167]
    ds_read_b64_tr_b16 v[246:247], v68 offset:4672
    v_mfma_f32_16x16x32_bf16 v[168:171], v[224:227], v[208:211], v[168:171]
    ds_read_b64_tr_b16 v[248:249], v68 offset:4192
    v_mfma_f32_16x16x32_bf16 v[172:175], v[224:227], v[212:215], v[172:175]
    ds_read_b64_tr_b16 v[250:251], v68 offset:4704
    s_waitcnt lgkmcnt(8)
    s_waitcnt vmcnt(9)
    v_mfma_f32_16x16x32_bf16 v[128:131], v[228:231], v[216:219], v[128:131]
    ds_read_b64_tr_b16 v[224:225], v69 offset:4160
    s_waitcnt vmcnt(8)
    v_mfma_f32_16x16x32_bf16 v[132:135], v[228:231], v[220:223], v[132:135]
    ds_read_b64_tr_b16 v[226:227], v69 offset:4672
    s_add_u32 s96, s85, 11
    s_and_b32 s97, s96, 15
    s_lshl_b32 s98, s97, 14
    s_add_u32 s16, s98, s15
    buffer_load_dwordx4 v[208:211], v2, s[32:35], s16 offen sc1
    v_mfma_f32_16x16x32_bf16 v[136:139], v[232:235], v[216:219], v[136:139]
    ds_read_b64_tr_b16 v[228:229], v69 offset:4192
    v_mfma_f32_16x16x32_bf16 v[140:143], v[232:235], v[220:223], v[140:143]
    ds_read_b64_tr_b16 v[230:231], v69 offset:4704
    s_waitcnt lgkmcnt(8)
    v_mfma_f32_16x16x32_bf16 v[112:115], v[236:239], v[216:219], v[112:115]
    ds_read_b64_tr_b16 v[232:233], v68 offset:20800
    v_mfma_f32_16x16x32_bf16 v[116:119], v[236:239], v[220:223], v[116:119]
    ds_read_b64_tr_b16 v[234:235], v68 offset:21312
    v_mfma_f32_16x16x32_bf16 v[120:123], v[240:243], v[216:219], v[120:123]
    ds_read_b64_tr_b16 v[236:237], v68 offset:20832
    v_mfma_f32_16x16x32_bf16 v[124:127], v[240:243], v[220:223], v[124:127]
    ds_read_b64_tr_b16 v[238:239], v68 offset:21344
    buffer_load_dwordx4 v[212:215], v2, s[32:35], s16 offen offset:1024 sc1
    s_waitcnt lgkmcnt(8)
    v_mfma_f32_16x16x32_bf16 v[80:83], v[244:247], v[216:219], v[80:83]
    ds_read_b64_tr_b16 v[240:241], v69 offset:20800
    v_mfma_f32_16x16x32_bf16 v[84:87], v[244:247], v[220:223], v[84:87]
    ds_read_b64_tr_b16 v[242:243], v69 offset:21312
    v_mfma_f32_16x16x32_bf16 v[88:91], v[248:251], v[216:219], v[88:91]
    ds_read_b64_tr_b16 v[244:245], v69 offset:20832
    v_mfma_f32_16x16x32_bf16 v[92:95], v[248:251], v[220:223], v[92:95]
    ds_read_b64_tr_b16 v[246:247], v69 offset:21344
    s_waitcnt lgkmcnt(8)
    v_mfma_f32_16x16x32_bf16 v[96:99], v[224:227], v[216:219], v[96:99]
    s_barrier
    ds_read_b64_tr_b16 v[248:249], v69 offset:33280
    v_mfma_f32_16x16x32_bf16 v[100:103], v[224:227], v[220:223], v[100:103]
    ds_read_b64_tr_b16 v[250:251], v69 offset:33792
    v_mfma_f32_16x16x32_bf16 v[104:107], v[228:231], v[216:219], v[104:107]
    ds_read_b64_tr_b16 v[224:225], v69 offset:33312
    v_mfma_f32_16x16x32_bf16 v[108:111], v[228:231], v[220:223], v[108:111]
    ds_read_b64_tr_b16 v[226:227], v69 offset:33824
    s_waitcnt lgkmcnt(8)
    v_mfma_f32_16x16x32_bf16 v[144:147], v[232:235], v[216:219], v[144:147]
    ds_read_b64_tr_b16 v[228:229], v68 offset:33280
    v_mfma_f32_16x16x32_bf16 v[148:151], v[232:235], v[220:223], v[148:151]
    ds_read_b64_tr_b16 v[230:231], v68 offset:33792
    v_mfma_f32_16x16x32_bf16 v[152:155], v[236:239], v[216:219], v[152:155]
    ds_read_b64_tr_b16 v[232:233], v68 offset:33312
    v_mfma_f32_16x16x32_bf16 v[156:159], v[236:239], v[220:223], v[156:159]
    ds_read_b64_tr_b16 v[234:235], v68 offset:33824
    s_waitcnt lgkmcnt(8)
    v_mfma_f32_16x16x32_bf16 v[160:163], v[240:243], v[216:219], v[160:163]
    ds_read_b64_tr_b16 v[236:237], v68 offset:24960
    v_mfma_f32_16x16x32_bf16 v[164:167], v[240:243], v[220:223], v[164:167]
    ds_read_b64_tr_b16 v[238:239], v68 offset:25472
    v_mfma_f32_16x16x32_bf16 v[168:171], v[244:247], v[216:219], v[168:171]
    ds_read_b64_tr_b16 v[240:241], v68 offset:24992
    v_mfma_f32_16x16x32_bf16 v[172:175], v[244:247], v[220:223], v[172:175]
    ds_read_b64_tr_b16 v[242:243], v68 offset:25504
    s_waitcnt lgkmcnt(8)
    s_waitcnt vmcnt(9)
    v_mfma_f32_16x16x32_bf16 v[128:131], v[248:251], v[176:179], v[128:131]
    ds_read_b64_tr_b16 v[244:245], v69 offset:24960
    s_waitcnt vmcnt(8)
    v_mfma_f32_16x16x32_bf16 v[132:135], v[248:251], v[180:183], v[132:135]
    ds_read_b64_tr_b16 v[246:247], v69 offset:25472
    buffer_load_dwordx4 v[216:219], v2, s[32:35], s16 offen offset:2048 sc1
    v_mfma_f32_16x16x32_bf16 v[136:139], v[224:227], v[176:179], v[136:139]
    ds_read_b64_tr_b16 v[248:249], v69 offset:24992
    v_mfma_f32_16x16x32_bf16 v[140:143], v[224:227], v[180:183], v[140:143]
    ds_read_b64_tr_b16 v[250:251], v69 offset:25504
    s_waitcnt lgkmcnt(8)
    v_mfma_f32_16x16x32_bf16 v[112:115], v[228:231], v[176:179], v[112:115]
    ds_read_b64_tr_b16 v[224:225], v68 offset:41600
    v_mfma_f32_16x16x32_bf16 v[116:119], v[228:231], v[180:183], v[116:119]
    ds_read_b64_tr_b16 v[226:227], v68 offset:42112
    v_mfma_f32_16x16x32_bf16 v[120:123], v[232:235], v[176:179], v[120:123]
    ds_read_b64_tr_b16 v[228:229], v68 offset:41632
    v_mfma_f32_16x16x32_bf16 v[124:127], v[232:235], v[180:183], v[124:127]
    ds_read_b64_tr_b16 v[230:231], v68 offset:42144
    buffer_load_dwordx4 v[220:223], v2, s[32:35], s16 offen offset:3072 sc1
    s_waitcnt lgkmcnt(8)
    v_mfma_f32_16x16x32_bf16 v[80:83], v[236:239], v[176:179], v[80:83]
    ds_read_b64_tr_b16 v[232:233], v69 offset:41600
    v_mfma_f32_16x16x32_bf16 v[84:87], v[236:239], v[180:183], v[84:87]
    ds_read_b64_tr_b16 v[234:235], v69 offset:42112
    v_mfma_f32_16x16x32_bf16 v[88:91], v[240:243], v[176:179], v[88:91]
    ds_read_b64_tr_b16 v[236:237], v69 offset:41632
    v_mfma_f32_16x16x32_bf16 v[92:95], v[240:243], v[180:183], v[92:95]
    ds_read_b64_tr_b16 v[238:239], v69 offset:42144
    s_waitcnt lgkmcnt(8)
    v_mfma_f32_16x16x32_bf16 v[96:99], v[244:247], v[176:179], v[96:99]
    ds_read_b64_tr_b16 v[240:241], v69 offset:37440
    v_mfma_f32_16x16x32_bf16 v[100:103], v[244:247], v[180:183], v[100:103]
    ds_read_b64_tr_b16 v[242:243], v69 offset:37952
    v_mfma_f32_16x16x32_bf16 v[104:107], v[248:251], v[176:179], v[104:107]
    ds_read_b64_tr_b16 v[244:245], v69 offset:37472
    v_mfma_f32_16x16x32_bf16 v[108:111], v[248:251], v[180:183], v[108:111]
    ds_read_b64_tr_b16 v[246:247], v69 offset:37984
    s_waitcnt lgkmcnt(8)
    v_mfma_f32_16x16x32_bf16 v[144:147], v[224:227], v[176:179], v[144:147]
    ds_read_b64_tr_b16 v[248:249], v68 offset:37440
    v_mfma_f32_16x16x32_bf16 v[148:151], v[224:227], v[180:183], v[148:151]
    ds_read_b64_tr_b16 v[250:251], v68 offset:37952
    v_mfma_f32_16x16x32_bf16 v[152:155], v[228:231], v[176:179], v[152:155]
    ds_read_b64_tr_b16 v[224:225], v68 offset:37472
    v_mfma_f32_16x16x32_bf16 v[156:159], v[228:231], v[180:183], v[156:159]
    ds_read_b64_tr_b16 v[226:227], v68 offset:37984
    s_waitcnt lgkmcnt(8)
    v_mfma_f32_16x16x32_bf16 v[160:163], v[232:235], v[176:179], v[160:163]
    ds_read_b64_tr_b16 v[228:229], v68 offset:29120
    v_mfma_f32_16x16x32_bf16 v[164:167], v[232:235], v[180:183], v[164:167]
    ds_read_b64_tr_b16 v[230:231], v68 offset:29632
    v_mfma_f32_16x16x32_bf16 v[168:171], v[236:239], v[176:179], v[168:171]
    ds_read_b64_tr_b16 v[232:233], v68 offset:29152
    v_mfma_f32_16x16x32_bf16 v[172:175], v[236:239], v[180:183], v[172:175]
    ds_read_b64_tr_b16 v[234:235], v68 offset:29664
    s_waitcnt lgkmcnt(8)
    s_waitcnt vmcnt(9)
    v_mfma_f32_16x16x32_bf16 v[128:131], v[240:243], v[184:187], v[128:131]
    ds_read_b64_tr_b16 v[236:237], v69 offset:29120
    s_waitcnt vmcnt(8)
    v_mfma_f32_16x16x32_bf16 v[132:135], v[240:243], v[188:191], v[132:135]
    ds_read_b64_tr_b16 v[238:239], v69 offset:29632
    s_add_u32 s96, s85, 12
    s_and_b32 s97, s96, 15
    s_lshl_b32 s98, s97, 14
    s_add_u32 s16, s98, s15
    buffer_load_dwordx4 v[176:179], v2, s[32:35], s16 offen sc1
    v_mfma_f32_16x16x32_bf16 v[136:139], v[244:247], v[184:187], v[136:139]
    ds_read_b64_tr_b16 v[240:241], v69 offset:29152
    v_mfma_f32_16x16x32_bf16 v[140:143], v[244:247], v[188:191], v[140:143]
    ds_read_b64_tr_b16 v[242:243], v69 offset:29664
    s_waitcnt lgkmcnt(8)
    v_mfma_f32_16x16x32_bf16 v[112:115], v[248:251], v[184:187], v[112:115]
    ds_read_b64_tr_b16 v[244:245], v68 offset:45760
    v_mfma_f32_16x16x32_bf16 v[116:119], v[248:251], v[188:191], v[116:119]
    ds_read_b64_tr_b16 v[246:247], v68 offset:46272
    v_mfma_f32_16x16x32_bf16 v[120:123], v[224:227], v[184:187], v[120:123]
    ds_read_b64_tr_b16 v[248:249], v68 offset:45792
    v_mfma_f32_16x16x32_bf16 v[124:127], v[224:227], v[188:191], v[124:127]
    ds_read_b64_tr_b16 v[250:251], v68 offset:46304
    buffer_load_dwordx4 v[180:183], v2, s[32:35], s16 offen offset:1024 sc1
    s_waitcnt lgkmcnt(8)
    v_mfma_f32_16x16x32_bf16 v[80:83], v[228:231], v[184:187], v[80:83]
    ds_read_b64_tr_b16 v[224:225], v69 offset:45760
    v_mfma_f32_16x16x32_bf16 v[84:87], v[228:231], v[188:191], v[84:87]
    ds_read_b64_tr_b16 v[226:227], v69 offset:46272
    v_mfma_f32_16x16x32_bf16 v[88:91], v[232:235], v[184:187], v[88:91]
    ds_read_b64_tr_b16 v[228:229], v69 offset:45792
    v_mfma_f32_16x16x32_bf16 v[92:95], v[232:235], v[188:191], v[92:95]
    ds_read_b64_tr_b16 v[230:231], v69 offset:46304
    s_waitcnt lgkmcnt(8)
    v_mfma_f32_16x16x32_bf16 v[96:99], v[236:239], v[184:187], v[96:99]
    s_barrier
    ds_read_b64_tr_b16 v[232:233], v71 offset:8320
    v_mfma_f32_16x16x32_bf16 v[100:103], v[236:239], v[188:191], v[100:103]
    ds_read_b64_tr_b16 v[234:235], v71 offset:8832
    v_mfma_f32_16x16x32_bf16 v[104:107], v[240:243], v[184:187], v[104:107]
    ds_read_b64_tr_b16 v[236:237], v71 offset:8352
    v_mfma_f32_16x16x32_bf16 v[108:111], v[240:243], v[188:191], v[108:111]
    ds_read_b64_tr_b16 v[238:239], v71 offset:8864
    s_waitcnt lgkmcnt(8)
    v_mfma_f32_16x16x32_bf16 v[144:147], v[244:247], v[184:187], v[144:147]
    ds_read_b64_tr_b16 v[240:241], v70 offset:8320
    v_mfma_f32_16x16x32_bf16 v[148:151], v[244:247], v[188:191], v[148:151]
    ds_read_b64_tr_b16 v[242:243], v70 offset:8832
    v_mfma_f32_16x16x32_bf16 v[152:155], v[248:251], v[184:187], v[152:155]
    ds_read_b64_tr_b16 v[244:245], v70 offset:8352
    v_mfma_f32_16x16x32_bf16 v[156:159], v[248:251], v[188:191], v[156:159]
    ds_read_b64_tr_b16 v[246:247], v70 offset:8864
    s_waitcnt lgkmcnt(8)
    v_mfma_f32_16x16x32_bf16 v[160:163], v[224:227], v[184:187], v[160:163]
    ds_read_b64_tr_b16 v[248:249], v70
    v_mfma_f32_16x16x32_bf16 v[164:167], v[224:227], v[188:191], v[164:167]
    ds_read_b64_tr_b16 v[250:251], v70 offset:512
    v_mfma_f32_16x16x32_bf16 v[168:171], v[228:231], v[184:187], v[168:171]
    ds_read_b64_tr_b16 v[224:225], v70 offset:32
    v_mfma_f32_16x16x32_bf16 v[172:175], v[228:231], v[188:191], v[172:175]
    ds_read_b64_tr_b16 v[226:227], v70 offset:544
    s_waitcnt lgkmcnt(8)
    s_waitcnt vmcnt(9)
    v_mfma_f32_16x16x32_bf16 v[128:131], v[232:235], v[192:195], v[128:131]
    ds_read_b64_tr_b16 v[228:229], v71
    s_waitcnt vmcnt(8)
    v_mfma_f32_16x16x32_bf16 v[132:135], v[232:235], v[196:199], v[132:135]
    ds_read_b64_tr_b16 v[230:231], v71 offset:512
    buffer_load_dwordx4 v[184:187], v2, s[32:35], s16 offen offset:2048 sc1
    v_mfma_f32_16x16x32_bf16 v[136:139], v[236:239], v[192:195], v[136:139]
    ds_read_b64_tr_b16 v[232:233], v71 offset:32
    v_mfma_f32_16x16x32_bf16 v[140:143], v[236:239], v[196:199], v[140:143]
    ds_read_b64_tr_b16 v[234:235], v71 offset:544
    s_waitcnt lgkmcnt(8)
    v_mfma_f32_16x16x32_bf16 v[112:115], v[240:243], v[192:195], v[112:115]
    ds_read_b64_tr_b16 v[236:237], v70 offset:16640
    v_mfma_f32_16x16x32_bf16 v[116:119], v[240:243], v[196:199], v[116:119]
    ds_read_b64_tr_b16 v[238:239], v70 offset:17152
    v_mfma_f32_16x16x32_bf16 v[120:123], v[244:247], v[192:195], v[120:123]
    ds_read_b64_tr_b16 v[240:241], v70 offset:16672
    v_mfma_f32_16x16x32_bf16 v[124:127], v[244:247], v[196:199], v[124:127]
    ds_read_b64_tr_b16 v[242:243], v70 offset:17184
    buffer_load_dwordx4 v[188:191], v2, s[32:35], s16 offen offset:3072 sc1
    s_waitcnt lgkmcnt(8)
    v_mfma_f32_16x16x32_bf16 v[80:83], v[248:251], v[192:195], v[80:83]
    ds_read_b64_tr_b16 v[244:245], v71 offset:16640
    v_mfma_f32_16x16x32_bf16 v[84:87], v[248:251], v[196:199], v[84:87]
    ds_read_b64_tr_b16 v[246:247], v71 offset:17152
    v_mfma_f32_16x16x32_bf16 v[88:91], v[224:227], v[192:195], v[88:91]
    ds_read_b64_tr_b16 v[248:249], v71 offset:16672
    v_mfma_f32_16x16x32_bf16 v[92:95], v[224:227], v[196:199], v[92:95]
    ds_read_b64_tr_b16 v[250:251], v71 offset:17184
    s_waitcnt lgkmcnt(8)
    v_mfma_f32_16x16x32_bf16 v[96:99], v[228:231], v[192:195], v[96:99]
    ds_read_b64_tr_b16 v[224:225], v71 offset:12480
    v_mfma_f32_16x16x32_bf16 v[100:103], v[228:231], v[196:199], v[100:103]
    ds_read_b64_tr_b16 v[226:227], v71 offset:12992
    v_mfma_f32_16x16x32_bf16 v[104:107], v[232:235], v[192:195], v[104:107]
    ds_read_b64_tr_b16 v[228:229], v71 offset:12512
    v_mfma_f32_16x16x32_bf16 v[108:111], v[232:235], v[196:199], v[108:111]
    ds_read_b64_tr_b16 v[230:231], v71 offset:13024
    s_waitcnt lgkmcnt(8)
    v_mfma_f32_16x16x32_bf16 v[144:147], v[236:239], v[192:195], v[144:147]
    ds_read_b64_tr_b16 v[232:233], v70 offset:12480
    v_mfma_f32_16x16x32_bf16 v[148:151], v[236:239], v[196:199], v[148:151]
    ds_read_b64_tr_b16 v[234:235], v70 offset:12992
    v_mfma_f32_16x16x32_bf16 v[152:155], v[240:243], v[192:195], v[152:155]
    ds_read_b64_tr_b16 v[236:237], v70 offset:12512
    v_mfma_f32_16x16x32_bf16 v[156:159], v[240:243], v[196:199], v[156:159]
    ds_read_b64_tr_b16 v[238:239], v70 offset:13024
    s_waitcnt lgkmcnt(8)
    v_mfma_f32_16x16x32_bf16 v[160:163], v[244:247], v[192:195], v[160:163]
    ds_read_b64_tr_b16 v[240:241], v70 offset:4160
    v_mfma_f32_16x16x32_bf16 v[164:167], v[244:247], v[196:199], v[164:167]
    ds_read_b64_tr_b16 v[242:243], v70 offset:4672
    v_mfma_f32_16x16x32_bf16 v[168:171], v[248:251], v[192:195], v[168:171]
    ds_read_b64_tr_b16 v[244:245], v70 offset:4192
    v_mfma_f32_16x16x32_bf16 v[172:175], v[248:251], v[196:199], v[172:175]
    ds_read_b64_tr_b16 v[246:247], v70 offset:4704
    s_waitcnt lgkmcnt(8)
    s_waitcnt vmcnt(9)
    v_mfma_f32_16x16x32_bf16 v[128:131], v[224:227], v[200:203], v[128:131]
    ds_read_b64_tr_b16 v[248:249], v71 offset:4160
    s_waitcnt vmcnt(8)
    v_mfma_f32_16x16x32_bf16 v[132:135], v[224:227], v[204:207], v[132:135]
    ds_read_b64_tr_b16 v[250:251], v71 offset:4672
    s_add_u32 s96, s85, 13
    s_and_b32 s97, s96, 15
    s_lshl_b32 s98, s97, 14
    s_add_u32 s16, s98, s15
    buffer_load_dwordx4 v[192:195], v2, s[32:35], s16 offen sc1
    v_mfma_f32_16x16x32_bf16 v[136:139], v[228:231], v[200:203], v[136:139]
    ds_read_b64_tr_b16 v[224:225], v71 offset:4192
    v_mfma_f32_16x16x32_bf16 v[140:143], v[228:231], v[204:207], v[140:143]
    ds_read_b64_tr_b16 v[226:227], v71 offset:4704
    s_waitcnt lgkmcnt(8)
    v_mfma_f32_16x16x32_bf16 v[112:115], v[232:235], v[200:203], v[112:115]
    ds_read_b64_tr_b16 v[228:229], v70 offset:20800
    v_mfma_f32_16x16x32_bf16 v[116:119], v[232:235], v[204:207], v[116:119]
    ds_read_b64_tr_b16 v[230:231], v70 offset:21312
    v_mfma_f32_16x16x32_bf16 v[120:123], v[236:239], v[200:203], v[120:123]
    ds_read_b64_tr_b16 v[232:233], v70 offset:20832
    v_mfma_f32_16x16x32_bf16 v[124:127], v[236:239], v[204:207], v[124:127]
    ds_read_b64_tr_b16 v[234:235], v70 offset:21344
    buffer_load_dwordx4 v[196:199], v2, s[32:35], s16 offen offset:1024 sc1
    s_waitcnt lgkmcnt(8)
    v_mfma_f32_16x16x32_bf16 v[80:83], v[240:243], v[200:203], v[80:83]
    ds_read_b64_tr_b16 v[236:237], v71 offset:20800
    v_mfma_f32_16x16x32_bf16 v[84:87], v[240:243], v[204:207], v[84:87]
    ds_read_b64_tr_b16 v[238:239], v71 offset:21312
    v_mfma_f32_16x16x32_bf16 v[88:91], v[244:247], v[200:203], v[88:91]
    ds_read_b64_tr_b16 v[240:241], v71 offset:20832
    v_mfma_f32_16x16x32_bf16 v[92:95], v[244:247], v[204:207], v[92:95]
    ds_read_b64_tr_b16 v[242:243], v71 offset:21344
    s_waitcnt lgkmcnt(8)
    v_mfma_f32_16x16x32_bf16 v[96:99], v[248:251], v[200:203], v[96:99]
    s_barrier
    ds_read_b64_tr_b16 v[244:245], v71 offset:33280
    v_mfma_f32_16x16x32_bf16 v[100:103], v[248:251], v[204:207], v[100:103]
    ds_read_b64_tr_b16 v[246:247], v71 offset:33792
    v_mfma_f32_16x16x32_bf16 v[104:107], v[224:227], v[200:203], v[104:107]
    ds_read_b64_tr_b16 v[248:249], v71 offset:33312
    v_mfma_f32_16x16x32_bf16 v[108:111], v[224:227], v[204:207], v[108:111]
    ds_read_b64_tr_b16 v[250:251], v71 offset:33824
    s_waitcnt lgkmcnt(8)
    v_mfma_f32_16x16x32_bf16 v[144:147], v[228:231], v[200:203], v[144:147]
    ds_read_b64_tr_b16 v[224:225], v70 offset:33280
    v_mfma_f32_16x16x32_bf16 v[148:151], v[228:231], v[204:207], v[148:151]
    ds_read_b64_tr_b16 v[226:227], v70 offset:33792
    v_mfma_f32_16x16x32_bf16 v[152:155], v[232:235], v[200:203], v[152:155]
    ds_read_b64_tr_b16 v[228:229], v70 offset:33312
    v_mfma_f32_16x16x32_bf16 v[156:159], v[232:235], v[204:207], v[156:159]
    ds_read_b64_tr_b16 v[230:231], v70 offset:33824
    s_waitcnt lgkmcnt(8)
    v_mfma_f32_16x16x32_bf16 v[160:163], v[236:239], v[200:203], v[160:163]
    ds_read_b64_tr_b16 v[232:233], v70 offset:24960
    v_mfma_f32_16x16x32_bf16 v[164:167], v[236:239], v[204:207], v[164:167]
    ds_read_b64_tr_b16 v[234:235], v70 offset:25472
    v_mfma_f32_16x16x32_bf16 v[168:171], v[240:243], v[200:203], v[168:171]
    ds_read_b64_tr_b16 v[236:237], v70 offset:24992
    v_mfma_f32_16x16x32_bf16 v[172:175], v[240:243], v[204:207], v[172:175]
    ds_read_b64_tr_b16 v[238:239], v70 offset:25504
    s_waitcnt lgkmcnt(8)
    s_waitcnt vmcnt(9)
    v_mfma_f32_16x16x32_bf16 v[128:131], v[244:247], v[208:211], v[128:131]
    ds_read_b64_tr_b16 v[240:241], v71 offset:24960
    s_waitcnt vmcnt(8)
    v_mfma_f32_16x16x32_bf16 v[132:135], v[244:247], v[212:215], v[132:135]
    ds_read_b64_tr_b16 v[242:243], v71 offset:25472
    buffer_load_dwordx4 v[200:203], v2, s[32:35], s16 offen offset:2048 sc1
    v_mfma_f32_16x16x32_bf16 v[136:139], v[248:251], v[208:211], v[136:139]
    ds_read_b64_tr_b16 v[244:245], v71 offset:24992
    v_mfma_f32_16x16x32_bf16 v[140:143], v[248:251], v[212:215], v[140:143]
    ds_read_b64_tr_b16 v[246:247], v71 offset:25504
    s_waitcnt lgkmcnt(8)
    v_mfma_f32_16x16x32_bf16 v[112:115], v[224:227], v[208:211], v[112:115]
    ds_read_b64_tr_b16 v[248:249], v70 offset:41600
    v_mfma_f32_16x16x32_bf16 v[116:119], v[224:227], v[212:215], v[116:119]
    ds_read_b64_tr_b16 v[250:251], v70 offset:42112
    v_mfma_f32_16x16x32_bf16 v[120:123], v[228:231], v[208:211], v[120:123]
    ds_read_b64_tr_b16 v[224:225], v70 offset:41632
    v_mfma_f32_16x16x32_bf16 v[124:127], v[228:231], v[212:215], v[124:127]
    ds_read_b64_tr_b16 v[226:227], v70 offset:42144
    buffer_load_dwordx4 v[204:207], v2, s[32:35], s16 offen offset:3072 sc1
    s_waitcnt lgkmcnt(8)
    v_mfma_f32_16x16x32_bf16 v[80:83], v[232:235], v[208:211], v[80:83]
    ds_read_b64_tr_b16 v[228:229], v71 offset:41600
    v_mfma_f32_16x16x32_bf16 v[84:87], v[232:235], v[212:215], v[84:87]
    ds_read_b64_tr_b16 v[230:231], v71 offset:42112
    v_mfma_f32_16x16x32_bf16 v[88:91], v[236:239], v[208:211], v[88:91]
    ds_read_b64_tr_b16 v[232:233], v71 offset:41632
    v_mfma_f32_16x16x32_bf16 v[92:95], v[236:239], v[212:215], v[92:95]
    ds_read_b64_tr_b16 v[234:235], v71 offset:42144
    s_waitcnt lgkmcnt(8)
    v_mfma_f32_16x16x32_bf16 v[96:99], v[240:243], v[208:211], v[96:99]
    ds_read_b64_tr_b16 v[236:237], v71 offset:37440
    v_mfma_f32_16x16x32_bf16 v[100:103], v[240:243], v[212:215], v[100:103]
    ds_read_b64_tr_b16 v[238:239], v71 offset:37952
    v_mfma_f32_16x16x32_bf16 v[104:107], v[244:247], v[208:211], v[104:107]
    ds_read_b64_tr_b16 v[240:241], v71 offset:37472
    v_mfma_f32_16x16x32_bf16 v[108:111], v[244:247], v[212:215], v[108:111]
    ds_read_b64_tr_b16 v[242:243], v71 offset:37984
    s_waitcnt lgkmcnt(8)
    v_mfma_f32_16x16x32_bf16 v[144:147], v[248:251], v[208:211], v[144:147]
    ds_read_b64_tr_b16 v[244:245], v70 offset:37440
    v_mfma_f32_16x16x32_bf16 v[148:151], v[248:251], v[212:215], v[148:151]
    ds_read_b64_tr_b16 v[246:247], v70 offset:37952
    v_mfma_f32_16x16x32_bf16 v[152:155], v[224:227], v[208:211], v[152:155]
    ds_read_b64_tr_b16 v[248:249], v70 offset:37472
    v_mfma_f32_16x16x32_bf16 v[156:159], v[224:227], v[212:215], v[156:159]
    ds_read_b64_tr_b16 v[250:251], v70 offset:37984
    s_waitcnt lgkmcnt(8)
    v_mfma_f32_16x16x32_bf16 v[160:163], v[228:231], v[208:211], v[160:163]
    ds_read_b64_tr_b16 v[224:225], v70 offset:29120
    v_mfma_f32_16x16x32_bf16 v[164:167], v[228:231], v[212:215], v[164:167]
    ds_read_b64_tr_b16 v[226:227], v70 offset:29632
    v_mfma_f32_16x16x32_bf16 v[168:171], v[232:235], v[208:211], v[168:171]
    ds_read_b64_tr_b16 v[228:229], v70 offset:29152
    v_mfma_f32_16x16x32_bf16 v[172:175], v[232:235], v[212:215], v[172:175]
    ds_read_b64_tr_b16 v[230:231], v70 offset:29664
    s_waitcnt lgkmcnt(8)
    s_waitcnt vmcnt(9)
    v_mfma_f32_16x16x32_bf16 v[128:131], v[236:239], v[216:219], v[128:131]
    ds_read_b64_tr_b16 v[232:233], v71 offset:29120
    s_waitcnt vmcnt(8)
    v_mfma_f32_16x16x32_bf16 v[132:135], v[236:239], v[220:223], v[132:135]
    ds_read_b64_tr_b16 v[234:235], v71 offset:29632
    s_add_u32 s96, s85, 14
    s_and_b32 s97, s96, 15
    s_lshl_b32 s98, s97, 14
    s_add_u32 s16, s98, s15
    buffer_load_dwordx4 v[208:211], v2, s[32:35], s16 offen sc1
    v_mfma_f32_16x16x32_bf16 v[136:139], v[240:243], v[216:219], v[136:139]
    ds_read_b64_tr_b16 v[236:237], v71 offset:29152
    v_mfma_f32_16x16x32_bf16 v[140:143], v[240:243], v[220:223], v[140:143]
    ds_read_b64_tr_b16 v[238:239], v71 offset:29664
    s_waitcnt lgkmcnt(8)
    v_mfma_f32_16x16x32_bf16 v[112:115], v[244:247], v[216:219], v[112:115]
    ds_read_b64_tr_b16 v[240:241], v70 offset:45760
    v_mfma_f32_16x16x32_bf16 v[116:119], v[244:247], v[220:223], v[116:119]
    ds_read_b64_tr_b16 v[242:243], v70 offset:46272
    v_mfma_f32_16x16x32_bf16 v[120:123], v[248:251], v[216:219], v[120:123]
    ds_read_b64_tr_b16 v[244:245], v70 offset:45792
    v_mfma_f32_16x16x32_bf16 v[124:127], v[248:251], v[220:223], v[124:127]
    ds_read_b64_tr_b16 v[246:247], v70 offset:46304
    buffer_load_dwordx4 v[212:215], v2, s[32:35], s16 offen offset:1024 sc1
    s_waitcnt lgkmcnt(8)
    v_mfma_f32_16x16x32_bf16 v[80:83], v[224:227], v[216:219], v[80:83]
    ds_read_b64_tr_b16 v[248:249], v71 offset:45760
    v_mfma_f32_16x16x32_bf16 v[84:87], v[224:227], v[220:223], v[84:87]
    ds_read_b64_tr_b16 v[250:251], v71 offset:46272
    v_mfma_f32_16x16x32_bf16 v[88:91], v[228:231], v[216:219], v[88:91]
    ds_read_b64_tr_b16 v[224:225], v71 offset:45792
    v_mfma_f32_16x16x32_bf16 v[92:95], v[228:231], v[220:223], v[92:95]
    ds_read_b64_tr_b16 v[226:227], v71 offset:46304
    s_waitcnt lgkmcnt(8)
    v_mfma_f32_16x16x32_bf16 v[96:99], v[232:235], v[216:219], v[96:99]
    s_barrier
    ds_read_b64_tr_b16 v[228:229], v67 offset:8320
    v_mfma_f32_16x16x32_bf16 v[100:103], v[232:235], v[220:223], v[100:103]
    ds_read_b64_tr_b16 v[230:231], v67 offset:8832
    v_mfma_f32_16x16x32_bf16 v[104:107], v[236:239], v[216:219], v[104:107]
    ds_read_b64_tr_b16 v[232:233], v67 offset:8352
    v_mfma_f32_16x16x32_bf16 v[108:111], v[236:239], v[220:223], v[108:111]
    ds_read_b64_tr_b16 v[234:235], v67 offset:8864
    s_waitcnt lgkmcnt(8)
    v_mfma_f32_16x16x32_bf16 v[144:147], v[240:243], v[216:219], v[144:147]
    ds_read_b64_tr_b16 v[236:237], v66 offset:8320
    v_mfma_f32_16x16x32_bf16 v[148:151], v[240:243], v[220:223], v[148:151]
    ds_read_b64_tr_b16 v[238:239], v66 offset:8832
    v_mfma_f32_16x16x32_bf16 v[152:155], v[244:247], v[216:219], v[152:155]
    ds_read_b64_tr_b16 v[240:241], v66 offset:8352
    v_mfma_f32_16x16x32_bf16 v[156:159], v[244:247], v[220:223], v[156:159]
    ds_read_b64_tr_b16 v[242:243], v66 offset:8864
    s_waitcnt lgkmcnt(8)
    v_mfma_f32_16x16x32_bf16 v[160:163], v[248:251], v[216:219], v[160:163]
    ds_read_b64_tr_b16 v[244:245], v66
    v_mfma_f32_16x16x32_bf16 v[164:167], v[248:251], v[220:223], v[164:167]
    ds_read_b64_tr_b16 v[246:247], v66 offset:512
    v_mfma_f32_16x16x32_bf16 v[168:171], v[224:227], v[216:219], v[168:171]
    ds_read_b64_tr_b16 v[248:249], v66 offset:32
    v_mfma_f32_16x16x32_bf16 v[172:175], v[224:227], v[220:223], v[172:175]
    ds_read_b64_tr_b16 v[250:251], v66 offset:544
    s_waitcnt lgkmcnt(8)
    s_waitcnt vmcnt(9)
    v_mfma_f32_16x16x32_bf16 v[128:131], v[228:231], v[176:179], v[128:131]
    ds_read_b64_tr_b16 v[224:225], v67
    s_waitcnt vmcnt(8)
    v_mfma_f32_16x16x32_bf16 v[132:135], v[228:231], v[180:183], v[132:135]
    ds_read_b64_tr_b16 v[226:227], v67 offset:512
    buffer_load_dwordx4 v[216:219], v2, s[32:35], s16 offen offset:2048 sc1
    v_mfma_f32_16x16x32_bf16 v[136:139], v[232:235], v[176:179], v[136:139]
    ds_read_b64_tr_b16 v[228:229], v67 offset:32
    v_mfma_f32_16x16x32_bf16 v[140:143], v[232:235], v[180:183], v[140:143]
    ds_read_b64_tr_b16 v[230:231], v67 offset:544
    s_waitcnt lgkmcnt(8)
    v_mfma_f32_16x16x32_bf16 v[112:115], v[236:239], v[176:179], v[112:115]
    ds_read_b64_tr_b16 v[232:233], v66 offset:16640
    v_mfma_f32_16x16x32_bf16 v[116:119], v[236:239], v[180:183], v[116:119]
    ds_read_b64_tr_b16 v[234:235], v66 offset:17152
    v_mfma_f32_16x16x32_bf16 v[120:123], v[240:243], v[176:179], v[120:123]
    ds_read_b64_tr_b16 v[236:237], v66 offset:16672
    v_mfma_f32_16x16x32_bf16 v[124:127], v[240:243], v[180:183], v[124:127]
    ds_read_b64_tr_b16 v[238:239], v66 offset:17184
    buffer_load_dwordx4 v[220:223], v2, s[32:35], s16 offen offset:3072 sc1
    s_waitcnt lgkmcnt(8)
    v_mfma_f32_16x16x32_bf16 v[80:83], v[244:247], v[176:179], v[80:83]
    ds_read_b64_tr_b16 v[240:241], v67 offset:16640
    v_mfma_f32_16x16x32_bf16 v[84:87], v[244:247], v[180:183], v[84:87]
    ds_read_b64_tr_b16 v[242:243], v67 offset:17152
    v_mfma_f32_16x16x32_bf16 v[88:91], v[248:251], v[176:179], v[88:91]
    ds_read_b64_tr_b16 v[244:245], v67 offset:16672
    v_mfma_f32_16x16x32_bf16 v[92:95], v[248:251], v[180:183], v[92:95]
    ds_read_b64_tr_b16 v[246:247], v67 offset:17184
    s_waitcnt lgkmcnt(8)
    v_mfma_f32_16x16x32_bf16 v[96:99], v[224:227], v[176:179], v[96:99]
    ds_read_b64_tr_b16 v[248:249], v67 offset:12480
    v_mfma_f32_16x16x32_bf16 v[100:103], v[224:227], v[180:183], v[100:103]
    ds_read_b64_tr_b16 v[250:251], v67 offset:12992
    v_mfma_f32_16x16x32_bf16 v[104:107], v[228:231], v[176:179], v[104:107]
    ds_read_b64_tr_b16 v[224:225], v67 offset:12512
    v_mfma_f32_16x16x32_bf16 v[108:111], v[228:231], v[180:183], v[108:111]
    ds_read_b64_tr_b16 v[226:227], v67 offset:13024
    s_waitcnt lgkmcnt(8)
    v_mfma_f32_16x16x32_bf16 v[144:147], v[232:235], v[176:179], v[144:147]
    ds_read_b64_tr_b16 v[228:229], v66 offset:12480
    v_mfma_f32_16x16x32_bf16 v[148:151], v[232:235], v[180:183], v[148:151]
    ds_read_b64_tr_b16 v[230:231], v66 offset:12992
    v_mfma_f32_16x16x32_bf16 v[152:155], v[236:239], v[176:179], v[152:155]
    ds_read_b64_tr_b16 v[232:233], v66 offset:12512
    v_mfma_f32_16x16x32_bf16 v[156:159], v[236:239], v[180:183], v[156:159]
    ds_read_b64_tr_b16 v[234:235], v66 offset:13024
    s_waitcnt lgkmcnt(8)
    v_mfma_f32_16x16x32_bf16 v[160:163], v[240:243], v[176:179], v[160:163]
    ds_read_b64_tr_b16 v[236:237], v66 offset:4160
    v_mfma_f32_16x16x32_bf16 v[164:167], v[240:243], v[180:183], v[164:167]
    ds_read_b64_tr_b16 v[238:239], v66 offset:4672
    v_mfma_f32_16x16x32_bf16 v[168:171], v[244:247], v[176:179], v[168:171]
    ds_read_b64_tr_b16 v[240:241], v66 offset:4192
    v_mfma_f32_16x16x32_bf16 v[172:175], v[244:247], v[180:183], v[172:175]
    ds_read_b64_tr_b16 v[242:243], v66 offset:4704
    s_waitcnt lgkmcnt(8)
    s_waitcnt vmcnt(9)
    v_mfma_f32_16x16x32_bf16 v[128:131], v[248:251], v[184:187], v[128:131]
    ds_read_b64_tr_b16 v[244:245], v67 offset:4160
    s_waitcnt vmcnt(8)
    v_mfma_f32_16x16x32_bf16 v[132:135], v[248:251], v[188:191], v[132:135]
    ds_read_b64_tr_b16 v[246:247], v67 offset:4672
    s_add_u32 s96, s85, 15
    s_and_b32 s97, s96, 15
    s_lshl_b32 s98, s97, 14
    s_add_u32 s16, s98, s15
    buffer_load_dwordx4 v[176:179], v2, s[32:35], s16 offen sc1
    v_mfma_f32_16x16x32_bf16 v[136:139], v[224:227], v[184:187], v[136:139]
    ds_read_b64_tr_b16 v[248:249], v67 offset:4192
    v_mfma_f32_16x16x32_bf16 v[140:143], v[224:227], v[188:191], v[140:143]
    ds_read_b64_tr_b16 v[250:251], v67 offset:4704
    s_waitcnt lgkmcnt(8)
    v_mfma_f32_16x16x32_bf16 v[112:115], v[228:231], v[184:187], v[112:115]
    ds_read_b64_tr_b16 v[224:225], v66 offset:20800
    v_mfma_f32_16x16x32_bf16 v[116:119], v[228:231], v[188:191], v[116:119]
    ds_read_b64_tr_b16 v[226:227], v66 offset:21312
    v_mfma_f32_16x16x32_bf16 v[120:123], v[232:235], v[184:187], v[120:123]
    ds_read_b64_tr_b16 v[228:229], v66 offset:20832
    v_mfma_f32_16x16x32_bf16 v[124:127], v[232:235], v[188:191], v[124:127]
    ds_read_b64_tr_b16 v[230:231], v66 offset:21344
    buffer_load_dwordx4 v[180:183], v2, s[32:35], s16 offen offset:1024 sc1
    s_waitcnt lgkmcnt(8)
    v_mfma_f32_16x16x32_bf16 v[80:83], v[236:239], v[184:187], v[80:83]
    ds_read_b64_tr_b16 v[232:233], v67 offset:20800
    v_mfma_f32_16x16x32_bf16 v[84:87], v[236:239], v[188:191], v[84:87]
    ds_read_b64_tr_b16 v[234:235], v67 offset:21312
    v_mfma_f32_16x16x32_bf16 v[88:91], v[240:243], v[184:187], v[88:91]
    ds_read_b64_tr_b16 v[236:237], v67 offset:20832
    v_mfma_f32_16x16x32_bf16 v[92:95], v[240:243], v[188:191], v[92:95]
    ds_read_b64_tr_b16 v[238:239], v67 offset:21344
    s_waitcnt lgkmcnt(8)
    v_mfma_f32_16x16x32_bf16 v[96:99], v[244:247], v[184:187], v[96:99]
    s_barrier
    ds_read_b64_tr_b16 v[240:241], v67 offset:33280
    v_mfma_f32_16x16x32_bf16 v[100:103], v[244:247], v[188:191], v[100:103]
    ds_read_b64_tr_b16 v[242:243], v67 offset:33792
    v_mfma_f32_16x16x32_bf16 v[104:107], v[248:251], v[184:187], v[104:107]
    ds_read_b64_tr_b16 v[244:245], v67 offset:33312
    v_mfma_f32_16x16x32_bf16 v[108:111], v[248:251], v[188:191], v[108:111]
    ds_read_b64_tr_b16 v[246:247], v67 offset:33824
    s_waitcnt lgkmcnt(8)
    v_mfma_f32_16x16x32_bf16 v[144:147], v[224:227], v[184:187], v[144:147]
    ds_read_b64_tr_b16 v[248:249], v66 offset:33280
    v_mfma_f32_16x16x32_bf16 v[148:151], v[224:227], v[188:191], v[148:151]
    ds_read_b64_tr_b16 v[250:251], v66 offset:33792
    v_mfma_f32_16x16x32_bf16 v[152:155], v[228:231], v[184:187], v[152:155]
    ds_read_b64_tr_b16 v[224:225], v66 offset:33312
    v_mfma_f32_16x16x32_bf16 v[156:159], v[228:231], v[188:191], v[156:159]
    ds_read_b64_tr_b16 v[226:227], v66 offset:33824
    s_waitcnt lgkmcnt(8)
    v_mfma_f32_16x16x32_bf16 v[160:163], v[232:235], v[184:187], v[160:163]
    ds_read_b64_tr_b16 v[228:229], v66 offset:24960
    v_mfma_f32_16x16x32_bf16 v[164:167], v[232:235], v[188:191], v[164:167]
    ds_read_b64_tr_b16 v[230:231], v66 offset:25472
    v_mfma_f32_16x16x32_bf16 v[168:171], v[236:239], v[184:187], v[168:171]
    ds_read_b64_tr_b16 v[232:233], v66 offset:24992
    v_mfma_f32_16x16x32_bf16 v[172:175], v[236:239], v[188:191], v[172:175]
    ds_read_b64_tr_b16 v[234:235], v66 offset:25504
    s_waitcnt lgkmcnt(8)
    s_waitcnt vmcnt(9)
    v_mfma_f32_16x16x32_bf16 v[128:131], v[240:243], v[192:195], v[128:131]
    ds_read_b64_tr_b16 v[236:237], v67 offset:24960
    s_waitcnt vmcnt(8)
    v_mfma_f32_16x16x32_bf16 v[132:135], v[240:243], v[196:199], v[132:135]
    ds_read_b64_tr_b16 v[238:239], v67 offset:25472
    buffer_load_dwordx4 v[184:187], v2, s[32:35], s16 offen offset:2048 sc1
    v_mfma_f32_16x16x32_bf16 v[136:139], v[244:247], v[192:195], v[136:139]
    ds_read_b64_tr_b16 v[240:241], v67 offset:24992
    v_mfma_f32_16x16x32_bf16 v[140:143], v[244:247], v[196:199], v[140:143]
    ds_read_b64_tr_b16 v[242:243], v67 offset:25504
    s_waitcnt lgkmcnt(8)
    v_mfma_f32_16x16x32_bf16 v[112:115], v[248:251], v[192:195], v[112:115]
    ds_read_b64_tr_b16 v[244:245], v66 offset:41600
    v_mfma_f32_16x16x32_bf16 v[116:119], v[248:251], v[196:199], v[116:119]
    ds_read_b64_tr_b16 v[246:247], v66 offset:42112
    v_mfma_f32_16x16x32_bf16 v[120:123], v[224:227], v[192:195], v[120:123]
    ds_read_b64_tr_b16 v[248:249], v66 offset:41632
    v_mfma_f32_16x16x32_bf16 v[124:127], v[224:227], v[196:199], v[124:127]
    ds_read_b64_tr_b16 v[250:251], v66 offset:42144
    buffer_load_dwordx4 v[188:191], v2, s[32:35], s16 offen offset:3072 sc1
    s_barrier
    s_waitcnt lgkmcnt(8)
    v_mfma_f32_16x16x32_bf16 v[80:83], v[228:231], v[192:195], v[80:83]
    ds_read_b64_tr_b16 v[224:225], v67 offset:41600
    v_mfma_f32_16x16x32_bf16 v[84:87], v[228:231], v[196:199], v[84:87]
    ds_read_b64_tr_b16 v[226:227], v67 offset:42112
    v_mfma_f32_16x16x32_bf16 v[88:91], v[232:235], v[192:195], v[88:91]
    ds_read_b64_tr_b16 v[228:229], v67 offset:41632
    v_mfma_f32_16x16x32_bf16 v[92:95], v[232:235], v[196:199], v[92:95]
    ds_read_b64_tr_b16 v[230:231], v67 offset:42144
    s_waitcnt lgkmcnt(8)
    v_mfma_f32_16x16x32_bf16 v[96:99], v[236:239], v[192:195], v[96:99]
    ds_read_b64_tr_b16 v[232:233], v67 offset:37440
    v_mfma_f32_16x16x32_bf16 v[100:103], v[236:239], v[196:199], v[100:103]
    ds_read_b64_tr_b16 v[234:235], v67 offset:37952
    v_mfma_f32_16x16x32_bf16 v[104:107], v[240:243], v[192:195], v[104:107]
    ds_read_b64_tr_b16 v[236:237], v67 offset:37472
    v_mfma_f32_16x16x32_bf16 v[108:111], v[240:243], v[196:199], v[108:111]
    ds_read_b64_tr_b16 v[238:239], v67 offset:37984
    s_waitcnt lgkmcnt(8)
    v_mfma_f32_16x16x32_bf16 v[144:147], v[244:247], v[192:195], v[144:147]
    ds_read_b64_tr_b16 v[240:241], v66 offset:37440
    v_mfma_f32_16x16x32_bf16 v[148:151], v[244:247], v[196:199], v[148:151]
    ds_read_b64_tr_b16 v[242:243], v66 offset:37952
    v_mfma_f32_16x16x32_bf16 v[152:155], v[248:251], v[192:195], v[152:155]
    ds_read_b64_tr_b16 v[244:245], v66 offset:37472
    v_mfma_f32_16x16x32_bf16 v[156:159], v[248:251], v[196:199], v[156:159]
    ds_read_b64_tr_b16 v[246:247], v66 offset:37984
    s_waitcnt lgkmcnt(8)
    v_mfma_f32_16x16x32_bf16 v[160:163], v[224:227], v[192:195], v[160:163]
    ds_read_b64_tr_b16 v[248:249], v66 offset:29120
    v_mfma_f32_16x16x32_bf16 v[164:167], v[224:227], v[196:199], v[164:167]
    ds_read_b64_tr_b16 v[250:251], v66 offset:29632
    v_mfma_f32_16x16x32_bf16 v[168:171], v[228:231], v[192:195], v[168:171]
    ds_read_b64_tr_b16 v[224:225], v66 offset:29152
    v_mfma_f32_16x16x32_bf16 v[172:175], v[228:231], v[196:199], v[172:175]
    ds_read_b64_tr_b16 v[226:227], v66 offset:29664
    s_waitcnt lgkmcnt(8)
    s_waitcnt vmcnt(9)
    v_mfma_f32_16x16x32_bf16 v[128:131], v[232:235], v[200:203], v[128:131]
    ds_read_b64_tr_b16 v[228:229], v67 offset:29120
    s_waitcnt vmcnt(8)
    v_mfma_f32_16x16x32_bf16 v[132:135], v[232:235], v[204:207], v[132:135]
    ds_read_b64_tr_b16 v[230:231], v67 offset:29632
    v_mfma_f32_16x16x32_bf16 v[136:139], v[236:239], v[200:203], v[136:139]
    ds_read_b64_tr_b16 v[232:233], v67 offset:29152
    v_mfma_f32_16x16x32_bf16 v[140:143], v[236:239], v[204:207], v[140:143]
    ds_read_b64_tr_b16 v[234:235], v67 offset:29664
    s_waitcnt lgkmcnt(8)
    v_mfma_f32_16x16x32_bf16 v[112:115], v[240:243], v[200:203], v[112:115]
    ds_read_b64_tr_b16 v[236:237], v66 offset:45760
    v_mfma_f32_16x16x32_bf16 v[116:119], v[240:243], v[204:207], v[116:119]
    ds_read_b64_tr_b16 v[238:239], v66 offset:46272
    v_mfma_f32_16x16x32_bf16 v[120:123], v[244:247], v[200:203], v[120:123]
    ds_read_b64_tr_b16 v[240:241], v66 offset:45792
    v_mfma_f32_16x16x32_bf16 v[124:127], v[244:247], v[204:207], v[124:127]
    ds_read_b64_tr_b16 v[242:243], v66 offset:46304
    s_waitcnt lgkmcnt(8)
    v_mfma_f32_16x16x32_bf16 v[80:83], v[248:251], v[200:203], v[80:83]
    ds_read_b64_tr_b16 v[244:245], v67 offset:45760
    v_mfma_f32_16x16x32_bf16 v[84:87], v[248:251], v[204:207], v[84:87]
    ds_read_b64_tr_b16 v[246:247], v67 offset:46272
    v_mfma_f32_16x16x32_bf16 v[88:91], v[224:227], v[200:203], v[88:91]
    ds_read_b64_tr_b16 v[248:249], v67 offset:45792
    v_mfma_f32_16x16x32_bf16 v[92:95], v[224:227], v[204:207], v[92:95]
    ds_read_b64_tr_b16 v[250:251], v67 offset:46304
    s_waitcnt lgkmcnt(8)
    v_mfma_f32_16x16x32_bf16 v[96:99], v[228:231], v[200:203], v[96:99]
    ds_read_b64_tr_b16 v[224:225], v69 offset:8320
    v_mfma_f32_16x16x32_bf16 v[100:103], v[228:231], v[204:207], v[100:103]
    ds_read_b64_tr_b16 v[226:227], v69 offset:8832
    v_mfma_f32_16x16x32_bf16 v[104:107], v[232:235], v[200:203], v[104:107]
    ds_read_b64_tr_b16 v[228:229], v69 offset:8352
    v_mfma_f32_16x16x32_bf16 v[108:111], v[232:235], v[204:207], v[108:111]
    ds_read_b64_tr_b16 v[230:231], v69 offset:8864
    s_waitcnt lgkmcnt(8)
    v_mfma_f32_16x16x32_bf16 v[144:147], v[236:239], v[200:203], v[144:147]
    ds_read_b64_tr_b16 v[232:233], v68 offset:8320
    v_mfma_f32_16x16x32_bf16 v[148:151], v[236:239], v[204:207], v[148:151]
    ds_read_b64_tr_b16 v[234:235], v68 offset:8832
    v_mfma_f32_16x16x32_bf16 v[152:155], v[240:243], v[200:203], v[152:155]
    ds_read_b64_tr_b16 v[236:237], v68 offset:8352
    v_mfma_f32_16x16x32_bf16 v[156:159], v[240:243], v[204:207], v[156:159]
    ds_read_b64_tr_b16 v[238:239], v68 offset:8864
    s_waitcnt lgkmcnt(8)
    v_mfma_f32_16x16x32_bf16 v[160:163], v[244:247], v[200:203], v[160:163]
    ds_read_b64_tr_b16 v[240:241], v68
    v_mfma_f32_16x16x32_bf16 v[164:167], v[244:247], v[204:207], v[164:167]
    ds_read_b64_tr_b16 v[242:243], v68 offset:512
    v_mfma_f32_16x16x32_bf16 v[168:171], v[248:251], v[200:203], v[168:171]
    ds_read_b64_tr_b16 v[244:245], v68 offset:32
    v_mfma_f32_16x16x32_bf16 v[172:175], v[248:251], v[204:207], v[172:175]
    ds_read_b64_tr_b16 v[246:247], v68 offset:544
    s_waitcnt lgkmcnt(8)
    s_waitcnt vmcnt(7)
    v_mfma_f32_16x16x32_bf16 v[128:131], v[224:227], v[208:211], v[128:131]
    ds_read_b64_tr_b16 v[248:249], v69
    s_waitcnt vmcnt(6)
    v_mfma_f32_16x16x32_bf16 v[132:135], v[224:227], v[212:215], v[132:135]
    ds_read_b64_tr_b16 v[250:251], v69 offset:512
    v_mfma_f32_16x16x32_bf16 v[136:139], v[228:231], v[208:211], v[136:139]
    ds_read_b64_tr_b16 v[224:225], v69 offset:32
    v_mfma_f32_16x16x32_bf16 v[140:143], v[228:231], v[212:215], v[140:143]
    ds_read_b64_tr_b16 v[226:227], v69 offset:544
    s_waitcnt lgkmcnt(8)
    v_mfma_f32_16x16x32_bf16 v[112:115], v[232:235], v[208:211], v[112:115]
    ds_read_b64_tr_b16 v[228:229], v68 offset:16640
    v_mfma_f32_16x16x32_bf16 v[116:119], v[232:235], v[212:215], v[116:119]
    ds_read_b64_tr_b16 v[230:231], v68 offset:17152
    v_mfma_f32_16x16x32_bf16 v[120:123], v[236:239], v[208:211], v[120:123]
    ds_read_b64_tr_b16 v[232:233], v68 offset:16672
    v_mfma_f32_16x16x32_bf16 v[124:127], v[236:239], v[212:215], v[124:127]
    ds_read_b64_tr_b16 v[234:235], v68 offset:17184
    s_waitcnt lgkmcnt(8)
    v_mfma_f32_16x16x32_bf16 v[80:83], v[240:243], v[208:211], v[80:83]
    ds_read_b64_tr_b16 v[236:237], v69 offset:16640
    v_mfma_f32_16x16x32_bf16 v[84:87], v[240:243], v[212:215], v[84:87]
    ds_read_b64_tr_b16 v[238:239], v69 offset:17152
    v_mfma_f32_16x16x32_bf16 v[88:91], v[244:247], v[208:211], v[88:91]
    ds_read_b64_tr_b16 v[240:241], v69 offset:16672
    v_mfma_f32_16x16x32_bf16 v[92:95], v[244:247], v[212:215], v[92:95]
    ds_read_b64_tr_b16 v[242:243], v69 offset:17184
    s_waitcnt lgkmcnt(8)
    v_mfma_f32_16x16x32_bf16 v[96:99], v[248:251], v[208:211], v[96:99]
    ds_read_b64_tr_b16 v[244:245], v69 offset:12480
    v_mfma_f32_16x16x32_bf16 v[100:103], v[248:251], v[212:215], v[100:103]
    ds_read_b64_tr_b16 v[246:247], v69 offset:12992
    v_mfma_f32_16x16x32_bf16 v[104:107], v[224:227], v[208:211], v[104:107]
    ds_read_b64_tr_b16 v[248:249], v69 offset:12512
    v_mfma_f32_16x16x32_bf16 v[108:111], v[224:227], v[212:215], v[108:111]
    ds_read_b64_tr_b16 v[250:251], v69 offset:13024
    s_waitcnt lgkmcnt(8)
    v_mfma_f32_16x16x32_bf16 v[144:147], v[228:231], v[208:211], v[144:147]
    ds_read_b64_tr_b16 v[224:225], v68 offset:12480
    v_mfma_f32_16x16x32_bf16 v[148:151], v[228:231], v[212:215], v[148:151]
    ds_read_b64_tr_b16 v[226:227], v68 offset:12992
    v_mfma_f32_16x16x32_bf16 v[152:155], v[232:235], v[208:211], v[152:155]
    ds_read_b64_tr_b16 v[228:229], v68 offset:12512
    v_mfma_f32_16x16x32_bf16 v[156:159], v[232:235], v[212:215], v[156:159]
    ds_read_b64_tr_b16 v[230:231], v68 offset:13024
    s_waitcnt lgkmcnt(8)
    v_mfma_f32_16x16x32_bf16 v[160:163], v[236:239], v[208:211], v[160:163]
    ds_read_b64_tr_b16 v[232:233], v68 offset:4160
    v_mfma_f32_16x16x32_bf16 v[164:167], v[236:239], v[212:215], v[164:167]
    ds_read_b64_tr_b16 v[234:235], v68 offset:4672
    v_mfma_f32_16x16x32_bf16 v[168:171], v[240:243], v[208:211], v[168:171]
    ds_read_b64_tr_b16 v[236:237], v68 offset:4192
    v_mfma_f32_16x16x32_bf16 v[172:175], v[240:243], v[212:215], v[172:175]
    ds_read_b64_tr_b16 v[238:239], v68 offset:4704
    s_waitcnt lgkmcnt(8)
    s_waitcnt vmcnt(5)
    v_mfma_f32_16x16x32_bf16 v[128:131], v[244:247], v[216:219], v[128:131]
    ds_read_b64_tr_b16 v[240:241], v69 offset:4160
    s_waitcnt vmcnt(4)
    v_mfma_f32_16x16x32_bf16 v[132:135], v[244:247], v[220:223], v[132:135]
    ds_read_b64_tr_b16 v[242:243], v69 offset:4672
    v_mfma_f32_16x16x32_bf16 v[136:139], v[248:251], v[216:219], v[136:139]
    ds_read_b64_tr_b16 v[244:245], v69 offset:4192
    v_mfma_f32_16x16x32_bf16 v[140:143], v[248:251], v[220:223], v[140:143]
    ds_read_b64_tr_b16 v[246:247], v69 offset:4704
    s_waitcnt lgkmcnt(8)
    v_mfma_f32_16x16x32_bf16 v[112:115], v[224:227], v[216:219], v[112:115]
    ds_read_b64_tr_b16 v[248:249], v68 offset:20800
    v_mfma_f32_16x16x32_bf16 v[116:119], v[224:227], v[220:223], v[116:119]
    ds_read_b64_tr_b16 v[250:251], v68 offset:21312
    v_mfma_f32_16x16x32_bf16 v[120:123], v[228:231], v[216:219], v[120:123]
    ds_read_b64_tr_b16 v[224:225], v68 offset:20832
    v_mfma_f32_16x16x32_bf16 v[124:127], v[228:231], v[220:223], v[124:127]
    ds_read_b64_tr_b16 v[226:227], v68 offset:21344
    s_waitcnt lgkmcnt(8)
    v_mfma_f32_16x16x32_bf16 v[80:83], v[232:235], v[216:219], v[80:83]
    ds_read_b64_tr_b16 v[228:229], v69 offset:20800
    v_mfma_f32_16x16x32_bf16 v[84:87], v[232:235], v[220:223], v[84:87]
    ds_read_b64_tr_b16 v[230:231], v69 offset:21312
    v_mfma_f32_16x16x32_bf16 v[88:91], v[236:239], v[216:219], v[88:91]
    ds_read_b64_tr_b16 v[232:233], v69 offset:20832
    v_mfma_f32_16x16x32_bf16 v[92:95], v[236:239], v[220:223], v[92:95]
    ds_read_b64_tr_b16 v[234:235], v69 offset:21344
    s_waitcnt lgkmcnt(8)
    v_mfma_f32_16x16x32_bf16 v[96:99], v[240:243], v[216:219], v[96:99]
    ds_read_b64_tr_b16 v[236:237], v69 offset:33280
    v_mfma_f32_16x16x32_bf16 v[100:103], v[240:243], v[220:223], v[100:103]
    ds_read_b64_tr_b16 v[238:239], v69 offset:33792
    v_mfma_f32_16x16x32_bf16 v[104:107], v[244:247], v[216:219], v[104:107]
    ds_read_b64_tr_b16 v[240:241], v69 offset:33312
    v_mfma_f32_16x16x32_bf16 v[108:111], v[244:247], v[220:223], v[108:111]
    ds_read_b64_tr_b16 v[242:243], v69 offset:33824
    s_waitcnt lgkmcnt(8)
    v_mfma_f32_16x16x32_bf16 v[144:147], v[248:251], v[216:219], v[144:147]
    ds_read_b64_tr_b16 v[244:245], v68 offset:33280
    v_mfma_f32_16x16x32_bf16 v[148:151], v[248:251], v[220:223], v[148:151]
    ds_read_b64_tr_b16 v[246:247], v68 offset:33792
    v_mfma_f32_16x16x32_bf16 v[152:155], v[224:227], v[216:219], v[152:155]
    ds_read_b64_tr_b16 v[248:249], v68 offset:33312
    v_mfma_f32_16x16x32_bf16 v[156:159], v[224:227], v[220:223], v[156:159]
    ds_read_b64_tr_b16 v[250:251], v68 offset:33824
    s_waitcnt lgkmcnt(8)
    v_mfma_f32_16x16x32_bf16 v[160:163], v[228:231], v[216:219], v[160:163]
    ds_read_b64_tr_b16 v[224:225], v68 offset:24960
    v_mfma_f32_16x16x32_bf16 v[164:167], v[228:231], v[220:223], v[164:167]
    ds_read_b64_tr_b16 v[226:227], v68 offset:25472
    v_mfma_f32_16x16x32_bf16 v[168:171], v[232:235], v[216:219], v[168:171]
    ds_read_b64_tr_b16 v[228:229], v68 offset:24992
    v_mfma_f32_16x16x32_bf16 v[172:175], v[232:235], v[220:223], v[172:175]
    ds_read_b64_tr_b16 v[230:231], v68 offset:25504
    s_waitcnt lgkmcnt(8)
    s_waitcnt vmcnt(3)
    v_mfma_f32_16x16x32_bf16 v[128:131], v[236:239], v[176:179], v[128:131]
    ds_read_b64_tr_b16 v[232:233], v69 offset:24960
    s_waitcnt vmcnt(2)
    v_mfma_f32_16x16x32_bf16 v[132:135], v[236:239], v[180:183], v[132:135]
    ds_read_b64_tr_b16 v[234:235], v69 offset:25472
    v_mfma_f32_16x16x32_bf16 v[136:139], v[240:243], v[176:179], v[136:139]
    ds_read_b64_tr_b16 v[236:237], v69 offset:24992
    v_mfma_f32_16x16x32_bf16 v[140:143], v[240:243], v[180:183], v[140:143]
    ds_read_b64_tr_b16 v[238:239], v69 offset:25504
    s_waitcnt lgkmcnt(8)
    v_mfma_f32_16x16x32_bf16 v[112:115], v[244:247], v[176:179], v[112:115]
    ds_read_b64_tr_b16 v[240:241], v68 offset:41600
    v_mfma_f32_16x16x32_bf16 v[116:119], v[244:247], v[180:183], v[116:119]
    ds_read_b64_tr_b16 v[242:243], v68 offset:42112
    v_mfma_f32_16x16x32_bf16 v[120:123], v[248:251], v[176:179], v[120:123]
    ds_read_b64_tr_b16 v[244:245], v68 offset:41632
    v_mfma_f32_16x16x32_bf16 v[124:127], v[248:251], v[180:183], v[124:127]
    ds_read_b64_tr_b16 v[246:247], v68 offset:42144
    s_waitcnt lgkmcnt(8)
    v_mfma_f32_16x16x32_bf16 v[80:83], v[224:227], v[176:179], v[80:83]
    ds_read_b64_tr_b16 v[248:249], v69 offset:41600
    v_mfma_f32_16x16x32_bf16 v[84:87], v[224:227], v[180:183], v[84:87]
    ds_read_b64_tr_b16 v[250:251], v69 offset:42112
    v_mfma_f32_16x16x32_bf16 v[88:91], v[228:231], v[176:179], v[88:91]
    ds_read_b64_tr_b16 v[224:225], v69 offset:41632
    v_mfma_f32_16x16x32_bf16 v[92:95], v[228:231], v[180:183], v[92:95]
    ds_read_b64_tr_b16 v[226:227], v69 offset:42144
    s_waitcnt lgkmcnt(8)
    v_mfma_f32_16x16x32_bf16 v[96:99], v[232:235], v[176:179], v[96:99]
    ds_read_b64_tr_b16 v[228:229], v69 offset:37440
    v_mfma_f32_16x16x32_bf16 v[100:103], v[232:235], v[180:183], v[100:103]
    ds_read_b64_tr_b16 v[230:231], v69 offset:37952
    v_mfma_f32_16x16x32_bf16 v[104:107], v[236:239], v[176:179], v[104:107]
    ds_read_b64_tr_b16 v[232:233], v69 offset:37472
    v_mfma_f32_16x16x32_bf16 v[108:111], v[236:239], v[180:183], v[108:111]
    ds_read_b64_tr_b16 v[234:235], v69 offset:37984
    s_waitcnt lgkmcnt(8)
    v_mfma_f32_16x16x32_bf16 v[144:147], v[240:243], v[176:179], v[144:147]
    ds_read_b64_tr_b16 v[236:237], v68 offset:37440
    v_mfma_f32_16x16x32_bf16 v[148:151], v[240:243], v[180:183], v[148:151]
    ds_read_b64_tr_b16 v[238:239], v68 offset:37952
    v_mfma_f32_16x16x32_bf16 v[152:155], v[244:247], v[176:179], v[152:155]
    ds_read_b64_tr_b16 v[240:241], v68 offset:37472
    v_mfma_f32_16x16x32_bf16 v[156:159], v[244:247], v[180:183], v[156:159]
    ds_read_b64_tr_b16 v[242:243], v68 offset:37984
    s_waitcnt lgkmcnt(8)
    v_mfma_f32_16x16x32_bf16 v[160:163], v[248:251], v[176:179], v[160:163]
    ds_read_b64_tr_b16 v[244:245], v68 offset:29120
    v_mfma_f32_16x16x32_bf16 v[164:167], v[248:251], v[180:183], v[164:167]
    ds_read_b64_tr_b16 v[246:247], v68 offset:29632
    v_mfma_f32_16x16x32_bf16 v[168:171], v[224:227], v[176:179], v[168:171]
    ds_read_b64_tr_b16 v[248:249], v68 offset:29152
    v_mfma_f32_16x16x32_bf16 v[172:175], v[224:227], v[180:183], v[172:175]
    ds_read_b64_tr_b16 v[250:251], v68 offset:29664
    s_waitcnt lgkmcnt(8)
    s_waitcnt vmcnt(1)
    v_mfma_f32_16x16x32_bf16 v[128:131], v[228:231], v[184:187], v[128:131]
    ds_read_b64_tr_b16 v[224:225], v69 offset:29120
    s_waitcnt vmcnt(0)
    v_mfma_f32_16x16x32_bf16 v[132:135], v[228:231], v[188:191], v[132:135]
    ds_read_b64_tr_b16 v[226:227], v69 offset:29632
    v_mfma_f32_16x16x32_bf16 v[136:139], v[232:235], v[184:187], v[136:139]
    ds_read_b64_tr_b16 v[228:229], v69 offset:29152
    v_mfma_f32_16x16x32_bf16 v[140:143], v[232:235], v[188:191], v[140:143]
    ds_read_b64_tr_b16 v[230:231], v69 offset:29664
    s_waitcnt lgkmcnt(8)
    v_mfma_f32_16x16x32_bf16 v[112:115], v[236:239], v[184:187], v[112:115]
    ds_read_b64_tr_b16 v[232:233], v68 offset:45760
    v_mfma_f32_16x16x32_bf16 v[116:119], v[236:239], v[188:191], v[116:119]
    ds_read_b64_tr_b16 v[234:235], v68 offset:46272
    v_mfma_f32_16x16x32_bf16 v[120:123], v[240:243], v[184:187], v[120:123]
    ds_read_b64_tr_b16 v[236:237], v68 offset:45792
    v_mfma_f32_16x16x32_bf16 v[124:127], v[240:243], v[188:191], v[124:127]
    ds_read_b64_tr_b16 v[238:239], v68 offset:46304
    s_waitcnt lgkmcnt(8)
    v_mfma_f32_16x16x32_bf16 v[80:83], v[244:247], v[184:187], v[80:83]
    ds_read_b64_tr_b16 v[240:241], v69 offset:45760
    v_mfma_f32_16x16x32_bf16 v[84:87], v[244:247], v[188:191], v[84:87]
    ds_read_b64_tr_b16 v[242:243], v69 offset:46272
    v_mfma_f32_16x16x32_bf16 v[88:91], v[248:251], v[184:187], v[88:91]
    ds_read_b64_tr_b16 v[244:245], v69 offset:45792
    v_mfma_f32_16x16x32_bf16 v[92:95], v[248:251], v[188:191], v[92:95]
    ds_read_b64_tr_b16 v[246:247], v69 offset:46304
    s_waitcnt lgkmcnt(8)
    v_mfma_f32_16x16x32_bf16 v[96:99], v[224:227], v[184:187], v[96:99]
    v_mfma_f32_16x16x32_bf16 v[100:103], v[224:227], v[188:191], v[100:103]
    v_mfma_f32_16x16x32_bf16 v[104:107], v[228:231], v[184:187], v[104:107]
    v_mfma_f32_16x16x32_bf16 v[108:111], v[228:231], v[188:191], v[108:111]
    s_waitcnt lgkmcnt(4)
    v_mfma_f32_16x16x32_bf16 v[144:147], v[232:235], v[184:187], v[144:147]
    v_mfma_f32_16x16x32_bf16 v[148:151], v[232:235], v[188:191], v[148:151]
    v_mfma_f32_16x16x32_bf16 v[152:155], v[236:239], v[184:187], v[152:155]
    v_mfma_f32_16x16x32_bf16 v[156:159], v[236:239], v[188:191], v[156:159]
    s_waitcnt lgkmcnt(0)
    v_mfma_f32_16x16x32_bf16 v[160:163], v[240:243], v[184:187], v[160:163]
    v_mfma_f32_16x16x32_bf16 v[164:167], v[240:243], v[188:191], v[164:167]
    v_mfma_f32_16x16x32_bf16 v[168:171], v[244:247], v[184:187], v[168:171]
    v_mfma_f32_16x16x32_bf16 v[172:175], v[244:247], v[188:191], v[172:175]
    v_cvt_pk_bf16_f32 v52, v128, v129
    v_cvt_pk_bf16_f32 v53, v130, v131
    v_cvt_pk_bf16_f32 v54, v132, v133
    v_cvt_pk_bf16_f32 v55, v134, v135
    v_cvt_pk_bf16_f32 v56, v136, v137
    v_cvt_pk_bf16_f32 v57, v138, v139
    v_cvt_pk_bf16_f32 v58, v140, v141
    v_cvt_pk_bf16_f32 v59, v142, v143
    ds_write_b64 v77, v[52:53]
    ds_write_b64 v77, v[54:55] offset:256
    ds_write_b64 v77, v[56:57] offset:1024
    ds_write_b64 v77, v[58:59] offset:1280
    v_cvt_pk_bf16_f32 v36, v112, v113
    v_cvt_pk_bf16_f32 v37, v114, v115
    v_cvt_pk_bf16_f32 v38, v116, v117
    v_cvt_pk_bf16_f32 v39, v118, v119
    v_cvt_pk_bf16_f32 v40, v120, v121
    v_cvt_pk_bf16_f32 v41, v122, v123
    v_cvt_pk_bf16_f32 v42, v124, v125
    v_cvt_pk_bf16_f32 v43, v126, v127
    v_permlane16_swap_b32 v36, v38
    v_permlane16_swap_b32 v37, v39
    v_permlane16_swap_b32 v40, v42
    v_permlane16_swap_b32 v41, v43
    s_waitcnt lgkmcnt(0)
    s_barrier
    s_setprio 0
    v_mfma_f32_32x32x16_bf16 v[112:127], v[28:31], v[36:39], 0
    v_mfma_f32_32x32x16_bf16 v[112:127], v[32:35], v[40:43], v[112:127]
    v_cvt_pk_bf16_f32 v52, v144, v145
    v_cvt_pk_bf16_f32 v53, v146, v147
    v_cvt_pk_bf16_f32 v54, v148, v149
    v_cvt_pk_bf16_f32 v55, v150, v151
    v_cvt_pk_bf16_f32 v56, v152, v153
    v_cvt_pk_bf16_f32 v57, v154, v155
    v_cvt_pk_bf16_f32 v58, v156, v157
    v_cvt_pk_bf16_f32 v59, v158, v159
    ds_write_b64 v78, v[52:53]
    ds_write_b64 v78, v[54:55] offset:512
    ds_write_b64 v78, v[56:57] offset:4096
    ds_write_b64 v78, v[58:59] offset:4608
    v_cvt_pk_bf16_f32 v44, v160, v161
    v_cvt_pk_bf16_f32 v45, v162, v163
    v_cvt_pk_bf16_f32 v46, v164, v165
    v_cvt_pk_bf16_f32 v47, v166, v167
    v_cvt_pk_bf16_f32 v48, v168, v169
    v_cvt_pk_bf16_f32 v49, v170, v171
    v_cvt_pk_bf16_f32 v50, v172, v173
    v_cvt_pk_bf16_f32 v51, v174, v175
    ds_write_b64 v78, v[44:45] offset:8192
    ds_write_b64 v78, v[46:47] offset:8704
    ds_write_b64 v78, v[48:49] offset:12288
    ds_write_b64 v78, v[50:51] offset:12800
    v_cvt_pk_bf16_f32 v36, v96, v97
    v_cvt_pk_bf16_f32 v37, v98, v99
    v_cvt_pk_bf16_f32 v38, v100, v101
    v_cvt_pk_bf16_f32 v39, v102, v103
    v_cvt_pk_bf16_f32 v40, v104, v105
    v_cvt_pk_bf16_f32 v41, v106, v107
    v_cvt_pk_bf16_f32 v42, v108, v109
    v_cvt_pk_bf16_f32 v43, v110, v111
    ds_write_b64 v77, v[36:37] offset:2048
    ds_write_b64 v77, v[38:39] offset:2304
    ds_write_b64 v77, v[40:41] offset:3072
    ds_write_b64 v77, v[42:43] offset:3328
    v_cvt_pk_bf16_f32 v44, v80, v81
    v_cvt_pk_bf16_f32 v45, v82, v83
    v_cvt_pk_bf16_f32 v46, v84, v85
    v_cvt_pk_bf16_f32 v47, v86, v87
    v_cvt_pk_bf16_f32 v48, v88, v89
    v_cvt_pk_bf16_f32 v49, v90, v91
    v_cvt_pk_bf16_f32 v50, v92, v93
    v_cvt_pk_bf16_f32 v51, v94, v95
    v_permlane16_swap_b32 v44, v46
    v_permlane16_swap_b32 v45, v47
    v_permlane16_swap_b32 v48, v50
    v_permlane16_swap_b32 v49, v51
    s_branch L_JOIN
L_HELP:
    s_add_u32 s96, s85, 5
    s_and_b32 s97, s96, 15
    s_lshl3_add_u32 s98, s97, s3
    s_sub_u32 s99, s98, 4
    s_mul_i32 s96, s99, 49152
    s_lshl_b32 s97, s11, 7
    s_add_u32 s82, s96, s97
    s_sub_u32 s96, s3, 4
    s_lshr_b32 s97, s96, 1
    s_mul_i32 s98, s97, 2080
    s_sub_u32 s99, s3, 4
    s_and_b32 s96, s99, 1
    s_mul_i32 s97, s96, 1056
    s_add_u32 s99, s98, s97
    s_add_u32 s20, s99, 124800
    s_mov_b32 m0, s20
    s_nop 0
    buffer_load_dwordx4 v62, s[40:43], s82 offen lds
    s_add_u32 s82, s82, 2048
    s_add_u32 m0, s20, 8320
    s_nop 0
    buffer_load_dwordx4 v62, s[40:43], s82 offen lds
    s_add_u32 s82, s82, 2048
    s_add_u32 m0, s20, 16640
    s_nop 0
    buffer_load_dwordx4 v62, s[40:43], s82 offen lds
    s_add_u32 s96, s85, 5
    s_and_b32 s97, s96, 15
    s_lshl3_add_u32 s98, s97, s3
    s_mul_i32 s99, s98, 49152
    s_lshl_b32 s96, s11, 7
    s_add_u32 s82, s99, s96
    s_lshr_b32 s96, s3, 1
    s_mul_i32 s97, s96, 2080
    s_and_b32 s98, s3, 1
    s_mul_i32 s99, s98, 1056
    s_add_u32 s96, s97, s99
    s_add_u32 s20, s96, 124800
    s_mov_b32 m0, s20
    s_nop 0
    buffer_load_dwordx4 v62, s[40:43], s82 offen lds
    s_add_u32 s82, s82, 2048
    s_add_u32 m0, s20, 8320
    s_nop 0
    buffer_load_dwordx4 v62, s[40:43], s82 offen lds
    s_add_u32 s82, s82, 2048
    s_add_u32 m0, s20, 16640
    s_nop 0
    buffer_load_dwordx4 v62, s[40:43], s82 offen lds
    s_and_b32 s96, s9, 3
    s_lshl2_add_u32 s97, s96, s3
    s_sub_u32 s98, s97, 4
    s_lshl_b32 s13, s98, 7
    v_lshrrev_b32 v61, 3, v1
    v_lshl_add_u32 v61, v61, 4, s13
    v_lshrrev_b32 v60, 3, v1
    v_mul_u32_u24 v60, 98304, v60
    v_and_b32 v9, 7, v1
    v_lshl_add_u32 v60, v9, 4, v60
    s_mul_i32 s96, s13, 6144
    s_bfe_u32 s97, s9, 131074
    s_lshl_b32 s98, s8, 1
    s_lshl4_add_u32 s99, s97, s98
    s_lshr_b32 s97, s9, 4
    s_add_u32 s98, s99, s97
    s_lshl_b32 s99, s98, 7
    s_add_u32 s97, s96, s99
    s_add_u32 s17, s97, 4096
    global_load_dwordx4 v[120:123], v61, s[86:87]
    s_waitcnt vmcnt(13)
    s_barrier
    buffer_load_dwordx4 v[80:83], v60, s[48:51], s17 offen nt
    s_add_u32 s17, s17, 12288
    buffer_load_dwordx4 v[84:87], v60, s[48:51], s17 offen nt
    s_add_u32 s17, s17, 12288
    s_waitcnt lgkmcnt(0)
    s_load_dword s24, s[32:33], s92 offset:512 glc
    s_load_dword s25, s[32:33], s92 offset:256 glc
    s_load_dword s26, s[32:33], s92 offset:1024 glc
    s_load_dword s27, s[32:33], s92 offset:768 glc
    s_waitcnt vmcnt(12)
    s_barrier
    s_add_u32 s96, s85, 6
    s_and_b32 s97, s96, 15
    s_lshl3_add_u32 s98, s97, s3
    s_sub_u32 s99, s98, 4
    s_mul_i32 s96, s99, 49152
    s_lshl_b32 s97, s11, 7
    s_add_u32 s82, s96, s97
    s_sub_u32 s96, s3, 4
    s_lshr_b32 s97, s96, 1
    s_mul_i32 s98, s97, 2080
    s_sub_u32 s99, s3, 4
    s_and_b32 s96, s99, 1
    s_mul_i32 s97, s96, 1056
    s_add_u32 s20, s98, s97
    s_mov_b32 m0, s20
    s_nop 0
    buffer_load_dwordx4 v62, s[40:43], s82 offen lds
    s_add_u32 s82, s82, 2048
    s_add_u32 m0, s20, 8320
    s_nop 0
    buffer_load_dwordx4 v62, s[40:43], s82 offen lds
    s_add_u32 s82, s82, 2048
    s_add_u32 m0, s20, 16640
    s_nop 0
    buffer_load_dwordx4 v62, s[40:43], s82 offen lds
    s_add_u32 s96, s85, 6
    s_and_b32 s97, s96, 15
    s_lshl3_add_u32 s98, s97, s3
    s_mul_i32 s99, s98, 49152
    s_lshl_b32 s96, s11, 7
    s_add_u32 s82, s99, s96
    s_lshr_b32 s96, s3, 1
    s_mul_i32 s97, s96, 2080
    s_and_b32 s98, s3, 1
    s_mul_i32 s99, s98, 1056
    s_add_u32 s20, s97, s99
    s_mov_b32 m0, s20
    s_nop 0
    buffer_load_dwordx4 v62, s[40:43], s82 offen lds
    s_add_u32 s82, s82, 2048
    s_add_u32 m0, s20, 8320
    s_nop 0
    buffer_load_dwordx4 v62, s[40:43], s82 offen lds
    s_add_u32 s82, s82, 2048
    s_add_u32 m0, s20, 16640
    s_nop 0
    buffer_load_dwordx4 v62, s[40:43], s82 offen lds
    s_waitcnt vmcnt(8)
    v_lshlrev_b32 v112, 16, v120
    v_mul_f32 v4, s7, v112
    v_exp_f32 v4, -v4
    s_nop 0
    v_add_f32 v4, 1.0, v4
    v_rcp_f32 v4, v4
    s_nop 0
    v_mul_f32 v112, v112, v4
    v_cvt_pk_bf16_f32 v112, 0, v112
    v_and_b32 v113, s6, v120
    v_mul_f32 v5, s7, v113
    v_exp_f32 v5, -v5
    s_nop 0
    v_add_f32 v5, 1.0, v5
    v_rcp_f32 v5, v5
    s_nop 0
    v_mul_f32 v113, v113, v5
    v_cvt_pk_bf16_f32 v113, 0, v113
    v_lshlrev_b32 v114, 16, v121
    v_mul_f32 v4, s7, v114
    v_exp_f32 v4, -v4
    s_nop 0
    v_add_f32 v4, 1.0, v4
    v_rcp_f32 v4, v4
    s_nop 0
    v_mul_f32 v114, v114, v4
    v_cvt_pk_bf16_f32 v114, 0, v114
    v_and_b32 v115, s6, v121
    v_mul_f32 v5, s7, v115
    v_exp_f32 v5, -v5
    s_nop 0
    v_add_f32 v5, 1.0, v5
    v_rcp_f32 v5, v5
    s_nop 0
    v_mul_f32 v115, v115, v5
    v_cvt_pk_bf16_f32 v115, 0, v115
    s_barrier
    s_add_u32 s96, s85, 7
    s_and_b32 s97, s96, 15
    s_lshl3_add_u32 s98, s97, s3
    s_sub_u32 s99, s98, 4
    s_mul_i32 s96, s99, 49152
    s_lshl_b32 s97, s11, 7
    s_add_u32 s82, s96, s97
    s_sub_u32 s96, s3, 4
    s_lshr_b32 s97, s96, 1
    s_mul_i32 s98, s97, 2080
    s_sub_u32 s99, s3, 4
    s_and_b32 s96, s99, 1
    s_mul_i32 s97, s96, 1056
    s_add_u32 s99, s98, s97
    s_add_u32 s20, s99, 24960
    s_mov_b32 m0, s20
    s_nop 0
    buffer_load_dwordx4 v62, s[40:43], s82 offen lds
    s_add_u32 s82, s82, 2048
    s_add_u32 m0, s20, 8320
    s_nop 0
    buffer_load_dwordx4 v62, s[40:43], s82 offen lds
    s_add_u32 s82, s82, 2048
    s_add_u32 m0, s20, 16640
    s_nop 0
    buffer_load_dwordx4 v62, s[40:43], s82 offen lds
    s_add_u32 s96, s85, 7
    s_and_b32 s97, s96, 15
    s_lshl3_add_u32 s98, s97, s3
    s_mul_i32 s99, s98, 49152
    s_lshl_b32 s96, s11, 7
    s_add_u32 s82, s99, s96
    s_lshr_b32 s96, s3, 1
    s_mul_i32 s97, s96, 2080
    s_and_b32 s98, s3, 1
    s_mul_i32 s99, s98, 1056
    s_add_u32 s96, s97, s99
    s_add_u32 s20, s96, 24960
    s_mov_b32 m0, s20
    s_nop 0
    buffer_load_dwordx4 v62, s[40:43], s82 offen lds
    s_add_u32 s82, s82, 2048
    s_add_u32 m0, s20, 8320
    s_nop 0
    buffer_load_dwordx4 v62, s[40:43], s82 offen lds
    s_add_u32 s82, s82, 2048
    s_add_u32 m0, s20, 16640
    s_nop 0
    buffer_load_dwordx4 v62, s[40:43], s82 offen lds
    buffer_load_dwordx4 v[88:91], v60, s[48:51], s17 offen nt
    s_add_u32 s17, s17, 12288
    buffer_load_dwordx4 v[92:95], v60, s[48:51], s17 offen nt
    s_add_u32 s17, s17, 12288
    v_lshlrev_b32 v116, 16, v122
    v_mul_f32 v4, s7, v116
    v_exp_f32 v4, -v4
    s_nop 0
    v_add_f32 v4, 1.0, v4
    v_rcp_f32 v4, v4
    s_nop 0
    v_mul_f32 v116, v116, v4
    v_cvt_pk_bf16_f32 v116, 0, v116
    v_and_b32 v117, s6, v122
    v_mul_f32 v5, s7, v117
    v_exp_f32 v5, -v5
    s_nop 0
    v_add_f32 v5, 1.0, v5
    v_rcp_f32 v5, v5
    s_nop 0
    v_mul_f32 v117, v117, v5
    v_cvt_pk_bf16_f32 v117, 0, v117
    v_lshlrev_b32 v118, 16, v123
    v_mul_f32 v4, s7, v118
    v_exp_f32 v4, -v4
    s_nop 0
    v_add_f32 v4, 1.0, v4
    v_rcp_f32 v4, v4
    s_nop 0
    v_mul_f32 v118, v118, v4
    v_cvt_pk_bf16_f32 v118, 0, v118
    v_and_b32 v119, s6, v123
    v_mul_f32 v5, s7, v119
    v_exp_f32 v5, -v5
    s_nop 0
    v_add_f32 v5, 1.0, v5
    v_rcp_f32 v5, v5
    s_nop 0
    v_mul_f32 v119, v119, v5
    v_cvt_pk_bf16_f32 v119, 0, v119
    s_barrier
    s_add_u32 s96, s85, 8
    s_and_b32 s97, s96, 15
    s_lshl3_add_u32 s98, s97, s3
    s_sub_u32 s99, s98, 4
    s_mul_i32 s96, s99, 49152
    s_lshl_b32 s97, s11, 7
    s_add_u32 s82, s96, s97
    s_sub_u32 s96, s3, 4
    s_lshr_b32 s97, s96, 1
    s_mul_i32 s98, s97, 2080
    s_sub_u32 s99, s3, 4
    s_and_b32 s96, s99, 1
    s_mul_i32 s97, s96, 1056
    s_add_u32 s99, s98, s97
    s_add_u32 s20, s99, 49920
    s_mov_b32 m0, s20
    s_nop 0
    buffer_load_dwordx4 v62, s[40:43], s82 offen lds
    s_add_u32 s82, s82, 2048
    s_add_u32 m0, s20, 8320
    s_nop 0
    buffer_load_dwordx4 v62, s[40:43], s82 offen lds
    s_add_u32 s82, s82, 2048
    s_add_u32 m0, s20, 16640
    s_nop 0
    buffer_load_dwordx4 v62, s[40:43], s82 offen lds
    s_add_u32 s96, s85, 8
    s_and_b32 s97, s96, 15
    s_lshl3_add_u32 s98, s97, s3
    s_mul_i32 s99, s98, 49152
    s_lshl_b32 s96, s11, 7
    s_add_u32 s82, s99, s96
    s_lshr_b32 s96, s3, 1
    s_mul_i32 s97, s96, 2080
    s_and_b32 s98, s3, 1
    s_mul_i32 s99, s98, 1056
    s_add_u32 s96, s97, s99
    s_add_u32 s20, s96, 49920
    s_mov_b32 m0, s20
    s_nop 0
    buffer_load_dwordx4 v62, s[40:43], s82 offen lds
    s_add_u32 s82, s82, 2048
    s_add_u32 m0, s20, 8320
    s_nop 0
    buffer_load_dwordx4 v62, s[40:43], s82 offen lds
    s_add_u32 s82, s82, 2048
    s_add_u32 m0, s20, 16640
    s_nop 0
    buffer_load_dwordx4 v62, s[40:43], s82 offen lds
    s_waitcnt lgkmcnt(0)
    s_load_dword s24, s[32:33], s92 offset:1536 glc
    s_load_dword s25, s[32:33], s92 offset:1280 glc
    s_load_dword s26, s[32:33], s92 offset:2048 glc
    s_load_dword s27, s[32:33], s92 offset:1792 glc
    s_barrier
    s_add_u32 s96, s85, 9
    s_and_b32 s97, s96, 15
    s_lshl3_add_u32 s98, s97, s3
    s_sub_u32 s99, s98, 4
    s_mul_i32 s96, s99, 49152
    s_lshl_b32 s97, s11, 7
    s_add_u32 s82, s96, s97
    s_sub_u32 s96, s3, 4
    s_lshr_b32 s97, s96, 1
    s_mul_i32 s98, s97, 2080
    s_sub_u32 s99, s3, 4
    s_and_b32 s96, s99, 1
    s_mul_i32 s97, s96, 1056
    s_add_u32 s99, s98, s97
    s_add_u32 s20, s99, 74880
    s_mov_b32 m0, s20
    s_nop 0
    buffer_load_dwordx4 v62, s[40:43], s82 offen lds
    s_add_u32 s82, s82, 2048
    s_add_u32 m0, s20, 8320
    s_nop 0
    buffer_load_dwordx4 v62, s[40:43], s82 offen lds
    s_add_u32 s82, s82, 2048
    s_add_u32 m0, s20, 16640
    s_nop 0
    buffer_load_dwordx4 v62, s[40:43], s82 offen lds
    s_add_u32 s96, s85, 9
    s_and_b32 s97, s96, 15
    s_lshl3_add_u32 s98, s97, s3
    s_mul_i32 s99, s98, 49152
    s_lshl_b32 s96, s11, 7
    s_add_u32 s82, s99, s96
    s_lshr_b32 s96, s3, 1
    s_mul_i32 s97, s96, 2080
    s_and_b32 s98, s3, 1
    s_mul_i32 s99, s98, 1056
    s_add_u32 s96, s97, s99
    s_add_u32 s20, s96, 74880
    s_mov_b32 m0, s20
    s_nop 0
    buffer_load_dwordx4 v62, s[40:43], s82 offen lds
    s_add_u32 s82, s82, 2048
    s_add_u32 m0, s20, 8320
    s_nop 0
    buffer_load_dwordx4 v62, s[40:43], s82 offen lds
    s_add_u32 s82, s82, 2048
    s_add_u32 m0, s20, 16640
    s_nop 0
    buffer_load_dwordx4 v62, s[40:43], s82 offen lds
    buffer_load_dwordx4 v[96:99], v60, s[48:51], s17 offen nt
    s_add_u32 s17, s17, 12288
    buffer_load_dwordx4 v[100:103], v60, s[48:51], s17 offen nt
    s_add_u32 s17, s17, 12288
    s_waitcnt vmcnt(29)
    v_lshlrev_b32 v4, 16, v80
    v_and_b32 v5, s6, v80
    v_mul_f32 v20, v4, v112
    v_mul_f32 v21, v5, v112
    v_lshlrev_b32 v6, 16, v81
    v_and_b32 v7, s6, v81
    v_mul_f32 v22, v6, v112
    v_mul_f32 v23, v7, v112
    v_lshlrev_b32 v4, 16, v82
    v_and_b32 v5, s6, v82
    v_mul_f32 v24, v4, v112
    v_mul_f32 v25, v5, v112
    v_lshlrev_b32 v6, 16, v83
    v_and_b32 v7, s6, v83
    v_mul_f32 v26, v6, v112
    v_mul_f32 v27, v7, v112
    s_waitcnt vmcnt(28)
    v_lshlrev_b32 v4, 16, v84
    v_and_b32 v5, s6, v84
    v_fmac_f32 v20, v4, v113
    v_fmac_f32 v21, v5, v113
    v_lshlrev_b32 v6, 16, v85
    v_and_b32 v7, s6, v85
    v_fmac_f32 v22, v6, v113
    v_fmac_f32 v23, v7, v113
    v_lshlrev_b32 v4, 16, v86
    v_and_b32 v5, s6, v86
    v_fmac_f32 v24, v4, v113
    v_fmac_f32 v25, v5, v113
    v_lshlrev_b32 v6, 16, v87
    v_and_b32 v7, s6, v87
    v_fmac_f32 v26, v6, v113
    v_fmac_f32 v27, v7, v113
    s_waitcnt vmcnt(22)
    s_barrier
    s_add_u32 s96, s85, 10
    s_and_b32 s97, s96, 15
    s_lshl3_add_u32 s98, s97, s3
    s_sub_u32 s99, s98, 4
    s_mul_i32 s96, s99, 49152
    s_lshl_b32 s97, s11, 7
    s_add_u32 s82, s96, s97
    s_sub_u32 s96, s3, 4
    s_lshr_b32 s97, s96, 1
    s_mul_i32 s98, s97, 2080
    s_sub_u32 s99, s3, 4
    s_and_b32 s96, s99, 1
    s_mul_i32 s97, s96, 1056
    s_add_u32 s99, s98, s97
    s_add_u32 s20, s99, 99840
    s_mov_b32 m0, s20
    s_nop 0
    buffer_load_dwordx4 v62, s[40:43], s82 offen lds
    s_add_u32 s82, s82, 2048
    s_add_u32 m0, s20, 8320
    s_nop 0
    buffer_load_dwordx4 v62, s[40:43], s82 offen lds
    s_add_u32 s82, s82, 2048
    s_add_u32 m0, s20, 16640
    s_nop 0
    buffer_load_dwordx4 v62, s[40:43], s82 offen lds
    s_add_u32 s96, s85, 10
    s_and_b32 s97, s96, 15
    s_lshl3_add_u32 s98, s97, s3
    s_mul_i32 s99, s98, 49152
    s_lshl_b32 s96, s11, 7
    s_add_u32 s82, s99, s96
    s_lshr_b32 s96, s3, 1
    s_mul_i32 s97, s96, 2080
    s_and_b32 s98, s3, 1
    s_mul_i32 s99, s98, 1056
    s_add_u32 s96, s97, s99
    s_add_u32 s20, s96, 99840
    s_mov_b32 m0, s20
    s_nop 0
    buffer_load_dwordx4 v62, s[40:43], s82 offen lds
    s_add_u32 s82, s82, 2048
    s_add_u32 m0, s20, 8320
    s_nop 0
    buffer_load_dwordx4 v62, s[40:43], s82 offen lds
    s_add_u32 s82, s82, 2048
    s_add_u32 m0, s20, 16640
    s_nop 0
    buffer_load_dwordx4 v62, s[40:43], s82 offen lds
    s_waitcnt vmcnt(22)
    s_barrier
    s_add_u32 s96, s85, 11
    s_and_b32 s97, s96, 15
    s_lshl3_add_u32 s98, s97, s3
    s_sub_u32 s99, s98, 4
    s_mul_i32 s96, s99, 49152
    s_lshl_b32 s97, s11, 7
    s_add_u32 s82, s96, s97
    s_sub_u32 s96, s3, 4
    s_lshr_b32 s97, s96, 1
    s_mul_i32 s98, s97, 2080
    s_sub_u32 s99, s3, 4
    s_and_b32 s96, s99, 1
    s_mul_i32 s97, s96, 1056
    s_add_u32 s99, s98, s97
    s_add_u32 s20, s99, 124800
    s_mov_b32 m0, s20
    s_nop 0
    buffer_load_dwordx4 v62, s[40:43], s82 offen lds
    s_add_u32 s82, s82, 2048
    s_add_u32 m0, s20, 8320
    s_nop 0
    buffer_load_dwordx4 v62, s[40:43], s82 offen lds
    s_add_u32 s82, s82, 2048
    s_add_u32 m0, s20, 16640
    s_nop 0
    buffer_load_dwordx4 v62, s[40:43], s82 offen lds
    s_add_u32 s96, s85, 11
    s_and_b32 s97, s96, 15
    s_lshl3_add_u32 s98, s97, s3
    s_mul_i32 s99, s98, 49152
    s_lshl_b32 s96, s11, 7
    s_add_u32 s82, s99, s96
    s_lshr_b32 s96, s3, 1
    s_mul_i32 s97, s96, 2080
    s_and_b32 s98, s3, 1
    s_mul_i32 s99, s98, 1056
    s_add_u32 s96, s97, s99
    s_add_u32 s20, s96, 124800
    s_mov_b32 m0, s20
    s_nop 0
    buffer_load_dwordx4 v62, s[40:43], s82 offen lds
    s_add_u32 s82, s82, 2048
    s_add_u32 m0, s20, 8320
    s_nop 0
    buffer_load_dwordx4 v62, s[40:43], s82 offen lds
    s_add_u32 s82, s82, 2048
    s_add_u32 m0, s20, 16640
    s_nop 0
    buffer_load_dwordx4 v62, s[40:43], s82 offen lds
    buffer_load_dwordx4 v[104:107], v60, s[48:51], s17 offen nt
    s_add_u32 s17, s17, 12288
    buffer_load_dwordx4 v[108:111], v60, s[48:51], s17 offen nt
    s_lshl2_add_u32 s96, s74, s75
    s_lshl_b32 s97, s96, 11
    s_and_b32 s98, s3, 1
    s_lshl_b32 s99, s98, 10
    s_add_u32 s96, s97, s99
    s_add_u32 s13, s96, 20971520
    s_lshl4_add_u32 s96, s21, s12
    s_lshl_b32 s97, s96, 11
    s_and_b32 s98, s3, 1
    s_lshl_b32 s99, s98, 10
    s_add_u32 s96, s97, s99
    s_add_u32 s14, s96, 12582912
    buffer_load_dwordx4 v[124:127], v2, s[32:35], s13 offen
    s_waitcnt vmcnt(30)
    v_lshlrev_b32 v4, 16, v88
    v_and_b32 v5, s6, v88
    v_fmac_f32 v20, v4, v114
    v_fmac_f32 v21, v5, v114
    v_lshlrev_b32 v6, 16, v89
    v_and_b32 v7, s6, v89
    v_fmac_f32 v22, v6, v114
    v_fmac_f32 v23, v7, v114
    v_lshlrev_b32 v4, 16, v90
    v_and_b32 v5, s6, v90
    v_fmac_f32 v24, v4, v114
    v_fmac_f32 v25, v5, v114
    v_lshlrev_b32 v6, 16, v91
    v_and_b32 v7, s6, v91
    v_fmac_f32 v26, v6, v114
    v_fmac_f32 v27, v7, v114
    s_waitcnt vmcnt(29)
    v_lshlrev_b32 v4, 16, v92
    v_and_b32 v5, s6, v92
    v_fmac_f32 v20, v4, v115
    v_fmac_f32 v21, v5, v115
    v_lshlrev_b32 v6, 16, v93
    v_and_b32 v7, s6, v93
    v_fmac_f32 v22, v6, v115
    v_fmac_f32 v23, v7, v115
    v_lshlrev_b32 v4, 16, v94
    v_and_b32 v5, s6, v94
    v_fmac_f32 v24, v4, v115
    v_fmac_f32 v25, v5, v115
    v_lshlrev_b32 v6, 16, v95
    v_and_b32 v7, s6, v95
    v_fmac_f32 v26, v6, v115
    v_fmac_f32 v27, v7, v115
    s_waitcnt lgkmcnt(0)
    s_load_dword s24, s[32:33], s92 offset:2560 glc
    s_load_dword s25, s[32:33], s92 offset:2304 glc
    s_load_dword s26, s[32:33], s92 offset:3072 glc
    s_load_dword s27, s[32:33], s92 offset:2816 glc
    s_load_dword s28, s[32:33], s92 offset:3584 glc
    s_load_dword s29, s[32:33], s92 offset:3328 glc
    s_waitcnt vmcnt(23)
    s_barrier
    s_add_u32 s96, s85, 12
    s_and_b32 s97, s96, 15
    s_lshl3_add_u32 s98, s97, s3
    s_sub_u32 s99, s98, 4
    s_mul_i32 s96, s99, 49152
    s_lshl_b32 s97, s11, 7
    s_add_u32 s82, s96, s97
    s_sub_u32 s96, s3, 4
    s_lshr_b32 s97, s96, 1
    s_mul_i32 s98, s97, 2080
    s_sub_u32 s99, s3, 4
    s_and_b32 s96, s99, 1
    s_mul_i32 s97, s96, 1056
    s_add_u32 s20, s98, s97
    s_mov_b32 m0, s20
    s_nop 0
    buffer_load_dwordx4 v62, s[40:43], s82 offen lds
    s_add_u32 s82, s82, 2048
    s_add_u32 m0, s20, 8320
    s_nop 0
    buffer_load_dwordx4 v62, s[40:43], s82 offen lds
    s_add_u32 s82, s82, 2048
    s_add_u32 m0, s20, 16640
    s_nop 0
    buffer_load_dwordx4 v62, s[40:43], s82 offen lds
    s_add_u32 s96, s85, 12
    s_and_b32 s97, s96, 15
    s_lshl3_add_u32 s98, s97, s3
    s_mul_i32 s99, s98, 49152
    s_lshl_b32 s96, s11, 7
    s_add_u32 s82, s99, s96
    s_lshr_b32 s96, s3, 1
    s_mul_i32 s97, s96, 2080
    s_and_b32 s98, s3, 1
    s_mul_i32 s99, s98, 1056
    s_add_u32 s20, s97, s99
    s_mov_b32 m0, s20
    s_nop 0
    buffer_load_dwordx4 v62, s[40:43], s82 offen lds
    s_add_u32 s82, s82, 2048
    s_add_u32 m0, s20, 8320
    s_nop 0
    buffer_load_dwordx4 v62, s[40:43], s82 offen lds
    s_add_u32 s82, s82, 2048
    s_add_u32 m0, s20, 16640
    s_nop 0
    buffer_load_dwordx4 v62, s[40:43], s82 offen lds
    s_waitcnt vmcnt(22)
    v_lshlrev_b32 v4, 16, v96
    v_and_b32 v5, s6, v96
    v_fmac_f32 v20, v4, v116
    v_fmac_f32 v21, v5, v116
    v_lshlrev_b32 v6, 16, v97
    v_and_b32 v7, s6, v97
    v_fmac_f32 v22, v6, v116
    v_fmac_f32 v23, v7, v116
    v_lshlrev_b32 v4, 16, v98
    v_and_b32 v5, s6, v98
    v_fmac_f32 v24, v4, v116
    v_fmac_f32 v25, v5, v116
    v_lshlrev_b32 v6, 16, v99
    v_and_b32 v7, s6, v99
    v_fmac_f32 v26, v6, v116
    v_fmac_f32 v27, v7, v116
    s_waitcnt vmcnt(21)
    v_lshlrev_b32 v4, 16, v100
    v_and_b32 v5, s6, v100
    v_fmac_f32 v20, v4, v117
    v_fmac_f32 v21, v5, v117
    v_lshlrev_b32 v6, 16, v101
    v_and_b32 v7, s6, v101
    v_fmac_f32 v22, v6, v117
    v_fmac_f32 v23, v7, v117
    v_lshlrev_b32 v4, 16, v102
    v_and_b32 v5, s6, v102
    v_fmac_f32 v24, v4, v117
    v_fmac_f32 v25, v5, v117
    v_lshlrev_b32 v6, 16, v103
    v_and_b32 v7, s6, v103
    v_fmac_f32 v26, v6, v117
    v_fmac_f32 v27, v7, v117
    s_barrier
    s_add_u32 s96, s85, 13
    s_and_b32 s97, s96, 15
    s_lshl3_add_u32 s98, s97, s3
    s_sub_u32 s99, s98, 4
    s_mul_i32 s96, s99, 49152
    s_lshl_b32 s97, s11, 7
    s_add_u32 s82, s96, s97
    s_sub_u32 s96, s3, 4
    s_lshr_b32 s97, s96, 1
    s_mul_i32 s98, s97, 2080
    s_sub_u32 s99, s3, 4
    s_and_b32 s96, s99, 1
    s_mul_i32 s97, s96, 1056
    s_add_u32 s99, s98, s97
    s_add_u32 s20, s99, 24960
    s_mov_b32 m0, s20
    s_nop 0
    buffer_load_dwordx4 v62, s[40:43], s82 offen lds
    s_add_u32 s82, s82, 2048
    s_add_u32 m0, s20, 8320
    s_nop 0
    buffer_load_dwordx4 v62, s[40:43], s82 offen lds
    s_add_u32 s82, s82, 2048
    s_add_u32 m0, s20, 16640
    s_nop 0
    buffer_load_dwordx4 v62, s[40:43], s82 offen lds
    s_add_u32 s96, s85, 13
    s_and_b32 s97, s96, 15
    s_lshl3_add_u32 s98, s97, s3
    s_mul_i32 s99, s98, 49152
    s_lshl_b32 s96, s11, 7
    s_add_u32 s82, s99, s96
    s_lshr_b32 s96, s3, 1
    s_mul_i32 s97, s96, 2080
    s_and_b32 s98, s3, 1
    s_mul_i32 s99, s98, 1056
    s_add_u32 s96, s97, s99
    s_add_u32 s20, s96, 24960
    s_mov_b32 m0, s20
    s_nop 0
    buffer_load_dwordx4 v62, s[40:43], s82 offen lds
    s_add_u32 s82, s82, 2048
    s_add_u32 m0, s20, 8320
    s_nop 0
    buffer_load_dwordx4 v62, s[40:43], s82 offen lds
    s_add_u32 s82, s82, 2048
    s_add_u32 m0, s20, 16640
    s_nop 0
    buffer_load_dwordx4 v62, s[40:43], s82 offen lds
    s_waitcnt vmcnt(14)
    v_lshlrev_b32 v4, 16, v104
    v_and_b32 v5, s6, v104
    v_fmac_f32 v20, v4, v118
    v_fmac_f32 v21, v5, v118
    v_lshlrev_b32 v6, 16, v105
    v_and_b32 v7, s6, v105
    v_fmac_f32 v22, v6, v118
    v_fmac_f32 v23, v7, v118
    v_lshlrev_b32 v4, 16, v106
    v_and_b32 v5, s6, v106
    v_fmac_f32 v24, v4, v118
    v_fmac_f32 v25, v5, v118
    v_lshlrev_b32 v6, 16, v107
    v_and_b32 v7, s6, v107
    v_fmac_f32 v26, v6, v118
    v_fmac_f32 v27, v7, v118
    s_waitcnt vmcnt(13)
    v_lshlrev_b32 v4, 16, v108
    v_and_b32 v5, s6, v108
    v_fmac_f32 v20, v4, v119
    v_fmac_f32 v21, v5, v119
    v_lshlrev_b32 v6, 16, v109
    v_and_b32 v7, s6, v109
    v_fmac_f32 v22, v6, v119
    v_fmac_f32 v23, v7, v119
    v_lshlrev_b32 v4, 16, v110
    v_and_b32 v5, s6, v110
    v_fmac_f32 v24, v4, v119
    v_fmac_f32 v25, v5, v119
    v_lshlrev_b32 v6, 16, v111
    v_and_b32 v7, s6, v111
    v_fmac_f32 v26, v6, v119
    v_fmac_f32 v27, v7, v119
    v_permlane32_swap_b32 v20, v24
    v_permlane32_swap_b32 v21, v25
    v_permlane32_swap_b32 v22, v26
    v_permlane32_swap_b32 v23, v27
    v_add_f32 v20, v20, v24
    v_add_f32 v21, v21, v25
    v_add_f32 v22, v22, v26
    v_add_f32 v23, v23, v27
    s_nop 0
    v_permlane16_swap_b32 v20, v22
    v_permlane16_swap_b32 v21, v23
    v_add_f32 v20, v20, v22
    v_add_f32 v21, v21, v23
    s_nop 0
    v_add_f32_dpp v20, v20, v20 row_ror:8 row_mask:0xf bank_mask:0xf
    v_add_f32_dpp v21, v21, v21 row_ror:8 row_mask:0xf bank_mask:0xf
    s_nop 1
    v_mov_b32_dpp v20, v21 quad_perm:[0,1,2,3] row_mask:0xf bank_mask:0xc
    ds_write_b32 v65, v20 offset:1024
    s_waitcnt lgkmcnt(0)
    s_barrier
    s_add_u32 s96, s85, 14
    s_and_b32 s97, s96, 15
    s_lshl3_add_u32 s98, s97, s3
    s_sub_u32 s99, s98, 4
    s_mul_i32 s96, s99, 49152
    s_lshl_b32 s97, s11, 7
    s_add_u32 s82, s96, s97
    s_sub_u32 s96, s3, 4
    s_lshr_b32 s97, s96, 1
    s_mul_i32 s98, s97, 2080
    s_sub_u32 s99, s3, 4
    s_and_b32 s96, s99, 1
    s_mul_i32 s97, s96, 1056
    s_add_u32 s99, s98, s97
    s_add_u32 s20, s99, 49920
    s_mov_b32 m0, s20
    s_nop 0
    buffer_load_dwordx4 v62, s[40:43], s82 offen lds
    s_add_u32 s82, s82, 2048
    s_add_u32 m0, s20, 8320
    s_nop 0
    buffer_load_dwordx4 v62, s[40:43], s82 offen lds
    s_add_u32 s82, s82, 2048
    s_add_u32 m0, s20, 16640
    s_nop 0
    buffer_load_dwordx4 v62, s[40:43], s82 offen lds
    s_add_u32 s96, s85, 14
    s_and_b32 s97, s96, 15
    s_lshl3_add_u32 s98, s97, s3
    s_mul_i32 s99, s98, 49152
    s_lshl_b32 s96, s11, 7
    s_add_u32 s82, s99, s96
    s_lshr_b32 s96, s3, 1
    s_mul_i32 s97, s96, 2080
    s_and_b32 s98, s3, 1
    s_mul_i32 s99, s98, 1056
    s_add_u32 s96, s97, s99
    s_add_u32 s20, s96, 49920
    s_mov_b32 m0, s20
    s_nop 0
    buffer_load_dwordx4 v62, s[40:43], s82 offen lds
    s_add_u32 s82, s82, 2048
    s_add_u32 m0, s20, 8320
    s_nop 0
    buffer_load_dwordx4 v62, s[40:43], s82 offen lds
    s_add_u32 s82, s82, 2048
    s_add_u32 m0, s20, 16640
    s_nop 0
    buffer_load_dwordx4 v62, s[40:43], s82 offen lds
    s_cmp_lg_u32 s3, 4
    s_cbranch_scc1 L_M2F
    ds_read_b128 v[20:23], v64 offset:1024
    s_bfe_u32 s96, s9, 131074
    s_lshl_b32 s97, s8, 1
    s_lshl4_add_u32 s98, s96, s97
    s_lshr_b32 s99, s9, 4
    s_add_u32 s96, s98, s99
    s_and_b32 s97, s9, 3
    s_lshl2_add_u32 s98, s96, s97
    s_lshl_b32 s99, s98, 9
    s_add_u32 s13, s99, 131072
    s_waitcnt lgkmcnt(0)
    v_add_f32 v20, v20, v21
    v_add_f32 v22, v22, v23
    v_mov_b32 v21, s4
    v_add_f32 v20, v20, v22
    buffer_store_dwordx2 v[20:21], v63, s[32:35], s13 offen sc1
L_M2F:
    s_barrier
    s_add_u32 s96, s85, 15
    s_and_b32 s97, s96, 15
    s_lshl3_add_u32 s98, s97, s3
    s_sub_u32 s99, s98, 4
    s_mul_i32 s96, s99, 49152
    s_lshl_b32 s97, s11, 7
    s_add_u32 s82, s96, s97
    s_sub_u32 s96, s3, 4
    s_lshr_b32 s97, s96, 1
    s_mul_i32 s98, s97, 2080
    s_sub_u32 s99, s3, 4
    s_and_b32 s96, s99, 1
    s_mul_i32 s97, s96, 1056
    s_add_u32 s99, s98, s97
    s_add_u32 s20, s99, 74880
    s_mov_b32 m0, s20
    s_nop 0
    buffer_load_dwordx4 v62, s[40:43], s82 offen lds
    s_add_u32 s82, s82, 2048
    s_add_u32 m0, s20, 8320
    s_nop 0
    buffer_load_dwordx4 v62, s[40:43], s82 offen lds
    s_add_u32 s82, s82, 2048
    s_add_u32 m0, s20, 16640
    s_nop 0
    buffer_load_dwordx4 v62, s[40:43], s82 offen lds
    s_add_u32 s96, s85, 15
    s_and_b32 s97, s96, 15
    s_lshl3_add_u32 s98, s97, s3
    s_mul_i32 s99, s98, 49152
    s_lshl_b32 s96, s11, 7
    s_add_u32 s82, s99, s96
    s_lshr_b32 s96, s3, 1
    s_mul_i32 s97, s96, 2080
    s_and_b32 s98, s3, 1
    s_mul_i32 s99, s98, 1056
    s_add_u32 s96, s97, s99
    s_add_u32 s20, s96, 74880
    s_mov_b32 m0, s20
    s_nop 0
    buffer_load_dwordx4 v62, s[40:43], s82 offen lds
    s_add_u32 s82, s82, 2048
    s_add_u32 m0, s20, 8320
    s_nop 0
    buffer_load_dwordx4 v62, s[40:43], s82 offen lds
    s_add_u32 s82, s82, 2048
    s_add_u32 m0, s20, 16640
    s_nop 0
    buffer_load_dwordx4 v62, s[40:43], s82 offen lds
    s_waitcnt vmcnt(18)
    s_barrier
    v_and_b32 v89, 31, v1
    v_lshlrev_b32 v89, 4, v89
    v_lshrrev_b32 v9, 5, v1
    v_lshl_add_u32 v89, v9, 9, v89
    s_and_b32 s96, s3, 3
    s_lshl4_add_u32 s97, s96, s12
    s_lshl_b32 s98, s97, 11
    s_add_u32 s18, s98, 131072
    s_lshl_b32 s13, s12, 7
    v_and_b32 v4, 31, v1
    v_lshl_add_u32 v4, v4, 2, s13
    global_load_dword v88, v4, s[78:79]
    buffer_load_dwordx4 v[80:83], v89, s[32:35], s18 offen sc1
    buffer_load_dwordx4 v[84:87], v89, s[32:35], s18 offen offset:1024 sc1
    s_waitcnt vmcnt(15)
    s_waitcnt vmcnt(9)
    s_waitcnt vmcnt(3)
    s_barrier
    s_waitcnt vmcnt(0)
    v_bitop3_b32 v4, v81, v83, s4 bitop3:0x7e
    v_bitop3_b32 v4, v4, v85, s4 bitop3:0xf6
    v_bitop3_b32 v4, v4, v87, s4 bitop3:0xf6
    v_cmp_ne_u32 vcc, 0, v4
    s_cbranch_vccz TOK_14
POLL_15:
    buffer_load_dwordx4 v[80:83], v89, s[32:35], s18 offen sc1
    buffer_load_dwordx4 v[84:87], v89, s[32:35], s18 offen offset:1024 sc1
    s_waitcnt vmcnt(0)
    v_bitop3_b32 v4, v81, v83, s4 bitop3:0x7e
    v_bitop3_b32 v4, v4, v85, s4 bitop3:0xf6
    v_bitop3_b32 v4, v4, v87, s4 bitop3:0xf6
    v_cmp_ne_u32 vcc, 0, v4
    s_cbranch_vccz PDONE_16
    s_add_u32 s5, s5, 1
    s_cmp_lt_u32 s5, 300000
    s_cbranch_scc1 POLL_15
PDONE_16:
TOK_14:
    s_and_b32 s96, s3, 3
    s_lshl_b32 s97, s96, 7
    s_add_u32 s13, s97, 139264
    v_and_b32 v4, 31, v1
    v_lshl_add_u32 v4, v4, 2, s13
    s_and_b32 s14, s3, 3
    v_add_f32 v80, v80, v84
    v_add_f32 v81, v82, v86
    v_mov_b32 v82, v80
    v_mov_b32 v83, v81
    s_cmp_eq_u32 s14, 2
    s_cselect_b32 s15, 1.0, 0
    v_permlane32_swap_b32 v80, v82
    v_permlane32_swap_b32 v81, v83
    v_pk_add_f32 v[80:81], v[80:81], v[82:83]
    v_cvt_pk_bf16_f32 v80, 0, v80
    v_cvt_pk_bf16_f32 v81, 0, v81
    v_add_f32 v80, s15, v80
    v_add_f32 v81, s15, v81
    v_cvt_pk_bf16_f32 v82, v80, v81
    ds_write_b32 v4, v82
    s_cbranch_scc0 L_NOG
    v_lshlrev_b32 v80, 16, v82
    v_and_b32 v81, s6, v82
    v_lshlrev_b32 v84, 16, v88
    v_and_b32 v85, s6, v88
    v_pk_mul_f32 v[84:85], v[84:85], v[80:81]
    v_cvt_pk_bf16_f32 v86, v84, v85
    v_lshlrev_b32 v80, 16, v86
    v_and_b32 v81, s6, v86
    v_pk_add_f32 v[80:81], v[84:85], v[80:81] neg_lo:[0,1] neg_hi:[0,1]
    v_cvt_pk_bf16_f32 v87, v80, v81
    v_add_f32 v80, v84, v85
    ds_write2_b32 v4, v86, v87 offset0:64 offset1:96
    ds_write_b32 v4, v88 offset:512
    v_add_f32_dpp v80, v80, v80 quad_perm:[1,0,3,2] row_mask:0xf bank_mask:0xf
    s_nop 1
    v_add_f32_dpp v80, v80, v80 quad_perm:[2,3,0,1] row_mask:0xf bank_mask:0xf
    s_nop 1
    v_add_f32_dpp v80, v80, v80 row_half_mirror row_mask:0xf bank_mask:0xf
    s_nop 1
    v_add_f32_dpp v80, v80, v80 row_ror:8 row_mask:0xf bank_mask:0xf
    s_lshl4_add_u32 s96, s21, s12
    s_lshl3_add_u32 s13, s96, 65536
    v_mov_b32 v82, v80
    v_mov_b32 v81, s4
    s_nop 0
    v_permlane16_swap_b32 v80, v82
    v_add_f32 v80, v80, v82
    s_mov_b64 exec, 1
    buffer_store_dwordx2 v[80:81], v3, s[32:35], s13 offen sc1
    s_mov_b64 exec, -1
L_NOG:
    s_barrier
    buffer_load_dword v90, v3, s[32:35], 0 offen offset:256 sc1
    s_lshl4_add_u32 s96, s11, s10
    s_lshl_b32 s97, s96, 10
    s_and_b32 s98, s3, 3
    s_lshl_b32 s99, s98, 8
    s_add_u32 s96, s97, s99
    s_add_u32 s13, s96, 29360128
    s_lshl_b32 s96, s11, 7
    s_add_u32 s14, s96, 32768
    v_lshlrev_b32 v60, 7, v1
    s_mov_b64 exec, 3
    buffer_load_dword v60, v60, s[32:35], s13 offen
    buffer_load_dword v61, v3, s[32:35], s14 offen
    s_mov_b64 exec, -1
    s_add_u32 s96, s84, 1114112
    s_and_b32 s97, s96, 1048575
    s_lshl_b32 s98, s83, 16
    s_xor_b32 s99, s97, s98
    s_xor_b32 s96, s88, 1048576
    s_add_u32 s13, s99, s96
    s_add_u32 m0, s89, 102400
    s_nop 0
    buffer_load_dwordx4 v74, s[44:47], s13 offen lds
    s_add_u32 s96, s84, 1179648
    s_and_b32 s97, s96, 1048575
    s_lshl_b32 s98, s83, 16
    s_xor_b32 s99, s97, s98
    s_xor_b32 s96, s88, 1048576
    s_add_u32 s13, s99, s96
    s_add_u32 m0, s89, 106496
    s_nop 0
    buffer_load_dwordx4 v74, s[44:47], s13 offen lds
    s_add_u32 s96, s84, 1245184
    s_and_b32 s97, s96, 1048575
    s_lshl_b32 s98, s83, 16
    s_xor_b32 s99, s97, s98
    s_xor_b32 s96, s88, 1048576
    s_add_u32 s13, s99, s96
    s_add_u32 m0, s89, 110592
    s_nop 0
    buffer_load_dwordx4 v74, s[44:47], s13 offen lds
    s_add_u32 s96, s84, 1310720
    s_and_b32 s97, s96, 1048575
    s_lshl_b32 s98, s83, 16
    s_xor_b32 s99, s97, s98
    s_xor_b32 s96, s88, 1048576
    s_add_u32 s13, s99, s96
    s_add_u32 m0, s89, 114688
    s_nop 0
    buffer_load_dwordx4 v74, s[44:47], s13 offen lds
    s_add_u32 s96, s84, 1376256
    s_and_b32 s97, s96, 1048575
    s_lshl_b32 s98, s83, 16
    s_xor_b32 s99, s97, s98
    s_xor_b32 s96, s88, 1048576
    s_add_u32 s13, s99, s96
    s_add_u32 m0, s89, 118784
    s_nop 0
    buffer_load_dwordx4 v74, s[44:47], s13 offen lds
    s_add_u32 s96, s84, 1441792
    s_and_b32 s97, s96, 1048575
    s_lshl_b32 s98, s83, 16
    s_xor_b32 s99, s97, s98
    s_xor_b32 s96, s88, 1048576
    s_add_u32 s13, s99, s96
    s_add_u32 m0, s89, 122880
    s_nop 0
    buffer_load_dwordx4 v74, s[44:47], s13 offen lds
    s_add_u32 s96, s84, 1507328
    s_and_b32 s97, s96, 1048575
    s_lshl_b32 s98, s83, 16
    s_xor_b32 s99, s97, s98
    s_xor_b32 s96, s88, 1048576
    s_add_u32 s13, s99, s96
    s_add_u32 m0, s89, 126976
    s_nop 0
    buffer_load_dwordx4 v74, s[44:47], s13 offen lds
    s_add_u32 s96, s84, 1572864
    s_and_b32 s97, s96, 1048575
    s_lshl_b32 s98, s83, 16
    s_xor_b32 s99, s97, s98
    s_xor_b32 s96, s88, 1048576
    s_add_u32 s13, s99, s96
    s_add_u32 m0, s89, 131072
    s_nop 0
    buffer_load_dwordx4 v74, s[44:47], s13 offen lds
    s_mov_b32 s13, s80
    buffer_load_dwordx4 v[176:179], v72, s[52:55], s13 offen nt
    s_add_u32 s13, s80, 4294049792
    buffer_load_dwordx4 v[180:183], v72, s[52:55], s13 offen nt
    s_add_u32 s13, s80, 57344
    buffer_load_dwordx4 v[184:187], v72, s[52:55], s13 offen nt
    s_add_u32 s13, s80, 4294107136
    buffer_load_dwordx4 v[188:191], v72, s[52:55], s13 offen nt
    s_add_u32 s13, s80, 114688
    buffer_load_dwordx4 v[192:195], v72, s[52:55], s13 offen nt
    s_add_u32 s13, s80, 4294164480
    buffer_load_dwordx4 v[196:199], v72, s[52:55], s13 offen nt
    s_add_u32 s13, s80, 172032
    buffer_load_dwordx4 v[200:203], v72, s[52:55], s13 offen nt
    s_add_u32 s13, s80, 4294221824
    buffer_load_dwordx4 v[204:207], v72, s[52:55], s13 offen nt
    s_waitcnt vmcnt(18)
    v_mov_b32 v4, 140160
    ds_write_b32 v4, v90
    s_waitcnt lgkmcnt(0)
    s_barrier
    ds_read_b128 v[36:39], v76
    ds_read_b128 v[40:43], v76 offset:1024
    s_waitcnt lgkmcnt(0)
    v_mfma_f32_32x32x16_bf16 v[112:127], v[28:31], v[36:39], 0
    v_mfma_f32_32x32x16_bf16 v[112:127], v[32:35], v[40:43], v[112:127]
    s_mov_b32 s13, s80
    buffer_load_dwordx4 v[208:211], v72, s[56:59], s13 offen nt
    s_add_u32 s13, s80, 4294049792
    buffer_load_dwordx4 v[212:215], v72, s[56:59], s13 offen nt
    s_add_u32 s13, s80, 57344
    buffer_load_dwordx4 v[216:219], v72, s[56:59], s13 offen nt
    s_add_u32 s13, s80, 4294107136
    buffer_load_dwordx4 v[220:223], v72, s[56:59], s13 offen nt
L_JOIN:
    s_nop 3
    v_cvt_pk_bf16_f32 v112, 0, v112
    v_cvt_pk_bf16_f32 v113, 0, v113
    v_cvt_pk_bf16_f32 v114, 0, v114
    v_cvt_pk_bf16_f32 v115, 0, v115
    v_cvt_pk_bf16_f32 v116, 0, v116
    v_cvt_pk_bf16_f32 v117, 0, v117
    v_cvt_pk_bf16_f32 v118, 0, v118
    v_cvt_pk_bf16_f32 v119, 0, v119
    v_cvt_pk_bf16_f32 v120, 0, v120
    v_cvt_pk_bf16_f32 v121, 0, v121
    v_cvt_pk_bf16_f32 v122, 0, v122
    v_cvt_pk_bf16_f32 v123, 0, v123
    v_cvt_pk_bf16_f32 v124, 0, v124
    v_cvt_pk_bf16_f32 v125, 0, v125
    v_cvt_pk_bf16_f32 v126, 0, v126
    v_cvt_pk_bf16_f32 v127, 0, v127
    v_max3_f32 v4, v112, v113, v114
    v_min3_f32 v5, v112, v113, v114
    v_max3_f32 v4, v4, v115, v116
    v_min3_f32 v5, v5, v115, v116
    v_max3_f32 v4, v4, v117, v118
    v_min3_f32 v5, v5, v117, v118
    v_max3_f32 v4, v4, v119, v120
    v_min3_f32 v5, v5, v119, v120
    v_max3_f32 v4, v4, v121, v122
    v_min3_f32 v5, v5, v121, v122
    v_max3_f32 v4, v4, v123, v124
    v_min3_f32 v5, v5, v123, v124
    v_max3_f32 v4, v4, v125, v126
    v_min3_f32 v5, v5, v125, v126
    v_max_f32 v6, v4, v127
    v_min_f32 v7, v5, v127
    v_max_f32 v4, v4, v127
    v_min_f32 v5, v5, v127
    s_nop 0
    v_permlane32_swap_b32 v4, v6
    v_permlane32_swap_b32 v5, v7
    v_max_f32 v4, v4, v6
    v_min_f32 v5, v5, v7
    v_pk_mul_f32 v[4:5], v[4:5], s[6:7] op_sel:[0,1]
    v_pk_fma_f32 v[128:129], v[112:113], s[6:7], v[4:5] op_sel:[0,1,0] op_sel_hi:[1,1,0] neg_lo:[0,0,1] neg_hi:[0,0,1]
    v_pk_fma_f32 v[112:113], v[112:113], s[6:7], v[4:5] op_sel:[0,1,1] neg_lo:[1,0,0] neg_hi:[1,0,0]
    v_pk_fma_f32 v[130:131], v[114:115], s[6:7], v[4:5] op_sel:[0,1,0] op_sel_hi:[1,1,0] neg_lo:[0,0,1] neg_hi:[0,0,1]
    v_pk_fma_f32 v[114:115], v[114:115], s[6:7], v[4:5] op_sel:[0,1,1] neg_lo:[1,0,0] neg_hi:[1,0,0]
    v_pk_fma_f32 v[132:133], v[116:117], s[6:7], v[4:5] op_sel:[0,1,0] op_sel_hi:[1,1,0] neg_lo:[0,0,1] neg_hi:[0,0,1]
    v_pk_fma_f32 v[116:117], v[116:117], s[6:7], v[4:5] op_sel:[0,1,1] neg_lo:[1,0,0] neg_hi:[1,0,0]
    v_pk_fma_f32 v[134:135], v[118:119], s[6:7], v[4:5] op_sel:[0,1,0] op_sel_hi:[1,1,0] neg_lo:[0,0,1] neg_hi:[0,0,1]
    v_pk_fma_f32 v[118:119], v[118:119], s[6:7], v[4:5] op_sel:[0,1,1] neg_lo:[1,0,0] neg_hi:[1,0,0]
    v_pk_fma_f32 v[136:137], v[120:121], s[6:7], v[4:5] op_sel:[0,1,0] op_sel_hi:[1,1,0] neg_lo:[0,0,1] neg_hi:[0,0,1]
    v_pk_fma_f32 v[120:121], v[120:121], s[6:7], v[4:5] op_sel:[0,1,1] neg_lo:[1,0,0] neg_hi:[1,0,0]
    v_pk_fma_f32 v[138:139], v[122:123], s[6:7], v[4:5] op_sel:[0,1,0] op_sel_hi:[1,1,0] neg_lo:[0,0,1] neg_hi:[0,0,1]
    v_pk_fma_f32 v[122:123], v[122:123], s[6:7], v[4:5] op_sel:[0,1,1] neg_lo:[1,0,0] neg_hi:[1,0,0]
    v_pk_fma_f32 v[140:141], v[124:125], s[6:7], v[4:5] op_sel:[0,1,0] op_sel_hi:[1,1,0] neg_lo:[0,0,1] neg_hi:[0,0,1]
    v_pk_fma_f32 v[124:125], v[124:125], s[6:7], v[4:5] op_sel:[0,1,1] neg_lo:[1,0,0] neg_hi:[1,0,0]
    v_pk_fma_f32 v[142:143], v[126:127], s[6:7], v[4:5] op_sel:[0,1,0] op_sel_hi:[1,1,0] neg_lo:[0,0,1] neg_hi:[0,0,1]
    v_pk_fma_f32 v[126:127], v[126:127], s[6:7], v[4:5] op_sel:[0,1,1] neg_lo:[1,0,0] neg_hi:[1,0,0]
    v_exp_f32 v128, v128
    v_exp_f32 v112, v112
    v_exp_f32 v129, v129
    v_exp_f32 v113, v113
    v_exp_f32 v130, v130
    v_exp_f32 v114, v114
    v_exp_f32 v131, v131
    v_exp_f32 v115, v115
    v_exp_f32 v132, v132
    v_exp_f32 v116, v116
    v_exp_f32 v133, v133
    v_exp_f32 v117, v117
    v_exp_f32 v134, v134
    v_exp_f32 v118, v118
    v_exp_f32 v135, v135
    v_exp_f32 v119, v119
    v_exp_f32 v136, v136
    v_exp_f32 v120, v120
    v_exp_f32 v137, v137
    v_exp_f32 v121, v121
    v_exp_f32 v138, v138
    v_exp_f32 v122, v122
    v_exp_f32 v139, v139
    v_exp_f32 v123, v123
    v_exp_f32 v140, v140
    v_exp_f32 v124, v124
    v_exp_f32 v141, v141
    v_exp_f32 v125, v125
    v_exp_f32 v142, v142
    v_exp_f32 v126, v126
    v_exp_f32 v143, v143
    v_exp_f32 v127, v127
    v_pk_add_f32 v[8:9], v[128:129], v[130:131]
    v_pk_add_f32 v[10:11], v[112:113], v[114:115]
    v_pk_add_f32 v[8:9], v[8:9], v[132:133]
    v_pk_add_f32 v[10:11], v[10:11], v[116:117]
    v_pk_add_f32 v[8:9], v[8:9], v[134:135]
    v_pk_add_f32 v[10:11], v[10:11], v[118:119]
    v_pk_add_f32 v[8:9], v[8:9], v[136:137]
    v_pk_add_f32 v[10:11], v[10:11], v[120:121]
    v_pk_add_f32 v[8:9], v[8:9], v[138:139]
    v_pk_add_f32 v[10:11], v[10:11], v[122:123]
    v_pk_add_f32 v[8:9], v[8:9], v[140:141]
    v_pk_add_f32 v[10:11], v[10:11], v[124:125]
    v_pk_add_f32 v[8:9], v[8:9], v[142:143]
    v_pk_add_f32 v[10:11], v[10:11], v[126:127]
    v_add_f32 v6, v8, v9
    v_add_f32 v7, v10, v11
    v_add_f32 v4, v8, v9
    v_add_f32 v5, v10, v11
    s_nop 0
    v_permlane32_swap_b32 v4, v6
    v_permlane32_swap_b32 v5, v7
    v_pk_add_f32 v[4:5], v[4:5], v[6:7]
    v_rcp_f32 v4, v4
    v_rcp_f32 v5, v5
    s_nop 0
    v_pk_mul_f32 v[128:129], v[128:129], v[4:5] op_sel_hi:[1,0]
    v_pk_mul_f32 v[112:113], v[112:113], v[4:5] op_sel:[0,1]
    v_pk_mul_f32 v[130:131], v[130:131], v[4:5] op_sel_hi:[1,0]
    v_pk_mul_f32 v[114:115], v[114:115], v[4:5] op_sel:[0,1]
    v_pk_mul_f32 v[132:133], v[132:133], v[4:5] op_sel_hi:[1,0]
    v_pk_mul_f32 v[116:117], v[116:117], v[4:5] op_sel:[0,1]
    v_pk_mul_f32 v[134:135], v[134:135], v[4:5] op_sel_hi:[1,0]
    v_pk_mul_f32 v[118:119], v[118:119], v[4:5] op_sel:[0,1]
    v_pk_mul_f32 v[136:137], v[136:137], v[4:5] op_sel_hi:[1,0]
    v_pk_mul_f32 v[120:121], v[120:121], v[4:5] op_sel:[0,1]
    v_pk_mul_f32 v[138:139], v[138:139], v[4:5] op_sel_hi:[1,0]
    v_pk_mul_f32 v[122:123], v[122:123], v[4:5] op_sel:[0,1]
    v_pk_mul_f32 v[140:141], v[140:141], v[4:5] op_sel_hi:[1,0]
    v_pk_mul_f32 v[124:125], v[124:125], v[4:5] op_sel:[0,1]
    v_pk_mul_f32 v[142:143], v[142:143], v[4:5] op_sel_hi:[1,0]
    v_pk_mul_f32 v[126:127], v[126:127], v[4:5] op_sel:[0,1]
    v_cvt_pk_bf16_f32 v80, v128, v129
    v_cvt_pk_bf16_f32 v88, v112, v113
    v_cvt_pk_bf16_f32 v81, v130, v131
    v_cvt_pk_bf16_f32 v89, v114, v115
    v_cvt_pk_bf16_f32 v82, v132, v133
    v_cvt_pk_bf16_f32 v90, v116, v117
    v_cvt_pk_bf16_f32 v83, v134, v135
    v_cvt_pk_bf16_f32 v91, v118, v119
    v_cvt_pk_bf16_f32 v84, v136, v137
    v_cvt_pk_bf16_f32 v92, v120, v121
    v_cvt_pk_bf16_f32 v85, v138, v139
    v_cvt_pk_bf16_f32 v93, v122, v123
    v_cvt_pk_bf16_f32 v86, v140, v141
    v_cvt_pk_bf16_f32 v94, v124, v125
    v_cvt_pk_bf16_f32 v87, v142, v143
    v_cvt_pk_bf16_f32 v95, v126, v127
    ds_write_b128 v75, v[80:83]
    ds_write_b128 v75, v[84:87] offset:4096
    ds_write_b128 v75, v[88:91] offset:8192
    ds_write_b128 v75, v[92:95] offset:12288
    s_lshl_b32 s13, s3, 12
    v_add_u32 v20, s13, v63
    s_lshl_b32 s96, s76, 13
    s_add_u32 s13, s96, 32768
    v_add_u32 v21, s13, v63
    v_mov_b32 v36, 0x3f803f80
    v_mov_b32 v37, 0x3f803f80
    v_mov_b32 v38, 0x3f803f80
    v_mov_b32 v39, 0x3f803f80
    s_lshl3_add_u32 s96, s11, s3
    s_lshl_b32 s97, s96, 5
    s_add_u32 s98, s97, s10
    s_lshl_b32 s99, s98, 10
    s_add_u32 s13, s99, 25165824
    s_add_u32 s15, s13, 16384
    s_lshl3_add_u32 s96, s11, s3
    s_lshl_b32 s97, s96, 10
    s_add_u32 s16, s97, 21495808
    s_lshl_b32 s96, s10, 6
    s_add_u32 s14, s96, s16
    s_waitcnt lgkmcnt(0)
    s_barrier
    s_lshl_b32 s96, s76, 6
    s_add_u32 s18, s96, 139264
    v_and_b32 v67, 7, v1
    v_lshl_add_u32 v67, v67, 2, s18
    v_lshrrev_b32 v9, 5, v1
    v_lshl_add_u32 v67, v9, 5, v67
    ds_read_b32 v64, v67
    ds_read_b32 v65, v67 offset:512
    ds_read_b32 v66, v67 offset:640
    ds_read_b32 v68, v67 offset:128
    ds_read_b32 v69, v67 offset:256
    ds_read_b32 v70, v67 offset:384
    ds_read_b32 v71, v67 offset:768
    v_mov_b32 v67, 140160
    ds_read_b32 v67, v67
    ds_read_b64_tr_b16 v[128:129], v20
    ds_read_b64_tr_b16 v[130:131], v20 offset:512
    ds_read_b64_tr_b16 v[144:145], v21
    ds_read_b64_tr_b16 v[146:147], v21 offset:512
    ds_read_b64_tr_b16 v[148:149], v21 offset:4096
    ds_read_b64_tr_b16 v[150:151], v21 offset:4608
    ds_read_b64_tr_b16 v[132:133], v20 offset:1024
    ds_read_b64_tr_b16 v[134:135], v20 offset:1536
    ds_read_b64_tr_b16 v[152:153], v21 offset:1024
    ds_read_b64_tr_b16 v[154:155], v21 offset:1536
    ds_read_b64_tr_b16 v[156:157], v21 offset:5120
    ds_read_b64_tr_b16 v[158:159], v21 offset:5632
    ds_read_b64_tr_b16 v[136:137], v20 offset:2048
    ds_read_b64_tr_b16 v[138:139], v20 offset:2560
    ds_read_b64_tr_b16 v[160:161], v21 offset:2048
    ds_read_b64_tr_b16 v[162:163], v21 offset:2560
    ds_read_b64_tr_b16 v[164:165], v21 offset:6144
    ds_read_b64_tr_b16 v[166:167], v21 offset:6656
    s_waitcnt lgkmcnt(12)
    v_mfma_f32_16x16x32_bf16 v[52:55], v[128:131], v[144:147], 0
    v_mfma_f32_16x16x32_bf16 v[56:59], v[128:131], v[148:151], 0
    v_mfma_f32_16x16x32_bf16 v[40:43], v[128:131], v[36:39], 0
    ds_read_b64_tr_b16 v[140:141], v20 offset:3072
    ds_read_b64_tr_b16 v[142:143], v20 offset:3584
    ds_read_b64_tr_b16 v[168:169], v21 offset:3072
    ds_read_b64_tr_b16 v[170:171], v21 offset:3584
    ds_read_b64_tr_b16 v[172:173], v21 offset:7168
    ds_read_b64_tr_b16 v[174:175], v21 offset:7680
    s_waitcnt lgkmcnt(12)
    v_mfma_f32_16x16x32_bf16 v[52:55], v[132:135], v[152:155], v[52:55]
    v_mfma_f32_16x16x32_bf16 v[56:59], v[132:135], v[156:159], v[56:59]
    v_mfma_f32_16x16x32_bf16 v[40:43], v[132:135], v[36:39], v[40:43]
    v_and_b32 v75, 15, v1
    v_lshlrev_b32 v75, 15, v75
    s_and_b32 s96, s10, 1
    s_and_b32 s97, s2, 135
    s_lshl_b32 s98, s97, 12
    s_lshr_b32 s99, s10, 1
    s_lshl_b32 s97, s99, 6
    s_add_u32 s99, s98, s97
    s_lshl2_add_u32 s98, s96, s99
    s_add_u32 s97, s98, 1048576
    s_add_u32 s17, s97, 512
    s_waitcnt lgkmcnt(6)
    v_mfma_f32_16x16x32_bf16 v[52:55], v[136:139], v[160:163], v[52:55]
    v_mfma_f32_16x16x32_bf16 v[56:59], v[136:139], v[164:167], v[56:59]
    v_mfma_f32_16x16x32_bf16 v[40:43], v[136:139], v[36:39], v[40:43]
    v_cmp_eq_u32 vcc, s4, v67
    s_nop 0
    s_cmp_eq_u32 vcc_lo, 0
    s_cselect_b32 s93, 1, 0
    s_waitcnt lgkmcnt(0)
    v_mfma_f32_16x16x32_bf16 v[52:55], v[140:143], v[168:171], v[52:55]
    v_mfma_f32_16x16x32_bf16 v[56:59], v[140:143], v[172:175], v[56:59]
    v_mfma_f32_16x16x32_bf16 v[40:43], v[140:143], v[36:39], v[40:43]
    s_cmp_lt_u32 s3, 4
    s_cbranch_scc1 L_NOQX
    ds_read_b128 v[44:47], v76 offset:2048
    ds_read_b128 v[48:51], v76 offset:3072
L_NOQX:
    s_nop 3
    buffer_store_dwordx4 v[52:55], v2, s[32:35], s13 offen sc1
    buffer_store_dwordx4 v[56:59], v2, s[32:35], s15 offen sc1
    s_mov_b32 exec_lo, 0x00010001
    s_mov_b32 exec_hi, 0x00010001
    buffer_store_dwordx4 v[40:43], v1, s[32:35], s14 offen sc1
    s_mov_b64 exec, -1
    s_waitcnt lgkmcnt(0)
    v_mfma_f32_32x32x16_bf16 v[112:127], v[28:31], v[44:47], 0
    v_mfma_f32_32x32x16_bf16 v[112:127], v[32:35], v[48:51], v[112:127]
    v_lshrrev_b32 v22, 3, v1
    v_lshlrev_b32 v22, 10, v22
    v_and_b32 v9, 7, v1
    v_lshl_add_u32 v22, v9, 4, v22
    v_and_b32 v76, 7, v1
    v_lshlrev_b32 v76, 4, v76
    v_lshrrev_b32 v9, 5, v1
    v_lshl_add_u32 v76, v9, 3, v76
    s_nop 3
    v_cvt_pk_bf16_f32 v112, 0, v112
    v_cvt_pk_bf16_f32 v113, 0, v113
    v_cvt_pk_bf16_f32 v114, 0, v114
    v_cvt_pk_bf16_f32 v115, 0, v115
    v_cvt_pk_bf16_f32 v116, 0, v116
    v_cvt_pk_bf16_f32 v117, 0, v117
    v_cvt_pk_bf16_f32 v118, 0, v118
    v_cvt_pk_bf16_f32 v119, 0, v119
    v_cvt_pk_bf16_f32 v120, 0, v120
    v_cvt_pk_bf16_f32 v121, 0, v121
    v_cvt_pk_bf16_f32 v122, 0, v122
    v_cvt_pk_bf16_f32 v123, 0, v123
    v_cvt_pk_bf16_f32 v124, 0, v124
    v_cvt_pk_bf16_f32 v125, 0, v125
    v_cvt_pk_bf16_f32 v126, 0, v126
    v_cvt_pk_bf16_f32 v127, 0, v127
    v_max3_f32 v52, v112, v113, v114
    v_min3_f32 v53, v112, v113, v114
    v_max3_f32 v52, v52, v115, v116
    v_min3_f32 v53, v53, v115, v116
    v_max3_f32 v52, v52, v117, v118
    v_min3_f32 v53, v53, v117, v118
    v_max3_f32 v52, v52, v119, v120
    v_min3_f32 v53, v53, v119, v120
    v_max3_f32 v52, v52, v121, v122
    v_min3_f32 v53, v53, v121, v122
    v_max3_f32 v52, v52, v123, v124
    v_min3_f32 v53, v53, v123, v124
    v_max3_f32 v52, v52, v125, v126
    v_min3_f32 v53, v53, v125, v126
    v_max_f32 v54, v52, v127
    v_min_f32 v55, v53, v127
    v_max_f32 v52, v52, v127
    v_min_f32 v53, v53, v127
    s_nop 0
    v_permlane32_swap_b32 v52, v54
    v_permlane32_swap_b32 v53, v55
    v_max_f32 v52, v52, v54
    v_min_f32 v53, v53, v55
    v_pk_mul_f32 v[52:53], v[52:53], s[6:7] op_sel:[0,1]
    v_pk_fma_f32 v[128:129], v[112:113], s[6:7], v[52:53] op_sel:[0,1,0] op_sel_hi:[1,1,0] neg_lo:[0,0,1] neg_hi:[0,0,1]
    v_pk_fma_f32 v[112:113], v[112:113], s[6:7], v[52:53] op_sel:[0,1,1] neg_lo:[1,0,0] neg_hi:[1,0,0]
    v_pk_fma_f32 v[130:131], v[114:115], s[6:7], v[52:53] op_sel:[0,1,0] op_sel_hi:[1,1,0] neg_lo:[0,0,1] neg_hi:[0,0,1]
    v_pk_fma_f32 v[114:115], v[114:115], s[6:7], v[52:53] op_sel:[0,1,1] neg_lo:[1,0,0] neg_hi:[1,0,0]
    v_pk_fma_f32 v[132:133], v[116:117], s[6:7], v[52:53] op_sel:[0,1,0] op_sel_hi:[1,1,0] neg_lo:[0,0,1] neg_hi:[0,0,1]
    v_pk_fma_f32 v[116:117], v[116:117], s[6:7], v[52:53] op_sel:[0,1,1] neg_lo:[1,0,0] neg_hi:[1,0,0]
    v_pk_fma_f32 v[134:135], v[118:119], s[6:7], v[52:53] op_sel:[0,1,0] op_sel_hi:[1,1,0] neg_lo:[0,0,1] neg_hi:[0,0,1]
    v_pk_fma_f32 v[118:119], v[118:119], s[6:7], v[52:53] op_sel:[0,1,1] neg_lo:[1,0,0] neg_hi:[1,0,0]
    v_pk_fma_f32 v[136:137], v[120:121], s[6:7], v[52:53] op_sel:[0,1,0] op_sel_hi:[1,1,0] neg_lo:[0,0,1] neg_hi:[0,0,1]
    v_pk_fma_f32 v[120:121], v[120:121], s[6:7], v[52:53] op_sel:[0,1,1] neg_lo:[1,0,0] neg_hi:[1,0,0]
    v_pk_fma_f32 v[138:139], v[122:123], s[6:7], v[52:53] op_sel:[0,1,0] op_sel_hi:[1,1,0] neg_lo:[0,0,1] neg_hi:[0,0,1]
    v_pk_fma_f32 v[122:123], v[122:123], s[6:7], v[52:53] op_sel:[0,1,1] neg_lo:[1,0,0] neg_hi:[1,0,0]
    v_pk_fma_f32 v[140:141], v[124:125], s[6:7], v[52:53] op_sel:[0,1,0] op_sel_hi:[1,1,0] neg_lo:[0,0,1] neg_hi:[0,0,1]
    v_pk_fma_f32 v[124:125], v[124:125], s[6:7], v[52:53] op_sel:[0,1,1] neg_lo:[1,0,0] neg_hi:[1,0,0]
    v_pk_fma_f32 v[142:143], v[126:127], s[6:7], v[52:53] op_sel:[0,1,0] op_sel_hi:[1,1,0] neg_lo:[0,0,1] neg_hi:[0,0,1]
    v_pk_fma_f32 v[126:127], v[126:127], s[6:7], v[52:53] op_sel:[0,1,1] neg_lo:[1,0,0] neg_hi:[1,0,0]
    v_exp_f32 v128, v128
    v_exp_f32 v112, v112
    v_exp_f32 v129, v129
    s_lshl_b32 s96, s11, 7
    s_add_u32 s18, s96, 32768
    s_lshl3_add_u32 s14, s10, s18
    v_and_b32 v23, 15, v1
    v_lshlrev_b32 v23, 3, v23
    s_waitcnt vmcnt(0)
    s_barrier
    s_cmp_lg_u32 s3, 0
    s_cbranch_scc1 L_PC
    v_mov_b32 v21, s4
    s_mov_b32 exec_hi, 0
    s_mov_b32 exec_lo, 65535
    buffer_store_dword v21, v75, s[32:35], s17 offen sc1
    s_mov_b64 exec, -1
L_PC:
    s_lshl4_add_u32 s96, s11, s10
    s_lshl_b32 s97, s96, 14
    s_lshl_b32 s98, s3, 7
    s_add_u32 s99, s97, s98
    s_add_u32 s13, s99, 25165824
    s_lshl4_add_u32 s96, s11, s10
    s_lshl_b32 s97, s96, 10
    s_lshl_b32 s98, s3, 7
    s_add_u32 s99, s97, s98
    s_add_u32 s15, s99, 29360128
    s_add_u32 s17, s17, 3072
    s_load_dwordx2 s[24:25], s[32:33], s92 offset:512 glc
    s_add_u32 s96, s84, 262144
    s_and_b32 s97, s96, 1048575
    s_lshl_b32 s98, s83, 16
    s_xor_b32 s99, s97, s98
    s_add_u32 s19, s99, s88
    s_add_u32 m0, s89, 49152
    s_nop 0
    buffer_load_dwordx4 v74, s[44:47], s19 offen lds
    v_exp_f32 v113, v113
    v_exp_f32 v130, v130
    v_exp_f32 v114, v114
    v_exp_f32 v131, v131
    v_exp_f32 v115, v115
    v_exp_f32 v132, v132
    v_exp_f32 v116, v116
    v_exp_f32 v133, v133
    v_exp_f32 v117, v117
    v_exp_f32 v134, v134
    s_add_u32 s96, s84, 393216
    s_and_b32 s97, s96, 1048575
    s_lshl_b32 s98, s83, 16
    s_xor_b32 s99, s97, s98
    s_add_u32 s19, s99, s88
    s_add_u32 m0, s89, 57344
    s_nop 0
    buffer_load_dwordx4 v74, s[44:47], s19 offen lds
    v_exp_f32 v118, v118
    v_exp_f32 v135, v135
    v_exp_f32 v119, v119
    v_exp_f32 v136, v136
    v_exp_f32 v120, v120
    v_exp_f32 v137, v137
    v_exp_f32 v121, v121
    v_exp_f32 v138, v138
    v_exp_f32 v122, v122
    s_add_u32 s96, s84, 524288
    s_and_b32 s97, s96, 1048575
    s_lshl_b32 s98, s83, 16
    s_xor_b32 s99, s97, s98
    s_add_u32 s19, s99, s88
    s_add_u32 m0, s89, 65536
    s_nop 0
    buffer_load_dwordx4 v74, s[44:47], s19 offen lds
    v_exp_f32 v139, v139
    v_exp_f32 v123, v123
    v_exp_f32 v140, v140
    v_exp_f32 v124, v124
    v_exp_f32 v141, v141
    v_exp_f32 v125, v125
    v_exp_f32 v142, v142
    v_exp_f32 v126, v126
    v_exp_f32 v143, v143
    v_exp_f32 v127, v127
    s_add_u32 s96, s84, 655360
    s_and_b32 s97, s96, 1048575
    s_lshl_b32 s98, s83, 16
    s_xor_b32 s99, s97, s98
    s_add_u32 s19, s99, s88
    s_add_u32 m0, s89, 73728
    s_nop 0
    buffer_load_dwordx4 v74, s[44:47], s19 offen lds
    v_pk_add_f32 v[56:57], v[128:129], v[130:131]
    v_pk_add_f32 v[58:59], v[112:113], v[114:115]
    v_pk_add_f32 v[56:57], v[56:57], v[132:133]
    v_pk_add_f32 v[58:59], v[58:59], v[116:117]
    v_pk_add_f32 v[56:57], v[56:57], v[134:135]
    v_pk_add_f32 v[58:59], v[58:59], v[118:119]
    v_pk_add_f32 v[56:57], v[56:57], v[136:137]
    v_pk_add_f32 v[58:59], v[58:59], v[120:121]
    v_pk_add_f32 v[56:57], v[56:57], v[138:139]
    s_add_u32 s96, s84, 786432
    s_and_b32 s97, s96, 1048575
    s_lshl_b32 s98, s83, 16
    s_xor_b32 s99, s97, s98
    s_add_u32 s19, s99, s88
    s_add_u32 m0, s89, 81920
    s_nop 0
    buffer_load_dwordx4 v74, s[44:47], s19 offen lds
    v_pk_add_f32 v[58:59], v[58:59], v[122:123]
    v_pk_add_f32 v[56:57], v[56:57], v[140:141]
    v_pk_add_f32 v[58:59], v[58:59], v[124:125]
    v_pk_add_f32 v[56:57], v[56:57], v[142:143]
    v_pk_add_f32 v[58:59], v[58:59], v[126:127]
    v_add_f32 v54, v56, v57
    v_add_f32 v55, v58, v59
    v_add_f32 v52, v56, v57
    v_add_f32 v53, v58, v59
    s_nop 0
    v_permlane32_swap_b32 v52, v54
    s_add_u32 s96, s84, 917504
    s_and_b32 s97, s96, 1048575
    s_lshl_b32 s98, s83, 16
    s_xor_b32 s99, s97, s98
    s_add_u32 s19, s99, s88
    s_add_u32 m0, s89, 90112
    s_nop 0
    buffer_load_dwordx4 v74, s[44:47], s19 offen lds
    v_permlane32_swap_b32 v53, v55
    v_pk_add_f32 v[52:53], v[52:53], v[54:55]
    v_rcp_f32 v52, v52
    v_rcp_f32 v53, v53
    s_nop 0
    v_pk_mul_f32 v[128:129], v[128:129], v[52:53] op_sel_hi:[1,0]
    v_pk_mul_f32 v[112:113], v[112:113], v[52:53] op_sel:[0,1]
    v_pk_mul_f32 v[130:131], v[130:131], v[52:53] op_sel_hi:[1,0]
    v_pk_mul_f32 v[114:115], v[114:115], v[52:53] op_sel:[0,1]
    v_pk_mul_f32 v[132:133], v[132:133], v[52:53] op_sel_hi:[1,0]
    s_branch SCHK_18
SPOLL_17:
    s_load_dwordx2 s[24:25], s[32:33], s92 offset:512 glc
SCHK_18:
    s_add_u32 s5, s5, 1
    s_cmp_ge_u32 s5, 300000
    s_waitcnt lgkmcnt(0)
    s_cbranch_scc1 SDONE_19
    s_cmp_lg_u32 s24, s4
    s_cbranch_scc1 SPOLL_17
    s_cmp_lg_u32 s25, s4
    s_cbranch_scc1 SPOLL_17
SDONE_19:
    s_barrier
    s_add_u32 s18, s13, 8192
    buffer_load_dwordx4 v[144:147], v22, s[32:35], s13 offen sc1
    buffer_load_dwordx4 v[148:151], v22, s[32:35], s18 offen sc1
    buffer_load_dwordx4 v[160:163], v2, s[32:35], s16 offen sc1
    s_lshl_b32 s96, s3, 5
    s_add_u32 s14, s96, 8192
    v_and_b32 v6, 3, v1
    v_lshl_add_u32 v6, v6, 3, s14
    v_lshrrev_b32 v9, 5, v1
    v_lshl_add_u32 v6, v9, 2, v6
    s_lshl_b32 s14, s3, 10
    v_and_b32 v5, 15, v1
    v_lshl_add_u32 v5, v5, 4, s14
    v_lshrrev_b32 v9, 5, v1
    v_lshl_add_u32 v5, v9, 9, v5
    v_bfe_u32 v9, v1, 4, 1
    v_lshl_add_u32 v5, v9, 3, v5
    s_lshl_b32 s96, s76, 7
    s_add_u32 s14, s96, 8192
    v_lshrrev_b32 v7, 5, v1
    v_lshl_add_u32 v7, v7, 4, s14
    s_lshl_b32 s14, s76, 12
    v_add_u32 v20, s14, v2
    v_pk_mul_f32 v[116:117], v[116:117], v[52:53] op_sel:[0,1]
    v_pk_mul_f32 v[134:135], v[134:135], v[52:53] op_sel_hi:[1,0]
    v_pk_mul_f32 v[118:119], v[118:119], v[52:53] op_sel:[0,1]
    v_pk_mul_f32 v[136:137], v[136:137], v[52:53] op_sel_hi:[1,0]
    v_pk_mul_f32 v[120:121], v[120:121], v[52:53] op_sel:[0,1]
    v_pk_mul_f32 v[138:139], v[138:139], v[52:53] op_sel_hi:[1,0]
    v_pk_mul_f32 v[122:123], v[122:123], v[52:53] op_sel:[0,1]
    v_pk_mul_f32 v[140:141], v[140:141], v[52:53] op_sel_hi:[1,0]
    v_pk_mul_f32 v[124:125], v[124:125], v[52:53] op_sel:[0,1]
    v_pk_mul_f32 v[142:143], v[142:143], v[52:53] op_sel_hi:[1,0]
    v_pk_mul_f32 v[126:127], v[126:127], v[52:53] op_sel:[0,1]
    v_cvt_pk_bf16_f32 v80, v128, v129
    v_cvt_pk_bf16_f32 v88, v112, v113
    v_cvt_pk_bf16_f32 v81, v130, v131
    v_cvt_pk_bf16_f32 v89, v114, v115
    v_cvt_pk_bf16_f32 v82, v132, v133
    v_cvt_pk_bf16_f32 v90, v116, v117
    v_cvt_pk_bf16_f32 v83, v134, v135
    v_cvt_pk_bf16_f32 v91, v118, v119
    v_cvt_pk_bf16_f32 v84, v136, v137
    v_cvt_pk_bf16_f32 v92, v120, v121
    v_cvt_pk_bf16_f32 v85, v138, v139
    v_cvt_pk_bf16_f32 v93, v122, v123
    v_cvt_pk_bf16_f32 v86, v140, v141
    v_cvt_pk_bf16_f32 v94, v124, v125
    v_cvt_pk_bf16_f32 v87, v142, v143
    v_cvt_pk_bf16_f32 v95, v126, v127
    s_waitcnt vmcnt(1)
    v_pk_add_f32 v[144:145], v[144:145], v[148:149]
    v_pk_add_f32 v[146:147], v[146:147], v[150:151]
    s_nop 1
    v_permlane32_swap_b32 v144, v146
    v_permlane32_swap_b32 v145, v147
    v_pk_add_f32 v[144:145], v[144:145], v[146:147]
    s_nop 1
    v_add_f32_dpp v144, v144, v144 row_ror:8 row_mask:0xf bank_mask:0xf
    v_add_f32_dpp v145, v145, v145 row_ror:8 row_mask:0xf bank_mask:0xf
    v_mov_b32 v146, v144
    v_mov_b32 v147, v145
    s_nop 0
    v_permlane16_swap_b32 v144, v146
    v_permlane16_swap_b32 v145, v147
    v_pk_add_f32 v[144:145], v[144:145], v[146:147]
    v_cvt_pk_bf16_f32 v144, v144, v145
    v_mov_b32 v145, s4
    s_mov_b32 exec_lo, 0xff
    s_mov_b32 exec_hi, 0xff
    s_cmp_lg_u32 s93, 0
    s_cbranch_scc1 LOC_20
    buffer_store_dwordx2 v[144:145], v76, s[32:35], s15 offen sc1
    s_branch LOCD_21
LOC_20:
    buffer_store_dwordx2 v[144:145], v76, s[32:35], s15 offen
LOCD_21:
    s_mov_b64 exec, -1
    v_mov_b32 v224, v144
    v_mov_b32 v225, v145
    v_add_u32 v226, s15, v76
    s_cbranch_scc1 L_PC2
    s_barrier
    s_cmp_lg_u32 s3, 0
    s_cbranch_scc1 L_PC2
    v_mov_b32 v21, s4
    s_mov_b32 exec_hi, 0
    s_mov_b32 exec_lo, 65535
    buffer_store_dword v21, v75, s[32:35], s17 offen sc1
    s_mov_b64 exec, -1
L_PC2:
    s_waitcnt vmcnt(0)
    s_add_u32 s96, s84, 1048576
    s_and_b32 s97, s96, 1048575
    s_lshl_b32 s98, s83, 16
    s_xor_b32 s99, s97, s98
    s_xor_b32 s96, s88, 1048576
    s_add_u32 s19, s99, s96
    s_add_u32 m0, s89, 98304
    s_nop 0
    buffer_load_dwordx4 v74, s[44:47], s19 offen lds
    v_permlane32_swap_b32 v160, v162
    v_permlane32_swap_b32 v161, v163
    v_pk_add_f32 v[160:161], v[160:161], v[162:163]
    s_nop 1
    v_add_f32_dpp v160, v160, v160 row_ror:4 row_mask:0xf bank_mask:0xf
    v_add_f32_dpp v161, v161, v161 row_ror:4 row_mask:0xf bank_mask:0xf
    s_add_u32 s96, s84, 1703936
    s_and_b32 s97, s96, 1048575
    s_lshl_b32 s98, s83, 16
    s_xor_b32 s99, s97, s98
    s_xor_b32 s96, s88, 1048576
    s_add_u32 s19, s99, s96
    s_add_u32 m0, s89, 139264
    s_nop 0
    buffer_load_dwordx4 v74, s[44:47], s19 offen lds
    v_add_f32_dpp v160, v160, v160 row_ror:8 row_mask:0xf bank_mask:0xf
    v_add_f32_dpp v161, v161, v161 row_ror:8 row_mask:0xf bank_mask:0xf
    v_mov_b32 v162, v160
    v_mov_b32 v163, v161
    s_add_u32 s96, s84, 1835008
    s_and_b32 s97, s96, 1048575
    s_lshl_b32 s98, s83, 16
    s_xor_b32 s99, s97, s98
    s_xor_b32 s96, s88, 1048576
    s_add_u32 s19, s99, s96
    s_add_u32 m0, s89, 147456
    s_nop 0
    buffer_load_dwordx4 v74, s[44:47], s19 offen lds
    v_permlane16_swap_b32 v160, v162
    v_permlane16_swap_b32 v161, v163
    v_pk_add_f32 v[160:161], v[160:161], v[162:163]
    v_cvt_pk_bf16_f32 v160, v160, v161
    ds_write_b32 v6, v160
    s_waitcnt lgkmcnt(0)
    s_barrier
    ds_read_b128 v[160:163], v7
    ds_read_b128 v[164:167], v7 offset:32
    ds_read_b128 v[168:171], v7 offset:64
    ds_read_b128 v[172:175], v7 offset:96
    s_waitcnt lgkmcnt(0)
    s_lshl3_add_u32 s96, s11, s3
    s_lshl_b32 s97, s96, 11
    s_add_u32 s13, s97, 29360128
    s_cmp_lg_u32 s93, 0
    s_cbranch_scc1 L_C2L
SPOLL_22:
    s_load_dwordx2 s[24:25], s[32:33], s92 offset:3584 glc
SCHK_23:
    s_add_u32 s5, s5, 1
    s_cmp_ge_u32 s5, 300000
    s_waitcnt lgkmcnt(0)
    s_cbranch_scc1 SDONE_24
    s_cmp_lg_u32 s24, s4
    s_cbranch_scc1 SPOLL_22
    s_cmp_lg_u32 s25, s4
    s_cbranch_scc1 SPOLL_22
SDONE_24:
L_C2L:
    buffer_load_dwordx4 v[152:155], v2, s[32:35], s13 offen sc1
    buffer_load_dwordx4 v[156:159], v2, s[32:35], s13 offen offset:1024 sc1
    v_mfma_f32_32x32x16_bf16 v[128:143], v[160:163], v[80:83], 0
    v_mfma_f32_32x32x16_bf16 v[128:143], v[164:167], v[84:87], v[128:143]
    v_mfma_f32_32x32x16_bf16 v[128:143], v[168:171], v[88:91], v[128:143]
    v_mfma_f32_32x32x16_bf16 v[128:143], v[172:175], v[92:95], v[128:143]
    s_nop 11
    v_cvt_pk_bf16_f32 v128, 0, v128
    v_add_f32 v128, 0x358637bd, v128
    v_cvt_pk_bf16_f32 v128, 0, v128
    v_rcp_f32 v128, v128
    s_waitcnt vmcnt(0)
    v_bitop3_b32 v4, v153, v155, s4 bitop3:0x7e
    v_bitop3_b32 v4, v4, v157, s4 bitop3:0xf6
    v_bitop3_b32 v4, v4, v159, s4 bitop3:0xf6
    v_cmp_ne_u32 vcc, 0, v4
    s_cbranch_vccz TOK_26
POLL_27:
    buffer_load_dwordx4 v[152:155], v2, s[32:35], s13 offen sc1
    buffer_load_dwordx4 v[156:159], v2, s[32:35], s13 offen offset:1024 sc1
    s_waitcnt vmcnt(0)
    v_bitop3_b32 v4, v153, v155, s4 bitop3:0x7e
    v_bitop3_b32 v4, v4, v157, s4 bitop3:0xf6
    v_bitop3_b32 v4, v4, v159, s4 bitop3:0xf6
    v_cmp_ne_u32 vcc, 0, v4
    s_cbranch_vccz PDONE_28
    s_add_u32 s5, s5, 1
    s_cmp_lt_u32 s5, 300000
    s_cbranch_scc1 POLL_27
PDONE_28:
TOK_26:
    ds_write2_b32 v5, v152, v154 offset0:0 offset1:1
    ds_write2_b32 v5, v156, v158 offset0:64 offset1:65
    s_waitcnt lgkmcnt(0)
    s_barrier
    ds_read_b128 v[144:147], v20
    ds_read_b128 v[148:151], v20 offset:1024
    ds_read_b128 v[152:155], v20 offset:2048
    ds_read_b128 v[156:159], v20 offset:3072
    s_and_b32 s96, s3, 3
    s_lshl2_add_u32 s97, s10, s96
    s_lshl4_add_u32 s98, s97, s11
    s_lshl1_add_u32 s99, s98, s76
    s_lshl_b32 s96, s99, 11
    s_add_u32 s13, s96, 8388608
    v_and_b32 v8, 15, v1
    v_lshlrev_b32 v8, 4, v8
    v_bfe_u32 v9, v1, 4, 1
    v_lshl_add_u32 v8, v9, 10, v8
    v_lshrrev_b32 v9, 5, v1
    v_lshl_add_u32 v8, v9, 8, v8
    s_waitcnt lgkmcnt(3)
    v_mfma_f32_32x32x16_bf16 v[112:127], v[144:147], v[80:83], 0
    s_waitcnt lgkmcnt(2)
    v_mfma_f32_32x32x16_bf16 v[112:127], v[148:151], v[84:87], v[112:127]
    s_waitcnt lgkmcnt(1)
    v_mfma_f32_32x32x16_bf16 v[112:127], v[152:155], v[88:91], v[112:127]
    s_waitcnt lgkmcnt(0)
    v_mfma_f32_32x32x16_bf16 v[112:127], v[156:159], v[92:95], v[112:127]
    s_nop 11
    v_cvt_pk_bf16_f32 v112, 0, v112
    v_cvt_pk_bf16_f32 v113, 0, v113
    v_cvt_pk_bf16_f32 v114, 0, v114
    v_cvt_pk_bf16_f32 v115, 0, v115
    v_cvt_pk_bf16_f32 v116, 0, v116
    v_cvt_pk_bf16_f32 v117, 0, v117
    v_cvt_pk_bf16_f32 v118, 0, v118
    v_cvt_pk_bf16_f32 v119, 0, v119
    v_pk_mul_f32 v[112:113], v[112:113], v[128:129] op_sel_hi:[1,0]
    v_pk_mul_f32 v[114:115], v[114:115], v[128:129] op_sel_hi:[1,0]
    v_pk_mul_f32 v[116:117], v[116:117], v[128:129] op_sel_hi:[1,0]
    v_pk_mul_f32 v[118:119], v[118:119], v[128:129] op_sel_hi:[1,0]
    v_cvt_pk_bf16_f32 v44, v112, v113
    v_cvt_pk_bf16_f32 v45, v114, v115
    v_cvt_pk_bf16_f32 v46, v116, v117
    v_cvt_pk_bf16_f32 v47, v118, v119
    buffer_store_dwordx4 v[44:47], v8, s[32:35], s13 offen sc1
    v_cvt_pk_bf16_f32 v120, 0, v120
    v_cvt_pk_bf16_f32 v121, 0, v121
    v_cvt_pk_bf16_f32 v122, 0, v122
    v_cvt_pk_bf16_f32 v123, 0, v123
    v_cvt_pk_bf16_f32 v124, 0, v124
    v_cvt_pk_bf16_f32 v125, 0, v125
    v_cvt_pk_bf16_f32 v126, 0, v126
    v_cvt_pk_bf16_f32 v127, 0, v127
    v_pk_mul_f32 v[120:121], v[120:121], v[128:129] op_sel_hi:[1,0]
    v_pk_mul_f32 v[122:123], v[122:123], v[128:129] op_sel_hi:[1,0]
    v_pk_mul_f32 v[124:125], v[124:125], v[128:129] op_sel_hi:[1,0]
    v_pk_mul_f32 v[126:127], v[126:127], v[128:129] op_sel_hi:[1,0]
    v_cvt_pk_bf16_f32 v48, v120, v121
    v_cvt_pk_bf16_f32 v49, v122, v123
    v_cvt_pk_bf16_f32 v50, v124, v125
    v_cvt_pk_bf16_f32 v51, v126, v127
    buffer_store_dwordx4 v[48:51], v8, s[32:35], s13 offen offset:512 sc1
    s_mul_i32 s96, s76, 65600
    s_add_u32 s17, s96, 32768
    v_lshrrev_b32 v20, 5, v1
    v_lshlrev_b32 v20, 11, v20
    v_bfe_u32 v9, v1, 4, 1
    v_lshl_add_u32 v20, v9, 9, v20
    v_bfe_u32 v9, v1, 2, 2
    v_lshl_add_u32 v20, v9, 7, v20
    v_bfe_u32 v9, v1, 3, 1
    v_lshl_add_u32 v20, v9, 6, v20
    v_bfe_u32 v9, v1, 1, 1
    v_lshl_add_u32 v20, v9, 5, v20
    v_bfe_u32 v9, v1, 4, 1
    v_lshl_add_u32 v20, v9, 4, v20
    v_and_b32 v9, 1, v1
    v_lshl_add_u32 v20, v9, 3, v20
    v_xor_b32 v20, s17, v20
    v_xor_b32 v21, 16, v20
    v_xor_b32 v22, 64, v20
    v_xor_b32 v23, 80, v20
    v_and_b32 v5, 7, v1
    v_lshlrev_b32 v5, 15, v5
    v_bfe_u32 v9, v1, 3, 1
    v_lshl_add_u32 v5, v9, 12, v5
    s_bfe_u32 s96, s11, 65538
    s_lshr_b32 s97, s10, 2
    s_and_b32 s98, s10, 3
    s_lshl_b32 s99, s98, 6
    s_lshl1_add_u32 s98, s97, s99
    s_lshl_b32 s97, s98, 12
    s_lshr_b32 s99, s11, 3
    s_and_b32 s98, s11, 3
    s_lshl2_add_u32 s99, s99, s98
    s_lshl_b32 s98, s99, 6
    s_add_u32 s99, s97, s98
    s_lshl2_add_u32 s97, s96, s99
    s_add_u32 s98, s97, 1048576
    s_add_u32 s15, s98, 1024
    v_mov_b32 v52, 0x10000
    v_mov_b32 v53, s6
    v_lshlrev_b32 v28, 16, v12
    v_and_b32 v29, s6, v12
    v_lshlrev_b32 v30, 16, v13
    v_and_b32 v31, s6, v13
    v_lshlrev_b32 v32, 16, v14
    v_and_b32 v33, s6, v14
    v_lshlrev_b32 v34, 16, v15
    v_and_b32 v35, s6, v15
    v_lshlrev_b32 v36, 16, v16
    v_and_b32 v37, s6, v16
    v_lshlrev_b32 v38, 16, v17
    v_and_b32 v39, s6, v17
    v_lshlrev_b32 v40, 16, v18
    v_and_b32 v41, s6, v18
    v_lshlrev_b32 v42, 16, v19
    v_and_b32 v43, s6, v19
    v_mul_u32_u24_dpp v76, v64, v52 row_newbcast:0 row_mask:0xf bank_mask:0xf
    v_and_b32_dpp v77, v64, v53 row_newbcast:0 row_mask:0xf bank_mask:0xf
    v_mul_u32_u24_dpp v78, v64, v52 row_newbcast:1 row_mask:0xf bank_mask:0xf
    v_and_b32_dpp v79, v64, v53 row_newbcast:1 row_mask:0xf bank_mask:0xf
    v_mul_u32_u24_dpp v80, v64, v52 row_newbcast:2 row_mask:0xf bank_mask:0xf
    v_and_b32_dpp v81, v64, v53 row_newbcast:2 row_mask:0xf bank_mask:0xf
    v_mul_u32_u24_dpp v82, v64, v52 row_newbcast:3 row_mask:0xf bank_mask:0xf
    v_and_b32_dpp v83, v64, v53 row_newbcast:3 row_mask:0xf bank_mask:0xf
    v_mul_u32_u24_dpp v84, v64, v52 row_newbcast:4 row_mask:0xf bank_mask:0xf
    v_and_b32_dpp v85, v64, v53 row_newbcast:4 row_mask:0xf bank_mask:0xf
    v_mul_u32_u24_dpp v86, v64, v52 row_newbcast:5 row_mask:0xf bank_mask:0xf
    v_and_b32_dpp v87, v64, v53 row_newbcast:5 row_mask:0xf bank_mask:0xf
    v_mul_u32_u24_dpp v88, v64, v52 row_newbcast:6 row_mask:0xf bank_mask:0xf
    v_and_b32_dpp v89, v64, v53 row_newbcast:6 row_mask:0xf bank_mask:0xf
    v_mul_u32_u24_dpp v90, v64, v52 row_newbcast:7 row_mask:0xf bank_mask:0xf
    v_and_b32_dpp v91, v64, v53 row_newbcast:7 row_mask:0xf bank_mask:0xf
    s_lshl1_add_u32 s96, s94, s77
    s_lshl_b32 s97, s96, 15
    s_add_u32 s19, s97, 8388608
    v_and_b32 v25, 15, v1
    v_lshlrev_b32 v25, 3, v25
    s_waitcnt vmcnt(0)
    s_waitcnt lgkmcnt(0)
    s_barrier
    s_cmp_lg_u32 s3, 0
    s_cbranch_scc1 L_PD
    v_mov_b32 v6, s4
    s_mov_b32 exec_hi, 0
    s_mov_b32 exec_lo, 65535
    buffer_store_dword v6, v5, s[32:35], s15 offen sc1
    s_mov_b64 exec, -1
L_PD:
    s_add_u32 s96, s84, 1966080
    s_and_b32 s97, s96, 1048575
    s_lshl_b32 s98, s83, 16
    s_xor_b32 s99, s97, s98
    s_xor_b32 s96, s88, 1048576
    s_add_u32 s13, s99, s96
    s_add_u32 m0, s89, 155648
    s_nop 0
    buffer_load_dwordx4 v74, s[44:47], s13 offen lds
    s_and_b32 s96, s84, 1048575
    s_lshl_b32 s97, s83, 16
    s_xor_b32 s98, s96, s97
    s_add_u32 s13, s98, s88
    s_add_u32 m0, s89, 32768
    s_nop 0
    buffer_load_dwordx4 v74, s[44:47], s13 offen lds
    s_add_u32 s96, s84, 131072
    s_and_b32 s97, s96, 1048575
    s_lshl_b32 s98, s83, 16
    s_xor_b32 s99, s97, s98
    s_add_u32 s13, s99, s88
    s_add_u32 m0, s89, 40960
    s_nop 0
    buffer_load_dwordx4 v74, s[44:47], s13 offen lds
    s_load_dwordx2 s[24:25], s[32:33], s92 offset:1024 glc
    v_mov_b32_dpp v112, v65 row_newbcast:0 row_mask:0xf bank_mask:0xf
    v_mov_b32_dpp v113, v65 row_newbcast:1 row_mask:0xf bank_mask:0xf
    v_mov_b32_dpp v114, v65 row_newbcast:2 row_mask:0xf bank_mask:0xf
    v_mov_b32_dpp v115, v65 row_newbcast:3 row_mask:0xf bank_mask:0xf
    v_mov_b32_dpp v116, v65 row_newbcast:4 row_mask:0xf bank_mask:0xf
    v_mov_b32_dpp v117, v65 row_newbcast:5 row_mask:0xf bank_mask:0xf
    v_mov_b32_dpp v118, v65 row_newbcast:6 row_mask:0xf bank_mask:0xf
    v_mov_b32_dpp v119, v65 row_newbcast:7 row_mask:0xf bank_mask:0xf
    v_mov_b32_dpp v120, v66 row_newbcast:0 row_mask:0xf bank_mask:0xf
    v_mov_b32_dpp v121, v66 row_newbcast:1 row_mask:0xf bank_mask:0xf
    v_mov_b32_dpp v122, v66 row_newbcast:2 row_mask:0xf bank_mask:0xf
    v_mov_b32_dpp v123, v66 row_newbcast:3 row_mask:0xf bank_mask:0xf
    v_mov_b32_dpp v124, v66 row_newbcast:4 row_mask:0xf bank_mask:0xf
    v_mov_b32_dpp v125, v66 row_newbcast:5 row_mask:0xf bank_mask:0xf
    v_mov_b32_dpp v126, v66 row_newbcast:6 row_mask:0xf bank_mask:0xf
    v_mov_b32_dpp v127, v66 row_newbcast:7 row_mask:0xf bank_mask:0xf
    s_waitcnt vmcnt(0)
    s_branch SCHK_30
SPOLL_29:
    s_load_dwordx2 s[24:25], s[32:33], s92 offset:1024 glc
SCHK_30:
    s_add_u32 s5, s5, 1
    s_cmp_ge_u32 s5, 300000
    s_waitcnt lgkmcnt(0)
    s_cbranch_scc1 SDONE_31
    s_cmp_lg_u32 s24, s4
    s_cbranch_scc1 SPOLL_29
SDONE_31:
    s_barrier
    s_cmp_lt_u32 s3, 4
    s_cbranch_scc1 L_P2
    s_setprio 1
L_P2:
    s_lshl_b32 s96, s21, 7
    s_add_u32 s18, s96, 65536
    s_lshl_b32 s96, s83, 11
    s_add_u32 s20, s96, s19
    buffer_load_dwordx4 v[160:163], v2, s[32:35], s20 offen sc1
    buffer_load_dwordx4 v[164:167], v2, s[32:35], s20 offen offset:1024 sc1
    ds_read_b64_tr_b16 v[228:229], v22
    ds_read_b64_tr_b16 v[230:231], v22 offset:1024
    ds_read_b64_tr_b16 v[232:233], v23
    ds_read_b64_tr_b16 v[234:235], v23 offset:1024
    ds_read_b64_tr_b16 v[236:237], v20
    ds_read_b64_tr_b16 v[238:239], v20 offset:1024
    ds_read_b64_tr_b16 v[240:241], v21
    ds_read_b64_tr_b16 v[242:243], v21 offset:1024
    s_xor_b32 s96, s83, 1
    s_lshl_b32 s97, s96, 11
    s_add_u32 s20, s97, s19
    buffer_load_dwordx4 v[168:171], v2, s[32:35], s20 offen sc1
    buffer_load_dwordx4 v[172:175], v2, s[32:35], s20 offen offset:1024 sc1
    s_waitcnt lgkmcnt(6)
    s_waitcnt vmcnt(3)
    v_mfma_f32_16x16x32_bf16 v[144:147], v[228:231], v[160:163], 0
    ds_read_b64_tr_b16 v[244:245], v22 offset:4096
    s_waitcnt vmcnt(2)
    v_mfma_f32_16x16x32_bf16 v[148:151], v[228:231], v[164:167], 0
    ds_read_b64_tr_b16 v[246:247], v22 offset:5120
    s_waitcnt lgkmcnt(6)
    v_mfma_f32_16x16x32_bf16 v[152:155], v[232:235], v[160:163], 0
    ds_read_b64_tr_b16 v[228:229], v23 offset:4096
    v_mfma_f32_16x16x32_bf16 v[156:159], v[232:235], v[164:167], 0
    ds_read_b64_tr_b16 v[230:231], v23 offset:5120
    s_waitcnt lgkmcnt(6)
    v_mfma_f32_16x16x32_bf16 v[128:131], v[236:239], v[160:163], 0
    ds_read_b64_tr_b16 v[232:233], v20 offset:4096
    v_mfma_f32_16x16x32_bf16 v[132:135], v[236:239], v[164:167], 0
    ds_read_b64_tr_b16 v[234:235], v20 offset:5120
    s_waitcnt lgkmcnt(6)
    v_mfma_f32_16x16x32_bf16 v[136:139], v[240:243], v[160:163], 0
    ds_read_b64_tr_b16 v[236:237], v21 offset:4096
    v_mfma_f32_16x16x32_bf16 v[140:143], v[240:243], v[164:167], 0
    ds_read_b64_tr_b16 v[238:239], v21 offset:5120
    s_xor_b32 s96, s83, 2
    s_lshl_b32 s97, s96, 11
    s_add_u32 s20, s97, s19
    buffer_load_dwordx4 v[160:163], v2, s[32:35], s20 offen sc1
    buffer_load_dwordx4 v[164:167], v2, s[32:35], s20 offen offset:1024 sc1
    s_waitcnt lgkmcnt(6)
    s_waitcnt vmcnt(3)
    v_mfma_f32_16x16x32_bf16 v[144:147], v[244:247], v[168:171], v[144:147]
    ds_read_b64_tr_b16 v[240:241], v22 offset:8192
    s_waitcnt vmcnt(2)
    v_mfma_f32_16x16x32_bf16 v[148:151], v[244:247], v[172:175], v[148:151]
    ds_read_b64_tr_b16 v[242:243], v22 offset:9216
    s_waitcnt lgkmcnt(6)
    v_mfma_f32_16x16x32_bf16 v[152:155], v[228:231], v[168:171], v[152:155]
    ds_read_b64_tr_b16 v[244:245], v23 offset:8192
    v_mfma_f32_16x16x32_bf16 v[156:159], v[228:231], v[172:175], v[156:159]
    ds_read_b64_tr_b16 v[246:247], v23 offset:9216
    s_waitcnt lgkmcnt(6)
    v_mfma_f32_16x16x32_bf16 v[128:131], v[232:235], v[168:171], v[128:131]
    ds_read_b64_tr_b16 v[228:229], v20 offset:8192
    v_mfma_f32_16x16x32_bf16 v[132:135], v[232:235], v[172:175], v[132:135]
    ds_read_b64_tr_b16 v[230:231], v20 offset:9216
    s_waitcnt lgkmcnt(6)
    v_mfma_f32_16x16x32_bf16 v[136:139], v[236:239], v[168:171], v[136:139]
    ds_read_b64_tr_b16 v[232:233], v21 offset:8192
    v_mfma_f32_16x16x32_bf16 v[140:143], v[236:239], v[172:175], v[140:143]
    ds_read_b64_tr_b16 v[234:235], v21 offset:9216
    s_xor_b32 s96, s83, 3
    s_lshl_b32 s97, s96, 11
    s_add_u32 s20, s97, s19
    buffer_load_dwordx4 v[168:171], v2, s[32:35], s20 offen sc1
    buffer_load_dwordx4 v[172:175], v2, s[32:35], s20 offen offset:1024 sc1
    s_waitcnt lgkmcnt(6)
    s_waitcnt vmcnt(3)
    v_mfma_f32_16x16x32_bf16 v[144:147], v[240:243], v[160:163], v[144:147]
    ds_read_b64_tr_b16 v[236:237], v22 offset:12288
    s_waitcnt vmcnt(2)
    v_mfma_f32_16x16x32_bf16 v[148:151], v[240:243], v[164:167], v[148:151]
    ds_read_b64_tr_b16 v[238:239], v22 offset:13312
    s_waitcnt lgkmcnt(6)
    v_mfma_f32_16x16x32_bf16 v[152:155], v[244:247], v[160:163], v[152:155]
    ds_read_b64_tr_b16 v[240:241], v23 offset:12288
    v_mfma_f32_16x16x32_bf16 v[156:159], v[244:247], v[164:167], v[156:159]
    ds_read_b64_tr_b16 v[242:243], v23 offset:13312
    s_waitcnt lgkmcnt(6)
    v_mfma_f32_16x16x32_bf16 v[128:131], v[228:231], v[160:163], v[128:131]
    ds_read_b64_tr_b16 v[244:245], v20 offset:12288
    v_mfma_f32_16x16x32_bf16 v[132:135], v[228:231], v[164:167], v[132:135]
    ds_read_b64_tr_b16 v[246:247], v20 offset:13312
    s_waitcnt lgkmcnt(6)
    v_mfma_f32_16x16x32_bf16 v[136:139], v[232:235], v[160:163], v[136:139]
    ds_read_b64_tr_b16 v[228:229], v21 offset:12288
    v_mfma_f32_16x16x32_bf16 v[140:143], v[232:235], v[164:167], v[140:143]
    ds_read_b64_tr_b16 v[230:231], v21 offset:13312
    s_xor_b32 s96, s83, 4
    s_lshl_b32 s97, s96, 11
    s_add_u32 s20, s97, s19
    buffer_load_dwordx4 v[160:163], v2, s[32:35], s20 offen sc1
    buffer_load_dwordx4 v[164:167], v2, s[32:35], s20 offen offset:1024 sc1
    s_waitcnt lgkmcnt(6)
    s_waitcnt vmcnt(3)
    v_mfma_f32_16x16x32_bf16 v[144:147], v[236:239], v[168:171], v[144:147]
    ds_read_b64_tr_b16 v[232:233], v22 offset:16384
    s_waitcnt vmcnt(2)
    v_mfma_f32_16x16x32_bf16 v[148:151], v[236:239], v[172:175], v[148:151]
    ds_read_b64_tr_b16 v[234:235], v22 offset:17408
    s_waitcnt lgkmcnt(6)
    v_mfma_f32_16x16x32_bf16 v[152:155], v[240:243], v[168:171], v[152:155]
    ds_read_b64_tr_b16 v[236:237], v23 offset:16384
    v_mfma_f32_16x16x32_bf16 v[156:159], v[240:243], v[172:175], v[156:159]
    ds_read_b64_tr_b16 v[238:239], v23 offset:17408
    s_waitcnt lgkmcnt(6)
    v_mfma_f32_16x16x32_bf16 v[128:131], v[244:247], v[168:171], v[128:131]
    ds_read_b64_tr_b16 v[240:241], v20 offset:16384
    v_mfma_f32_16x16x32_bf16 v[132:135], v[244:247], v[172:175], v[132:135]
    ds_read_b64_tr_b16 v[242:243], v20 offset:17408
    s_waitcnt lgkmcnt(6)
    v_mfma_f32_16x16x32_bf16 v[136:139], v[228:231], v[168:171], v[136:139]
    ds_read_b64_tr_b16 v[244:245], v21 offset:16384
    v_mfma_f32_16x16x32_bf16 v[140:143], v[228:231], v[172:175], v[140:143]
    ds_read_b64_tr_b16 v[246:247], v21 offset:17408
    s_xor_b32 s96, s83, 5
    s_lshl_b32 s97, s96, 11
    s_add_u32 s20, s97, s19
    buffer_load_dwordx4 v[168:171], v2, s[32:35], s20 offen sc1
    buffer_load_dwordx4 v[172:175], v2, s[32:35], s20 offen offset:1024 sc1
    s_waitcnt lgkmcnt(6)
    s_waitcnt vmcnt(3)
    v_mfma_f32_16x16x32_bf16 v[144:147], v[232:235], v[160:163], v[144:147]
    ds_read_b64_tr_b16 v[228:229], v22 offset:20480
    s_waitcnt vmcnt(2)
    v_mfma_f32_16x16x32_bf16 v[148:151], v[232:235], v[164:167], v[148:151]
    ds_read_b64_tr_b16 v[230:231], v22 offset:21504
    s_setprio 0
    s_waitcnt lgkmcnt(6)
    v_mfma_f32_16x16x32_bf16 v[152:155], v[236:239], v[160:163], v[152:155]
    ds_read_b64_tr_b16 v[232:233], v23 offset:20480
    v_mfma_f32_16x16x32_bf16 v[156:159], v[236:239], v[164:167], v[156:159]
    ds_read_b64_tr_b16 v[234:235], v23 offset:21504
    s_waitcnt lgkmcnt(6)
    v_mfma_f32_16x16x32_bf16 v[128:131], v[240:243], v[160:163], v[128:131]
    ds_read_b64_tr_b16 v[236:237], v20 offset:20480
    v_mfma_f32_16x16x32_bf16 v[132:135], v[240:243], v[164:167], v[132:135]
    ds_read_b64_tr_b16 v[238:239], v20 offset:21504
    s_waitcnt lgkmcnt(6)
    v_mfma_f32_16x16x32_bf16 v[136:139], v[244:247], v[160:163], v[136:139]
    ds_read_b64_tr_b16 v[240:241], v21 offset:20480
    v_mfma_f32_16x16x32_bf16 v[140:143], v[244:247], v[164:167], v[140:143]
    ds_read_b64_tr_b16 v[242:243], v21 offset:21504
    s_xor_b32 s96, s83, 6
    s_lshl_b32 s97, s96, 11
    s_add_u32 s20, s97, s19
    buffer_load_dwordx4 v[160:163], v2, s[32:35], s20 offen sc1
    buffer_load_dwordx4 v[164:167], v2, s[32:35], s20 offen offset:1024 sc1
    s_waitcnt lgkmcnt(6)
    s_waitcnt vmcnt(3)
    v_mfma_f32_16x16x32_bf16 v[144:147], v[228:231], v[168:171], v[144:147]
    ds_read_b64_tr_b16 v[244:245], v22 offset:24576
    s_waitcnt vmcnt(2)
    v_mfma_f32_16x16x32_bf16 v[148:151], v[228:231], v[172:175], v[148:151]
    ds_read_b64_tr_b16 v[246:247], v22 offset:25600
    s_waitcnt lgkmcnt(6)
    v_mfma_f32_16x16x32_bf16 v[152:155], v[232:235], v[168:171], v[152:155]
    ds_read_b64_tr_b16 v[228:229], v23 offset:24576
    v_mfma_f32_16x16x32_bf16 v[156:159], v[232:235], v[172:175], v[156:159]
    ds_read_b64_tr_b16 v[230:231], v23 offset:25600
    s_waitcnt lgkmcnt(6)
    v_mfma_f32_16x16x32_bf16 v[128:131], v[236:239], v[168:171], v[128:131]
    ds_read_b64_tr_b16 v[232:233], v20 offset:24576
    v_mfma_f32_16x16x32_bf16 v[132:135], v[236:239], v[172:175], v[132:135]
    ds_read_b64_tr_b16 v[234:235], v20 offset:25600
    s_waitcnt lgkmcnt(6)
    v_mfma_f32_16x16x32_bf16 v[136:139], v[240:243], v[168:171], v[136:139]
    ds_read_b64_tr_b16 v[236:237], v21 offset:24576
    v_mfma_f32_16x16x32_bf16 v[140:143], v[240:243], v[172:175], v[140:143]
    ds_read_b64_tr_b16 v[238:239], v21 offset:25600
    s_xor_b32 s96, s83, 7
    s_lshl_b32 s97, s96, 11
    s_add_u32 s20, s97, s19
    buffer_load_dwordx4 v[168:171], v2, s[32:35], s20 offen sc1
    buffer_load_dwordx4 v[172:175], v2, s[32:35], s20 offen offset:1024 sc1
    s_waitcnt lgkmcnt(6)
    s_waitcnt vmcnt(3)
    v_mfma_f32_16x16x32_bf16 v[144:147], v[244:247], v[160:163], v[144:147]
    ds_read_b64_tr_b16 v[240:241], v22 offset:28672
    s_waitcnt vmcnt(2)
    v_mfma_f32_16x16x32_bf16 v[148:151], v[244:247], v[164:167], v[148:151]
    ds_read_b64_tr_b16 v[242:243], v22 offset:29696
    s_waitcnt lgkmcnt(6)
    v_mfma_f32_16x16x32_bf16 v[152:155], v[228:231], v[160:163], v[152:155]
    ds_read_b64_tr_b16 v[244:245], v23 offset:28672
    v_mfma_f32_16x16x32_bf16 v[156:159], v[228:231], v[164:167], v[156:159]
    ds_read_b64_tr_b16 v[246:247], v23 offset:29696
    s_waitcnt lgkmcnt(6)
    v_mfma_f32_16x16x32_bf16 v[128:131], v[232:235], v[160:163], v[128:131]
    ds_read_b64_tr_b16 v[228:229], v20 offset:28672
    v_mfma_f32_16x16x32_bf16 v[132:135], v[232:235], v[164:167], v[132:135]
    ds_read_b64_tr_b16 v[230:231], v20 offset:29696
    s_waitcnt lgkmcnt(6)
    v_mfma_f32_16x16x32_bf16 v[136:139], v[236:239], v[160:163], v[136:139]
    ds_read_b64_tr_b16 v[232:233], v21 offset:28672
    v_mfma_f32_16x16x32_bf16 v[140:143], v[236:239], v[164:167], v[140:143]
    ds_read_b64_tr_b16 v[234:235], v21 offset:29696
    s_cmp_eq_u32 s25, s4
    s_cbranch_scc1 L_D2
SPOLL_32:
    s_load_dwordx2 s[24:25], s[32:33], s92 offset:1024 glc
SCHK_33:
    s_add_u32 s5, s5, 1
    s_cmp_ge_u32 s5, 300000
    s_waitcnt lgkmcnt(0)
    s_cbranch_scc1 SDONE_34
    s_cmp_lg_u32 s25, s4
    s_cbranch_scc1 SPOLL_32
SDONE_34:
L_D2:
    s_barrier
    s_xor_b32 s96, s83, 8
    s_lshl_b32 s97, s96, 11
    s_add_u32 s20, s97, s19
    buffer_load_dwordx4 v[160:163], v2, s[32:35], s20 offen sc1
    buffer_load_dwordx4 v[164:167], v2, s[32:35], s20 offen offset:1024 sc1
    s_waitcnt lgkmcnt(6)
    s_waitcnt vmcnt(3)
    v_mfma_f32_16x16x32_bf16 v[144:147], v[240:243], v[168:171], v[144:147]
    ds_read_b64_tr_b16 v[236:237], v22 offset:32768
    s_waitcnt vmcnt(2)
    v_mfma_f32_16x16x32_bf16 v[148:151], v[240:243], v[172:175], v[148:151]
    ds_read_b64_tr_b16 v[238:239], v22 offset:33792
    s_waitcnt lgkmcnt(6)
    v_mfma_f32_16x16x32_bf16 v[152:155], v[244:247], v[168:171], v[152:155]
    ds_read_b64_tr_b16 v[240:241], v23 offset:32768
    v_mfma_f32_16x16x32_bf16 v[156:159], v[244:247], v[172:175], v[156:159]
    ds_read_b64_tr_b16 v[242:243], v23 offset:33792
    s_waitcnt lgkmcnt(6)
    v_mfma_f32_16x16x32_bf16 v[128:131], v[228:231], v[168:171], v[128:131]
    ds_read_b64_tr_b16 v[244:245], v20 offset:32768
    v_mfma_f32_16x16x32_bf16 v[132:135], v[228:231], v[172:175], v[132:135]
    ds_read_b64_tr_b16 v[246:247], v20 offset:33792
    s_waitcnt lgkmcnt(6)
    v_mfma_f32_16x16x32_bf16 v[136:139], v[232:235], v[168:171], v[136:139]
    ds_read_b64_tr_b16 v[228:229], v21 offset:32768
    v_mfma_f32_16x16x32_bf16 v[140:143], v[232:235], v[172:175], v[140:143]
    ds_read_b64_tr_b16 v[230:231], v21 offset:33792
    s_xor_b32 s96, s83, 9
    s_lshl_b32 s97, s96, 11
    s_add_u32 s20, s97, s19
    buffer_load_dwordx4 v[168:171], v2, s[32:35], s20 offen sc1
    buffer_load_dwordx4 v[172:175], v2, s[32:35], s20 offen offset:1024 sc1
    s_waitcnt lgkmcnt(6)
    s_waitcnt vmcnt(3)
    v_mfma_f32_16x16x32_bf16 v[144:147], v[236:239], v[160:163], v[144:147]
    ds_read_b64_tr_b16 v[232:233], v22 offset:36864
    s_waitcnt vmcnt(2)
    v_mfma_f32_16x16x32_bf16 v[148:151], v[236:239], v[164:167], v[148:151]
    ds_read_b64_tr_b16 v[234:235], v22 offset:37888
    s_waitcnt lgkmcnt(6)
    v_mfma_f32_16x16x32_bf16 v[152:155], v[240:243], v[160:163], v[152:155]
    ds_read_b64_tr_b16 v[236:237], v23 offset:36864
    v_mfma_f32_16x16x32_bf16 v[156:159], v[240:243], v[164:167], v[156:159]
    ds_read_b64_tr_b16 v[238:239], v23 offset:37888
    s_waitcnt lgkmcnt(6)
    v_mfma_f32_16x16x32_bf16 v[128:131], v[244:247], v[160:163], v[128:131]
    ds_read_b64_tr_b16 v[240:241], v20 offset:36864
    v_mfma_f32_16x16x32_bf16 v[132:135], v[244:247], v[164:167], v[132:135]
    ds_read_b64_tr_b16 v[242:243], v20 offset:37888
    s_waitcnt lgkmcnt(6)
    v_mfma_f32_16x16x32_bf16 v[136:139], v[228:231], v[160:163], v[136:139]
    ds_read_b64_tr_b16 v[244:245], v21 offset:36864
    v_mfma_f32_16x16x32_bf16 v[140:143], v[228:231], v[164:167], v[140:143]
    ds_read_b64_tr_b16 v[246:247], v21 offset:37888
    s_xor_b32 s96, s83, 10
    s_lshl_b32 s97, s96, 11
    s_add_u32 s20, s97, s19
    buffer_load_dwordx4 v[160:163], v2, s[32:35], s20 offen sc1
    buffer_load_dwordx4 v[164:167], v2, s[32:35], s20 offen offset:1024 sc1
    s_waitcnt lgkmcnt(6)
    s_waitcnt vmcnt(3)
    v_mfma_f32_16x16x32_bf16 v[144:147], v[232:235], v[168:171], v[144:147]
    ds_read_b64_tr_b16 v[228:229], v22 offset:40960
    s_waitcnt vmcnt(2)
    v_mfma_f32_16x16x32_bf16 v[148:151], v[232:235], v[172:175], v[148:151]
    ds_read_b64_tr_b16 v[230:231], v22 offset:41984
    s_waitcnt lgkmcnt(6)
    v_mfma_f32_16x16x32_bf16 v[152:155], v[236:239], v[168:171], v[152:155]
    ds_read_b64_tr_b16 v[232:233], v23 offset:40960
    v_mfma_f32_16x16x32_bf16 v[156:159], v[236:239], v[172:175], v[156:159]
    ds_read_b64_tr_b16 v[234:235], v23 offset:41984
    s_waitcnt lgkmcnt(6)
    v_mfma_f32_16x16x32_bf16 v[128:131], v[240:243], v[168:171], v[128:131]
    ds_read_b64_tr_b16 v[236:237], v20 offset:40960
    v_mfma_f32_16x16x32_bf16 v[132:135], v[240:243], v[172:175], v[132:135]
    ds_read_b64_tr_b16 v[238:239], v20 offset:41984
    s_waitcnt lgkmcnt(6)
    v_mfma_f32_16x16x32_bf16 v[136:139], v[244:247], v[168:171], v[136:139]
    ds_read_b64_tr_b16 v[240:241], v21 offset:40960
    v_mfma_f32_16x16x32_bf16 v[140:143], v[244:247], v[172:175], v[140:143]
    ds_read_b64_tr_b16 v[242:243], v21 offset:41984
    s_xor_b32 s96, s83, 11
    s_lshl_b32 s97, s96, 11
    s_add_u32 s20, s97, s19
    buffer_load_dwordx4 v[168:171], v2, s[32:35], s20 offen sc1
    buffer_load_dwordx4 v[172:175], v2, s[32:35], s20 offen offset:1024 sc1
    s_waitcnt lgkmcnt(6)
    s_waitcnt vmcnt(3)
    v_mfma_f32_16x16x32_bf16 v[144:147], v[228:231], v[160:163], v[144:147]
    ds_read_b64_tr_b16 v[244:245], v22 offset:45056
    s_waitcnt vmcnt(2)
    v_mfma_f32_16x16x32_bf16 v[148:151], v[228:231], v[164:167], v[148:151]
    ds_read_b64_tr_b16 v[246:247], v22 offset:46080
    s_waitcnt lgkmcnt(6)
    v_mfma_f32_16x16x32_bf16 v[152:155], v[232:235], v[160:163], v[152:155]
    ds_read_b64_tr_b16 v[228:229], v23 offset:45056
    v_mfma_f32_16x16x32_bf16 v[156:159], v[232:235], v[164:167], v[156:159]
    ds_read_b64_tr_b16 v[230:231], v23 offset:46080
    s_waitcnt lgkmcnt(6)
    v_mfma_f32_16x16x32_bf16 v[128:131], v[236:239], v[160:163], v[128:131]
    ds_read_b64_tr_b16 v[232:233], v20 offset:45056
    v_mfma_f32_16x16x32_bf16 v[132:135], v[236:239], v[164:167], v[132:135]
    ds_read_b64_tr_b16 v[234:235], v20 offset:46080
    s_waitcnt lgkmcnt(6)
    v_mfma_f32_16x16x32_bf16 v[136:139], v[240:243], v[160:163], v[136:139]
    ds_read_b64_tr_b16 v[236:237], v21 offset:45056
    v_mfma_f32_16x16x32_bf16 v[140:143], v[240:243], v[164:167], v[140:143]
    ds_read_b64_tr_b16 v[238:239], v21 offset:46080
    s_xor_b32 s96, s83, 12
    s_lshl_b32 s97, s96, 11
    s_add_u32 s20, s97, s19
    buffer_load_dwordx4 v[160:163], v2, s[32:35], s20 offen sc1
    buffer_load_dwordx4 v[164:167], v2, s[32:35], s20 offen offset:1024 sc1
    s_waitcnt lgkmcnt(6)
    s_waitcnt vmcnt(3)
    v_mfma_f32_16x16x32_bf16 v[144:147], v[244:247], v[168:171], v[144:147]
    ds_read_b64_tr_b16 v[240:241], v22 offset:49152
    s_waitcnt vmcnt(2)
    v_mfma_f32_16x16x32_bf16 v[148:151], v[244:247], v[172:175], v[148:151]
    ds_read_b64_tr_b16 v[242:243], v22 offset:50176
    s_waitcnt lgkmcnt(6)
    v_mfma_f32_16x16x32_bf16 v[152:155], v[228:231], v[168:171], v[152:155]
    ds_read_b64_tr_b16 v[244:245], v23 offset:49152
    v_mfma_f32_16x16x32_bf16 v[156:159], v[228:231], v[172:175], v[156:159]
    ds_read_b64_tr_b16 v[246:247], v23 offset:50176
    s_waitcnt lgkmcnt(6)
    v_mfma_f32_16x16x32_bf16 v[128:131], v[232:235], v[168:171], v[128:131]
    ds_read_b64_tr_b16 v[228:229], v20 offset:49152
    v_mfma_f32_16x16x32_bf16 v[132:135], v[232:235], v[172:175], v[132:135]
    ds_read_b64_tr_b16 v[230:231], v20 offset:50176
    s_waitcnt lgkmcnt(6)
    v_mfma_f32_16x16x32_bf16 v[136:139], v[236:239], v[168:171], v[136:139]
    ds_read_b64_tr_b16 v[232:233], v21 offset:49152
    v_mfma_f32_16x16x32_bf16 v[140:143], v[236:239], v[172:175], v[140:143]
    ds_read_b64_tr_b16 v[234:235], v21 offset:50176
    s_xor_b32 s96, s83, 13
    s_lshl_b32 s97, s96, 11
    s_add_u32 s20, s97, s19
    buffer_load_dwordx4 v[168:171], v2, s[32:35], s20 offen sc1
    buffer_load_dwordx4 v[172:175], v2, s[32:35], s20 offen offset:1024 sc1
    s_waitcnt lgkmcnt(6)
    s_waitcnt vmcnt(3)
    v_mfma_f32_16x16x32_bf16 v[144:147], v[240:243], v[160:163], v[144:147]
    ds_read_b64_tr_b16 v[236:237], v22 offset:53248
    s_waitcnt vmcnt(2)
    v_mfma_f32_16x16x32_bf16 v[148:151], v[240:243], v[164:167], v[148:151]
    ds_read_b64_tr_b16 v[238:239], v22 offset:54272
    s_waitcnt lgkmcnt(6)
    v_mfma_f32_16x16x32_bf16 v[152:155], v[244:247], v[160:163], v[152:155]
    ds_read_b64_tr_b16 v[240:241], v23 offset:53248
    v_mfma_f32_16x16x32_bf16 v[156:159], v[244:247], v[164:167], v[156:159]
    ds_read_b64_tr_b16 v[242:243], v23 offset:54272
    s_waitcnt lgkmcnt(6)
    v_mfma_f32_16x16x32_bf16 v[128:131], v[228:231], v[160:163], v[128:131]
    ds_read_b64_tr_b16 v[244:245], v20 offset:53248
    v_mfma_f32_16x16x32_bf16 v[132:135], v[228:231], v[164:167], v[132:135]
    ds_read_b64_tr_b16 v[246:247], v20 offset:54272
    s_waitcnt lgkmcnt(6)
    v_mfma_f32_16x16x32_bf16 v[136:139], v[232:235], v[160:163], v[136:139]
    ds_read_b64_tr_b16 v[228:229], v21 offset:53248
    v_mfma_f32_16x16x32_bf16 v[140:143], v[232:235], v[164:167], v[140:143]
    ds_read_b64_tr_b16 v[230:231], v21 offset:54272
    s_xor_b32 s96, s83, 14
    s_lshl_b32 s97, s96, 11
    s_add_u32 s20, s97, s19
    buffer_load_dwordx4 v[160:163], v2, s[32:35], s20 offen sc1
    buffer_load_dwordx4 v[164:167], v2, s[32:35], s20 offen offset:1024 sc1
    s_waitcnt lgkmcnt(6)
    s_waitcnt vmcnt(3)
    v_mfma_f32_16x16x32_bf16 v[144:147], v[236:239], v[168:171], v[144:147]
    ds_read_b64_tr_b16 v[232:233], v22 offset:57344
    s_waitcnt vmcnt(2)
    v_mfma_f32_16x16x32_bf16 v[148:151], v[236:239], v[172:175], v[148:151]
    ds_read_b64_tr_b16 v[234:235], v22 offset:58368
    s_waitcnt lgkmcnt(6)
    v_mfma_f32_16x16x32_bf16 v[152:155], v[240:243], v[168:171], v[152:155]
    ds_read_b64_tr_b16 v[236:237], v23 offset:57344
    v_mfma_f32_16x16x32_bf16 v[156:159], v[240:243], v[172:175], v[156:159]
    ds_read_b64_tr_b16 v[238:239], v23 offset:58368
    s_waitcnt lgkmcnt(6)
    v_mfma_f32_16x16x32_bf16 v[128:131], v[244:247], v[168:171], v[128:131]
    ds_read_b64_tr_b16 v[240:241], v20 offset:57344
    v_mfma_f32_16x16x32_bf16 v[132:135], v[244:247], v[172:175], v[132:135]
    ds_read_b64_tr_b16 v[242:243], v20 offset:58368
    s_waitcnt lgkmcnt(6)
    v_mfma_f32_16x16x32_bf16 v[136:139], v[228:231], v[168:171], v[136:139]
    ds_read_b64_tr_b16 v[244:245], v21 offset:57344
    v_mfma_f32_16x16x32_bf16 v[140:143], v[228:231], v[172:175], v[140:143]
    ds_read_b64_tr_b16 v[246:247], v21 offset:58368
    s_xor_b32 s96, s83, 15
    s_lshl_b32 s97, s96, 11
    s_add_u32 s20, s97, s19
    buffer_load_dwordx4 v[168:171], v2, s[32:35], s20 offen sc1
    buffer_load_dwordx4 v[172:175], v2, s[32:35], s20 offen offset:1024 sc1
    buffer_load_dwordx2 v[26:27], v25, s[32:35], s18 offen sc1
    s_mov_b32 exec_lo, 0xff
    s_mov_b32 exec_hi, 0xff
    buffer_store_dwordx2 v[224:225], v226, s[32:35], 0 offen sc1
    s_mov_b64 exec, -1
    s_waitcnt lgkmcnt(6)
    s_waitcnt vmcnt(5)
    v_mfma_f32_16x16x32_bf16 v[144:147], v[232:235], v[160:163], v[144:147]
    ds_read_b64_tr_b16 v[228:229], v22 offset:61440
    s_waitcnt vmcnt(4)
    v_mfma_f32_16x16x32_bf16 v[148:151], v[232:235], v[164:167], v[148:151]
    ds_read_b64_tr_b16 v[230:231], v22 offset:62464
    s_waitcnt lgkmcnt(6)
    v_mfma_f32_16x16x32_bf16 v[152:155], v[236:239], v[160:163], v[152:155]
    ds_read_b64_tr_b16 v[232:233], v23 offset:61440
    v_mfma_f32_16x16x32_bf16 v[156:159], v[236:239], v[164:167], v[156:159]
    ds_read_b64_tr_b16 v[234:235], v23 offset:62464
    s_waitcnt lgkmcnt(6)
    v_mfma_f32_16x16x32_bf16 v[128:131], v[240:243], v[160:163], v[128:131]
    ds_read_b64_tr_b16 v[236:237], v20 offset:61440
    v_mfma_f32_16x16x32_bf16 v[132:135], v[240:243], v[164:167], v[132:135]
    ds_read_b64_tr_b16 v[238:239], v20 offset:62464
    s_waitcnt lgkmcnt(6)
    v_mfma_f32_16x16x32_bf16 v[136:139], v[244:247], v[160:163], v[136:139]
    ds_read_b64_tr_b16 v[240:241], v21 offset:61440
    v_mfma_f32_16x16x32_bf16 v[140:143], v[244:247], v[164:167], v[140:143]
    ds_read_b64_tr_b16 v[242:243], v21 offset:62464
    s_waitcnt lgkmcnt(6)
    s_waitcnt vmcnt(3)
    v_mfma_f32_16x16x32_bf16 v[144:147], v[228:231], v[168:171], v[144:147]
    s_waitcnt vmcnt(2)
    v_mfma_f32_16x16x32_bf16 v[148:151], v[228:231], v[172:175], v[148:151]
    s_waitcnt lgkmcnt(4)
    v_mfma_f32_16x16x32_bf16 v[152:155], v[232:235], v[168:171], v[152:155]
    v_mfma_f32_16x16x32_bf16 v[156:159], v[232:235], v[172:175], v[156:159]
    s_waitcnt lgkmcnt(2)
    v_mfma_f32_16x16x32_bf16 v[128:131], v[236:239], v[168:171], v[128:131]
    v_mfma_f32_16x16x32_bf16 v[132:135], v[236:239], v[172:175], v[132:135]
    s_waitcnt lgkmcnt(0)
    v_mfma_f32_16x16x32_bf16 v[136:139], v[240:243], v[168:171], v[136:139]
    v_mfma_f32_16x16x32_bf16 v[140:143], v[240:243], v[172:175], v[140:143]
    s_setprio 0
    s_lshl_b32 s13, s3, 12
    v_add_u32 v4, s13, v2
    v_xor_b32 v5, 0x4000, v4
    ds_write_b128 v4, v[144:147]
    ds_write_b128 v4, v[148:151] offset:1024
    ds_write_b128 v4, v[152:155] offset:2048
    ds_write_b128 v4, v[156:159] offset:3072
    s_lshl_b32 s96, s76, 11
    s_and_b32 s97, s3, 3
    s_lshl_b32 s98, s97, 9
    s_add_u32 s99, s96, s98
    s_add_u32 s13, s99, 131072
    v_and_b32 v6, 31, v1
    v_lshl_add_u32 v6, v6, 4, s13
    v_lshrrev_b32 v9, 5, v1
    v_lshl_add_u32 v6, v9, 3, v6
    s_lshl_b32 s96, s76, 6
    s_add_u32 s13, s96, 139008
    v_and_b32 v7, 7, v1
    v_lshl_add_u32 v7, v7, 2, s13
    v_lshrrev_b32 v9, 5, v1
    v_lshl_add_u32 v7, v9, 5, v7
    s_lshl_b32 s96, s21, 15
    s_lshl_b32 s97, s3, 8
    s_add_u32 s98, s96, s97
    s_add_u32 s19, s98, 12582912
    v_and_b32 v24, 15, v1
    v_lshlrev_b32 v24, 4, v24
    v_lshrrev_b32 v9, 4, v1
    v_lshl_add_u32 v24, v9, 11, v24
    v_mov_b32 v232, 0x3f803f80
    s_waitcnt lgkmcnt(0)
    s_barrier
    ds_read_b128 v[144:147], v5
    ds_read_b128 v[148:151], v5 offset:1024
    ds_read_b128 v[152:155], v5 offset:2048
    ds_read_b128 v[156:159], v5 offset:3072
    s_add_u32 s14, s80, 114688
    s_lshl2_add_u32 m0, s89, 67584
    s_nop 0
    buffer_load_dwordx4 v72, s[56:59], s14 offen nt lds
    s_add_u32 s14, s80, 172032
    s_lshl2_add_u32 m0, s89, 68608
    s_nop 0
    buffer_load_dwordx4 v72, s[56:59], s14 offen nt lds
    s_mov_b32 s14, s81
    s_lshl2_add_u32 m0, s89, 98304
    s_nop 0
    buffer_load_dwordx4 v73, s[60:63], s14 offen nt lds
    s_waitcnt lgkmcnt(3)
    v_pk_add_f32 v[128:129], v[128:129], v[144:145]
    v_pk_add_f32 v[130:131], v[130:131], v[146:147]
    s_waitcnt lgkmcnt(2)
    v_pk_add_f32 v[132:133], v[132:133], v[148:149]
    v_pk_add_f32 v[134:135], v[134:135], v[150:151]
    s_nop 0
    v_permlane16_swap_b32 v128, v132
    v_permlane16_swap_b32 v129, v133
    v_permlane16_swap_b32 v130, v134
    v_permlane16_swap_b32 v131, v135
    v_cvt_pk_bf16_f32 v128, 0, v128
    v_cvt_pk_bf16_f32 v129, 0, v129
    v_cvt_pk_bf16_f32 v130, 0, v130
    v_cvt_pk_bf16_f32 v131, 0, v131
    v_cvt_pk_bf16_f32 v132, 0, v132
    v_cvt_pk_bf16_f32 v133, 0, v133
    v_cvt_pk_bf16_f32 v134, 0, v134
    v_cvt_pk_bf16_f32 v135, 0, v135
    v_pk_mul_f32 v[128:129], v[128:129], v[76:77]
    v_pk_mul_f32 v[130:131], v[130:131], v[78:79]
    v_pk_mul_f32 v[132:133], v[132:133], v[80:81]
    v_pk_mul_f32 v[134:135], v[134:135], v[82:83]
    v_cvt_pk_bf16_f32 v128, 0, v128
    v_cvt_pk_bf16_f32 v129, 0, v129
    v_cvt_pk_bf16_f32 v130, 0, v130
    v_cvt_pk_bf16_f32 v131, 0, v131
    v_cvt_pk_bf16_f32 v132, 0, v132
    v_cvt_pk_bf16_f32 v133, 0, v133
    v_cvt_pk_bf16_f32 v134, 0, v134
    v_cvt_pk_bf16_f32 v135, 0, v135
    v_pk_add_f32 v[128:129], v[128:129], v[28:29]
    v_pk_add_f32 v[130:131], v[130:131], v[30:31]
    v_pk_add_f32 v[132:133], v[132:133], v[32:33]
    v_pk_add_f32 v[134:135], v[134:135], v[34:35]
    v_cvt_pk_bf16_f32 v12, v128, v129
    v_cvt_pk_bf16_f32 v13, v130, v131
    v_cvt_pk_bf16_f32 v14, v132, v133
    v_cvt_pk_bf16_f32 v15, v134, v135
    s_waitcnt lgkmcnt(1)
    v_pk_add_f32 v[136:137], v[136:137], v[152:153]
    v_pk_add_f32 v[138:139], v[138:139], v[154:155]
    s_waitcnt lgkmcnt(0)
    v_pk_add_f32 v[140:141], v[140:141], v[156:157]
    v_pk_add_f32 v[142:143], v[142:143], v[158:159]
    s_nop 0
    v_permlane16_swap_b32 v136, v140
    v_permlane16_swap_b32 v137, v141
    v_permlane16_swap_b32 v138, v142
    v_permlane16_swap_b32 v139, v143
    v_cvt_pk_bf16_f32 v136, 0, v136
    v_cvt_pk_bf16_f32 v137, 0, v137
    v_cvt_pk_bf16_f32 v138, 0, v138
    v_cvt_pk_bf16_f32 v139, 0, v139
    v_cvt_pk_bf16_f32 v140, 0, v140
    v_cvt_pk_bf16_f32 v141, 0, v141
    v_cvt_pk_bf16_f32 v142, 0, v142
    v_cvt_pk_bf16_f32 v143, 0, v143
    v_pk_mul_f32 v[136:137], v[136:137], v[84:85]
    v_pk_mul_f32 v[138:139], v[138:139], v[86:87]
    v_pk_mul_f32 v[140:141], v[140:141], v[88:89]
    v_pk_mul_f32 v[142:143], v[142:143], v[90:91]
    v_cvt_pk_bf16_f32 v136, 0, v136
    v_cvt_pk_bf16_f32 v137, 0, v137
    v_cvt_pk_bf16_f32 v138, 0, v138
    v_cvt_pk_bf16_f32 v139, 0, v139
    v_cvt_pk_bf16_f32 v140, 0, v140
    v_cvt_pk_bf16_f32 v141, 0, v141
    v_cvt_pk_bf16_f32 v142, 0, v142
    v_cvt_pk_bf16_f32 v143, 0, v143
    v_pk_add_f32 v[136:137], v[136:137], v[36:37]
    v_pk_add_f32 v[138:139], v[138:139], v[38:39]
    v_pk_add_f32 v[140:141], v[140:141], v[40:41]
    v_pk_add_f32 v[142:143], v[142:143], v[42:43]
    v_cvt_pk_bf16_f32 v16, v136, v137
    v_cvt_pk_bf16_f32 v17, v138, v139
    v_cvt_pk_bf16_f32 v18, v140, v141
    v_cvt_pk_bf16_f32 v19, v142, v143
    v_dot2_f32_bf16 v228, v12, v232, 0
    v_dot2_f32_bf16 v230, v12, v12, 0
    v_dot2_f32_bf16 v229, v12, v112, 0
    v_dot2_f32_bf16 v231, v12, v120, 0
    v_dot2_f32_bf16 v228, v13, v232, v228
    v_dot2_f32_bf16 v230, v13, v13, v230
    v_dot2_f32_bf16 v229, v13, v113, v229
    v_dot2_f32_bf16 v231, v13, v121, v231
    v_dot2_f32_bf16 v228, v14, v232, v228
    v_dot2_f32_bf16 v230, v14, v14, v230
    v_dot2_f32_bf16 v229, v14, v114, v229
    v_dot2_f32_bf16 v231, v14, v122, v231
    v_dot2_f32_bf16 v228, v15, v232, v228
    v_dot2_f32_bf16 v230, v15, v15, v230
    v_dot2_f32_bf16 v229, v15, v115, v229
    v_dot2_f32_bf16 v231, v15, v123, v231
    v_dot2_f32_bf16 v228, v16, v232, v228
    v_dot2_f32_bf16 v230, v16, v16, v230
    v_dot2_f32_bf16 v229, v16, v116, v229
    v_dot2_f32_bf16 v231, v16, v124, v231
    v_dot2_f32_bf16 v228, v17, v232, v228
    v_dot2_f32_bf16 v230, v17, v17, v230
    v_dot2_f32_bf16 v229, v17, v117, v229
    v_dot2_f32_bf16 v231, v17, v125, v231
    v_dot2_f32_bf16 v228, v18, v232, v228
    v_dot2_f32_bf16 v230, v18, v18, v230
    v_dot2_f32_bf16 v229, v18, v118, v229
    v_dot2_f32_bf16 v231, v18, v126, v231
    v_dot2_f32_bf16 v228, v19, v232, v228
    v_dot2_f32_bf16 v230, v19, v19, v230
    v_dot2_f32_bf16 v229, v19, v119, v229
    v_dot2_f32_bf16 v231, v19, v127, v231
    s_nop 0
    v_permlane32_swap_b32 v228, v230
    s_nop 0
    v_permlane32_swap_b32 v229, v231
    v_pk_add_f32 v[228:229], v[228:229], v[230:231]
    ds_write_b64 v6, v[228:229]
    ds_write_b32 v7, v68
    ds_write_b32 v7, v69 offset:128
    ds_write_b32 v7, v70 offset:256
    ds_write_b32 v7, v71 offset:384
    v_add_u32 v4, 131072, v2
    v_and_b32 v5, 7, v1
    v_lshlrev_b32 v5, 15, v5
    v_bfe_u32 v9, v1, 3, 1
    v_lshl_add_u32 v5, v9, 12, v5
    s_lshl4_add_u32 s96, s21, s12
    s_lshl_b32 s97, s96, 11
    s_add_u32 s13, s97, 12582912
    s_and_b32 s96, s12, 1
    s_lshr_b32 s97, s21, 2
    s_and_b32 s98, s21, 3
    s_lshl_b32 s99, s98, 6
    s_lshl1_add_u32 s98, s97, s99
    s_lshl_b32 s97, s98, 12
    s_lshr_b32 s99, s12, 1
    s_lshl_b32 s98, s99, 6
    s_add_u32 s99, s97, s98
    s_lshl2_add_u32 s97, s96, s99
    s_add_u32 s98, s97, 1048576
    s_add_u32 s16, s98, 1536
    s_waitcnt lgkmcnt(0)
    s_barrier
    s_cmp_lg_u32 s3, 0
    s_cbranch_scc1 L_PE
    ds_read_b128 v[144:147], v4 offset:0
    ds_read_b128 v[148:151], v4 offset:2048
    ds_read_b128 v[152:155], v4 offset:1024
    ds_read_b128 v[156:159], v4 offset:3072
    s_waitcnt lgkmcnt(2)
    v_pk_add_f32 v[144:145], v[144:145], v[148:149]
    v_pk_add_f32 v[146:147], v[146:147], v[150:151]
    v_add_f32 v145, v145, v147
    v_mov_b32 v147, s4
    s_waitcnt lgkmcnt(0)
    v_pk_add_f32 v[152:153], v[152:153], v[156:157]
    v_pk_add_f32 v[154:155], v[154:155], v[158:159]
    v_add_f32 v153, v153, v155
    v_mov_b32 v155, s4
    buffer_store_dwordx4 v[144:147], v2, s[32:35], s13 offen sc1
    buffer_store_dwordx4 v[152:155], v2, s[32:35], s13 offen offset:1024 sc1
    s_mov_b64 exec, 0xffff
    buffer_store_dword v147, v5, s[32:35], s16 offen sc1
    s_mov_b64 exec, -1
L_PE:
    s_load_dwordx2 s[24:25], s[32:33], s92 offset:1536 glc
    s_and_b32 s96, s3, 3
    s_mul_i32 s97, s96, 4608
    s_lshl_b32 s98, s76, 6
    s_add_u32 s16, s97, s98
    v_and_b32 v23, 31, v1
    v_mul_u32_u24 v23, 144, v23
    v_lshrrev_b32 v9, 5, v1
    v_lshl_add_u32 v23, v9, 5, v23
    v_add_u32 v23, s16, v23
    ds_write_b128 v23, v[12:15]
    ds_write_b128 v23, v[16:19] offset:16
    v_add_u32 v23, 139776, v23
    s_lshl3_add_u32 s96, s21, s3
    s_lshl_b32 s97, s96, 5
    s_sub_u32 s15, 4094, s97
    v_and_b32 v22, 15, v1
    v_lshlrev_b32 v22, 1, v22
    v_sub_u32 v22, s15, v22
    s_lshl_b32 s96, s3, 7
    s_add_u32 s15, s96, 135168
    v_and_b32 v8, 15, v1
    v_lshl_add_u32 v8, v8, 3, s15
    s_and_b32 s96, s3, 3
    s_lshl_b32 s97, s96, 8
    s_add_u32 s15, s97, 135168
    v_and_b32 v10, 31, v1
    v_lshl_add_u32 v10, v10, 3, s15
    v_and_b32 v11, 7, v1
    v_lshlrev_b32 v11, 3, v11
    v_add_u32 v11, 136192, v11
    s_waitcnt vmcnt(4)
    v_cmp_ne_u32 vcc, s4, v27
    s_cbranch_vccz TOK_38
POLL_39:
    buffer_load_dwordx2 v[26:27], v25, s[32:35], s18 offen sc1
    s_waitcnt vmcnt(0)
    v_cmp_ne_u32 vcc, s4, v27
    s_cbranch_vccz PDONE_40
    s_add_u32 s5, s5, 1
    s_cmp_lt_u32 s5, 300000
    s_cbranch_scc1 POLL_39
PDONE_40:
TOK_38:
    v_add_f32_dpp v26, v26, v26 quad_perm:[1,0,3,2] row_mask:0xf bank_mask:0xf
    s_nop 1
    v_add_f32_dpp v26, v26, v26 quad_perm:[2,3,0,1] row_mask:0xf bank_mask:0xf
    s_nop 1
    v_add_f32_dpp v26, v26, v26 row_half_mirror row_mask:0xf bank_mask:0xf
    s_nop 1
    v_add_f32_dpp v26, v26, v26 row_ror:8 row_mask:0xf bank_mask:0xf
    s_cmp_lg_u32 s3, 1
    s_cbranch_scc1 L_NOCT
    v_and_b32 v5, 15, v1
    v_lshlrev_b32 v5, 3, v5
    v_add_u32 v5, 139008, v5
    ds_read_b64 v[142:143], v5
    ds_read_b64 v[146:147], v5 offset:128
    ds_read_b64 v[148:149], v5 offset:384
    s_waitcnt lgkmcnt(0)
    v_lshlrev_b32 v140, 16, v142
    v_and_b32 v141, s6, v142
    v_lshlrev_b32 v142, 16, v143
    v_and_b32 v143, s6, v143
    v_lshlrev_b32 v144, 16, v146
    v_and_b32 v145, s6, v146
    v_lshlrev_b32 v146, 16, v147
    v_and_b32 v147, s6, v147
L_NOCT:
    s_cmp_lt_u32 s3, 4
    s_cbranch_scc1 L_NOST
    s_sub_u32 s96, s3, 4
    s_lshl_b32 s97, s96, 12
    s_add_u32 s13, s97, 32768
    v_add_u32 v4, s13, v2
    v_add_u32 v7, 65536, v4
    ds_write_b128 v4, v[176:179] offset:16384
    ds_write_b128 v4, v[180:183]
    ds_write_b128 v4, v[184:187] offset:17408
    ds_write_b128 v4, v[188:191] offset:1024
    ds_write_b128 v4, v[192:195] offset:18432
    ds_write_b128 v4, v[196:199] offset:2048
    ds_write_b128 v4, v[200:203] offset:19456
    ds_write_b128 v4, v[204:207] offset:3072
    ds_write_b128 v4, v[208:211] offset:49152
    ds_write_b128 v4, v[212:215] offset:32768
    ds_write_b128 v4, v[216:219] offset:50176
    ds_write_b128 v4, v[220:223] offset:33792
L_NOST:
    s_branch SCHK_36
SPOLL_35:
    s_load_dwordx2 s[24:25], s[32:33], s92 offset:1536 glc
SCHK_36:
    s_add_u32 s5, s5, 1
    s_cmp_ge_u32 s5, 300000
    s_waitcnt lgkmcnt(0)
    s_cbranch_scc1 SDONE_37
    s_cmp_lg_u32 s24, s4
    s_cbranch_scc1 SPOLL_35
    s_cmp_lg_u32 s25, s4
    s_cbranch_scc1 SPOLL_35
SDONE_37:
    s_barrier
    s_mov_b32 s13, s19
    buffer_load_dwordx4 v[124:127], v24, s[32:35], s13 offen sc1
    s_add_u32 s13, s19, 8192
    buffer_load_dwordx4 v[128:131], v24, s[32:35], s13 offen sc1
    s_add_u32 s13, s19, 16384
    buffer_load_dwordx4 v[132:135], v24, s[32:35], s13 offen sc1
    s_add_u32 s13, s19, 24576
    buffer_load_dwordx4 v[136:139], v24, s[32:35], s13 offen sc1
    v_lshlrev_b32 v28, 16, v12
    v_and_b32 v29, s6, v12
    v_lshlrev_b32 v30, 16, v13
    v_and_b32 v31, s6, v13
    v_lshlrev_b32 v32, 16, v14
    v_and_b32 v33, s6, v14
    v_lshlrev_b32 v34, 16, v15
    v_and_b32 v35, s6, v15
    v_lshlrev_b32 v36, 16, v16
    v_and_b32 v37, s6, v16
    v_lshlrev_b32 v38, 16, v17
    v_and_b32 v39, s6, v17
    v_lshlrev_b32 v40, 16, v18
    v_and_b32 v41, s6, v18
    v_lshlrev_b32 v42, 16, v19
    v_and_b32 v43, s6, v19
    v_mul_u32_u24_dpp v92, v68, v52 row_newbcast:0 row_mask:0xf bank_mask:0xf
    v_and_b32_dpp v93, v68, v53 row_newbcast:0 row_mask:0xf bank_mask:0xf
    v_mul_u32_u24_dpp v94, v68, v52 row_newbcast:1 row_mask:0xf bank_mask:0xf
    v_and_b32_dpp v95, v68, v53 row_newbcast:1 row_mask:0xf bank_mask:0xf
    v_mul_u32_u24_dpp v96, v68, v52 row_newbcast:2 row_mask:0xf bank_mask:0xf
    v_and_b32_dpp v97, v68, v53 row_newbcast:2 row_mask:0xf bank_mask:0xf
    v_mul_u32_u24_dpp v98, v68, v52 row_newbcast:3 row_mask:0xf bank_mask:0xf
    v_and_b32_dpp v99, v68, v53 row_newbcast:3 row_mask:0xf bank_mask:0xf
    v_mul_u32_u24_dpp v100, v68, v52 row_newbcast:4 row_mask:0xf bank_mask:0xf
    v_and_b32_dpp v101, v68, v53 row_newbcast:4 row_mask:0xf bank_mask:0xf
    v_mul_u32_u24_dpp v102, v68, v52 row_newbcast:5 row_mask:0xf bank_mask:0xf
    v_and_b32_dpp v103, v68, v53 row_newbcast:5 row_mask:0xf bank_mask:0xf
    v_mul_u32_u24_dpp v104, v68, v52 row_newbcast:6 row_mask:0xf bank_mask:0xf
    v_and_b32_dpp v105, v68, v53 row_newbcast:6 row_mask:0xf bank_mask:0xf
    v_mul_u32_u24_dpp v106, v68, v52 row_newbcast:7 row_mask:0xf bank_mask:0xf
    v_and_b32_dpp v107, v68, v53 row_newbcast:7 row_mask:0xf bank_mask:0xf
    v_mul_u32_u24_dpp v108, v69, v52 row_newbcast:0 row_mask:0xf bank_mask:0xf
    v_and_b32_dpp v109, v69, v53 row_newbcast:0 row_mask:0xf bank_mask:0xf
    v_mul_u32_u24_dpp v110, v69, v52 row_newbcast:1 row_mask:0xf bank_mask:0xf
    v_and_b32_dpp v111, v69, v53 row_newbcast:1 row_mask:0xf bank_mask:0xf
    v_mul_u32_u24_dpp v112, v69, v52 row_newbcast:2 row_mask:0xf bank_mask:0xf
    v_and_b32_dpp v113, v69, v53 row_newbcast:2 row_mask:0xf bank_mask:0xf
    v_mul_u32_u24_dpp v114, v69, v52 row_newbcast:3 row_mask:0xf bank_mask:0xf
    v_and_b32_dpp v115, v69, v53 row_newbcast:3 row_mask:0xf bank_mask:0xf
    v_mul_u32_u24_dpp v116, v69, v52 row_newbcast:4 row_mask:0xf bank_mask:0xf
    v_and_b32_dpp v117, v69, v53 row_newbcast:4 row_mask:0xf bank_mask:0xf
    v_mul_u32_u24_dpp v118, v69, v52 row_newbcast:5 row_mask:0xf bank_mask:0xf
    v_and_b32_dpp v119, v69, v53 row_newbcast:5 row_mask:0xf bank_mask:0xf
    v_mul_u32_u24_dpp v120, v69, v52 row_newbcast:6 row_mask:0xf bank_mask:0xf
    v_and_b32_dpp v121, v69, v53 row_newbcast:6 row_mask:0xf bank_mask:0xf
    v_mul_u32_u24_dpp v122, v69, v52 row_newbcast:7 row_mask:0xf bank_mask:0xf
    v_and_b32_dpp v123, v69, v53 row_newbcast:7 row_mask:0xf bank_mask:0xf
    s_waitcnt vmcnt(0)
    v_bitop3_b32 v4, v127, v131, s4 bitop3:0x7e
    v_bitop3_b32 v4, v4, v135, s4 bitop3:0xf6
    v_bitop3_b32 v4, v4, v139, s4 bitop3:0xf6
    v_cmp_ne_u32 vcc, 0, v4
    s_cbranch_vccz TOK_42
POLL_43:
    s_mov_b32 s13, s19
    buffer_load_dwordx4 v[124:127], v24, s[32:35], s13 offen sc1
    s_add_u32 s13, s19, 8192
    buffer_load_dwordx4 v[128:131], v24, s[32:35], s13 offen sc1
    s_add_u32 s13, s19, 16384
    buffer_load_dwordx4 v[132:135], v24, s[32:35], s13 offen sc1
    s_add_u32 s13, s19, 24576
    buffer_load_dwordx4 v[136:139], v24, s[32:35], s13 offen sc1
    s_waitcnt vmcnt(0)
    v_bitop3_b32 v4, v127, v131, s4 bitop3:0x7e
    v_bitop3_b32 v4, v4, v135, s4 bitop3:0xf6
    v_bitop3_b32 v4, v4, v139, s4 bitop3:0xf6
    v_cmp_ne_u32 vcc, 0, v4
    s_cbranch_vccz PDONE_44
    s_add_u32 s5, s5, 1
    s_cmp_lt_u32 s5, 300000
    s_cbranch_scc1 POLL_43
PDONE_44:
TOK_42:
    s_lshl2_add_u32 s96, s74, s75
    s_lshl_b32 s97, s96, 11
    s_lshl_b32 s98, s3, 8
    s_add_u32 s99, s97, s98
    s_add_u32 s15, s99, 20971520
    v_lshlrev_b32 v24, 7, v1
    s_mov_b64 exec, 3
    buffer_load_dword v24, v24, s[32:35], s15 offen
    s_mov_b64 exec, -1
    s_add_u32 s15, s81, 4096
    s_lshl2_add_u32 m0, s89, 99328
    s_nop 0
    buffer_load_dwordx4 v73, s[60:63], s15 offen nt lds
    v_pk_add_f32 v[124:125], v[124:125], v[128:129]
    v_pk_add_f32 v[132:133], v[132:133], v[136:137]
    v_add_f32 v126, v126, v130
    v_add_f32 v134, v134, v138
    v_pk_add_f32 v[124:125], v[124:125], v[132:133]
    v_add_f32 v126, v126, v134
    v_mov_b32 v127, v125
    s_nop 0
    v_permlane32_swap_b32 v124, v126
    v_permlane32_swap_b32 v125, v127
    v_add_f32 v124, v124, v126
    v_add_f32 v125, v125, v127
    s_nop 1
    v_permlane16_swap_b32 v124, v125
    v_add_f32 v127, v124, v125
    v_add_f32 v124, v124, v125
    s_nop 1
    v_permlane16_swap_b32 v124, v127
    v_mul_f32 v126, 0x3a800000, v124
    v_mul_f32 v124, 0x3a800000, v124
    s_nop 1
    v_permlane32_swap_b32 v124, v126
    v_fma_f32 v21, -v124, v124, v126
    v_cvt_pk_bf16_f32 v20, 0, v124
    v_max_f32 v21, 0, v21
    v_cvt_pk_bf16_f32 v21, 0, v21
    v_add_f32 v21, 0x3727c5ac, v21
    v_cvt_pk_bf16_f32 v21, 0, v21
    v_sqrt_f32 v21, v21
    s_nop 0
    v_cvt_pk_bf16_f32 v21, 0, v21
    s_lshl3_add_u32 s13, s3, 136192
    v_rcp_f32 v21, v21
    v_fma_f32 v127, -v20, v26, v127
    v_mov_b32 v5, s13
    v_mul_f32 v127, v127, v21
    ds_write_b64 v8, v[20:21]
    s_movk_i32 s13, 0xfff
    v_ashrrev_i32 v124, 31, v127
    v_or_b32 v124, 0x80000000, v124
    v_xor_b32 v124, v124, v127
    v_bfi_b32 v56, s13, v22, v124
    s_nop 1
    v_min_u32_dpp v57, v56, v56 row_ror:8 row_mask:0xf bank_mask:0xf
    v_max_u32_dpp v56, v56, v56 row_ror:8 row_mask:0xf bank_mask:0xf
    s_nop 1
    v_min_u32_dpp v58, v56, v56 row_ror:4 row_mask:0xf bank_mask:0xf
    v_max_u32_dpp v57, v57, v57 row_ror:4 row_mask:0xf bank_mask:0xf
    v_max_u32_dpp v56, v56, v56 row_ror:4 row_mask:0xf bank_mask:0xf
    v_max_u32 v57, v57, v58
    s_nop 0
    v_min_u32_dpp v58, v56, v56 row_ror:2 row_mask:0xf bank_mask:0xf
    v_max_u32_dpp v57, v57, v57 row_ror:2 row_mask:0xf bank_mask:0xf
    v_max_u32_dpp v56, v56, v56 row_ror:2 row_mask:0xf bank_mask:0xf
    v_max_u32 v57, v57, v58
    s_nop 0
    v_min_u32_dpp v58, v56, v56 row_ror:1 row_mask:0xf bank_mask:0xf
    v_max_u32_dpp v57, v57, v57 row_ror:1 row_mask:0xf bank_mask:0xf
    v_max_u32_dpp v56, v56, v56 row_ror:1 row_mask:0xf bank_mask:0xf
    v_max_u32 v57, v57, v58
    ds_write_b64 v5, v[56:57]
    v_and_b32 v6, 3, v1
    v_lshlrev_b32 v6, 18, v6
    v_bfe_u32 v9, v1, 2, 2
    v_lshl_add_u32 v6, v9, 13, v6
    s_and_b32 s96, s21, 1
    s_and_b32 s97, s12, 7
    s_lshr_b32 s98, s12, 3
    s_lshl3_add_u32 s99, s97, s98
    s_lshl_b32 s97, s99, 12
    s_lshr_b32 s98, s21, 1
    s_lshl_b32 s99, s98, 6
    s_add_u32 s98, s97, s99
    s_lshl4_add_u32 s97, s96, s98
    s_add_u32 s99, s97, 1048576
    s_add_u32 s14, s99, 2560
    s_waitcnt lgkmcnt(0)
    s_barrier
    ds_read_b64 v[56:57], v11
    ds_read_b64 v[20:21], v10
    s_waitcnt lgkmcnt(1)
    v_min_u32_dpp v58, v56, v56 quad_perm:[1,0,3,2] row_mask:0xf bank_mask:0xf
    v_max_u32_dpp v57, v57, v57 quad_perm:[1,0,3,2] row_mask:0xf bank_mask:0xf
    v_max_u32_dpp v56, v56, v56 quad_perm:[1,0,3,2] row_mask:0xf bank_mask:0xf
    v_max_u32 v57, v57, v58
    s_nop 0
    v_min_u32_dpp v58, v56, v56 quad_perm:[2,3,0,1] row_mask:0xf bank_mask:0xf
    v_max_u32_dpp v57, v57, v57 quad_perm:[2,3,0,1] row_mask:0xf bank_mask:0xf
    v_max_u32_dpp v56, v56, v56 quad_perm:[2,3,0,1] row_mask:0xf bank_mask:0xf
    v_max_u32 v57, v57, v58
    s_nop 0
    v_min_u32_dpp v58, v56, v56 row_half_mirror row_mask:0xf bank_mask:0xf
    v_max_u32_dpp v57, v57, v57 row_half_mirror row_mask:0xf bank_mask:0xf
    v_max_u32_dpp v56, v56, v56 row_half_mirror row_mask:0xf bank_mask:0xf
    v_max_u32 v57, v57, v58
    v_or_b32 v58, 1, v57
    v_mov_b32 v57, s4
    v_mov_b32 v59, s4
    s_cmp_lg_u32 s3, 0
    s_cbranch_scc1 L_NOF
    s_mov_b64 exec, 0xffff
    buffer_store_dwordx4 v[56:59], v6, s[32:35], s14 offen sc1
    s_mov_b64 exec, -1
L_NOF:
    s_cmp_lg_u32 s3, 1
    s_cbranch_scc1 L_NOC
    v_and_b32 v4, 16, v1
    v_cmp_eq_u32 vcc, 0, v4
    s_nop 1
    v_cndmask_b32 v4, v58, v56, vcc
    v_not_b32 v4, v4
    v_bfe_u32 v4, v4, 1, 7
    v_lshlrev_b32 v6, 3, v4
    v_mul_u32_u24 v4, 144, v4
    v_add_u32 v6, 135168, v6
    v_and_b32 v5, 15, v1
    v_lshlrev_b32 v5, 3, v5
    v_add_u32 v4, v4, v5
    ds_read_b64 v[128:129], v6
    ds_read_b64 v[124:125], v4 offset:0
    v_and_b32 v6, 15, v1
    v_lshlrev_b32 v6, 4, v6
    v_bfe_u32 v9, v1, 4, 1
    v_lshl_add_u32 v6, v9, 14, v6
    v_lshrrev_b32 v9, 5, v1
    v_lshl_add_u32 v6, v9, 12, v6
    v_bfe_u32 v7, v1, 4, 1
    v_lshlrev_b32 v7, 14, v7
    s_lshl_b32 s96, s21, 15
    s_lshl_b32 s97, s12, 8
    s_add_u32 s98, s96, s97
    s_add_u32 s13, s98, 33554432
    s_lshl_b32 s96, s21, 15
    s_lshl3_add_u32 s97, s12, s96
    s_add_u32 s98, s97, 8192
    s_add_u32 s16, s98, 33554432
    v_mov_b32 v127, s4
    s_waitcnt lgkmcnt(0)
    v_lshlrev_b32 v132, 16, v124
    v_and_b32 v133, s6, v124
    v_lshlrev_b32 v134, 16, v125
    v_and_b32 v135, s6, v125
    v_pk_add_f32 v[132:133], v[132:133], v[128:129] op_sel_hi:[1,0] neg_lo:[0,1] neg_hi:[0,1]
    v_pk_add_f32 v[134:135], v[134:135], v[128:129] op_sel_hi:[1,0] neg_lo:[0,1] neg_hi:[0,1]
    v_cvt_pk_bf16_f32 v132, 0, v132
    v_cvt_pk_bf16_f32 v133, 0, v133
    v_cvt_pk_bf16_f32 v134, 0, v134
    v_cvt_pk_bf16_f32 v135, 0, v135
    v_pk_mul_f32 v[132:133], v[132:133], v[128:129] op_sel:[0,1]
    v_pk_mul_f32 v[134:135], v[134:135], v[128:129] op_sel:[0,1]
    v_cvt_pk_bf16_f32 v132, 0, v132
    v_cvt_pk_bf16_f32 v133, 0, v133
    v_cvt_pk_bf16_f32 v134, 0, v134
    v_cvt_pk_bf16_f32 v135, 0, v135
    v_pk_mul_f32 v[132:133], v[132:133], v[144:145]
    v_pk_mul_f32 v[134:135], v[134:135], v[146:147]
    v_cvt_pk_bf16_f32 v132, 0, v132
    v_cvt_pk_bf16_f32 v133, 0, v133
    v_cvt_pk_bf16_f32 v134, 0, v134
    v_cvt_pk_bf16_f32 v135, 0, v135
    v_pk_add_f32 v[132:133], v[132:133], v[140:141]
    v_pk_add_f32 v[134:135], v[134:135], v[142:143]
    v_mov_b32 v126, v125
    v_mov_b32 v125, s4
    s_mov_b32 exec_hi, 0
    v_cvt_pk_bf16_f32 v124, v132, v133
    v_cvt_pk_bf16_f32 v126, v134, v135
    s_mov_b32 exec_hi, -1
    v_dot2_f32_bf16 v128, v124, v148, 0
    v_mov_b32 v129, s4
    v_dot2_f32_bf16 v128, v126, v149, v128
    buffer_store_dwordx4 v[124:127], v6, s[32:35], s13 offen sc1
    s_nop 1
    v_add_f32_dpp v128, v128, v128 quad_perm:[1,0,3,2] row_mask:0xf bank_mask:0xf
    s_nop 1
    v_add_f32_dpp v128, v128, v128 quad_perm:[2,3,0,1] row_mask:0xf bank_mask:0xf
    s_nop 1
    v_add_f32_dpp v128, v128, v128 row_half_mirror row_mask:0xf bank_mask:0xf
    s_nop 1
    v_add_f32_dpp v128, v128, v128 row_ror:8 row_mask:0xf bank_mask:0xf
    s_mov_b64 exec, 0x10001
    buffer_store_dwordx2 v[128:129], v7, s[32:35], s16 offen sc1
    s_mov_b64 exec, -1
L_NOC:
    s_waitcnt lgkmcnt(0)
    s_add_u32 s13, s81, 8192
    s_lshl2_add_u32 m0, s89, 100352
    s_nop 0
    buffer_load_dwordx4 v73, s[60:63], s13 offen nt lds
    s_load_dwordx8 s[24:31], s[32:33], s92 offset:2560 glc
    v_pk_add_f32 v[76:77], v[28:29], v[20:21] op_sel_hi:[1,0] neg_lo:[0,1] neg_hi:[0,1]
    v_pk_add_f32 v[78:79], v[30:31], v[20:21] op_sel_hi:[1,0] neg_lo:[0,1] neg_hi:[0,1]
    v_pk_add_f32 v[80:81], v[32:33], v[20:21] op_sel_hi:[1,0] neg_lo:[0,1] neg_hi:[0,1]
    v_pk_add_f32 v[82:83], v[34:35], v[20:21] op_sel_hi:[1,0] neg_lo:[0,1] neg_hi:[0,1]
    v_pk_add_f32 v[84:85], v[36:37], v[20:21] op_sel_hi:[1,0] neg_lo:[0,1] neg_hi:[0,1]
    v_pk_add_f32 v[86:87], v[38:39], v[20:21] op_sel_hi:[1,0] neg_lo:[0,1] neg_hi:[0,1]
    v_pk_add_f32 v[88:89], v[40:41], v[20:21] op_sel_hi:[1,0] neg_lo:[0,1] neg_hi:[0,1]
    v_pk_add_f32 v[90:91], v[42:43], v[20:21] op_sel_hi:[1,0] neg_lo:[0,1] neg_hi:[0,1]
    v_cvt_pk_bf16_f32 v76, 0, v76
    v_cvt_pk_bf16_f32 v77, 0, v77
    v_cvt_pk_bf16_f32 v78, 0, v78
    v_cvt_pk_bf16_f32 v79, 0, v79
    v_cvt_pk_bf16_f32 v80, 0, v80
    v_cvt_pk_bf16_f32 v81, 0, v81
    v_cvt_pk_bf16_f32 v82, 0, v82
    v_cvt_pk_bf16_f32 v83, 0, v83
    v_cvt_pk_bf16_f32 v84, 0, v84
    v_cvt_pk_bf16_f32 v85, 0, v85
    v_cvt_pk_bf16_f32 v86, 0, v86
    v_cvt_pk_bf16_f32 v87, 0, v87
    v_cvt_pk_bf16_f32 v88, 0, v88
    v_cvt_pk_bf16_f32 v89, 0, v89
    v_cvt_pk_bf16_f32 v90, 0, v90
    v_cvt_pk_bf16_f32 v91, 0, v91
    v_pk_mul_f32 v[76:77], v[76:77], v[20:21] op_sel:[0,1]
    v_pk_mul_f32 v[78:79], v[78:79], v[20:21] op_sel:[0,1]
    v_pk_mul_f32 v[80:81], v[80:81], v[20:21] op_sel:[0,1]
    v_pk_mul_f32 v[82:83], v[82:83], v[20:21] op_sel:[0,1]
    v_pk_mul_f32 v[84:85], v[84:85], v[20:21] op_sel:[0,1]
    v_pk_mul_f32 v[86:87], v[86:87], v[20:21] op_sel:[0,1]
    v_pk_mul_f32 v[88:89], v[88:89], v[20:21] op_sel:[0,1]
    v_pk_mul_f32 v[90:91], v[90:91], v[20:21] op_sel:[0,1]
    v_cvt_pk_bf16_f32 v76, 0, v76
    v_cvt_pk_bf16_f32 v77, 0, v77
    v_cvt_pk_bf16_f32 v78, 0, v78
    v_cvt_pk_bf16_f32 v79, 0, v79
    v_cvt_pk_bf16_f32 v80, 0, v80
    v_cvt_pk_bf16_f32 v81, 0, v81
    v_cvt_pk_bf16_f32 v82, 0, v82
    v_cvt_pk_bf16_f32 v83, 0, v83
    v_cvt_pk_bf16_f32 v84, 0, v84
    v_cvt_pk_bf16_f32 v85, 0, v85
    v_cvt_pk_bf16_f32 v86, 0, v86
    v_cvt_pk_bf16_f32 v87, 0, v87
    v_cvt_pk_bf16_f32 v88, 0, v88
    v_cvt_pk_bf16_f32 v89, 0, v89
    v_cvt_pk_bf16_f32 v90, 0, v90
    v_cvt_pk_bf16_f32 v91, 0, v91
    v_pk_mul_f32 v[76:77], v[76:77], v[108:109]
    v_pk_mul_f32 v[78:79], v[78:79], v[110:111]
    v_pk_mul_f32 v[80:81], v[80:81], v[112:113]
    v_pk_mul_f32 v[82:83], v[82:83], v[114:115]
    v_pk_mul_f32 v[84:85], v[84:85], v[116:117]
    v_pk_mul_f32 v[86:87], v[86:87], v[118:119]
    v_pk_mul_f32 v[88:89], v[88:89], v[120:121]
    v_pk_mul_f32 v[90:91], v[90:91], v[122:123]
    v_cvt_pk_bf16_f32 v76, 0, v76
    v_cvt_pk_bf16_f32 v77, 0, v77
    v_cvt_pk_bf16_f32 v78, 0, v78
    v_cvt_pk_bf16_f32 v79, 0, v79
    v_cvt_pk_bf16_f32 v80, 0, v80
    v_cvt_pk_bf16_f32 v81, 0, v81
    v_cvt_pk_bf16_f32 v82, 0, v82
    v_cvt_pk_bf16_f32 v83, 0, v83
    v_cvt_pk_bf16_f32 v84, 0, v84
    v_cvt_pk_bf16_f32 v85, 0, v85
    v_cvt_pk_bf16_f32 v86, 0, v86
    v_cvt_pk_bf16_f32 v87, 0, v87
    v_cvt_pk_bf16_f32 v88, 0, v88
    v_cvt_pk_bf16_f32 v89, 0, v89
    v_cvt_pk_bf16_f32 v90, 0, v90
    v_cvt_pk_bf16_f32 v91, 0, v91
    v_pk_add_f32 v[76:77], v[76:77], v[92:93]
    v_pk_add_f32 v[78:79], v[78:79], v[94:95]
    v_pk_add_f32 v[80:81], v[80:81], v[96:97]
    v_pk_add_f32 v[82:83], v[82:83], v[98:99]
    v_pk_add_f32 v[84:85], v[84:85], v[100:101]
    v_pk_add_f32 v[86:87], v[86:87], v[102:103]
    v_pk_add_f32 v[88:89], v[88:89], v[104:105]
    v_pk_add_f32 v[90:91], v[90:91], v[106:107]
    v_cvt_pk_bf16_f32 v76, 0, v76
    v_cvt_pk_bf16_f32 v77, 0, v77
    v_cvt_pk_bf16_f32 v78, 0, v78
    v_cvt_pk_bf16_f32 v79, 0, v79
    v_cvt_pk_bf16_f32 v80, 0, v80
    v_cvt_pk_bf16_f32 v81, 0, v81
    v_cvt_pk_bf16_f32 v82, 0, v82
    v_cvt_pk_bf16_f32 v83, 0, v83
    v_cvt_pk_bf16_f32 v84, 0, v84
    v_cvt_pk_bf16_f32 v85, 0, v85
    v_cvt_pk_bf16_f32 v86, 0, v86
    v_cvt_pk_bf16_f32 v87, 0, v87
    v_cvt_pk_bf16_f32 v88, 0, v88
    v_cvt_pk_bf16_f32 v89, 0, v89
    v_cvt_pk_bf16_f32 v90, 0, v90
    v_cvt_pk_bf16_f32 v91, 0, v91
    s_lshr_b32 s96, s3, 2
    s_lshl_b32 s97, s96, 15
    s_and_b32 s98, s3, 3
    s_lshl_b32 s99, s98, 5
    s_add_u32 s96, s97, s99
    s_add_u32 s13, s96, 32768
    v_lshrrev_b32 v54, 4, v1
    v_lshlrev_b32 v54, 13, v54
    v_bfe_u32 v9, v1, 2, 2
    v_lshl_add_u32 v54, v9, 7, v54
    v_bfe_u32 v9, v1, 3, 2
    v_lshl_add_u32 v54, v9, 5, v54
    v_and_b32 v9, 3, v1
    v_lshl_add_u32 v54, v9, 3, v54
    v_xor_b32 v54, s13, v54
    s_lshl_b32 s13, s3, 6
    v_bfe_u32 v55, v1, 2, 1
    v_lshlrev_b32 v55, 9, v55
    v_bfe_u32 v9, v1, 3, 1
    v_lshl_add_u32 v55, v9, 12, v55
    v_lshrrev_b32 v9, 5, v1
    v_lshl_add_u32 v55, v9, 11, v55
    v_bfe_u32 v9, v1, 2, 2
    v_lshl_add_u32 v55, v9, 6, v55
    v_bfe_u32 v9, v1, 4, 1
    v_lshl_add_u32 v55, v9, 5, v55
    v_and_b32 v9, 3, v1
    v_lshl_add_u32 v55, v9, 3, v55
    v_xor_b32 v55, s13, v55
    v_add_u32 v55, 98304, v55
    v_and_b32 v60, 7, v1
    v_lshlrev_b32 v60, 4, v60
    v_lshrrev_b32 v9, 4, v1
    v_lshl_add_u32 v60, v9, 7, v60
    v_add_u32 v60, 136704, v60
    s_lshl4_add_u32 s13, s3, 136256
    v_mov_b32 v4, s13
    v_and_b32 v5, 7, v1
    v_lshlrev_b32 v5, 4, v5
    v_add_u32 v5, 136256, v5
    v_and_b32 v8, 8, v1
    v_cmp_eq_u32 s[22:23], 0, v8
    s_branch SCHK_46
SPOLL_45:
    s_load_dwordx8 s[24:31], s[32:33], s92 offset:2560 glc
SCHK_46:
    s_add_u32 s5, s5, 1
    s_cmp_ge_u32 s5, 300000
    s_waitcnt lgkmcnt(0)
    s_cbranch_scc1 SDONE_47
    s_cmp_lg_u32 s25, s4
    s_cbranch_scc1 SPOLL_45
    s_cmp_lg_u32 s27, s4
    s_cbranch_scc1 SPOLL_45
    s_cmp_lg_u32 s29, s4
    s_cbranch_scc1 SPOLL_45
    s_cmp_lg_u32 s31, s4
    s_cbranch_scc1 SPOLL_45
SDONE_47:
    s_min_u32 s25, s24, s28
    s_max_u32 s24, s24, s28
    s_max_u32 s27, s26, s30
    s_min_u32 s26, s26, s30
    s_max_u32 s28, s25, s27
    s_min_u32 s25, s25, s27
    v_mov_b32 v140, s24
    v_mov_b32 v143, s26
    v_mov_b32 v141, s28
    v_mov_b32 v142, s25
    ds_write_b128 v4, v[140:143]
    s_waitcnt lgkmcnt(0)
    s_barrier
    s_cmp_lt_u32 s3, 4
    s_cbranch_scc1 L_CSEL
    s_add_u32 s13, s81, 12288
    s_lshl2_add_u32 m0, s89, 101376
    s_nop 0
    buffer_load_dwordx4 v73, s[60:63], s13 offen nt lds
    ds_read_b64_tr_b16 v[156:157], v54
    ds_read_b64_tr_b16 v[158:159], v54 offset:512
    ds_read_b64_tr_b16 v[160:161], v54 offset:1024
    ds_read_b64_tr_b16 v[162:163], v54 offset:1536
    ds_read_b64_tr_b16 v[164:165], v54 offset:2048
    ds_read_b64_tr_b16 v[166:167], v54 offset:2560
    ds_read_b64_tr_b16 v[168:169], v54 offset:3072
    ds_read_b64_tr_b16 v[170:171], v54 offset:3584
    ds_read_b64_tr_b16 v[172:173], v54 offset:4096
    ds_read_b64_tr_b16 v[174:175], v54 offset:4608
    ds_read_b64_tr_b16 v[176:177], v54 offset:5120
    ds_read_b64_tr_b16 v[178:179], v54 offset:5632
    ds_read_b64_tr_b16 v[180:181], v54 offset:6144
    ds_read_b64_tr_b16 v[182:183], v54 offset:6656
    ds_read_b64_tr_b16 v[184:185], v54 offset:7168
    ds_read_b64_tr_b16 v[186:187], v54 offset:7680
    v_mul_u32_u24_dpp v92, v70, v52 row_newbcast:0 row_mask:0xf bank_mask:0xf
    v_and_b32_dpp v93, v70, v53 row_newbcast:0 row_mask:0xf bank_mask:0xf
    v_mul_u32_u24_dpp v94, v70, v52 row_newbcast:1 row_mask:0xf bank_mask:0xf
    v_and_b32_dpp v95, v70, v53 row_newbcast:1 row_mask:0xf bank_mask:0xf
    v_mul_u32_u24_dpp v96, v70, v52 row_newbcast:2 row_mask:0xf bank_mask:0xf
    v_and_b32_dpp v97, v70, v53 row_newbcast:2 row_mask:0xf bank_mask:0xf
    v_mul_u32_u24_dpp v98, v70, v52 row_newbcast:3 row_mask:0xf bank_mask:0xf
    v_and_b32_dpp v99, v70, v53 row_newbcast:3 row_mask:0xf bank_mask:0xf
    v_mul_u32_u24_dpp v100, v70, v52 row_newbcast:4 row_mask:0xf bank_mask:0xf
    v_and_b32_dpp v101, v70, v53 row_newbcast:4 row_mask:0xf bank_mask:0xf
    v_mul_u32_u24_dpp v102, v70, v52 row_newbcast:5 row_mask:0xf bank_mask:0xf
    v_and_b32_dpp v103, v70, v53 row_newbcast:5 row_mask:0xf bank_mask:0xf
    v_mul_u32_u24_dpp v104, v70, v52 row_newbcast:6 row_mask:0xf bank_mask:0xf
    v_and_b32_dpp v105, v70, v53 row_newbcast:6 row_mask:0xf bank_mask:0xf
    v_mul_u32_u24_dpp v106, v70, v52 row_newbcast:7 row_mask:0xf bank_mask:0xf
    v_and_b32_dpp v107, v70, v53 row_newbcast:7 row_mask:0xf bank_mask:0xf
    v_pk_mul_f32 v[76:77], v[76:77], v[92:93]
    v_pk_mul_f32 v[78:79], v[78:79], v[94:95]
    v_pk_mul_f32 v[80:81], v[80:81], v[96:97]
    v_pk_mul_f32 v[82:83], v[82:83], v[98:99]
    v_pk_mul_f32 v[84:85], v[84:85], v[100:101]
    v_pk_mul_f32 v[86:87], v[86:87], v[102:103]
    v_pk_mul_f32 v[88:89], v[88:89], v[104:105]
    v_pk_mul_f32 v[90:91], v[90:91], v[106:107]
    v_cvt_pk_bf16_f32 v76, 0, v76
    v_cvt_pk_bf16_f32 v77, 0, v77
    v_cvt_pk_bf16_f32 v78, 0, v78
    v_cvt_pk_bf16_f32 v79, 0, v79
    v_cvt_pk_bf16_f32 v80, 0, v80
    v_cvt_pk_bf16_f32 v81, 0, v81
    v_cvt_pk_bf16_f32 v82, 0, v82
    v_cvt_pk_bf16_f32 v83, 0, v83
    v_cvt_pk_bf16_f32 v84, 0, v84
    v_cvt_pk_bf16_f32 v85, 0, v85
    v_cvt_pk_bf16_f32 v86, 0, v86
    v_cvt_pk_bf16_f32 v87, 0, v87
    v_cvt_pk_bf16_f32 v88, 0, v88
    v_cvt_pk_bf16_f32 v89, 0, v89
    v_cvt_pk_bf16_f32 v90, 0, v90
    v_cvt_pk_bf16_f32 v91, 0, v91
    v_pk_add_f32 v[76:77], v[76:77], v[28:29]
    v_pk_add_f32 v[78:79], v[78:79], v[30:31]
    v_pk_add_f32 v[80:81], v[80:81], v[32:33]
    v_pk_add_f32 v[82:83], v[82:83], v[34:35]
    v_pk_add_f32 v[84:85], v[84:85], v[36:37]
    v_pk_add_f32 v[86:87], v[86:87], v[38:39]
    v_pk_add_f32 v[88:89], v[88:89], v[40:41]
    v_pk_add_f32 v[90:91], v[90:91], v[42:43]
    v_cvt_pk_bf16_f32 v44, v76, v77
    v_cvt_pk_bf16_f32 v45, v78, v79
    v_cvt_pk_bf16_f32 v46, v80, v81
    v_cvt_pk_bf16_f32 v47, v82, v83
    v_cvt_pk_bf16_f32 v48, v84, v85
    v_cvt_pk_bf16_f32 v49, v86, v87
    v_cvt_pk_bf16_f32 v50, v88, v89
    v_cvt_pk_bf16_f32 v51, v90, v91
    ds_write_b128 v23, v[44:47]
    ds_write_b128 v23, v[48:51] offset:16
    s_mul_i32 s96, s3, 2304
    s_add_u32 s16, s96, 139776
    v_lshrrev_b32 v23, 3, v1
    v_mul_u32_u24 v23, 144, v23
    v_and_b32 v9, 7, v1
    v_lshl_add_u32 v23, v9, 4, v23
    v_add_u32 v23, s16, v23
    s_branch L_CSELD
L_CSEL:
    ds_read_b128 v[140:143], v5
    s_lshl_b32 s96, s3, 9
    s_add_u32 s13, s96, 136704
    v_add_u32 v6, s13, v63
    s_lshl2_add_u32 s13, s3, 136384
    v_mov_b32 v7, s13
    s_waitcnt lgkmcnt(0)
    v_max_u32_dpp v144, v143, v140 quad_perm:[1,0,3,2] row_mask:0xf bank_mask:0xf
    v_max_u32_dpp v145, v142, v141 quad_perm:[1,0,3,2] row_mask:0xf bank_mask:0xf
    v_max_u32_dpp v146, v141, v142 quad_perm:[1,0,3,2] row_mask:0xf bank_mask:0xf
    v_max_u32_dpp v147, v140, v143 quad_perm:[1,0,3,2] row_mask:0xf bank_mask:0xf
    v_max_u32 v148, v144, v146
    v_max_u32 v149, v145, v147
    v_min_u32 v150, v144, v146
    v_min_u32 v151, v145, v147
    v_max_u32 v140, v148, v149
    v_min_u32 v141, v148, v149
    v_max_u32 v142, v150, v151
    v_min_u32 v143, v150, v151
    s_nop 1
    v_max_u32_dpp v144, v143, v140 quad_perm:[2,3,0,1] row_mask:0xf bank_mask:0xf
    v_max_u32_dpp v145, v142, v141 quad_perm:[2,3,0,1] row_mask:0xf bank_mask:0xf
    v_max_u32_dpp v146, v141, v142 quad_perm:[2,3,0,1] row_mask:0xf bank_mask:0xf
    v_max_u32_dpp v147, v140, v143 quad_perm:[2,3,0,1] row_mask:0xf bank_mask:0xf
    v_max_u32 v148, v144, v146
    v_max_u32 v149, v145, v147
    v_min_u32 v150, v144, v146
    v_min_u32 v151, v145, v147
    v_max_u32 v140, v148, v149
    v_min_u32 v141, v148, v149
    v_max_u32 v142, v150, v151
    v_min_u32 v143, v150, v151
    s_nop 1
    v_max_u32_dpp v144, v143, v140 row_half_mirror row_mask:0xf bank_mask:0xf
    v_max_u32_dpp v145, v142, v141 row_half_mirror row_mask:0xf bank_mask:0xf
    v_max_u32_dpp v146, v141, v142 row_half_mirror row_mask:0xf bank_mask:0xf
    v_max_u32_dpp v147, v140, v143 row_half_mirror row_mask:0xf bank_mask:0xf
    v_readfirstlane_b32 s24, v144
    v_readfirstlane_b32 s25, v145
    v_readfirstlane_b32 s26, v146
    v_readfirstlane_b32 s27, v147
    s_bitcmp1_b32 s3, 0
    s_cselect_b32 s24, s25, s24
    s_cselect_b32 s26, s27, s26
    s_bitcmp1_b32 s3, 1
    s_cselect_b32 s24, s26, s24
    s_and_b32 s15, s24, 4095
    s_lshr_b32 s96, s15, 8
    s_sub_u32 s97, 15, s96
    s_and_b32 s98, s15, 1
    s_lshl1_add_u32 s99, s97, s98
    s_lshl_b32 s96, s99, 14
    s_add_u32 s13, s96, 33554432
    s_lshl_b32 s96, s75, 10
    s_add_u32 s14, s96, s13
    s_add_u32 s13, s13, 8192
    v_and_b32 v10, 15, v1
    v_lshlrev_b32 v10, 3, v10
    buffer_load_dwordx2 v[144:145], v10, s[32:35], s13 offen sc1
    buffer_load_dwordx4 v[140:143], v2, s[32:35], s14 offen sc1
    s_add_u32 s16, s81, 12288
    s_lshl2_add_u32 m0, s89, 101376
    s_nop 0
    buffer_load_dwordx4 v73, s[60:63], s16 offen nt lds
    ds_read_b64_tr_b16 v[156:157], v54
    ds_read_b64_tr_b16 v[158:159], v54 offset:512
    ds_read_b64_tr_b16 v[160:161], v54 offset:1024
    ds_read_b64_tr_b16 v[162:163], v54 offset:1536
    ds_read_b64_tr_b16 v[164:165], v54 offset:2048
    ds_read_b64_tr_b16 v[166:167], v54 offset:2560
    ds_read_b64_tr_b16 v[168:169], v54 offset:3072
    ds_read_b64_tr_b16 v[170:171], v54 offset:3584
    ds_read_b64_tr_b16 v[172:173], v54 offset:4096
    ds_read_b64_tr_b16 v[174:175], v54 offset:4608
    ds_read_b64_tr_b16 v[176:177], v54 offset:5120
    ds_read_b64_tr_b16 v[178:179], v54 offset:5632
    ds_read_b64_tr_b16 v[180:181], v54 offset:6144
    ds_read_b64_tr_b16 v[182:183], v54 offset:6656
    ds_read_b64_tr_b16 v[184:185], v54 offset:7168
    ds_read_b64_tr_b16 v[186:187], v54 offset:7680
    v_mul_u32_u24_dpp v92, v70, v52 row_newbcast:0 row_mask:0xf bank_mask:0xf
    v_and_b32_dpp v93, v70, v53 row_newbcast:0 row_mask:0xf bank_mask:0xf
    v_mul_u32_u24_dpp v94, v70, v52 row_newbcast:1 row_mask:0xf bank_mask:0xf
    v_and_b32_dpp v95, v70, v53 row_newbcast:1 row_mask:0xf bank_mask:0xf
    v_mul_u32_u24_dpp v96, v70, v52 row_newbcast:2 row_mask:0xf bank_mask:0xf
    v_and_b32_dpp v97, v70, v53 row_newbcast:2 row_mask:0xf bank_mask:0xf
    v_mul_u32_u24_dpp v98, v70, v52 row_newbcast:3 row_mask:0xf bank_mask:0xf
    v_and_b32_dpp v99, v70, v53 row_newbcast:3 row_mask:0xf bank_mask:0xf
    v_mul_u32_u24_dpp v100, v70, v52 row_newbcast:4 row_mask:0xf bank_mask:0xf
    v_and_b32_dpp v101, v70, v53 row_newbcast:4 row_mask:0xf bank_mask:0xf
    v_mul_u32_u24_dpp v102, v70, v52 row_newbcast:5 row_mask:0xf bank_mask:0xf
    v_and_b32_dpp v103, v70, v53 row_newbcast:5 row_mask:0xf bank_mask:0xf
    v_mul_u32_u24_dpp v104, v70, v52 row_newbcast:6 row_mask:0xf bank_mask:0xf
    v_and_b32_dpp v105, v70, v53 row_newbcast:6 row_mask:0xf bank_mask:0xf
    v_mul_u32_u24_dpp v106, v70, v52 row_newbcast:7 row_mask:0xf bank_mask:0xf
    v_and_b32_dpp v107, v70, v53 row_newbcast:7 row_mask:0xf bank_mask:0xf
    v_pk_mul_f32 v[76:77], v[76:77], v[92:93]
    v_pk_mul_f32 v[78:79], v[78:79], v[94:95]
    v_pk_mul_f32 v[80:81], v[80:81], v[96:97]
    v_pk_mul_f32 v[82:83], v[82:83], v[98:99]
    v_pk_mul_f32 v[84:85], v[84:85], v[100:101]
    v_pk_mul_f32 v[86:87], v[86:87], v[102:103]
    v_pk_mul_f32 v[88:89], v[88:89], v[104:105]
    v_pk_mul_f32 v[90:91], v[90:91], v[106:107]
    v_cvt_pk_bf16_f32 v76, 0, v76
    v_cvt_pk_bf16_f32 v77, 0, v77
    v_cvt_pk_bf16_f32 v78, 0, v78
    v_cvt_pk_bf16_f32 v79, 0, v79
    v_cvt_pk_bf16_f32 v80, 0, v80
    v_cvt_pk_bf16_f32 v81, 0, v81
    v_cvt_pk_bf16_f32 v82, 0, v82
    v_cvt_pk_bf16_f32 v83, 0, v83
    v_cvt_pk_bf16_f32 v84, 0, v84
    v_cvt_pk_bf16_f32 v85, 0, v85
    v_cvt_pk_bf16_f32 v86, 0, v86
    v_cvt_pk_bf16_f32 v87, 0, v87
    v_cvt_pk_bf16_f32 v88, 0, v88
    v_cvt_pk_bf16_f32 v89, 0, v89
    v_cvt_pk_bf16_f32 v90, 0, v90
    v_cvt_pk_bf16_f32 v91, 0, v91
    v_pk_add_f32 v[76:77], v[76:77], v[28:29]
    v_pk_add_f32 v[78:79], v[78:79], v[30:31]
    v_pk_add_f32 v[80:81], v[80:81], v[32:33]
    v_pk_add_f32 v[82:83], v[82:83], v[34:35]
    v_pk_add_f32 v[84:85], v[84:85], v[36:37]
    v_pk_add_f32 v[86:87], v[86:87], v[38:39]
    v_pk_add_f32 v[88:89], v[88:89], v[40:41]
    v_pk_add_f32 v[90:91], v[90:91], v[42:43]
    v_cvt_pk_bf16_f32 v44, v76, v77
    v_cvt_pk_bf16_f32 v45, v78, v79
    v_cvt_pk_bf16_f32 v46, v80, v81
    v_cvt_pk_bf16_f32 v47, v82, v83
    v_cvt_pk_bf16_f32 v48, v84, v85
    v_cvt_pk_bf16_f32 v49, v86, v87
    v_cvt_pk_bf16_f32 v50, v88, v89
    v_cvt_pk_bf16_f32 v51, v90, v91
    ds_write_b128 v23, v[44:47]
    ds_write_b128 v23, v[48:51] offset:16
    s_mul_i32 s96, s3, 2304
    s_add_u32 s16, s96, 139776
    v_lshrrev_b32 v23, 3, v1
    v_mul_u32_u24 v23, 144, v23
    v_and_b32 v9, 7, v1
    v_lshl_add_u32 v23, v9, 4, v23
    v_add_u32 v23, s16, v23
    s_lshl2_add_u32 s15, s15, s3
    s_waitcnt vmcnt(1)
    v_bitop3_b32 v8, v141, v143, s4 bitop3:0x7e
    v_bitop3_b32 v8, v8, v145, s4 bitop3:0xf6
    v_cmp_ne_u32 vcc, 0, v8
    s_cbranch_vccz TOK_49
POLL_50:
    buffer_load_dwordx2 v[144:145], v10, s[32:35], s13 offen sc1
    buffer_load_dwordx4 v[140:143], v2, s[32:35], s14 offen sc1
    s_waitcnt vmcnt(0)
    v_bitop3_b32 v8, v141, v143, s4 bitop3:0x7e
    v_bitop3_b32 v8, v8, v145, s4 bitop3:0xf6
    v_cmp_ne_u32 vcc, 0, v8
    s_cbranch_vccz PDONE_51
    s_add_u32 s5, s5, 1
    s_cmp_lt_u32 s5, 300000
    s_cbranch_scc1 POLL_50
PDONE_51:
TOK_49:
    ds_write2_b32 v6, v140, v142 offset0:0 offset1:1
    v_add_f32_dpp v144, v144, v144 quad_perm:[1,0,3,2] row_mask:0xf bank_mask:0xf
    s_nop 1
    v_add_f32_dpp v144, v144, v144 quad_perm:[2,3,0,1] row_mask:0xf bank_mask:0xf
    s_nop 1
    v_add_f32_dpp v144, v144, v144 row_half_mirror row_mask:0xf bank_mask:0xf
    s_nop 1
    v_add_f32_dpp v144, v144, v144 row_ror:8 row_mask:0xf bank_mask:0xf
    v_cvt_pk_bf16_f32 v144, 0, v144
    v_ashrrev_i32 v145, 31, v144
    v_or_b32 v145, 0x80000000, v145
    v_xor_b32 v144, v144, v145
    v_and_b32 v144, s6, v144
    v_or_b32 v144, s15, v144
    ds_write_b32 v7, v144
L_CSELD:
    v_mov_b32 v4, 136384
    v_and_b32 v8, 15, v1
    v_lshlrev_b32 v8, 4, v8
    v_lshrrev_b32 v9, 5, v1
    v_lshl_add_u32 v8, v9, 3, v8
    s_lshl_b32 s96, s74, 13
    s_add_u32 s14, s96, 20971520
    s_lshl3_add_u32 s96, s75, s3
    s_lshl_b32 s97, s96, 8
    s_add_u32 s20, s97, s14
    s_waitcnt lgkmcnt(0)
    s_barrier
    ds_read_b128 v[140:143], v4
    s_waitcnt lgkmcnt(0)
    v_max_u32 v144, v140, v141
    v_max_u32 v145, v142, v143
    v_min_u32 v146, v140, v141
    v_min_u32 v147, v142, v143
    v_min_u32 v141, v144, v145
    v_max_u32 v140, v144, v145
    v_max3_u32 v141, v141, v146, v147
    v_cndmask_b32 v4, v141, v140, s[22:23]
    v_readfirstlane_b32 s68, v140
    v_and_b32 v4, 3, v4
    v_readfirstlane_b32 s69, v141
    v_lshl_add_u32 v4, v4, 9, v60
    ds_read_b128 v[144:147], v4
    ds_read_b128 v[44:47], v23
    ds_read_b128 v[48:51], v23 offset:1152
    s_bfe_u32 s70, s68, 720899
    s_bfe_u32 s71, s69, 720899
    s_sub_u32 s70, 2047, s70
    s_sub_u32 s71, 2047, s71
    s_waitcnt lgkmcnt(2)
    v_mfma_f32_16x16x32_bf16 v[204:207], v[144:147], v[156:159], 0
    v_mfma_f32_16x16x32_bf16 v[208:211], v[144:147], v[160:163], 0
    v_mfma_f32_16x16x32_bf16 v[212:215], v[144:147], v[164:167], 0
    v_mfma_f32_16x16x32_bf16 v[216:219], v[144:147], v[168:171], 0
    v_mfma_f32_16x16x32_bf16 v[220:223], v[144:147], v[172:175], 0
    v_mfma_f32_16x16x32_bf16 v[224:227], v[144:147], v[176:179], 0
    v_mfma_f32_16x16x32_bf16 v[228:231], v[144:147], v[180:183], 0
    v_mfma_f32_16x16x32_bf16 v[232:235], v[144:147], v[184:187], 0
    s_nop 1
    v_add_f32 v140, v204, v209
    s_nop 0
    v_add_f32 v141, v214, v219
    s_nop 0
    v_add_f32 v142, v220, v225
    s_nop 0
    v_add_f32 v143, v230, v235
    v_add_f32 v140, v140, v141
    v_add_f32 v142, v142, v143
    v_mov_b32 v141, s4
    s_nop 0
    v_permlane16_swap_b32 v142, v143
    s_cmp_ge_u32 s9, 28
    s_cbranch_scc1 L_NOHP
    v_add_f32 v140, v140, v143
    s_mov_b32 exec_lo, 0xffff
    s_mov_b32 exec_hi, 0xffff
    s_cmp_lg_u32 s93, 0
    s_cbranch_scc1 LOC_52
    buffer_store_dwordx2 v[140:141], v8, s[32:35], s20 offen sc1
    s_branch LOCD_53
LOC_52:
    buffer_store_dwordx2 v[140:141], v8, s[32:35], s20 offen
LOCD_53:
    s_mov_b64 exec, -1
L_NOHP:
    v_mov_b32 v72, v140
    v_mov_b32 v73, v141
    v_add_u32 v74, s20, v8
    s_waitcnt lgkmcnt(0)
    s_bitcmp1_b32 s21, 2
    s_cselect_b32 s17, s71, s70
    s_cselect_b32 s18, s69, s68
    s_cmp_lg_u32 s3, 7
    s_cbranch_scc1 L_NOFZ
    s_cmp_lg_u32 s2, 0
    s_cbranch_scc1 L_NONON
    v_mov_b32 v6, s4
    s_mov_b64 exec, 1
    buffer_store_dword v6, v3, s[32:35], 0 offen sc1
    s_mov_b64 exec, -1
L_NONON:
    s_lshr_b32 s96, s21, 3
    s_and_b32 s97, s21, 1
    s_lshl1_add_u32 s19, s96, s97
    s_lshr_b32 s96, s21, 2
    s_lshl_b32 s97, s96, 1
    s_lshl3_add_u32 s98, s12, s97
    s_and_b32 s99, s21, 1
    s_add_u32 s96, s98, s99
    s_mul_i32 s97, s96, 7168
    s_add_u32 s20, s97, 22020096
    s_lshl_b32 s96, s17, 11
    s_lshl_b32 s97, s12, 7
    s_add_u32 s98, s96, s97
    s_lshl_b32 s99, s19, 5
    s_add_u32 s82, s98, s99
    v_and_b32 v10, 7, v1
    v_lshlrev_b32 v10, 2, v10
    s_lshl_b32 s96, s19, 5
    s_add_u32 s13, s96, 139264
    v_add_u32 v5, s13, v10
    ds_read_b32 v238, v5
    s_lshr_b32 s96, s17, 7
    s_bfe_u32 s97, s18, 65538
    s_lshl1_add_u32 s98, s96, s97
    s_lshl_b32 s99, s98, 14
    s_lshl_b32 s96, s12, 8
    s_add_u32 s97, s99, s96
    s_lshl_b32 s98, s19, 6
    s_add_u32 s99, s97, s98
    s_add_u32 s68, s99, 33554432
    s_add_u32 s69, s68, 4096
    v_and_b32 v11, 7, v1
    v_lshlrev_b32 v11, 3, v11
    buffer_load_dwordx2 v[20:21], v11, s[32:35], s68 offen sc1
    buffer_load_dwordx2 v[236:237], v11, s[32:35], s69 offen sc1
    s_and_b32 s13, s18, s6
    s_ashr_i32 s15, s13, 31
    s_andn2_b32 s15, 0x7fff0000, s15
    s_or_b32 s15, s15, 0x80000000
    s_xor_b32 s13, s13, s15
    v_mov_b32 v239, s13
    v_mul_f32 v239, s7, v239
    v_exp_f32 v239, -v239
    s_nop 0
    v_add_f32 v239, 1.0, v239
    v_rcp_f32 v239, v239
    s_nop 0
    v_cvt_pk_bf16_f32 v239, 0, v239
L_NOFZ:
    s_cmp_lt_u32 s9, 28
    s_cbranch_scc1 L_HSEC
    s_branch L_GSEC
L_HSEC:
    s_cmp_lt_u32 s3, 4
    s_cbranch_scc1 L_HW
    s_branch L_NOH
L_HW:
    s_lshl_b32 s96, s3, 8
    s_add_u32 s13, s96, s14
    v_lshrrev_b32 v4, 4, v1
    v_lshlrev_b32 v4, 11, v4
    v_and_b32 v9, 15, v1
    v_lshl_add_u32 v4, v9, 4, v4
    s_lshl_b32 s96, s3, 5
    s_add_u32 s15, s96, 138752
    v_lshrrev_b32 v5, 5, v1
    v_lshl_add_u32 v5, v5, 7, s15
    v_bfe_u32 v9, v1, 2, 1
    v_lshl_add_u32 v5, v9, 4, v5
    v_bfe_u32 v9, v1, 1, 1
    v_lshl_add_u32 v5, v9, 3, v5
    v_bfe_u32 v9, v1, 3, 1
    v_lshl_add_u32 v5, v9, 2, v5
    v_and_b32 v9, 1, v1
    v_lshl_add_u32 v5, v9, 1, v5
    s_cmp_lg_u32 s93, 0
    s_cbranch_scc1 L_HLOC
SPOLL_54:
    s_load_dword s24, s[32:33], s13 offset:1276 glc
    s_load_dword s25, s[32:33], s13 offset:3324 glc
    s_load_dword s26, s[32:33], s13 offset:5372 glc
    s_load_dword s27, s[32:33], s13 offset:7420 glc
SCHK_55:
    s_add_u32 s5, s5, 1
    s_cmp_ge_u32 s5, 300000
    s_waitcnt lgkmcnt(0)
    s_cbranch_scc1 SDONE_56
    s_cmp_lg_u32 s24, s4
    s_cbranch_scc1 SPOLL_54
    s_cmp_lg_u32 s25, s4
    s_cbranch_scc1 SPOLL_54
    s_cmp_lg_u32 s26, s4
    s_cbranch_scc1 SPOLL_54
    s_cmp_lg_u32 s27, s4
    s_cbranch_scc1 SPOLL_54
SDONE_56:
L_HLOC:
    buffer_load_dwordx4 v[204:207], v4, s[32:35], s13 offen sc1
    buffer_load_dwordx4 v[208:211], v4, s[32:35], s13 offen offset:1024 sc1
    s_waitcnt vmcnt(0)
    v_bitop3_b32 v6, v205, v207, s4 bitop3:0x7e
    v_bitop3_b32 v6, v6, v209, s4 bitop3:0xf6
    v_bitop3_b32 v6, v6, v211, s4 bitop3:0xf6
    v_cmp_ne_u32 vcc, 0, v6
    s_cbranch_vccz TOK_58
POLL_59:
    buffer_load_dwordx4 v[204:207], v4, s[32:35], s13 offen sc1
    buffer_load_dwordx4 v[208:211], v4, s[32:35], s13 offen offset:1024 sc1
    s_waitcnt vmcnt(0)
    v_bitop3_b32 v6, v205, v207, s4 bitop3:0x7e
    v_bitop3_b32 v6, v6, v209, s4 bitop3:0xf6
    v_bitop3_b32 v6, v6, v211, s4 bitop3:0xf6
    v_cmp_ne_u32 vcc, 0, v6
    s_cbranch_vccz PDONE_60
    s_add_u32 s5, s5, 1
    s_cmp_lt_u32 s5, 300000
    s_cbranch_scc1 POLL_59
PDONE_60:
TOK_58:
    v_permlane32_swap_b32 v204, v206
    v_permlane32_swap_b32 v208, v210
    v_add_f32 v204, v204, v206
    v_add_f32 v208, v208, v210
    v_mov_b32 v206, v204
    v_mov_b32 v210, v208
    s_nop 0
    v_permlane16_swap_b32 v204, v206
    v_permlane16_swap_b32 v208, v210
    v_add_f32 v204, v204, v206
    v_add_f32 v208, v208, v210
    v_cvt_pk_bf16_f32 v204, 0, v204
    v_cvt_pk_bf16_f32 v208, 0, v208
    v_mul_f32 v6, s7, v204
    v_exp_f32 v6, -v6
    s_nop 0
    v_add_f32 v6, 1.0, v6
    v_rcp_f32 v6, v6
    s_nop 0
    v_mul_f32 v204, v204, v6
    v_cvt_pk_bf16_f32 v204, 0, v204
    v_mul_f32 v204, v204, v208
    v_cvt_pk_bf16_f32 v204, v204, v204
    ds_write_b16 v5, v204
L_NOH:
    v_bfe_u32 v4, v1, 2, 1
    v_lshlrev_b32 v4, 7, v4
    v_lshrrev_b32 v9, 5, v1
    v_lshl_add_u32 v4, v9, 4, v4
    v_add_u32 v4, 138752, v4
    v_lshrrev_b32 v5, 4, v1
    v_mul_u32_u24 v5, 7168, v5
    v_and_b32 v9, 15, v1
    v_lshl_add_u32 v5, v9, 3, v5
    v_and_b32 v6, 1, v1
    v_lshlrev_b32 v6, 18, v6
    v_bfe_u32 v9, v1, 1, 1
    v_lshl_add_u32 v6, v9, 13, v6
    s_lshl3_add_u32 s96, s75, s3
    s_mul_i32 s97, s96, 28672
    s_lshl_b32 s98, s74, 7
    s_add_u32 s99, s97, s98
    s_add_u32 s13, s99, 22020096
    s_lshr_b32 s96, s9, 2
    s_and_b32 s97, s75, 1
    s_lshr_b32 s98, s3, 1
    s_lshl2_add_u32 s99, s97, s98
    s_and_b32 s97, s3, 1
    s_lshl_b32 s98, s97, 2
    s_lshl3_add_u32 s97, s99, s98
    s_lshr_b32 s99, s75, 1
    s_add_u32 s98, s97, s99
    s_lshl_b32 s97, s98, 12
    s_lshl_b32 s99, s8, 6
    s_add_u32 s98, s97, s99
    s_lshl2_add_u32 s97, s96, s98
    s_add_u32 s99, s97, 1048576
    s_add_u32 s14, s99, 3072
    s_waitcnt vmcnt(0)
    s_waitcnt lgkmcnt(0)
    s_barrier
    ds_read_b128 v[204:207], v4
    ds_read_b64_tr_b16 v[188:189], v55
    ds_read_b64_tr_b16 v[190:191], v55 offset:1024
    ds_read_b128 v[208:211], v4 offset:32
    ds_read_b64_tr_b16 v[192:193], v55 offset:8192
    ds_read_b64_tr_b16 v[194:195], v55 offset:9216
    ds_read_b128 v[212:215], v4 offset:64
    ds_read_b64_tr_b16 v[196:197], v55 offset:16384
    ds_read_b64_tr_b16 v[198:199], v55 offset:17408
    ds_read_b128 v[216:219], v4 offset:96
    ds_read_b64_tr_b16 v[200:201], v55 offset:24576
    ds_read_b64_tr_b16 v[202:203], v55 offset:25600
    s_waitcnt lgkmcnt(9)
    v_mfma_f32_32x32x16_bf16 v[220:235], v[204:207], v[188:191], 0
    s_waitcnt lgkmcnt(6)
    v_mfma_f32_32x32x16_bf16 v[220:235], v[208:211], v[192:195], v[220:235]
    s_waitcnt lgkmcnt(3)
    v_mfma_f32_32x32x16_bf16 v[220:235], v[212:215], v[196:199], v[220:235]
    s_waitcnt lgkmcnt(0)
    v_mfma_f32_32x32x16_bf16 v[220:235], v[216:219], v[200:203], v[220:235]
    s_nop 11
    v_mov_b32 v221, s4
    buffer_store_dwordx2 v[220:221], v5, s[32:35], s13 offen sc1
    s_mov_b64 exec, 15
    buffer_store_dword v221, v6, s[32:35], s14 offen sc1
    s_mov_b64 exec, -1
    s_waitcnt lgkmcnt(0)
L_GSEC:
    s_lshl_b32 s96, s21, 7
    s_lshl4_add_u32 s13, s3, s96
    v_lshrrev_b32 v22, 3, v1
    v_lshl_add_u32 v22, v22, 0, s13
    s_lshl_b32 s96, s13, 11
    s_lshl_b32 s97, s12, 7
    s_add_u32 s15, s96, s97
    s_add_u32 s16, s15, 16384
    v_lshrrev_b32 v25, 3, v1
    v_lshlrev_b32 v25, 11, v25
    v_and_b32 v9, 7, v1
    v_lshl_add_u32 v25, v9, 4, v25
    v_cmp_ne_u32 vcc, s70, v22
    v_cmp_ne_u32 s[22:23], s71, v22
    s_nop 0
    s_and_b64 exec, vcc, s[22:23]
    buffer_store_dwordx4 v[44:47], v25, s[64:67], s15 offen sc1
    s_mov_b64 exec, -1
    v_add_u32 v22, 8, v22
    v_cmp_ne_u32 vcc, s70, v22
    v_cmp_ne_u32 s[22:23], s71, v22
    s_nop 0
    s_and_b64 exec, vcc, s[22:23]
    buffer_store_dwordx4 v[48:51], v25, s[64:67], s16 offen sc1
    s_mov_b64 exec, -1
    s_cmp_lt_u32 s9, 16
    s_cbranch_scc1 L_GF
    s_cmp_ge_u32 s9, 28
    s_cbranch_scc1 L_FIN
    s_waitcnt vmcnt(0)
    s_mov_b32 exec_lo, 0xffff
    s_mov_b32 exec_hi, 0xffff
    buffer_store_dwordx2 v[72:73], v74, s[32:35], 0 offen sc1
    s_mov_b64 exec, -1
    s_branch L_FIN
L_GF:
SPOLL_61:
    s_load_dwordx8 s[24:31], s[32:33], s92 offset:3072 glc
SCHK_62:
    s_add_u32 s5, s5, 1
    s_cmp_ge_u32 s5, 300000
    s_waitcnt lgkmcnt(0)
    s_cbranch_scc1 SDONE_63
    s_cmp_lg_u32 s24, s4
    s_cbranch_scc1 SPOLL_61
    s_cmp_lg_u32 s25, s4
    s_cbranch_scc1 SPOLL_61
    s_cmp_lg_u32 s26, s4
    s_cbranch_scc1 SPOLL_61
    s_cmp_lg_u32 s27, s4
    s_cbranch_scc1 SPOLL_61
    s_cmp_lg_u32 s28, s4
    s_cbranch_scc1 SPOLL_61
    s_cmp_lg_u32 s29, s4
    s_cbranch_scc1 SPOLL_61
    s_cmp_lg_u32 s30, s4
    s_cbranch_scc1 SPOLL_61
SDONE_63:
    s_barrier
    s_mov_b32 exec_lo, 0xffff
    s_mov_b32 exec_hi, 0xffff
    buffer_store_dwordx2 v[72:73], v74, s[32:35], 0 offen sc1
    s_mov_b64 exec, -1
    s_cmp_lg_u32 s3, 7
    s_cbranch_scc1 L_FIN
    s_add_u32 s13, s20, 4096
POLL_64:
    buffer_load_dwordx4 v[204:207], v2, s[32:35], s20 offen sc1
    buffer_load_dwordx4 v[208:211], v2, s[32:35], s20 offen offset:1024 sc1
    buffer_load_dwordx4 v[212:215], v2, s[32:35], s20 offen offset:2048 sc1
    buffer_load_dwordx4 v[216:219], v2, s[32:35], s20 offen offset:3072 sc1
    buffer_load_dwordx4 v[140:143], v2, s[32:35], s13 offen sc1
    buffer_load_dwordx4 v[144:147], v2, s[32:35], s13 offen offset:1024 sc1
    buffer_load_dwordx4 v[148:151], v2, s[32:35], s13 offen offset:2048 sc1
    s_waitcnt vmcnt(0)
    v_bitop3_b32 v4, v205, v207, s4 bitop3:0x7e
    v_bitop3_b32 v4, v4, v209, s4 bitop3:0xf6
    v_bitop3_b32 v4, v4, v211, s4 bitop3:0xf6
    v_bitop3_b32 v4, v4, v213, s4 bitop3:0xf6
    v_bitop3_b32 v4, v4, v215, s4 bitop3:0xf6
    v_bitop3_b32 v4, v4, v217, s4 bitop3:0xf6
    v_bitop3_b32 v4, v4, v219, s4 bitop3:0xf6
    v_bitop3_b32 v4, v4, v141, s4 bitop3:0xf6
    v_bitop3_b32 v4, v4, v143, s4 bitop3:0xf6
    v_bitop3_b32 v4, v4, v145, s4 bitop3:0xf6
    v_bitop3_b32 v4, v4, v147, s4 bitop3:0xf6
    v_bitop3_b32 v4, v4, v149, s4 bitop3:0xf6
    v_bitop3_b32 v4, v4, v151, s4 bitop3:0xf6
    v_cmp_ne_u32 vcc, 0, v4
    s_cbranch_vccz PDONE_65
    s_add_u32 s5, s5, 1
    s_cmp_lt_u32 s5, 300000
    s_cbranch_scc1 POLL_64
PDONE_65:
    v_bitop3_b32 v4, v21, v237, s4 bitop3:0x7e
    v_cmp_ne_u32 vcc, 0, v4
    s_cbranch_vccz TOK_66
POLL_67:
    buffer_load_dwordx2 v[20:21], v11, s[32:35], s68 offen sc1
    buffer_load_dwordx2 v[236:237], v11, s[32:35], s69 offen sc1
    s_waitcnt vmcnt(0)
    v_bitop3_b32 v4, v21, v237, s4 bitop3:0x7e
    v_cmp_ne_u32 vcc, 0, v4
    s_cbranch_vccz PDONE_68
    s_add_u32 s5, s5, 1
    s_cmp_lt_u32 s5, 300000
    s_cbranch_scc1 POLL_67
PDONE_68:
TOK_66:
    v_add_f32 v204, v204, v208
    v_add_f32 v206, v206, v210
    v_add_f32 v204, v204, v212
    v_add_f32 v206, v206, v214
    v_add_f32 v204, v204, v216
    v_add_f32 v206, v206, v218
    v_add_f32 v204, v204, v140
    v_add_f32 v206, v206, v142
    v_add_f32 v204, v204, v144
    v_add_f32 v206, v206, v146
    v_add_f32 v204, v204, v148
    v_add_f32 v206, v206, v150
    v_mov_b32 v205, v206
    v_add_f32_dpp v204, v204, v204 row_ror:8 row_mask:0xf bank_mask:0xf
    s_nop 0
    v_add_f32_dpp v205, v205, v205 row_ror:8 row_mask:0xf bank_mask:0xf
    v_mov_b32 v206, v204
    v_mov_b32 v207, v205
    s_nop 0
    v_permlane16_swap_b32 v204, v206
    v_permlane16_swap_b32 v205, v207
    v_pk_add_f32 v[204:205], v[204:205], v[206:207]
    v_mov_b32 v206, v204
    v_mov_b32 v207, v205
    s_nop 0
    v_permlane32_swap_b32 v204, v206
    v_permlane32_swap_b32 v205, v207
    v_pk_add_f32 v[204:205], v[204:205], v[206:207]
    v_cvt_pk_bf16_f32 v204, 0, v204
    v_cvt_pk_bf16_f32 v205, 0, v205
    v_pk_mul_f32 v[204:205], v[204:205], v[238:239] op_sel:[0,1]
    v_lshlrev_b32 v4, 16, v20
    v_and_b32 v5, s6, v20
    v_cvt_pk_bf16_f32 v204, 0, v204
    v_cvt_pk_bf16_f32 v205, 0, v205
    v_pk_add_f32 v[204:205], v[204:205], v[4:5]
    v_lshlrev_b32 v4, 16, v238
    v_and_b32 v5, s6, v238
    v_cvt_pk_bf16_f32 v204, 0, v204
    v_cvt_pk_bf16_f32 v205, 0, v205
    v_pk_mul_f32 v[204:205], v[204:205], v[4:5]
    v_lshlrev_b32 v4, 16, v236
    v_and_b32 v5, s6, v236
    v_cvt_pk_bf16_f32 v204, 0, v204
    v_cvt_pk_bf16_f32 v205, 0, v205
    v_pk_add_f32 v[204:205], v[204:205], v[4:5]
    v_cvt_pk_bf16_f32 v204, v204, v205
    s_mov_b64 exec, 0xff
    buffer_store_dword v204, v10, s[64:67], s82 offen sc1
    s_mov_b64 exec, -1
L_FIN:
L_END:
    s_endpgm
.p2align 10
.fill 768, 4, 0xbf800000
.section .rodata,"a"
.p2align 6
.amdhsa_kernel adaLN_cond__linear_kernel_hedgehog__moe_arch_mod__prompt_kernel
  .amdhsa_next_free_vgpr 256
  .amdhsa_next_free_sgpr 102
  .amdhsa_accum_offset 256
  .amdhsa_group_segment_fixed_size 0
  .amdhsa_kernarg_size 112
  .amdhsa_user_sgpr_count 2
  .amdhsa_user_sgpr_kernarg_segment_ptr 1
  .amdhsa_system_sgpr_workgroup_id_x 1
  .amdhsa_float_denorm_mode_32 3
  .amdhsa_float_denorm_mode_16_64 3
.end_amdhsa_kernel
```

```asm
; @launch grid=(256,1,1) block=(512,1,1) lds=163840
.amdgcn_target "amdgcn-amd-amdhsa--gfx950"
.text
.globl adaLN_cond__linear_kernel_hedgehog__moe_arch_mod__prompt_kernel
.p2align 8
.type adaLN_cond__linear_kernel_hedgehog__moe_arch_mod__prompt_kernel,@function
adaLN_cond__linear_kernel_hedgehog__moe_arch_mod__prompt_kernel:
    s_load_dwordx16 s[68:83], s[0:1], 0
    s_load_dwordx8 s[84:91], s[0:1], 64
    s_load_dwordx2 s[32:33], s[0:1], 104
    s_load_dwordx2 s[30:31], s[0:1], 96
    s_cmp_ge_u32 s2, 256
    s_cbranch_scc1 L_END
    v_lshrrev_b32 v4, 6, v0
    v_and_b32 v1, 63, v0
    v_mov_b32 v3, 0
    v_readfirstlane_b32 s3, v4
    v_lshlrev_b32 v2, 4, v1
    s_and_b32 s8, s2, 7
    s_lshr_b32 s9, s2, 3
    s_lshl2_add_u32 s96, s8, s3
    s_lshl_b32 s15, s96, 6
    s_mul_i32 s96, s15, 6144
    s_xor_b32 s97, s9, 1
    s_lshl_b32 s98, s97, 7
    s_add_u32 s13, s96, s98
    v_lshrrev_b32 v60, 3, v1
    v_mul_u32_u24 v60, 49152, v60
    v_and_b32 v9, 7, v1
    v_lshl_add_u32 v60, v9, 4, v60
    v_lshrrev_b32 v61, 3, v1
    v_lshl_add_u32 v61, v61, 3, s15
    s_lshl_b32 s96, s8, 5
    s_add_u32 s97, s96, s9
    s_lshl2_add_u32 s98, s97, s3
    s_sub_u32 s99, s98, 4
    s_lshl_b32 s16, s99, 12
    s_mov_b32 s50, 12582912
    s_mov_b32 s51, 0x20000
    s_mov_b32 s38, 4194304
    s_mov_b32 s39, 0x20000
    s_mov_b32 s34, 268435456
    s_mov_b32 s35, 0x20000
    s_getreg_b32 s94, hwreg(HW_REG_XCC_ID, 0, 3)
    s_getpc_b64 s[22:23]
    s_mul_i32 s96, s9, 7
    s_add_u32 s97, s96, s3
    s_lshl_b32 s19, s97, 7
    v_lshrrev_b32 v10, 5, v1
    v_mul_u32_u24 v10, 28672, v10
    v_add_u32 v10, s19, v10
    v_min_u32 v10, 44032, v10
    s_cmp_ge_u32 s3, 4
    s_waitcnt lgkmcnt(0)
    s_mov_b64 s[48:49], s[88:89]
    s_mov_b64 s[36:37], s[68:69]
    s_load_dword s4, s[32:33], 0
    s_cbranch_scc1 L_FS
    global_load_dwordx2 v[96:97], v61, s[86:87]
    buffer_load_dwordx4 v[80:83], v60, s[48:51], s13 offen nt
    s_add_u32 s13, s13, 12288
    buffer_load_dwordx4 v[84:87], v60, s[48:51], s13 offen nt
    s_add_u32 s13, s13, 12288
    buffer_load_dwordx4 v[88:91], v60, s[48:51], s13 offen nt
    s_add_u32 s13, s13, 12288
    buffer_load_dwordx4 v[92:95], v60, s[48:51], s13 offen nt
    s_barrier
    s_barrier
    s_and_b32 s22, s22, 0xfffffc00
    global_load_dword v78, v10, s[22:23]
    s_mov_b32 s42, 6291456
    s_mov_b32 s43, 0x20000
    s_mov_b32 s46, 2097152
    s_mov_b32 s47, 0x20000
    s_mov_b32 s54, 7340032
    s_mov_b32 s55, 0x20000
    s_mov_b32 s58, 7340032
    s_mov_b32 s59, 0x20000
    s_mov_b32 s62, 7340032
    s_mov_b32 s63, 0x20000
    s_mov_b32 s66, 4194304
    s_mov_b32 s67, 0x20000
    s_mov_b64 s[40:41], s[70:71]
    s_mov_b64 s[44:45], s[74:75]
    s_mov_b64 s[52:53], s[80:81]
    s_mov_b64 s[56:57], s[82:83]
    s_mov_b64 s[60:61], s[84:85]
    s_mov_b64 s[64:65], s[90:91]
    s_mov_b32 s5, 0
    s_mov_b32 s6, 0xffff0000
    s_mov_b32 s7, 0x3fb8aa3b
    s_lshr_b32 s76, s3, 2
    v_bfe_u32 v6, v1, 4, 1
    v_lshlrev_b32 v6, 6, v6
    v_and_b32 v62, 7, v1
    v_lshlrev_b32 v62, 4, v62
    v_xor_b32 v62, v62, v6
    v_lshrrev_b32 v6, 3, v1
    v_mul_u32_u24 v6, 6144, v6
    v_add_u32 v62, v62, v6
    v_lshlrev_b32 v63, 3, v1
    v_add_u32 v64, 149760, v2
    s_and_b32 s96, s3, 3
    s_lshl2_add_u32 s13, s96, 149760
    v_lshrrev_b32 v65, 4, v1
    v_lshl_add_u32 v65, v65, 5, s13
    v_and_b32 v9, 7, v1
    v_lshl_add_u32 v65, v9, 7, v65
    v_bfe_u32 v9, v1, 3, 1
    v_lshl_add_u32 v65, v9, 4, v65
    s_and_b32 s96, s8, 6
    s_and_b32 s97, s8, 1
    s_lshr_b32 s98, s9, 4
    s_lshl1_add_u32 s99, s97, s98
    s_lshl_b32 s97, s99, 6
    s_add_u32 s98, s96, s97
    s_lshl3_add_u32 s99, s3, s98
    s_lshl_b32 s96, s99, 10
    s_and_b32 s97, s9, 15
    s_lshl_b32 s98, s97, 6
    s_add_u32 s99, s96, s98
    s_add_u32 s14, s99, 262144
    s_xor_b32 s96, s9, 1
    s_and_b32 s97, s96, 15
    s_lshl4_add_u32 s98, s3, s97
    s_lshr_b32 s99, s9, 4
    s_lshl1_add_u32 s96, s98, s99
    s_lshl3_add_u32 s97, s96, s8
    s_lshl_b32 s98, s97, 9
    s_add_u32 s13, s98, 524288
    s_lshr_b32 s96, s9, 4
    s_xor_b32 s97, s9, 1
    s_and_b32 s98, s97, 7
    s_lshl_b32 s99, s3, 1
    s_lshl3_add_u32 s97, s98, s99
    s_bfe_u32 s98, s9, 65539
    s_add_u32 s99, s97, s98
    s_lshl_b32 s97, s99, 9
    s_lshl_b32 s98, s8, 6
    s_add_u32 s99, s97, s98
    s_lshl2_add_u32 s97, s96, s99
    s_add_u32 s15, s97, 2097152
    v_and_b32 v10, 3, v1
    v_lshlrev_b32 v10, 15, v10
    s_waitcnt vmcnt(5)
    v_lshlrev_b32 v98, 16, v97
    v_and_b32 v99, s6, v97
    v_and_b32 v97, s6, v96
    v_lshlrev_b32 v96, 16, v96
    v_mul_f32 v4, s7, v96
    v_exp_f32 v4, -v4
    s_nop 0
    v_add_f32 v4, 1.0, v4
    v_rcp_f32 v4, v4
    s_nop 0
    v_mul_f32 v96, v96, v4
    v_cvt_pk_bf16_f32 v96, 0, v96
    v_mul_f32 v5, s7, v97
    v_exp_f32 v5, -v5
    s_nop 0
    v_add_f32 v5, 1.0, v5
    v_rcp_f32 v5, v5
    s_nop 0
    v_mul_f32 v97, v97, v5
    v_cvt_pk_bf16_f32 v97, 0, v97
    v_mul_f32 v4, s7, v98
    v_exp_f32 v4, -v4
    s_nop 0
    v_add_f32 v4, 1.0, v4
    v_rcp_f32 v4, v4
    s_nop 0
    v_mul_f32 v98, v98, v4
    v_cvt_pk_bf16_f32 v98, 0, v98
    v_mul_f32 v5, s7, v99
    v_exp_f32 v5, -v5
    s_nop 0
    v_add_f32 v5, 1.0, v5
    v_rcp_f32 v5, v5
    s_nop 0
    v_mul_f32 v99, v99, v5
    v_cvt_pk_bf16_f32 v99, 0, v99
    s_waitcnt vmcnt(4)
    v_lshlrev_b32 v4, 16, v80
    v_and_b32 v5, s6, v80
    v_pk_mul_f32 v[20:21], v[4:5], v[96:97] op_sel:[0,0] op_sel_hi:[1,0]
    v_lshlrev_b32 v6, 16, v81
    v_and_b32 v7, s6, v81
    v_pk_mul_f32 v[22:23], v[6:7], v[96:97] op_sel:[0,0] op_sel_hi:[1,0]
    v_lshlrev_b32 v4, 16, v82
    v_and_b32 v5, s6, v82
    v_pk_mul_f32 v[24:25], v[4:5], v[96:97] op_sel:[0,0] op_sel_hi:[1,0]
    v_lshlrev_b32 v6, 16, v83
    v_and_b32 v7, s6, v83
    v_pk_mul_f32 v[26:27], v[6:7], v[96:97] op_sel:[0,0] op_sel_hi:[1,0]
    s_waitcnt vmcnt(3)
    v_lshlrev_b32 v4, 16, v84
    v_and_b32 v5, s6, v84
    v_pk_fma_f32 v[20:21], v[4:5], v[96:97], v[20:21] op_sel:[0,1,0] op_sel_hi:[1,1,1]
    v_lshlrev_b32 v6, 16, v85
    v_and_b32 v7, s6, v85
    v_pk_fma_f32 v[22:23], v[6:7], v[96:97], v[22:23] op_sel:[0,1,0] op_sel_hi:[1,1,1]
    v_lshlrev_b32 v4, 16, v86
    v_and_b32 v5, s6, v86
    v_pk_fma_f32 v[24:25], v[4:5], v[96:97], v[24:25] op_sel:[0,1,0] op_sel_hi:[1,1,1]
    v_lshlrev_b32 v6, 16, v87
    v_and_b32 v7, s6, v87
    v_pk_fma_f32 v[26:27], v[6:7], v[96:97], v[26:27] op_sel:[0,1,0] op_sel_hi:[1,1,1]
    s_waitcnt vmcnt(2)
    v_lshlrev_b32 v4, 16, v88
    v_and_b32 v5, s6, v88
    v_pk_fma_f32 v[20:21], v[4:5], v[98:99], v[20:21] op_sel:[0,0,0] op_sel_hi:[1,0,1]
    v_lshlrev_b32 v6, 16, v89
    v_and_b32 v7, s6, v89
    v_pk_fma_f32 v[22:23], v[6:7], v[98:99], v[22:23] op_sel:[0,0,0] op_sel_hi:[1,0,1]
    v_lshlrev_b32 v4, 16, v90
    v_and_b32 v5, s6, v90
    v_pk_fma_f32 v[24:25], v[4:5], v[98:99], v[24:25] op_sel:[0,0,0] op_sel_hi:[1,0,1]
    v_lshlrev_b32 v6, 16, v91
    v_and_b32 v7, s6, v91
    v_pk_fma_f32 v[26:27], v[6:7], v[98:99], v[26:27] op_sel:[0,0,0] op_sel_hi:[1,0,1]
    s_waitcnt vmcnt(1)
    v_lshlrev_b32 v4, 16, v92
    v_and_b32 v5, s6, v92
    v_pk_fma_f32 v[20:21], v[4:5], v[98:99], v[20:21] op_sel:[0,1,0] op_sel_hi:[1,1,1]
    v_lshlrev_b32 v6, 16, v93
    v_and_b32 v7, s6, v93
    v_pk_fma_f32 v[22:23], v[6:7], v[98:99], v[22:23] op_sel:[0,1,0] op_sel_hi:[1,1,1]
    v_lshlrev_b32 v4, 16, v94
    v_and_b32 v5, s6, v94
    v_pk_fma_f32 v[24:25], v[4:5], v[98:99], v[24:25] op_sel:[0,1,0] op_sel_hi:[1,1,1]
    v_lshlrev_b32 v6, 16, v95
    v_and_b32 v7, s6, v95
    v_pk_fma_f32 v[26:27], v[6:7], v[98:99], v[26:27] op_sel:[0,1,0] op_sel_hi:[1,1,1]
    v_permlane32_swap_b32 v20, v24
    v_permlane32_swap_b32 v21, v25
    v_permlane32_swap_b32 v22, v26
    v_permlane32_swap_b32 v23, v27
    v_add_f32 v20, v20, v24
    v_add_f32 v21, v21, v25
    v_add_f32 v22, v22, v26
    v_add_f32 v23, v23, v27
    s_nop 0
    v_permlane16_swap_b32 v20, v22
    v_permlane16_swap_b32 v21, v23
    v_add_f32 v20, v20, v22
    v_add_f32 v21, v21, v23
    s_nop 0
    v_add_f32_dpp v20, v20, v20 row_ror:8 row_mask:0xf bank_mask:0xf
    v_add_f32_dpp v21, v21, v21 row_ror:8 row_mask:0xf bank_mask:0xf
    s_nop 1
    v_mov_b32_dpp v20, v21 quad_perm:[0,1,2,3] row_mask:0xf bank_mask:0xc
    ds_write_b32 v65, v20
    s_waitcnt lgkmcnt(0)
    s_barrier
    ds_read_b128 v[20:23], v64 offset:0
    s_mul_i32 s4, s4, 0x9e3779b1
    s_add_u32 s4, s4, 0x7f4a7c15
    s_waitcnt lgkmcnt(0)
    v_pk_add_f32 v[20:21], v[20:21], v[22:23]
    v_add_f32 v20, v20, v21
    v_mov_b32 v21, s4
    buffer_store_dwordx2 v[20:21], v63, s[32:35], s13 offen sc1
    s_mov_b64 exec, 15
    buffer_store_dword v21, v10, s[32:35], s15 offen sc1
    s_mov_b64 exec, -1
    s_lshl2_add_u32 s96, s2, s3
    s_mul_i32 s13, s96, 6144
    s_branch L_FJ
L_FS:
    s_barrier
    buffer_load_dwordx4 v[80:83], v2, s[36:39], s16 offen
    buffer_load_dwordx4 v[84:87], v2, s[36:39], s16 offen offset:1024
    buffer_load_dwordx4 v[88:91], v2, s[36:39], s16 offen offset:2048
    buffer_load_dwordx4 v[92:95], v2, s[36:39], s16 offen offset:3072
    s_lshl2_add_u32 s96, s2, s3
    s_sub_u32 s97, s96, 4
    s_lshl_b32 s98, s97, 7
    s_add_u32 s17, s98, 2097152
    s_load_dword s24, s[32:33], s17 offset:0 glc
    s_load_dword s25, s[32:33], s17 offset:64 glc
    s_lshl_b32 s96, s2, 5
    s_add_u32 s97, s96, s3
    s_sub_u32 s98, s97, 4
    s_lshl_b32 s99, s98, 7
    s_add_u32 s17, s99, 1048576
    s_load_dword s24, s[32:33], s17 offset:0 glc
    s_load_dword s25, s[32:33], s17 offset:64 glc
    s_lshl_b32 s19, s94, 5
    v_mov_b32 v78, 1
    v_mov_b32 v79, s19
    s_barrier
    s_cmp_lg_u32 s3, 7
    s_cbranch_scc1 L_NOTK
    s_mov_b64 exec, 1
    global_atomic_add v78, v79, v78, s[30:31] sc0 sc1
    s_mov_b64 exec, -1
    s_branch L_TK0
L_NOTK:
    s_and_b32 s22, s22, 0xfffffc00
    global_load_dword v78, v10, s[22:23]
L_TK0:
    s_mov_b32 s42, 6291456
    s_mov_b32 s43, 0x20000
    s_mov_b32 s46, 2097152
    s_mov_b32 s47, 0x20000
    s_mov_b32 s54, 7340032
    s_mov_b32 s55, 0x20000
    s_mov_b32 s58, 7340032
    s_mov_b32 s59, 0x20000
    s_mov_b32 s62, 7340032
    s_mov_b32 s63, 0x20000
    s_mov_b32 s66, 4194304
    s_mov_b32 s67, 0x20000
    s_mov_b64 s[40:41], s[70:71]
    s_mov_b64 s[44:45], s[74:75]
    s_mov_b64 s[52:53], s[80:81]
    s_mov_b64 s[56:57], s[82:83]
    s_mov_b64 s[60:61], s[84:85]
    s_mov_b64 s[64:65], s[90:91]
    s_mov_b32 s5, 0
    s_mov_b32 s6, 0xffff0000
    s_mov_b32 s7, 0x3fb8aa3b
    s_lshr_b32 s76, s3, 2
    v_bfe_u32 v6, v1, 4, 1
    v_lshlrev_b32 v6, 6, v6
    v_and_b32 v62, 7, v1
    v_lshlrev_b32 v62, 4, v62
    v_xor_b32 v62, v62, v6
    v_lshrrev_b32 v6, 3, v1
    v_mul_u32_u24 v6, 6144, v6
    v_add_u32 v62, v62, v6
    v_lshlrev_b32 v63, 3, v1
    v_add_u32 v64, 149760, v2
    s_and_b32 s96, s3, 3
    s_lshl2_add_u32 s13, s96, 149760
    v_lshrrev_b32 v65, 4, v1
    v_lshl_add_u32 v65, v65, 5, s13
    v_and_b32 v9, 7, v1
    v_lshl_add_u32 v65, v9, 7, v65
    v_bfe_u32 v9, v1, 3, 1
    v_lshl_add_u32 v65, v9, 4, v65
    s_and_b32 s96, s8, 6
    s_and_b32 s97, s8, 1
    s_lshr_b32 s98, s9, 4
    s_lshl1_add_u32 s99, s97, s98
    s_lshl_b32 s97, s99, 6
    s_add_u32 s98, s96, s97
    s_lshl3_add_u32 s99, s3, s98
    s_lshl_b32 s96, s99, 10
    s_and_b32 s97, s9, 15
    s_lshl_b32 s98, s97, 6
    s_add_u32 s99, s96, s98
    s_add_u32 s14, s99, 262144
    s_sub_u32 s96, s3, 4
    s_lshl4_add_u32 s13, s96, 151808
    v_lshrrev_b32 v10, 5, v1
    v_lshl_add_u32 v10, v10, 3, s13
    s_barrier
    s_waitcnt vmcnt(1)
    s_waitcnt lgkmcnt(0)
    s_mul_i32 s4, s4, 0x9e3779b1
    s_add_u32 s4, s4, 0x7f4a7c15
    v_mov_b32 v104, 0x3f803f80
    v_dot2_f32_bf16 v100, v80, v104, 0
    v_dot2_f32_bf16 v102, v80, v80, 0
    v_dot2_f32_bf16 v101, v88, v104, 0
    v_dot2_f32_bf16 v103, v88, v88, 0
    v_dot2_f32_bf16 v100, v81, v104, v100
    v_dot2_f32_bf16 v102, v81, v81, v102
    v_dot2_f32_bf16 v101, v89, v104, v101
    v_dot2_f32_bf16 v103, v89, v89, v103
    v_dot2_f32_bf16 v100, v82, v104, v100
    v_dot2_f32_bf16 v102, v82, v82, v102
    v_dot2_f32_bf16 v101, v90, v104, v101
    v_dot2_f32_bf16 v103, v90, v90, v103
    v_dot2_f32_bf16 v100, v83, v104, v100
    v_dot2_f32_bf16 v102, v83, v83, v102
    v_dot2_f32_bf16 v101, v91, v104, v101
    v_dot2_f32_bf16 v103, v91, v91, v103
    v_dot2_f32_bf16 v100, v84, v104, v100
    v_dot2_f32_bf16 v102, v84, v84, v102
    v_dot2_f32_bf16 v101, v92, v104, v101
    v_dot2_f32_bf16 v103, v92, v92, v103
    v_dot2_f32_bf16 v100, v85, v104, v100
    v_dot2_f32_bf16 v102, v85, v85, v102
    v_dot2_f32_bf16 v101, v93, v104, v101
    v_dot2_f32_bf16 v103, v93, v93, v103
    v_dot2_f32_bf16 v100, v86, v104, v100
    v_dot2_f32_bf16 v102, v86, v86, v102
    v_dot2_f32_bf16 v101, v94, v104, v101
    v_dot2_f32_bf16 v103, v94, v94, v103
    v_dot2_f32_bf16 v100, v87, v104, v100
    v_dot2_f32_bf16 v102, v87, v87, v102
    v_dot2_f32_bf16 v101, v95, v104, v101
    v_dot2_f32_bf16 v103, v95, v95, v103
    s_nop 1
    v_permlane32_swap_b32 v100, v101
    v_permlane32_swap_b32 v102, v103
    v_add_f32 v100, v100, v101
    v_add_f32 v102, v102, v103
    s_nop 1
    v_permlane16_swap_b32 v100, v102
    v_add_f32 v100, v100, v102
    s_nop 1
    v_add_f32_dpp v100, v100, v100 quad_perm:[1,0,3,2] row_mask:0xf bank_mask:0xf
    s_nop 1
    v_add_f32_dpp v100, v100, v100 quad_perm:[2,3,0,1] row_mask:0xf bank_mask:0xf
    s_nop 1
    v_add_f32_dpp v100, v100, v100 row_half_mirror row_mask:0xf bank_mask:0xf
    s_nop 1
    v_add_f32_dpp v100, v100, v100 row_ror:8 row_mask:0xf bank_mask:0xf
    v_mul_f32 v102, 0x3a800000, v100
    v_mul_f32 v100, 0x3a800000, v100
    s_nop 1
    v_permlane16_swap_b32 v100, v102
    v_fma_f32 v117, -v100, v100, v102
    v_cvt_pk_bf16_f32 v116, 0, v100
    v_max_f32 v117, 0, v117
    v_cvt_pk_bf16_f32 v117, 0, v117
    v_add_f32 v117, 0x3727c5ac, v117
    v_cvt_pk_bf16_f32 v117, 0, v117
    v_sqrt_f32 v117, v117
    s_nop 0
    v_cvt_pk_bf16_f32 v117, 0, v117
    v_lshrrev_b32 v116, 16, v116
    v_or_b32 v116, v116, v117
    v_mov_b32 v117, s4
    ds_write_b64 v10, v[116:117]
L_FJ:
    v_and_b32 v5, 3, v1
    v_lshlrev_b32 v5, 4, v5
    v_add_u32 v5, 151808, v5
    v_and_b32 v4, 3, v1
    v_lshlrev_b32 v4, 4, v4
    v_bfe_u32 v9, v1, 2, 1
    v_lshl_add_u32 v4, v9, 10, v4
    v_and_b32 v10, 31, v1
    v_lshlrev_b32 v10, 11, v10
    v_lshrrev_b32 v9, 5, v1
    v_lshl_add_u32 v10, v9, 5, v10
    v_and_b32 v6, 1, v1
    v_lshlrev_b32 v6, 9, v6
    v_bfe_u32 v9, v1, 1, 1
    v_lshl_add_u32 v6, v9, 8, v6
    s_and_b32 s96, s9, 3
    s_and_b32 s97, s8, 6
    s_and_b32 s98, s8, 1
    s_lshr_b32 s99, s9, 4
    s_lshl1_add_u32 s98, s98, s99
    s_lshl_b32 s99, s98, 6
    s_add_u32 s98, s97, s99
    s_lshl3_add_u32 s97, s3, s98
    s_lshl_b32 s99, s97, 9
    s_bfe_u32 s98, s9, 131074
    s_lshl_b32 s97, s98, 6
    s_add_u32 s98, s99, s97
    s_lshl2_add_u32 s99, s96, s98
    s_add_u32 s97, s99, 16
    s_add_u32 s15, s97, 2097152
    s_waitcnt lgkmcnt(0)
    s_barrier
    ds_read_b128 v[116:119], v5
    s_waitcnt lgkmcnt(0)
    s_mov_b64 exec, 0xff
    buffer_store_dwordx4 v[116:119], v4, s[32:35], s14 offen sc1
    s_mov_b64 exec, 15
    buffer_store_dword v117, v6, s[32:35], s15 offen sc1
    s_mov_b64 exec, -1
    s_cmp_lg_u32 s3, 7
    s_cbranch_scc1 L_NOTK2
    s_mov_b32 s13, 0
    s_waitcnt vmcnt(2)
L_TK:
    v_readfirstlane_b32 s15, v78
    s_nop 0
    s_cmp_lt_u32 s15, 32
    s_cbranch_scc1 L_TKOK
    v_mov_b32 v78, s4
    s_mov_b64 exec, 1
    buffer_store_dword v78, v3, s[32:35], 0 offen offset:256 sc1
    s_mov_b64 exec, -1
    s_add_u32 s13, s13, 1
    s_cmp_lt_u32 s13, 8
    s_cbranch_scc0 L_TKNO
    s_add_u32 s94, s94, 1
    s_and_b32 s94, s94, 7
    s_lshl_b32 s19, s94, 5
    v_mov_b32 v78, 1
    v_mov_b32 v79, s19
    s_mov_b64 exec, 1
    global_atomic_add v78, v79, v78, s[30:31] sc0 sc1
    s_mov_b64 exec, -1
    s_waitcnt vmcnt(0)
    s_branch L_TK
L_TKNO:
    s_and_b32 s94, s2, 7
    s_lshr_b32 s15, s2, 3
L_TKOK:
    s_lshl3_add_u32 s15, s15, s94
    v_mov_b32 v78, s15
    ds_write_b32 v5, v78 offset:64
L_NOTK2:
    s_waitcnt lgkmcnt(0)
    s_barrier
    ds_read_b32 v120, v5 offset:64
    s_waitcnt lgkmcnt(0)
    v_readfirstlane_b32 s2, v120
    s_nop 0
    s_and_b32 s8, s2, 7
    s_lshr_b32 s9, s2, 3
    s_and_b32 s96, s8, 1
    s_and_b32 s97, s9, 7
    s_lshl3_add_u32 s12, s96, s97
    s_lshr_b32 s96, s8, 1
    s_lshr_b32 s97, s9, 3
    s_lshl2_add_u32 s21, s96, s97
    s_and_b32 s96, s3, 3
    s_lshl2_add_u32 s94, s21, s96
    s_lshl1_add_u32 s95, s12, s76
    s_lshl_b32 s96, s94, 16
    s_lshl_b32 s97, s95, 6
    s_add_u32 s18, s96, s97
    buffer_load_dwordx4 v[12:15], v10, s[36:39], s18 offen
    buffer_load_dwordx4 v[16:19], v10, s[36:39], s18 offen offset:16
    s_lshr_b32 s96, s8, 1
    s_lshl4_add_u32 s97, s96, s12
    s_lshl4_add_u32 s98, s97, s3
    s_lshl_b32 s99, s98, 9
    s_add_u32 s13, s99, 524288
    s_lshl3_add_u32 s96, s2, s3
    s_lshl_b32 s97, s96, 6
    s_add_u32 s15, s97, 2097152
    s_and_b32 s96, s3, 3
    s_lshl2_add_u32 s97, s2, s96
    s_lshl_b32 s98, s97, 8
    s_add_u32 s14, s98, 262144
    s_load_dwordx8 s[24:31], s[32:33], s15 offset:0 glc
    s_and_b32 s10, s9, 15
    s_lshr_b32 s96, s8, 2
    s_and_b32 s97, s8, 1
    s_lshl1_add_u32 s98, s96, s97
    s_and_b32 s99, s8, 2
    s_lshl2_add_u32 s96, s98, s99
    s_lshr_b32 s97, s9, 4
    s_add_u32 s11, s96, s97
    s_and_b32 s85, s9, 12
    s_lshl_b32 s96, s2, 6
    s_add_u32 s97, s96, s3
    s_lshl_b32 s98, s97, 6
    s_add_u32 s92, s98, 1048576
    s_lshr_b32 s96, s9, 4
    s_xor_b32 s77, s76, s96
    s_lshr_b32 s96, s9, 3
    s_xor_b32 s97, s96, s9
    s_and_b32 s98, s97, 1
    s_lshl_b32 s83, s98, 2
    s_mul_i32 s96, s8, 7
    s_lshr_b32 s97, s9, 2
    s_add_u32 s74, s96, s97
    s_and_b32 s75, s9, 3
    v_and_b32 v8, 31, v1
    v_lshlrev_b32 v8, 3, v8
    v_and_b32 v4, 31, v1
    v_lshlrev_b32 v4, 4, v4
    v_lshrrev_b32 v9, 5, v1
    v_lshl_add_u32 v4, v9, 12, v4
    s_lshl2_add_u32 s16, s3, 152320
    v_lshl_add_u32 v5, v1, 6, s16
    s_lshl_b32 s96, s76, 10
    s_add_u32 s16, s96, 152320
    v_and_b32 v6, 15, v1
    v_lshl_add_u32 v6, v6, 5, s16
    v_lshrrev_b32 v9, 5, v1
    v_lshl_add_u32 v6, v9, 9, v6
    s_branch SCHK_2
SPOLL_1:
    s_load_dwordx8 s[24:31], s[32:33], s15 offset:0 glc
SCHK_2:
    s_add_u32 s5, s5, 1
    s_cmp_ge_u32 s5, 300000
    s_waitcnt lgkmcnt(0)
    s_cbranch_scc1 SDONE_3
    s_cmp_lg_u32 s24, s4
    s_cbranch_scc1 SPOLL_1
    s_cmp_lg_u32 s25, s4
    s_cbranch_scc1 SPOLL_1
    s_cmp_lg_u32 s28, s4
    s_cbranch_scc1 SPOLL_1
    s_cmp_lg_u32 s29, s4
    s_cbranch_scc1 SPOLL_1
    s_cmp_lg_u32 s30, s4
    s_cbranch_scc1 SPOLL_1
    s_cmp_lg_u32 s31, s4
    s_cbranch_scc1 SPOLL_1
SDONE_3:
    buffer_load_dwordx4 v[120:123], v4, s[32:35], s13 offen sc1
    buffer_load_dwordx2 v[116:117], v8, s[32:35], s14 offen sc1
    s_barrier
    s_lshl_b32 s96, s11, 12
    s_lshl_b32 s97, s3, 9
    s_add_u32 s16, s96, s97
    v_add_u32 v10, s16, v2
    s_lshl_b32 s96, s3, 9
    s_add_u32 m0, s96, 156416
    s_mov_b32 exec_hi, 0
    global_load_lds_dwordx4 v10, s[72:73]
    s_mov_b32 exec_hi, -1
    s_and_b32 s20, s9, 3
    s_add_u32 s96, s20, s85
    s_and_b32 s97, s96, 15
    s_lshl3_add_u32 s98, s97, s3
    s_mul_i32 s99, s98, 49152
    s_lshl_b32 s96, s11, 7
    s_add_u32 s82, s99, s96
    s_mul_i32 s96, s20, 24960
    s_lshr_b32 s97, s3, 1
    s_mul_i32 s98, s97, 2080
    s_add_u32 s99, s96, s98
    s_and_b32 s97, s3, 1
    s_mul_i32 s96, s97, 1056
    s_add_u32 s20, s99, s96
    s_mov_b32 m0, s20
    s_nop 0
    buffer_load_dwordx4 v62, s[40:43], s82 offen lds
    s_add_u32 s82, s82, 2048
    s_add_u32 m0, s20, 8320
    s_nop 0
    buffer_load_dwordx4 v62, s[40:43], s82 offen lds
    s_add_u32 s82, s82, 2048
    s_add_u32 m0, s20, 16640
    s_nop 0
    buffer_load_dwordx4 v62, s[40:43], s82 offen lds
    s_waitcnt vmcnt(5)
    v_bitop3_b32 v7, v121, v123, s4 bitop3:0x7e
    v_cmp_ne_u32 vcc, 0, v7
    s_cbranch_vccz TOK_5
POLL_6:
    buffer_load_dwordx4 v[120:123], v4, s[32:35], s13 offen sc1
    s_waitcnt vmcnt(0)
    v_bitop3_b32 v7, v121, v123, s4 bitop3:0x7e
    v_cmp_ne_u32 vcc, 0, v7
    s_cbranch_vccz PDONE_7
    s_add_u32 s5, s5, 1
    s_cmp_lt_u32 s5, 300000
    s_cbranch_scc1 POLL_6
PDONE_7:
TOK_5:
    ds_write2_b32 v5, v120, v122 offset0:0 offset1:8
    v_lshlrev_b32 v100, 16, v12
    v_and_b32 v101, s6, v12
    v_lshlrev_b32 v102, 16, v13
    v_and_b32 v103, s6, v13
    v_lshlrev_b32 v104, 16, v14
    v_and_b32 v105, s6, v14
    v_lshlrev_b32 v106, 16, v15
    v_and_b32 v107, s6, v15
    v_lshlrev_b32 v108, 16, v16
    v_and_b32 v109, s6, v16
    v_lshlrev_b32 v110, 16, v17
    v_and_b32 v111, s6, v17
    v_lshlrev_b32 v112, 16, v18
    v_and_b32 v113, s6, v18
    v_lshlrev_b32 v114, 16, v19
    v_and_b32 v115, s6, v19
    s_waitcnt lgkmcnt(0)
    s_barrier
    ds_read_b128 v[88:91], v6 offset:2048
    ds_read_b128 v[92:95], v6 offset:2064
    ds_read_b128 v[80:83], v6
    ds_read_b128 v[84:87], v6 offset:16
    s_waitcnt vmcnt(4)
    v_cmp_ne_u32 vcc, s4, v117
    s_cbranch_vccz TOK_8
POLL_9:
    buffer_load_dwordx2 v[116:117], v8, s[32:35], s14 offen sc1
    s_waitcnt vmcnt(0)
    v_cmp_ne_u32 vcc, s4, v117
    s_cbranch_vccz PDONE_10
    s_add_u32 s5, s5, 1
    s_cmp_lt_u32 s5, 300000
    s_cbranch_scc1 POLL_9
PDONE_10:
TOK_8:
    v_lshlrev_b32 v117, 16, v116
    v_and_b32 v116, s6, v116
    v_rcp_f32 v116, v116
    s_nop 0
    v_pk_add_f32 v[100:101], v[100:101], v[116:117] op_sel:[0,1] neg_lo:[0,1] neg_hi:[0,1]
    v_pk_add_f32 v[102:103], v[102:103], v[116:117] op_sel:[0,1] neg_lo:[0,1] neg_hi:[0,1]
    v_pk_add_f32 v[104:105], v[104:105], v[116:117] op_sel:[0,1] neg_lo:[0,1] neg_hi:[0,1]
    v_pk_add_f32 v[106:107], v[106:107], v[116:117] op_sel:[0,1] neg_lo:[0,1] neg_hi:[0,1]
    v_pk_add_f32 v[108:109], v[108:109], v[116:117] op_sel:[0,1] neg_lo:[0,1] neg_hi:[0,1]
    v_pk_add_f32 v[110:111], v[110:111], v[116:117] op_sel:[0,1] neg_lo:[0,1] neg_hi:[0,1]
    v_pk_add_f32 v[112:113], v[112:113], v[116:117] op_sel:[0,1] neg_lo:[0,1] neg_hi:[0,1]
    v_pk_add_f32 v[114:115], v[114:115], v[116:117] op_sel:[0,1] neg_lo:[0,1] neg_hi:[0,1]
    s_lshl4_add_u32 s96, s21, s12
    s_and_b32 s97, s3, 3
    s_lshl2_add_u32 s98, s96, s97
    s_lshl1_add_u32 s99, s98, s76
    s_lshl_b32 s96, s99, 11
    s_add_u32 s13, s96, 4194304
    v_and_b32 v8, 15, v1
    v_lshlrev_b32 v8, 4, v8
    v_bfe_u32 v9, v1, 4, 1
    v_lshl_add_u32 v8, v9, 10, v8
    v_lshrrev_b32 v9, 5, v1
    v_lshl_add_u32 v8, v9, 9, v8
    s_waitcnt lgkmcnt(2)
    v_pk_add_f32 v[88:89], v[88:89], v[90:91]
    v_pk_add_f32 v[92:93], v[92:93], v[94:95]
    v_pk_add_f32 v[88:89], v[88:89], v[92:93]
    v_add_f32 v88, v88, v89
    v_cvt_pk_bf16_f32 v88, 0, v88
    s_waitcnt lgkmcnt(0)
    v_pk_add_f32 v[80:81], v[80:81], v[82:83]
    v_pk_add_f32 v[84:85], v[84:85], v[86:87]
    v_pk_add_f32 v[80:81], v[80:81], v[84:85]
    v_add_f32 v80, v80, v81
    v_add_f32 v88, 1.0, v88
    v_cvt_pk_bf16_f32 v88, 0, v88
    v_cvt_pk_bf16_f32 v80, 0, v80
    s_lshl_b32 s96, s3, 8
    s_add_u32 s16, s96, 160512
    v_and_b32 v4, 15, v1
    v_lshl_add_u32 v4, v4, 2, s16
    v_lshrrev_b32 v9, 5, v1
    v_lshl_add_u32 v4, v9, 6, v4
    v_lshrrev_b32 v5, 5, v1
    v_lshl_add_u32 v5, v5, 6, s16
    ds_write2_b32 v4, v88, v80 offset0:0 offset1:32
    ds_read_b128 v[132:135], v5
    ds_read_b128 v[136:139], v5 offset:16
    ds_read_b128 v[140:143], v5 offset:32
    ds_read_b128 v[144:147], v5 offset:48
    ds_read_b128 v[148:151], v5 offset:128
    ds_read_b128 v[152:155], v5 offset:144
    ds_read_b128 v[156:159], v5 offset:160
    ds_read_b128 v[160:163], v5 offset:176
    v_cvt_pk_bf16_f32 v100, 0, v100
    v_cvt_pk_bf16_f32 v101, 0, v101
    v_cvt_pk_bf16_f32 v102, 0, v102
    v_cvt_pk_bf16_f32 v103, 0, v103
    v_cvt_pk_bf16_f32 v104, 0, v104
    v_cvt_pk_bf16_f32 v105, 0, v105
    v_cvt_pk_bf16_f32 v106, 0, v106
    v_cvt_pk_bf16_f32 v107, 0, v107
    v_pk_mul_f32 v[100:101], v[100:101], v[116:117] op_sel_hi:[1,0]
    v_pk_mul_f32 v[102:103], v[102:103], v[116:117] op_sel_hi:[1,0]
    v_pk_mul_f32 v[104:105], v[104:105], v[116:117] op_sel_hi:[1,0]
    v_pk_mul_f32 v[106:107], v[106:107], v[116:117] op_sel_hi:[1,0]
    v_cvt_pk_bf16_f32 v100, 0, v100
    v_cvt_pk_bf16_f32 v101, 0, v101
    v_cvt_pk_bf16_f32 v102, 0, v102
    v_cvt_pk_bf16_f32 v103, 0, v103
    v_cvt_pk_bf16_f32 v104, 0, v104
    v_cvt_pk_bf16_f32 v105, 0, v105
    v_cvt_pk_bf16_f32 v106, 0, v106
    v_cvt_pk_bf16_f32 v107, 0, v107
    v_cvt_pk_bf16_f32 v108, 0, v108
    v_cvt_pk_bf16_f32 v109, 0, v109
    v_cvt_pk_bf16_f32 v110, 0, v110
    v_cvt_pk_bf16_f32 v111, 0, v111
    v_cvt_pk_bf16_f32 v112, 0, v112
    v_cvt_pk_bf16_f32 v113, 0, v113
    v_cvt_pk_bf16_f32 v114, 0, v114
    v_cvt_pk_bf16_f32 v115, 0, v115
    v_pk_mul_f32 v[108:109], v[108:109], v[116:117] op_sel_hi:[1,0]
    v_pk_mul_f32 v[110:111], v[110:111], v[116:117] op_sel_hi:[1,0]
    v_pk_mul_f32 v[112:113], v[112:113], v[116:117] op_sel_hi:[1,0]
    v_pk_mul_f32 v[114:115], v[114:115], v[116:117] op_sel_hi:[1,0]
    v_cvt_pk_bf16_f32 v108, 0, v108
    v_cvt_pk_bf16_f32 v109, 0, v109
    v_cvt_pk_bf16_f32 v110, 0, v110
    v_cvt_pk_bf16_f32 v111, 0, v111
    v_cvt_pk_bf16_f32 v112, 0, v112
    v_cvt_pk_bf16_f32 v113, 0, v113
    v_cvt_pk_bf16_f32 v114, 0, v114
    v_cvt_pk_bf16_f32 v115, 0, v115
    s_waitcnt lgkmcnt(6)
    v_pk_mul_f32 v[100:101], v[100:101], v[132:133]
    v_pk_mul_f32 v[102:103], v[102:103], v[134:135]
    v_pk_mul_f32 v[104:105], v[104:105], v[136:137]
    v_pk_mul_f32 v[106:107], v[106:107], v[138:139]
    v_cvt_pk_bf16_f32 v100, 0, v100
    v_cvt_pk_bf16_f32 v101, 0, v101
    v_cvt_pk_bf16_f32 v102, 0, v102
    v_cvt_pk_bf16_f32 v103, 0, v103
    v_cvt_pk_bf16_f32 v104, 0, v104
    v_cvt_pk_bf16_f32 v105, 0, v105
    v_cvt_pk_bf16_f32 v106, 0, v106
    v_cvt_pk_bf16_f32 v107, 0, v107
    s_waitcnt lgkmcnt(2)
    v_pk_add_f32 v[100:101], v[100:101], v[148:149]
    v_pk_add_f32 v[102:103], v[102:103], v[150:151]
    v_pk_add_f32 v[104:105], v[104:105], v[152:153]
    v_pk_add_f32 v[106:107], v[106:107], v[154:155]
    v_cvt_pk_bf16_f32 v124, v100, v101
    v_cvt_pk_bf16_f32 v125, v102, v103
    v_cvt_pk_bf16_f32 v126, v104, v105
    v_cvt_pk_bf16_f32 v127, v106, v107
    buffer_store_dwordx4 v[124:127], v8, s[32:35], s13 offen sc1
    v_pk_mul_f32 v[108:109], v[108:109], v[140:141]
    v_pk_mul_f32 v[110:111], v[110:111], v[142:143]
    v_pk_mul_f32 v[112:113], v[112:113], v[144:145]
    v_pk_mul_f32 v[114:115], v[114:115], v[146:147]
    v_cvt_pk_bf16_f32 v108, 0, v108
    v_cvt_pk_bf16_f32 v109, 0, v109
    v_cvt_pk_bf16_f32 v110, 0, v110
    v_cvt_pk_bf16_f32 v111, 0, v111
    v_cvt_pk_bf16_f32 v112, 0, v112
    v_cvt_pk_bf16_f32 v113, 0, v113
    v_cvt_pk_bf16_f32 v114, 0, v114
    v_cvt_pk_bf16_f32 v115, 0, v115
    s_waitcnt lgkmcnt(0)
    v_pk_add_f32 v[108:109], v[108:109], v[156:157]
    v_pk_add_f32 v[110:111], v[110:111], v[158:159]
    v_pk_add_f32 v[112:113], v[112:113], v[160:161]
    v_pk_add_f32 v[114:115], v[114:115], v[162:163]
    v_cvt_pk_bf16_f32 v128, v108, v109
    v_cvt_pk_bf16_f32 v129, v110, v111
    v_cvt_pk_bf16_f32 v130, v112, v113
    v_cvt_pk_bf16_f32 v131, v114, v115
    buffer_store_dwordx4 v[128:131], v8, s[32:35], s13 offen offset:256 sc1
    v_lshrrev_b32 v66, 5, v1
    v_mul_u32_u24 v66, 2080, v66
    v_bfe_u32 v9, v1, 2, 2
    v_lshl_add_u32 v66, v9, 7, v66
    v_bfe_u32 v9, v1, 3, 1
    v_lshl_add_u32 v66, v9, 6, v66
    v_and_b32 v9, 3, v1
    v_lshl_add_u32 v66, v9, 3, v66
    v_bfe_u32 v67, v1, 4, 1
    v_mul_u32_u24 v67, 1056, v67
    v_bfe_u32 v68, v1, 3, 1
    v_lshlrev_b32 v68, 7, v68
    v_add_u32 v66, v66, v67
    v_sub_u32 v67, v66, v68
    v_add_u32 v67, 64, v67
    v_add_u32 v68, 49920, v66
    v_add_u32 v69, 49920, v67
    v_add_u32 v70, 99840, v66
    v_add_u32 v71, 99840, v67
    s_lshl_b32 s96, s76, 11
    s_add_u32 s14, s96, 156416
    v_bfe_u32 v4, v1, 2, 2
    v_lshl_add_u32 v4, v4, 6, s14
    v_bfe_u32 v9, v1, 4, 1
    v_lshl_add_u32 v4, v9, 5, v4
    v_and_b32 v9, 3, v1
    v_lshl_add_u32 v4, v9, 3, v4
    v_lshrrev_b32 v9, 5, v1
    v_lshl_add_u32 v4, v9, 9, v4
    v_and_b32 v5, 7, v1
    v_lshlrev_b32 v5, 12, v5
    v_bfe_u32 v9, v1, 3, 1
    v_lshl_add_u32 v5, v9, 19, v5
    s_and_b32 s96, s12, 1
    s_lshl_b32 s97, s21, 15
    s_lshr_b32 s98, s12, 1
    s_lshl_b32 s99, s98, 6
    s_add_u32 s98, s97, s99
    s_lshl2_add_u32 s97, s96, s98
    s_add_u32 s13, s97, 1048576
    v_bfe_u32 v6, v1, 4, 1
    v_lshlrev_b32 v6, 6, v6
    v_lshrrev_b32 v9, 5, v1
    v_lshl_add_u32 v6, v9, 4, v6
    v_and_b32 v74, 7, v1
    v_lshlrev_b32 v74, 4, v74
    v_xor_b32 v74, v74, v6
    v_lshrrev_b32 v6, 3, v1
    v_lshlrev_b32 v6, 11, v6
    v_add_u32 v74, v74, v6
    s_and_b32 s96, s3, 2
    s_lshl_b32 s14, s96, 5
    v_bfe_u32 v6, v1, 4, 1
    v_lshl_add_u32 v6, v6, 5, s14
    v_and_b32 v72, 7, v1
    v_lshlrev_b32 v72, 4, v72
    v_xor_b32 v72, v72, v6
    v_lshrrev_b32 v6, 3, v1
    v_mul_u32_u24 v6, 7168, v6
    v_add_u32 v72, v72, v6
    s_and_b32 s96, s3, 1
    s_lshl_b32 s14, s96, 7
    v_lshrrev_b32 v6, 5, v1
    v_lshl_add_u32 v6, v6, 6, s14
    v_and_b32 v73, 31, v1
    v_lshlrev_b32 v73, 4, v73
    v_lshrrev_b32 v9, 5, v1
    v_lshl_add_u32 v73, v9, 11, v73
    v_xor_b32 v73, v73, v6
    s_lshl3_add_u32 s96, s75, s3
    s_mul_i32 s97, s96, 229376
    s_lshl_b32 s98, s74, 7
    s_add_u32 s80, s97, s98
    s_lshl3_add_u32 s96, s74, s3
    s_lshl_b32 s97, s96, 14
    s_lshl_b32 s98, s75, 9
    s_add_u32 s81, s97, s98
    s_cmp_ge_u32 s9, 28
    s_cselect_b32 s54, 0, s54
    s_cselect_b32 s58, 0, s58
    s_cselect_b32 s62, 0, s62
    s_waitcnt vmcnt(0)
    s_barrier
    s_cmp_lg_u32 s3, 0
    s_cbranch_scc1 L_PB
    v_mov_b32 v6, s4
    s_mov_b32 exec_hi, 0
    s_mov_b32 exec_lo, 65535
    buffer_store_dword v6, v5, s[32:35], s13 offen sc1
    s_mov_b64 exec, -1
L_PB:
    s_and_b32 s20, s9, 3
    s_cmp_le_u32 s20, 0
    s_cselect_b32 s20, 1, 0
    s_add_u32 s96, s20, s85
    s_and_b32 s97, s96, 15
    s_lshl3_add_u32 s98, s97, s3
    s_mul_i32 s99, s98, 49152
    s_lshl_b32 s96, s11, 7
    s_add_u32 s82, s99, s96
    s_mul_i32 s96, s20, 24960
    s_lshr_b32 s97, s3, 1
    s_mul_i32 s98, s97, 2080
    s_add_u32 s99, s96, s98
    s_and_b32 s97, s3, 1
    s_mul_i32 s96, s97, 1056
    s_add_u32 s20, s99, s96
    s_mov_b32 m0, s20
    s_nop 0
    buffer_load_dwordx4 v62, s[40:43], s82 offen lds
    s_add_u32 s82, s82, 2048
    s_add_u32 m0, s20, 8320
    s_nop 0
    buffer_load_dwordx4 v62, s[40:43], s82 offen lds
    s_add_u32 s82, s82, 2048
    s_add_u32 m0, s20, 16640
    s_nop 0
    buffer_load_dwordx4 v62, s[40:43], s82 offen lds
    s_and_b32 s20, s9, 3
    s_cmp_le_u32 s20, 1
    s_cselect_b32 s20, 2, 1
    s_add_u32 s96, s20, s85
    s_and_b32 s97, s96, 15
    s_lshl3_add_u32 s98, s97, s3
    s_mul_i32 s99, s98, 49152
    s_lshl_b32 s96, s11, 7
    s_add_u32 s82, s99, s96
    s_mul_i32 s96, s20, 24960
    s_lshr_b32 s97, s3, 1
    s_mul_i32 s98, s97, 2080
    s_add_u32 s99, s96, s98
    s_and_b32 s97, s3, 1
    s_mul_i32 s96, s97, 1056
    s_add_u32 s20, s99, s96
    s_mov_b32 m0, s20
    s_nop 0
    buffer_load_dwordx4 v62, s[40:43], s82 offen lds
    s_add_u32 s82, s82, 2048
    s_add_u32 m0, s20, 8320
    s_nop 0
    buffer_load_dwordx4 v62, s[40:43], s82 offen lds
    s_add_u32 s82, s82, 2048
    s_add_u32 m0, s20, 16640
    s_nop 0
    buffer_load_dwordx4 v62, s[40:43], s82 offen lds
    ds_read_b64_tr_b16 v[28:29], v4
    ds_read_b64_tr_b16 v[30:31], v4 offset:256
    ds_read_b64_tr_b16 v[32:33], v4 offset:1024
    ds_read_b64_tr_b16 v[34:35], v4 offset:1280
    s_lshl_b32 s96, s10, 6
    s_add_u32 s97, s96, s3
    s_lshl_b32 s98, s97, 12
    s_add_u32 s15, s98, 4194304
    s_and_b32 s96, s3, 3
    s_lshl_b32 s97, s96, 12
    s_add_u32 s13, s97, 147456
    v_add_u32 v76, s13, v2
    v_and_b32 v77, 15, v1
    v_lshl_add_u32 v77, v77, 4, s13
    v_lshrrev_b32 v9, 5, v1
    v_lshl_add_u32 v77, v9, 9, v77
    v_bfe_u32 v9, v1, 4, 1
    v_lshl_add_u32 v77, v9, 3, v77
    s_and_b32 s96, s3, 3
    s_lshl_b32 s97, s96, 10
    s_add_u32 s13, s97, 32768
    v_and_b32 v78, 15, v1
    v_lshl_add_u32 v78, v78, 5, s13
    v_lshrrev_b32 v9, 4, v1
    v_lshl_add_u32 v78, v9, 3, v78
    s_and_b32 s96, s3, 3
    s_lshl_b32 s97, s96, 10
    s_lshl_b32 s98, s76, 14
    s_add_u32 s13, s97, s98
    v_and_b32 v75, 31, v1
    v_lshl_add_u32 v75, v75, 5, s13
    v_lshrrev_b32 v9, 5, v1
    v_lshl_add_u32 v75, v9, 4, v75
    s_lshl_b32 s84, s3, 14
    s_lshr_b32 s96, s9, 4
    s_lshl_b32 s97, s96, 20
    s_lshl_b32 s98, s12, 7
    s_add_u32 s88, s97, s98
    s_lshl_b32 s89, s3, 10
    s_load_dwordx2 s[24:25], s[32:33], s92 offset:0 glc
    s_and_b32 s20, s9, 3
    s_cmp_le_u32 s20, 2
    s_cselect_b32 s20, 3, 2
    s_add_u32 s96, s20, s85
    s_and_b32 s97, s96, 15
    s_lshl3_add_u32 s98, s97, s3
    s_mul_i32 s99, s98, 49152
    s_lshl_b32 s96, s11, 7
    s_add_u32 s82, s99, s96
    s_mul_i32 s96, s20, 24960
    s_lshr_b32 s97, s3, 1
    s_mul_i32 s98, s97, 2080
    s_add_u32 s99, s96, s98
    s_and_b32 s97, s3, 1
    s_mul_i32 s96, s97, 1056
    s_add_u32 s20, s99, s96
    s_mov_b32 m0, s20
    s_nop 0
    buffer_load_dwordx4 v62, s[40:43], s82 offen lds
    s_add_u32 s82, s82, 2048
    s_add_u32 m0, s20, 8320
    s_nop 0
    buffer_load_dwordx4 v62, s[40:43], s82 offen lds
    s_add_u32 s82, s82, 2048
    s_add_u32 m0, s20, 16640
    s_nop 0
    buffer_load_dwordx4 v62, s[40:43], s82 offen lds
    s_add_u32 s96, s85, 4
    s_and_b32 s97, s96, 15
    s_lshl3_add_u32 s98, s97, s3
    s_mul_i32 s99, s98, 49152
    s_lshl_b32 s96, s11, 7
    s_add_u32 s82, s99, s96
    s_lshr_b32 s96, s3, 1
    s_mul_i32 s97, s96, 2080
    s_and_b32 s98, s3, 1
    s_mul_i32 s99, s98, 1056
    s_add_u32 s96, s97, s99
    s_add_u32 s20, s96, 99840
    s_mov_b32 m0, s20
    s_nop 0
    buffer_load_dwordx4 v62, s[40:43], s82 offen lds
    s_add_u32 s82, s82, 2048
    s_add_u32 m0, s20, 8320
    s_nop 0
    buffer_load_dwordx4 v62, s[40:43], s82 offen lds
    s_add_u32 s82, s82, 2048
    s_add_u32 m0, s20, 16640
    s_nop 0
    buffer_load_dwordx4 v62, s[40:43], s82 offen lds
    s_branch SCHK_12
SPOLL_11:
    s_load_dwordx2 s[24:25], s[32:33], s92 offset:0 glc
SCHK_12:
    s_add_u32 s5, s5, 1
    s_cmp_ge_u32 s5, 300000
    s_waitcnt lgkmcnt(0)
    s_cbranch_scc1 SDONE_13
    s_cmp_lg_u32 s24, s4
    s_cbranch_scc1 SPOLL_11
    s_cmp_lg_u32 s25, s4
    s_cbranch_scc1 SPOLL_11
SDONE_13:
    s_waitcnt vmcnt(9)
    s_barrier
    s_cmp_ge_u32 s3, 4
    s_cbranch_scc1 L_HELP
    s_setprio 2
    s_and_b32 s96, s85, 15
    s_lshl_b32 s97, s96, 14
    s_add_u32 s16, s97, s15
    buffer_load_dwordx4 v[176:179], v2, s[32:35], s16 offen sc1
    buffer_load_dwordx4 v[180:183], v2, s[32:35], s16 offen offset:1024 sc1
    ds_read_b64_tr_b16 v[224:225], v67 offset:8320
    ds_read_b64_tr_b16 v[226:227], v67 offset:8832
    ds_read_b64_tr_b16 v[228:229], v67 offset:8352
    ds_read_b64_tr_b16 v[230:231], v67 offset:8864
    ds_read_b64_tr_b16 v[232:233], v66 offset:8320
    ds_read_b64_tr_b16 v[234:235], v66 offset:8832
    ds_read_b64_tr_b16 v[236:237], v66 offset:8352
    ds_read_b64_tr_b16 v[238:239], v66 offset:8864
    ds_read_b64_tr_b16 v[240:241], v66
    ds_read_b64_tr_b16 v[242:243], v66 offset:512
    ds_read_b64_tr_b16 v[244:245], v66 offset:32
    ds_read_b64_tr_b16 v[246:247], v66 offset:544
    buffer_load_dwordx4 v[184:187], v2, s[32:35], s16 offen offset:2048 sc1
    buffer_load_dwordx4 v[188:191], v2, s[32:35], s16 offen offset:3072 sc1
    s_waitcnt lgkmcnt(8)
    s_waitcnt vmcnt(3)
    v_mfma_f32_16x16x32_bf16 v[128:131], v[224:227], v[176:179], 0
    ds_read_b64_tr_b16 v[248:249], v67
    s_waitcnt vmcnt(2)
    v_mfma_f32_16x16x32_bf16 v[132:135], v[224:227], v[180:183], 0
    ds_read_b64_tr_b16 v[250:251], v67 offset:512
    s_add_u32 s96, s85, 1
    s_and_b32 s97, s96, 15
    s_lshl_b32 s98, s97, 14
    s_add_u32 s16, s98, s15
    buffer_load_dwordx4 v[192:195], v2, s[32:35], s16 offen sc1
    v_mfma_f32_16x16x32_bf16 v[136:139], v[228:231], v[176:179], 0
    ds_read_b64_tr_b16 v[224:225], v67 offset:32
    v_mfma_f32_16x16x32_bf16 v[140:143], v[228:231], v[180:183], 0
    ds_read_b64_tr_b16 v[226:227], v67 offset:544
    s_waitcnt lgkmcnt(8)
    v_mfma_f32_16x16x32_bf16 v[112:115], v[232:235], v[176:179], 0
    ds_read_b64_tr_b16 v[228:229], v66 offset:16640
    v_mfma_f32_16x16x32_bf16 v[116:119], v[232:235], v[180:183], 0
    ds_read_b64_tr_b16 v[230:231], v66 offset:17152
    v_mfma_f32_16x16x32_bf16 v[120:123], v[236:239], v[176:179], 0
    ds_read_b64_tr_b16 v[232:233], v66 offset:16672
    v_mfma_f32_16x16x32_bf16 v[124:127], v[236:239], v[180:183], 0
    ds_read_b64_tr_b16 v[234:235], v66 offset:17184
    buffer_load_dwordx4 v[196:199], v2, s[32:35], s16 offen offset:1024 sc1
    s_waitcnt lgkmcnt(8)
    v_mfma_f32_16x16x32_bf16 v[80:83], v[240:243], v[176:179], 0
    ds_read_b64_tr_b16 v[236:237], v67 offset:16640
    v_mfma_f32_16x16x32_bf16 v[84:87], v[240:243], v[180:183], 0
    ds_read_b64_tr_b16 v[238:239], v67 offset:17152
    v_mfma_f32_16x16x32_bf16 v[88:91], v[244:247], v[176:179], 0
    ds_read_b64_tr_b16 v[240:241], v67 offset:16672
    v_mfma_f32_16x16x32_bf16 v[92:95], v[244:247], v[180:183], 0
    ds_read_b64_tr_b16 v[242:243], v67 offset:17184
    s_waitcnt lgkmcnt(8)
    v_mfma_f32_16x16x32_bf16 v[96:99], v[248:251], v[176:179], 0
    ds_read_b64_tr_b16 v[244:245], v67 offset:12480
    v_mfma_f32_16x16x32_bf16 v[100:103], v[248:251], v[180:183], 0
    ds_read_b64_tr_b16 v[246:247], v67 offset:12992
    buffer_load_dwordx4 v[200:203], v2, s[32:35], s16 offen offset:2048 sc1
    v_mfma_f32_16x16x32_bf16 v[104:107], v[224:227], v[176:179], 0
    ds_read_b64_tr_b16 v[248:249], v67 offset:12512
    v_mfma_f32_16x16x32_bf16 v[108:111], v[224:227], v[180:183], 0
    ds_read_b64_tr_b16 v[250:251], v67 offset:13024
    s_waitcnt lgkmcnt(8)
    v_mfma_f32_16x16x32_bf16 v[144:147], v[228:231], v[176:179], 0
    ds_read_b64_tr_b16 v[224:225], v66 offset:12480
    v_mfma_f32_16x16x32_bf16 v[148:151], v[228:231], v[180:183], 0
    ds_read_b64_tr_b16 v[226:227], v66 offset:12992
    v_mfma_f32_16x16x32_bf16 v[152:155], v[232:235], v[176:179], 0
    ds_read_b64_tr_b16 v[228:229], v66 offset:12512
    v_mfma_f32_16x16x32_bf16 v[156:159], v[232:235], v[180:183], 0
    ds_read_b64_tr_b16 v[230:231], v66 offset:13024
    buffer_load_dwordx4 v[204:207], v2, s[32:35], s16 offen offset:3072 sc1
    s_waitcnt lgkmcnt(8)
    v_mfma_f32_16x16x32_bf16 v[160:163], v[236:239], v[176:179], 0
    ds_read_b64_tr_b16 v[232:233], v66 offset:4160
    v_mfma_f32_16x16x32_bf16 v[164:167], v[236:239], v[180:183], 0
    ds_read_b64_tr_b16 v[234:235], v66 offset:4672
    v_mfma_f32_16x16x32_bf16 v[168:171], v[240:243], v[176:179], 0
    ds_read_b64_tr_b16 v[236:237], v66 offset:4192
    v_mfma_f32_16x16x32_bf16 v[172:175], v[240:243], v[180:183], 0
    ds_read_b64_tr_b16 v[238:239], v66 offset:4704
    s_waitcnt lgkmcnt(8)
    s_waitcnt vmcnt(5)
    v_mfma_f32_16x16x32_bf16 v[128:131], v[244:247], v[184:187], v[128:131]
    ds_read_b64_tr_b16 v[240:241], v67 offset:4160
    s_waitcnt vmcnt(4)
    v_mfma_f32_16x16x32_bf16 v[132:135], v[244:247], v[188:191], v[132:135]
    ds_read_b64_tr_b16 v[242:243], v67 offset:4672
    s_add_u32 s96, s85, 2
    s_and_b32 s97, s96, 15
    s_lshl_b32 s98, s97, 14
    s_add_u32 s16, s98, s15
    buffer_load_dwordx4 v[208:211], v2, s[32:35], s16 offen sc1
    v_mfma_f32_16x16x32_bf16 v[136:139], v[248:251], v[184:187], v[136:139]
    ds_read_b64_tr_b16 v[244:245], v67 offset:4192
    v_mfma_f32_16x16x32_bf16 v[140:143], v[248:251], v[188:191], v[140:143]
    ds_read_b64_tr_b16 v[246:247], v67 offset:4704
    s_waitcnt lgkmcnt(8)
    v_mfma_f32_16x16x32_bf16 v[112:115], v[224:227], v[184:187], v[112:115]
    ds_read_b64_tr_b16 v[248:249], v66 offset:20800
    v_mfma_f32_16x16x32_bf16 v[116:119], v[224:227], v[188:191], v[116:119]
    ds_read_b64_tr_b16 v[250:251], v66 offset:21312
    v_mfma_f32_16x16x32_bf16 v[120:123], v[228:231], v[184:187], v[120:123]
    ds_read_b64_tr_b16 v[224:225], v66 offset:20832
    v_mfma_f32_16x16x32_bf16 v[124:127], v[228:231], v[188:191], v[124:127]
    ds_read_b64_tr_b16 v[226:227], v66 offset:21344
    buffer_load_dwordx4 v[212:215], v2, s[32:35], s16 offen offset:1024 sc1
    s_waitcnt lgkmcnt(8)
    v_mfma_f32_16x16x32_bf16 v[80:83], v[232:235], v[184:187], v[80:83]
    ds_read_b64_tr_b16 v[228:229], v67 offset:20800
    v_mfma_f32_16x16x32_bf16 v[84:87], v[232:235], v[188:191], v[84:87]
    ds_read_b64_tr_b16 v[230:231], v67 offset:21312
    v_mfma_f32_16x16x32_bf16 v[88:91], v[236:239], v[184:187], v[88:91]
    ds_read_b64_tr_b16 v[232:233], v67 offset:20832
    v_mfma_f32_16x16x32_bf16 v[92:95], v[236:239], v[188:191], v[92:95]
    ds_read_b64_tr_b16 v[234:235], v67 offset:21344
    s_waitcnt lgkmcnt(8)
    v_mfma_f32_16x16x32_bf16 v[96:99], v[240:243], v[184:187], v[96:99]
    s_barrier
    ds_read_b64_tr_b16 v[236:237], v67 offset:33280
    v_mfma_f32_16x16x32_bf16 v[100:103], v[240:243], v[188:191], v[100:103]
    ds_read_b64_tr_b16 v[238:239], v67 offset:33792
    buffer_load_dwordx4 v[216:219], v2, s[32:35], s16 offen offset:2048 sc1
    v_mfma_f32_16x16x32_bf16 v[104:107], v[244:247], v[184:187], v[104:107]
    ds_read_b64_tr_b16 v[240:241], v67 offset:33312
    v_mfma_f32_16x16x32_bf16 v[108:111], v[244:247], v[188:191], v[108:111]
    ds_read_b64_tr_b16 v[242:243], v67 offset:33824
    s_waitcnt lgkmcnt(8)
    v_mfma_f32_16x16x32_bf16 v[144:147], v[248:251], v[184:187], v[144:147]
    ds_read_b64_tr_b16 v[244:245], v66 offset:33280
    v_mfma_f32_16x16x32_bf16 v[148:151], v[248:251], v[188:191], v[148:151]
    ds_read_b64_tr_b16 v[246:247], v66 offset:33792
    v_mfma_f32_16x16x32_bf16 v[152:155], v[224:227], v[184:187], v[152:155]
    ds_read_b64_tr_b16 v[248:249], v66 offset:33312
    v_mfma_f32_16x16x32_bf16 v[156:159], v[224:227], v[188:191], v[156:159]
    ds_read_b64_tr_b16 v[250:251], v66 offset:33824
    buffer_load_dwordx4 v[220:223], v2, s[32:35], s16 offen offset:3072 sc1
    s_waitcnt lgkmcnt(8)
    v_mfma_f32_16x16x32_bf16 v[160:163], v[228:231], v[184:187], v[160:163]
    ds_read_b64_tr_b16 v[224:225], v66 offset:24960
    v_mfma_f32_16x16x32_bf16 v[164:167], v[228:231], v[188:191], v[164:167]
    ds_read_b64_tr_b16 v[226:227], v66 offset:25472
    v_mfma_f32_16x16x32_bf16 v[168:171], v[232:235], v[184:187], v[168:171]
    ds_read_b64_tr_b16 v[228:229], v66 offset:24992
    v_mfma_f32_16x16x32_bf16 v[172:175], v[232:235], v[188:191], v[172:175]
    ds_read_b64_tr_b16 v[230:231], v66 offset:25504
    s_waitcnt lgkmcnt(8)
    s_waitcnt vmcnt(6)
    v_mfma_f32_16x16x32_bf16 v[128:131], v[236:239], v[192:195], v[128:131]
    ds_read_b64_tr_b16 v[232:233], v67 offset:24960
    v_mfma_f32_16x16x32_bf16 v[132:135], v[236:239], v[196:199], v[132:135]
    ds_read_b64_tr_b16 v[234:235], v67 offset:25472
    s_add_u32 s96, s85, 3
    s_and_b32 s97, s96, 15
    s_lshl_b32 s98, s97, 14
    s_add_u32 s16, s98, s15
    buffer_load_dwordx4 v[176:179], v2, s[32:35], s16 offen sc1
    v_mfma_f32_16x16x32_bf16 v[136:139], v[240:243], v[192:195], v[136:139]
    ds_read_b64_tr_b16 v[236:237], v67 offset:24992
    v_mfma_f32_16x16x32_bf16 v[140:143], v[240:243], v[196:199], v[140:143]
    ds_read_b64_tr_b16 v[238:239], v67 offset:25504
    s_waitcnt lgkmcnt(8)
    v_mfma_f32_16x16x32_bf16 v[112:115], v[244:247], v[192:195], v[112:115]
    ds_read_b64_tr_b16 v[240:241], v66 offset:41600
    v_mfma_f32_16x16x32_bf16 v[116:119], v[244:247], v[196:199], v[116:119]
    ds_read_b64_tr_b16 v[242:243], v66 offset:42112
    v_mfma_f32_16x16x32_bf16 v[120:123], v[248:251], v[192:195], v[120:123]
    ds_read_b64_tr_b16 v[244:245], v66 offset:41632
    v_mfma_f32_16x16x32_bf16 v[124:127], v[248:251], v[196:199], v[124:127]
    ds_read_b64_tr_b16 v[246:247], v66 offset:42144
    buffer_load_dwordx4 v[180:183], v2, s[32:35], s16 offen offset:1024 sc1
    s_waitcnt lgkmcnt(8)
    v_mfma_f32_16x16x32_bf16 v[80:83], v[224:227], v[192:195], v[80:83]
    ds_read_b64_tr_b16 v[248:249], v67 offset:41600
    v_mfma_f32_16x16x32_bf16 v[84:87], v[224:227], v[196:199], v[84:87]
    ds_read_b64_tr_b16 v[250:251], v67 offset:42112
    v_mfma_f32_16x16x32_bf16 v[88:91], v[228:231], v[192:195], v[88:91]
    ds_read_b64_tr_b16 v[224:225], v67 offset:41632
    v_mfma_f32_16x16x32_bf16 v[92:95], v[228:231], v[196:199], v[92:95]
    ds_read_b64_tr_b16 v[226:227], v67 offset:42144
    s_waitcnt lgkmcnt(8)
    v_mfma_f32_16x16x32_bf16 v[96:99], v[232:235], v[192:195], v[96:99]
    ds_read_b64_tr_b16 v[228:229], v67 offset:37440
    v_mfma_f32_16x16x32_bf16 v[100:103], v[232:235], v[196:199], v[100:103]
    ds_read_b64_tr_b16 v[230:231], v67 offset:37952
    buffer_load_dwordx4 v[184:187], v2, s[32:35], s16 offen offset:2048 sc1
    v_mfma_f32_16x16x32_bf16 v[104:107], v[236:239], v[192:195], v[104:107]
    ds_read_b64_tr_b16 v[232:233], v67 offset:37472
    v_mfma_f32_16x16x32_bf16 v[108:111], v[236:239], v[196:199], v[108:111]
    ds_read_b64_tr_b16 v[234:235], v67 offset:37984
    s_waitcnt lgkmcnt(8)
    v_mfma_f32_16x16x32_bf16 v[144:147], v[240:243], v[192:195], v[144:147]
    ds_read_b64_tr_b16 v[236:237], v66 offset:37440
    v_mfma_f32_16x16x32_bf16 v[148:151], v[240:243], v[196:199], v[148:151]
    ds_read_b64_tr_b16 v[238:239], v66 offset:37952
    v_mfma_f32_16x16x32_bf16 v[152:155], v[244:247], v[192:195], v[152:155]
    ds_read_b64_tr_b16 v[240:241], v66 offset:37472
    v_mfma_f32_16x16x32_bf16 v[156:159], v[244:247], v[196:199], v[156:159]
    ds_read_b64_tr_b16 v[242:243], v66 offset:37984
    buffer_load_dwordx4 v[188:191], v2, s[32:35], s16 offen offset:3072 sc1
    s_waitcnt lgkmcnt(8)
    v_mfma_f32_16x16x32_bf16 v[160:163], v[248:251], v[192:195], v[160:163]
    ds_read_b64_tr_b16 v[244:245], v66 offset:29120
    v_mfma_f32_16x16x32_bf16 v[164:167], v[248:251], v[196:199], v[164:167]
    ds_read_b64_tr_b16 v[246:247], v66 offset:29632
    v_mfma_f32_16x16x32_bf16 v[168:171], v[224:227], v[192:195], v[168:171]
    ds_read_b64_tr_b16 v[248:249], v66 offset:29152
    v_mfma_f32_16x16x32_bf16 v[172:175], v[224:227], v[196:199], v[172:175]
    ds_read_b64_tr_b16 v[250:251], v66 offset:29664
    s_waitcnt lgkmcnt(8)
    s_waitcnt vmcnt(8)
    v_mfma_f32_16x16x32_bf16 v[128:131], v[228:231], v[200:203], v[128:131]
    ds_read_b64_tr_b16 v[224:225], v67 offset:29120
    v_mfma_f32_16x16x32_bf16 v[132:135], v[228:231], v[204:207], v[132:135]
    ds_read_b64_tr_b16 v[226:227], v67 offset:29632
    s_add_u32 s96, s85, 4
    s_and_b32 s97, s96, 15
    s_lshl_b32 s98, s97, 14
    s_add_u32 s16, s98, s15
    buffer_load_dwordx4 v[192:195], v2, s[32:35], s16 offen sc1
    v_mfma_f32_16x16x32_bf16 v[136:139], v[232:235], v[200:203], v[136:139]
    ds_read_b64_tr_b16 v[228:229], v67 offset:29152
    v_mfma_f32_16x16x32_bf16 v[140:143], v[232:235], v[204:207], v[140:143]
    ds_read_b64_tr_b16 v[230:231], v67 offset:29664
    s_waitcnt lgkmcnt(8)
    v_mfma_f32_16x16x32_bf16 v[112:115], v[236:239], v[200:203], v[112:115]
    ds_read_b64_tr_b16 v[232:233], v66 offset:45760
    v_mfma_f32_16x16x32_bf16 v[116:119], v[236:239], v[204:207], v[116:119]
    ds_read_b64_tr_b16 v[234:235], v66 offset:46272
    v_mfma_f32_16x16x32_bf16 v[120:123], v[240:243], v[200:203], v[120:123]
    ds_read_b64_tr_b16 v[236:237], v66 offset:45792
    v_mfma_f32_16x16x32_bf16 v[124:127], v[240:243], v[204:207], v[124:127]
    ds_read_b64_tr_b16 v[238:239], v66 offset:46304
    buffer_load_dwordx4 v[196:199], v2, s[32:35], s16 offen offset:1024 sc1
    s_waitcnt lgkmcnt(8)
    v_mfma_f32_16x16x32_bf16 v[80:83], v[244:247], v[200:203], v[80:83]
    ds_read_b64_tr_b16 v[240:241], v67 offset:45760
    v_mfma_f32_16x16x32_bf16 v[84:87], v[244:247], v[204:207], v[84:87]
    ds_read_b64_tr_b16 v[242:243], v67 offset:46272
    v_mfma_f32_16x16x32_bf16 v[88:91], v[248:251], v[200:203], v[88:91]
    ds_read_b64_tr_b16 v[244:245], v67 offset:45792
    v_mfma_f32_16x16x32_bf16 v[92:95], v[248:251], v[204:207], v[92:95]
    ds_read_b64_tr_b16 v[246:247], v67 offset:46304
    s_waitcnt lgkmcnt(8)
    v_mfma_f32_16x16x32_bf16 v[96:99], v[224:227], v[200:203], v[96:99]
    s_barrier
    ds_read_b64_tr_b16 v[248:249], v69 offset:8320
    v_mfma_f32_16x16x32_bf16 v[100:103], v[224:227], v[204:207], v[100:103]
    ds_read_b64_tr_b16 v[250:251], v69 offset:8832
    v_mfma_f32_16x16x32_bf16 v[104:107], v[228:231], v[200:203], v[104:107]
    ds_read_b64_tr_b16 v[224:225], v69 offset:8352
    v_mfma_f32_16x16x32_bf16 v[108:111], v[228:231], v[204:207], v[108:111]
    ds_read_b64_tr_b16 v[226:227], v69 offset:8864
    s_waitcnt lgkmcnt(8)
    v_mfma_f32_16x16x32_bf16 v[144:147], v[232:235], v[200:203], v[144:147]
    ds_read_b64_tr_b16 v[228:229], v68 offset:8320
    v_mfma_f32_16x16x32_bf16 v[148:151], v[232:235], v[204:207], v[148:151]
    ds_read_b64_tr_b16 v[230:231], v68 offset:8832
    v_mfma_f32_16x16x32_bf16 v[152:155], v[236:239], v[200:203], v[152:155]
    ds_read_b64_tr_b16 v[232:233], v68 offset:8352
    v_mfma_f32_16x16x32_bf16 v[156:159], v[236:239], v[204:207], v[156:159]
    ds_read_b64_tr_b16 v[234:235], v68 offset:8864
    s_waitcnt lgkmcnt(8)
    v_mfma_f32_16x16x32_bf16 v[160:163], v[240:243], v[200:203], v[160:163]
    ds_read_b64_tr_b16 v[236:237], v68
    v_mfma_f32_16x16x32_bf16 v[164:167], v[240:243], v[204:207], v[164:167]
    ds_read_b64_tr_b16 v[238:239], v68 offset:512
    v_mfma_f32_16x16x32_bf16 v[168:171], v[244:247], v[200:203], v[168:171]
    ds_read_b64_tr_b16 v[240:241], v68 offset:32
    v_mfma_f32_16x16x32_bf16 v[172:175], v[244:247], v[204:207], v[172:175]
    ds_read_b64_tr_b16 v[242:243], v68 offset:544
    s_waitcnt lgkmcnt(8)
    s_waitcnt vmcnt(8)
    v_mfma_f32_16x16x32_bf16 v[128:131], v[248:251], v[208:211], v[128:131]
    ds_read_b64_tr_b16 v[244:245], v69
    v_mfma_f32_16x16x32_bf16 v[132:135], v[248:251], v[212:215], v[132:135]
    ds_read_b64_tr_b16 v[246:247], v69 offset:512
    buffer_load_dwordx4 v[200:203], v2, s[32:35], s16 offen offset:2048 sc1
    v_mfma_f32_16x16x32_bf16 v[136:139], v[224:227], v[208:211], v[136:139]
    ds_read_b64_tr_b16 v[248:249], v69 offset:32
    v_mfma_f32_16x16x32_bf16 v[140:143], v[224:227], v[212:215], v[140:143]
    ds_read_b64_tr_b16 v[250:251], v69 offset:544
    s_waitcnt lgkmcnt(8)
    v_mfma_f32_16x16x32_bf16 v[112:115], v[228:231], v[208:211], v[112:115]
    ds_read_b64_tr_b16 v[224:225], v68 offset:16640
    v_mfma_f32_16x16x32_bf16 v[116:119], v[228:231], v[212:215], v[116:119]
    ds_read_b64_tr_b16 v[226:227], v68 offset:17152
    v_mfma_f32_16x16x32_bf16 v[120:123], v[232:235], v[208:211], v[120:123]
    ds_read_b64_tr_b16 v[228:229], v68 offset:16672
    v_mfma_f32_16x16x32_bf16 v[124:127], v[232:235], v[212:215], v[124:127]
    ds_read_b64_tr_b16 v[230:231], v68 offset:17184
    buffer_load_dwordx4 v[204:207], v2, s[32:35], s16 offen offset:3072 sc1
    s_waitcnt lgkmcnt(8)
    v_mfma_f32_16x16x32_bf16 v[80:83], v[236:239], v[208:211], v[80:83]
    ds_read_b64_tr_b16 v[232:233], v69 offset:16640
    v_mfma_f32_16x16x32_bf16 v[84:87], v[236:239], v[212:215], v[84:87]
    ds_read_b64_tr_b16 v[234:235], v69 offset:17152
    v_mfma_f32_16x16x32_bf16 v[88:91], v[240:243], v[208:211], v[88:91]
    ds_read_b64_tr_b16 v[236:237], v69 offset:16672
    v_mfma_f32_16x16x32_bf16 v[92:95], v[240:243], v[212:215], v[92:95]
    ds_read_b64_tr_b16 v[238:239], v69 offset:17184
    s_waitcnt lgkmcnt(8)
    v_mfma_f32_16x16x32_bf16 v[96:99], v[244:247], v[208:211], v[96:99]
    ds_read_b64_tr_b16 v[240:241], v69 offset:12480
    v_mfma_f32_16x16x32_bf16 v[100:103], v[244:247], v[212:215], v[100:103]
    ds_read_b64_tr_b16 v[242:243], v69 offset:12992
    v_mfma_f32_16x16x32_bf16 v[104:107], v[248:251], v[208:211], v[104:107]
    ds_read_b64_tr_b16 v[244:245], v69 offset:12512
    v_mfma_f32_16x16x32_bf16 v[108:111], v[248:251], v[212:215], v[108:111]
    ds_read_b64_tr_b16 v[246:247], v69 offset:13024
    s_waitcnt lgkmcnt(8)
    v_mfma_f32_16x16x32_bf16 v[144:147], v[224:227], v[208:211], v[144:147]
    ds_read_b64_tr_b16 v[248:249], v68 offset:12480
    v_mfma_f32_16x16x32_bf16 v[148:151], v[224:227], v[212:215], v[148:151]
    ds_read_b64_tr_b16 v[250:251], v68 offset:12992
    v_mfma_f32_16x16x32_bf16 v[152:155], v[228:231], v[208:211], v[152:155]
    ds_read_b64_tr_b16 v[224:225], v68 offset:12512
    v_mfma_f32_16x16x32_bf16 v[156:159], v[228:231], v[212:215], v[156:159]
    ds_read_b64_tr_b16 v[226:227], v68 offset:13024
    s_waitcnt lgkmcnt(8)
    v_mfma_f32_16x16x32_bf16 v[160:163], v[232:235], v[208:211], v[160:163]
    ds_read_b64_tr_b16 v[228:229], v68 offset:4160
    v_mfma_f32_16x16x32_bf16 v[164:167], v[232:235], v[212:215], v[164:167]
    ds_read_b64_tr_b16 v[230:231], v68 offset:4672
    v_mfma_f32_16x16x32_bf16 v[168:171], v[236:239], v[208:211], v[168:171]
    ds_read_b64_tr_b16 v[232:233], v68 offset:4192
    v_mfma_f32_16x16x32_bf16 v[172:175], v[236:239], v[212:215], v[172:175]
    ds_read_b64_tr_b16 v[234:235], v68 offset:4704
    s_waitcnt lgkmcnt(8)
    s_waitcnt vmcnt(8)
    v_mfma_f32_16x16x32_bf16 v[128:131], v[240:243], v[216:219], v[128:131]
    ds_read_b64_tr_b16 v[236:237], v69 offset:4160
    v_mfma_f32_16x16x32_bf16 v[132:135], v[240:243], v[220:223], v[132:135]
    ds_read_b64_tr_b16 v[238:239], v69 offset:4672
    s_add_u32 s96, s85, 5
    s_and_b32 s97, s96, 15
    s_lshl_b32 s98, s97, 14
    s_add_u32 s16, s98, s15
    buffer_load_dwordx4 v[208:211], v2, s[32:35], s16 offen sc1
    v_mfma_f32_16x16x32_bf16 v[136:139], v[244:247], v[216:219], v[136:139]
    ds_read_b64_tr_b16 v[240:241], v69 offset:4192
    v_mfma_f32_16x16x32_bf16 v[140:143], v[244:247], v[220:223], v[140:143]
    ds_read_b64_tr_b16 v[242:243], v69 offset:4704
    s_waitcnt lgkmcnt(8)
    v_mfma_f32_16x16x32_bf16 v[112:115], v[248:251], v[216:219], v[112:115]
    ds_read_b64_tr_b16 v[244:245], v68 offset:20800
    v_mfma_f32_16x16x32_bf16 v[116:119], v[248:251], v[220:223], v[116:119]
    ds_read_b64_tr_b16 v[246:247], v68 offset:21312
    v_mfma_f32_16x16x32_bf16 v[120:123], v[224:227], v[216:219], v[120:123]
    ds_read_b64_tr_b16 v[248:249], v68 offset:20832
    v_mfma_f32_16x16x32_bf16 v[124:127], v[224:227], v[220:223], v[124:127]
    ds_read_b64_tr_b16 v[250:251], v68 offset:21344
    buffer_load_dwordx4 v[212:215], v2, s[32:35], s16 offen offset:1024 sc1
    s_waitcnt lgkmcnt(8)
    v_mfma_f32_16x16x32_bf16 v[80:83], v[228:231], v[216:219], v[80:83]
    ds_read_b64_tr_b16 v[224:225], v69 offset:20800
    v_mfma_f32_16x16x32_bf16 v[84:87], v[228:231], v[220:223], v[84:87]
    ds_read_b64_tr_b16 v[226:227], v69 offset:21312
    v_mfma_f32_16x16x32_bf16 v[88:91], v[232:235], v[216:219], v[88:91]
    ds_read_b64_tr_b16 v[228:229], v69 offset:20832
    v_mfma_f32_16x16x32_bf16 v[92:95], v[232:235], v[220:223], v[92:95]
    ds_read_b64_tr_b16 v[230:231], v69 offset:21344
    s_waitcnt lgkmcnt(8)
    v_mfma_f32_16x16x32_bf16 v[96:99], v[236:239], v[216:219], v[96:99]
    s_barrier
    ds_read_b64_tr_b16 v[232:233], v69 offset:33280
    v_mfma_f32_16x16x32_bf16 v[100:103], v[236:239], v[220:223], v[100:103]
    ds_read_b64_tr_b16 v[234:235], v69 offset:33792
    v_mfma_f32_16x16x32_bf16 v[104:107], v[240:243], v[216:219], v[104:107]
    ds_read_b64_tr_b16 v[236:237], v69 offset:33312
    v_mfma_f32_16x16x32_bf16 v[108:111], v[240:243], v[220:223], v[108:111]
    ds_read_b64_tr_b16 v[238:239], v69 offset:33824
    s_waitcnt lgkmcnt(8)
    v_mfma_f32_16x16x32_bf16 v[144:147], v[244:247], v[216:219], v[144:147]
    ds_read_b64_tr_b16 v[240:241], v68 offset:33280
    v_mfma_f32_16x16x32_bf16 v[148:151], v[244:247], v[220:223], v[148:151]
    ds_read_b64_tr_b16 v[242:243], v68 offset:33792
    v_mfma_f32_16x16x32_bf16 v[152:155], v[248:251], v[216:219], v[152:155]
    ds_read_b64_tr_b16 v[244:245], v68 offset:33312
    v_mfma_f32_16x16x32_bf16 v[156:159], v[248:251], v[220:223], v[156:159]
    ds_read_b64_tr_b16 v[246:247], v68 offset:33824
    s_waitcnt lgkmcnt(8)
    v_mfma_f32_16x16x32_bf16 v[160:163], v[224:227], v[216:219], v[160:163]
    ds_read_b64_tr_b16 v[248:249], v68 offset:24960
    v_mfma_f32_16x16x32_bf16 v[164:167], v[224:227], v[220:223], v[164:167]
    ds_read_b64_tr_b16 v[250:251], v68 offset:25472
    v_mfma_f32_16x16x32_bf16 v[168:171], v[228:231], v[216:219], v[168:171]
    ds_read_b64_tr_b16 v[224:225], v68 offset:24992
    v_mfma_f32_16x16x32_bf16 v[172:175], v[228:231], v[220:223], v[172:175]
    ds_read_b64_tr_b16 v[226:227], v68 offset:25504
    s_waitcnt lgkmcnt(8)
    s_waitcnt vmcnt(8)
    v_mfma_f32_16x16x32_bf16 v[128:131], v[232:235], v[176:179], v[128:131]
    ds_read_b64_tr_b16 v[228:229], v69 offset:24960
    v_mfma_f32_16x16x32_bf16 v[132:135], v[232:235], v[180:183], v[132:135]
    ds_read_b64_tr_b16 v[230:231], v69 offset:25472
    buffer_load_dwordx4 v[216:219], v2, s[32:35], s16 offen offset:2048 sc1
    v_mfma_f32_16x16x32_bf16 v[136:139], v[236:239], v[176:179], v[136:139]
    ds_read_b64_tr_b16 v[232:233], v69 offset:24992
    v_mfma_f32_16x16x32_bf16 v[140:143], v[236:239], v[180:183], v[140:143]
    ds_read_b64_tr_b16 v[234:235], v69 offset:25504
    s_waitcnt lgkmcnt(8)
    v_mfma_f32_16x16x32_bf16 v[112:115], v[240:243], v[176:179], v[112:115]
    ds_read_b64_tr_b16 v[236:237], v68 offset:41600
    v_mfma_f32_16x16x32_bf16 v[116:119], v[240:243], v[180:183], v[116:119]
    ds_read_b64_tr_b16 v[238:239], v68 offset:42112
    v_mfma_f32_16x16x32_bf16 v[120:123], v[244:247], v[176:179], v[120:123]
    ds_read_b64_tr_b16 v[240:241], v68 offset:41632
    v_mfma_f32_16x16x32_bf16 v[124:127], v[244:247], v[180:183], v[124:127]
    ds_read_b64_tr_b16 v[242:243], v68 offset:42144
    buffer_load_dwordx4 v[220:223], v2, s[32:35], s16 offen offset:3072 sc1
    s_waitcnt lgkmcnt(8)
    v_mfma_f32_16x16x32_bf16 v[80:83], v[248:251], v[176:179], v[80:83]
    ds_read_b64_tr_b16 v[244:245], v69 offset:41600
    v_mfma_f32_16x16x32_bf16 v[84:87], v[248:251], v[180:183], v[84:87]
    ds_read_b64_tr_b16 v[246:247], v69 offset:42112
    v_mfma_f32_16x16x32_bf16 v[88:91], v[224:227], v[176:179], v[88:91]
    ds_read_b64_tr_b16 v[248:249], v69 offset:41632
    v_mfma_f32_16x16x32_bf16 v[92:95], v[224:227], v[180:183], v[92:95]
    ds_read_b64_tr_b16 v[250:251], v69 offset:42144
    s_waitcnt lgkmcnt(8)
    v_mfma_f32_16x16x32_bf16 v[96:99], v[228:231], v[176:179], v[96:99]
    ds_read_b64_tr_b16 v[224:225], v69 offset:37440
    v_mfma_f32_16x16x32_bf16 v[100:103], v[228:231], v[180:183], v[100:103]
    ds_read_b64_tr_b16 v[226:227], v69 offset:37952
    v_mfma_f32_16x16x32_bf16 v[104:107], v[232:235], v[176:179], v[104:107]
    ds_read_b64_tr_b16 v[228:229], v69 offset:37472
    v_mfma_f32_16x16x32_bf16 v[108:111], v[232:235], v[180:183], v[108:111]
    ds_read_b64_tr_b16 v[230:231], v69 offset:37984
    s_waitcnt lgkmcnt(8)
    v_mfma_f32_16x16x32_bf16 v[144:147], v[236:239], v[176:179], v[144:147]
    ds_read_b64_tr_b16 v[232:233], v68 offset:37440
    v_mfma_f32_16x16x32_bf16 v[148:151], v[236:239], v[180:183], v[148:151]
    ds_read_b64_tr_b16 v[234:235], v68 offset:37952
    v_mfma_f32_16x16x32_bf16 v[152:155], v[240:243], v[176:179], v[152:155]
    ds_read_b64_tr_b16 v[236:237], v68 offset:37472
    v_mfma_f32_16x16x32_bf16 v[156:159], v[240:243], v[180:183], v[156:159]
    ds_read_b64_tr_b16 v[238:239], v68 offset:37984
    s_waitcnt lgkmcnt(8)
    v_mfma_f32_16x16x32_bf16 v[160:163], v[244:247], v[176:179], v[160:163]
    ds_read_b64_tr_b16 v[240:241], v68 offset:29120
    v_mfma_f32_16x16x32_bf16 v[164:167], v[244:247], v[180:183], v[164:167]
    ds_read_b64_tr_b16 v[242:243], v68 offset:29632
    v_mfma_f32_16x16x32_bf16 v[168:171], v[248:251], v[176:179], v[168:171]
    ds_read_b64_tr_b16 v[244:245], v68 offset:29152
    v_mfma_f32_16x16x32_bf16 v[172:175], v[248:251], v[180:183], v[172:175]
    ds_read_b64_tr_b16 v[246:247], v68 offset:29664
    s_waitcnt lgkmcnt(8)
    s_waitcnt vmcnt(8)
    v_mfma_f32_16x16x32_bf16 v[128:131], v[224:227], v[184:187], v[128:131]
    ds_read_b64_tr_b16 v[248:249], v69 offset:29120
    v_mfma_f32_16x16x32_bf16 v[132:135], v[224:227], v[188:191], v[132:135]
    ds_read_b64_tr_b16 v[250:251], v69 offset:29632
    s_add_u32 s96, s85, 6
    s_and_b32 s97, s96, 15
    s_lshl_b32 s98, s97, 14
    s_add_u32 s16, s98, s15
    buffer_load_dwordx4 v[176:179], v2, s[32:35], s16 offen sc1
    v_mfma_f32_16x16x32_bf16 v[136:139], v[228:231], v[184:187], v[136:139]
    ds_read_b64_tr_b16 v[224:225], v69 offset:29152
    v_mfma_f32_16x16x32_bf16 v[140:143], v[228:231], v[188:191], v[140:143]
    ds_read_b64_tr_b16 v[226:227], v69 offset:29664
    s_waitcnt lgkmcnt(8)
    v_mfma_f32_16x16x32_bf16 v[112:115], v[232:235], v[184:187], v[112:115]
    ds_read_b64_tr_b16 v[228:229], v68 offset:45760
    v_mfma_f32_16x16x32_bf16 v[116:119], v[232:235], v[188:191], v[116:119]
    ds_read_b64_tr_b16 v[230:231], v68 offset:46272
    v_mfma_f32_16x16x32_bf16 v[120:123], v[236:239], v[184:187], v[120:123]
    ds_read_b64_tr_b16 v[232:233], v68 offset:45792
    v_mfma_f32_16x16x32_bf16 v[124:127], v[236:239], v[188:191], v[124:127]
    ds_read_b64_tr_b16 v[234:235], v68 offset:46304
    buffer_load_dwordx4 v[180:183], v2, s[32:35], s16 offen offset:1024 sc1
    s_waitcnt lgkmcnt(8)
    v_mfma_f32_16x16x32_bf16 v[80:83], v[240:243], v[184:187], v[80:83]
    ds_read_b64_tr_b16 v[236:237], v69 offset:45760
    v_mfma_f32_16x16x32_bf16 v[84:87], v[240:243], v[188:191], v[84:87]
    ds_read_b64_tr_b16 v[238:239], v69 offset:46272
    v_mfma_f32_16x16x32_bf16 v[88:91], v[244:247], v[184:187], v[88:91]
    ds_read_b64_tr_b16 v[240:241], v69 offset:45792
    v_mfma_f32_16x16x32_bf16 v[92:95], v[244:247], v[188:191], v[92:95]
    ds_read_b64_tr_b16 v[242:243], v69 offset:46304
    s_waitcnt lgkmcnt(8)
    v_mfma_f32_16x16x32_bf16 v[96:99], v[248:251], v[184:187], v[96:99]
    s_barrier
    ds_read_b64_tr_b16 v[244:245], v71 offset:8320
    v_mfma_f32_16x16x32_bf16 v[100:103], v[248:251], v[188:191], v[100:103]
    ds_read_b64_tr_b16 v[246:247], v71 offset:8832
    v_mfma_f32_16x16x32_bf16 v[104:107], v[224:227], v[184:187], v[104:107]
    ds_read_b64_tr_b16 v[248:249], v71 offset:8352
    v_mfma_f32_16x16x32_bf16 v[108:111], v[224:227], v[188:191], v[108:111]
    ds_read_b64_tr_b16 v[250:251], v71 offset:8864
    s_waitcnt lgkmcnt(8)
    v_mfma_f32_16x16x32_bf16 v[144:147], v[228:231], v[184:187], v[144:147]
    ds_read_b64_tr_b16 v[224:225], v70 offset:8320
    v_mfma_f32_16x16x32_bf16 v[148:151], v[228:231], v[188:191], v[148:151]
    ds_read_b64_tr_b16 v[226:227], v70 offset:8832
    v_mfma_f32_16x16x32_bf16 v[152:155], v[232:235], v[184:187], v[152:155]
    ds_read_b64_tr_b16 v[228:229], v70 offset:8352
    v_mfma_f32_16x16x32_bf16 v[156:159], v[232:235], v[188:191], v[156:159]
    ds_read_b64_tr_b16 v[230:231], v70 offset:8864
    s_waitcnt lgkmcnt(8)
    v_mfma_f32_16x16x32_bf16 v[160:163], v[236:239], v[184:187], v[160:163]
    ds_read_b64_tr_b16 v[232:233], v70
    v_mfma_f32_16x16x32_bf16 v[164:167], v[236:239], v[188:191], v[164:167]
    ds_read_b64_tr_b16 v[234:235], v70 offset:512
    v_mfma_f32_16x16x32_bf16 v[168:171], v[240:243], v[184:187], v[168:171]
    ds_read_b64_tr_b16 v[236:237], v70 offset:32
    v_mfma_f32_16x16x32_bf16 v[172:175], v[240:243], v[188:191], v[172:175]
    ds_read_b64_tr_b16 v[238:239], v70 offset:544
    s_waitcnt lgkmcnt(8)
    s_waitcnt vmcnt(8)
    v_mfma_f32_16x16x32_bf16 v[128:131], v[244:247], v[192:195], v[128:131]
    ds_read_b64_tr_b16 v[240:241], v71
    v_mfma_f32_16x16x32_bf16 v[132:135], v[244:247], v[196:199], v[132:135]
    ds_read_b64_tr_b16 v[242:243], v71 offset:512
    buffer_load_dwordx4 v[184:187], v2, s[32:35], s16 offen offset:2048 sc1
    v_mfma_f32_16x16x32_bf16 v[136:139], v[248:251], v[192:195], v[136:139]
    ds_read_b64_tr_b16 v[244:245], v71 offset:32
    v_mfma_f32_16x16x32_bf16 v[140:143], v[248:251], v[196:199], v[140:143]
    ds_read_b64_tr_b16 v[246:247], v71 offset:544
    s_waitcnt lgkmcnt(8)
    v_mfma_f32_16x16x32_bf16 v[112:115], v[224:227], v[192:195], v[112:115]
    ds_read_b64_tr_b16 v[248:249], v70 offset:16640
    v_mfma_f32_16x16x32_bf16 v[116:119], v[224:227], v[196:199], v[116:119]
    ds_read_b64_tr_b16 v[250:251], v70 offset:17152
    v_mfma_f32_16x16x32_bf16 v[120:123], v[228:231], v[192:195], v[120:123]
    ds_read_b64_tr_b16 v[224:225], v70 offset:16672
    v_mfma_f32_16x16x32_bf16 v[124:127], v[228:231], v[196:199], v[124:127]
    ds_read_b64_tr_b16 v[226:227], v70 offset:17184
    buffer_load_dwordx4 v[188:191], v2, s[32:35], s16 offen offset:3072 sc1
    s_waitcnt lgkmcnt(8)
    v_mfma_f32_16x16x32_bf16 v[80:83], v[232:235], v[192:195], v[80:83]
    ds_read_b64_tr_b16 v[228:229], v71 offset:16640
    v_mfma_f32_16x16x32_bf16 v[84:87], v[232:235], v[196:199], v[84:87]
    ds_read_b64_tr_b16 v[230:231], v71 offset:17152
    v_mfma_f32_16x16x32_bf16 v[88:91], v[236:239], v[192:195], v[88:91]
    ds_read_b64_tr_b16 v[232:233], v71 offset:16672
    v_mfma_f32_16x16x32_bf16 v[92:95], v[236:239], v[196:199], v[92:95]
    ds_read_b64_tr_b16 v[234:235], v71 offset:17184
    s_waitcnt lgkmcnt(8)
    v_mfma_f32_16x16x32_bf16 v[96:99], v[240:243], v[192:195], v[96:99]
    ds_read_b64_tr_b16 v[236:237], v71 offset:12480
    v_mfma_f32_16x16x32_bf16 v[100:103], v[240:243], v[196:199], v[100:103]
    ds_read_b64_tr_b16 v[238:239], v71 offset:12992
    v_mfma_f32_16x16x32_bf16 v[104:107], v[244:247], v[192:195], v[104:107]
    ds_read_b64_tr_b16 v[240:241], v71 offset:12512
    v_mfma_f32_16x16x32_bf16 v[108:111], v[244:247], v[196:199], v[108:111]
    ds_read_b64_tr_b16 v[242:243], v71 offset:13024
    s_waitcnt lgkmcnt(8)
    v_mfma_f32_16x16x32_bf16 v[144:147], v[248:251], v[192:195], v[144:147]
    ds_read_b64_tr_b16 v[244:245], v70 offset:12480
    v_mfma_f32_16x16x32_bf16 v[148:151], v[248:251], v[196:199], v[148:151]
    ds_read_b64_tr_b16 v[246:247], v70 offset:12992
    v_mfma_f32_16x16x32_bf16 v[152:155], v[224:227], v[192:195], v[152:155]
    ds_read_b64_tr_b16 v[248:249], v70 offset:12512
    v_mfma_f32_16x16x32_bf16 v[156:159], v[224:227], v[196:199], v[156:159]
    ds_read_b64_tr_b16 v[250:251], v70 offset:13024
    s_waitcnt lgkmcnt(8)
    v_mfma_f32_16x16x32_bf16 v[160:163], v[228:231], v[192:195], v[160:163]
    ds_read_b64_tr_b16 v[224:225], v70 offset:4160
    v_mfma_f32_16x16x32_bf16 v[164:167], v[228:231], v[196:199], v[164:167]
    ds_read_b64_tr_b16 v[226:227], v70 offset:4672
    v_mfma_f32_16x16x32_bf16 v[168:171], v[232:235], v[192:195], v[168:171]
    ds_read_b64_tr_b16 v[228:229], v70 offset:4192
    v_mfma_f32_16x16x32_bf16 v[172:175], v[232:235], v[196:199], v[172:175]
    ds_read_b64_tr_b16 v[230:231], v70 offset:4704
    s_waitcnt lgkmcnt(8)
    s_waitcnt vmcnt(8)
    v_mfma_f32_16x16x32_bf16 v[128:131], v[236:239], v[200:203], v[128:131]
    ds_read_b64_tr_b16 v[232:233], v71 offset:4160
    v_mfma_f32_16x16x32_bf16 v[132:135], v[236:239], v[204:207], v[132:135]
    ds_read_b64_tr_b16 v[234:235], v71 offset:4672
    s_add_u32 s96, s85, 7
    s_and_b32 s97, s96, 15
    s_lshl_b32 s98, s97, 14
    s_add_u32 s16, s98, s15
    buffer_load_dwordx4 v[192:195], v2, s[32:35], s16 offen sc1
    v_mfma_f32_16x16x32_bf16 v[136:139], v[240:243], v[200:203], v[136:139]
    ds_read_b64_tr_b16 v[236:237], v71 offset:4192
    v_mfma_f32_16x16x32_bf16 v[140:143], v[240:243], v[204:207], v[140:143]
    ds_read_b64_tr_b16 v[238:239], v71 offset:4704
    s_waitcnt lgkmcnt(8)
    v_mfma_f32_16x16x32_bf16 v[112:115], v[244:247], v[200:203], v[112:115]
    ds_read_b64_tr_b16 v[240:241], v70 offset:20800
    v_mfma_f32_16x16x32_bf16 v[116:119], v[244:247], v[204:207], v[116:119]
    ds_read_b64_tr_b16 v[242:243], v70 offset:21312
    v_mfma_f32_16x16x32_bf16 v[120:123], v[248:251], v[200:203], v[120:123]
    ds_read_b64_tr_b16 v[244:245], v70 offset:20832
    v_mfma_f32_16x16x32_bf16 v[124:127], v[248:251], v[204:207], v[124:127]
    ds_read_b64_tr_b16 v[246:247], v70 offset:21344
    buffer_load_dwordx4 v[196:199], v2, s[32:35], s16 offen offset:1024 sc1
    s_waitcnt lgkmcnt(8)
    v_mfma_f32_16x16x32_bf16 v[80:83], v[224:227], v[200:203], v[80:83]
    ds_read_b64_tr_b16 v[248:249], v71 offset:20800
    v_mfma_f32_16x16x32_bf16 v[84:87], v[224:227], v[204:207], v[84:87]
    ds_read_b64_tr_b16 v[250:251], v71 offset:21312
    v_mfma_f32_16x16x32_bf16 v[88:91], v[228:231], v[200:203], v[88:91]
    ds_read_b64_tr_b16 v[224:225], v71 offset:20832
    v_mfma_f32_16x16x32_bf16 v[92:95], v[228:231], v[204:207], v[92:95]
    ds_read_b64_tr_b16 v[226:227], v71 offset:21344
    s_waitcnt lgkmcnt(8)
    v_mfma_f32_16x16x32_bf16 v[96:99], v[232:235], v[200:203], v[96:99]
    s_barrier
    ds_read_b64_tr_b16 v[228:229], v71 offset:33280
    v_mfma_f32_16x16x32_bf16 v[100:103], v[232:235], v[204:207], v[100:103]
    ds_read_b64_tr_b16 v[230:231], v71 offset:33792
    v_mfma_f32_16x16x32_bf16 v[104:107], v[236:239], v[200:203], v[104:107]
    ds_read_b64_tr_b16 v[232:233], v71 offset:33312
    v_mfma_f32_16x16x32_bf16 v[108:111], v[236:239], v[204:207], v[108:111]
    ds_read_b64_tr_b16 v[234:235], v71 offset:33824
    s_waitcnt lgkmcnt(8)
    v_mfma_f32_16x16x32_bf16 v[144:147], v[240:243], v[200:203], v[144:147]
    ds_read_b64_tr_b16 v[236:237], v70 offset:33280
    v_mfma_f32_16x16x32_bf16 v[148:151], v[240:243], v[204:207], v[148:151]
    ds_read_b64_tr_b16 v[238:239], v70 offset:33792
    v_mfma_f32_16x16x32_bf16 v[152:155], v[244:247], v[200:203], v[152:155]
    ds_read_b64_tr_b16 v[240:241], v70 offset:33312
    v_mfma_f32_16x16x32_bf16 v[156:159], v[244:247], v[204:207], v[156:159]
    ds_read_b64_tr_b16 v[242:243], v70 offset:33824
    s_waitcnt lgkmcnt(8)
    v_mfma_f32_16x16x32_bf16 v[160:163], v[248:251], v[200:203], v[160:163]
    ds_read_b64_tr_b16 v[244:245], v70 offset:24960
    v_mfma_f32_16x16x32_bf16 v[164:167], v[248:251], v[204:207], v[164:167]
    ds_read_b64_tr_b16 v[246:247], v70 offset:25472
    v_mfma_f32_16x16x32_bf16 v[168:171], v[224:227], v[200:203], v[168:171]
    ds_read_b64_tr_b16 v[248:249], v70 offset:24992
    v_mfma_f32_16x16x32_bf16 v[172:175], v[224:227], v[204:207], v[172:175]
    ds_read_b64_tr_b16 v[250:251], v70 offset:25504
    s_waitcnt lgkmcnt(8)
    s_waitcnt vmcnt(8)
    v_mfma_f32_16x16x32_bf16 v[128:131], v[228:231], v[208:211], v[128:131]
    ds_read_b64_tr_b16 v[224:225], v71 offset:24960
    v_mfma_f32_16x16x32_bf16 v[132:135], v[228:231], v[212:215], v[132:135]
    ds_read_b64_tr_b16 v[226:227], v71 offset:25472
    buffer_load_dwordx4 v[200:203], v2, s[32:35], s16 offen offset:2048 sc1
    v_mfma_f32_16x16x32_bf16 v[136:139], v[232:235], v[208:211], v[136:139]
    ds_read_b64_tr_b16 v[228:229], v71 offset:24992
    v_mfma_f32_16x16x32_bf16 v[140:143], v[232:235], v[212:215], v[140:143]
    ds_read_b64_tr_b16 v[230:231], v71 offset:25504
    s_waitcnt lgkmcnt(8)
    v_mfma_f32_16x16x32_bf16 v[112:115], v[236:239], v[208:211], v[112:115]
    ds_read_b64_tr_b16 v[232:233], v70 offset:41600
    v_mfma_f32_16x16x32_bf16 v[116:119], v[236:239], v[212:215], v[116:119]
    ds_read_b64_tr_b16 v[234:235], v70 offset:42112
    v_mfma_f32_16x16x32_bf16 v[120:123], v[240:243], v[208:211], v[120:123]
    ds_read_b64_tr_b16 v[236:237], v70 offset:41632
    v_mfma_f32_16x16x32_bf16 v[124:127], v[240:243], v[212:215], v[124:127]
    ds_read_b64_tr_b16 v[238:239], v70 offset:42144
    buffer_load_dwordx4 v[204:207], v2, s[32:35], s16 offen offset:3072 sc1
    s_waitcnt lgkmcnt(8)
    v_mfma_f32_16x16x32_bf16 v[80:83], v[244:247], v[208:211], v[80:83]
    ds_read_b64_tr_b16 v[240:241], v71 offset:41600
    v_mfma_f32_16x16x32_bf16 v[84:87], v[244:247], v[212:215], v[84:87]
    ds_read_b64_tr_b16 v[242:243], v71 offset:42112
    v_mfma_f32_16x16x32_bf16 v[88:91], v[248:251], v[208:211], v[88:91]
    ds_read_b64_tr_b16 v[244:245], v71 offset:41632
    v_mfma_f32_16x16x32_bf16 v[92:95], v[248:251], v[212:215], v[92:95]
    ds_read_b64_tr_b16 v[246:247], v71 offset:42144
    s_waitcnt lgkmcnt(8)
    v_mfma_f32_16x16x32_bf16 v[96:99], v[224:227], v[208:211], v[96:99]
    ds_read_b64_tr_b16 v[248:249], v71 offset:37440
    v_mfma_f32_16x16x32_bf16 v[100:103], v[224:227], v[212:215], v[100:103]
    ds_read_b64_tr_b16 v[250:251], v71 offset:37952
    v_mfma_f32_16x16x32_bf16 v[104:107], v[228:231], v[208:211], v[104:107]
    ds_read_b64_tr_b16 v[224:225], v71 offset:37472
    v_mfma_f32_16x16x32_bf16 v[108:111], v[228:231], v[212:215], v[108:111]
    ds_read_b64_tr_b16 v[226:227], v71 offset:37984
    s_waitcnt lgkmcnt(8)
    v_mfma_f32_16x16x32_bf16 v[144:147], v[232:235], v[208:211], v[144:147]
    ds_read_b64_tr_b16 v[228:229], v70 offset:37440
    v_mfma_f32_16x16x32_bf16 v[148:151], v[232:235], v[212:215], v[148:151]
    ds_read_b64_tr_b16 v[230:231], v70 offset:37952
    v_mfma_f32_16x16x32_bf16 v[152:155], v[236:239], v[208:211], v[152:155]
    ds_read_b64_tr_b16 v[232:233], v70 offset:37472
    v_mfma_f32_16x16x32_bf16 v[156:159], v[236:239], v[212:215], v[156:159]
    ds_read_b64_tr_b16 v[234:235], v70 offset:37984
    s_waitcnt lgkmcnt(8)
    v_mfma_f32_16x16x32_bf16 v[160:163], v[240:243], v[208:211], v[160:163]
    ds_read_b64_tr_b16 v[236:237], v70 offset:29120
    v_mfma_f32_16x16x32_bf16 v[164:167], v[240:243], v[212:215], v[164:167]
    ds_read_b64_tr_b16 v[238:239], v70 offset:29632
    v_mfma_f32_16x16x32_bf16 v[168:171], v[244:247], v[208:211], v[168:171]
    ds_read_b64_tr_b16 v[240:241], v70 offset:29152
    v_mfma_f32_16x16x32_bf16 v[172:175], v[244:247], v[212:215], v[172:175]
    ds_read_b64_tr_b16 v[242:243], v70 offset:29664
    s_waitcnt lgkmcnt(8)
    s_waitcnt vmcnt(8)
    v_mfma_f32_16x16x32_bf16 v[128:131], v[248:251], v[216:219], v[128:131]
    ds_read_b64_tr_b16 v[244:245], v71 offset:29120
    v_mfma_f32_16x16x32_bf16 v[132:135], v[248:251], v[220:223], v[132:135]
    ds_read_b64_tr_b16 v[246:247], v71 offset:29632
    s_add_u32 s96, s85, 8
    s_and_b32 s97, s96, 15
    s_lshl_b32 s98, s97, 14
    s_add_u32 s16, s98, s15
    buffer_load_dwordx4 v[208:211], v2, s[32:35], s16 offen sc1
    v_mfma_f32_16x16x32_bf16 v[136:139], v[224:227], v[216:219], v[136:139]
    ds_read_b64_tr_b16 v[248:249], v71 offset:29152
    v_mfma_f32_16x16x32_bf16 v[140:143], v[224:227], v[220:223], v[140:143]
    ds_read_b64_tr_b16 v[250:251], v71 offset:29664
    s_waitcnt lgkmcnt(8)
    v_mfma_f32_16x16x32_bf16 v[112:115], v[228:231], v[216:219], v[112:115]
    ds_read_b64_tr_b16 v[224:225], v70 offset:45760
    v_mfma_f32_16x16x32_bf16 v[116:119], v[228:231], v[220:223], v[116:119]
    ds_read_b64_tr_b16 v[226:227], v70 offset:46272
    v_mfma_f32_16x16x32_bf16 v[120:123], v[232:235], v[216:219], v[120:123]
    ds_read_b64_tr_b16 v[228:229], v70 offset:45792
    v_mfma_f32_16x16x32_bf16 v[124:127], v[232:235], v[220:223], v[124:127]
    ds_read_b64_tr_b16 v[230:231], v70 offset:46304
    buffer_load_dwordx4 v[212:215], v2, s[32:35], s16 offen offset:1024 sc1
    s_waitcnt lgkmcnt(8)
    v_mfma_f32_16x16x32_bf16 v[80:83], v[236:239], v[216:219], v[80:83]
    ds_read_b64_tr_b16 v[232:233], v71 offset:45760
    v_mfma_f32_16x16x32_bf16 v[84:87], v[236:239], v[220:223], v[84:87]
    ds_read_b64_tr_b16 v[234:235], v71 offset:46272
    v_mfma_f32_16x16x32_bf16 v[88:91], v[240:243], v[216:219], v[88:91]
    ds_read_b64_tr_b16 v[236:237], v71 offset:45792
    v_mfma_f32_16x16x32_bf16 v[92:95], v[240:243], v[220:223], v[92:95]
    ds_read_b64_tr_b16 v[238:239], v71 offset:46304
    s_waitcnt lgkmcnt(8)
    v_mfma_f32_16x16x32_bf16 v[96:99], v[244:247], v[216:219], v[96:99]
    s_barrier
    ds_read_b64_tr_b16 v[240:241], v67 offset:8320
    v_mfma_f32_16x16x32_bf16 v[100:103], v[244:247], v[220:223], v[100:103]
    ds_read_b64_tr_b16 v[242:243], v67 offset:8832
    v_mfma_f32_16x16x32_bf16 v[104:107], v[248:251], v[216:219], v[104:107]
    ds_read_b64_tr_b16 v[244:245], v67 offset:8352
    v_mfma_f32_16x16x32_bf16 v[108:111], v[248:251], v[220:223], v[108:111]
    ds_read_b64_tr_b16 v[246:247], v67 offset:8864
    s_waitcnt lgkmcnt(8)
    v_mfma_f32_16x16x32_bf16 v[144:147], v[224:227], v[216:219], v[144:147]
    ds_read_b64_tr_b16 v[248:249], v66 offset:8320
    v_mfma_f32_16x16x32_bf16 v[148:151], v[224:227], v[220:223], v[148:151]
    ds_read_b64_tr_b16 v[250:251], v66 offset:8832
    v_mfma_f32_16x16x32_bf16 v[152:155], v[228:231], v[216:219], v[152:155]
    ds_read_b64_tr_b16 v[224:225], v66 offset:8352
    v_mfma_f32_16x16x32_bf16 v[156:159], v[228:231], v[220:223], v[156:159]
    ds_read_b64_tr_b16 v[226:227], v66 offset:8864
    s_waitcnt lgkmcnt(8)
    v_mfma_f32_16x16x32_bf16 v[160:163], v[232:235], v[216:219], v[160:163]
    ds_read_b64_tr_b16 v[228:229], v66
    v_mfma_f32_16x16x32_bf16 v[164:167], v[232:235], v[220:223], v[164:167]
    ds_read_b64_tr_b16 v[230:231], v66 offset:512
    v_mfma_f32_16x16x32_bf16 v[168:171], v[236:239], v[216:219], v[168:171]
    ds_read_b64_tr_b16 v[232:233], v66 offset:32
    v_mfma_f32_16x16x32_bf16 v[172:175], v[236:239], v[220:223], v[172:175]
    ds_read_b64_tr_b16 v[234:235], v66 offset:544
    s_waitcnt lgkmcnt(8)
    s_waitcnt vmcnt(8)
    v_mfma_f32_16x16x32_bf16 v[128:131], v[240:243], v[176:179], v[128:131]
    ds_read_b64_tr_b16 v[236:237], v67
    v_mfma_f32_16x16x32_bf16 v[132:135], v[240:243], v[180:183], v[132:135]
    ds_read_b64_tr_b16 v[238:239], v67 offset:512
    buffer_load_dwordx4 v[216:219], v2, s[32:35], s16 offen offset:2048 sc1
    v_mfma_f32_16x16x32_bf16 v[136:139], v[244:247], v[176:179], v[136:139]
    ds_read_b64_tr_b16 v[240:241], v67 offset:32
    v_mfma_f32_16x16x32_bf16 v[140:143], v[244:247], v[180:183], v[140:143]
    ds_read_b64_tr_b16 v[242:243], v67 offset:544
    s_waitcnt lgkmcnt(8)
    v_mfma_f32_16x16x32_bf16 v[112:115], v[248:251], v[176:179], v[112:115]
    ds_read_b64_tr_b16 v[244:245], v66 offset:16640
    v_mfma_f32_16x16x32_bf16 v[116:119], v[248:251], v[180:183], v[116:119]
    ds_read_b64_tr_b16 v[246:247], v66 offset:17152
    v_mfma_f32_16x16x32_bf16 v[120:123], v[224:227], v[176:179], v[120:123]
    ds_read_b64_tr_b16 v[248:249], v66 offset:16672
    v_mfma_f32_16x16x32_bf16 v[124:127], v[224:227], v[180:183], v[124:127]
    ds_read_b64_tr_b16 v[250:251], v66 offset:17184
    buffer_load_dwordx4 v[220:223], v2, s[32:35], s16 offen offset:3072 sc1
    s_waitcnt lgkmcnt(8)
    v_mfma_f32_16x16x32_bf16 v[80:83], v[228:231], v[176:179], v[80:83]
    ds_read_b64_tr_b16 v[224:225], v67 offset:16640
    v_mfma_f32_16x16x32_bf16 v[84:87], v[228:231], v[180:183], v[84:87]
    ds_read_b64_tr_b16 v[226:227], v67 offset:17152
    v_mfma_f32_16x16x32_bf16 v[88:91], v[232:235], v[176:179], v[88:91]
    ds_read_b64_tr_b16 v[228:229], v67 offset:16672
    v_mfma_f32_16x16x32_bf16 v[92:95], v[232:235], v[180:183], v[92:95]
    ds_read_b64_tr_b16 v[230:231], v67 offset:17184
    s_waitcnt lgkmcnt(8)
    v_mfma_f32_16x16x32_bf16 v[96:99], v[236:239], v[176:179], v[96:99]
    ds_read_b64_tr_b16 v[232:233], v67 offset:12480
    v_mfma_f32_16x16x32_bf16 v[100:103], v[236:239], v[180:183], v[100:103]
    ds_read_b64_tr_b16 v[234:235], v67 offset:12992
    v_mfma_f32_16x16x32_bf16 v[104:107], v[240:243], v[176:179], v[104:107]
    ds_read_b64_tr_b16 v[236:237], v67 offset:12512
    v_mfma_f32_16x16x32_bf16 v[108:111], v[240:243], v[180:183], v[108:111]
    ds_read_b64_tr_b16 v[238:239], v67 offset:13024
    s_waitcnt lgkmcnt(8)
    v_mfma_f32_16x16x32_bf16 v[144:147], v[244:247], v[176:179], v[144:147]
    ds_read_b64_tr_b16 v[240:241], v66 offset:12480
    v_mfma_f32_16x16x32_bf16 v[148:151], v[244:247], v[180:183], v[148:151]
    ds_read_b64_tr_b16 v[242:243], v66 offset:12992
    v_mfma_f32_16x16x32_bf16 v[152:155], v[248:251], v[176:179], v[152:155]
    ds_read_b64_tr_b16 v[244:245], v66 offset:12512
    v_mfma_f32_16x16x32_bf16 v[156:159], v[248:251], v[180:183], v[156:159]
    ds_read_b64_tr_b16 v[246:247], v66 offset:13024
    s_waitcnt lgkmcnt(8)
    v_mfma_f32_16x16x32_bf16 v[160:163], v[224:227], v[176:179], v[160:163]
    ds_read_b64_tr_b16 v[248:249], v66 offset:4160
    v_mfma_f32_16x16x32_bf16 v[164:167], v[224:227], v[180:183], v[164:167]
    ds_read_b64_tr_b16 v[250:251], v66 offset:4672
    v_mfma_f32_16x16x32_bf16 v[168:171], v[228:231], v[176:179], v[168:171]
    ds_read_b64_tr_b16 v[224:225], v66 offset:4192
    v_mfma_f32_16x16x32_bf16 v[172:175], v[228:231], v[180:183], v[172:175]
    ds_read_b64_tr_b16 v[226:227], v66 offset:4704
    s_waitcnt lgkmcnt(8)
    s_waitcnt vmcnt(8)
    v_mfma_f32_16x16x32_bf16 v[128:131], v[232:235], v[184:187], v[128:131]
    ds_read_b64_tr_b16 v[228:229], v67 offset:4160
    v_mfma_f32_16x16x32_bf16 v[132:135], v[232:235], v[188:191], v[132:135]
    ds_read_b64_tr_b16 v[230:231], v67 offset:4672
    s_add_u32 s96, s85, 9
    s_and_b32 s97, s96, 15
    s_lshl_b32 s98, s97, 14
    s_add_u32 s16, s98, s15
    buffer_load_dwordx4 v[176:179], v2, s[32:35], s16 offen sc1
    v_mfma_f32_16x16x32_bf16 v[136:139], v[236:239], v[184:187], v[136:139]
    ds_read_b64_tr_b16 v[232:233], v67 offset:4192
    v_mfma_f32_16x16x32_bf16 v[140:143], v[236:239], v[188:191], v[140:143]
    ds_read_b64_tr_b16 v[234:235], v67 offset:4704
    s_waitcnt lgkmcnt(8)
    v_mfma_f32_16x16x32_bf16 v[112:115], v[240:243], v[184:187], v[112:115]
    ds_read_b64_tr_b16 v[236:237], v66 offset:20800
    v_mfma_f32_16x16x32_bf16 v[116:119], v[240:243], v[188:191], v[116:119]
    ds_read_b64_tr_b16 v[238:239], v66 offset:21312
    v_mfma_f32_16x16x32_bf16 v[120:123], v[244:247], v[184:187], v[120:123]
    ds_read_b64_tr_b16 v[240:241], v66 offset:20832
    v_mfma_f32_16x16x32_bf16 v[124:127], v[244:247], v[188:191], v[124:127]
    ds_read_b64_tr_b16 v[242:243], v66 offset:21344
    buffer_load_dwordx4 v[180:183], v2, s[32:35], s16 offen offset:1024 sc1
    s_waitcnt lgkmcnt(8)
    v_mfma_f32_16x16x32_bf16 v[80:83], v[248:251], v[184:187], v[80:83]
    ds_read_b64_tr_b16 v[244:245], v67 offset:20800
    v_mfma_f32_16x16x32_bf16 v[84:87], v[248:251], v[188:191], v[84:87]
    ds_read_b64_tr_b16 v[246:247], v67 offset:21312
    v_mfma_f32_16x16x32_bf16 v[88:91], v[224:227], v[184:187], v[88:91]
    ds_read_b64_tr_b16 v[248:249], v67 offset:20832
    v_mfma_f32_16x16x32_bf16 v[92:95], v[224:227], v[188:191], v[92:95]
    ds_read_b64_tr_b16 v[250:251], v67 offset:21344
    s_waitcnt lgkmcnt(8)
    v_mfma_f32_16x16x32_bf16 v[96:99], v[228:231], v[184:187], v[96:99]
    s_barrier
    ds_read_b64_tr_b16 v[224:225], v67 offset:33280
    v_mfma_f32_16x16x32_bf16 v[100:103], v[228:231], v[188:191], v[100:103]
    ds_read_b64_tr_b16 v[226:227], v67 offset:33792
    v_mfma_f32_16x16x32_bf16 v[104:107], v[232:235], v[184:187], v[104:107]
    ds_read_b64_tr_b16 v[228:229], v67 offset:33312
    v_mfma_f32_16x16x32_bf16 v[108:111], v[232:235], v[188:191], v[108:111]
    ds_read_b64_tr_b16 v[230:231], v67 offset:33824
    s_waitcnt lgkmcnt(8)
    v_mfma_f32_16x16x32_bf16 v[144:147], v[236:239], v[184:187], v[144:147]
    ds_read_b64_tr_b16 v[232:233], v66 offset:33280
    v_mfma_f32_16x16x32_bf16 v[148:151], v[236:239], v[188:191], v[148:151]
    ds_read_b64_tr_b16 v[234:235], v66 offset:33792
    v_mfma_f32_16x16x32_bf16 v[152:155], v[240:243], v[184:187], v[152:155]
    ds_read_b64_tr_b16 v[236:237], v66 offset:33312
    v_mfma_f32_16x16x32_bf16 v[156:159], v[240:243], v[188:191], v[156:159]
    ds_read_b64_tr_b16 v[238:239], v66 offset:33824
    s_waitcnt lgkmcnt(8)
    v_mfma_f32_16x16x32_bf16 v[160:163], v[244:247], v[184:187], v[160:163]
    ds_read_b64_tr_b16 v[240:241], v66 offset:24960
    v_mfma_f32_16x16x32_bf16 v[164:167], v[244:247], v[188:191], v[164:167]
    ds_read_b64_tr_b16 v[242:243], v66 offset:25472
    v_mfma_f32_16x16x32_bf16 v[168:171], v[248:251], v[184:187], v[168:171]
    ds_read_b64_tr_b16 v[244:245], v66 offset:24992
    v_mfma_f32_16x16x32_bf16 v[172:175], v[248:251], v[188:191], v[172:175]
    ds_read_b64_tr_b16 v[246:247], v66 offset:25504
    s_waitcnt lgkmcnt(8)
    s_waitcnt vmcnt(8)
    v_mfma_f32_16x16x32_bf16 v[128:131], v[224:227], v[192:195], v[128:131]
    ds_read_b64_tr_b16 v[248:249], v67 offset:24960
    v_mfma_f32_16x16x32_bf16 v[132:135], v[224:227], v[196:199], v[132:135]
    ds_read_b64_tr_b16 v[250:251], v67 offset:25472
    buffer_load_dwordx4 v[184:187], v2, s[32:35], s16 offen offset:2048 sc1
    v_mfma_f32_16x16x32_bf16 v[136:139], v[228:231], v[192:195], v[136:139]
    ds_read_b64_tr_b16 v[224:225], v67 offset:24992
    v_mfma_f32_16x16x32_bf16 v[140:143], v[228:231], v[196:199], v[140:143]
    ds_read_b64_tr_b16 v[226:227], v67 offset:25504
    s_waitcnt lgkmcnt(8)
    v_mfma_f32_16x16x32_bf16 v[112:115], v[232:235], v[192:195], v[112:115]
    ds_read_b64_tr_b16 v[228:229], v66 offset:41600
    v_mfma_f32_16x16x32_bf16 v[116:119], v[232:235], v[196:199], v[116:119]
    ds_read_b64_tr_b16 v[230:231], v66 offset:42112
    v_mfma_f32_16x16x32_bf16 v[120:123], v[236:239], v[192:195], v[120:123]
    ds_read_b64_tr_b16 v[232:233], v66 offset:41632
    v_mfma_f32_16x16x32_bf16 v[124:127], v[236:239], v[196:199], v[124:127]
    ds_read_b64_tr_b16 v[234:235], v66 offset:42144
    buffer_load_dwordx4 v[188:191], v2, s[32:35], s16 offen offset:3072 sc1
    s_waitcnt lgkmcnt(8)
    v_mfma_f32_16x16x32_bf16 v[80:83], v[240:243], v[192:195], v[80:83]
    ds_read_b64_tr_b16 v[236:237], v67 offset:41600
    v_mfma_f32_16x16x32_bf16 v[84:87], v[240:243], v[196:199], v[84:87]
    ds_read_b64_tr_b16 v[238:239], v67 offset:42112
    v_mfma_f32_16x16x32_bf16 v[88:91], v[244:247], v[192:195], v[88:91]
    ds_read_b64_tr_b16 v[240:241], v67 offset:41632
    v_mfma_f32_16x16x32_bf16 v[92:95], v[244:247], v[196:199], v[92:95]
    ds_read_b64_tr_b16 v[242:243], v67 offset:42144
    s_waitcnt lgkmcnt(8)
    v_mfma_f32_16x16x32_bf16 v[96:99], v[248:251], v[192:195], v[96:99]
    ds_read_b64_tr_b16 v[244:245], v67 offset:37440
    v_mfma_f32_16x16x32_bf16 v[100:103], v[248:251], v[196:199], v[100:103]
    ds_read_b64_tr_b16 v[246:247], v67 offset:37952
    v_mfma_f32_16x16x32_bf16 v[104:107], v[224:227], v[192:195], v[104:107]
    ds_read_b64_tr_b16 v[248:249], v67 offset:37472
    v_mfma_f32_16x16x32_bf16 v[108:111], v[224:227], v[196:199], v[108:111]
    ds_read_b64_tr_b16 v[250:251], v67 offset:37984
    s_waitcnt lgkmcnt(8)
    v_mfma_f32_16x16x32_bf16 v[144:147], v[228:231], v[192:195], v[144:147]
    ds_read_b64_tr_b16 v[224:225], v66 offset:37440
    v_mfma_f32_16x16x32_bf16 v[148:151], v[228:231], v[196:199], v[148:151]
    ds_read_b64_tr_b16 v[226:227], v66 offset:37952
    v_mfma_f32_16x16x32_bf16 v[152:155], v[232:235], v[192:195], v[152:155]
    ds_read_b64_tr_b16 v[228:229], v66 offset:37472
    v_mfma_f32_16x16x32_bf16 v[156:159], v[232:235], v[196:199], v[156:159]
    ds_read_b64_tr_b16 v[230:231], v66 offset:37984
    s_waitcnt lgkmcnt(8)
    v_mfma_f32_16x16x32_bf16 v[160:163], v[236:239], v[192:195], v[160:163]
    ds_read_b64_tr_b16 v[232:233], v66 offset:29120
    v_mfma_f32_16x16x32_bf16 v[164:167], v[236:239], v[196:199], v[164:167]
    ds_read_b64_tr_b16 v[234:235], v66 offset:29632
    v_mfma_f32_16x16x32_bf16 v[168:171], v[240:243], v[192:195], v[168:171]
    ds_read_b64_tr_b16 v[236:237], v66 offset:29152
    v_mfma_f32_16x16x32_bf16 v[172:175], v[240:243], v[196:199], v[172:175]
    ds_read_b64_tr_b16 v[238:239], v66 offset:29664
    s_waitcnt lgkmcnt(8)
    s_waitcnt vmcnt(8)
    v_mfma_f32_16x16x32_bf16 v[128:131], v[244:247], v[200:203], v[128:131]
    ds_read_b64_tr_b16 v[240:241], v67 offset:29120
    v_mfma_f32_16x16x32_bf16 v[132:135], v[244:247], v[204:207], v[132:135]
    ds_read_b64_tr_b16 v[242:243], v67 offset:29632
    s_add_u32 s96, s85, 10
    s_and_b32 s97, s96, 15
    s_lshl_b32 s98, s97, 14
    s_add_u32 s16, s98, s15
    buffer_load_dwordx4 v[192:195], v2, s[32:35], s16 offen sc1
    v_mfma_f32_16x16x32_bf16 v[136:139], v[248:251], v[200:203], v[136:139]
    ds_read_b64_tr_b16 v[244:245], v67 offset:29152
    v_mfma_f32_16x16x32_bf16 v[140:143], v[248:251], v[204:207], v[140:143]
    ds_read_b64_tr_b16 v[246:247], v67 offset:29664
    s_waitcnt lgkmcnt(8)
    v_mfma_f32_16x16x32_bf16 v[112:115], v[224:227], v[200:203], v[112:115]
    ds_read_b64_tr_b16 v[248:249], v66 offset:45760
    v_mfma_f32_16x16x32_bf16 v[116:119], v[224:227], v[204:207], v[116:119]
    ds_read_b64_tr_b16 v[250:251], v66 offset:46272
    v_mfma_f32_16x16x32_bf16 v[120:123], v[228:231], v[200:203], v[120:123]
    ds_read_b64_tr_b16 v[224:225], v66 offset:45792
    v_mfma_f32_16x16x32_bf16 v[124:127], v[228:231], v[204:207], v[124:127]
    ds_read_b64_tr_b16 v[226:227], v66 offset:46304
    buffer_load_dwordx4 v[196:199], v2, s[32:35], s16 offen offset:1024 sc1
    s_waitcnt lgkmcnt(8)
    v_mfma_f32_16x16x32_bf16 v[80:83], v[232:235], v[200:203], v[80:83]
    ds_read_b64_tr_b16 v[228:229], v67 offset:45760
    v_mfma_f32_16x16x32_bf16 v[84:87], v[232:235], v[204:207], v[84:87]
    ds_read_b64_tr_b16 v[230:231], v67 offset:46272
    v_mfma_f32_16x16x32_bf16 v[88:91], v[236:239], v[200:203], v[88:91]
    ds_read_b64_tr_b16 v[232:233], v67 offset:45792
    v_mfma_f32_16x16x32_bf16 v[92:95], v[236:239], v[204:207], v[92:95]
    ds_read_b64_tr_b16 v[234:235], v67 offset:46304
    s_waitcnt lgkmcnt(8)
    v_mfma_f32_16x16x32_bf16 v[96:99], v[240:243], v[200:203], v[96:99]
    s_barrier
    ds_read_b64_tr_b16 v[236:237], v69 offset:8320
    v_mfma_f32_16x16x32_bf16 v[100:103], v[240:243], v[204:207], v[100:103]
    ds_read_b64_tr_b16 v[238:239], v69 offset:8832
    v_mfma_f32_16x16x32_bf16 v[104:107], v[244:247], v[200:203], v[104:107]
    ds_read_b64_tr_b16 v[240:241], v69 offset:8352
    v_mfma_f32_16x16x32_bf16 v[108:111], v[244:247], v[204:207], v[108:111]
    ds_read_b64_tr_b16 v[242:243], v69 offset:8864
    s_waitcnt lgkmcnt(8)
    v_mfma_f32_16x16x32_bf16 v[144:147], v[248:251], v[200:203], v[144:147]
    ds_read_b64_tr_b16 v[244:245], v68 offset:8320
    v_mfma_f32_16x16x32_bf16 v[148:151], v[248:251], v[204:207], v[148:151]
    ds_read_b64_tr_b16 v[246:247], v68 offset:8832
    v_mfma_f32_16x16x32_bf16 v[152:155], v[224:227], v[200:203], v[152:155]
    ds_read_b64_tr_b16 v[248:249], v68 offset:8352
    v_mfma_f32_16x16x32_bf16 v[156:159], v[224:227], v[204:207], v[156:159]
    ds_read_b64_tr_b16 v[250:251], v68 offset:8864
    s_waitcnt lgkmcnt(8)
    v_mfma_f32_16x16x32_bf16 v[160:163], v[228:231], v[200:203], v[160:163]
    ds_read_b64_tr_b16 v[224:225], v68
    v_mfma_f32_16x16x32_bf16 v[164:167], v[228:231], v[204:207], v[164:167]
    ds_read_b64_tr_b16 v[226:227], v68 offset:512
    v_mfma_f32_16x16x32_bf16 v[168:171], v[232:235], v[200:203], v[168:171]
    ds_read_b64_tr_b16 v[228:229], v68 offset:32
    v_mfma_f32_16x16x32_bf16 v[172:175], v[232:235], v[204:207], v[172:175]
    ds_read_b64_tr_b16 v[230:231], v68 offset:544
    s_waitcnt lgkmcnt(8)
    s_waitcnt vmcnt(8)
    v_mfma_f32_16x16x32_bf16 v[128:131], v[236:239], v[208:211], v[128:131]
    ds_read_b64_tr_b16 v[232:233], v69
    v_mfma_f32_16x16x32_bf16 v[132:135], v[236:239], v[212:215], v[132:135]
    ds_read_b64_tr_b16 v[234:235], v69 offset:512
    buffer_load_dwordx4 v[200:203], v2, s[32:35], s16 offen offset:2048 sc1
    v_mfma_f32_16x16x32_bf16 v[136:139], v[240:243], v[208:211], v[136:139]
    ds_read_b64_tr_b16 v[236:237], v69 offset:32
    v_mfma_f32_16x16x32_bf16 v[140:143], v[240:243], v[212:215], v[140:143]
    ds_read_b64_tr_b16 v[238:239], v69 offset:544
    s_waitcnt lgkmcnt(8)
    v_mfma_f32_16x16x32_bf16 v[112:115], v[244:247], v[208:211], v[112:115]
    ds_read_b64_tr_b16 v[240:241], v68 offset:16640
    v_mfma_f32_16x16x32_bf16 v[116:119], v[244:247], v[212:215], v[116:119]
    ds_read_b64_tr_b16 v[242:243], v68 offset:17152
    v_mfma_f32_16x16x32_bf16 v[120:123], v[248:251], v[208:211], v[120:123]
    ds_read_b64_tr_b16 v[244:245], v68 offset:16672
    v_mfma_f32_16x16x32_bf16 v[124:127], v[248:251], v[212:215], v[124:127]
    ds_read_b64_tr_b16 v[246:247], v68 offset:17184
    buffer_load_dwordx4 v[204:207], v2, s[32:35], s16 offen offset:3072 sc1
    s_waitcnt lgkmcnt(8)
    v_mfma_f32_16x16x32_bf16 v[80:83], v[224:227], v[208:211], v[80:83]
    ds_read_b64_tr_b16 v[248:249], v69 offset:16640
    v_mfma_f32_16x16x32_bf16 v[84:87], v[224:227], v[212:215], v[84:87]
    ds_read_b64_tr_b16 v[250:251], v69 offset:17152
    v_mfma_f32_16x16x32_bf16 v[88:91], v[228:231], v[208:211], v[88:91]
    ds_read_b64_tr_b16 v[224:225], v69 offset:16672
    v_mfma_f32_16x16x32_bf16 v[92:95], v[228:231], v[212:215], v[92:95]
    ds_read_b64_tr_b16 v[226:227], v69 offset:17184
    s_waitcnt lgkmcnt(8)
    v_mfma_f32_16x16x32_bf16 v[96:99], v[232:235], v[208:211], v[96:99]
    ds_read_b64_tr_b16 v[228:229], v69 offset:12480
    v_mfma_f32_16x16x32_bf16 v[100:103], v[232:235], v[212:215], v[100:103]
    ds_read_b64_tr_b16 v[230:231], v69 offset:12992
    v_mfma_f32_16x16x32_bf16 v[104:107], v[236:239], v[208:211], v[104:107]
    ds_read_b64_tr_b16 v[232:233], v69 offset:12512
    v_mfma_f32_16x16x32_bf16 v[108:111], v[236:239], v[212:215], v[108:111]
    ds_read_b64_tr_b16 v[234:235], v69 offset:13024
    s_waitcnt lgkmcnt(8)
    v_mfma_f32_16x16x32_bf16 v[144:147], v[240:243], v[208:211], v[144:147]
    ds_read_b64_tr_b16 v[236:237], v68 offset:12480
    v_mfma_f32_16x16x32_bf16 v[148:151], v[240:243], v[212:215], v[148:151]
    ds_read_b64_tr_b16 v[238:239], v68 offset:12992
    v_mfma_f32_16x16x32_bf16 v[152:155], v[244:247], v[208:211], v[152:155]
    ds_read_b64_tr_b16 v[240:241], v68 offset:12512
    v_mfma_f32_16x16x32_bf16 v[156:159], v[244:247], v[212:215], v[156:159]
    ds_read_b64_tr_b16 v[242:243], v68 offset:13024
    s_waitcnt lgkmcnt(8)
    v_mfma_f32_16x16x32_bf16 v[160:163], v[248:251], v[208:211], v[160:163]
    ds_read_b64_tr_b16 v[244:245], v68 offset:4160
    v_mfma_f32_16x16x32_bf16 v[164:167], v[248:251], v[212:215], v[164:167]
    ds_read_b64_tr_b16 v[246:247], v68 offset:4672
    v_mfma_f32_16x16x32_bf16 v[168:171], v[224:227], v[208:211], v[168:171]
    ds_read_b64_tr_b16 v[248:249], v68 offset:4192
    v_mfma_f32_16x16x32_bf16 v[172:175], v[224:227], v[212:215], v[172:175]
    ds_read_b64_tr_b16 v[250:251], v68 offset:4704
    s_waitcnt lgkmcnt(8)
    s_waitcnt vmcnt(8)
    v_mfma_f32_16x16x32_bf16 v[128:131], v[228:231], v[216:219], v[128:131]
    ds_read_b64_tr_b16 v[224:225], v69 offset:4160
    v_mfma_f32_16x16x32_bf16 v[132:135], v[228:231], v[220:223], v[132:135]
    ds_read_b64_tr_b16 v[226:227], v69 offset:4672
    s_add_u32 s96, s85, 11
    s_and_b32 s97, s96, 15
    s_lshl_b32 s98, s97, 14
    s_add_u32 s16, s98, s15
    buffer_load_dwordx4 v[208:211], v2, s[32:35], s16 offen sc1
    v_mfma_f32_16x16x32_bf16 v[136:139], v[232:235], v[216:219], v[136:139]
    ds_read_b64_tr_b16 v[228:229], v69 offset:4192
    v_mfma_f32_16x16x32_bf16 v[140:143], v[232:235], v[220:223], v[140:143]
    ds_read_b64_tr_b16 v[230:231], v69 offset:4704
    s_waitcnt lgkmcnt(8)
    v_mfma_f32_16x16x32_bf16 v[112:115], v[236:239], v[216:219], v[112:115]
    ds_read_b64_tr_b16 v[232:233], v68 offset:20800
    v_mfma_f32_16x16x32_bf16 v[116:119], v[236:239], v[220:223], v[116:119]
    ds_read_b64_tr_b16 v[234:235], v68 offset:21312
    v_mfma_f32_16x16x32_bf16 v[120:123], v[240:243], v[216:219], v[120:123]
    ds_read_b64_tr_b16 v[236:237], v68 offset:20832
    v_mfma_f32_16x16x32_bf16 v[124:127], v[240:243], v[220:223], v[124:127]
    ds_read_b64_tr_b16 v[238:239], v68 offset:21344
    buffer_load_dwordx4 v[212:215], v2, s[32:35], s16 offen offset:1024 sc1
    s_waitcnt lgkmcnt(8)
    v_mfma_f32_16x16x32_bf16 v[80:83], v[244:247], v[216:219], v[80:83]
    ds_read_b64_tr_b16 v[240:241], v69 offset:20800
    v_mfma_f32_16x16x32_bf16 v[84:87], v[244:247], v[220:223], v[84:87]
    ds_read_b64_tr_b16 v[242:243], v69 offset:21312
    v_mfma_f32_16x16x32_bf16 v[88:91], v[248:251], v[216:219], v[88:91]
    ds_read_b64_tr_b16 v[244:245], v69 offset:20832
    v_mfma_f32_16x16x32_bf16 v[92:95], v[248:251], v[220:223], v[92:95]
    ds_read_b64_tr_b16 v[246:247], v69 offset:21344
    s_waitcnt lgkmcnt(8)
    v_mfma_f32_16x16x32_bf16 v[96:99], v[224:227], v[216:219], v[96:99]
    s_barrier
    ds_read_b64_tr_b16 v[248:249], v69 offset:33280
    v_mfma_f32_16x16x32_bf16 v[100:103], v[224:227], v[220:223], v[100:103]
    ds_read_b64_tr_b16 v[250:251], v69 offset:33792
    v_mfma_f32_16x16x32_bf16 v[104:107], v[228:231], v[216:219], v[104:107]
    ds_read_b64_tr_b16 v[224:225], v69 offset:33312
    v_mfma_f32_16x16x32_bf16 v[108:111], v[228:231], v[220:223], v[108:111]
    ds_read_b64_tr_b16 v[226:227], v69 offset:33824
    s_waitcnt lgkmcnt(8)
    v_mfma_f32_16x16x32_bf16 v[144:147], v[232:235], v[216:219], v[144:147]
    ds_read_b64_tr_b16 v[228:229], v68 offset:33280
    v_mfma_f32_16x16x32_bf16 v[148:151], v[232:235], v[220:223], v[148:151]
    ds_read_b64_tr_b16 v[230:231], v68 offset:33792
    v_mfma_f32_16x16x32_bf16 v[152:155], v[236:239], v[216:219], v[152:155]
    ds_read_b64_tr_b16 v[232:233], v68 offset:33312
    v_mfma_f32_16x16x32_bf16 v[156:159], v[236:239], v[220:223], v[156:159]
    ds_read_b64_tr_b16 v[234:235], v68 offset:33824
    s_waitcnt lgkmcnt(8)
    v_mfma_f32_16x16x32_bf16 v[160:163], v[240:243], v[216:219], v[160:163]
    ds_read_b64_tr_b16 v[236:237], v68 offset:24960
    v_mfma_f32_16x16x32_bf16 v[164:167], v[240:243], v[220:223], v[164:167]
    ds_read_b64_tr_b16 v[238:239], v68 offset:25472
    v_mfma_f32_16x16x32_bf16 v[168:171], v[244:247], v[216:219], v[168:171]
    ds_read_b64_tr_b16 v[240:241], v68 offset:24992
    v_mfma_f32_16x16x32_bf16 v[172:175], v[244:247], v[220:223], v[172:175]
    ds_read_b64_tr_b16 v[242:243], v68 offset:25504
    s_waitcnt lgkmcnt(8)
    s_waitcnt vmcnt(8)
    v_mfma_f32_16x16x32_bf16 v[128:131], v[248:251], v[176:179], v[128:131]
    ds_read_b64_tr_b16 v[244:245], v69 offset:24960
    v_mfma_f32_16x16x32_bf16 v[132:135], v[248:251], v[180:183], v[132:135]
    ds_read_b64_tr_b16 v[246:247], v69 offset:25472
    buffer_load_dwordx4 v[216:219], v2, s[32:35], s16 offen offset:2048 sc1
    v_mfma_f32_16x16x32_bf16 v[136:139], v[224:227], v[176:179], v[136:139]
    ds_read_b64_tr_b16 v[248:249], v69 offset:24992
    v_mfma_f32_16x16x32_bf16 v[140:143], v[224:227], v[180:183], v[140:143]
    ds_read_b64_tr_b16 v[250:251], v69 offset:25504
    s_waitcnt lgkmcnt(8)
    v_mfma_f32_16x16x32_bf16 v[112:115], v[228:231], v[176:179], v[112:115]
    ds_read_b64_tr_b16 v[224:225], v68 offset:41600
    v_mfma_f32_16x16x32_bf16 v[116:119], v[228:231], v[180:183], v[116:119]
    ds_read_b64_tr_b16 v[226:227], v68 offset:42112
    v_mfma_f32_16x16x32_bf16 v[120:123], v[232:235], v[176:179], v[120:123]
    ds_read_b64_tr_b16 v[228:229], v68 offset:41632
    v_mfma_f32_16x16x32_bf16 v[124:127], v[232:235], v[180:183], v[124:127]
    ds_read_b64_tr_b16 v[230:231], v68 offset:42144
    buffer_load_dwordx4 v[220:223], v2, s[32:35], s16 offen offset:3072 sc1
    s_waitcnt lgkmcnt(8)
    v_mfma_f32_16x16x32_bf16 v[80:83], v[236:239], v[176:179], v[80:83]
    ds_read_b64_tr_b16 v[232:233], v69 offset:41600
    v_mfma_f32_16x16x32_bf16 v[84:87], v[236:239], v[180:183], v[84:87]
    ds_read_b64_tr_b16 v[234:235], v69 offset:42112
    v_mfma_f32_16x16x32_bf16 v[88:91], v[240:243], v[176:179], v[88:91]
    ds_read_b64_tr_b16 v[236:237], v69 offset:41632
    v_mfma_f32_16x16x32_bf16 v[92:95], v[240:243], v[180:183], v[92:95]
    ds_read_b64_tr_b16 v[238:239], v69 offset:42144
    s_waitcnt lgkmcnt(8)
    v_mfma_f32_16x16x32_bf16 v[96:99], v[244:247], v[176:179], v[96:99]
    ds_read_b64_tr_b16 v[240:241], v69 offset:37440
    v_mfma_f32_16x16x32_bf16 v[100:103], v[244:247], v[180:183], v[100:103]
    ds_read_b64_tr_b16 v[242:243], v69 offset:37952
    v_mfma_f32_16x16x32_bf16 v[104:107], v[248:251], v[176:179], v[104:107]
    ds_read_b64_tr_b16 v[244:245], v69 offset:37472
    v_mfma_f32_16x16x32_bf16 v[108:111], v[248:251], v[180:183], v[108:111]
    ds_read_b64_tr_b16 v[246:247], v69 offset:37984
    s_waitcnt lgkmcnt(8)
    v_mfma_f32_16x16x32_bf16 v[144:147], v[224:227], v[176:179], v[144:147]
    ds_read_b64_tr_b16 v[248:249], v68 offset:37440
    v_mfma_f32_16x16x32_bf16 v[148:151], v[224:227], v[180:183], v[148:151]
    ds_read_b64_tr_b16 v[250:251], v68 offset:37952
    v_mfma_f32_16x16x32_bf16 v[152:155], v[228:231], v[176:179], v[152:155]
    ds_read_b64_tr_b16 v[224:225], v68 offset:37472
    v_mfma_f32_16x16x32_bf16 v[156:159], v[228:231], v[180:183], v[156:159]
    ds_read_b64_tr_b16 v[226:227], v68 offset:37984
    s_waitcnt lgkmcnt(8)
    v_mfma_f32_16x16x32_bf16 v[160:163], v[232:235], v[176:179], v[160:163]
    ds_read_b64_tr_b16 v[228:229], v68 offset:29120
    v_mfma_f32_16x16x32_bf16 v[164:167], v[232:235], v[180:183], v[164:167]
    ds_read_b64_tr_b16 v[230:231], v68 offset:29632
    v_mfma_f32_16x16x32_bf16 v[168:171], v[236:239], v[176:179], v[168:171]
    ds_read_b64_tr_b16 v[232:233], v68 offset:29152
    v_mfma_f32_16x16x32_bf16 v[172:175], v[236:239], v[180:183], v[172:175]
    ds_read_b64_tr_b16 v[234:235], v68 offset:29664
    s_waitcnt lgkmcnt(8)
    s_waitcnt vmcnt(8)
    v_mfma_f32_16x16x32_bf16 v[128:131], v[240:243], v[184:187], v[128:131]
    ds_read_b64_tr_b16 v[236:237], v69 offset:29120
    v_mfma_f32_16x16x32_bf16 v[132:135], v[240:243], v[188:191], v[132:135]
    ds_read_b64_tr_b16 v[238:239], v69 offset:29632
    s_add_u32 s96, s85, 12
    s_and_b32 s97, s96, 15
    s_lshl_b32 s98, s97, 14
    s_add_u32 s16, s98, s15
    buffer_load_dwordx4 v[176:179], v2, s[32:35], s16 offen sc1
    v_mfma_f32_16x16x32_bf16 v[136:139], v[244:247], v[184:187], v[136:139]
    ds_read_b64_tr_b16 v[240:241], v69 offset:29152
    v_mfma_f32_16x16x32_bf16 v[140:143], v[244:247], v[188:191], v[140:143]
    ds_read_b64_tr_b16 v[242:243], v69 offset:29664
    s_waitcnt lgkmcnt(8)
    v_mfma_f32_16x16x32_bf16 v[112:115], v[248:251], v[184:187], v[112:115]
    ds_read_b64_tr_b16 v[244:245], v68 offset:45760
    v_mfma_f32_16x16x32_bf16 v[116:119], v[248:251], v[188:191], v[116:119]
    ds_read_b64_tr_b16 v[246:247], v68 offset:46272
    v_mfma_f32_16x16x32_bf16 v[120:123], v[224:227], v[184:187], v[120:123]
    ds_read_b64_tr_b16 v[248:249], v68 offset:45792
    v_mfma_f32_16x16x32_bf16 v[124:127], v[224:227], v[188:191], v[124:127]
    ds_read_b64_tr_b16 v[250:251], v68 offset:46304
    buffer_load_dwordx4 v[180:183], v2, s[32:35], s16 offen offset:1024 sc1
    s_waitcnt lgkmcnt(8)
    v_mfma_f32_16x16x32_bf16 v[80:83], v[228:231], v[184:187], v[80:83]
    ds_read_b64_tr_b16 v[224:225], v69 offset:45760
    v_mfma_f32_16x16x32_bf16 v[84:87], v[228:231], v[188:191], v[84:87]
    ds_read_b64_tr_b16 v[226:227], v69 offset:46272
    v_mfma_f32_16x16x32_bf16 v[88:91], v[232:235], v[184:187], v[88:91]
    ds_read_b64_tr_b16 v[228:229], v69 offset:45792
    v_mfma_f32_16x16x32_bf16 v[92:95], v[232:235], v[188:191], v[92:95]
    ds_read_b64_tr_b16 v[230:231], v69 offset:46304
    s_waitcnt lgkmcnt(8)
    v_mfma_f32_16x16x32_bf16 v[96:99], v[236:239], v[184:187], v[96:99]
    s_barrier
    ds_read_b64_tr_b16 v[232:233], v71 offset:8320
    v_mfma_f32_16x16x32_bf16 v[100:103], v[236:239], v[188:191], v[100:103]
    ds_read_b64_tr_b16 v[234:235], v71 offset:8832
    v_mfma_f32_16x16x32_bf16 v[104:107], v[240:243], v[184:187], v[104:107]
    ds_read_b64_tr_b16 v[236:237], v71 offset:8352
    v_mfma_f32_16x16x32_bf16 v[108:111], v[240:243], v[188:191], v[108:111]
    ds_read_b64_tr_b16 v[238:239], v71 offset:8864
    s_waitcnt lgkmcnt(8)
    v_mfma_f32_16x16x32_bf16 v[144:147], v[244:247], v[184:187], v[144:147]
    ds_read_b64_tr_b16 v[240:241], v70 offset:8320
    v_mfma_f32_16x16x32_bf16 v[148:151], v[244:247], v[188:191], v[148:151]
    ds_read_b64_tr_b16 v[242:243], v70 offset:8832
    v_mfma_f32_16x16x32_bf16 v[152:155], v[248:251], v[184:187], v[152:155]
    ds_read_b64_tr_b16 v[244:245], v70 offset:8352
    v_mfma_f32_16x16x32_bf16 v[156:159], v[248:251], v[188:191], v[156:159]
    ds_read_b64_tr_b16 v[246:247], v70 offset:8864
    s_waitcnt lgkmcnt(8)
    v_mfma_f32_16x16x32_bf16 v[160:163], v[224:227], v[184:187], v[160:163]
    ds_read_b64_tr_b16 v[248:249], v70
    v_mfma_f32_16x16x32_bf16 v[164:167], v[224:227], v[188:191], v[164:167]
    ds_read_b64_tr_b16 v[250:251], v70 offset:512
    v_mfma_f32_16x16x32_bf16 v[168:171], v[228:231], v[184:187], v[168:171]
    ds_read_b64_tr_b16 v[224:225], v70 offset:32
    v_mfma_f32_16x16x32_bf16 v[172:175], v[228:231], v[188:191], v[172:175]
    ds_read_b64_tr_b16 v[226:227], v70 offset:544
    s_waitcnt lgkmcnt(8)
    s_waitcnt vmcnt(8)
    v_mfma_f32_16x16x32_bf16 v[128:131], v[232:235], v[192:195], v[128:131]
    ds_read_b64_tr_b16 v[228:229], v71
    v_mfma_f32_16x16x32_bf16 v[132:135], v[232:235], v[196:199], v[132:135]
    ds_read_b64_tr_b16 v[230:231], v71 offset:512
    buffer_load_dwordx4 v[184:187], v2, s[32:35], s16 offen offset:2048 sc1
    v_mfma_f32_16x16x32_bf16 v[136:139], v[236:239], v[192:195], v[136:139]
    ds_read_b64_tr_b16 v[232:233], v71 offset:32
    v_mfma_f32_16x16x32_bf16 v[140:143], v[236:239], v[196:199], v[140:143]
    ds_read_b64_tr_b16 v[234:235], v71 offset:544
    s_waitcnt lgkmcnt(8)
    v_mfma_f32_16x16x32_bf16 v[112:115], v[240:243], v[192:195], v[112:115]
    ds_read_b64_tr_b16 v[236:237], v70 offset:16640
    v_mfma_f32_16x16x32_bf16 v[116:119], v[240:243], v[196:199], v[116:119]
    ds_read_b64_tr_b16 v[238:239], v70 offset:17152
    v_mfma_f32_16x16x32_bf16 v[120:123], v[244:247], v[192:195], v[120:123]
    ds_read_b64_tr_b16 v[240:241], v70 offset:16672
    v_mfma_f32_16x16x32_bf16 v[124:127], v[244:247], v[196:199], v[124:127]
    ds_read_b64_tr_b16 v[242:243], v70 offset:17184
    buffer_load_dwordx4 v[188:191], v2, s[32:35], s16 offen offset:3072 sc1
    s_waitcnt lgkmcnt(8)
    v_mfma_f32_16x16x32_bf16 v[80:83], v[248:251], v[192:195], v[80:83]
    ds_read_b64_tr_b16 v[244:245], v71 offset:16640
    v_mfma_f32_16x16x32_bf16 v[84:87], v[248:251], v[196:199], v[84:87]
    ds_read_b64_tr_b16 v[246:247], v71 offset:17152
    v_mfma_f32_16x16x32_bf16 v[88:91], v[224:227], v[192:195], v[88:91]
    ds_read_b64_tr_b16 v[248:249], v71 offset:16672
    v_mfma_f32_16x16x32_bf16 v[92:95], v[224:227], v[196:199], v[92:95]
    ds_read_b64_tr_b16 v[250:251], v71 offset:17184
    s_waitcnt lgkmcnt(8)
    v_mfma_f32_16x16x32_bf16 v[96:99], v[228:231], v[192:195], v[96:99]
    ds_read_b64_tr_b16 v[224:225], v71 offset:12480
    v_mfma_f32_16x16x32_bf16 v[100:103], v[228:231], v[196:199], v[100:103]
    ds_read_b64_tr_b16 v[226:227], v71 offset:12992
    v_mfma_f32_16x16x32_bf16 v[104:107], v[232:235], v[192:195], v[104:107]
    ds_read_b64_tr_b16 v[228:229], v71 offset:12512
    v_mfma_f32_16x16x32_bf16 v[108:111], v[232:235], v[196:199], v[108:111]
    ds_read_b64_tr_b16 v[230:231], v71 offset:13024
    s_waitcnt lgkmcnt(8)
    v_mfma_f32_16x16x32_bf16 v[144:147], v[236:239], v[192:195], v[144:147]
    ds_read_b64_tr_b16 v[232:233], v70 offset:12480
    v_mfma_f32_16x16x32_bf16 v[148:151], v[236:239], v[196:199], v[148:151]
    ds_read_b64_tr_b16 v[234:235], v70 offset:12992
    v_mfma_f32_16x16x32_bf16 v[152:155], v[240:243], v[192:195], v[152:155]
    ds_read_b64_tr_b16 v[236:237], v70 offset:12512
    v_mfma_f32_16x16x32_bf16 v[156:159], v[240:243], v[196:199], v[156:159]
    ds_read_b64_tr_b16 v[238:239], v70 offset:13024
    s_waitcnt lgkmcnt(8)
    v_mfma_f32_16x16x32_bf16 v[160:163], v[244:247], v[192:195], v[160:163]
    ds_read_b64_tr_b16 v[240:241], v70 offset:4160
    v_mfma_f32_16x16x32_bf16 v[164:167], v[244:247], v[196:199], v[164:167]
    ds_read_b64_tr_b16 v[242:243], v70 offset:4672
    v_mfma_f32_16x16x32_bf16 v[168:171], v[248:251], v[192:195], v[168:171]
    ds_read_b64_tr_b16 v[244:245], v70 offset:4192
    v_mfma_f32_16x16x32_bf16 v[172:175], v[248:251], v[196:199], v[172:175]
    ds_read_b64_tr_b16 v[246:247], v70 offset:4704
    s_waitcnt lgkmcnt(8)
    s_waitcnt vmcnt(8)
    v_mfma_f32_16x16x32_bf16 v[128:131], v[224:227], v[200:203], v[128:131]
    ds_read_b64_tr_b16 v[248:249], v71 offset:4160
    v_mfma_f32_16x16x32_bf16 v[132:135], v[224:227], v[204:207], v[132:135]
    ds_read_b64_tr_b16 v[250:251], v71 offset:4672
    s_add_u32 s96, s85, 13
    s_and_b32 s97, s96, 15
    s_lshl_b32 s98, s97, 14
    s_add_u32 s16, s98, s15
    buffer_load_dwordx4 v[192:195], v2, s[32:35], s16 offen sc1
    v_mfma_f32_16x16x32_bf16 v[136:139], v[228:231], v[200:203], v[136:139]
    ds_read_b64_tr_b16 v[224:225], v71 offset:4192
    v_mfma_f32_16x16x32_bf16 v[140:143], v[228:231], v[204:207], v[140:143]
    ds_read_b64_tr_b16 v[226:227], v71 offset:4704
    s_waitcnt lgkmcnt(8)
    v_mfma_f32_16x16x32_bf16 v[112:115], v[232:235], v[200:203], v[112:115]
    ds_read_b64_tr_b16 v[228:229], v70 offset:20800
    v_mfma_f32_16x16x32_bf16 v[116:119], v[232:235], v[204:207], v[116:119]
    ds_read_b64_tr_b16 v[230:231], v70 offset:21312
    v_mfma_f32_16x16x32_bf16 v[120:123], v[236:239], v[200:203], v[120:123]
    ds_read_b64_tr_b16 v[232:233], v70 offset:20832
    v_mfma_f32_16x16x32_bf16 v[124:127], v[236:239], v[204:207], v[124:127]
    ds_read_b64_tr_b16 v[234:235], v70 offset:21344
    buffer_load_dwordx4 v[196:199], v2, s[32:35], s16 offen offset:1024 sc1
    s_waitcnt lgkmcnt(8)
    v_mfma_f32_16x16x32_bf16 v[80:83], v[240:243], v[200:203], v[80:83]
    ds_read_b64_tr_b16 v[236:237], v71 offset:20800
    v_mfma_f32_16x16x32_bf16 v[84:87], v[240:243], v[204:207], v[84:87]
    ds_read_b64_tr_b16 v[238:239], v71 offset:21312
    v_mfma_f32_16x16x32_bf16 v[88:91], v[244:247], v[200:203], v[88:91]
    ds_read_b64_tr_b16 v[240:241], v71 offset:20832
    v_mfma_f32_16x16x32_bf16 v[92:95], v[244:247], v[204:207], v[92:95]
    ds_read_b64_tr_b16 v[242:243], v71 offset:21344
    s_waitcnt lgkmcnt(8)
    v_mfma_f32_16x16x32_bf16 v[96:99], v[248:251], v[200:203], v[96:99]
    s_barrier
    ds_read_b64_tr_b16 v[244:245], v71 offset:33280
    v_mfma_f32_16x16x32_bf16 v[100:103], v[248:251], v[204:207], v[100:103]
    ds_read_b64_tr_b16 v[246:247], v71 offset:33792
    v_mfma_f32_16x16x32_bf16 v[104:107], v[224:227], v[200:203], v[104:107]
    ds_read_b64_tr_b16 v[248:249], v71 offset:33312
    v_mfma_f32_16x16x32_bf16 v[108:111], v[224:227], v[204:207], v[108:111]
    ds_read_b64_tr_b16 v[250:251], v71 offset:33824
    s_waitcnt lgkmcnt(8)
    v_mfma_f32_16x16x32_bf16 v[144:147], v[228:231], v[200:203], v[144:147]
    ds_read_b64_tr_b16 v[224:225], v70 offset:33280
    v_mfma_f32_16x16x32_bf16 v[148:151], v[228:231], v[204:207], v[148:151]
    ds_read_b64_tr_b16 v[226:227], v70 offset:33792
    v_mfma_f32_16x16x32_bf16 v[152:155], v[232:235], v[200:203], v[152:155]
    ds_read_b64_tr_b16 v[228:229], v70 offset:33312
    v_mfma_f32_16x16x32_bf16 v[156:159], v[232:235], v[204:207], v[156:159]
    ds_read_b64_tr_b16 v[230:231], v70 offset:33824
    s_waitcnt lgkmcnt(8)
    v_mfma_f32_16x16x32_bf16 v[160:163], v[236:239], v[200:203], v[160:163]
    ds_read_b64_tr_b16 v[232:233], v70 offset:24960
    v_mfma_f32_16x16x32_bf16 v[164:167], v[236:239], v[204:207], v[164:167]
    ds_read_b64_tr_b16 v[234:235], v70 offset:25472
    v_mfma_f32_16x16x32_bf16 v[168:171], v[240:243], v[200:203], v[168:171]
    ds_read_b64_tr_b16 v[236:237], v70 offset:24992
    v_mfma_f32_16x16x32_bf16 v[172:175], v[240:243], v[204:207], v[172:175]
    ds_read_b64_tr_b16 v[238:239], v70 offset:25504
    s_waitcnt lgkmcnt(8)
    s_waitcnt vmcnt(8)
    v_mfma_f32_16x16x32_bf16 v[128:131], v[244:247], v[208:211], v[128:131]
    ds_read_b64_tr_b16 v[240:241], v71 offset:24960
    v_mfma_f32_16x16x32_bf16 v[132:135], v[244:247], v[212:215], v[132:135]
    ds_read_b64_tr_b16 v[242:243], v71 offset:25472
    buffer_load_dwordx4 v[200:203], v2, s[32:35], s16 offen offset:2048 sc1
    v_mfma_f32_16x16x32_bf16 v[136:139], v[248:251], v[208:211], v[136:139]
    ds_read_b64_tr_b16 v[244:245], v71 offset:24992
    v_mfma_f32_16x16x32_bf16 v[140:143], v[248:251], v[212:215], v[140:143]
    ds_read_b64_tr_b16 v[246:247], v71 offset:25504
    s_waitcnt lgkmcnt(8)
    v_mfma_f32_16x16x32_bf16 v[112:115], v[224:227], v[208:211], v[112:115]
    ds_read_b64_tr_b16 v[248:249], v70 offset:41600
    v_mfma_f32_16x16x32_bf16 v[116:119], v[224:227], v[212:215], v[116:119]
    ds_read_b64_tr_b16 v[250:251], v70 offset:42112
    v_mfma_f32_16x16x32_bf16 v[120:123], v[228:231], v[208:211], v[120:123]
    ds_read_b64_tr_b16 v[224:225], v70 offset:41632
    v_mfma_f32_16x16x32_bf16 v[124:127], v[228:231], v[212:215], v[124:127]
    ds_read_b64_tr_b16 v[226:227], v70 offset:42144
    buffer_load_dwordx4 v[204:207], v2, s[32:35], s16 offen offset:3072 sc1
    s_waitcnt lgkmcnt(8)
    v_mfma_f32_16x16x32_bf16 v[80:83], v[232:235], v[208:211], v[80:83]
    ds_read_b64_tr_b16 v[228:229], v71 offset:41600
    v_mfma_f32_16x16x32_bf16 v[84:87], v[232:235], v[212:215], v[84:87]
    ds_read_b64_tr_b16 v[230:231], v71 offset:42112
    v_mfma_f32_16x16x32_bf16 v[88:91], v[236:239], v[208:211], v[88:91]
    ds_read_b64_tr_b16 v[232:233], v71 offset:41632
    v_mfma_f32_16x16x32_bf16 v[92:95], v[236:239], v[212:215], v[92:95]
    ds_read_b64_tr_b16 v[234:235], v71 offset:42144
    s_waitcnt lgkmcnt(8)
    v_mfma_f32_16x16x32_bf16 v[96:99], v[240:243], v[208:211], v[96:99]
    ds_read_b64_tr_b16 v[236:237], v71 offset:37440
    v_mfma_f32_16x16x32_bf16 v[100:103], v[240:243], v[212:215], v[100:103]
    ds_read_b64_tr_b16 v[238:239], v71 offset:37952
    v_mfma_f32_16x16x32_bf16 v[104:107], v[244:247], v[208:211], v[104:107]
    ds_read_b64_tr_b16 v[240:241], v71 offset:37472
    v_mfma_f32_16x16x32_bf16 v[108:111], v[244:247], v[212:215], v[108:111]
    ds_read_b64_tr_b16 v[242:243], v71 offset:37984
    s_waitcnt lgkmcnt(8)
    v_mfma_f32_16x16x32_bf16 v[144:147], v[248:251], v[208:211], v[144:147]
    ds_read_b64_tr_b16 v[244:245], v70 offset:37440
    v_mfma_f32_16x16x32_bf16 v[148:151], v[248:251], v[212:215], v[148:151]
    ds_read_b64_tr_b16 v[246:247], v70 offset:37952
    v_mfma_f32_16x16x32_bf16 v[152:155], v[224:227], v[208:211], v[152:155]
    ds_read_b64_tr_b16 v[248:249], v70 offset:37472
    v_mfma_f32_16x16x32_bf16 v[156:159], v[224:227], v[212:215], v[156:159]
    ds_read_b64_tr_b16 v[250:251], v70 offset:37984
    s_waitcnt lgkmcnt(8)
    v_mfma_f32_16x16x32_bf16 v[160:163], v[228:231], v[208:211], v[160:163]
    ds_read_b64_tr_b16 v[224:225], v70 offset:29120
    v_mfma_f32_16x16x32_bf16 v[164:167], v[228:231], v[212:215], v[164:167]
    ds_read_b64_tr_b16 v[226:227], v70 offset:29632
    v_mfma_f32_16x16x32_bf16 v[168:171], v[232:235], v[208:211], v[168:171]
    ds_read_b64_tr_b16 v[228:229], v70 offset:29152
    v_mfma_f32_16x16x32_bf16 v[172:175], v[232:235], v[212:215], v[172:175]
    ds_read_b64_tr_b16 v[230:231], v70 offset:29664
    s_waitcnt lgkmcnt(8)
    s_waitcnt vmcnt(8)
    v_mfma_f32_16x16x32_bf16 v[128:131], v[236:239], v[216:219], v[128:131]
    ds_read_b64_tr_b16 v[232:233], v71 offset:29120
    v_mfma_f32_16x16x32_bf16 v[132:135], v[236:239], v[220:223], v[132:135]
    ds_read_b64_tr_b16 v[234:235], v71 offset:29632
    s_add_u32 s96, s85, 14
    s_and_b32 s97, s96, 15
    s_lshl_b32 s98, s97, 14
    s_add_u32 s16, s98, s15
    buffer_load_dwordx4 v[208:211], v2, s[32:35], s16 offen sc1
    v_mfma_f32_16x16x32_bf16 v[136:139], v[240:243], v[216:219], v[136:139]
    ds_read_b64_tr_b16 v[236:237], v71 offset:29152
    v_mfma_f32_16x16x32_bf16 v[140:143], v[240:243], v[220:223], v[140:143]
    ds_read_b64_tr_b16 v[238:239], v71 offset:29664
    s_waitcnt lgkmcnt(8)
    v_mfma_f32_16x16x32_bf16 v[112:115], v[244:247], v[216:219], v[112:115]
    ds_read_b64_tr_b16 v[240:241], v70 offset:45760
    v_mfma_f32_16x16x32_bf16 v[116:119], v[244:247], v[220:223], v[116:119]
    ds_read_b64_tr_b16 v[242:243], v70 offset:46272
    v_mfma_f32_16x16x32_bf16 v[120:123], v[248:251], v[216:219], v[120:123]
    ds_read_b64_tr_b16 v[244:245], v70 offset:45792
    v_mfma_f32_16x16x32_bf16 v[124:127], v[248:251], v[220:223], v[124:127]
    ds_read_b64_tr_b16 v[246:247], v70 offset:46304
    buffer_load_dwordx4 v[212:215], v2, s[32:35], s16 offen offset:1024 sc1
    s_waitcnt lgkmcnt(8)
    v_mfma_f32_16x16x32_bf16 v[80:83], v[224:227], v[216:219], v[80:83]
    ds_read_b64_tr_b16 v[248:249], v71 offset:45760
    v_mfma_f32_16x16x32_bf16 v[84:87], v[224:227], v[220:223], v[84:87]
    ds_read_b64_tr_b16 v[250:251], v71 offset:46272
    v_mfma_f32_16x16x32_bf16 v[88:91], v[228:231], v[216:219], v[88:91]
    ds_read_b64_tr_b16 v[224:225], v71 offset:45792
    v_mfma_f32_16x16x32_bf16 v[92:95], v[228:231], v[220:223], v[92:95]
    ds_read_b64_tr_b16 v[226:227], v71 offset:46304
    s_waitcnt lgkmcnt(8)
    v_mfma_f32_16x16x32_bf16 v[96:99], v[232:235], v[216:219], v[96:99]
    s_barrier
    ds_read_b64_tr_b16 v[228:229], v67 offset:8320
    v_mfma_f32_16x16x32_bf16 v[100:103], v[232:235], v[220:223], v[100:103]
    ds_read_b64_tr_b16 v[230:231], v67 offset:8832
    v_mfma_f32_16x16x32_bf16 v[104:107], v[236:239], v[216:219], v[104:107]
    ds_read_b64_tr_b16 v[232:233], v67 offset:8352
    v_mfma_f32_16x16x32_bf16 v[108:111], v[236:239], v[220:223], v[108:111]
    ds_read_b64_tr_b16 v[234:235], v67 offset:8864
    s_waitcnt lgkmcnt(8)
    v_mfma_f32_16x16x32_bf16 v[144:147], v[240:243], v[216:219], v[144:147]
    ds_read_b64_tr_b16 v[236:237], v66 offset:8320
    v_mfma_f32_16x16x32_bf16 v[148:151], v[240:243], v[220:223], v[148:151]
    ds_read_b64_tr_b16 v[238:239], v66 offset:8832
    v_mfma_f32_16x16x32_bf16 v[152:155], v[244:247], v[216:219], v[152:155]
    ds_read_b64_tr_b16 v[240:241], v66 offset:8352
    v_mfma_f32_16x16x32_bf16 v[156:159], v[244:247], v[220:223], v[156:159]
    ds_read_b64_tr_b16 v[242:243], v66 offset:8864
    s_waitcnt lgkmcnt(8)
    v_mfma_f32_16x16x32_bf16 v[160:163], v[248:251], v[216:219], v[160:163]
    ds_read_b64_tr_b16 v[244:245], v66
    v_mfma_f32_16x16x32_bf16 v[164:167], v[248:251], v[220:223], v[164:167]
    ds_read_b64_tr_b16 v[246:247], v66 offset:512
    v_mfma_f32_16x16x32_bf16 v[168:171], v[224:227], v[216:219], v[168:171]
    ds_read_b64_tr_b16 v[248:249], v66 offset:32
    v_mfma_f32_16x16x32_bf16 v[172:175], v[224:227], v[220:223], v[172:175]
    ds_read_b64_tr_b16 v[250:251], v66 offset:544
    s_waitcnt lgkmcnt(8)
    s_waitcnt vmcnt(8)
    v_mfma_f32_16x16x32_bf16 v[128:131], v[228:231], v[176:179], v[128:131]
    ds_read_b64_tr_b16 v[224:225], v67
    v_mfma_f32_16x16x32_bf16 v[132:135], v[228:231], v[180:183], v[132:135]
    ds_read_b64_tr_b16 v[226:227], v67 offset:512
    buffer_load_dwordx4 v[216:219], v2, s[32:35], s16 offen offset:2048 sc1
    v_mfma_f32_16x16x32_bf16 v[136:139], v[232:235], v[176:179], v[136:139]
    ds_read_b64_tr_b16 v[228:229], v67 offset:32
    v_mfma_f32_16x16x32_bf16 v[140:143], v[232:235], v[180:183], v[140:143]
    ds_read_b64_tr_b16 v[230:231], v67 offset:544
    s_waitcnt lgkmcnt(8)
    v_mfma_f32_16x16x32_bf16 v[112:115], v[236:239], v[176:179], v[112:115]
    ds_read_b64_tr_b16 v[232:233], v66 offset:16640
    v_mfma_f32_16x16x32_bf16 v[116:119], v[236:239], v[180:183], v[116:119]
    ds_read_b64_tr_b16 v[234:235], v66 offset:17152
    v_mfma_f32_16x16x32_bf16 v[120:123], v[240:243], v[176:179], v[120:123]
    ds_read_b64_tr_b16 v[236:237], v66 offset:16672
    v_mfma_f32_16x16x32_bf16 v[124:127], v[240:243], v[180:183], v[124:127]
    ds_read_b64_tr_b16 v[238:239], v66 offset:17184
    buffer_load_dwordx4 v[220:223], v2, s[32:35], s16 offen offset:3072 sc1
    s_waitcnt lgkmcnt(8)
    v_mfma_f32_16x16x32_bf16 v[80:83], v[244:247], v[176:179], v[80:83]
    ds_read_b64_tr_b16 v[240:241], v67 offset:16640
    v_mfma_f32_16x16x32_bf16 v[84:87], v[244:247], v[180:183], v[84:87]
    ds_read_b64_tr_b16 v[242:243], v67 offset:17152
    v_mfma_f32_16x16x32_bf16 v[88:91], v[248:251], v[176:179], v[88:91]
    ds_read_b64_tr_b16 v[244:245], v67 offset:16672
    v_mfma_f32_16x16x32_bf16 v[92:95], v[248:251], v[180:183], v[92:95]
    ds_read_b64_tr_b16 v[246:247], v67 offset:17184
    s_waitcnt lgkmcnt(8)
    v_mfma_f32_16x16x32_bf16 v[96:99], v[224:227], v[176:179], v[96:99]
    ds_read_b64_tr_b16 v[248:249], v67 offset:12480
    v_mfma_f32_16x16x32_bf16 v[100:103], v[224:227], v[180:183], v[100:103]
    ds_read_b64_tr_b16 v[250:251], v67 offset:12992
    v_mfma_f32_16x16x32_bf16 v[104:107], v[228:231], v[176:179], v[104:107]
    ds_read_b64_tr_b16 v[224:225], v67 offset:12512
    v_mfma_f32_16x16x32_bf16 v[108:111], v[228:231], v[180:183], v[108:111]
    ds_read_b64_tr_b16 v[226:227], v67 offset:13024
    s_waitcnt lgkmcnt(8)
    v_mfma_f32_16x16x32_bf16 v[144:147], v[232:235], v[176:179], v[144:147]
    ds_read_b64_tr_b16 v[228:229], v66 offset:12480
    v_mfma_f32_16x16x32_bf16 v[148:151], v[232:235], v[180:183], v[148:151]
    ds_read_b64_tr_b16 v[230:231], v66 offset:12992
    v_mfma_f32_16x16x32_bf16 v[152:155], v[236:239], v[176:179], v[152:155]
    ds_read_b64_tr_b16 v[232:233], v66 offset:12512
    v_mfma_f32_16x16x32_bf16 v[156:159], v[236:239], v[180:183], v[156:159]
    ds_read_b64_tr_b16 v[234:235], v66 offset:13024
    s_waitcnt lgkmcnt(8)
    v_mfma_f32_16x16x32_bf16 v[160:163], v[240:243], v[176:179], v[160:163]
    ds_read_b64_tr_b16 v[236:237], v66 offset:4160
    v_mfma_f32_16x16x32_bf16 v[164:167], v[240:243], v[180:183], v[164:167]
    ds_read_b64_tr_b16 v[238:239], v66 offset:4672
    v_mfma_f32_16x16x32_bf16 v[168:171], v[244:247], v[176:179], v[168:171]
    ds_read_b64_tr_b16 v[240:241], v66 offset:4192
    v_mfma_f32_16x16x32_bf16 v[172:175], v[244:247], v[180:183], v[172:175]
    ds_read_b64_tr_b16 v[242:243], v66 offset:4704
    s_waitcnt lgkmcnt(8)
    s_waitcnt vmcnt(8)
    v_mfma_f32_16x16x32_bf16 v[128:131], v[248:251], v[184:187], v[128:131]
    ds_read_b64_tr_b16 v[244:245], v67 offset:4160
    v_mfma_f32_16x16x32_bf16 v[132:135], v[248:251], v[188:191], v[132:135]
    ds_read_b64_tr_b16 v[246:247], v67 offset:4672
    s_add_u32 s96, s85, 15
    s_and_b32 s97, s96, 15
    s_lshl_b32 s98, s97, 14
    s_add_u32 s16, s98, s15
    buffer_load_dwordx4 v[176:179], v2, s[32:35], s16 offen sc1
    v_mfma_f32_16x16x32_bf16 v[136:139], v[224:227], v[184:187], v[136:139]
    ds_read_b64_tr_b16 v[248:249], v67 offset:4192
    v_mfma_f32_16x16x32_bf16 v[140:143], v[224:227], v[188:191], v[140:143]
    ds_read_b64_tr_b16 v[250:251], v67 offset:4704
    s_waitcnt lgkmcnt(8)
    v_mfma_f32_16x16x32_bf16 v[112:115], v[228:231], v[184:187], v[112:115]
    ds_read_b64_tr_b16 v[224:225], v66 offset:20800
    v_mfma_f32_16x16x32_bf16 v[116:119], v[228:231], v[188:191], v[116:119]
    ds_read_b64_tr_b16 v[226:227], v66 offset:21312
    v_mfma_f32_16x16x32_bf16 v[120:123], v[232:235], v[184:187], v[120:123]
    ds_read_b64_tr_b16 v[228:229], v66 offset:20832
    v_mfma_f32_16x16x32_bf16 v[124:127], v[232:235], v[188:191], v[124:127]
    ds_read_b64_tr_b16 v[230:231], v66 offset:21344
    buffer_load_dwordx4 v[180:183], v2, s[32:35], s16 offen offset:1024 sc1
    s_waitcnt lgkmcnt(8)
    v_mfma_f32_16x16x32_bf16 v[80:83], v[236:239], v[184:187], v[80:83]
    ds_read_b64_tr_b16 v[232:233], v67 offset:20800
    v_mfma_f32_16x16x32_bf16 v[84:87], v[236:239], v[188:191], v[84:87]
    ds_read_b64_tr_b16 v[234:235], v67 offset:21312
    v_mfma_f32_16x16x32_bf16 v[88:91], v[240:243], v[184:187], v[88:91]
    ds_read_b64_tr_b16 v[236:237], v67 offset:20832
    v_mfma_f32_16x16x32_bf16 v[92:95], v[240:243], v[188:191], v[92:95]
    ds_read_b64_tr_b16 v[238:239], v67 offset:21344
    s_waitcnt lgkmcnt(8)
    v_mfma_f32_16x16x32_bf16 v[96:99], v[244:247], v[184:187], v[96:99]
    s_barrier
    ds_read_b64_tr_b16 v[240:241], v67 offset:33280
    v_mfma_f32_16x16x32_bf16 v[100:103], v[244:247], v[188:191], v[100:103]
    ds_read_b64_tr_b16 v[242:243], v67 offset:33792
    v_mfma_f32_16x16x32_bf16 v[104:107], v[248:251], v[184:187], v[104:107]
    ds_read_b64_tr_b16 v[244:245], v67 offset:33312
    v_mfma_f32_16x16x32_bf16 v[108:111], v[248:251], v[188:191], v[108:111]
    ds_read_b64_tr_b16 v[246:247], v67 offset:33824
    s_waitcnt lgkmcnt(8)
    v_mfma_f32_16x16x32_bf16 v[144:147], v[224:227], v[184:187], v[144:147]
    ds_read_b64_tr_b16 v[248:249], v66 offset:33280
    v_mfma_f32_16x16x32_bf16 v[148:151], v[224:227], v[188:191], v[148:151]
    ds_read_b64_tr_b16 v[250:251], v66 offset:33792
    v_mfma_f32_16x16x32_bf16 v[152:155], v[228:231], v[184:187], v[152:155]
    ds_read_b64_tr_b16 v[224:225], v66 offset:33312
    v_mfma_f32_16x16x32_bf16 v[156:159], v[228:231], v[188:191], v[156:159]
    ds_read_b64_tr_b16 v[226:227], v66 offset:33824
    s_waitcnt lgkmcnt(8)
    v_mfma_f32_16x16x32_bf16 v[160:163], v[232:235], v[184:187], v[160:163]
    ds_read_b64_tr_b16 v[228:229], v66 offset:24960
    v_mfma_f32_16x16x32_bf16 v[164:167], v[232:235], v[188:191], v[164:167]
    ds_read_b64_tr_b16 v[230:231], v66 offset:25472
    v_mfma_f32_16x16x32_bf16 v[168:171], v[236:239], v[184:187], v[168:171]
    ds_read_b64_tr_b16 v[232:233], v66 offset:24992
    v_mfma_f32_16x16x32_bf16 v[172:175], v[236:239], v[188:191], v[172:175]
    ds_read_b64_tr_b16 v[234:235], v66 offset:25504
    s_waitcnt lgkmcnt(8)
    s_waitcnt vmcnt(8)
    v_mfma_f32_16x16x32_bf16 v[128:131], v[240:243], v[192:195], v[128:131]
    ds_read_b64_tr_b16 v[236:237], v67 offset:24960
    v_mfma_f32_16x16x32_bf16 v[132:135], v[240:243], v[196:199], v[132:135]
    ds_read_b64_tr_b16 v[238:239], v67 offset:25472
    buffer_load_dwordx4 v[184:187], v2, s[32:35], s16 offen offset:2048 sc1
    v_mfma_f32_16x16x32_bf16 v[136:139], v[244:247], v[192:195], v[136:139]
    ds_read_b64_tr_b16 v[240:241], v67 offset:24992
    v_mfma_f32_16x16x32_bf16 v[140:143], v[244:247], v[196:199], v[140:143]
    ds_read_b64_tr_b16 v[242:243], v67 offset:25504
    s_waitcnt lgkmcnt(8)
    v_mfma_f32_16x16x32_bf16 v[112:115], v[248:251], v[192:195], v[112:115]
    ds_read_b64_tr_b16 v[244:245], v66 offset:41600
    v_mfma_f32_16x16x32_bf16 v[116:119], v[248:251], v[196:199], v[116:119]
    ds_read_b64_tr_b16 v[246:247], v66 offset:42112
    v_mfma_f32_16x16x32_bf16 v[120:123], v[224:227], v[192:195], v[120:123]
    ds_read_b64_tr_b16 v[248:249], v66 offset:41632
    v_mfma_f32_16x16x32_bf16 v[124:127], v[224:227], v[196:199], v[124:127]
    ds_read_b64_tr_b16 v[250:251], v66 offset:42144
    buffer_load_dwordx4 v[188:191], v2, s[32:35], s16 offen offset:3072 sc1
    s_barrier
    s_waitcnt lgkmcnt(8)
    v_mfma_f32_16x16x32_bf16 v[80:83], v[228:231], v[192:195], v[80:83]
    ds_read_b64_tr_b16 v[224:225], v67 offset:41600
    v_mfma_f32_16x16x32_bf16 v[84:87], v[228:231], v[196:199], v[84:87]
    ds_read_b64_tr_b16 v[226:227], v67 offset:42112
    v_mfma_f32_16x16x32_bf16 v[88:91], v[232:235], v[192:195], v[88:91]
    ds_read_b64_tr_b16 v[228:229], v67 offset:41632
    v_mfma_f32_16x16x32_bf16 v[92:95], v[232:235], v[196:199], v[92:95]
    ds_read_b64_tr_b16 v[230:231], v67 offset:42144
    s_waitcnt lgkmcnt(8)
    v_mfma_f32_16x16x32_bf16 v[96:99], v[236:239], v[192:195], v[96:99]
    ds_read_b64_tr_b16 v[232:233], v67 offset:37440
    v_mfma_f32_16x16x32_bf16 v[100:103], v[236:239], v[196:199], v[100:103]
    ds_read_b64_tr_b16 v[234:235], v67 offset:37952
    v_mfma_f32_16x16x32_bf16 v[104:107], v[240:243], v[192:195], v[104:107]
    ds_read_b64_tr_b16 v[236:237], v67 offset:37472
    v_mfma_f32_16x16x32_bf16 v[108:111], v[240:243], v[196:199], v[108:111]
    ds_read_b64_tr_b16 v[238:239], v67 offset:37984
    s_waitcnt lgkmcnt(8)
    v_mfma_f32_16x16x32_bf16 v[144:147], v[244:247], v[192:195], v[144:147]
    ds_read_b64_tr_b16 v[240:241], v66 offset:37440
    v_mfma_f32_16x16x32_bf16 v[148:151], v[244:247], v[196:199], v[148:151]
    ds_read_b64_tr_b16 v[242:243], v66 offset:37952
    v_mfma_f32_16x16x32_bf16 v[152:155], v[248:251], v[192:195], v[152:155]
    ds_read_b64_tr_b16 v[244:245], v66 offset:37472
    v_mfma_f32_16x16x32_bf16 v[156:159], v[248:251], v[196:199], v[156:159]
    ds_read_b64_tr_b16 v[246:247], v66 offset:37984
    s_waitcnt lgkmcnt(8)
    v_mfma_f32_16x16x32_bf16 v[160:163], v[224:227], v[192:195], v[160:163]
    ds_read_b64_tr_b16 v[248:249], v66 offset:29120
    v_mfma_f32_16x16x32_bf16 v[164:167], v[224:227], v[196:199], v[164:167]
    ds_read_b64_tr_b16 v[250:251], v66 offset:29632
    v_mfma_f32_16x16x32_bf16 v[168:171], v[228:231], v[192:195], v[168:171]
    ds_read_b64_tr_b16 v[224:225], v66 offset:29152
    v_mfma_f32_16x16x32_bf16 v[172:175], v[228:231], v[196:199], v[172:175]
    ds_read_b64_tr_b16 v[226:227], v66 offset:29664
    s_waitcnt lgkmcnt(8)
    s_waitcnt vmcnt(8)
    v_mfma_f32_16x16x32_bf16 v[128:131], v[232:235], v[200:203], v[128:131]
    ds_read_b64_tr_b16 v[228:229], v67 offset:29120
    v_mfma_f32_16x16x32_bf16 v[132:135], v[232:235], v[204:207], v[132:135]
    ds_read_b64_tr_b16 v[230:231], v67 offset:29632
    v_mfma_f32_16x16x32_bf16 v[136:139], v[236:239], v[200:203], v[136:139]
    ds_read_b64_tr_b16 v[232:233], v67 offset:29152
    v_mfma_f32_16x16x32_bf16 v[140:143], v[236:239], v[204:207], v[140:143]
    ds_read_b64_tr_b16 v[234:235], v67 offset:29664
    s_waitcnt lgkmcnt(8)
    v_mfma_f32_16x16x32_bf16 v[112:115], v[240:243], v[200:203], v[112:115]
    ds_read_b64_tr_b16 v[236:237], v66 offset:45760
    v_mfma_f32_16x16x32_bf16 v[116:119], v[240:243], v[204:207], v[116:119]
    ds_read_b64_tr_b16 v[238:239], v66 offset:46272
    v_mfma_f32_16x16x32_bf16 v[120:123], v[244:247], v[200:203], v[120:123]
    ds_read_b64_tr_b16 v[240:241], v66 offset:45792
    v_mfma_f32_16x16x32_bf16 v[124:127], v[244:247], v[204:207], v[124:127]
    ds_read_b64_tr_b16 v[242:243], v66 offset:46304
    s_waitcnt lgkmcnt(8)
    v_mfma_f32_16x16x32_bf16 v[80:83], v[248:251], v[200:203], v[80:83]
    ds_read_b64_tr_b16 v[244:245], v67 offset:45760
    v_mfma_f32_16x16x32_bf16 v[84:87], v[248:251], v[204:207], v[84:87]
    ds_read_b64_tr_b16 v[246:247], v67 offset:46272
    v_mfma_f32_16x16x32_bf16 v[88:91], v[224:227], v[200:203], v[88:91]
    ds_read_b64_tr_b16 v[248:249], v67 offset:45792
    v_mfma_f32_16x16x32_bf16 v[92:95], v[224:227], v[204:207], v[92:95]
    ds_read_b64_tr_b16 v[250:251], v67 offset:46304
    s_waitcnt lgkmcnt(8)
    v_mfma_f32_16x16x32_bf16 v[96:99], v[228:231], v[200:203], v[96:99]
    ds_read_b64_tr_b16 v[224:225], v69 offset:8320
    v_mfma_f32_16x16x32_bf16 v[100:103], v[228:231], v[204:207], v[100:103]
    ds_read_b64_tr_b16 v[226:227], v69 offset:8832
    v_mfma_f32_16x16x32_bf16 v[104:107], v[232:235], v[200:203], v[104:107]
    ds_read_b64_tr_b16 v[228:229], v69 offset:8352
    v_mfma_f32_16x16x32_bf16 v[108:111], v[232:235], v[204:207], v[108:111]
    ds_read_b64_tr_b16 v[230:231], v69 offset:8864
    s_waitcnt lgkmcnt(8)
    v_mfma_f32_16x16x32_bf16 v[144:147], v[236:239], v[200:203], v[144:147]
    ds_read_b64_tr_b16 v[232:233], v68 offset:8320
    v_mfma_f32_16x16x32_bf16 v[148:151], v[236:239], v[204:207], v[148:151]
    ds_read_b64_tr_b16 v[234:235], v68 offset:8832
    v_mfma_f32_16x16x32_bf16 v[152:155], v[240:243], v[200:203], v[152:155]
    ds_read_b64_tr_b16 v[236:237], v68 offset:8352
    v_mfma_f32_16x16x32_bf16 v[156:159], v[240:243], v[204:207], v[156:159]
    ds_read_b64_tr_b16 v[238:239], v68 offset:8864
    s_waitcnt lgkmcnt(8)
    v_mfma_f32_16x16x32_bf16 v[160:163], v[244:247], v[200:203], v[160:163]
    ds_read_b64_tr_b16 v[240:241], v68
    v_mfma_f32_16x16x32_bf16 v[164:167], v[244:247], v[204:207], v[164:167]
    ds_read_b64_tr_b16 v[242:243], v68 offset:512
    v_mfma_f32_16x16x32_bf16 v[168:171], v[248:251], v[200:203], v[168:171]
    ds_read_b64_tr_b16 v[244:245], v68 offset:32
    v_mfma_f32_16x16x32_bf16 v[172:175], v[248:251], v[204:207], v[172:175]
    ds_read_b64_tr_b16 v[246:247], v68 offset:544
    s_waitcnt lgkmcnt(8)
    s_waitcnt vmcnt(6)
    v_mfma_f32_16x16x32_bf16 v[128:131], v[224:227], v[208:211], v[128:131]
    ds_read_b64_tr_b16 v[248:249], v69
    v_mfma_f32_16x16x32_bf16 v[132:135], v[224:227], v[212:215], v[132:135]
    ds_read_b64_tr_b16 v[250:251], v69 offset:512
    v_mfma_f32_16x16x32_bf16 v[136:139], v[228:231], v[208:211], v[136:139]
    ds_read_b64_tr_b16 v[224:225], v69 offset:32
    v_mfma_f32_16x16x32_bf16 v[140:143], v[228:231], v[212:215], v[140:143]
    ds_read_b64_tr_b16 v[226:227], v69 offset:544
    s_waitcnt lgkmcnt(8)
    v_mfma_f32_16x16x32_bf16 v[112:115], v[232:235], v[208:211], v[112:115]
    ds_read_b64_tr_b16 v[228:229], v68 offset:16640
    v_mfma_f32_16x16x32_bf16 v[116:119], v[232:235], v[212:215], v[116:119]
    ds_read_b64_tr_b16 v[230:231], v68 offset:17152
    v_mfma_f32_16x16x32_bf16 v[120:123], v[236:239], v[208:211], v[120:123]
    ds_read_b64_tr_b16 v[232:233], v68 offset:16672
    v_mfma_f32_16x16x32_bf16 v[124:127], v[236:239], v[212:215], v[124:127]
    ds_read_b64_tr_b16 v[234:235], v68 offset:17184
    s_waitcnt lgkmcnt(8)
    v_mfma_f32_16x16x32_bf16 v[80:83], v[240:243], v[208:211], v[80:83]
    ds_read_b64_tr_b16 v[236:237], v69 offset:16640
    v_mfma_f32_16x16x32_bf16 v[84:87], v[240:243], v[212:215], v[84:87]
    ds_read_b64_tr_b16 v[238:239], v69 offset:17152
    v_mfma_f32_16x16x32_bf16 v[88:91], v[244:247], v[208:211], v[88:91]
    ds_read_b64_tr_b16 v[240:241], v69 offset:16672
    v_mfma_f32_16x16x32_bf16 v[92:95], v[244:247], v[212:215], v[92:95]
    ds_read_b64_tr_b16 v[242:243], v69 offset:17184
    s_waitcnt lgkmcnt(8)
    v_mfma_f32_16x16x32_bf16 v[96:99], v[248:251], v[208:211], v[96:99]
    ds_read_b64_tr_b16 v[244:245], v69 offset:12480
    v_mfma_f32_16x16x32_bf16 v[100:103], v[248:251], v[212:215], v[100:103]
    ds_read_b64_tr_b16 v[246:247], v69 offset:12992
    v_mfma_f32_16x16x32_bf16 v[104:107], v[224:227], v[208:211], v[104:107]
    ds_read_b64_tr_b16 v[248:249], v69 offset:12512
    v_mfma_f32_16x16x32_bf16 v[108:111], v[224:227], v[212:215], v[108:111]
    ds_read_b64_tr_b16 v[250:251], v69 offset:13024
    s_waitcnt lgkmcnt(8)
    v_mfma_f32_16x16x32_bf16 v[144:147], v[228:231], v[208:211], v[144:147]
    ds_read_b64_tr_b16 v[224:225], v68 offset:12480
    v_mfma_f32_16x16x32_bf16 v[148:151], v[228:231], v[212:215], v[148:151]
    ds_read_b64_tr_b16 v[226:227], v68 offset:12992
    v_mfma_f32_16x16x32_bf16 v[152:155], v[232:235], v[208:211], v[152:155]
    ds_read_b64_tr_b16 v[228:229], v68 offset:12512
    v_mfma_f32_16x16x32_bf16 v[156:159], v[232:235], v[212:215], v[156:159]
    ds_read_b64_tr_b16 v[230:231], v68 offset:13024
    s_waitcnt lgkmcnt(8)
    v_mfma_f32_16x16x32_bf16 v[160:163], v[236:239], v[208:211], v[160:163]
    ds_read_b64_tr_b16 v[232:233], v68 offset:4160
    v_mfma_f32_16x16x32_bf16 v[164:167], v[236:239], v[212:215], v[164:167]
    ds_read_b64_tr_b16 v[234:235], v68 offset:4672
    v_mfma_f32_16x16x32_bf16 v[168:171], v[240:243], v[208:211], v[168:171]
    ds_read_b64_tr_b16 v[236:237], v68 offset:4192
    v_mfma_f32_16x16x32_bf16 v[172:175], v[240:243], v[212:215], v[172:175]
    ds_read_b64_tr_b16 v[238:239], v68 offset:4704
    s_waitcnt lgkmcnt(8)
    s_waitcnt vmcnt(4)
    v_mfma_f32_16x16x32_bf16 v[128:131], v[244:247], v[216:219], v[128:131]
    ds_read_b64_tr_b16 v[240:241], v69 offset:4160
    v_mfma_f32_16x16x32_bf16 v[132:135], v[244:247], v[220:223], v[132:135]
    ds_read_b64_tr_b16 v[242:243], v69 offset:4672
    v_mfma_f32_16x16x32_bf16 v[136:139], v[248:251], v[216:219], v[136:139]
    ds_read_b64_tr_b16 v[244:245], v69 offset:4192
    v_mfma_f32_16x16x32_bf16 v[140:143], v[248:251], v[220:223], v[140:143]
    ds_read_b64_tr_b16 v[246:247], v69 offset:4704
    s_waitcnt lgkmcnt(8)
    v_mfma_f32_16x16x32_bf16 v[112:115], v[224:227], v[216:219], v[112:115]
    ds_read_b64_tr_b16 v[248:249], v68 offset:20800
    v_mfma_f32_16x16x32_bf16 v[116:119], v[224:227], v[220:223], v[116:119]
    ds_read_b64_tr_b16 v[250:251], v68 offset:21312
    v_mfma_f32_16x16x32_bf16 v[120:123], v[228:231], v[216:219], v[120:123]
    ds_read_b64_tr_b16 v[224:225], v68 offset:20832
    v_mfma_f32_16x16x32_bf16 v[124:127], v[228:231], v[220:223], v[124:127]
    ds_read_b64_tr_b16 v[226:227], v68 offset:21344
    s_waitcnt lgkmcnt(8)
    v_mfma_f32_16x16x32_bf16 v[80:83], v[232:235], v[216:219], v[80:83]
    ds_read_b64_tr_b16 v[228:229], v69 offset:20800
    v_mfma_f32_16x16x32_bf16 v[84:87], v[232:235], v[220:223], v[84:87]
    ds_read_b64_tr_b16 v[230:231], v69 offset:21312
    v_mfma_f32_16x16x32_bf16 v[88:91], v[236:239], v[216:219], v[88:91]
    ds_read_b64_tr_b16 v[232:233], v69 offset:20832
    v_mfma_f32_16x16x32_bf16 v[92:95], v[236:239], v[220:223], v[92:95]
    ds_read_b64_tr_b16 v[234:235], v69 offset:21344
    s_waitcnt lgkmcnt(8)
    v_mfma_f32_16x16x32_bf16 v[96:99], v[240:243], v[216:219], v[96:99]
    ds_read_b64_tr_b16 v[236:237], v69 offset:33280
    v_mfma_f32_16x16x32_bf16 v[100:103], v[240:243], v[220:223], v[100:103]
    ds_read_b64_tr_b16 v[238:239], v69 offset:33792
    v_mfma_f32_16x16x32_bf16 v[104:107], v[244:247], v[216:219], v[104:107]
    ds_read_b64_tr_b16 v[240:241], v69 offset:33312
    v_mfma_f32_16x16x32_bf16 v[108:111], v[244:247], v[220:223], v[108:111]
    ds_read_b64_tr_b16 v[242:243], v69 offset:33824
    s_waitcnt lgkmcnt(8)
    v_mfma_f32_16x16x32_bf16 v[144:147], v[248:251], v[216:219], v[144:147]
    ds_read_b64_tr_b16 v[244:245], v68 offset:33280
    v_mfma_f32_16x16x32_bf16 v[148:151], v[248:251], v[220:223], v[148:151]
    ds_read_b64_tr_b16 v[246:247], v68 offset:33792
    v_mfma_f32_16x16x32_bf16 v[152:155], v[224:227], v[216:219], v[152:155]
    ds_read_b64_tr_b16 v[248:249], v68 offset:33312
    v_mfma_f32_16x16x32_bf16 v[156:159], v[224:227], v[220:223], v[156:159]
    ds_read_b64_tr_b16 v[250:251], v68 offset:33824
    s_waitcnt lgkmcnt(8)
    v_mfma_f32_16x16x32_bf16 v[160:163], v[228:231], v[216:219], v[160:163]
    ds_read_b64_tr_b16 v[224:225], v68 offset:24960
    v_mfma_f32_16x16x32_bf16 v[164:167], v[228:231], v[220:223], v[164:167]
    ds_read_b64_tr_b16 v[226:227], v68 offset:25472
    v_mfma_f32_16x16x32_bf16 v[168:171], v[232:235], v[216:219], v[168:171]
    ds_read_b64_tr_b16 v[228:229], v68 offset:24992
    v_mfma_f32_16x16x32_bf16 v[172:175], v[232:235], v[220:223], v[172:175]
    ds_read_b64_tr_b16 v[230:231], v68 offset:25504
    s_waitcnt lgkmcnt(8)
    s_waitcnt vmcnt(2)
    v_mfma_f32_16x16x32_bf16 v[128:131], v[236:239], v[176:179], v[128:131]
    ds_read_b64_tr_b16 v[232:233], v69 offset:24960
    v_mfma_f32_16x16x32_bf16 v[132:135], v[236:239], v[180:183], v[132:135]
    ds_read_b64_tr_b16 v[234:235], v69 offset:25472
    v_mfma_f32_16x16x32_bf16 v[136:139], v[240:243], v[176:179], v[136:139]
    ds_read_b64_tr_b16 v[236:237], v69 offset:24992
    v_mfma_f32_16x16x32_bf16 v[140:143], v[240:243], v[180:183], v[140:143]
    ds_read_b64_tr_b16 v[238:239], v69 offset:25504
    s_waitcnt lgkmcnt(8)
    v_mfma_f32_16x16x32_bf16 v[112:115], v[244:247], v[176:179], v[112:115]
    ds_read_b64_tr_b16 v[240:241], v68 offset:41600
    v_mfma_f32_16x16x32_bf16 v[116:119], v[244:247], v[180:183], v[116:119]
    ds_read_b64_tr_b16 v[242:243], v68 offset:42112
    v_mfma_f32_16x16x32_bf16 v[120:123], v[248:251], v[176:179], v[120:123]
    ds_read_b64_tr_b16 v[244:245], v68 offset:41632
    v_mfma_f32_16x16x32_bf16 v[124:127], v[248:251], v[180:183], v[124:127]
    ds_read_b64_tr_b16 v[246:247], v68 offset:42144
    s_waitcnt lgkmcnt(8)
    v_mfma_f32_16x16x32_bf16 v[80:83], v[224:227], v[176:179], v[80:83]
    ds_read_b64_tr_b16 v[248:249], v69 offset:41600
    v_mfma_f32_16x16x32_bf16 v[84:87], v[224:227], v[180:183], v[84:87]
    ds_read_b64_tr_b16 v[250:251], v69 offset:42112
    v_mfma_f32_16x16x32_bf16 v[88:91], v[228:231], v[176:179], v[88:91]
    ds_read_b64_tr_b16 v[224:225], v69 offset:41632
    v_mfma_f32_16x16x32_bf16 v[92:95], v[228:231], v[180:183], v[92:95]
    ds_read_b64_tr_b16 v[226:227], v69 offset:42144
    s_waitcnt lgkmcnt(8)
    v_mfma_f32_16x16x32_bf16 v[96:99], v[232:235], v[176:179], v[96:99]
    ds_read_b64_tr_b16 v[228:229], v69 offset:37440
    v_mfma_f32_16x16x32_bf16 v[100:103], v[232:235], v[180:183], v[100:103]
    ds_read_b64_tr_b16 v[230:231], v69 offset:37952
    v_mfma_f32_16x16x32_bf16 v[104:107], v[236:239], v[176:179], v[104:107]
    ds_read_b64_tr_b16 v[232:233], v69 offset:37472
    v_mfma_f32_16x16x32_bf16 v[108:111], v[236:239], v[180:183], v[108:111]
    ds_read_b64_tr_b16 v[234:235], v69 offset:37984
    s_waitcnt lgkmcnt(8)
    v_mfma_f32_16x16x32_bf16 v[144:147], v[240:243], v[176:179], v[144:147]
    ds_read_b64_tr_b16 v[236:237], v68 offset:37440
    v_mfma_f32_16x16x32_bf16 v[148:151], v[240:243], v[180:183], v[148:151]
    ds_read_b64_tr_b16 v[238:239], v68 offset:37952
    v_mfma_f32_16x16x32_bf16 v[152:155], v[244:247], v[176:179], v[152:155]
    ds_read_b64_tr_b16 v[240:241], v68 offset:37472
    v_mfma_f32_16x16x32_bf16 v[156:159], v[244:247], v[180:183], v[156:159]
    ds_read_b64_tr_b16 v[242:243], v68 offset:37984
    s_waitcnt lgkmcnt(8)
    v_mfma_f32_16x16x32_bf16 v[160:163], v[248:251], v[176:179], v[160:163]
    ds_read_b64_tr_b16 v[244:245], v68 offset:29120
    v_mfma_f32_16x16x32_bf16 v[164:167], v[248:251], v[180:183], v[164:167]
    ds_read_b64_tr_b16 v[246:247], v68 offset:29632
    v_mfma_f32_16x16x32_bf16 v[168:171], v[224:227], v[176:179], v[168:171]
    ds_read_b64_tr_b16 v[248:249], v68 offset:29152
    v_mfma_f32_16x16x32_bf16 v[172:175], v[224:227], v[180:183], v[172:175]
    ds_read_b64_tr_b16 v[250:251], v68 offset:29664
    s_waitcnt lgkmcnt(8)
    s_waitcnt vmcnt(0)
    v_mfma_f32_16x16x32_bf16 v[128:131], v[228:231], v[184:187], v[128:131]
    ds_read_b64_tr_b16 v[224:225], v69 offset:29120
    v_mfma_f32_16x16x32_bf16 v[132:135], v[228:231], v[188:191], v[132:135]
    ds_read_b64_tr_b16 v[226:227], v69 offset:29632
    v_mfma_f32_16x16x32_bf16 v[136:139], v[232:235], v[184:187], v[136:139]
    ds_read_b64_tr_b16 v[228:229], v69 offset:29152
    v_mfma_f32_16x16x32_bf16 v[140:143], v[232:235], v[188:191], v[140:143]
    ds_read_b64_tr_b16 v[230:231], v69 offset:29664
    s_waitcnt lgkmcnt(8)
    v_mfma_f32_16x16x32_bf16 v[112:115], v[236:239], v[184:187], v[112:115]
    ds_read_b64_tr_b16 v[232:233], v68 offset:45760
    v_mfma_f32_16x16x32_bf16 v[116:119], v[236:239], v[188:191], v[116:119]
    ds_read_b64_tr_b16 v[234:235], v68 offset:46272
    v_mfma_f32_16x16x32_bf16 v[120:123], v[240:243], v[184:187], v[120:123]
    ds_read_b64_tr_b16 v[236:237], v68 offset:45792
    v_mfma_f32_16x16x32_bf16 v[124:127], v[240:243], v[188:191], v[124:127]
    ds_read_b64_tr_b16 v[238:239], v68 offset:46304
    s_waitcnt lgkmcnt(8)
    v_mfma_f32_16x16x32_bf16 v[80:83], v[244:247], v[184:187], v[80:83]
    ds_read_b64_tr_b16 v[240:241], v69 offset:45760
    v_mfma_f32_16x16x32_bf16 v[84:87], v[244:247], v[188:191], v[84:87]
    ds_read_b64_tr_b16 v[242:243], v69 offset:46272
    v_mfma_f32_16x16x32_bf16 v[88:91], v[248:251], v[184:187], v[88:91]
    ds_read_b64_tr_b16 v[244:245], v69 offset:45792
    v_mfma_f32_16x16x32_bf16 v[92:95], v[248:251], v[188:191], v[92:95]
    ds_read_b64_tr_b16 v[246:247], v69 offset:46304
    s_waitcnt lgkmcnt(8)
    v_mfma_f32_16x16x32_bf16 v[96:99], v[224:227], v[184:187], v[96:99]
    v_mfma_f32_16x16x32_bf16 v[100:103], v[224:227], v[188:191], v[100:103]
    v_mfma_f32_16x16x32_bf16 v[104:107], v[228:231], v[184:187], v[104:107]
    v_mfma_f32_16x16x32_bf16 v[108:111], v[228:231], v[188:191], v[108:111]
    s_waitcnt lgkmcnt(4)
    v_mfma_f32_16x16x32_bf16 v[144:147], v[232:235], v[184:187], v[144:147]
    v_mfma_f32_16x16x32_bf16 v[148:151], v[232:235], v[188:191], v[148:151]
    v_mfma_f32_16x16x32_bf16 v[152:155], v[236:239], v[184:187], v[152:155]
    v_mfma_f32_16x16x32_bf16 v[156:159], v[236:239], v[188:191], v[156:159]
    s_waitcnt lgkmcnt(0)
    v_mfma_f32_16x16x32_bf16 v[160:163], v[240:243], v[184:187], v[160:163]
    v_mfma_f32_16x16x32_bf16 v[164:167], v[240:243], v[188:191], v[164:167]
    v_mfma_f32_16x16x32_bf16 v[168:171], v[244:247], v[184:187], v[168:171]
    v_mfma_f32_16x16x32_bf16 v[172:175], v[244:247], v[188:191], v[172:175]
    v_cvt_pk_bf16_f32 v52, v128, v129
    v_cvt_pk_bf16_f32 v53, v130, v131
    v_cvt_pk_bf16_f32 v54, v132, v133
    v_cvt_pk_bf16_f32 v55, v134, v135
    v_cvt_pk_bf16_f32 v56, v136, v137
    v_cvt_pk_bf16_f32 v57, v138, v139
    v_cvt_pk_bf16_f32 v58, v140, v141
    v_cvt_pk_bf16_f32 v59, v142, v143
    ds_write_b64 v77, v[52:53]
    ds_write_b64 v77, v[54:55] offset:256
    ds_write_b64 v77, v[56:57] offset:1024
    ds_write_b64 v77, v[58:59] offset:1280
    v_cvt_pk_bf16_f32 v36, v112, v113
    v_cvt_pk_bf16_f32 v37, v114, v115
    v_cvt_pk_bf16_f32 v38, v116, v117
    v_cvt_pk_bf16_f32 v39, v118, v119
    v_cvt_pk_bf16_f32 v40, v120, v121
    v_cvt_pk_bf16_f32 v41, v122, v123
    v_cvt_pk_bf16_f32 v42, v124, v125
    v_cvt_pk_bf16_f32 v43, v126, v127
    v_permlane16_swap_b32 v36, v38
    v_permlane16_swap_b32 v37, v39
    v_permlane16_swap_b32 v40, v42
    v_permlane16_swap_b32 v41, v43
    s_waitcnt lgkmcnt(0)
    s_barrier
    s_setprio 0
    v_mfma_f32_32x32x16_bf16 v[112:127], v[28:31], v[36:39], 0
    v_mfma_f32_32x32x16_bf16 v[112:127], v[32:35], v[40:43], v[112:127]
    v_cvt_pk_bf16_f32 v52, v144, v145
    v_cvt_pk_bf16_f32 v53, v146, v147
    v_cvt_pk_bf16_f32 v54, v148, v149
    v_cvt_pk_bf16_f32 v55, v150, v151
    v_cvt_pk_bf16_f32 v56, v152, v153
    v_cvt_pk_bf16_f32 v57, v154, v155
    v_cvt_pk_bf16_f32 v58, v156, v157
    v_cvt_pk_bf16_f32 v59, v158, v159
    ds_write_b64 v78, v[52:53]
    ds_write_b64 v78, v[54:55] offset:512
    ds_write_b64 v78, v[56:57] offset:4096
    ds_write_b64 v78, v[58:59] offset:4608
    v_cvt_pk_bf16_f32 v44, v160, v161
    v_cvt_pk_bf16_f32 v45, v162, v163
    v_cvt_pk_bf16_f32 v46, v164, v165
    v_cvt_pk_bf16_f32 v47, v166, v167
    v_cvt_pk_bf16_f32 v48, v168, v169
    v_cvt_pk_bf16_f32 v49, v170, v171
    v_cvt_pk_bf16_f32 v50, v172, v173
    v_cvt_pk_bf16_f32 v51, v174, v175
    ds_write_b64 v78, v[44:45] offset:8192
    ds_write_b64 v78, v[46:47] offset:8704
    ds_write_b64 v78, v[48:49] offset:12288
    ds_write_b64 v78, v[50:51] offset:12800
    v_cvt_pk_bf16_f32 v36, v96, v97
    v_cvt_pk_bf16_f32 v37, v98, v99
    v_cvt_pk_bf16_f32 v38, v100, v101
    v_cvt_pk_bf16_f32 v39, v102, v103
    v_cvt_pk_bf16_f32 v40, v104, v105
    v_cvt_pk_bf16_f32 v41, v106, v107
    v_cvt_pk_bf16_f32 v42, v108, v109
    v_cvt_pk_bf16_f32 v43, v110, v111
    ds_write_b64 v77, v[36:37] offset:2048
    ds_write_b64 v77, v[38:39] offset:2304
    ds_write_b64 v77, v[40:41] offset:3072
    ds_write_b64 v77, v[42:43] offset:3328
    v_cvt_pk_bf16_f32 v44, v80, v81
    v_cvt_pk_bf16_f32 v45, v82, v83
    v_cvt_pk_bf16_f32 v46, v84, v85
    v_cvt_pk_bf16_f32 v47, v86, v87
    v_cvt_pk_bf16_f32 v48, v88, v89
    v_cvt_pk_bf16_f32 v49, v90, v91
    v_cvt_pk_bf16_f32 v50, v92, v93
    v_cvt_pk_bf16_f32 v51, v94, v95
    v_permlane16_swap_b32 v44, v46
    v_permlane16_swap_b32 v45, v47
    v_permlane16_swap_b32 v48, v50
    v_permlane16_swap_b32 v49, v51
    s_branch L_JOIN
L_HELP:
    s_add_u32 s96, s85, 5
    s_and_b32 s97, s96, 15
    s_lshl3_add_u32 s98, s97, s3
    s_sub_u32 s99, s98, 4
    s_mul_i32 s96, s99, 49152
    s_lshl_b32 s97, s11, 7
    s_add_u32 s82, s96, s97
    s_sub_u32 s96, s3, 4
    s_lshr_b32 s97, s96, 1
    s_mul_i32 s98, s97, 2080
    s_sub_u32 s99, s3, 4
    s_and_b32 s96, s99, 1
    s_mul_i32 s97, s96, 1056
    s_add_u32 s99, s98, s97
    s_add_u32 s20, s99, 124800
    s_mov_b32 m0, s20
    s_nop 0
    buffer_load_dwordx4 v62, s[40:43], s82 offen lds
    s_add_u32 s82, s82, 2048
    s_add_u32 m0, s20, 8320
    s_nop 0
    buffer_load_dwordx4 v62, s[40:43], s82 offen lds
    s_add_u32 s82, s82, 2048
    s_add_u32 m0, s20, 16640
    s_nop 0
    buffer_load_dwordx4 v62, s[40:43], s82 offen lds
    s_add_u32 s96, s85, 5
    s_and_b32 s97, s96, 15
    s_lshl3_add_u32 s98, s97, s3
    s_mul_i32 s99, s98, 49152
    s_lshl_b32 s96, s11, 7
    s_add_u32 s82, s99, s96
    s_lshr_b32 s96, s3, 1
    s_mul_i32 s97, s96, 2080
    s_and_b32 s98, s3, 1
    s_mul_i32 s99, s98, 1056
    s_add_u32 s96, s97, s99
    s_add_u32 s20, s96, 124800
    s_mov_b32 m0, s20
    s_nop 0
    buffer_load_dwordx4 v62, s[40:43], s82 offen lds
    s_add_u32 s82, s82, 2048
    s_add_u32 m0, s20, 8320
    s_nop 0
    buffer_load_dwordx4 v62, s[40:43], s82 offen lds
    s_add_u32 s82, s82, 2048
    s_add_u32 m0, s20, 16640
    s_nop 0
    buffer_load_dwordx4 v62, s[40:43], s82 offen lds
    s_and_b32 s96, s9, 3
    s_lshl2_add_u32 s97, s96, s3
    s_sub_u32 s98, s97, 4
    s_lshl_b32 s13, s98, 7
    v_lshrrev_b32 v61, 3, v1
    v_lshl_add_u32 v61, v61, 4, s13
    v_lshrrev_b32 v60, 3, v1
    v_mul_u32_u24 v60, 98304, v60
    v_and_b32 v9, 7, v1
    v_lshl_add_u32 v60, v9, 4, v60
    s_mul_i32 s96, s13, 6144
    s_bfe_u32 s97, s9, 131074
    s_lshl_b32 s98, s8, 1
    s_lshl4_add_u32 s99, s97, s98
    s_lshr_b32 s97, s9, 4
    s_add_u32 s98, s99, s97
    s_lshl_b32 s99, s98, 7
    s_add_u32 s97, s96, s99
    s_add_u32 s17, s97, 4096
    global_load_dwordx4 v[120:123], v61, s[86:87]
    s_waitcnt vmcnt(13)
    s_barrier
    buffer_load_dwordx4 v[80:83], v60, s[48:51], s17 offen nt
    s_add_u32 s17, s17, 12288
    buffer_load_dwordx4 v[84:87], v60, s[48:51], s17 offen nt
    s_add_u32 s17, s17, 12288
    s_waitcnt lgkmcnt(0)
    s_load_dword s24, s[32:33], s92 offset:512 glc
    s_load_dword s25, s[32:33], s92 offset:256 glc
    s_load_dword s26, s[32:33], s92 offset:1024 glc
    s_load_dword s27, s[32:33], s92 offset:768 glc
    s_waitcnt vmcnt(12)
    s_barrier
    s_add_u32 s96, s85, 6
    s_and_b32 s97, s96, 15
    s_lshl3_add_u32 s98, s97, s3
    s_sub_u32 s99, s98, 4
    s_mul_i32 s96, s99, 49152
    s_lshl_b32 s97, s11, 7
    s_add_u32 s82, s96, s97
    s_sub_u32 s96, s3, 4
    s_lshr_b32 s97, s96, 1
    s_mul_i32 s98, s97, 2080
    s_sub_u32 s99, s3, 4
    s_and_b32 s96, s99, 1
    s_mul_i32 s97, s96, 1056
    s_add_u32 s20, s98, s97
    s_mov_b32 m0, s20
    s_nop 0
    buffer_load_dwordx4 v62, s[40:43], s82 offen lds
    s_add_u32 s82, s82, 2048
    s_add_u32 m0, s20, 8320
    s_nop 0
    buffer_load_dwordx4 v62, s[40:43], s82 offen lds
    s_add_u32 s82, s82, 2048
    s_add_u32 m0, s20, 16640
    s_nop 0
    buffer_load_dwordx4 v62, s[40:43], s82 offen lds
    s_add_u32 s96, s85, 6
    s_and_b32 s97, s96, 15
    s_lshl3_add_u32 s98, s97, s3
    s_mul_i32 s99, s98, 49152
    s_lshl_b32 s96, s11, 7
    s_add_u32 s82, s99, s96
    s_lshr_b32 s96, s3, 1
    s_mul_i32 s97, s96, 2080
    s_and_b32 s98, s3, 1
    s_mul_i32 s99, s98, 1056
    s_add_u32 s20, s97, s99
    s_mov_b32 m0, s20
    s_nop 0
    buffer_load_dwordx4 v62, s[40:43], s82 offen lds
    s_add_u32 s82, s82, 2048
    s_add_u32 m0, s20, 8320
    s_nop 0
    buffer_load_dwordx4 v62, s[40:43], s82 offen lds
    s_add_u32 s82, s82, 2048
    s_add_u32 m0, s20, 16640
    s_nop 0
    buffer_load_dwordx4 v62, s[40:43], s82 offen lds
    s_waitcnt vmcnt(8)
    v_lshlrev_b32 v112, 16, v120
    v_mul_f32 v4, s7, v112
    v_exp_f32 v4, -v4
    s_nop 0
    v_add_f32 v4, 1.0, v4
    v_rcp_f32 v4, v4
    s_nop 0
    v_mul_f32 v112, v112, v4
    v_cvt_pk_bf16_f32 v112, 0, v112
    v_and_b32 v113, s6, v120
    v_mul_f32 v5, s7, v113
    v_exp_f32 v5, -v5
    s_nop 0
    v_add_f32 v5, 1.0, v5
    v_rcp_f32 v5, v5
    s_nop 0
    v_mul_f32 v113, v113, v5
    v_cvt_pk_bf16_f32 v113, 0, v113
    v_lshlrev_b32 v114, 16, v121
    v_mul_f32 v4, s7, v114
    v_exp_f32 v4, -v4
    s_nop 0
    v_add_f32 v4, 1.0, v4
    v_rcp_f32 v4, v4
    s_nop 0
    v_mul_f32 v114, v114, v4
    v_cvt_pk_bf16_f32 v114, 0, v114
    v_and_b32 v115, s6, v121
    v_mul_f32 v5, s7, v115
    v_exp_f32 v5, -v5
    s_nop 0
    v_add_f32 v5, 1.0, v5
    v_rcp_f32 v5, v5
    s_nop 0
    v_mul_f32 v115, v115, v5
    v_cvt_pk_bf16_f32 v115, 0, v115
    s_barrier
    s_add_u32 s96, s85, 7
    s_and_b32 s97, s96, 15
    s_lshl3_add_u32 s98, s97, s3
    s_sub_u32 s99, s98, 4
    s_mul_i32 s96, s99, 49152
    s_lshl_b32 s97, s11, 7
    s_add_u32 s82, s96, s97
    s_sub_u32 s96, s3, 4
    s_lshr_b32 s97, s96, 1
    s_mul_i32 s98, s97, 2080
    s_sub_u32 s99, s3, 4
    s_and_b32 s96, s99, 1
    s_mul_i32 s97, s96, 1056
    s_add_u32 s99, s98, s97
    s_add_u32 s20, s99, 24960
    s_mov_b32 m0, s20
    s_nop 0
    buffer_load_dwordx4 v62, s[40:43], s82 offen lds
    s_add_u32 s82, s82, 2048
    s_add_u32 m0, s20, 8320
    s_nop 0
    buffer_load_dwordx4 v62, s[40:43], s82 offen lds
    s_add_u32 s82, s82, 2048
    s_add_u32 m0, s20, 16640
    s_nop 0
    buffer_load_dwordx4 v62, s[40:43], s82 offen lds
    s_add_u32 s96, s85, 7
    s_and_b32 s97, s96, 15
    s_lshl3_add_u32 s98, s97, s3
    s_mul_i32 s99, s98, 49152
    s_lshl_b32 s96, s11, 7
    s_add_u32 s82, s99, s96
    s_lshr_b32 s96, s3, 1
    s_mul_i32 s97, s96, 2080
    s_and_b32 s98, s3, 1
    s_mul_i32 s99, s98, 1056
    s_add_u32 s96, s97, s99
    s_add_u32 s20, s96, 24960
    s_mov_b32 m0, s20
    s_nop 0
    buffer_load_dwordx4 v62, s[40:43], s82 offen lds
    s_add_u32 s82, s82, 2048
    s_add_u32 m0, s20, 8320
    s_nop 0
    buffer_load_dwordx4 v62, s[40:43], s82 offen lds
    s_add_u32 s82, s82, 2048
    s_add_u32 m0, s20, 16640
    s_nop 0
    buffer_load_dwordx4 v62, s[40:43], s82 offen lds
    buffer_load_dwordx4 v[88:91], v60, s[48:51], s17 offen nt
    s_add_u32 s17, s17, 12288
    buffer_load_dwordx4 v[92:95], v60, s[48:51], s17 offen nt
    s_add_u32 s17, s17, 12288
    v_lshlrev_b32 v116, 16, v122
    v_mul_f32 v4, s7, v116
    v_exp_f32 v4, -v4
    s_nop 0
    v_add_f32 v4, 1.0, v4
    v_rcp_f32 v4, v4
    s_nop 0
    v_mul_f32 v116, v116, v4
    v_cvt_pk_bf16_f32 v116, 0, v116
    v_and_b32 v117, s6, v122
    v_mul_f32 v5, s7, v117
    v_exp_f32 v5, -v5
    s_nop 0
    v_add_f32 v5, 1.0, v5
    v_rcp_f32 v5, v5
    s_nop 0
    v_mul_f32 v117, v117, v5
    v_cvt_pk_bf16_f32 v117, 0, v117
    v_lshlrev_b32 v118, 16, v123
    v_mul_f32 v4, s7, v118
    v_exp_f32 v4, -v4
    s_nop 0
    v_add_f32 v4, 1.0, v4
    v_rcp_f32 v4, v4
    s_nop 0
    v_mul_f32 v118, v118, v4
    v_cvt_pk_bf16_f32 v118, 0, v118
    v_and_b32 v119, s6, v123
    v_mul_f32 v5, s7, v119
    v_exp_f32 v5, -v5
    s_nop 0
    v_add_f32 v5, 1.0, v5
    v_rcp_f32 v5, v5
    s_nop 0
    v_mul_f32 v119, v119, v5
    v_cvt_pk_bf16_f32 v119, 0, v119
    s_barrier
    s_add_u32 s96, s85, 8
    s_and_b32 s97, s96, 15
    s_lshl3_add_u32 s98, s97, s3
    s_sub_u32 s99, s98, 4
    s_mul_i32 s96, s99, 49152
    s_lshl_b32 s97, s11, 7
    s_add_u32 s82, s96, s97
    s_sub_u32 s96, s3, 4
    s_lshr_b32 s97, s96, 1
    s_mul_i32 s98, s97, 2080
    s_sub_u32 s99, s3, 4
    s_and_b32 s96, s99, 1
    s_mul_i32 s97, s96, 1056
    s_add_u32 s99, s98, s97
    s_add_u32 s20, s99, 49920
    s_mov_b32 m0, s20
    s_nop 0
    buffer_load_dwordx4 v62, s[40:43], s82 offen lds
    s_add_u32 s82, s82, 2048
    s_add_u32 m0, s20, 8320
    s_nop 0
    buffer_load_dwordx4 v62, s[40:43], s82 offen lds
    s_add_u32 s82, s82, 2048
    s_add_u32 m0, s20, 16640
    s_nop 0
    buffer_load_dwordx4 v62, s[40:43], s82 offen lds
    s_add_u32 s96, s85, 8
    s_and_b32 s97, s96, 15
    s_lshl3_add_u32 s98, s97, s3
    s_mul_i32 s99, s98, 49152
    s_lshl_b32 s96, s11, 7
    s_add_u32 s82, s99, s96
    s_lshr_b32 s96, s3, 1
    s_mul_i32 s97, s96, 2080
    s_and_b32 s98, s3, 1
    s_mul_i32 s99, s98, 1056
    s_add_u32 s96, s97, s99
    s_add_u32 s20, s96, 49920
    s_mov_b32 m0, s20
    s_nop 0
    buffer_load_dwordx4 v62, s[40:43], s82 offen lds
    s_add_u32 s82, s82, 2048
    s_add_u32 m0, s20, 8320
    s_nop 0
    buffer_load_dwordx4 v62, s[40:43], s82 offen lds
    s_add_u32 s82, s82, 2048
    s_add_u32 m0, s20, 16640
    s_nop 0
    buffer_load_dwordx4 v62, s[40:43], s82 offen lds
    s_waitcnt lgkmcnt(0)
    s_load_dword s24, s[32:33], s92 offset:1536 glc
    s_load_dword s25, s[32:33], s92 offset:1280 glc
    s_load_dword s26, s[32:33], s92 offset:2048 glc
    s_load_dword s27, s[32:33], s92 offset:1792 glc
    s_waitcnt vmcnt(21)
    v_lshlrev_b32 v4, 16, v80
    v_and_b32 v5, s6, v80
    v_mul_f32 v20, v4, v112
    v_mul_f32 v21, v5, v112
    v_lshlrev_b32 v6, 16, v81
    v_and_b32 v7, s6, v81
    v_mul_f32 v22, v6, v112
    v_mul_f32 v23, v7, v112
    v_lshlrev_b32 v4, 16, v82
    v_and_b32 v5, s6, v82
    v_mul_f32 v24, v4, v112
    v_mul_f32 v25, v5, v112
    v_lshlrev_b32 v6, 16, v83
    v_and_b32 v7, s6, v83
    v_mul_f32 v26, v6, v112
    v_mul_f32 v27, v7, v112
    s_barrier
    s_add_u32 s96, s85, 9
    s_and_b32 s97, s96, 15
    s_lshl3_add_u32 s98, s97, s3
    s_sub_u32 s99, s98, 4
    s_mul_i32 s96, s99, 49152
    s_lshl_b32 s97, s11, 7
    s_add_u32 s82, s96, s97
    s_sub_u32 s96, s3, 4
    s_lshr_b32 s97, s96, 1
    s_mul_i32 s98, s97, 2080
    s_sub_u32 s99, s3, 4
    s_and_b32 s96, s99, 1
    s_mul_i32 s97, s96, 1056
    s_add_u32 s99, s98, s97
    s_add_u32 s20, s99, 74880
    s_mov_b32 m0, s20
    s_nop 0
    buffer_load_dwordx4 v62, s[40:43], s82 offen lds
    s_add_u32 s82, s82, 2048
    s_add_u32 m0, s20, 8320
    s_nop 0
    buffer_load_dwordx4 v62, s[40:43], s82 offen lds
    s_add_u32 s82, s82, 2048
    s_add_u32 m0, s20, 16640
    s_nop 0
    buffer_load_dwordx4 v62, s[40:43], s82 offen lds
    s_add_u32 s96, s85, 9
    s_and_b32 s97, s96, 15
    s_lshl3_add_u32 s98, s97, s3
    s_mul_i32 s99, s98, 49152
    s_lshl_b32 s96, s11, 7
    s_add_u32 s82, s99, s96
    s_lshr_b32 s96, s3, 1
    s_mul_i32 s97, s96, 2080
    s_and_b32 s98, s3, 1
    s_mul_i32 s99, s98, 1056
    s_add_u32 s96, s97, s99
    s_add_u32 s20, s96, 74880
    s_mov_b32 m0, s20
    s_nop 0
    buffer_load_dwordx4 v62, s[40:43], s82 offen lds
    s_add_u32 s82, s82, 2048
    s_add_u32 m0, s20, 8320
    s_nop 0
    buffer_load_dwordx4 v62, s[40:43], s82 offen lds
    s_add_u32 s82, s82, 2048
    s_add_u32 m0, s20, 16640
    s_nop 0
    buffer_load_dwordx4 v62, s[40:43], s82 offen lds
    buffer_load_dwordx4 v[96:99], v60, s[48:51], s17 offen nt
    s_add_u32 s17, s17, 12288
    buffer_load_dwordx4 v[100:103], v60, s[48:51], s17 offen nt
    s_add_u32 s17, s17, 12288
    s_waitcnt vmcnt(28)
    v_lshlrev_b32 v4, 16, v84
    v_and_b32 v5, s6, v84
    v_fmac_f32 v20, v4, v113
    v_fmac_f32 v21, v5, v113
    v_lshlrev_b32 v6, 16, v85
    v_and_b32 v7, s6, v85
    v_fmac_f32 v22, v6, v113
    v_fmac_f32 v23, v7, v113
    v_lshlrev_b32 v4, 16, v86
    v_and_b32 v5, s6, v86
    v_fmac_f32 v24, v4, v113
    v_fmac_f32 v25, v5, v113
    v_lshlrev_b32 v6, 16, v87
    v_and_b32 v7, s6, v87
    v_fmac_f32 v26, v6, v113
    v_fmac_f32 v27, v7, v113
    s_waitcnt vmcnt(22)
    s_barrier
    s_add_u32 s96, s85, 10
    s_and_b32 s97, s96, 15
    s_lshl3_add_u32 s98, s97, s3
    s_sub_u32 s99, s98, 4
    s_mul_i32 s96, s99, 49152
    s_lshl_b32 s97, s11, 7
    s_add_u32 s82, s96, s97
    s_sub_u32 s96, s3, 4
    s_lshr_b32 s97, s96, 1
    s_mul_i32 s98, s97, 2080
    s_sub_u32 s99, s3, 4
    s_and_b32 s96, s99, 1
    s_mul_i32 s97, s96, 1056
    s_add_u32 s99, s98, s97
    s_add_u32 s20, s99, 99840
    s_mov_b32 m0, s20
    s_nop 0
    buffer_load_dwordx4 v62, s[40:43], s82 offen lds
    s_add_u32 s82, s82, 2048
    s_add_u32 m0, s20, 8320
    s_nop 0
    buffer_load_dwordx4 v62, s[40:43], s82 offen lds
    s_add_u32 s82, s82, 2048
    s_add_u32 m0, s20, 16640
    s_nop 0
    buffer_load_dwordx4 v62, s[40:43], s82 offen lds
    s_add_u32 s96, s85, 10
    s_and_b32 s97, s96, 15
    s_lshl3_add_u32 s98, s97, s3
    s_mul_i32 s99, s98, 49152
    s_lshl_b32 s96, s11, 7
    s_add_u32 s82, s99, s96
    s_lshr_b32 s96, s3, 1
    s_mul_i32 s97, s96, 2080
    s_and_b32 s98, s3, 1
    s_mul_i32 s99, s98, 1056
    s_add_u32 s96, s97, s99
    s_add_u32 s20, s96, 99840
    s_mov_b32 m0, s20
    s_nop 0
    buffer_load_dwordx4 v62, s[40:43], s82 offen lds
    s_add_u32 s82, s82, 2048
    s_add_u32 m0, s20, 8320
    s_nop 0
    buffer_load_dwordx4 v62, s[40:43], s82 offen lds
    s_add_u32 s82, s82, 2048
    s_add_u32 m0, s20, 16640
    s_nop 0
    buffer_load_dwordx4 v62, s[40:43], s82 offen lds
    s_waitcnt vmcnt(21)
    v_lshlrev_b32 v4, 16, v88
    v_and_b32 v5, s6, v88
    v_fmac_f32 v20, v4, v114
    v_fmac_f32 v21, v5, v114
    v_lshlrev_b32 v6, 16, v89
    v_and_b32 v7, s6, v89
    v_fmac_f32 v22, v6, v114
    v_fmac_f32 v23, v7, v114
    v_lshlrev_b32 v4, 16, v90
    v_and_b32 v5, s6, v90
    v_fmac_f32 v24, v4, v114
    v_fmac_f32 v25, v5, v114
    v_lshlrev_b32 v6, 16, v91
    v_and_b32 v7, s6, v91
    v_fmac_f32 v26, v6, v114
    v_fmac_f32 v27, v7, v114
    s_barrier
    s_add_u32 s96, s85, 11
    s_and_b32 s97, s96, 15
    s_lshl3_add_u32 s98, s97, s3
    s_sub_u32 s99, s98, 4
    s_mul_i32 s96, s99, 49152
    s_lshl_b32 s97, s11, 7
    s_add_u32 s82, s96, s97
    s_sub_u32 s96, s3, 4
    s_lshr_b32 s97, s96, 1
    s_mul_i32 s98, s97, 2080
    s_sub_u32 s99, s3, 4
    s_and_b32 s96, s99, 1
    s_mul_i32 s97, s96, 1056
    s_add_u32 s99, s98, s97
    s_add_u32 s20, s99, 124800
    s_mov_b32 m0, s20
    s_nop 0
    buffer_load_dwordx4 v62, s[40:43], s82 offen lds
    s_add_u32 s82, s82, 2048
    s_add_u32 m0, s20, 8320
    s_nop 0
    buffer_load_dwordx4 v62, s[40:43], s82 offen lds
    s_add_u32 s82, s82, 2048
    s_add_u32 m0, s20, 16640
    s_nop 0
    buffer_load_dwordx4 v62, s[40:43], s82 offen lds
    s_add_u32 s96, s85, 11
    s_and_b32 s97, s96, 15
    s_lshl3_add_u32 s98, s97, s3
    s_mul_i32 s99, s98, 49152
    s_lshl_b32 s96, s11, 7
    s_add_u32 s82, s99, s96
    s_lshr_b32 s96, s3, 1
    s_mul_i32 s97, s96, 2080
    s_and_b32 s98, s3, 1
    s_mul_i32 s99, s98, 1056
    s_add_u32 s96, s97, s99
    s_add_u32 s20, s96, 124800
    s_mov_b32 m0, s20
    s_nop 0
    buffer_load_dwordx4 v62, s[40:43], s82 offen lds
    s_add_u32 s82, s82, 2048
    s_add_u32 m0, s20, 8320
    s_nop 0
    buffer_load_dwordx4 v62, s[40:43], s82 offen lds
    s_add_u32 s82, s82, 2048
    s_add_u32 m0, s20, 16640
    s_nop 0
    buffer_load_dwordx4 v62, s[40:43], s82 offen lds
    buffer_load_dwordx4 v[104:107], v60, s[48:51], s17 offen nt
    s_add_u32 s17, s17, 12288
    buffer_load_dwordx4 v[108:111], v60, s[48:51], s17 offen nt
    s_lshl2_add_u32 s96, s74, s75
    s_lshl_b32 s97, s96, 11
    s_and_b32 s98, s3, 1
    s_lshl_b32 s99, s98, 10
    s_add_u32 s96, s97, s99
    s_add_u32 s13, s96, 20971520
    s_lshl4_add_u32 s96, s21, s12
    s_lshl_b32 s97, s96, 11
    s_and_b32 s98, s3, 1
    s_lshl_b32 s99, s98, 10
    s_add_u32 s96, s97, s99
    s_add_u32 s14, s96, 12582912
    buffer_load_dwordx4 v[124:127], v2, s[32:35], s13 offen
    s_waitcnt vmcnt(29)
    v_lshlrev_b32 v4, 16, v92
    v_and_b32 v5, s6, v92
    v_fmac_f32 v20, v4, v115
    v_fmac_f32 v21, v5, v115
    v_lshlrev_b32 v6, 16, v93
    v_and_b32 v7, s6, v93
    v_fmac_f32 v22, v6, v115
    v_fmac_f32 v23, v7, v115
    v_lshlrev_b32 v4, 16, v94
    v_and_b32 v5, s6, v94
    v_fmac_f32 v24, v4, v115
    v_fmac_f32 v25, v5, v115
    v_lshlrev_b32 v6, 16, v95
    v_and_b32 v7, s6, v95
    v_fmac_f32 v26, v6, v115
    v_fmac_f32 v27, v7, v115
    s_waitcnt lgkmcnt(0)
    s_load_dword s24, s[32:33], s92 offset:2560 glc
    s_load_dword s25, s[32:33], s92 offset:2304 glc
    s_load_dword s26, s[32:33], s92 offset:3072 glc
    s_load_dword s27, s[32:33], s92 offset:2816 glc
    s_load_dword s28, s[32:33], s92 offset:3584 glc
    s_load_dword s29, s[32:33], s92 offset:3328 glc
    s_waitcnt vmcnt(23)
    s_barrier
    s_add_u32 s96, s85, 12
    s_and_b32 s97, s96, 15
    s_lshl3_add_u32 s98, s97, s3
    s_sub_u32 s99, s98, 4
    s_mul_i32 s96, s99, 49152
    s_lshl_b32 s97, s11, 7
    s_add_u32 s82, s96, s97
    s_sub_u32 s96, s3, 4
    s_lshr_b32 s97, s96, 1
    s_mul_i32 s98, s97, 2080
    s_sub_u32 s99, s3, 4
    s_and_b32 s96, s99, 1
    s_mul_i32 s97, s96, 1056
    s_add_u32 s20, s98, s97
    s_mov_b32 m0, s20
    s_nop 0
    buffer_load_dwordx4 v62, s[40:43], s82 offen lds
    s_add_u32 s82, s82, 2048
    s_add_u32 m0, s20, 8320
    s_nop 0
    buffer_load_dwordx4 v62, s[40:43], s82 offen lds
    s_add_u32 s82, s82, 2048
    s_add_u32 m0, s20, 16640
    s_nop 0
    buffer_load_dwordx4 v62, s[40:43], s82 offen lds
    s_add_u32 s96, s85, 12
    s_and_b32 s97, s96, 15
    s_lshl3_add_u32 s98, s97, s3
    s_mul_i32 s99, s98, 49152
    s_lshl_b32 s96, s11, 7
    s_add_u32 s82, s99, s96
    s_lshr_b32 s96, s3, 1
    s_mul_i32 s97, s96, 2080
    s_and_b32 s98, s3, 1
    s_mul_i32 s99, s98, 1056
    s_add_u32 s20, s97, s99
    s_mov_b32 m0, s20
    s_nop 0
    buffer_load_dwordx4 v62, s[40:43], s82 offen lds
    s_add_u32 s82, s82, 2048
    s_add_u32 m0, s20, 8320
    s_nop 0
    buffer_load_dwordx4 v62, s[40:43], s82 offen lds
    s_add_u32 s82, s82, 2048
    s_add_u32 m0, s20, 16640
    s_nop 0
    buffer_load_dwordx4 v62, s[40:43], s82 offen lds
    s_waitcnt vmcnt(22)
    v_lshlrev_b32 v4, 16, v96
    v_and_b32 v5, s6, v96
    v_fmac_f32 v20, v4, v116
    v_fmac_f32 v21, v5, v116
    v_lshlrev_b32 v6, 16, v97
    v_and_b32 v7, s6, v97
    v_fmac_f32 v22, v6, v116
    v_fmac_f32 v23, v7, v116
    v_lshlrev_b32 v4, 16, v98
    v_and_b32 v5, s6, v98
    v_fmac_f32 v24, v4, v116
    v_fmac_f32 v25, v5, v116
    v_lshlrev_b32 v6, 16, v99
    v_and_b32 v7, s6, v99
    v_fmac_f32 v26, v6, v116
    v_fmac_f32 v27, v7, v116
    s_waitcnt vmcnt(21)
    v_lshlrev_b32 v4, 16, v100
    v_and_b32 v5, s6, v100
    v_fmac_f32 v20, v4, v117
    v_fmac_f32 v21, v5, v117
    v_lshlrev_b32 v6, 16, v101
    v_and_b32 v7, s6, v101
    v_fmac_f32 v22, v6, v117
    v_fmac_f32 v23, v7, v117
    v_lshlrev_b32 v4, 16, v102
    v_and_b32 v5, s6, v102
    v_fmac_f32 v24, v4, v117
    v_fmac_f32 v25, v5, v117
    v_lshlrev_b32 v6, 16, v103
    v_and_b32 v7, s6, v103
    v_fmac_f32 v26, v6, v117
    v_fmac_f32 v27, v7, v117
    s_barrier
    s_add_u32 s96, s85, 13
    s_and_b32 s97, s96, 15
    s_lshl3_add_u32 s98, s97, s3
    s_sub_u32 s99, s98, 4
    s_mul_i32 s96, s99, 49152
    s_lshl_b32 s97, s11, 7
    s_add_u32 s82, s96, s97
    s_sub_u32 s96, s3, 4
    s_lshr_b32 s97, s96, 1
    s_mul_i32 s98, s97, 2080
    s_sub_u32 s99, s3, 4
    s_and_b32 s96, s99, 1
    s_mul_i32 s97, s96, 1056
    s_add_u32 s99, s98, s97
    s_add_u32 s20, s99, 24960
    s_mov_b32 m0, s20
    s_nop 0
    buffer_load_dwordx4 v62, s[40:43], s82 offen lds
    s_add_u32 s82, s82, 2048
    s_add_u32 m0, s20, 8320
    s_nop 0
    buffer_load_dwordx4 v62, s[40:43], s82 offen lds
    s_add_u32 s82, s82, 2048
    s_add_u32 m0, s20, 16640
    s_nop 0
    buffer_load_dwordx4 v62, s[40:43], s82 offen lds
    s_add_u32 s96, s85, 13
    s_and_b32 s97, s96, 15
    s_lshl3_add_u32 s98, s97, s3
    s_mul_i32 s99, s98, 49152
    s_lshl_b32 s96, s11, 7
    s_add_u32 s82, s99, s96
    s_lshr_b32 s96, s3, 1
    s_mul_i32 s97, s96, 2080
    s_and_b32 s98, s3, 1
    s_mul_i32 s99, s98, 1056
    s_add_u32 s96, s97, s99
    s_add_u32 s20, s96, 24960
    s_mov_b32 m0, s20
    s_nop 0
    buffer_load_dwordx4 v62, s[40:43], s82 offen lds
    s_add_u32 s82, s82, 2048
    s_add_u32 m0, s20, 8320
    s_nop 0
    buffer_load_dwordx4 v62, s[40:43], s82 offen lds
    s_add_u32 s82, s82, 2048
    s_add_u32 m0, s20, 16640
    s_nop 0
    buffer_load_dwordx4 v62, s[40:43], s82 offen lds
    s_waitcnt vmcnt(14)
    v_lshlrev_b32 v4, 16, v104
    v_and_b32 v5, s6, v104
    v_fmac_f32 v20, v4, v118
    v_fmac_f32 v21, v5, v118
    v_lshlrev_b32 v6, 16, v105
    v_and_b32 v7, s6, v105
    v_fmac_f32 v22, v6, v118
    v_fmac_f32 v23, v7, v118
    v_lshlrev_b32 v4, 16, v106
    v_and_b32 v5, s6, v106
    v_fmac_f32 v24, v4, v118
    v_fmac_f32 v25, v5, v118
    v_lshlrev_b32 v6, 16, v107
    v_and_b32 v7, s6, v107
    v_fmac_f32 v26, v6, v118
    v_fmac_f32 v27, v7, v118
    s_waitcnt vmcnt(13)
    v_lshlrev_b32 v4, 16, v108
    v_and_b32 v5, s6, v108
    v_fmac_f32 v20, v4, v119
    v_fmac_f32 v21, v5, v119
    v_lshlrev_b32 v6, 16, v109
    v_and_b32 v7, s6, v109
    v_fmac_f32 v22, v6, v119
    v_fmac_f32 v23, v7, v119
    v_lshlrev_b32 v4, 16, v110
    v_and_b32 v5, s6, v110
    v_fmac_f32 v24, v4, v119
    v_fmac_f32 v25, v5, v119
    v_lshlrev_b32 v6, 16, v111
    v_and_b32 v7, s6, v111
    v_fmac_f32 v26, v6, v119
    v_fmac_f32 v27, v7, v119
    v_permlane32_swap_b32 v20, v24
    v_permlane32_swap_b32 v21, v25
    v_permlane32_swap_b32 v22, v26
    v_permlane32_swap_b32 v23, v27
    v_add_f32 v20, v20, v24
    v_add_f32 v21, v21, v25
    v_add_f32 v22, v22, v26
    v_add_f32 v23, v23, v27
    s_nop 0
    v_permlane16_swap_b32 v20, v22
    v_permlane16_swap_b32 v21, v23
    v_add_f32 v20, v20, v22
    v_add_f32 v21, v21, v23
    s_nop 0
    v_add_f32_dpp v20, v20, v20 row_ror:8 row_mask:0xf bank_mask:0xf
    v_add_f32_dpp v21, v21, v21 row_ror:8 row_mask:0xf bank_mask:0xf
    s_nop 1
    v_mov_b32_dpp v20, v21 quad_perm:[0,1,2,3] row_mask:0xf bank_mask:0xc
    ds_write_b32 v65, v20 offset:1024
    s_waitcnt lgkmcnt(0)
    s_barrier
    s_add_u32 s96, s85, 14
    s_and_b32 s97, s96, 15
    s_lshl3_add_u32 s98, s97, s3
    s_sub_u32 s99, s98, 4
    s_mul_i32 s96, s99, 49152
    s_lshl_b32 s97, s11, 7
    s_add_u32 s82, s96, s97
    s_sub_u32 s96, s3, 4
    s_lshr_b32 s97, s96, 1
    s_mul_i32 s98, s97, 2080
    s_sub_u32 s99, s3, 4
    s_and_b32 s96, s99, 1
    s_mul_i32 s97, s96, 1056
    s_add_u32 s99, s98, s97
    s_add_u32 s20, s99, 49920
    s_mov_b32 m0, s20
    s_nop 0
    buffer_load_dwordx4 v62, s[40:43], s82 offen lds
    s_add_u32 s82, s82, 2048
    s_add_u32 m0, s20, 8320
    s_nop 0
    buffer_load_dwordx4 v62, s[40:43], s82 offen lds
    s_add_u32 s82, s82, 2048
    s_add_u32 m0, s20, 16640
    s_nop 0
    buffer_load_dwordx4 v62, s[40:43], s82 offen lds
    s_add_u32 s96, s85, 14
    s_and_b32 s97, s96, 15
    s_lshl3_add_u32 s98, s97, s3
    s_mul_i32 s99, s98, 49152
    s_lshl_b32 s96, s11, 7
    s_add_u32 s82, s99, s96
    s_lshr_b32 s96, s3, 1
    s_mul_i32 s97, s96, 2080
    s_and_b32 s98, s3, 1
    s_mul_i32 s99, s98, 1056
    s_add_u32 s96, s97, s99
    s_add_u32 s20, s96, 49920
    s_mov_b32 m0, s20
    s_nop 0
    buffer_load_dwordx4 v62, s[40:43], s82 offen lds
    s_add_u32 s82, s82, 2048
    s_add_u32 m0, s20, 8320
    s_nop 0
    buffer_load_dwordx4 v62, s[40:43], s82 offen lds
    s_add_u32 s82, s82, 2048
    s_add_u32 m0, s20, 16640
    s_nop 0
    buffer_load_dwordx4 v62, s[40:43], s82 offen lds
    s_cmp_lg_u32 s3, 4
    s_cbranch_scc1 L_M2F
    ds_read_b128 v[20:23], v64 offset:1024
    s_bfe_u32 s96, s9, 131074
    s_lshl_b32 s97, s8, 1
    s_lshl4_add_u32 s98, s96, s97
    s_lshr_b32 s99, s9, 4
    s_add_u32 s96, s98, s99
    s_and_b32 s97, s9, 3
    s_lshl2_add_u32 s98, s96, s97
    s_lshl_b32 s99, s98, 9
    s_add_u32 s13, s99, 131072
    s_waitcnt lgkmcnt(0)
    v_add_f32 v20, v20, v21
    v_add_f32 v22, v22, v23
    v_mov_b32 v21, s4
    v_add_f32 v20, v20, v22
    buffer_store_dwordx2 v[20:21], v63, s[32:35], s13 offen sc1
L_M2F:
    s_barrier
    s_add_u32 s96, s85, 15
    s_and_b32 s97, s96, 15
    s_lshl3_add_u32 s98, s97, s3
    s_sub_u32 s99, s98, 4
    s_mul_i32 s96, s99, 49152
    s_lshl_b32 s97, s11, 7
    s_add_u32 s82, s96, s97
    s_sub_u32 s96, s3, 4
    s_lshr_b32 s97, s96, 1
    s_mul_i32 s98, s97, 2080
    s_sub_u32 s99, s3, 4
    s_and_b32 s96, s99, 1
    s_mul_i32 s97, s96, 1056
    s_add_u32 s99, s98, s97
    s_add_u32 s20, s99, 74880
    s_mov_b32 m0, s20
    s_nop 0
    buffer_load_dwordx4 v62, s[40:43], s82 offen lds
    s_add_u32 s82, s82, 2048
    s_add_u32 m0, s20, 8320
    s_nop 0
    buffer_load_dwordx4 v62, s[40:43], s82 offen lds
    s_add_u32 s82, s82, 2048
    s_add_u32 m0, s20, 16640
    s_nop 0
    buffer_load_dwordx4 v62, s[40:43], s82 offen lds
    s_add_u32 s96, s85, 15
    s_and_b32 s97, s96, 15
    s_lshl3_add_u32 s98, s97, s3
    s_mul_i32 s99, s98, 49152
    s_lshl_b32 s96, s11, 7
    s_add_u32 s82, s99, s96
    s_lshr_b32 s96, s3, 1
    s_mul_i32 s97, s96, 2080
    s_and_b32 s98, s3, 1
    s_mul_i32 s99, s98, 1056
    s_add_u32 s96, s97, s99
    s_add_u32 s20, s96, 74880
    s_mov_b32 m0, s20
    s_nop 0
    buffer_load_dwordx4 v62, s[40:43], s82 offen lds
    s_add_u32 s82, s82, 2048
    s_add_u32 m0, s20, 8320
    s_nop 0
    buffer_load_dwordx4 v62, s[40:43], s82 offen lds
    s_add_u32 s82, s82, 2048
    s_add_u32 m0, s20, 16640
    s_nop 0
    buffer_load_dwordx4 v62, s[40:43], s82 offen lds
    s_mov_b32 s13, s80
    buffer_load_dwordx4 v[176:179], v72, s[52:55], s13 offen nt
    s_add_u32 s13, s80, 4294049792
    buffer_load_dwordx4 v[180:183], v72, s[52:55], s13 offen nt
    s_waitcnt vmcnt(20)
    s_barrier
    s_waitcnt vmcnt(14)
    s_waitcnt vmcnt(8)
    s_waitcnt vmcnt(2)
    s_barrier
    v_and_b32 v89, 31, v1
    v_lshlrev_b32 v89, 4, v89
    v_lshrrev_b32 v9, 5, v1
    v_lshl_add_u32 v89, v9, 9, v89
    s_and_b32 s96, s3, 3
    s_lshl4_add_u32 s97, s96, s12
    s_lshl_b32 s98, s97, 11
    s_add_u32 s18, s98, 131072
    s_lshl_b32 s13, s12, 7
    v_and_b32 v4, 31, v1
    v_lshl_add_u32 v4, v4, 2, s13
    global_load_dword v88, v4, s[78:79]
    buffer_load_dwordx4 v[80:83], v89, s[32:35], s18 offen sc1
    buffer_load_dwordx4 v[84:87], v89, s[32:35], s18 offen offset:1024 sc1
    s_barrier
    s_lshl4_add_u32 s96, s11, s10
    s_lshl_b32 s97, s96, 10
    s_and_b32 s98, s3, 3
    s_lshl_b32 s99, s98, 8
    s_add_u32 s96, s97, s99
    s_add_u32 s13, s96, 29360128
    s_lshl_b32 s96, s11, 7
    s_add_u32 s14, s96, 32768
    v_lshlrev_b32 v60, 7, v1
    s_mov_b64 exec, 3
    buffer_load_dword v60, v60, s[32:35], s13 offen
    buffer_load_dword v61, v3, s[32:35], s14 offen
    s_mov_b64 exec, -1
    s_add_u32 s96, s84, 1114112
    s_and_b32 s97, s96, 1048575
    s_lshl_b32 s98, s83, 16
    s_xor_b32 s99, s97, s98
    s_xor_b32 s96, s88, 1048576
    s_add_u32 s13, s99, s96
    s_add_u32 m0, s89, 102400
    s_nop 0
    buffer_load_dwordx4 v74, s[44:47], s13 offen lds
    s_add_u32 s96, s84, 1179648
    s_and_b32 s97, s96, 1048575
    s_lshl_b32 s98, s83, 16
    s_xor_b32 s99, s97, s98
    s_xor_b32 s96, s88, 1048576
    s_add_u32 s13, s99, s96
    s_add_u32 m0, s89, 106496
    s_nop 0
    buffer_load_dwordx4 v74, s[44:47], s13 offen lds
    s_add_u32 s96, s84, 1245184
    s_and_b32 s97, s96, 1048575
    s_lshl_b32 s98, s83, 16
    s_xor_b32 s99, s97, s98
    s_xor_b32 s96, s88, 1048576
    s_add_u32 s13, s99, s96
    s_add_u32 m0, s89, 110592
    s_nop 0
    buffer_load_dwordx4 v74, s[44:47], s13 offen lds
    s_add_u32 s96, s84, 1310720
    s_and_b32 s97, s96, 1048575
    s_lshl_b32 s98, s83, 16
    s_xor_b32 s99, s97, s98
    s_xor_b32 s96, s88, 1048576
    s_add_u32 s13, s99, s96
    s_add_u32 m0, s89, 114688
    s_nop 0
    buffer_load_dwordx4 v74, s[44:47], s13 offen lds
    s_add_u32 s96, s84, 1376256
    s_and_b32 s97, s96, 1048575
    s_lshl_b32 s98, s83, 16
    s_xor_b32 s99, s97, s98
    s_xor_b32 s96, s88, 1048576
    s_add_u32 s13, s99, s96
    s_add_u32 m0, s89, 118784
    s_nop 0
    buffer_load_dwordx4 v74, s[44:47], s13 offen lds
    s_add_u32 s96, s84, 1441792
    s_and_b32 s97, s96, 1048575
    s_lshl_b32 s98, s83, 16
    s_xor_b32 s99, s97, s98
    s_xor_b32 s96, s88, 1048576
    s_add_u32 s13, s99, s96
    s_add_u32 m0, s89, 122880
    s_nop 0
    buffer_load_dwordx4 v74, s[44:47], s13 offen lds
    s_add_u32 s96, s84, 1507328
    s_and_b32 s97, s96, 1048575
    s_lshl_b32 s98, s83, 16
    s_xor_b32 s99, s97, s98
    s_xor_b32 s96, s88, 1048576
    s_add_u32 s13, s99, s96
    s_add_u32 m0, s89, 126976
    s_nop 0
    buffer_load_dwordx4 v74, s[44:47], s13 offen lds
    s_add_u32 s96, s84, 1572864
    s_and_b32 s97, s96, 1048575
    s_lshl_b32 s98, s83, 16
    s_xor_b32 s99, s97, s98
    s_xor_b32 s96, s88, 1048576
    s_add_u32 s13, s99, s96
    s_add_u32 m0, s89, 131072
    s_nop 0
    buffer_load_dwordx4 v74, s[44:47], s13 offen lds
    s_add_u32 s13, s80, 57344
    buffer_load_dwordx4 v[184:187], v72, s[52:55], s13 offen nt
    s_add_u32 s13, s80, 4294107136
    buffer_load_dwordx4 v[188:191], v72, s[52:55], s13 offen nt
    s_add_u32 s13, s80, 114688
    buffer_load_dwordx4 v[192:195], v72, s[52:55], s13 offen nt
    s_add_u32 s13, s80, 4294164480
    buffer_load_dwordx4 v[196:199], v72, s[52:55], s13 offen nt
    s_add_u32 s13, s80, 172032
    buffer_load_dwordx4 v[200:203], v72, s[52:55], s13 offen nt
    s_add_u32 s13, s80, 4294221824
    buffer_load_dwordx4 v[204:207], v72, s[52:55], s13 offen nt
    s_mov_b32 s13, s80
    buffer_load_dwordx4 v[208:211], v72, s[56:59], s13 offen nt
    s_add_u32 s13, s80, 4294049792
    buffer_load_dwordx4 v[212:215], v72, s[56:59], s13 offen nt
    s_waitcnt vmcnt(18)
    v_bitop3_b32 v4, v81, v83, s4 bitop3:0x7e
    v_bitop3_b32 v4, v4, v85, s4 bitop3:0xf6
    v_bitop3_b32 v4, v4, v87, s4 bitop3:0xf6
    v_cmp_ne_u32 vcc, 0, v4
    s_cbranch_vccz TOK_14
POLL_15:
    buffer_load_dwordx4 v[80:83], v89, s[32:35], s18 offen sc1
    buffer_load_dwordx4 v[84:87], v89, s[32:35], s18 offen offset:1024 sc1
    s_waitcnt vmcnt(0)
    v_bitop3_b32 v4, v81, v83, s4 bitop3:0x7e
    v_bitop3_b32 v4, v4, v85, s4 bitop3:0xf6
    v_bitop3_b32 v4, v4, v87, s4 bitop3:0xf6
    v_cmp_ne_u32 vcc, 0, v4
    s_cbranch_vccz PDONE_16
    s_add_u32 s5, s5, 1
    s_cmp_lt_u32 s5, 300000
    s_cbranch_scc1 POLL_15
PDONE_16:
TOK_14:
    s_and_b32 s96, s3, 3
    s_lshl_b32 s97, s96, 7
    s_add_u32 s13, s97, 139264
    v_and_b32 v4, 31, v1
    v_lshl_add_u32 v4, v4, 2, s13
    s_and_b32 s14, s3, 3
    v_add_f32 v80, v80, v84
    v_add_f32 v81, v82, v86
    v_mov_b32 v82, v80
    v_mov_b32 v83, v81
    s_cmp_eq_u32 s14, 2
    s_cselect_b32 s15, 1.0, 0
    v_permlane32_swap_b32 v80, v82
    v_permlane32_swap_b32 v81, v83
    v_pk_add_f32 v[80:81], v[80:81], v[82:83]
    v_cvt_pk_bf16_f32 v80, 0, v80
    v_cvt_pk_bf16_f32 v81, 0, v81
    v_add_f32 v80, s15, v80
    v_add_f32 v81, s15, v81
    v_cvt_pk_bf16_f32 v82, v80, v81
    ds_write_b32 v4, v82
    s_cbranch_scc0 L_NOG
    v_lshlrev_b32 v80, 16, v82
    v_and_b32 v81, s6, v82
    v_lshlrev_b32 v84, 16, v88
    v_and_b32 v85, s6, v88
    v_pk_mul_f32 v[84:85], v[84:85], v[80:81]
    v_cvt_pk_bf16_f32 v86, v84, v85
    v_lshlrev_b32 v80, 16, v86
    v_and_b32 v81, s6, v86
    v_pk_add_f32 v[80:81], v[84:85], v[80:81] neg_lo:[0,1] neg_hi:[0,1]
    v_cvt_pk_bf16_f32 v87, v80, v81
    v_add_f32 v80, v84, v85
    ds_write2_b32 v4, v86, v87 offset0:64 offset1:96
    ds_write_b32 v4, v88 offset:512
    v_add_f32_dpp v80, v80, v80 quad_perm:[1,0,3,2] row_mask:0xf bank_mask:0xf
    s_nop 1
    v_add_f32_dpp v80, v80, v80 quad_perm:[2,3,0,1] row_mask:0xf bank_mask:0xf
    s_nop 1
    v_add_f32_dpp v80, v80, v80 row_half_mirror row_mask:0xf bank_mask:0xf
    s_nop 1
    v_add_f32_dpp v80, v80, v80 row_ror:8 row_mask:0xf bank_mask:0xf
    s_lshl4_add_u32 s96, s21, s12
    s_lshl3_add_u32 s13, s96, 65536
    v_mov_b32 v82, v80
    v_mov_b32 v81, s4
    s_nop 0
    v_permlane16_swap_b32 v80, v82
    v_add_f32 v80, v80, v82
    s_mov_b64 exec, 1
    buffer_store_dwordx2 v[80:81], v3, s[32:35], s13 offen sc1
    s_mov_b64 exec, -1
L_NOG:
    s_waitcnt lgkmcnt(0)
    s_barrier
    ds_read_b128 v[36:39], v76
    ds_read_b128 v[40:43], v76 offset:1024
    s_waitcnt lgkmcnt(0)
    v_mfma_f32_32x32x16_bf16 v[112:127], v[28:31], v[36:39], 0
    v_mfma_f32_32x32x16_bf16 v[112:127], v[32:35], v[40:43], v[112:127]
    s_add_u32 s13, s80, 57344
    buffer_load_dwordx4 v[216:219], v72, s[56:59], s13 offen nt
    s_add_u32 s13, s80, 4294107136
    buffer_load_dwordx4 v[220:223], v72, s[56:59], s13 offen nt
L_JOIN:
    s_nop 7
    v_cvt_pk_bf16_f32 v112, 0, v112
    v_cvt_pk_bf16_f32 v113, 0, v113
    v_cvt_pk_bf16_f32 v114, 0, v114
    v_cvt_pk_bf16_f32 v115, 0, v115
    v_cvt_pk_bf16_f32 v116, 0, v116
    v_cvt_pk_bf16_f32 v117, 0, v117
    v_cvt_pk_bf16_f32 v118, 0, v118
    v_cvt_pk_bf16_f32 v119, 0, v119
    v_cvt_pk_bf16_f32 v120, 0, v120
    v_cvt_pk_bf16_f32 v121, 0, v121
    v_cvt_pk_bf16_f32 v122, 0, v122
    v_cvt_pk_bf16_f32 v123, 0, v123
    v_cvt_pk_bf16_f32 v124, 0, v124
    v_cvt_pk_bf16_f32 v125, 0, v125
    v_cvt_pk_bf16_f32 v126, 0, v126
    v_cvt_pk_bf16_f32 v127, 0, v127
    v_max3_f32 v4, v112, v113, v114
    v_min3_f32 v5, v112, v113, v114
    v_max3_f32 v4, v4, v115, v116
    v_min3_f32 v5, v5, v115, v116
    v_max3_f32 v4, v4, v117, v118
    v_min3_f32 v5, v5, v117, v118
    v_max3_f32 v4, v4, v119, v120
    v_min3_f32 v5, v5, v119, v120
    v_max3_f32 v4, v4, v121, v122
    v_min3_f32 v5, v5, v121, v122
    v_max3_f32 v4, v4, v123, v124
    v_min3_f32 v5, v5, v123, v124
    v_max3_f32 v4, v4, v125, v126
    v_min3_f32 v5, v5, v125, v126
    v_max_f32 v6, v4, v127
    v_min_f32 v7, v5, v127
    v_max_f32 v4, v4, v127
    v_min_f32 v5, v5, v127
    s_nop 0
    v_permlane32_swap_b32 v4, v6
    v_permlane32_swap_b32 v5, v7
    v_max_f32 v4, v4, v6
    v_min_f32 v5, v5, v7
    v_pk_mul_f32 v[4:5], v[4:5], s[6:7] op_sel:[0,1]
    v_pk_fma_f32 v[128:129], v[112:113], s[6:7], v[4:5] op_sel:[0,1,0] op_sel_hi:[1,1,0] neg_lo:[0,0,1] neg_hi:[0,0,1]
    v_pk_fma_f32 v[112:113], v[112:113], s[6:7], v[4:5] op_sel:[0,1,1] neg_lo:[1,0,0] neg_hi:[1,0,0]
    v_pk_fma_f32 v[130:131], v[114:115], s[6:7], v[4:5] op_sel:[0,1,0] op_sel_hi:[1,1,0] neg_lo:[0,0,1] neg_hi:[0,0,1]
    v_pk_fma_f32 v[114:115], v[114:115], s[6:7], v[4:5] op_sel:[0,1,1] neg_lo:[1,0,0] neg_hi:[1,0,0]
    v_pk_fma_f32 v[132:133], v[116:117], s[6:7], v[4:5] op_sel:[0,1,0] op_sel_hi:[1,1,0] neg_lo:[0,0,1] neg_hi:[0,0,1]
    v_pk_fma_f32 v[116:117], v[116:117], s[6:7], v[4:5] op_sel:[0,1,1] neg_lo:[1,0,0] neg_hi:[1,0,0]
    v_pk_fma_f32 v[134:135], v[118:119], s[6:7], v[4:5] op_sel:[0,1,0] op_sel_hi:[1,1,0] neg_lo:[0,0,1] neg_hi:[0,0,1]
    v_pk_fma_f32 v[118:119], v[118:119], s[6:7], v[4:5] op_sel:[0,1,1] neg_lo:[1,0,0] neg_hi:[1,0,0]
    v_pk_fma_f32 v[136:137], v[120:121], s[6:7], v[4:5] op_sel:[0,1,0] op_sel_hi:[1,1,0] neg_lo:[0,0,1] neg_hi:[0,0,1]
    v_pk_fma_f32 v[120:121], v[120:121], s[6:7], v[4:5] op_sel:[0,1,1] neg_lo:[1,0,0] neg_hi:[1,0,0]
    v_pk_fma_f32 v[138:139], v[122:123], s[6:7], v[4:5] op_sel:[0,1,0] op_sel_hi:[1,1,0] neg_lo:[0,0,1] neg_hi:[0,0,1]
    v_pk_fma_f32 v[122:123], v[122:123], s[6:7], v[4:5] op_sel:[0,1,1] neg_lo:[1,0,0] neg_hi:[1,0,0]
    v_pk_fma_f32 v[140:141], v[124:125], s[6:7], v[4:5] op_sel:[0,1,0] op_sel_hi:[1,1,0] neg_lo:[0,0,1] neg_hi:[0,0,1]
    v_pk_fma_f32 v[124:125], v[124:125], s[6:7], v[4:5] op_sel:[0,1,1] neg_lo:[1,0,0] neg_hi:[1,0,0]
    v_pk_fma_f32 v[142:143], v[126:127], s[6:7], v[4:5] op_sel:[0,1,0] op_sel_hi:[1,1,0] neg_lo:[0,0,1] neg_hi:[0,0,1]
    v_pk_fma_f32 v[126:127], v[126:127], s[6:7], v[4:5] op_sel:[0,1,1] neg_lo:[1,0,0] neg_hi:[1,0,0]
    v_exp_f32 v128, v128
    v_exp_f32 v112, v112
    v_exp_f32 v129, v129
    v_exp_f32 v113, v113
    v_exp_f32 v130, v130
    v_exp_f32 v114, v114
    v_exp_f32 v131, v131
    v_exp_f32 v115, v115
    v_exp_f32 v132, v132
    v_exp_f32 v116, v116
    v_exp_f32 v133, v133
    v_exp_f32 v117, v117
    v_exp_f32 v134, v134
    v_exp_f32 v118, v118
    v_exp_f32 v135, v135
    v_exp_f32 v119, v119
    v_exp_f32 v136, v136
    v_exp_f32 v120, v120
    v_exp_f32 v137, v137
    v_exp_f32 v121, v121
    v_exp_f32 v138, v138
    v_exp_f32 v122, v122
    v_exp_f32 v139, v139
    v_exp_f32 v123, v123
    v_exp_f32 v140, v140
    v_exp_f32 v124, v124
    v_exp_f32 v141, v141
    v_exp_f32 v125, v125
    v_exp_f32 v142, v142
    v_exp_f32 v126, v126
    v_exp_f32 v143, v143
    v_exp_f32 v127, v127
    v_pk_add_f32 v[8:9], v[128:129], v[130:131]
    v_pk_add_f32 v[10:11], v[112:113], v[114:115]
    v_pk_add_f32 v[8:9], v[8:9], v[132:133]
    v_pk_add_f32 v[10:11], v[10:11], v[116:117]
    v_pk_add_f32 v[8:9], v[8:9], v[134:135]
    v_pk_add_f32 v[10:11], v[10:11], v[118:119]
    v_pk_add_f32 v[8:9], v[8:9], v[136:137]
    v_pk_add_f32 v[10:11], v[10:11], v[120:121]
    v_pk_add_f32 v[8:9], v[8:9], v[138:139]
    v_pk_add_f32 v[10:11], v[10:11], v[122:123]
    v_pk_add_f32 v[8:9], v[8:9], v[140:141]
    v_pk_add_f32 v[10:11], v[10:11], v[124:125]
    v_pk_add_f32 v[8:9], v[8:9], v[142:143]
    v_pk_add_f32 v[10:11], v[10:11], v[126:127]
    v_add_f32 v6, v8, v9
    v_add_f32 v7, v10, v11
    v_add_f32 v4, v8, v9
    v_add_f32 v5, v10, v11
    s_nop 0
    v_permlane32_swap_b32 v4, v6
    v_permlane32_swap_b32 v5, v7
    v_pk_add_f32 v[4:5], v[4:5], v[6:7]
    v_rcp_f32 v4, v4
    v_rcp_f32 v5, v5
    s_nop 0
    v_pk_mul_f32 v[128:129], v[128:129], v[4:5] op_sel_hi:[1,0]
    v_pk_mul_f32 v[112:113], v[112:113], v[4:5] op_sel:[0,1]
    v_pk_mul_f32 v[130:131], v[130:131], v[4:5] op_sel_hi:[1,0]
    v_pk_mul_f32 v[114:115], v[114:115], v[4:5] op_sel:[0,1]
    v_pk_mul_f32 v[132:133], v[132:133], v[4:5] op_sel_hi:[1,0]
    v_pk_mul_f32 v[116:117], v[116:117], v[4:5] op_sel:[0,1]
    v_pk_mul_f32 v[134:135], v[134:135], v[4:5] op_sel_hi:[1,0]
    v_pk_mul_f32 v[118:119], v[118:119], v[4:5] op_sel:[0,1]
    v_pk_mul_f32 v[136:137], v[136:137], v[4:5] op_sel_hi:[1,0]
    v_pk_mul_f32 v[120:121], v[120:121], v[4:5] op_sel:[0,1]
    v_pk_mul_f32 v[138:139], v[138:139], v[4:5] op_sel_hi:[1,0]
    v_pk_mul_f32 v[122:123], v[122:123], v[4:5] op_sel:[0,1]
    v_pk_mul_f32 v[140:141], v[140:141], v[4:5] op_sel_hi:[1,0]
    v_pk_mul_f32 v[124:125], v[124:125], v[4:5] op_sel:[0,1]
    v_pk_mul_f32 v[142:143], v[142:143], v[4:5] op_sel_hi:[1,0]
    v_pk_mul_f32 v[126:127], v[126:127], v[4:5] op_sel:[0,1]
    v_cvt_pk_bf16_f32 v80, v128, v129
    v_cvt_pk_bf16_f32 v88, v112, v113
    v_cvt_pk_bf16_f32 v81, v130, v131
    v_cvt_pk_bf16_f32 v89, v114, v115
    v_cvt_pk_bf16_f32 v82, v132, v133
    v_cvt_pk_bf16_f32 v90, v116, v117
    v_cvt_pk_bf16_f32 v83, v134, v135
    v_cvt_pk_bf16_f32 v91, v118, v119
    v_cvt_pk_bf16_f32 v84, v136, v137
    v_cvt_pk_bf16_f32 v92, v120, v121
    v_cvt_pk_bf16_f32 v85, v138, v139
    v_cvt_pk_bf16_f32 v93, v122, v123
    v_cvt_pk_bf16_f32 v86, v140, v141
    v_cvt_pk_bf16_f32 v94, v124, v125
    v_cvt_pk_bf16_f32 v87, v142, v143
    v_cvt_pk_bf16_f32 v95, v126, v127
    ds_write_b128 v75, v[80:83]
    ds_write_b128 v75, v[84:87] offset:4096
    ds_write_b128 v75, v[88:91] offset:8192
    ds_write_b128 v75, v[92:95] offset:12288
    s_lshl_b32 s13, s3, 12
    v_add_u32 v20, s13, v63
    s_lshl_b32 s96, s76, 13
    s_add_u32 s13, s96, 32768
    v_add_u32 v21, s13, v63
    v_mov_b32 v36, 0x3f803f80
    v_mov_b32 v37, 0x3f803f80
    v_mov_b32 v38, 0x3f803f80
    v_mov_b32 v39, 0x3f803f80
    s_lshl3_add_u32 s96, s11, s3
    s_lshl_b32 s97, s96, 5
    s_add_u32 s98, s97, s10
    s_lshl_b32 s99, s98, 10
    s_add_u32 s13, s99, 25165824
    s_add_u32 s15, s13, 16384
    s_lshl3_add_u32 s96, s11, s3
    s_lshl_b32 s97, s96, 10
    s_add_u32 s16, s97, 21495808
    s_lshl_b32 s96, s10, 6
    s_add_u32 s14, s96, s16
    s_waitcnt lgkmcnt(0)
    s_barrier
    s_lshl_b32 s96, s76, 6
    s_add_u32 s18, s96, 139264
    v_and_b32 v67, 7, v1
    v_lshl_add_u32 v67, v67, 2, s18
    v_lshrrev_b32 v9, 5, v1
    v_lshl_add_u32 v67, v9, 5, v67
    ds_read_b32 v64, v67
    ds_read_b32 v65, v67 offset:512
    ds_read_b32 v66, v67 offset:640
    ds_read_b32 v68, v67 offset:128
    ds_read_b32 v69, v67 offset:256
    ds_read_b32 v70, v67 offset:384
    ds_read_b32 v71, v67 offset:768
    ds_read_b64_tr_b16 v[128:129], v20
    ds_read_b64_tr_b16 v[130:131], v20 offset:512
    ds_read_b64_tr_b16 v[144:145], v21
    ds_read_b64_tr_b16 v[146:147], v21 offset:512
    ds_read_b64_tr_b16 v[148:149], v21 offset:4096
    ds_read_b64_tr_b16 v[150:151], v21 offset:4608
    ds_read_b64_tr_b16 v[132:133], v20 offset:1024
    ds_read_b64_tr_b16 v[134:135], v20 offset:1536
    ds_read_b64_tr_b16 v[152:153], v21 offset:1024
    ds_read_b64_tr_b16 v[154:155], v21 offset:1536
    ds_read_b64_tr_b16 v[156:157], v21 offset:5120
    ds_read_b64_tr_b16 v[158:159], v21 offset:5632
    ds_read_b64_tr_b16 v[136:137], v20 offset:2048
    ds_read_b64_tr_b16 v[138:139], v20 offset:2560
    ds_read_b64_tr_b16 v[160:161], v21 offset:2048
    ds_read_b64_tr_b16 v[162:163], v21 offset:2560
    ds_read_b64_tr_b16 v[164:165], v21 offset:6144
    ds_read_b64_tr_b16 v[166:167], v21 offset:6656
    s_waitcnt lgkmcnt(12)
    v_mfma_f32_16x16x32_bf16 v[52:55], v[128:131], v[144:147], 0
    v_mfma_f32_16x16x32_bf16 v[56:59], v[128:131], v[148:151], 0
    v_mfma_f32_16x16x32_bf16 v[40:43], v[128:131], v[36:39], 0
    ds_read_b64_tr_b16 v[140:141], v20 offset:3072
    ds_read_b64_tr_b16 v[142:143], v20 offset:3584
    ds_read_b64_tr_b16 v[168:169], v21 offset:3072
    ds_read_b64_tr_b16 v[170:171], v21 offset:3584
    ds_read_b64_tr_b16 v[172:173], v21 offset:7168
    ds_read_b64_tr_b16 v[174:175], v21 offset:7680
    s_waitcnt lgkmcnt(12)
    v_mfma_f32_16x16x32_bf16 v[52:55], v[132:135], v[152:155], v[52:55]
    v_mfma_f32_16x16x32_bf16 v[56:59], v[132:135], v[156:159], v[56:59]
    v_mfma_f32_16x16x32_bf16 v[40:43], v[132:135], v[36:39], v[40:43]
    v_and_b32 v75, 15, v1
    v_lshlrev_b32 v75, 15, v75
    s_and_b32 s96, s10, 1
    s_and_b32 s97, s2, 135
    s_lshl_b32 s98, s97, 12
    s_lshr_b32 s99, s10, 1
    s_lshl_b32 s97, s99, 6
    s_add_u32 s99, s98, s97
    s_lshl2_add_u32 s98, s96, s99
    s_add_u32 s97, s98, 1048576
    s_add_u32 s17, s97, 512
    s_waitcnt lgkmcnt(6)
    v_mfma_f32_16x16x32_bf16 v[52:55], v[136:139], v[160:163], v[52:55]
    v_mfma_f32_16x16x32_bf16 v[56:59], v[136:139], v[164:167], v[56:59]
    v_mfma_f32_16x16x32_bf16 v[40:43], v[136:139], v[36:39], v[40:43]
    s_waitcnt lgkmcnt(0)
    v_mfma_f32_16x16x32_bf16 v[52:55], v[140:143], v[168:171], v[52:55]
    v_mfma_f32_16x16x32_bf16 v[56:59], v[140:143], v[172:175], v[56:59]
    v_mfma_f32_16x16x32_bf16 v[40:43], v[140:143], v[36:39], v[40:43]
    s_cmp_lt_u32 s3, 4
    s_cbranch_scc1 L_NOQX
    ds_read_b128 v[44:47], v76 offset:2048
    ds_read_b128 v[48:51], v76 offset:3072
L_NOQX:
    s_nop 3
    buffer_store_dwordx4 v[52:55], v2, s[32:35], s13 offen sc1
    buffer_store_dwordx4 v[56:59], v2, s[32:35], s15 offen sc1
    s_mov_b32 exec_lo, 0x00010001
    s_mov_b32 exec_hi, 0x00010001
    buffer_store_dwordx4 v[40:43], v1, s[32:35], s14 offen sc1
    s_mov_b64 exec, -1
    s_waitcnt lgkmcnt(0)
    v_mfma_f32_32x32x16_bf16 v[112:127], v[28:31], v[44:47], 0
    v_mfma_f32_32x32x16_bf16 v[112:127], v[32:35], v[48:51], v[112:127]
    v_lshrrev_b32 v22, 3, v1
    v_lshlrev_b32 v22, 10, v22
    v_and_b32 v9, 7, v1
    v_lshl_add_u32 v22, v9, 4, v22
    v_and_b32 v76, 7, v1
    v_lshlrev_b32 v76, 4, v76
    v_lshrrev_b32 v9, 5, v1
    v_lshl_add_u32 v76, v9, 3, v76
    s_nop 3
    v_cvt_pk_bf16_f32 v112, 0, v112
    v_cvt_pk_bf16_f32 v113, 0, v113
    v_cvt_pk_bf16_f32 v114, 0, v114
    v_cvt_pk_bf16_f32 v115, 0, v115
    v_cvt_pk_bf16_f32 v116, 0, v116
    v_cvt_pk_bf16_f32 v117, 0, v117
    v_cvt_pk_bf16_f32 v118, 0, v118
    v_cvt_pk_bf16_f32 v119, 0, v119
    v_cvt_pk_bf16_f32 v120, 0, v120
    v_cvt_pk_bf16_f32 v121, 0, v121
    v_cvt_pk_bf16_f32 v122, 0, v122
    v_cvt_pk_bf16_f32 v123, 0, v123
    v_cvt_pk_bf16_f32 v124, 0, v124
    v_cvt_pk_bf16_f32 v125, 0, v125
    v_cvt_pk_bf16_f32 v126, 0, v126
    v_cvt_pk_bf16_f32 v127, 0, v127
    v_max3_f32 v52, v112, v113, v114
    v_min3_f32 v53, v112, v113, v114
    v_max3_f32 v52, v52, v115, v116
    v_min3_f32 v53, v53, v115, v116
    v_max3_f32 v52, v52, v117, v118
    v_min3_f32 v53, v53, v117, v118
    v_max3_f32 v52, v52, v119, v120
    v_min3_f32 v53, v53, v119, v120
    v_max3_f32 v52, v52, v121, v122
    v_min3_f32 v53, v53, v121, v122
    v_max3_f32 v52, v52, v123, v124
    v_min3_f32 v53, v53, v123, v124
    v_max3_f32 v52, v52, v125, v126
    v_min3_f32 v53, v53, v125, v126
    v_max_f32 v54, v52, v127
    v_min_f32 v55, v53, v127
    v_max_f32 v52, v52, v127
    v_min_f32 v53, v53, v127
    s_nop 0
    v_permlane32_swap_b32 v52, v54
    v_permlane32_swap_b32 v53, v55
    v_max_f32 v52, v52, v54
    v_min_f32 v53, v53, v55
    v_pk_mul_f32 v[52:53], v[52:53], s[6:7] op_sel:[0,1]
    v_pk_fma_f32 v[128:129], v[112:113], s[6:7], v[52:53] op_sel:[0,1,0] op_sel_hi:[1,1,0] neg_lo:[0,0,1] neg_hi:[0,0,1]
    v_pk_fma_f32 v[112:113], v[112:113], s[6:7], v[52:53] op_sel:[0,1,1] neg_lo:[1,0,0] neg_hi:[1,0,0]
    v_pk_fma_f32 v[130:131], v[114:115], s[6:7], v[52:53] op_sel:[0,1,0] op_sel_hi:[1,1,0] neg_lo:[0,0,1] neg_hi:[0,0,1]
    v_pk_fma_f32 v[114:115], v[114:115], s[6:7], v[52:53] op_sel:[0,1,1] neg_lo:[1,0,0] neg_hi:[1,0,0]
    v_pk_fma_f32 v[132:133], v[116:117], s[6:7], v[52:53] op_sel:[0,1,0] op_sel_hi:[1,1,0] neg_lo:[0,0,1] neg_hi:[0,0,1]
    v_pk_fma_f32 v[116:117], v[116:117], s[6:7], v[52:53] op_sel:[0,1,1] neg_lo:[1,0,0] neg_hi:[1,0,0]
    v_pk_fma_f32 v[134:135], v[118:119], s[6:7], v[52:53] op_sel:[0,1,0] op_sel_hi:[1,1,0] neg_lo:[0,0,1] neg_hi:[0,0,1]
    v_pk_fma_f32 v[118:119], v[118:119], s[6:7], v[52:53] op_sel:[0,1,1] neg_lo:[1,0,0] neg_hi:[1,0,0]
    v_pk_fma_f32 v[136:137], v[120:121], s[6:7], v[52:53] op_sel:[0,1,0] op_sel_hi:[1,1,0] neg_lo:[0,0,1] neg_hi:[0,0,1]
    v_pk_fma_f32 v[120:121], v[120:121], s[6:7], v[52:53] op_sel:[0,1,1] neg_lo:[1,0,0] neg_hi:[1,0,0]
    v_pk_fma_f32 v[138:139], v[122:123], s[6:7], v[52:53] op_sel:[0,1,0] op_sel_hi:[1,1,0] neg_lo:[0,0,1] neg_hi:[0,0,1]
    v_pk_fma_f32 v[122:123], v[122:123], s[6:7], v[52:53] op_sel:[0,1,1] neg_lo:[1,0,0] neg_hi:[1,0,0]
    v_pk_fma_f32 v[140:141], v[124:125], s[6:7], v[52:53] op_sel:[0,1,0] op_sel_hi:[1,1,0] neg_lo:[0,0,1] neg_hi:[0,0,1]
    v_pk_fma_f32 v[124:125], v[124:125], s[6:7], v[52:53] op_sel:[0,1,1] neg_lo:[1,0,0] neg_hi:[1,0,0]
    v_pk_fma_f32 v[142:143], v[126:127], s[6:7], v[52:53] op_sel:[0,1,0] op_sel_hi:[1,1,0] neg_lo:[0,0,1] neg_hi:[0,0,1]
    v_pk_fma_f32 v[126:127], v[126:127], s[6:7], v[52:53] op_sel:[0,1,1] neg_lo:[1,0,0] neg_hi:[1,0,0]
    v_exp_f32 v128, v128
    v_exp_f32 v112, v112
    v_exp_f32 v129, v129
    s_lshl_b32 s96, s11, 7
    s_add_u32 s18, s96, 32768
    s_lshl3_add_u32 s14, s10, s18
    v_and_b32 v23, 15, v1
    v_lshlrev_b32 v23, 3, v23
    s_waitcnt vmcnt(0)
    s_barrier
    s_cmp_lg_u32 s3, 0
    s_cbranch_scc1 L_PC
    v_mov_b32 v21, s4
    s_mov_b32 exec_hi, 0
    s_mov_b32 exec_lo, 65535
    buffer_store_dword v21, v75, s[32:35], s17 offen sc1
    s_mov_b64 exec, -1
L_PC:
    buffer_load_dword v67, v3, s[32:35], 0 offen offset:256 sc1
    s_lshl4_add_u32 s96, s11, s10
    s_lshl_b32 s97, s96, 14
    s_lshl_b32 s98, s3, 7
    s_add_u32 s99, s97, s98
    s_add_u32 s13, s99, 25165824
    s_lshl4_add_u32 s96, s11, s10
    s_lshl_b32 s97, s96, 10
    s_lshl_b32 s98, s3, 7
    s_add_u32 s99, s97, s98
    s_add_u32 s15, s99, 29360128
    s_add_u32 s17, s17, 3072
    s_load_dwordx2 s[24:25], s[32:33], s92 offset:512 glc
    s_add_u32 s96, s84, 262144
    s_and_b32 s97, s96, 1048575
    s_lshl_b32 s98, s83, 16
    s_xor_b32 s99, s97, s98
    s_add_u32 s19, s99, s88
    s_add_u32 m0, s89, 49152
    s_nop 0
    buffer_load_dwordx4 v74, s[44:47], s19 offen lds
    v_exp_f32 v113, v113
    v_exp_f32 v130, v130
    v_exp_f32 v114, v114
    v_exp_f32 v131, v131
    v_exp_f32 v115, v115
    v_exp_f32 v132, v132
    v_exp_f32 v116, v116
    v_exp_f32 v133, v133
    v_exp_f32 v117, v117
    v_exp_f32 v134, v134
    s_add_u32 s96, s84, 393216
    s_and_b32 s97, s96, 1048575
    s_lshl_b32 s98, s83, 16
    s_xor_b32 s99, s97, s98
    s_add_u32 s19, s99, s88
    s_add_u32 m0, s89, 57344
    s_nop 0
    buffer_load_dwordx4 v74, s[44:47], s19 offen lds
    v_exp_f32 v118, v118
    v_exp_f32 v135, v135
    v_exp_f32 v119, v119
    v_exp_f32 v136, v136
    v_exp_f32 v120, v120
    v_exp_f32 v137, v137
    v_exp_f32 v121, v121
    v_exp_f32 v138, v138
    v_exp_f32 v122, v122
    s_add_u32 s96, s84, 524288
    s_and_b32 s97, s96, 1048575
    s_lshl_b32 s98, s83, 16
    s_xor_b32 s99, s97, s98
    s_add_u32 s19, s99, s88
    s_add_u32 m0, s89, 65536
    s_nop 0
    buffer_load_dwordx4 v74, s[44:47], s19 offen lds
    v_exp_f32 v139, v139
    v_exp_f32 v123, v123
    v_exp_f32 v140, v140
    v_exp_f32 v124, v124
    v_exp_f32 v141, v141
    v_exp_f32 v125, v125
    v_exp_f32 v142, v142
    v_exp_f32 v126, v126
    v_exp_f32 v143, v143
    v_exp_f32 v127, v127
    s_add_u32 s96, s84, 655360
    s_and_b32 s97, s96, 1048575
    s_lshl_b32 s98, s83, 16
    s_xor_b32 s99, s97, s98
    s_add_u32 s19, s99, s88
    s_add_u32 m0, s89, 73728
    s_nop 0
    buffer_load_dwordx4 v74, s[44:47], s19 offen lds
    v_pk_add_f32 v[56:57], v[128:129], v[130:131]
    v_pk_add_f32 v[58:59], v[112:113], v[114:115]
    v_pk_add_f32 v[56:57], v[56:57], v[132:133]
    v_pk_add_f32 v[58:59], v[58:59], v[116:117]
    v_pk_add_f32 v[56:57], v[56:57], v[134:135]
    v_pk_add_f32 v[58:59], v[58:59], v[118:119]
    v_pk_add_f32 v[56:57], v[56:57], v[136:137]
    v_pk_add_f32 v[58:59], v[58:59], v[120:121]
    v_pk_add_f32 v[56:57], v[56:57], v[138:139]
    s_add_u32 s96, s84, 786432
    s_and_b32 s97, s96, 1048575
    s_lshl_b32 s98, s83, 16
    s_xor_b32 s99, s97, s98
    s_add_u32 s19, s99, s88
    s_add_u32 m0, s89, 81920
    s_nop 0
    buffer_load_dwordx4 v74, s[44:47], s19 offen lds
    v_pk_add_f32 v[58:59], v[58:59], v[122:123]
    v_pk_add_f32 v[56:57], v[56:57], v[140:141]
    v_pk_add_f32 v[58:59], v[58:59], v[124:125]
    v_pk_add_f32 v[56:57], v[56:57], v[142:143]
    v_pk_add_f32 v[58:59], v[58:59], v[126:127]
    v_add_f32 v54, v56, v57
    v_add_f32 v55, v58, v59
    v_add_f32 v52, v56, v57
    v_add_f32 v53, v58, v59
    s_nop 0
    v_permlane32_swap_b32 v52, v54
    s_add_u32 s96, s84, 917504
    s_and_b32 s97, s96, 1048575
    s_lshl_b32 s98, s83, 16
    s_xor_b32 s99, s97, s98
    s_add_u32 s19, s99, s88
    s_add_u32 m0, s89, 90112
    s_nop 0
    buffer_load_dwordx4 v74, s[44:47], s19 offen lds
    v_permlane32_swap_b32 v53, v55
    v_pk_add_f32 v[52:53], v[52:53], v[54:55]
    v_rcp_f32 v52, v52
    v_rcp_f32 v53, v53
    s_nop 0
    v_pk_mul_f32 v[128:129], v[128:129], v[52:53] op_sel_hi:[1,0]
    v_pk_mul_f32 v[112:113], v[112:113], v[52:53] op_sel:[0,1]
    v_pk_mul_f32 v[130:131], v[130:131], v[52:53] op_sel_hi:[1,0]
    v_pk_mul_f32 v[114:115], v[114:115], v[52:53] op_sel:[0,1]
    v_pk_mul_f32 v[132:133], v[132:133], v[52:53] op_sel_hi:[1,0]
    s_branch SCHK_18
SPOLL_17:
    s_load_dwordx2 s[24:25], s[32:33], s92 offset:512 glc
SCHK_18:
    s_add_u32 s5, s5, 1
    s_cmp_ge_u32 s5, 300000
    s_waitcnt lgkmcnt(0)
    s_cbranch_scc1 SDONE_19
    s_cmp_lg_u32 s24, s4
    s_cbranch_scc1 SPOLL_17
    s_cmp_lg_u32 s25, s4
    s_cbranch_scc1 SPOLL_17
SDONE_19:
    s_barrier
    s_add_u32 s18, s13, 8192
    buffer_load_dwordx4 v[144:147], v22, s[32:35], s13 offen sc1
    buffer_load_dwordx4 v[148:151], v22, s[32:35], s18 offen sc1
    buffer_load_dwordx4 v[160:163], v2, s[32:35], s16 offen sc1
    s_lshl_b32 s96, s3, 5
    s_add_u32 s14, s96, 8192
    v_and_b32 v6, 3, v1
    v_lshl_add_u32 v6, v6, 3, s14
    v_lshrrev_b32 v9, 5, v1
    v_lshl_add_u32 v6, v9, 2, v6
    s_lshl_b32 s14, s3, 10
    v_and_b32 v5, 15, v1
    v_lshl_add_u32 v5, v5, 4, s14
    v_lshrrev_b32 v9, 5, v1
    v_lshl_add_u32 v5, v9, 9, v5
    v_bfe_u32 v9, v1, 4, 1
    v_lshl_add_u32 v5, v9, 3, v5
    s_lshl_b32 s96, s76, 7
    s_add_u32 s14, s96, 8192
    v_lshrrev_b32 v7, 5, v1
    v_lshl_add_u32 v7, v7, 4, s14
    s_lshl_b32 s14, s76, 12
    v_add_u32 v20, s14, v2
    v_pk_mul_f32 v[116:117], v[116:117], v[52:53] op_sel:[0,1]
    v_pk_mul_f32 v[134:135], v[134:135], v[52:53] op_sel_hi:[1,0]
    v_pk_mul_f32 v[118:119], v[118:119], v[52:53] op_sel:[0,1]
    v_pk_mul_f32 v[136:137], v[136:137], v[52:53] op_sel_hi:[1,0]
    v_pk_mul_f32 v[120:121], v[120:121], v[52:53] op_sel:[0,1]
    v_pk_mul_f32 v[138:139], v[138:139], v[52:53] op_sel_hi:[1,0]
    v_pk_mul_f32 v[122:123], v[122:123], v[52:53] op_sel:[0,1]
    v_pk_mul_f32 v[140:141], v[140:141], v[52:53] op_sel_hi:[1,0]
    v_pk_mul_f32 v[124:125], v[124:125], v[52:53] op_sel:[0,1]
    v_pk_mul_f32 v[142:143], v[142:143], v[52:53] op_sel_hi:[1,0]
    v_pk_mul_f32 v[126:127], v[126:127], v[52:53] op_sel:[0,1]
    v_cvt_pk_bf16_f32 v80, v128, v129
    v_cvt_pk_bf16_f32 v88, v112, v113
    v_cvt_pk_bf16_f32 v81, v130, v131
    v_cvt_pk_bf16_f32 v89, v114, v115
    v_cvt_pk_bf16_f32 v82, v132, v133
    v_cvt_pk_bf16_f32 v90, v116, v117
    v_cvt_pk_bf16_f32 v83, v134, v135
    v_cvt_pk_bf16_f32 v91, v118, v119
    v_cvt_pk_bf16_f32 v84, v136, v137
    v_cvt_pk_bf16_f32 v92, v120, v121
    v_cvt_pk_bf16_f32 v85, v138, v139
    v_cvt_pk_bf16_f32 v93, v122, v123
    v_cvt_pk_bf16_f32 v86, v140, v141
    v_cvt_pk_bf16_f32 v94, v124, v125
    v_cvt_pk_bf16_f32 v87, v142, v143
    v_cvt_pk_bf16_f32 v95, v126, v127
    s_waitcnt vmcnt(1)
    v_cmp_eq_u32 vcc, s4, v67
    s_nop 0
    s_cmp_eq_u32 vcc_lo, 0
    s_cselect_b32 s93, 1, 0
    v_pk_add_f32 v[144:145], v[144:145], v[148:149]
    v_pk_add_f32 v[146:147], v[146:147], v[150:151]
    s_nop 1
    v_permlane32_swap_b32 v144, v146
    v_permlane32_swap_b32 v145, v147
    v_pk_add_f32 v[144:145], v[144:145], v[146:147]
    s_nop 1
    v_add_f32_dpp v144, v144, v144 row_ror:8 row_mask:0xf bank_mask:0xf
    v_add_f32_dpp v145, v145, v145 row_ror:8 row_mask:0xf bank_mask:0xf
    v_mov_b32 v146, v144
    v_mov_b32 v147, v145
    s_nop 0
    v_permlane16_swap_b32 v144, v146
    v_permlane16_swap_b32 v145, v147
    v_pk_add_f32 v[144:145], v[144:145], v[146:147]
    v_cvt_pk_bf16_f32 v144, v144, v145
    v_mov_b32 v145, s4
    s_mov_b32 exec_lo, 0xff
    s_mov_b32 exec_hi, 0xff
    s_cmp_lg_u32 s93, 0
    s_cbranch_scc1 LOC_20
    buffer_store_dwordx2 v[144:145], v76, s[32:35], s15 offen sc1
    s_branch LOCD_21
LOC_20:
    buffer_store_dwordx2 v[144:145], v76, s[32:35], s15 offen
LOCD_21:
    s_mov_b64 exec, -1
    v_mov_b32 v224, v144
    v_mov_b32 v225, v145
    v_add_u32 v226, s15, v76
    s_cbranch_scc1 L_PC2
    s_barrier
    s_cmp_lg_u32 s3, 0
    s_cbranch_scc1 L_PC2
    v_mov_b32 v21, s4
    s_mov_b32 exec_hi, 0
    s_mov_b32 exec_lo, 65535
    buffer_store_dword v21, v75, s[32:35], s17 offen sc1
    s_mov_b64 exec, -1
L_PC2:
    s_lshl3_add_u32 s96, s11, s3
    s_lshl_b32 s97, s96, 11
    s_add_u32 s13, s97, 29360128
    s_waitcnt vmcnt(0)
    v_permlane32_swap_b32 v160, v162
    v_permlane32_swap_b32 v161, v163
    v_pk_add_f32 v[160:161], v[160:161], v[162:163]
    s_nop 1
    v_add_f32_dpp v160, v160, v160 row_ror:4 row_mask:0xf bank_mask:0xf
    v_add_f32_dpp v161, v161, v161 row_ror:4 row_mask:0xf bank_mask:0xf
    s_nop 0
    v_add_f32_dpp v160, v160, v160 row_ror:8 row_mask:0xf bank_mask:0xf
    v_add_f32_dpp v161, v161, v161 row_ror:8 row_mask:0xf bank_mask:0xf
    v_mov_b32 v162, v160
    v_mov_b32 v163, v161
    s_nop 0
    v_permlane16_swap_b32 v160, v162
    v_permlane16_swap_b32 v161, v163
    v_pk_add_f32 v[160:161], v[160:161], v[162:163]
    v_cvt_pk_bf16_f32 v160, v160, v161
    ds_write_b32 v6, v160
    s_cmp_lg_u32 s93, 0
    s_cbranch_scc1 L_C2L
SPOLL_22:
    s_load_dwordx2 s[24:25], s[32:33], s92 offset:3584 glc
SCHK_23:
    s_add_u32 s5, s5, 1
    s_cmp_ge_u32 s5, 300000
    s_waitcnt lgkmcnt(0)
    s_cbranch_scc1 SDONE_24
    s_cmp_lg_u32 s24, s4
    s_cbranch_scc1 SPOLL_22
    s_cmp_lg_u32 s25, s4
    s_cbranch_scc1 SPOLL_22
SDONE_24:
L_C2L:
    buffer_load_dwordx4 v[152:155], v2, s[32:35], s13 offen sc1
    buffer_load_dwordx4 v[156:159], v2, s[32:35], s13 offen offset:1024 sc1
    s_waitcnt vmcnt(0)
    v_bitop3_b32 v4, v153, v155, s4 bitop3:0x7e
    v_bitop3_b32 v4, v4, v157, s4 bitop3:0xf6
    v_bitop3_b32 v4, v4, v159, s4 bitop3:0xf6
    v_cmp_ne_u32 vcc, 0, v4
    s_cbranch_vccz TOK_26
POLL_27:
    buffer_load_dwordx4 v[152:155], v2, s[32:35], s13 offen sc1
    buffer_load_dwordx4 v[156:159], v2, s[32:35], s13 offen offset:1024 sc1
    s_waitcnt vmcnt(0)
    v_bitop3_b32 v4, v153, v155, s4 bitop3:0x7e
    v_bitop3_b32 v4, v4, v157, s4 bitop3:0xf6
    v_bitop3_b32 v4, v4, v159, s4 bitop3:0xf6
    v_cmp_ne_u32 vcc, 0, v4
    s_cbranch_vccz PDONE_28
    s_add_u32 s5, s5, 1
    s_cmp_lt_u32 s5, 300000
    s_cbranch_scc1 POLL_27
PDONE_28:
TOK_26:
    ds_write2_b32 v5, v152, v154 offset0:0 offset1:1
    ds_write2_b32 v5, v156, v158 offset0:64 offset1:65
    s_waitcnt lgkmcnt(0)
    s_barrier
    ds_read_b128 v[160:163], v7
    ds_read_b128 v[164:167], v7 offset:32
    ds_read_b128 v[168:171], v7 offset:64
    ds_read_b128 v[172:175], v7 offset:96
    ds_read_b128 v[144:147], v20
    ds_read_b128 v[148:151], v20 offset:1024
    ds_read_b128 v[152:155], v20 offset:2048
    ds_read_b128 v[156:159], v20 offset:3072
    s_add_u32 s96, s84, 1048576
    s_and_b32 s97, s96, 1048575
    s_lshl_b32 s98, s83, 16
    s_xor_b32 s99, s97, s98
    s_xor_b32 s96, s88, 1048576
    s_add_u32 s19, s99, s96
    s_add_u32 m0, s89, 98304
    s_nop 0
    buffer_load_dwordx4 v74, s[44:47], s19 offen lds
    s_add_u32 s96, s84, 1703936
    s_and_b32 s97, s96, 1048575
    s_lshl_b32 s98, s83, 16
    s_xor_b32 s99, s97, s98
    s_xor_b32 s96, s88, 1048576
    s_add_u32 s19, s99, s96
    s_add_u32 m0, s89, 139264
    s_nop 0
    buffer_load_dwordx4 v74, s[44:47], s19 offen lds
    s_add_u32 s96, s84, 1835008
    s_and_b32 s97, s96, 1048575
    s_lshl_b32 s98, s83, 16
    s_xor_b32 s99, s97, s98
    s_xor_b32 s96, s88, 1048576
    s_add_u32 s19, s99, s96
    s_add_u32 m0, s89, 147456
    s_nop 0
    buffer_load_dwordx4 v74, s[44:47], s19 offen lds
    s_and_b32 s96, s3, 3
    s_lshl2_add_u32 s97, s10, s96
    s_lshl4_add_u32 s98, s97, s11
    s_lshl1_add_u32 s99, s98, s76
    s_lshl_b32 s96, s99, 11
    s_add_u32 s13, s96, 8388608
    v_and_b32 v8, 15, v1
    v_lshlrev_b32 v8, 4, v8
    v_bfe_u32 v9, v1, 4, 1
    v_lshl_add_u32 v8, v9, 10, v8
    v_lshrrev_b32 v9, 5, v1
    v_lshl_add_u32 v8, v9, 8, v8
    s_waitcnt lgkmcnt(7)
    v_mfma_f32_32x32x16_bf16 v[128:143], v[160:163], v[80:83], 0
    s_waitcnt lgkmcnt(6)
    v_mfma_f32_32x32x16_bf16 v[128:143], v[164:167], v[84:87], v[128:143]
    s_waitcnt lgkmcnt(5)
    v_mfma_f32_32x32x16_bf16 v[128:143], v[168:171], v[88:91], v[128:143]
    s_waitcnt lgkmcnt(4)
    v_mfma_f32_32x32x16_bf16 v[128:143], v[172:175], v[92:95], v[128:143]
    s_waitcnt lgkmcnt(3)
    v_mfma_f32_32x32x16_bf16 v[112:127], v[144:147], v[80:83], 0
    s_waitcnt lgkmcnt(2)
    v_mfma_f32_32x32x16_bf16 v[112:127], v[148:151], v[84:87], v[112:127]
    s_waitcnt lgkmcnt(1)
    v_mfma_f32_32x32x16_bf16 v[112:127], v[152:155], v[88:91], v[112:127]
    s_waitcnt lgkmcnt(0)
    v_mfma_f32_32x32x16_bf16 v[112:127], v[156:159], v[92:95], v[112:127]
    s_nop 3
    v_cvt_pk_bf16_f32 v128, 0, v128
    v_add_f32 v128, 0x358637bd, v128
    v_cvt_pk_bf16_f32 v128, 0, v128
    v_rcp_f32 v128, v128
    s_nop 3
    v_cvt_pk_bf16_f32 v112, 0, v112
    v_cvt_pk_bf16_f32 v113, 0, v113
    v_cvt_pk_bf16_f32 v114, 0, v114
    v_cvt_pk_bf16_f32 v115, 0, v115
    v_cvt_pk_bf16_f32 v116, 0, v116
    v_cvt_pk_bf16_f32 v117, 0, v117
    v_cvt_pk_bf16_f32 v118, 0, v118
    v_cvt_pk_bf16_f32 v119, 0, v119
    v_pk_mul_f32 v[112:113], v[112:113], v[128:129] op_sel_hi:[1,0]
    v_pk_mul_f32 v[114:115], v[114:115], v[128:129] op_sel_hi:[1,0]
    v_pk_mul_f32 v[116:117], v[116:117], v[128:129] op_sel_hi:[1,0]
    v_pk_mul_f32 v[118:119], v[118:119], v[128:129] op_sel_hi:[1,0]
    v_cvt_pk_bf16_f32 v44, v112, v113
    v_cvt_pk_bf16_f32 v45, v114, v115
    v_cvt_pk_bf16_f32 v46, v116, v117
    v_cvt_pk_bf16_f32 v47, v118, v119
    buffer_store_dwordx4 v[44:47], v8, s[32:35], s13 offen sc1
    v_cvt_pk_bf16_f32 v120, 0, v120
    v_cvt_pk_bf16_f32 v121, 0, v121
    v_cvt_pk_bf16_f32 v122, 0, v122
    v_cvt_pk_bf16_f32 v123, 0, v123
    v_cvt_pk_bf16_f32 v124, 0, v124
    v_cvt_pk_bf16_f32 v125, 0, v125
    v_cvt_pk_bf16_f32 v126, 0, v126
    v_cvt_pk_bf16_f32 v127, 0, v127
    v_pk_mul_f32 v[120:121], v[120:121], v[128:129] op_sel_hi:[1,0]
    v_pk_mul_f32 v[122:123], v[122:123], v[128:129] op_sel_hi:[1,0]
    v_pk_mul_f32 v[124:125], v[124:125], v[128:129] op_sel_hi:[1,0]
    v_pk_mul_f32 v[126:127], v[126:127], v[128:129] op_sel_hi:[1,0]
    v_cvt_pk_bf16_f32 v48, v120, v121
    v_cvt_pk_bf16_f32 v49, v122, v123
    v_cvt_pk_bf16_f32 v50, v124, v125
    v_cvt_pk_bf16_f32 v51, v126, v127
    buffer_store_dwordx4 v[48:51], v8, s[32:35], s13 offen offset:512 sc1
    s_mul_i32 s96, s76, 65600
    s_add_u32 s17, s96, 32768
    v_lshrrev_b32 v20, 5, v1
    v_lshlrev_b32 v20, 11, v20
    v_bfe_u32 v9, v1, 4, 1
    v_lshl_add_u32 v20, v9, 9, v20
    v_bfe_u32 v9, v1, 2, 2
    v_lshl_add_u32 v20, v9, 7, v20
    v_bfe_u32 v9, v1, 3, 1
    v_lshl_add_u32 v20, v9, 6, v20
    v_bfe_u32 v9, v1, 1, 1
    v_lshl_add_u32 v20, v9, 5, v20
    v_bfe_u32 v9, v1, 4, 1
    v_lshl_add_u32 v20, v9, 4, v20
    v_and_b32 v9, 1, v1
    v_lshl_add_u32 v20, v9, 3, v20
    v_xor_b32 v20, s17, v20
    v_xor_b32 v21, 16, v20
    v_xor_b32 v22, 64, v20
    v_xor_b32 v23, 80, v20
    v_and_b32 v5, 7, v1
    v_lshlrev_b32 v5, 15, v5
    v_bfe_u32 v9, v1, 3, 1
    v_lshl_add_u32 v5, v9, 12, v5
    s_bfe_u32 s96, s11, 65538
    s_lshr_b32 s97, s10, 2
    s_and_b32 s98, s10, 3
    s_lshl_b32 s99, s98, 6
    s_lshl1_add_u32 s98, s97, s99
    s_lshl_b32 s97, s98, 12
    s_lshr_b32 s99, s11, 3
    s_and_b32 s98, s11, 3
    s_lshl2_add_u32 s99, s99, s98
    s_lshl_b32 s98, s99, 6
    s_add_u32 s99, s97, s98
    s_lshl2_add_u32 s97, s96, s99
    s_add_u32 s98, s97, 1048576
    s_add_u32 s15, s98, 1024
    v_mov_b32 v52, 0x10000
    v_mov_b32 v53, s6
    v_lshlrev_b32 v28, 16, v12
    v_and_b32 v29, s6, v12
    v_lshlrev_b32 v30, 16, v13
    v_and_b32 v31, s6, v13
    v_lshlrev_b32 v32, 16, v14
    v_and_b32 v33, s6, v14
    v_lshlrev_b32 v34, 16, v15
    v_and_b32 v35, s6, v15
    v_lshlrev_b32 v36, 16, v16
    v_and_b32 v37, s6, v16
    v_lshlrev_b32 v38, 16, v17
    v_and_b32 v39, s6, v17
    v_lshlrev_b32 v40, 16, v18
    v_and_b32 v41, s6, v18
    v_lshlrev_b32 v42, 16, v19
    v_and_b32 v43, s6, v19
    v_mul_u32_u24_dpp v76, v64, v52 row_newbcast:0 row_mask:0xf bank_mask:0xf
    v_and_b32_dpp v77, v64, v53 row_newbcast:0 row_mask:0xf bank_mask:0xf
    v_mul_u32_u24_dpp v78, v64, v52 row_newbcast:1 row_mask:0xf bank_mask:0xf
    v_and_b32_dpp v79, v64, v53 row_newbcast:1 row_mask:0xf bank_mask:0xf
    v_mul_u32_u24_dpp v80, v64, v52 row_newbcast:2 row_mask:0xf bank_mask:0xf
    v_and_b32_dpp v81, v64, v53 row_newbcast:2 row_mask:0xf bank_mask:0xf
    v_mul_u32_u24_dpp v82, v64, v52 row_newbcast:3 row_mask:0xf bank_mask:0xf
    v_and_b32_dpp v83, v64, v53 row_newbcast:3 row_mask:0xf bank_mask:0xf
    v_mul_u32_u24_dpp v84, v64, v52 row_newbcast:4 row_mask:0xf bank_mask:0xf
    v_and_b32_dpp v85, v64, v53 row_newbcast:4 row_mask:0xf bank_mask:0xf
    v_mul_u32_u24_dpp v86, v64, v52 row_newbcast:5 row_mask:0xf bank_mask:0xf
    v_and_b32_dpp v87, v64, v53 row_newbcast:5 row_mask:0xf bank_mask:0xf
    v_mul_u32_u24_dpp v88, v64, v52 row_newbcast:6 row_mask:0xf bank_mask:0xf
    v_and_b32_dpp v89, v64, v53 row_newbcast:6 row_mask:0xf bank_mask:0xf
    v_mul_u32_u24_dpp v90, v64, v52 row_newbcast:7 row_mask:0xf bank_mask:0xf
    v_and_b32_dpp v91, v64, v53 row_newbcast:7 row_mask:0xf bank_mask:0xf
    s_lshl1_add_u32 s96, s94, s77
    s_lshl_b32 s97, s96, 15
    s_add_u32 s19, s97, 8388608
    v_and_b32 v25, 15, v1
    v_lshlrev_b32 v25, 3, v25
    s_waitcnt vmcnt(0)
    s_waitcnt lgkmcnt(0)
    s_barrier
    s_cmp_lg_u32 s3, 0
    s_cbranch_scc1 L_PD
    v_mov_b32 v6, s4
    s_mov_b32 exec_hi, 0
    s_mov_b32 exec_lo, 65535
    buffer_store_dword v6, v5, s[32:35], s15 offen sc1
    s_mov_b64 exec, -1
L_PD:
    s_add_u32 s96, s84, 1966080
    s_and_b32 s97, s96, 1048575
    s_lshl_b32 s98, s83, 16
    s_xor_b32 s99, s97, s98
    s_xor_b32 s96, s88, 1048576
    s_add_u32 s13, s99, s96
    s_add_u32 m0, s89, 155648
    s_nop 0
    buffer_load_dwordx4 v74, s[44:47], s13 offen lds
    s_and_b32 s96, s84, 1048575
    s_lshl_b32 s97, s83, 16
    s_xor_b32 s98, s96, s97
    s_add_u32 s13, s98, s88
    s_add_u32 m0, s89, 32768
    s_nop 0
    buffer_load_dwordx4 v74, s[44:47], s13 offen lds
    s_add_u32 s96, s84, 131072
    s_and_b32 s97, s96, 1048575
    s_lshl_b32 s98, s83, 16
    s_xor_b32 s99, s97, s98
    s_add_u32 s13, s99, s88
    s_add_u32 m0, s89, 40960
    s_nop 0
    buffer_load_dwordx4 v74, s[44:47], s13 offen lds
    s_load_dwordx2 s[24:25], s[32:33], s92 offset:1024 glc
    v_mov_b32_dpp v112, v65 row_newbcast:0 row_mask:0xf bank_mask:0xf
    v_mov_b32_dpp v113, v65 row_newbcast:1 row_mask:0xf bank_mask:0xf
    v_mov_b32_dpp v114, v65 row_newbcast:2 row_mask:0xf bank_mask:0xf
    v_mov_b32_dpp v115, v65 row_newbcast:3 row_mask:0xf bank_mask:0xf
    v_mov_b32_dpp v116, v65 row_newbcast:4 row_mask:0xf bank_mask:0xf
    v_mov_b32_dpp v117, v65 row_newbcast:5 row_mask:0xf bank_mask:0xf
    v_mov_b32_dpp v118, v65 row_newbcast:6 row_mask:0xf bank_mask:0xf
    v_mov_b32_dpp v119, v65 row_newbcast:7 row_mask:0xf bank_mask:0xf
    v_mov_b32_dpp v120, v66 row_newbcast:0 row_mask:0xf bank_mask:0xf
    v_mov_b32_dpp v121, v66 row_newbcast:1 row_mask:0xf bank_mask:0xf
    v_mov_b32_dpp v122, v66 row_newbcast:2 row_mask:0xf bank_mask:0xf
    v_mov_b32_dpp v123, v66 row_newbcast:3 row_mask:0xf bank_mask:0xf
    v_mov_b32_dpp v124, v66 row_newbcast:4 row_mask:0xf bank_mask:0xf
    v_mov_b32_dpp v125, v66 row_newbcast:5 row_mask:0xf bank_mask:0xf
    v_mov_b32_dpp v126, v66 row_newbcast:6 row_mask:0xf bank_mask:0xf
    v_mov_b32_dpp v127, v66 row_newbcast:7 row_mask:0xf bank_mask:0xf
    s_waitcnt vmcnt(0)
    s_branch SCHK_30
SPOLL_29:
    s_load_dwordx2 s[24:25], s[32:33], s92 offset:1024 glc
SCHK_30:
    s_add_u32 s5, s5, 1
    s_cmp_ge_u32 s5, 300000
    s_waitcnt lgkmcnt(0)
    s_cbranch_scc1 SDONE_31
    s_cmp_lg_u32 s24, s4
    s_cbranch_scc1 SPOLL_29
SDONE_31:
    s_barrier
    s_cmp_lt_u32 s3, 4
    s_cbranch_scc1 L_P2
    s_setprio 1
L_P2:
    s_lshl_b32 s96, s21, 7
    s_add_u32 s18, s96, 65536
    s_lshl_b32 s96, s83, 11
    s_add_u32 s20, s96, s19
    buffer_load_dwordx4 v[160:163], v2, s[32:35], s20 offen sc1
    buffer_load_dwordx4 v[164:167], v2, s[32:35], s20 offen offset:1024 sc1
    ds_read_b64_tr_b16 v[228:229], v22
    ds_read_b64_tr_b16 v[230:231], v22 offset:1024
    ds_read_b64_tr_b16 v[232:233], v23
    ds_read_b64_tr_b16 v[234:235], v23 offset:1024
    ds_read_b64_tr_b16 v[236:237], v20
    ds_read_b64_tr_b16 v[238:239], v20 offset:1024
    ds_read_b64_tr_b16 v[240:241], v21
    ds_read_b64_tr_b16 v[242:243], v21 offset:1024
    s_xor_b32 s96, s83, 1
    s_lshl_b32 s97, s96, 11
    s_add_u32 s20, s97, s19
    buffer_load_dwordx4 v[168:171], v2, s[32:35], s20 offen sc1
    buffer_load_dwordx4 v[172:175], v2, s[32:35], s20 offen offset:1024 sc1
    s_waitcnt lgkmcnt(6)
    s_waitcnt vmcnt(3)
    v_mfma_f32_16x16x32_bf16 v[144:147], v[228:231], v[160:163], 0
    ds_read_b64_tr_b16 v[244:245], v22 offset:4096
    s_waitcnt vmcnt(2)
    v_mfma_f32_16x16x32_bf16 v[148:151], v[228:231], v[164:167], 0
    ds_read_b64_tr_b16 v[246:247], v22 offset:5120
    s_waitcnt lgkmcnt(6)
    v_mfma_f32_16x16x32_bf16 v[152:155], v[232:235], v[160:163], 0
    ds_read_b64_tr_b16 v[228:229], v23 offset:4096
    v_mfma_f32_16x16x32_bf16 v[156:159], v[232:235], v[164:167], 0
    ds_read_b64_tr_b16 v[230:231], v23 offset:5120
    s_waitcnt lgkmcnt(6)
    v_mfma_f32_16x16x32_bf16 v[128:131], v[236:239], v[160:163], 0
    ds_read_b64_tr_b16 v[232:233], v20 offset:4096
    v_mfma_f32_16x16x32_bf16 v[132:135], v[236:239], v[164:167], 0
    ds_read_b64_tr_b16 v[234:235], v20 offset:5120
    s_waitcnt lgkmcnt(6)
    v_mfma_f32_16x16x32_bf16 v[136:139], v[240:243], v[160:163], 0
    ds_read_b64_tr_b16 v[236:237], v21 offset:4096
    v_mfma_f32_16x16x32_bf16 v[140:143], v[240:243], v[164:167], 0
    ds_read_b64_tr_b16 v[238:239], v21 offset:5120
    s_xor_b32 s96, s83, 2
    s_lshl_b32 s97, s96, 11
    s_add_u32 s20, s97, s19
    buffer_load_dwordx4 v[160:163], v2, s[32:35], s20 offen sc1
    buffer_load_dwordx4 v[164:167], v2, s[32:35], s20 offen offset:1024 sc1
    s_waitcnt lgkmcnt(6)
    s_waitcnt vmcnt(3)
    v_mfma_f32_16x16x32_bf16 v[144:147], v[244:247], v[168:171], v[144:147]
    ds_read_b64_tr_b16 v[240:241], v22 offset:8192
    s_waitcnt vmcnt(2)
    v_mfma_f32_16x16x32_bf16 v[148:151], v[244:247], v[172:175], v[148:151]
    ds_read_b64_tr_b16 v[242:243], v22 offset:9216
    s_waitcnt lgkmcnt(6)
    v_mfma_f32_16x16x32_bf16 v[152:155], v[228:231], v[168:171], v[152:155]
    ds_read_b64_tr_b16 v[244:245], v23 offset:8192
    v_mfma_f32_16x16x32_bf16 v[156:159], v[228:231], v[172:175], v[156:159]
    ds_read_b64_tr_b16 v[246:247], v23 offset:9216
    s_waitcnt lgkmcnt(6)
    v_mfma_f32_16x16x32_bf16 v[128:131], v[232:235], v[168:171], v[128:131]
    ds_read_b64_tr_b16 v[228:229], v20 offset:8192
    v_mfma_f32_16x16x32_bf16 v[132:135], v[232:235], v[172:175], v[132:135]
    ds_read_b64_tr_b16 v[230:231], v20 offset:9216
    s_waitcnt lgkmcnt(6)
    v_mfma_f32_16x16x32_bf16 v[136:139], v[236:239], v[168:171], v[136:139]
    ds_read_b64_tr_b16 v[232:233], v21 offset:8192
    v_mfma_f32_16x16x32_bf16 v[140:143], v[236:239], v[172:175], v[140:143]
    ds_read_b64_tr_b16 v[234:235], v21 offset:9216
    s_xor_b32 s96, s83, 3
    s_lshl_b32 s97, s96, 11
    s_add_u32 s20, s97, s19
    buffer_load_dwordx4 v[168:171], v2, s[32:35], s20 offen sc1
    buffer_load_dwordx4 v[172:175], v2, s[32:35], s20 offen offset:1024 sc1
    s_waitcnt lgkmcnt(6)
    s_waitcnt vmcnt(3)
    v_mfma_f32_16x16x32_bf16 v[144:147], v[240:243], v[160:163], v[144:147]
    ds_read_b64_tr_b16 v[236:237], v22 offset:12288
    s_waitcnt vmcnt(2)
    v_mfma_f32_16x16x32_bf16 v[148:151], v[240:243], v[164:167], v[148:151]
    ds_read_b64_tr_b16 v[238:239], v22 offset:13312
    s_waitcnt lgkmcnt(6)
    v_mfma_f32_16x16x32_bf16 v[152:155], v[244:247], v[160:163], v[152:155]
    ds_read_b64_tr_b16 v[240:241], v23 offset:12288
    v_mfma_f32_16x16x32_bf16 v[156:159], v[244:247], v[164:167], v[156:159]
    ds_read_b64_tr_b16 v[242:243], v23 offset:13312
    s_waitcnt lgkmcnt(6)
    v_mfma_f32_16x16x32_bf16 v[128:131], v[228:231], v[160:163], v[128:131]
    ds_read_b64_tr_b16 v[244:245], v20 offset:12288
    v_mfma_f32_16x16x32_bf16 v[132:135], v[228:231], v[164:167], v[132:135]
    ds_read_b64_tr_b16 v[246:247], v20 offset:13312
    s_waitcnt lgkmcnt(6)
    v_mfma_f32_16x16x32_bf16 v[136:139], v[232:235], v[160:163], v[136:139]
    ds_read_b64_tr_b16 v[228:229], v21 offset:12288
    v_mfma_f32_16x16x32_bf16 v[140:143], v[232:235], v[164:167], v[140:143]
    ds_read_b64_tr_b16 v[230:231], v21 offset:13312
    s_xor_b32 s96, s83, 4
    s_lshl_b32 s97, s96, 11
    s_add_u32 s20, s97, s19
    buffer_load_dwordx4 v[160:163], v2, s[32:35], s20 offen sc1
    buffer_load_dwordx4 v[164:167], v2, s[32:35], s20 offen offset:1024 sc1
    s_waitcnt lgkmcnt(6)
    s_waitcnt vmcnt(3)
    v_mfma_f32_16x16x32_bf16 v[144:147], v[236:239], v[168:171], v[144:147]
    ds_read_b64_tr_b16 v[232:233], v22 offset:16384
    s_waitcnt vmcnt(2)
    v_mfma_f32_16x16x32_bf16 v[148:151], v[236:239], v[172:175], v[148:151]
    ds_read_b64_tr_b16 v[234:235], v22 offset:17408
    s_waitcnt lgkmcnt(6)
    v_mfma_f32_16x16x32_bf16 v[152:155], v[240:243], v[168:171], v[152:155]
    ds_read_b64_tr_b16 v[236:237], v23 offset:16384
    v_mfma_f32_16x16x32_bf16 v[156:159], v[240:243], v[172:175], v[156:159]
    ds_read_b64_tr_b16 v[238:239], v23 offset:17408
    s_waitcnt lgkmcnt(6)
    v_mfma_f32_16x16x32_bf16 v[128:131], v[244:247], v[168:171], v[128:131]
    ds_read_b64_tr_b16 v[240:241], v20 offset:16384
    v_mfma_f32_16x16x32_bf16 v[132:135], v[244:247], v[172:175], v[132:135]
    ds_read_b64_tr_b16 v[242:243], v20 offset:17408
    s_waitcnt lgkmcnt(6)
    v_mfma_f32_16x16x32_bf16 v[136:139], v[228:231], v[168:171], v[136:139]
    ds_read_b64_tr_b16 v[244:245], v21 offset:16384
    v_mfma_f32_16x16x32_bf16 v[140:143], v[228:231], v[172:175], v[140:143]
    ds_read_b64_tr_b16 v[246:247], v21 offset:17408
    s_xor_b32 s96, s83, 5
    s_lshl_b32 s97, s96, 11
    s_add_u32 s20, s97, s19
    buffer_load_dwordx4 v[168:171], v2, s[32:35], s20 offen sc1
    buffer_load_dwordx4 v[172:175], v2, s[32:35], s20 offen offset:1024 sc1
    s_waitcnt lgkmcnt(6)
    s_waitcnt vmcnt(3)
    v_mfma_f32_16x16x32_bf16 v[144:147], v[232:235], v[160:163], v[144:147]
    ds_read_b64_tr_b16 v[228:229], v22 offset:20480
    s_waitcnt vmcnt(2)
    v_mfma_f32_16x16x32_bf16 v[148:151], v[232:235], v[164:167], v[148:151]
    ds_read_b64_tr_b16 v[230:231], v22 offset:21504
    s_waitcnt lgkmcnt(6)
    v_mfma_f32_16x16x32_bf16 v[152:155], v[236:239], v[160:163], v[152:155]
    ds_read_b64_tr_b16 v[232:233], v23 offset:20480
    v_mfma_f32_16x16x32_bf16 v[156:159], v[236:239], v[164:167], v[156:159]
    ds_read_b64_tr_b16 v[234:235], v23 offset:21504
    s_waitcnt lgkmcnt(6)
    v_mfma_f32_16x16x32_bf16 v[128:131], v[240:243], v[160:163], v[128:131]
    ds_read_b64_tr_b16 v[236:237], v20 offset:20480
    v_mfma_f32_16x16x32_bf16 v[132:135], v[240:243], v[164:167], v[132:135]
    ds_read_b64_tr_b16 v[238:239], v20 offset:21504
    s_setprio 0
    s_waitcnt lgkmcnt(6)
    v_mfma_f32_16x16x32_bf16 v[136:139], v[244:247], v[160:163], v[136:139]
    ds_read_b64_tr_b16 v[240:241], v21 offset:20480
    v_mfma_f32_16x16x32_bf16 v[140:143], v[244:247], v[164:167], v[140:143]
    ds_read_b64_tr_b16 v[242:243], v21 offset:21504
    s_xor_b32 s96, s83, 6
    s_lshl_b32 s97, s96, 11
    s_add_u32 s20, s97, s19
    buffer_load_dwordx4 v[160:163], v2, s[32:35], s20 offen sc1
    buffer_load_dwordx4 v[164:167], v2, s[32:35], s20 offen offset:1024 sc1
    s_waitcnt lgkmcnt(6)
    s_waitcnt vmcnt(3)
    v_mfma_f32_16x16x32_bf16 v[144:147], v[228:231], v[168:171], v[144:147]
    ds_read_b64_tr_b16 v[244:245], v22 offset:24576
    s_waitcnt vmcnt(2)
    v_mfma_f32_16x16x32_bf16 v[148:151], v[228:231], v[172:175], v[148:151]
    ds_read_b64_tr_b16 v[246:247], v22 offset:25600
    s_waitcnt lgkmcnt(6)
    v_mfma_f32_16x16x32_bf16 v[152:155], v[232:235], v[168:171], v[152:155]
    ds_read_b64_tr_b16 v[228:229], v23 offset:24576
    v_mfma_f32_16x16x32_bf16 v[156:159], v[232:235], v[172:175], v[156:159]
    ds_read_b64_tr_b16 v[230:231], v23 offset:25600
    s_waitcnt lgkmcnt(6)
    v_mfma_f32_16x16x32_bf16 v[128:131], v[236:239], v[168:171], v[128:131]
    ds_read_b64_tr_b16 v[232:233], v20 offset:24576
    v_mfma_f32_16x16x32_bf16 v[132:135], v[236:239], v[172:175], v[132:135]
    ds_read_b64_tr_b16 v[234:235], v20 offset:25600
    s_waitcnt lgkmcnt(6)
    v_mfma_f32_16x16x32_bf16 v[136:139], v[240:243], v[168:171], v[136:139]
    ds_read_b64_tr_b16 v[236:237], v21 offset:24576
    v_mfma_f32_16x16x32_bf16 v[140:143], v[240:243], v[172:175], v[140:143]
    ds_read_b64_tr_b16 v[238:239], v21 offset:25600
    s_xor_b32 s96, s83, 7
    s_lshl_b32 s97, s96, 11
    s_add_u32 s20, s97, s19
    buffer_load_dwordx4 v[168:171], v2, s[32:35], s20 offen sc1
    buffer_load_dwordx4 v[172:175], v2, s[32:35], s20 offen offset:1024 sc1
    s_waitcnt lgkmcnt(6)
    s_waitcnt vmcnt(3)
    v_mfma_f32_16x16x32_bf16 v[144:147], v[244:247], v[160:163], v[144:147]
    ds_read_b64_tr_b16 v[240:241], v22 offset:28672
    s_waitcnt vmcnt(2)
    v_mfma_f32_16x16x32_bf16 v[148:151], v[244:247], v[164:167], v[148:151]
    ds_read_b64_tr_b16 v[242:243], v22 offset:29696
    s_waitcnt lgkmcnt(6)
    v_mfma_f32_16x16x32_bf16 v[152:155], v[228:231], v[160:163], v[152:155]
    ds_read_b64_tr_b16 v[244:245], v23 offset:28672
    v_mfma_f32_16x16x32_bf16 v[156:159], v[228:231], v[164:167], v[156:159]
    ds_read_b64_tr_b16 v[246:247], v23 offset:29696
    s_waitcnt lgkmcnt(6)
    v_mfma_f32_16x16x32_bf16 v[128:131], v[232:235], v[160:163], v[128:131]
    ds_read_b64_tr_b16 v[228:229], v20 offset:28672
    v_mfma_f32_16x16x32_bf16 v[132:135], v[232:235], v[164:167], v[132:135]
    ds_read_b64_tr_b16 v[230:231], v20 offset:29696
    s_waitcnt lgkmcnt(6)
    v_mfma_f32_16x16x32_bf16 v[136:139], v[236:239], v[160:163], v[136:139]
    ds_read_b64_tr_b16 v[232:233], v21 offset:28672
    v_mfma_f32_16x16x32_bf16 v[140:143], v[236:239], v[164:167], v[140:143]
    ds_read_b64_tr_b16 v[234:235], v21 offset:29696
    s_cmp_eq_u32 s25, s4
    s_cbranch_scc1 L_D2
SPOLL_32:
    s_load_dwordx2 s[24:25], s[32:33], s92 offset:1024 glc
SCHK_33:
    s_add_u32 s5, s5, 1
    s_cmp_ge_u32 s5, 300000
    s_waitcnt lgkmcnt(0)
    s_cbranch_scc1 SDONE_34
    s_cmp_lg_u32 s25, s4
    s_cbranch_scc1 SPOLL_32
SDONE_34:
L_D2:
    s_barrier
    s_xor_b32 s96, s83, 8
    s_lshl_b32 s97, s96, 11
    s_add_u32 s20, s97, s19
    buffer_load_dwordx4 v[160:163], v2, s[32:35], s20 offen sc1
    buffer_load_dwordx4 v[164:167], v2, s[32:35], s20 offen offset:1024 sc1
    s_waitcnt lgkmcnt(6)
    s_waitcnt vmcnt(3)
    v_mfma_f32_16x16x32_bf16 v[144:147], v[240:243], v[168:171], v[144:147]
    ds_read_b64_tr_b16 v[236:237], v22 offset:32768
    s_waitcnt vmcnt(2)
    v_mfma_f32_16x16x32_bf16 v[148:151], v[240:243], v[172:175], v[148:151]
    ds_read_b64_tr_b16 v[238:239], v22 offset:33792
    s_waitcnt lgkmcnt(6)
    v_mfma_f32_16x16x32_bf16 v[152:155], v[244:247], v[168:171], v[152:155]
    ds_read_b64_tr_b16 v[240:241], v23 offset:32768
    v_mfma_f32_16x16x32_bf16 v[156:159], v[244:247], v[172:175], v[156:159]
    ds_read_b64_tr_b16 v[242:243], v23 offset:33792
    s_waitcnt lgkmcnt(6)
    v_mfma_f32_16x16x32_bf16 v[128:131], v[228:231], v[168:171], v[128:131]
    ds_read_b64_tr_b16 v[244:245], v20 offset:32768
    v_mfma_f32_16x16x32_bf16 v[132:135], v[228:231], v[172:175], v[132:135]
    ds_read_b64_tr_b16 v[246:247], v20 offset:33792
    s_waitcnt lgkmcnt(6)
    v_mfma_f32_16x16x32_bf16 v[136:139], v[232:235], v[168:171], v[136:139]
    ds_read_b64_tr_b16 v[228:229], v21 offset:32768
    v_mfma_f32_16x16x32_bf16 v[140:143], v[232:235], v[172:175], v[140:143]
    ds_read_b64_tr_b16 v[230:231], v21 offset:33792
    s_xor_b32 s96, s83, 9
    s_lshl_b32 s97, s96, 11
    s_add_u32 s20, s97, s19
    buffer_load_dwordx4 v[168:171], v2, s[32:35], s20 offen sc1
    buffer_load_dwordx4 v[172:175], v2, s[32:35], s20 offen offset:1024 sc1
    s_waitcnt lgkmcnt(6)
    s_waitcnt vmcnt(3)
    v_mfma_f32_16x16x32_bf16 v[144:147], v[236:239], v[160:163], v[144:147]
    ds_read_b64_tr_b16 v[232:233], v22 offset:36864
    s_waitcnt vmcnt(2)
    v_mfma_f32_16x16x32_bf16 v[148:151], v[236:239], v[164:167], v[148:151]
    ds_read_b64_tr_b16 v[234:235], v22 offset:37888
    s_waitcnt lgkmcnt(6)
    v_mfma_f32_16x16x32_bf16 v[152:155], v[240:243], v[160:163], v[152:155]
    ds_read_b64_tr_b16 v[236:237], v23 offset:36864
    v_mfma_f32_16x16x32_bf16 v[156:159], v[240:243], v[164:167], v[156:159]
    ds_read_b64_tr_b16 v[238:239], v23 offset:37888
    s_waitcnt lgkmcnt(6)
    v_mfma_f32_16x16x32_bf16 v[128:131], v[244:247], v[160:163], v[128:131]
    ds_read_b64_tr_b16 v[240:241], v20 offset:36864
    v_mfma_f32_16x16x32_bf16 v[132:135], v[244:247], v[164:167], v[132:135]
    ds_read_b64_tr_b16 v[242:243], v20 offset:37888
    s_waitcnt lgkmcnt(6)
    v_mfma_f32_16x16x32_bf16 v[136:139], v[228:231], v[160:163], v[136:139]
    ds_read_b64_tr_b16 v[244:245], v21 offset:36864
    v_mfma_f32_16x16x32_bf16 v[140:143], v[228:231], v[164:167], v[140:143]
    ds_read_b64_tr_b16 v[246:247], v21 offset:37888
    s_xor_b32 s96, s83, 10
    s_lshl_b32 s97, s96, 11
    s_add_u32 s20, s97, s19
    buffer_load_dwordx4 v[160:163], v2, s[32:35], s20 offen sc1
    buffer_load_dwordx4 v[164:167], v2, s[32:35], s20 offen offset:1024 sc1
    s_waitcnt lgkmcnt(6)
    s_waitcnt vmcnt(3)
    v_mfma_f32_16x16x32_bf16 v[144:147], v[232:235], v[168:171], v[144:147]
    ds_read_b64_tr_b16 v[228:229], v22 offset:40960
    s_waitcnt vmcnt(2)
    v_mfma_f32_16x16x32_bf16 v[148:151], v[232:235], v[172:175], v[148:151]
    ds_read_b64_tr_b16 v[230:231], v22 offset:41984
    s_waitcnt lgkmcnt(6)
    v_mfma_f32_16x16x32_bf16 v[152:155], v[236:239], v[168:171], v[152:155]
    ds_read_b64_tr_b16 v[232:233], v23 offset:40960
    v_mfma_f32_16x16x32_bf16 v[156:159], v[236:239], v[172:175], v[156:159]
    ds_read_b64_tr_b16 v[234:235], v23 offset:41984
    s_waitcnt lgkmcnt(6)
    v_mfma_f32_16x16x32_bf16 v[128:131], v[240:243], v[168:171], v[128:131]
    ds_read_b64_tr_b16 v[236:237], v20 offset:40960
    v_mfma_f32_16x16x32_bf16 v[132:135], v[240:243], v[172:175], v[132:135]
    ds_read_b64_tr_b16 v[238:239], v20 offset:41984
    s_waitcnt lgkmcnt(6)
    v_mfma_f32_16x16x32_bf16 v[136:139], v[244:247], v[168:171], v[136:139]
    ds_read_b64_tr_b16 v[240:241], v21 offset:40960
    v_mfma_f32_16x16x32_bf16 v[140:143], v[244:247], v[172:175], v[140:143]
    ds_read_b64_tr_b16 v[242:243], v21 offset:41984
    s_xor_b32 s96, s83, 11
    s_lshl_b32 s97, s96, 11
    s_add_u32 s20, s97, s19
    buffer_load_dwordx4 v[168:171], v2, s[32:35], s20 offen sc1
    buffer_load_dwordx4 v[172:175], v2, s[32:35], s20 offen offset:1024 sc1
    s_waitcnt lgkmcnt(6)
    s_waitcnt vmcnt(3)
    v_mfma_f32_16x16x32_bf16 v[144:147], v[228:231], v[160:163], v[144:147]
    ds_read_b64_tr_b16 v[244:245], v22 offset:45056
    s_waitcnt vmcnt(2)
    v_mfma_f32_16x16x32_bf16 v[148:151], v[228:231], v[164:167], v[148:151]
    ds_read_b64_tr_b16 v[246:247], v22 offset:46080
    s_waitcnt lgkmcnt(6)
    v_mfma_f32_16x16x32_bf16 v[152:155], v[232:235], v[160:163], v[152:155]
    ds_read_b64_tr_b16 v[228:229], v23 offset:45056
    v_mfma_f32_16x16x32_bf16 v[156:159], v[232:235], v[164:167], v[156:159]
    ds_read_b64_tr_b16 v[230:231], v23 offset:46080
    s_waitcnt lgkmcnt(6)
    v_mfma_f32_16x16x32_bf16 v[128:131], v[236:239], v[160:163], v[128:131]
    ds_read_b64_tr_b16 v[232:233], v20 offset:45056
    v_mfma_f32_16x16x32_bf16 v[132:135], v[236:239], v[164:167], v[132:135]
    ds_read_b64_tr_b16 v[234:235], v20 offset:46080
    s_waitcnt lgkmcnt(6)
    v_mfma_f32_16x16x32_bf16 v[136:139], v[240:243], v[160:163], v[136:139]
    ds_read_b64_tr_b16 v[236:237], v21 offset:45056
    v_mfma_f32_16x16x32_bf16 v[140:143], v[240:243], v[164:167], v[140:143]
    ds_read_b64_tr_b16 v[238:239], v21 offset:46080
    s_xor_b32 s96, s83, 12
    s_lshl_b32 s97, s96, 11
    s_add_u32 s20, s97, s19
    buffer_load_dwordx4 v[160:163], v2, s[32:35], s20 offen sc1
    buffer_load_dwordx4 v[164:167], v2, s[32:35], s20 offen offset:1024 sc1
    s_waitcnt lgkmcnt(6)
    s_waitcnt vmcnt(3)
    v_mfma_f32_16x16x32_bf16 v[144:147], v[244:247], v[168:171], v[144:147]
    ds_read_b64_tr_b16 v[240:241], v22 offset:49152
    s_waitcnt vmcnt(2)
    v_mfma_f32_16x16x32_bf16 v[148:151], v[244:247], v[172:175], v[148:151]
    ds_read_b64_tr_b16 v[242:243], v22 offset:50176
    s_waitcnt lgkmcnt(6)
    v_mfma_f32_16x16x32_bf16 v[152:155], v[228:231], v[168:171], v[152:155]
    ds_read_b64_tr_b16 v[244:245], v23 offset:49152
    v_mfma_f32_16x16x32_bf16 v[156:159], v[228:231], v[172:175], v[156:159]
    ds_read_b64_tr_b16 v[246:247], v23 offset:50176
    s_waitcnt lgkmcnt(6)
    v_mfma_f32_16x16x32_bf16 v[128:131], v[232:235], v[168:171], v[128:131]
    ds_read_b64_tr_b16 v[228:229], v20 offset:49152
    v_mfma_f32_16x16x32_bf16 v[132:135], v[232:235], v[172:175], v[132:135]
    ds_read_b64_tr_b16 v[230:231], v20 offset:50176
    s_waitcnt lgkmcnt(6)
    v_mfma_f32_16x16x32_bf16 v[136:139], v[236:239], v[168:171], v[136:139]
    ds_read_b64_tr_b16 v[232:233], v21 offset:49152
    v_mfma_f32_16x16x32_bf16 v[140:143], v[236:239], v[172:175], v[140:143]
    ds_read_b64_tr_b16 v[234:235], v21 offset:50176
    s_xor_b32 s96, s83, 13
    s_lshl_b32 s97, s96, 11
    s_add_u32 s20, s97, s19
    buffer_load_dwordx4 v[168:171], v2, s[32:35], s20 offen sc1
    buffer_load_dwordx4 v[172:175], v2, s[32:35], s20 offen offset:1024 sc1
    s_waitcnt lgkmcnt(6)
    s_waitcnt vmcnt(3)
    v_mfma_f32_16x16x32_bf16 v[144:147], v[240:243], v[160:163], v[144:147]
    ds_read_b64_tr_b16 v[236:237], v22 offset:53248
    s_waitcnt vmcnt(2)
    v_mfma_f32_16x16x32_bf16 v[148:151], v[240:243], v[164:167], v[148:151]
    ds_read_b64_tr_b16 v[238:239], v22 offset:54272
    s_waitcnt lgkmcnt(6)
    v_mfma_f32_16x16x32_bf16 v[152:155], v[244:247], v[160:163], v[152:155]
    ds_read_b64_tr_b16 v[240:241], v23 offset:53248
    v_mfma_f32_16x16x32_bf16 v[156:159], v[244:247], v[164:167], v[156:159]
    ds_read_b64_tr_b16 v[242:243], v23 offset:54272
    s_waitcnt lgkmcnt(6)
    v_mfma_f32_16x16x32_bf16 v[128:131], v[228:231], v[160:163], v[128:131]
    ds_read_b64_tr_b16 v[244:245], v20 offset:53248
    v_mfma_f32_16x16x32_bf16 v[132:135], v[228:231], v[164:167], v[132:135]
    ds_read_b64_tr_b16 v[246:247], v20 offset:54272
    s_waitcnt lgkmcnt(6)
    v_mfma_f32_16x16x32_bf16 v[136:139], v[232:235], v[160:163], v[136:139]
    ds_read_b64_tr_b16 v[228:229], v21 offset:53248
    v_mfma_f32_16x16x32_bf16 v[140:143], v[232:235], v[164:167], v[140:143]
    ds_read_b64_tr_b16 v[230:231], v21 offset:54272
    s_xor_b32 s96, s83, 14
    s_lshl_b32 s97, s96, 11
    s_add_u32 s20, s97, s19
    buffer_load_dwordx4 v[160:163], v2, s[32:35], s20 offen sc1
    buffer_load_dwordx4 v[164:167], v2, s[32:35], s20 offen offset:1024 sc1
    s_waitcnt lgkmcnt(6)
    s_waitcnt vmcnt(3)
    v_mfma_f32_16x16x32_bf16 v[144:147], v[236:239], v[168:171], v[144:147]
    ds_read_b64_tr_b16 v[232:233], v22 offset:57344
    s_waitcnt vmcnt(2)
    v_mfma_f32_16x16x32_bf16 v[148:151], v[236:239], v[172:175], v[148:151]
    ds_read_b64_tr_b16 v[234:235], v22 offset:58368
    s_waitcnt lgkmcnt(6)
    v_mfma_f32_16x16x32_bf16 v[152:155], v[240:243], v[168:171], v[152:155]
    ds_read_b64_tr_b16 v[236:237], v23 offset:57344
    v_mfma_f32_16x16x32_bf16 v[156:159], v[240:243], v[172:175], v[156:159]
    ds_read_b64_tr_b16 v[238:239], v23 offset:58368
    s_waitcnt lgkmcnt(6)
    v_mfma_f32_16x16x32_bf16 v[128:131], v[244:247], v[168:171], v[128:131]
    ds_read_b64_tr_b16 v[240:241], v20 offset:57344
    v_mfma_f32_16x16x32_bf16 v[132:135], v[244:247], v[172:175], v[132:135]
    ds_read_b64_tr_b16 v[242:243], v20 offset:58368
    s_waitcnt lgkmcnt(6)
    v_mfma_f32_16x16x32_bf16 v[136:139], v[228:231], v[168:171], v[136:139]
    ds_read_b64_tr_b16 v[244:245], v21 offset:57344
    v_mfma_f32_16x16x32_bf16 v[140:143], v[228:231], v[172:175], v[140:143]
    ds_read_b64_tr_b16 v[246:247], v21 offset:58368
    s_xor_b32 s96, s83, 15
    s_lshl_b32 s97, s96, 11
    s_add_u32 s20, s97, s19
    buffer_load_dwordx4 v[168:171], v2, s[32:35], s20 offen sc1
    buffer_load_dwordx4 v[172:175], v2, s[32:35], s20 offen offset:1024 sc1
    buffer_load_dwordx2 v[26:27], v25, s[32:35], s18 offen sc1
    s_mov_b32 exec_lo, 0xff
    s_mov_b32 exec_hi, 0xff
    buffer_store_dwordx2 v[224:225], v226, s[32:35], 0 offen sc1
    s_mov_b64 exec, -1
    s_waitcnt lgkmcnt(6)
    s_waitcnt vmcnt(5)
    v_mfma_f32_16x16x32_bf16 v[144:147], v[232:235], v[160:163], v[144:147]
    ds_read_b64_tr_b16 v[228:229], v22 offset:61440
    s_waitcnt vmcnt(4)
    v_mfma_f32_16x16x32_bf16 v[148:151], v[232:235], v[164:167], v[148:151]
    ds_read_b64_tr_b16 v[230:231], v22 offset:62464
    s_waitcnt lgkmcnt(6)
    v_mfma_f32_16x16x32_bf16 v[152:155], v[236:239], v[160:163], v[152:155]
    ds_read_b64_tr_b16 v[232:233], v23 offset:61440
    v_mfma_f32_16x16x32_bf16 v[156:159], v[236:239], v[164:167], v[156:159]
    ds_read_b64_tr_b16 v[234:235], v23 offset:62464
    s_waitcnt lgkmcnt(6)
    v_mfma_f32_16x16x32_bf16 v[128:131], v[240:243], v[160:163], v[128:131]
    ds_read_b64_tr_b16 v[236:237], v20 offset:61440
    v_mfma_f32_16x16x32_bf16 v[132:135], v[240:243], v[164:167], v[132:135]
    ds_read_b64_tr_b16 v[238:239], v20 offset:62464
    s_waitcnt lgkmcnt(6)
    v_mfma_f32_16x16x32_bf16 v[136:139], v[244:247], v[160:163], v[136:139]
    ds_read_b64_tr_b16 v[240:241], v21 offset:61440
    v_mfma_f32_16x16x32_bf16 v[140:143], v[244:247], v[164:167], v[140:143]
    ds_read_b64_tr_b16 v[242:243], v21 offset:62464
    s_waitcnt lgkmcnt(6)
    s_waitcnt vmcnt(3)
    v_mfma_f32_16x16x32_bf16 v[144:147], v[228:231], v[168:171], v[144:147]
    s_waitcnt vmcnt(2)
    v_mfma_f32_16x16x32_bf16 v[148:151], v[228:231], v[172:175], v[148:151]
    s_waitcnt lgkmcnt(4)
    v_mfma_f32_16x16x32_bf16 v[152:155], v[232:235], v[168:171], v[152:155]
    v_mfma_f32_16x16x32_bf16 v[156:159], v[232:235], v[172:175], v[156:159]
    s_waitcnt lgkmcnt(2)
    v_mfma_f32_16x16x32_bf16 v[128:131], v[236:239], v[168:171], v[128:131]
    v_mfma_f32_16x16x32_bf16 v[132:135], v[236:239], v[172:175], v[132:135]
    s_waitcnt lgkmcnt(0)
    v_mfma_f32_16x16x32_bf16 v[136:139], v[240:243], v[168:171], v[136:139]
    v_mfma_f32_16x16x32_bf16 v[140:143], v[240:243], v[172:175], v[140:143]
    s_setprio 0
    s_lshl_b32 s13, s3, 12
    v_add_u32 v4, s13, v2
    v_xor_b32 v5, 0x4000, v4
    ds_write_b128 v4, v[144:147]
    ds_write_b128 v4, v[148:151] offset:1024
    ds_write_b128 v4, v[152:155] offset:2048
    ds_write_b128 v4, v[156:159] offset:3072
    s_lshl_b32 s96, s76, 11
    s_and_b32 s97, s3, 3
    s_lshl_b32 s98, s97, 9
    s_add_u32 s99, s96, s98
    s_add_u32 s13, s99, 131072
    v_and_b32 v6, 31, v1
    v_lshl_add_u32 v6, v6, 4, s13
    v_lshrrev_b32 v9, 5, v1
    v_lshl_add_u32 v6, v9, 3, v6
    s_lshl_b32 s96, s76, 6
    s_add_u32 s13, s96, 139008
    v_and_b32 v7, 7, v1
    v_lshl_add_u32 v7, v7, 2, s13
    v_lshrrev_b32 v9, 5, v1
    v_lshl_add_u32 v7, v9, 5, v7
    s_lshl_b32 s96, s21, 15
    s_lshl_b32 s97, s3, 8
    s_add_u32 s98, s96, s97
    s_add_u32 s19, s98, 12582912
    v_and_b32 v24, 15, v1
    v_lshlrev_b32 v24, 4, v24
    v_lshrrev_b32 v9, 4, v1
    v_lshl_add_u32 v24, v9, 11, v24
    v_mov_b32 v232, 0x3f803f80
    s_waitcnt lgkmcnt(0)
    s_barrier
    ds_read_b128 v[144:147], v5
    ds_read_b128 v[148:151], v5 offset:1024
    ds_read_b128 v[152:155], v5 offset:2048
    ds_read_b128 v[156:159], v5 offset:3072
    s_add_u32 s14, s80, 114688
    s_lshl2_add_u32 m0, s89, 67584
    s_nop 0
    buffer_load_dwordx4 v72, s[56:59], s14 offen nt lds
    s_add_u32 s14, s80, 172032
    s_lshl2_add_u32 m0, s89, 68608
    s_nop 0
    buffer_load_dwordx4 v72, s[56:59], s14 offen nt lds
    s_mov_b32 s14, s81
    s_lshl2_add_u32 m0, s89, 98304
    s_nop 0
    buffer_load_dwordx4 v73, s[60:63], s14 offen nt lds
    s_waitcnt lgkmcnt(3)
    v_pk_add_f32 v[128:129], v[128:129], v[144:145]
    v_pk_add_f32 v[130:131], v[130:131], v[146:147]
    s_waitcnt lgkmcnt(2)
    v_pk_add_f32 v[132:133], v[132:133], v[148:149]
    v_pk_add_f32 v[134:135], v[134:135], v[150:151]
    s_nop 0
    v_permlane16_swap_b32 v128, v132
    v_permlane16_swap_b32 v129, v133
    v_permlane16_swap_b32 v130, v134
    v_permlane16_swap_b32 v131, v135
    v_cvt_pk_bf16_f32 v128, 0, v128
    v_cvt_pk_bf16_f32 v129, 0, v129
    v_cvt_pk_bf16_f32 v130, 0, v130
    v_cvt_pk_bf16_f32 v131, 0, v131
    v_cvt_pk_bf16_f32 v132, 0, v132
    v_cvt_pk_bf16_f32 v133, 0, v133
    v_cvt_pk_bf16_f32 v134, 0, v134
    v_cvt_pk_bf16_f32 v135, 0, v135
    v_pk_mul_f32 v[128:129], v[128:129], v[76:77]
    v_pk_mul_f32 v[130:131], v[130:131], v[78:79]
    v_pk_mul_f32 v[132:133], v[132:133], v[80:81]
    v_pk_mul_f32 v[134:135], v[134:135], v[82:83]
    v_cvt_pk_bf16_f32 v128, 0, v128
    v_cvt_pk_bf16_f32 v129, 0, v129
    v_cvt_pk_bf16_f32 v130, 0, v130
    v_cvt_pk_bf16_f32 v131, 0, v131
    v_cvt_pk_bf16_f32 v132, 0, v132
    v_cvt_pk_bf16_f32 v133, 0, v133
    v_cvt_pk_bf16_f32 v134, 0, v134
    v_cvt_pk_bf16_f32 v135, 0, v135
    v_pk_add_f32 v[128:129], v[128:129], v[28:29]
    v_pk_add_f32 v[130:131], v[130:131], v[30:31]
    v_pk_add_f32 v[132:133], v[132:133], v[32:33]
    v_pk_add_f32 v[134:135], v[134:135], v[34:35]
    v_cvt_pk_bf16_f32 v12, v128, v129
    v_cvt_pk_bf16_f32 v13, v130, v131
    v_cvt_pk_bf16_f32 v14, v132, v133
    v_cvt_pk_bf16_f32 v15, v134, v135
    s_waitcnt lgkmcnt(1)
    v_pk_add_f32 v[136:137], v[136:137], v[152:153]
    v_pk_add_f32 v[138:139], v[138:139], v[154:155]
    s_waitcnt lgkmcnt(0)
    v_pk_add_f32 v[140:141], v[140:141], v[156:157]
    v_pk_add_f32 v[142:143], v[142:143], v[158:159]
    s_nop 0
    v_permlane16_swap_b32 v136, v140
    v_permlane16_swap_b32 v137, v141
    v_permlane16_swap_b32 v138, v142
    v_permlane16_swap_b32 v139, v143
    v_cvt_pk_bf16_f32 v136, 0, v136
    v_cvt_pk_bf16_f32 v137, 0, v137
    v_cvt_pk_bf16_f32 v138, 0, v138
    v_cvt_pk_bf16_f32 v139, 0, v139
    v_cvt_pk_bf16_f32 v140, 0, v140
    v_cvt_pk_bf16_f32 v141, 0, v141
    v_cvt_pk_bf16_f32 v142, 0, v142
    v_cvt_pk_bf16_f32 v143, 0, v143
    v_pk_mul_f32 v[136:137], v[136:137], v[84:85]
    v_pk_mul_f32 v[138:139], v[138:139], v[86:87]
    v_pk_mul_f32 v[140:141], v[140:141], v[88:89]
    v_pk_mul_f32 v[142:143], v[142:143], v[90:91]
    v_cvt_pk_bf16_f32 v136, 0, v136
    v_cvt_pk_bf16_f32 v137, 0, v137
    v_cvt_pk_bf16_f32 v138, 0, v138
    v_cvt_pk_bf16_f32 v139, 0, v139
    v_cvt_pk_bf16_f32 v140, 0, v140
    v_cvt_pk_bf16_f32 v141, 0, v141
    v_cvt_pk_bf16_f32 v142, 0, v142
    v_cvt_pk_bf16_f32 v143, 0, v143
    v_pk_add_f32 v[136:137], v[136:137], v[36:37]
    v_pk_add_f32 v[138:139], v[138:139], v[38:39]
    v_pk_add_f32 v[140:141], v[140:141], v[40:41]
    v_pk_add_f32 v[142:143], v[142:143], v[42:43]
    v_cvt_pk_bf16_f32 v16, v136, v137
    v_cvt_pk_bf16_f32 v17, v138, v139
    v_cvt_pk_bf16_f32 v18, v140, v141
    v_cvt_pk_bf16_f32 v19, v142, v143
    v_dot2_f32_bf16 v228, v12, v232, 0
    v_dot2_f32_bf16 v230, v12, v12, 0
    v_dot2_f32_bf16 v229, v12, v112, 0
    v_dot2_f32_bf16 v231, v12, v120, 0
    v_dot2_f32_bf16 v228, v13, v232, v228
    v_dot2_f32_bf16 v230, v13, v13, v230
    v_dot2_f32_bf16 v229, v13, v113, v229
    v_dot2_f32_bf16 v231, v13, v121, v231
    v_dot2_f32_bf16 v228, v14, v232, v228
    v_dot2_f32_bf16 v230, v14, v14, v230
    v_dot2_f32_bf16 v229, v14, v114, v229
    v_dot2_f32_bf16 v231, v14, v122, v231
    v_dot2_f32_bf16 v228, v15, v232, v228
    v_dot2_f32_bf16 v230, v15, v15, v230
    v_dot2_f32_bf16 v229, v15, v115, v229
    v_dot2_f32_bf16 v231, v15, v123, v231
    v_dot2_f32_bf16 v228, v16, v232, v228
    v_dot2_f32_bf16 v230, v16, v16, v230
    v_dot2_f32_bf16 v229, v16, v116, v229
    v_dot2_f32_bf16 v231, v16, v124, v231
    v_dot2_f32_bf16 v228, v17, v232, v228
    v_dot2_f32_bf16 v230, v17, v17, v230
    v_dot2_f32_bf16 v229, v17, v117, v229
    v_dot2_f32_bf16 v231, v17, v125, v231
    v_dot2_f32_bf16 v228, v18, v232, v228
    v_dot2_f32_bf16 v230, v18, v18, v230
    v_dot2_f32_bf16 v229, v18, v118, v229
    v_dot2_f32_bf16 v231, v18, v126, v231
    v_dot2_f32_bf16 v228, v19, v232, v228
    v_dot2_f32_bf16 v230, v19, v19, v230
    v_dot2_f32_bf16 v229, v19, v119, v229
    v_dot2_f32_bf16 v231, v19, v127, v231
    s_nop 0
    v_permlane32_swap_b32 v228, v230
    s_nop 0
    v_permlane32_swap_b32 v229, v231
    v_pk_add_f32 v[228:229], v[228:229], v[230:231]
    ds_write_b64 v6, v[228:229]
    ds_write_b32 v7, v68
    ds_write_b32 v7, v69 offset:128
    ds_write_b32 v7, v70 offset:256
    ds_write_b32 v7, v71 offset:384
    v_add_u32 v4, 131072, v2
    v_and_b32 v5, 7, v1
    v_lshlrev_b32 v5, 15, v5
    v_bfe_u32 v9, v1, 3, 1
    v_lshl_add_u32 v5, v9, 12, v5
    s_lshl4_add_u32 s96, s21, s12
    s_lshl_b32 s97, s96, 11
    s_add_u32 s13, s97, 12582912
    s_and_b32 s96, s12, 1
    s_lshr_b32 s97, s21, 2
    s_and_b32 s98, s21, 3
    s_lshl_b32 s99, s98, 6
    s_lshl1_add_u32 s98, s97, s99
    s_lshl_b32 s97, s98, 12
    s_lshr_b32 s99, s12, 1
    s_lshl_b32 s98, s99, 6
    s_add_u32 s99, s97, s98
    s_lshl2_add_u32 s97, s96, s99
    s_add_u32 s98, s97, 1048576
    s_add_u32 s16, s98, 1536
    s_waitcnt lgkmcnt(0)
    s_barrier
    s_cmp_lg_u32 s3, 0
    s_cbranch_scc1 L_PE
    ds_read_b128 v[144:147], v4 offset:0
    ds_read_b128 v[148:151], v4 offset:2048
    ds_read_b128 v[152:155], v4 offset:1024
    ds_read_b128 v[156:159], v4 offset:3072
    s_waitcnt lgkmcnt(2)
    v_pk_add_f32 v[144:145], v[144:145], v[148:149]
    v_pk_add_f32 v[146:147], v[146:147], v[150:151]
    v_add_f32 v145, v145, v147
    v_mov_b32 v147, s4
    s_waitcnt lgkmcnt(0)
    v_pk_add_f32 v[152:153], v[152:153], v[156:157]
    v_pk_add_f32 v[154:155], v[154:155], v[158:159]
    v_add_f32 v153, v153, v155
    v_mov_b32 v155, s4
    buffer_store_dwordx4 v[144:147], v2, s[32:35], s13 offen sc1
    buffer_store_dwordx4 v[152:155], v2, s[32:35], s13 offen offset:1024 sc1
    s_mov_b64 exec, 0xffff
    buffer_store_dword v147, v5, s[32:35], s16 offen sc1
    s_mov_b64 exec, -1
L_PE:
    s_load_dwordx2 s[24:25], s[32:33], s92 offset:1536 glc
    s_and_b32 s96, s3, 3
    s_mul_i32 s97, s96, 4608
    s_lshl_b32 s98, s76, 6
    s_add_u32 s16, s97, s98
    v_and_b32 v23, 31, v1
    v_mul_u32_u24 v23, 144, v23
    v_lshrrev_b32 v9, 5, v1
    v_lshl_add_u32 v23, v9, 5, v23
    v_add_u32 v23, s16, v23
    ds_write_b128 v23, v[12:15]
    ds_write_b128 v23, v[16:19] offset:16
    v_add_u32 v23, 139776, v23
    s_lshl3_add_u32 s96, s21, s3
    s_lshl_b32 s97, s96, 5
    s_sub_u32 s15, 4094, s97
    v_and_b32 v22, 15, v1
    v_lshlrev_b32 v22, 1, v22
    v_sub_u32 v22, s15, v22
    s_lshl_b32 s96, s3, 7
    s_add_u32 s15, s96, 135168
    v_and_b32 v8, 15, v1
    v_lshl_add_u32 v8, v8, 3, s15
    s_and_b32 s96, s3, 3
    s_lshl_b32 s97, s96, 8
    s_add_u32 s15, s97, 135168
    v_and_b32 v10, 31, v1
    v_lshl_add_u32 v10, v10, 3, s15
    v_and_b32 v11, 7, v1
    v_lshlrev_b32 v11, 3, v11
    v_add_u32 v11, 136192, v11
    s_waitcnt vmcnt(4)
    v_cmp_ne_u32 vcc, s4, v27
    s_cbranch_vccz TOK_38
POLL_39:
    buffer_load_dwordx2 v[26:27], v25, s[32:35], s18 offen sc1
    s_waitcnt vmcnt(0)
    v_cmp_ne_u32 vcc, s4, v27
    s_cbranch_vccz PDONE_40
    s_add_u32 s5, s5, 1
    s_cmp_lt_u32 s5, 300000
    s_cbranch_scc1 POLL_39
PDONE_40:
TOK_38:
    v_add_f32_dpp v26, v26, v26 quad_perm:[1,0,3,2] row_mask:0xf bank_mask:0xf
    s_nop 1
    v_add_f32_dpp v26, v26, v26 quad_perm:[2,3,0,1] row_mask:0xf bank_mask:0xf
    s_nop 1
    v_add_f32_dpp v26, v26, v26 row_half_mirror row_mask:0xf bank_mask:0xf
    s_nop 1
    v_add_f32_dpp v26, v26, v26 row_ror:8 row_mask:0xf bank_mask:0xf
    s_cmp_lg_u32 s3, 1
    s_cbranch_scc1 L_NOCT
    v_and_b32 v5, 15, v1
    v_lshlrev_b32 v5, 3, v5
    v_add_u32 v5, 139008, v5
    ds_read_b64 v[142:143], v5
    ds_read_b64 v[146:147], v5 offset:128
    ds_read_b64 v[148:149], v5 offset:384
    s_waitcnt lgkmcnt(0)
    v_lshlrev_b32 v140, 16, v142
    v_and_b32 v141, s6, v142
    v_lshlrev_b32 v142, 16, v143
    v_and_b32 v143, s6, v143
    v_lshlrev_b32 v144, 16, v146
    v_and_b32 v145, s6, v146
    v_lshlrev_b32 v146, 16, v147
    v_and_b32 v147, s6, v147
L_NOCT:
    s_cmp_lt_u32 s3, 4
    s_cbranch_scc1 L_NOST
    s_sub_u32 s96, s3, 4
    s_lshl_b32 s97, s96, 12
    s_add_u32 s13, s97, 32768
    v_add_u32 v4, s13, v2
    v_add_u32 v7, 65536, v4
    ds_write_b128 v4, v[176:179] offset:16384
    ds_write_b128 v4, v[180:183]
    ds_write_b128 v4, v[184:187] offset:17408
    ds_write_b128 v4, v[188:191] offset:1024
    ds_write_b128 v4, v[192:195] offset:18432
    ds_write_b128 v4, v[196:199] offset:2048
    ds_write_b128 v4, v[200:203] offset:19456
    ds_write_b128 v4, v[204:207] offset:3072
    ds_write_b128 v4, v[208:211] offset:49152
    ds_write_b128 v4, v[212:215] offset:32768
    ds_write_b128 v4, v[216:219] offset:50176
    ds_write_b128 v4, v[220:223] offset:33792
L_NOST:
    s_branch SCHK_36
SPOLL_35:
    s_load_dwordx2 s[24:25], s[32:33], s92 offset:1536 glc
SCHK_36:
    s_add_u32 s5, s5, 1
    s_cmp_ge_u32 s5, 300000
    s_waitcnt lgkmcnt(0)
    s_cbranch_scc1 SDONE_37
    s_cmp_lg_u32 s24, s4
    s_cbranch_scc1 SPOLL_35
    s_cmp_lg_u32 s25, s4
    s_cbranch_scc1 SPOLL_35
SDONE_37:
    s_barrier
    s_mov_b32 s13, s19
    buffer_load_dwordx4 v[124:127], v24, s[32:35], s13 offen sc1
    s_add_u32 s13, s19, 8192
    buffer_load_dwordx4 v[128:131], v24, s[32:35], s13 offen sc1
    s_add_u32 s13, s19, 16384
    buffer_load_dwordx4 v[132:135], v24, s[32:35], s13 offen sc1
    s_add_u32 s13, s19, 24576
    buffer_load_dwordx4 v[136:139], v24, s[32:35], s13 offen sc1
    v_lshlrev_b32 v28, 16, v12
    v_and_b32 v29, s6, v12
    v_lshlrev_b32 v30, 16, v13
    v_and_b32 v31, s6, v13
    v_lshlrev_b32 v32, 16, v14
    v_and_b32 v33, s6, v14
    v_lshlrev_b32 v34, 16, v15
    v_and_b32 v35, s6, v15
    v_lshlrev_b32 v36, 16, v16
    v_and_b32 v37, s6, v16
    v_lshlrev_b32 v38, 16, v17
    v_and_b32 v39, s6, v17
    v_lshlrev_b32 v40, 16, v18
    v_and_b32 v41, s6, v18
    v_lshlrev_b32 v42, 16, v19
    v_and_b32 v43, s6, v19
    v_mul_u32_u24_dpp v92, v68, v52 row_newbcast:0 row_mask:0xf bank_mask:0xf
    v_and_b32_dpp v93, v68, v53 row_newbcast:0 row_mask:0xf bank_mask:0xf
    v_mul_u32_u24_dpp v94, v68, v52 row_newbcast:1 row_mask:0xf bank_mask:0xf
    v_and_b32_dpp v95, v68, v53 row_newbcast:1 row_mask:0xf bank_mask:0xf
    v_mul_u32_u24_dpp v96, v68, v52 row_newbcast:2 row_mask:0xf bank_mask:0xf
    v_and_b32_dpp v97, v68, v53 row_newbcast:2 row_mask:0xf bank_mask:0xf
    v_mul_u32_u24_dpp v98, v68, v52 row_newbcast:3 row_mask:0xf bank_mask:0xf
    v_and_b32_dpp v99, v68, v53 row_newbcast:3 row_mask:0xf bank_mask:0xf
    v_mul_u32_u24_dpp v100, v68, v52 row_newbcast:4 row_mask:0xf bank_mask:0xf
    v_and_b32_dpp v101, v68, v53 row_newbcast:4 row_mask:0xf bank_mask:0xf
    v_mul_u32_u24_dpp v102, v68, v52 row_newbcast:5 row_mask:0xf bank_mask:0xf
    v_and_b32_dpp v103, v68, v53 row_newbcast:5 row_mask:0xf bank_mask:0xf
    v_mul_u32_u24_dpp v104, v68, v52 row_newbcast:6 row_mask:0xf bank_mask:0xf
    v_and_b32_dpp v105, v68, v53 row_newbcast:6 row_mask:0xf bank_mask:0xf
    v_mul_u32_u24_dpp v106, v68, v52 row_newbcast:7 row_mask:0xf bank_mask:0xf
    v_and_b32_dpp v107, v68, v53 row_newbcast:7 row_mask:0xf bank_mask:0xf
    v_mul_u32_u24_dpp v108, v69, v52 row_newbcast:0 row_mask:0xf bank_mask:0xf
    v_and_b32_dpp v109, v69, v53 row_newbcast:0 row_mask:0xf bank_mask:0xf
    v_mul_u32_u24_dpp v110, v69, v52 row_newbcast:1 row_mask:0xf bank_mask:0xf
    v_and_b32_dpp v111, v69, v53 row_newbcast:1 row_mask:0xf bank_mask:0xf
    v_mul_u32_u24_dpp v112, v69, v52 row_newbcast:2 row_mask:0xf bank_mask:0xf
    v_and_b32_dpp v113, v69, v53 row_newbcast:2 row_mask:0xf bank_mask:0xf
    v_mul_u32_u24_dpp v114, v69, v52 row_newbcast:3 row_mask:0xf bank_mask:0xf
    v_and_b32_dpp v115, v69, v53 row_newbcast:3 row_mask:0xf bank_mask:0xf
    v_mul_u32_u24_dpp v116, v69, v52 row_newbcast:4 row_mask:0xf bank_mask:0xf
    v_and_b32_dpp v117, v69, v53 row_newbcast:4 row_mask:0xf bank_mask:0xf
    v_mul_u32_u24_dpp v118, v69, v52 row_newbcast:5 row_mask:0xf bank_mask:0xf
    v_and_b32_dpp v119, v69, v53 row_newbcast:5 row_mask:0xf bank_mask:0xf
    v_mul_u32_u24_dpp v120, v69, v52 row_newbcast:6 row_mask:0xf bank_mask:0xf
    v_and_b32_dpp v121, v69, v53 row_newbcast:6 row_mask:0xf bank_mask:0xf
    v_mul_u32_u24_dpp v122, v69, v52 row_newbcast:7 row_mask:0xf bank_mask:0xf
    v_and_b32_dpp v123, v69, v53 row_newbcast:7 row_mask:0xf bank_mask:0xf
    s_waitcnt vmcnt(0)
    v_bitop3_b32 v4, v127, v131, s4 bitop3:0x7e
    v_bitop3_b32 v4, v4, v135, s4 bitop3:0xf6
    v_bitop3_b32 v4, v4, v139, s4 bitop3:0xf6
    v_cmp_ne_u32 vcc, 0, v4
    s_cbranch_vccz TOK_42
POLL_43:
    s_mov_b32 s13, s19
    buffer_load_dwordx4 v[124:127], v24, s[32:35], s13 offen sc1
    s_add_u32 s13, s19, 8192
    buffer_load_dwordx4 v[128:131], v24, s[32:35], s13 offen sc1
    s_add_u32 s13, s19, 16384
    buffer_load_dwordx4 v[132:135], v24, s[32:35], s13 offen sc1
    s_add_u32 s13, s19, 24576
    buffer_load_dwordx4 v[136:139], v24, s[32:35], s13 offen sc1
    s_waitcnt vmcnt(0)
    v_bitop3_b32 v4, v127, v131, s4 bitop3:0x7e
    v_bitop3_b32 v4, v4, v135, s4 bitop3:0xf6
    v_bitop3_b32 v4, v4, v139, s4 bitop3:0xf6
    v_cmp_ne_u32 vcc, 0, v4
    s_cbranch_vccz PDONE_44
    s_add_u32 s5, s5, 1
    s_cmp_lt_u32 s5, 300000
    s_cbranch_scc1 POLL_43
PDONE_44:
TOK_42:
    s_lshl2_add_u32 s96, s74, s75
    s_lshl_b32 s97, s96, 11
    s_lshl_b32 s98, s3, 8
    s_add_u32 s99, s97, s98
    s_add_u32 s15, s99, 20971520
    v_lshlrev_b32 v24, 7, v1
    s_mov_b64 exec, 3
    buffer_load_dword v24, v24, s[32:35], s15 offen
    s_mov_b64 exec, -1
    v_pk_add_f32 v[124:125], v[124:125], v[128:129]
    v_pk_add_f32 v[132:133], v[132:133], v[136:137]
    v_add_f32 v126, v126, v130
    v_add_f32 v134, v134, v138
    v_pk_add_f32 v[124:125], v[124:125], v[132:133]
    v_add_f32 v126, v126, v134
    v_mov_b32 v127, v125
    s_nop 0
    v_permlane32_swap_b32 v124, v126
    v_permlane32_swap_b32 v125, v127
    v_add_f32 v124, v124, v126
    v_add_f32 v125, v125, v127
    s_nop 1
    v_permlane16_swap_b32 v124, v125
    v_add_f32 v127, v124, v125
    v_add_f32 v124, v124, v125
    s_nop 1
    v_permlane16_swap_b32 v124, v127
    v_mul_f32 v126, 0x3a800000, v124
    v_mul_f32 v124, 0x3a800000, v124
    s_nop 1
    v_permlane32_swap_b32 v124, v126
    v_fma_f32 v21, -v124, v124, v126
    v_cvt_pk_bf16_f32 v20, 0, v124
    v_max_f32 v21, 0, v21
    v_cvt_pk_bf16_f32 v21, 0, v21
    v_add_f32 v21, 0x3727c5ac, v21
    v_cvt_pk_bf16_f32 v21, 0, v21
    v_sqrt_f32 v21, v21
    s_nop 0
    v_cvt_pk_bf16_f32 v21, 0, v21
    s_lshl3_add_u32 s13, s3, 136192
    v_rcp_f32 v21, v21
    v_fma_f32 v127, -v20, v26, v127
    v_mov_b32 v5, s13
    v_mul_f32 v127, v127, v21
    ds_write_b64 v8, v[20:21]
    s_movk_i32 s13, 0xfff
    v_ashrrev_i32 v124, 31, v127
    v_or_b32 v124, 0x80000000, v124
    v_xor_b32 v124, v124, v127
    v_bfi_b32 v56, s13, v22, v124
    s_nop 1
    v_min_u32_dpp v57, v56, v56 row_ror:8 row_mask:0xf bank_mask:0xf
    v_max_u32_dpp v56, v56, v56 row_ror:8 row_mask:0xf bank_mask:0xf
    s_nop 1
    v_min_u32_dpp v58, v56, v56 row_ror:4 row_mask:0xf bank_mask:0xf
    v_max_u32_dpp v57, v57, v57 row_ror:4 row_mask:0xf bank_mask:0xf
    v_max_u32_dpp v56, v56, v56 row_ror:4 row_mask:0xf bank_mask:0xf
    v_max_u32 v57, v57, v58
    s_nop 0
    v_min_u32_dpp v58, v56, v56 row_ror:2 row_mask:0xf bank_mask:0xf
    v_max_u32_dpp v57, v57, v57 row_ror:2 row_mask:0xf bank_mask:0xf
    v_max_u32_dpp v56, v56, v56 row_ror:2 row_mask:0xf bank_mask:0xf
    v_max_u32 v57, v57, v58
    s_nop 0
    v_min_u32_dpp v58, v56, v56 row_ror:1 row_mask:0xf bank_mask:0xf
    v_max_u32_dpp v57, v57, v57 row_ror:1 row_mask:0xf bank_mask:0xf
    v_max_u32_dpp v56, v56, v56 row_ror:1 row_mask:0xf bank_mask:0xf
    v_max_u32 v57, v57, v58
    ds_write_b64 v5, v[56:57]
    v_and_b32 v6, 3, v1
    v_lshlrev_b32 v6, 18, v6
    v_bfe_u32 v9, v1, 2, 2
    v_lshl_add_u32 v6, v9, 13, v6
    s_and_b32 s96, s21, 1
    s_and_b32 s97, s12, 7
    s_lshr_b32 s98, s12, 3
    s_lshl3_add_u32 s99, s97, s98
    s_lshl_b32 s97, s99, 12
    s_lshr_b32 s98, s21, 1
    s_lshl_b32 s99, s98, 6
    s_add_u32 s98, s97, s99
    s_lshl4_add_u32 s97, s96, s98
    s_add_u32 s99, s97, 1048576
    s_add_u32 s14, s99, 2560
    s_waitcnt lgkmcnt(0)
    s_barrier
    ds_read_b64 v[56:57], v11
    ds_read_b64 v[20:21], v10
    s_waitcnt lgkmcnt(1)
    v_min_u32_dpp v58, v56, v56 quad_perm:[1,0,3,2] row_mask:0xf bank_mask:0xf
    v_max_u32_dpp v57, v57, v57 quad_perm:[1,0,3,2] row_mask:0xf bank_mask:0xf
    v_max_u32_dpp v56, v56, v56 quad_perm:[1,0,3,2] row_mask:0xf bank_mask:0xf
    v_max_u32 v57, v57, v58
    s_nop 0
    v_min_u32_dpp v58, v56, v56 quad_perm:[2,3,0,1] row_mask:0xf bank_mask:0xf
    v_max_u32_dpp v57, v57, v57 quad_perm:[2,3,0,1] row_mask:0xf bank_mask:0xf
    v_max_u32_dpp v56, v56, v56 quad_perm:[2,3,0,1] row_mask:0xf bank_mask:0xf
    v_max_u32 v57, v57, v58
    s_nop 0
    v_min_u32_dpp v58, v56, v56 row_half_mirror row_mask:0xf bank_mask:0xf
    v_max_u32_dpp v57, v57, v57 row_half_mirror row_mask:0xf bank_mask:0xf
    v_max_u32_dpp v56, v56, v56 row_half_mirror row_mask:0xf bank_mask:0xf
    v_max_u32 v57, v57, v58
    v_or_b32 v58, 1, v57
    v_mov_b32 v57, s4
    v_mov_b32 v59, s4
    s_cmp_lg_u32 s3, 0
    s_cbranch_scc1 L_NOF
    s_mov_b64 exec, 0xffff
    buffer_store_dwordx4 v[56:59], v6, s[32:35], s14 offen sc1
    s_mov_b64 exec, -1
L_NOF:
    s_cmp_lg_u32 s3, 1
    s_cbranch_scc1 L_NOC
    v_and_b32 v4, 16, v1
    v_cmp_eq_u32 vcc, 0, v4
    s_nop 1
    v_cndmask_b32 v4, v58, v56, vcc
    v_not_b32 v4, v4
    v_bfe_u32 v4, v4, 1, 7
    v_lshlrev_b32 v6, 3, v4
    v_mul_u32_u24 v4, 144, v4
    v_add_u32 v6, 135168, v6
    v_and_b32 v5, 15, v1
    v_lshlrev_b32 v5, 3, v5
    v_add_u32 v4, v4, v5
    ds_read_b64 v[128:129], v6
    ds_read_b64 v[124:125], v4 offset:0
    v_and_b32 v6, 15, v1
    v_lshlrev_b32 v6, 4, v6
    v_bfe_u32 v9, v1, 4, 1
    v_lshl_add_u32 v6, v9, 14, v6
    v_lshrrev_b32 v9, 5, v1
    v_lshl_add_u32 v6, v9, 12, v6
    v_bfe_u32 v7, v1, 4, 1
    v_lshlrev_b32 v7, 14, v7
    s_lshl_b32 s96, s21, 15
    s_lshl_b32 s97, s12, 8
    s_add_u32 s98, s96, s97
    s_add_u32 s13, s98, 33554432
    s_lshl_b32 s96, s21, 15
    s_lshl3_add_u32 s97, s12, s96
    s_add_u32 s98, s97, 8192
    s_add_u32 s16, s98, 33554432
    v_mov_b32 v127, s4
    s_waitcnt lgkmcnt(0)
    v_lshlrev_b32 v132, 16, v124
    v_and_b32 v133, s6, v124
    v_lshlrev_b32 v134, 16, v125
    v_and_b32 v135, s6, v125
    v_pk_add_f32 v[132:133], v[132:133], v[128:129] op_sel_hi:[1,0] neg_lo:[0,1] neg_hi:[0,1]
    v_pk_add_f32 v[134:135], v[134:135], v[128:129] op_sel_hi:[1,0] neg_lo:[0,1] neg_hi:[0,1]
    v_cvt_pk_bf16_f32 v132, 0, v132
    v_cvt_pk_bf16_f32 v133, 0, v133
    v_cvt_pk_bf16_f32 v134, 0, v134
    v_cvt_pk_bf16_f32 v135, 0, v135
    v_pk_mul_f32 v[132:133], v[132:133], v[128:129] op_sel:[0,1]
    v_pk_mul_f32 v[134:135], v[134:135], v[128:129] op_sel:[0,1]
    v_cvt_pk_bf16_f32 v132, 0, v132
    v_cvt_pk_bf16_f32 v133, 0, v133
    v_cvt_pk_bf16_f32 v134, 0, v134
    v_cvt_pk_bf16_f32 v135, 0, v135
    v_pk_mul_f32 v[132:133], v[132:133], v[144:145]
    v_pk_mul_f32 v[134:135], v[134:135], v[146:147]
    v_cvt_pk_bf16_f32 v132, 0, v132
    v_cvt_pk_bf16_f32 v133, 0, v133
    v_cvt_pk_bf16_f32 v134, 0, v134
    v_cvt_pk_bf16_f32 v135, 0, v135
    v_pk_add_f32 v[132:133], v[132:133], v[140:141]
    v_pk_add_f32 v[134:135], v[134:135], v[142:143]
    v_mov_b32 v126, v125
    v_mov_b32 v125, s4
    s_mov_b32 exec_hi, 0
    v_cvt_pk_bf16_f32 v124, v132, v133
    v_cvt_pk_bf16_f32 v126, v134, v135
    s_mov_b32 exec_hi, -1
    v_dot2_f32_bf16 v128, v124, v148, 0
    v_mov_b32 v129, s4
    v_dot2_f32_bf16 v128, v126, v149, v128
    buffer_store_dwordx4 v[124:127], v6, s[32:35], s13 offen sc1
    s_nop 1
    v_add_f32_dpp v128, v128, v128 quad_perm:[1,0,3,2] row_mask:0xf bank_mask:0xf
    s_nop 1
    v_add_f32_dpp v128, v128, v128 quad_perm:[2,3,0,1] row_mask:0xf bank_mask:0xf
    s_nop 1
    v_add_f32_dpp v128, v128, v128 row_half_mirror row_mask:0xf bank_mask:0xf
    s_nop 1
    v_add_f32_dpp v128, v128, v128 row_ror:8 row_mask:0xf bank_mask:0xf
    s_mov_b64 exec, 0x10001
    buffer_store_dwordx2 v[128:129], v7, s[32:35], s16 offen sc1
    s_mov_b64 exec, -1
L_NOC:
    s_waitcnt lgkmcnt(0)
    s_add_u32 s13, s81, 4096
    s_lshl2_add_u32 m0, s89, 99328
    s_nop 0
    buffer_load_dwordx4 v73, s[60:63], s13 offen nt lds
    s_add_u32 s13, s81, 8192
    s_lshl2_add_u32 m0, s89, 100352
    s_nop 0
    buffer_load_dwordx4 v73, s[60:63], s13 offen nt lds
    s_add_u32 s13, s81, 12288
    s_lshl2_add_u32 m0, s89, 101376
    s_nop 0
    buffer_load_dwordx4 v73, s[60:63], s13 offen nt lds
    s_load_dwordx8 s[24:31], s[32:33], s92 offset:2560 glc
    v_pk_add_f32 v[76:77], v[28:29], v[20:21] op_sel_hi:[1,0] neg_lo:[0,1] neg_hi:[0,1]
    v_pk_add_f32 v[78:79], v[30:31], v[20:21] op_sel_hi:[1,0] neg_lo:[0,1] neg_hi:[0,1]
    v_pk_add_f32 v[80:81], v[32:33], v[20:21] op_sel_hi:[1,0] neg_lo:[0,1] neg_hi:[0,1]
    v_pk_add_f32 v[82:83], v[34:35], v[20:21] op_sel_hi:[1,0] neg_lo:[0,1] neg_hi:[0,1]
    v_pk_add_f32 v[84:85], v[36:37], v[20:21] op_sel_hi:[1,0] neg_lo:[0,1] neg_hi:[0,1]
    v_pk_add_f32 v[86:87], v[38:39], v[20:21] op_sel_hi:[1,0] neg_lo:[0,1] neg_hi:[0,1]
    v_pk_add_f32 v[88:89], v[40:41], v[20:21] op_sel_hi:[1,0] neg_lo:[0,1] neg_hi:[0,1]
    v_pk_add_f32 v[90:91], v[42:43], v[20:21] op_sel_hi:[1,0] neg_lo:[0,1] neg_hi:[0,1]
    v_cvt_pk_bf16_f32 v76, 0, v76
    v_cvt_pk_bf16_f32 v77, 0, v77
    v_cvt_pk_bf16_f32 v78, 0, v78
    v_cvt_pk_bf16_f32 v79, 0, v79
    v_cvt_pk_bf16_f32 v80, 0, v80
    v_cvt_pk_bf16_f32 v81, 0, v81
    v_cvt_pk_bf16_f32 v82, 0, v82
    v_cvt_pk_bf16_f32 v83, 0, v83
    v_cvt_pk_bf16_f32 v84, 0, v84
    v_cvt_pk_bf16_f32 v85, 0, v85
    v_cvt_pk_bf16_f32 v86, 0, v86
    v_cvt_pk_bf16_f32 v87, 0, v87
    v_cvt_pk_bf16_f32 v88, 0, v88
    v_cvt_pk_bf16_f32 v89, 0, v89
    v_cvt_pk_bf16_f32 v90, 0, v90
    v_cvt_pk_bf16_f32 v91, 0, v91
    v_pk_mul_f32 v[76:77], v[76:77], v[20:21] op_sel:[0,1]
    v_pk_mul_f32 v[78:79], v[78:79], v[20:21] op_sel:[0,1]
    v_pk_mul_f32 v[80:81], v[80:81], v[20:21] op_sel:[0,1]
    v_pk_mul_f32 v[82:83], v[82:83], v[20:21] op_sel:[0,1]
    v_pk_mul_f32 v[84:85], v[84:85], v[20:21] op_sel:[0,1]
    v_pk_mul_f32 v[86:87], v[86:87], v[20:21] op_sel:[0,1]
    v_pk_mul_f32 v[88:89], v[88:89], v[20:21] op_sel:[0,1]
    v_pk_mul_f32 v[90:91], v[90:91], v[20:21] op_sel:[0,1]
    v_cvt_pk_bf16_f32 v76, 0, v76
    v_cvt_pk_bf16_f32 v77, 0, v77
    v_cvt_pk_bf16_f32 v78, 0, v78
    v_cvt_pk_bf16_f32 v79, 0, v79
    v_cvt_pk_bf16_f32 v80, 0, v80
    v_cvt_pk_bf16_f32 v81, 0, v81
    v_cvt_pk_bf16_f32 v82, 0, v82
    v_cvt_pk_bf16_f32 v83, 0, v83
    v_cvt_pk_bf16_f32 v84, 0, v84
    v_cvt_pk_bf16_f32 v85, 0, v85
    v_cvt_pk_bf16_f32 v86, 0, v86
    v_cvt_pk_bf16_f32 v87, 0, v87
    v_cvt_pk_bf16_f32 v88, 0, v88
    v_cvt_pk_bf16_f32 v89, 0, v89
    v_cvt_pk_bf16_f32 v90, 0, v90
    v_cvt_pk_bf16_f32 v91, 0, v91
    v_pk_mul_f32 v[76:77], v[76:77], v[108:109]
    v_pk_mul_f32 v[78:79], v[78:79], v[110:111]
    v_pk_mul_f32 v[80:81], v[80:81], v[112:113]
    v_pk_mul_f32 v[82:83], v[82:83], v[114:115]
    v_pk_mul_f32 v[84:85], v[84:85], v[116:117]
    v_pk_mul_f32 v[86:87], v[86:87], v[118:119]
    v_pk_mul_f32 v[88:89], v[88:89], v[120:121]
    v_pk_mul_f32 v[90:91], v[90:91], v[122:123]
    v_cvt_pk_bf16_f32 v76, 0, v76
    v_cvt_pk_bf16_f32 v77, 0, v77
    v_cvt_pk_bf16_f32 v78, 0, v78
    v_cvt_pk_bf16_f32 v79, 0, v79
    v_cvt_pk_bf16_f32 v80, 0, v80
    v_cvt_pk_bf16_f32 v81, 0, v81
    v_cvt_pk_bf16_f32 v82, 0, v82
    v_cvt_pk_bf16_f32 v83, 0, v83
    v_cvt_pk_bf16_f32 v84, 0, v84
    v_cvt_pk_bf16_f32 v85, 0, v85
    v_cvt_pk_bf16_f32 v86, 0, v86
    v_cvt_pk_bf16_f32 v87, 0, v87
    v_cvt_pk_bf16_f32 v88, 0, v88
    v_cvt_pk_bf16_f32 v89, 0, v89
    v_cvt_pk_bf16_f32 v90, 0, v90
    v_cvt_pk_bf16_f32 v91, 0, v91
    v_pk_add_f32 v[76:77], v[76:77], v[92:93]
    v_pk_add_f32 v[78:79], v[78:79], v[94:95]
    v_pk_add_f32 v[80:81], v[80:81], v[96:97]
    v_pk_add_f32 v[82:83], v[82:83], v[98:99]
    v_pk_add_f32 v[84:85], v[84:85], v[100:101]
    v_pk_add_f32 v[86:87], v[86:87], v[102:103]
    v_pk_add_f32 v[88:89], v[88:89], v[104:105]
    v_pk_add_f32 v[90:91], v[90:91], v[106:107]
    v_cvt_pk_bf16_f32 v76, 0, v76
    v_cvt_pk_bf16_f32 v77, 0, v77
    v_cvt_pk_bf16_f32 v78, 0, v78
    v_cvt_pk_bf16_f32 v79, 0, v79
    v_cvt_pk_bf16_f32 v80, 0, v80
    v_cvt_pk_bf16_f32 v81, 0, v81
    v_cvt_pk_bf16_f32 v82, 0, v82
    v_cvt_pk_bf16_f32 v83, 0, v83
    v_cvt_pk_bf16_f32 v84, 0, v84
    v_cvt_pk_bf16_f32 v85, 0, v85
    v_cvt_pk_bf16_f32 v86, 0, v86
    v_cvt_pk_bf16_f32 v87, 0, v87
    v_cvt_pk_bf16_f32 v88, 0, v88
    v_cvt_pk_bf16_f32 v89, 0, v89
    v_cvt_pk_bf16_f32 v90, 0, v90
    v_cvt_pk_bf16_f32 v91, 0, v91
    s_lshr_b32 s96, s3, 2
    s_lshl_b32 s97, s96, 15
    s_and_b32 s98, s3, 3
    s_lshl_b32 s99, s98, 5
    s_add_u32 s96, s97, s99
    s_add_u32 s13, s96, 32768
    v_lshrrev_b32 v54, 4, v1
    v_lshlrev_b32 v54, 13, v54
    v_bfe_u32 v9, v1, 2, 2
    v_lshl_add_u32 v54, v9, 7, v54
    v_bfe_u32 v9, v1, 3, 2
    v_lshl_add_u32 v54, v9, 5, v54
    v_and_b32 v9, 3, v1
    v_lshl_add_u32 v54, v9, 3, v54
    v_xor_b32 v54, s13, v54
    s_lshl_b32 s13, s3, 6
    v_bfe_u32 v55, v1, 2, 1
    v_lshlrev_b32 v55, 9, v55
    v_bfe_u32 v9, v1, 3, 1
    v_lshl_add_u32 v55, v9, 12, v55
    v_lshrrev_b32 v9, 5, v1
    v_lshl_add_u32 v55, v9, 11, v55
    v_bfe_u32 v9, v1, 2, 2
    v_lshl_add_u32 v55, v9, 6, v55
    v_bfe_u32 v9, v1, 4, 1
    v_lshl_add_u32 v55, v9, 5, v55
    v_and_b32 v9, 3, v1
    v_lshl_add_u32 v55, v9, 3, v55
    v_xor_b32 v55, s13, v55
    v_add_u32 v55, 98304, v55
    v_and_b32 v60, 7, v1
    v_lshlrev_b32 v60, 4, v60
    v_lshrrev_b32 v9, 4, v1
    v_lshl_add_u32 v60, v9, 7, v60
    v_add_u32 v60, 136704, v60
    s_lshl4_add_u32 s13, s3, 136256
    v_mov_b32 v4, s13
    v_and_b32 v5, 7, v1
    v_lshlrev_b32 v5, 4, v5
    v_add_u32 v5, 136256, v5
    v_and_b32 v8, 8, v1
    v_cmp_eq_u32 s[22:23], 0, v8
    s_branch SCHK_46
SPOLL_45:
    s_load_dwordx8 s[24:31], s[32:33], s92 offset:2560 glc
SCHK_46:
    s_add_u32 s5, s5, 1
    s_cmp_ge_u32 s5, 300000
    s_waitcnt lgkmcnt(0)
    s_cbranch_scc1 SDONE_47
    s_cmp_lg_u32 s25, s4
    s_cbranch_scc1 SPOLL_45
    s_cmp_lg_u32 s27, s4
    s_cbranch_scc1 SPOLL_45
    s_cmp_lg_u32 s29, s4
    s_cbranch_scc1 SPOLL_45
    s_cmp_lg_u32 s31, s4
    s_cbranch_scc1 SPOLL_45
SDONE_47:
    s_min_u32 s25, s24, s28
    s_max_u32 s24, s24, s28
    s_max_u32 s27, s26, s30
    s_min_u32 s26, s26, s30
    s_max_u32 s28, s25, s27
    s_min_u32 s25, s25, s27
    v_mov_b32 v140, s24
    v_mov_b32 v143, s26
    v_mov_b32 v141, s28
    v_mov_b32 v142, s25
    ds_write_b128 v4, v[140:143]
    s_waitcnt lgkmcnt(0)
    s_barrier
    s_cmp_lt_u32 s3, 4
    s_cbranch_scc1 L_CSEL
    ds_read_b64_tr_b16 v[156:157], v54
    ds_read_b64_tr_b16 v[158:159], v54 offset:512
    ds_read_b64_tr_b16 v[160:161], v54 offset:1024
    ds_read_b64_tr_b16 v[162:163], v54 offset:1536
    ds_read_b64_tr_b16 v[164:165], v54 offset:2048
    ds_read_b64_tr_b16 v[166:167], v54 offset:2560
    ds_read_b64_tr_b16 v[168:169], v54 offset:3072
    ds_read_b64_tr_b16 v[170:171], v54 offset:3584
    ds_read_b64_tr_b16 v[172:173], v54 offset:4096
    ds_read_b64_tr_b16 v[174:175], v54 offset:4608
    ds_read_b64_tr_b16 v[176:177], v54 offset:5120
    ds_read_b64_tr_b16 v[178:179], v54 offset:5632
    ds_read_b64_tr_b16 v[180:181], v54 offset:6144
    ds_read_b64_tr_b16 v[182:183], v54 offset:6656
    ds_read_b64_tr_b16 v[184:185], v54 offset:7168
    ds_read_b64_tr_b16 v[186:187], v54 offset:7680
    v_mul_u32_u24_dpp v92, v70, v52 row_newbcast:0 row_mask:0xf bank_mask:0xf
    v_and_b32_dpp v93, v70, v53 row_newbcast:0 row_mask:0xf bank_mask:0xf
    v_mul_u32_u24_dpp v94, v70, v52 row_newbcast:1 row_mask:0xf bank_mask:0xf
    v_and_b32_dpp v95, v70, v53 row_newbcast:1 row_mask:0xf bank_mask:0xf
    v_mul_u32_u24_dpp v96, v70, v52 row_newbcast:2 row_mask:0xf bank_mask:0xf
    v_and_b32_dpp v97, v70, v53 row_newbcast:2 row_mask:0xf bank_mask:0xf
    v_mul_u32_u24_dpp v98, v70, v52 row_newbcast:3 row_mask:0xf bank_mask:0xf
    v_and_b32_dpp v99, v70, v53 row_newbcast:3 row_mask:0xf bank_mask:0xf
    v_mul_u32_u24_dpp v100, v70, v52 row_newbcast:4 row_mask:0xf bank_mask:0xf
    v_and_b32_dpp v101, v70, v53 row_newbcast:4 row_mask:0xf bank_mask:0xf
    v_mul_u32_u24_dpp v102, v70, v52 row_newbcast:5 row_mask:0xf bank_mask:0xf
    v_and_b32_dpp v103, v70, v53 row_newbcast:5 row_mask:0xf bank_mask:0xf
    v_mul_u32_u24_dpp v104, v70, v52 row_newbcast:6 row_mask:0xf bank_mask:0xf
    v_and_b32_dpp v105, v70, v53 row_newbcast:6 row_mask:0xf bank_mask:0xf
    v_mul_u32_u24_dpp v106, v70, v52 row_newbcast:7 row_mask:0xf bank_mask:0xf
    v_and_b32_dpp v107, v70, v53 row_newbcast:7 row_mask:0xf bank_mask:0xf
    v_pk_mul_f32 v[76:77], v[76:77], v[92:93]
    v_pk_mul_f32 v[78:79], v[78:79], v[94:95]
    v_pk_mul_f32 v[80:81], v[80:81], v[96:97]
    v_pk_mul_f32 v[82:83], v[82:83], v[98:99]
    v_pk_mul_f32 v[84:85], v[84:85], v[100:101]
    v_pk_mul_f32 v[86:87], v[86:87], v[102:103]
    v_pk_mul_f32 v[88:89], v[88:89], v[104:105]
    v_pk_mul_f32 v[90:91], v[90:91], v[106:107]
    v_cvt_pk_bf16_f32 v76, 0, v76
    v_cvt_pk_bf16_f32 v77, 0, v77
    v_cvt_pk_bf16_f32 v78, 0, v78
    v_cvt_pk_bf16_f32 v79, 0, v79
    v_cvt_pk_bf16_f32 v80, 0, v80
    v_cvt_pk_bf16_f32 v81, 0, v81
    v_cvt_pk_bf16_f32 v82, 0, v82
    v_cvt_pk_bf16_f32 v83, 0, v83
    v_cvt_pk_bf16_f32 v84, 0, v84
    v_cvt_pk_bf16_f32 v85, 0, v85
    v_cvt_pk_bf16_f32 v86, 0, v86
    v_cvt_pk_bf16_f32 v87, 0, v87
    v_cvt_pk_bf16_f32 v88, 0, v88
    v_cvt_pk_bf16_f32 v89, 0, v89
    v_cvt_pk_bf16_f32 v90, 0, v90
    v_cvt_pk_bf16_f32 v91, 0, v91
    v_pk_add_f32 v[76:77], v[76:77], v[28:29]
    v_pk_add_f32 v[78:79], v[78:79], v[30:31]
    v_pk_add_f32 v[80:81], v[80:81], v[32:33]
    v_pk_add_f32 v[82:83], v[82:83], v[34:35]
    v_pk_add_f32 v[84:85], v[84:85], v[36:37]
    v_pk_add_f32 v[86:87], v[86:87], v[38:39]
    v_pk_add_f32 v[88:89], v[88:89], v[40:41]
    v_pk_add_f32 v[90:91], v[90:91], v[42:43]
    v_cvt_pk_bf16_f32 v44, v76, v77
    v_cvt_pk_bf16_f32 v45, v78, v79
    v_cvt_pk_bf16_f32 v46, v80, v81
    v_cvt_pk_bf16_f32 v47, v82, v83
    v_cvt_pk_bf16_f32 v48, v84, v85
    v_cvt_pk_bf16_f32 v49, v86, v87
    v_cvt_pk_bf16_f32 v50, v88, v89
    v_cvt_pk_bf16_f32 v51, v90, v91
    ds_write_b128 v23, v[44:47]
    ds_write_b128 v23, v[48:51] offset:16
    s_mul_i32 s96, s3, 2304
    s_add_u32 s16, s96, 139776
    v_lshrrev_b32 v23, 3, v1
    v_mul_u32_u24 v23, 144, v23
    v_and_b32 v9, 7, v1
    v_lshl_add_u32 v23, v9, 4, v23
    v_add_u32 v23, s16, v23
    s_branch L_CSELD
L_CSEL:
    ds_read_b128 v[140:143], v5
    s_lshl_b32 s96, s3, 9
    s_add_u32 s13, s96, 136704
    v_add_u32 v6, s13, v63
    s_lshl2_add_u32 s13, s3, 136384
    v_mov_b32 v7, s13
    s_waitcnt lgkmcnt(0)
    v_max_u32_dpp v144, v143, v140 quad_perm:[1,0,3,2] row_mask:0xf bank_mask:0xf
    v_max_u32_dpp v145, v142, v141 quad_perm:[1,0,3,2] row_mask:0xf bank_mask:0xf
    v_max_u32_dpp v146, v141, v142 quad_perm:[1,0,3,2] row_mask:0xf bank_mask:0xf
    v_max_u32_dpp v147, v140, v143 quad_perm:[1,0,3,2] row_mask:0xf bank_mask:0xf
    v_max_u32 v148, v144, v146
    v_max_u32 v149, v145, v147
    v_min_u32 v150, v144, v146
    v_min_u32 v151, v145, v147
    v_max_u32 v140, v148, v149
    v_min_u32 v141, v148, v149
    v_max_u32 v142, v150, v151
    v_min_u32 v143, v150, v151
    s_nop 1
    v_max_u32_dpp v144, v143, v140 quad_perm:[2,3,0,1] row_mask:0xf bank_mask:0xf
    v_max_u32_dpp v145, v142, v141 quad_perm:[2,3,0,1] row_mask:0xf bank_mask:0xf
    v_max_u32_dpp v146, v141, v142 quad_perm:[2,3,0,1] row_mask:0xf bank_mask:0xf
    v_max_u32_dpp v147, v140, v143 quad_perm:[2,3,0,1] row_mask:0xf bank_mask:0xf
    v_max_u32 v148, v144, v146
    v_max_u32 v149, v145, v147
    v_min_u32 v150, v144, v146
    v_min_u32 v151, v145, v147
    v_max_u32 v140, v148, v149
    v_min_u32 v141, v148, v149
    v_max_u32 v142, v150, v151
    v_min_u32 v143, v150, v151
    s_nop 1
    v_max_u32_dpp v144, v143, v140 row_half_mirror row_mask:0xf bank_mask:0xf
    v_max_u32_dpp v145, v142, v141 row_half_mirror row_mask:0xf bank_mask:0xf
    v_max_u32_dpp v146, v141, v142 row_half_mirror row_mask:0xf bank_mask:0xf
    v_max_u32_dpp v147, v140, v143 row_half_mirror row_mask:0xf bank_mask:0xf
    v_readfirstlane_b32 s24, v144
    v_readfirstlane_b32 s25, v145
    v_readfirstlane_b32 s26, v146
    v_readfirstlane_b32 s27, v147
    s_bitcmp1_b32 s3, 0
    s_cselect_b32 s24, s25, s24
    s_cselect_b32 s26, s27, s26
    s_bitcmp1_b32 s3, 1
    s_cselect_b32 s24, s26, s24
    s_and_b32 s15, s24, 4095
    s_lshr_b32 s96, s15, 8
    s_sub_u32 s97, 15, s96
    s_and_b32 s98, s15, 1
    s_lshl1_add_u32 s99, s97, s98
    s_lshl_b32 s96, s99, 14
    s_add_u32 s13, s96, 33554432
    s_lshl_b32 s96, s75, 10
    s_add_u32 s14, s96, s13
    s_add_u32 s13, s13, 8192
    v_and_b32 v10, 15, v1
    v_lshlrev_b32 v10, 3, v10
    buffer_load_dwordx2 v[144:145], v10, s[32:35], s13 offen sc1
    buffer_load_dwordx4 v[140:143], v2, s[32:35], s14 offen sc1
    ds_read_b64_tr_b16 v[156:157], v54
    ds_read_b64_tr_b16 v[158:159], v54 offset:512
    ds_read_b64_tr_b16 v[160:161], v54 offset:1024
    ds_read_b64_tr_b16 v[162:163], v54 offset:1536
    ds_read_b64_tr_b16 v[164:165], v54 offset:2048
    ds_read_b64_tr_b16 v[166:167], v54 offset:2560
    ds_read_b64_tr_b16 v[168:169], v54 offset:3072
    ds_read_b64_tr_b16 v[170:171], v54 offset:3584
    ds_read_b64_tr_b16 v[172:173], v54 offset:4096
    ds_read_b64_tr_b16 v[174:175], v54 offset:4608
    ds_read_b64_tr_b16 v[176:177], v54 offset:5120
    ds_read_b64_tr_b16 v[178:179], v54 offset:5632
    ds_read_b64_tr_b16 v[180:181], v54 offset:6144
    ds_read_b64_tr_b16 v[182:183], v54 offset:6656
    ds_read_b64_tr_b16 v[184:185], v54 offset:7168
    ds_read_b64_tr_b16 v[186:187], v54 offset:7680
    v_mul_u32_u24_dpp v92, v70, v52 row_newbcast:0 row_mask:0xf bank_mask:0xf
    v_and_b32_dpp v93, v70, v53 row_newbcast:0 row_mask:0xf bank_mask:0xf
    v_mul_u32_u24_dpp v94, v70, v52 row_newbcast:1 row_mask:0xf bank_mask:0xf
    v_and_b32_dpp v95, v70, v53 row_newbcast:1 row_mask:0xf bank_mask:0xf
    v_mul_u32_u24_dpp v96, v70, v52 row_newbcast:2 row_mask:0xf bank_mask:0xf
    v_and_b32_dpp v97, v70, v53 row_newbcast:2 row_mask:0xf bank_mask:0xf
    v_mul_u32_u24_dpp v98, v70, v52 row_newbcast:3 row_mask:0xf bank_mask:0xf
    v_and_b32_dpp v99, v70, v53 row_newbcast:3 row_mask:0xf bank_mask:0xf
    v_mul_u32_u24_dpp v100, v70, v52 row_newbcast:4 row_mask:0xf bank_mask:0xf
    v_and_b32_dpp v101, v70, v53 row_newbcast:4 row_mask:0xf bank_mask:0xf
    v_mul_u32_u24_dpp v102, v70, v52 row_newbcast:5 row_mask:0xf bank_mask:0xf
    v_and_b32_dpp v103, v70, v53 row_newbcast:5 row_mask:0xf bank_mask:0xf
    v_mul_u32_u24_dpp v104, v70, v52 row_newbcast:6 row_mask:0xf bank_mask:0xf
    v_and_b32_dpp v105, v70, v53 row_newbcast:6 row_mask:0xf bank_mask:0xf
    v_mul_u32_u24_dpp v106, v70, v52 row_newbcast:7 row_mask:0xf bank_mask:0xf
    v_and_b32_dpp v107, v70, v53 row_newbcast:7 row_mask:0xf bank_mask:0xf
    v_pk_mul_f32 v[76:77], v[76:77], v[92:93]
    v_pk_mul_f32 v[78:79], v[78:79], v[94:95]
    v_pk_mul_f32 v[80:81], v[80:81], v[96:97]
    v_pk_mul_f32 v[82:83], v[82:83], v[98:99]
    v_pk_mul_f32 v[84:85], v[84:85], v[100:101]
    v_pk_mul_f32 v[86:87], v[86:87], v[102:103]
    v_pk_mul_f32 v[88:89], v[88:89], v[104:105]
    v_pk_mul_f32 v[90:91], v[90:91], v[106:107]
    v_cvt_pk_bf16_f32 v76, 0, v76
    v_cvt_pk_bf16_f32 v77, 0, v77
    v_cvt_pk_bf16_f32 v78, 0, v78
    v_cvt_pk_bf16_f32 v79, 0, v79
    v_cvt_pk_bf16_f32 v80, 0, v80
    v_cvt_pk_bf16_f32 v81, 0, v81
    v_cvt_pk_bf16_f32 v82, 0, v82
    v_cvt_pk_bf16_f32 v83, 0, v83
    v_cvt_pk_bf16_f32 v84, 0, v84
    v_cvt_pk_bf16_f32 v85, 0, v85
    v_cvt_pk_bf16_f32 v86, 0, v86
    v_cvt_pk_bf16_f32 v87, 0, v87
    v_cvt_pk_bf16_f32 v88, 0, v88
    v_cvt_pk_bf16_f32 v89, 0, v89
    v_cvt_pk_bf16_f32 v90, 0, v90
    v_cvt_pk_bf16_f32 v91, 0, v91
    v_pk_add_f32 v[76:77], v[76:77], v[28:29]
    v_pk_add_f32 v[78:79], v[78:79], v[30:31]
    v_pk_add_f32 v[80:81], v[80:81], v[32:33]
    v_pk_add_f32 v[82:83], v[82:83], v[34:35]
    v_pk_add_f32 v[84:85], v[84:85], v[36:37]
    v_pk_add_f32 v[86:87], v[86:87], v[38:39]
    v_pk_add_f32 v[88:89], v[88:89], v[40:41]
    v_pk_add_f32 v[90:91], v[90:91], v[42:43]
    v_cvt_pk_bf16_f32 v44, v76, v77
    v_cvt_pk_bf16_f32 v45, v78, v79
    v_cvt_pk_bf16_f32 v46, v80, v81
    v_cvt_pk_bf16_f32 v47, v82, v83
    v_cvt_pk_bf16_f32 v48, v84, v85
    v_cvt_pk_bf16_f32 v49, v86, v87
    v_cvt_pk_bf16_f32 v50, v88, v89
    v_cvt_pk_bf16_f32 v51, v90, v91
    ds_write_b128 v23, v[44:47]
    ds_write_b128 v23, v[48:51] offset:16
    s_mul_i32 s96, s3, 2304
    s_add_u32 s16, s96, 139776
    v_lshrrev_b32 v23, 3, v1
    v_mul_u32_u24 v23, 144, v23
    v_and_b32 v9, 7, v1
    v_lshl_add_u32 v23, v9, 4, v23
    v_add_u32 v23, s16, v23
    s_lshl2_add_u32 s15, s15, s3
    s_waitcnt vmcnt(0)
    v_bitop3_b32 v8, v141, v143, s4 bitop3:0x7e
    v_bitop3_b32 v8, v8, v145, s4 bitop3:0xf6
    v_cmp_ne_u32 vcc, 0, v8
    s_cbranch_vccz TOK_49
POLL_50:
    buffer_load_dwordx2 v[144:145], v10, s[32:35], s13 offen sc1
    buffer_load_dwordx4 v[140:143], v2, s[32:35], s14 offen sc1
    s_waitcnt vmcnt(0)
    v_bitop3_b32 v8, v141, v143, s4 bitop3:0x7e
    v_bitop3_b32 v8, v8, v145, s4 bitop3:0xf6
    v_cmp_ne_u32 vcc, 0, v8
    s_cbranch_vccz PDONE_51
    s_add_u32 s5, s5, 1
    s_cmp_lt_u32 s5, 300000
    s_cbranch_scc1 POLL_50
PDONE_51:
TOK_49:
    ds_write2_b32 v6, v140, v142 offset0:0 offset1:1
    v_add_f32_dpp v144, v144, v144 quad_perm:[1,0,3,2] row_mask:0xf bank_mask:0xf
    s_nop 1
    v_add_f32_dpp v144, v144, v144 quad_perm:[2,3,0,1] row_mask:0xf bank_mask:0xf
    s_nop 1
    v_add_f32_dpp v144, v144, v144 row_half_mirror row_mask:0xf bank_mask:0xf
    s_nop 1
    v_add_f32_dpp v144, v144, v144 row_ror:8 row_mask:0xf bank_mask:0xf
    v_cvt_pk_bf16_f32 v144, 0, v144
    v_ashrrev_i32 v145, 31, v144
    v_or_b32 v145, 0x80000000, v145
    v_xor_b32 v144, v144, v145
    v_and_b32 v144, s6, v144
    v_or_b32 v144, s15, v144
    ds_write_b32 v7, v144
L_CSELD:
    v_mov_b32 v4, 136384
    v_and_b32 v8, 15, v1
    v_lshlrev_b32 v8, 4, v8
    v_lshrrev_b32 v9, 5, v1
    v_lshl_add_u32 v8, v9, 3, v8
    s_lshl_b32 s96, s74, 13
    s_add_u32 s14, s96, 20971520
    s_lshl3_add_u32 s96, s75, s3
    s_lshl_b32 s97, s96, 8
    s_add_u32 s20, s97, s14
    s_waitcnt lgkmcnt(0)
    s_barrier
    ds_read_b128 v[140:143], v4
    s_waitcnt lgkmcnt(0)
    v_max_u32 v144, v140, v141
    v_max_u32 v145, v142, v143
    v_min_u32 v146, v140, v141
    v_min_u32 v147, v142, v143
    v_min_u32 v141, v144, v145
    v_max_u32 v140, v144, v145
    v_max3_u32 v141, v141, v146, v147
    v_cndmask_b32 v4, v141, v140, s[22:23]
    v_readfirstlane_b32 s68, v140
    v_and_b32 v4, 3, v4
    v_readfirstlane_b32 s69, v141
    v_lshl_add_u32 v4, v4, 9, v60
    ds_read_b128 v[144:147], v4
    ds_read_b128 v[44:47], v23
    ds_read_b128 v[48:51], v23 offset:1152
    s_bfe_u32 s70, s68, 720899
    s_bfe_u32 s71, s69, 720899
    s_sub_u32 s70, 2047, s70
    s_sub_u32 s71, 2047, s71
    s_waitcnt lgkmcnt(2)
    v_mfma_f32_16x16x32_bf16 v[204:207], v[144:147], v[156:159], 0
    v_mfma_f32_16x16x32_bf16 v[208:211], v[144:147], v[160:163], 0
    v_mfma_f32_16x16x32_bf16 v[212:215], v[144:147], v[164:167], 0
    v_mfma_f32_16x16x32_bf16 v[216:219], v[144:147], v[168:171], 0
    v_mfma_f32_16x16x32_bf16 v[220:223], v[144:147], v[172:175], 0
    v_mfma_f32_16x16x32_bf16 v[224:227], v[144:147], v[176:179], 0
    v_mfma_f32_16x16x32_bf16 v[228:231], v[144:147], v[180:183], 0
    v_mfma_f32_16x16x32_bf16 v[232:235], v[144:147], v[184:187], 0
    s_nop 1
    v_add_f32 v140, v204, v209
    s_nop 0
    v_add_f32 v141, v214, v219
    s_nop 0
    v_add_f32 v142, v220, v225
    s_nop 0
    v_add_f32 v143, v230, v235
    v_add_f32 v140, v140, v141
    v_add_f32 v142, v142, v143
    v_mov_b32 v141, s4
    s_nop 0
    v_permlane16_swap_b32 v142, v143
    s_cmp_ge_u32 s9, 28
    s_cbranch_scc1 L_NOHP
    v_add_f32 v140, v140, v143
    s_mov_b32 exec_lo, 0xffff
    s_mov_b32 exec_hi, 0xffff
    s_cmp_lg_u32 s93, 0
    s_cbranch_scc1 LOC_52
    buffer_store_dwordx2 v[140:141], v8, s[32:35], s20 offen sc1
    s_branch LOCD_53
LOC_52:
    buffer_store_dwordx2 v[140:141], v8, s[32:35], s20 offen
LOCD_53:
    s_mov_b64 exec, -1
L_NOHP:
    v_mov_b32 v72, v140
    v_mov_b32 v73, v141
    v_add_u32 v74, s20, v8
    s_waitcnt lgkmcnt(0)
    s_bitcmp1_b32 s21, 2
    s_cselect_b32 s17, s71, s70
    s_cselect_b32 s18, s69, s68
    s_cmp_lg_u32 s3, 7
    s_cbranch_scc1 L_NOFZ
    s_cmp_lg_u32 s2, 0
    s_cbranch_scc1 L_NONON
    v_mov_b32 v6, s4
    s_mov_b64 exec, 1
    buffer_store_dword v6, v3, s[32:35], 0 offen sc1
    s_mov_b64 exec, -1
L_NONON:
    s_lshr_b32 s96, s21, 3
    s_and_b32 s97, s21, 1
    s_lshl1_add_u32 s19, s96, s97
    s_lshr_b32 s96, s21, 2
    s_lshl_b32 s97, s96, 1
    s_lshl3_add_u32 s98, s12, s97
    s_and_b32 s99, s21, 1
    s_add_u32 s96, s98, s99
    s_mul_i32 s97, s96, 7168
    s_add_u32 s20, s97, 22020096
    s_lshl_b32 s96, s17, 11
    s_lshl_b32 s97, s12, 7
    s_add_u32 s98, s96, s97
    s_lshl_b32 s99, s19, 5
    s_add_u32 s82, s98, s99
    v_and_b32 v10, 7, v1
    v_lshlrev_b32 v10, 2, v10
    s_lshl_b32 s96, s19, 5
    s_add_u32 s13, s96, 139264
    v_add_u32 v5, s13, v10
    ds_read_b32 v238, v5
    s_lshr_b32 s96, s17, 7
    s_bfe_u32 s97, s18, 65538
    s_lshl1_add_u32 s98, s96, s97
    s_lshl_b32 s99, s98, 14
    s_lshl_b32 s96, s12, 8
    s_add_u32 s97, s99, s96
    s_lshl_b32 s98, s19, 6
    s_add_u32 s99, s97, s98
    s_add_u32 s68, s99, 33554432
    s_add_u32 s69, s68, 4096
    v_and_b32 v11, 7, v1
    v_lshlrev_b32 v11, 3, v11
    buffer_load_dwordx2 v[20:21], v11, s[32:35], s68 offen sc1
    buffer_load_dwordx2 v[236:237], v11, s[32:35], s69 offen sc1
    s_and_b32 s13, s18, s6
    s_ashr_i32 s15, s13, 31
    s_andn2_b32 s15, 0x7fff0000, s15
    s_or_b32 s15, s15, 0x80000000
    s_xor_b32 s13, s13, s15
    v_mov_b32 v239, s13
    v_mul_f32 v239, s7, v239
    v_exp_f32 v239, -v239
    s_nop 0
    v_add_f32 v239, 1.0, v239
    v_rcp_f32 v239, v239
    s_nop 0
    v_cvt_pk_bf16_f32 v239, 0, v239
L_NOFZ:
    s_cmp_lt_u32 s9, 28
    s_cbranch_scc1 L_HSEC
    s_branch L_GSEC
L_HSEC:
    s_cmp_lt_u32 s3, 4
    s_cbranch_scc1 L_HW
    s_branch L_NOH
L_HW:
    s_lshl_b32 s96, s3, 8
    s_add_u32 s13, s96, s14
    v_lshrrev_b32 v4, 4, v1
    v_lshlrev_b32 v4, 11, v4
    v_and_b32 v9, 15, v1
    v_lshl_add_u32 v4, v9, 4, v4
    s_lshl_b32 s96, s3, 5
    s_add_u32 s15, s96, 138752
    v_lshrrev_b32 v5, 5, v1
    v_lshl_add_u32 v5, v5, 7, s15
    v_bfe_u32 v9, v1, 2, 1
    v_lshl_add_u32 v5, v9, 4, v5
    v_bfe_u32 v9, v1, 1, 1
    v_lshl_add_u32 v5, v9, 3, v5
    v_bfe_u32 v9, v1, 3, 1
    v_lshl_add_u32 v5, v9, 2, v5
    v_and_b32 v9, 1, v1
    v_lshl_add_u32 v5, v9, 1, v5
    s_cmp_lg_u32 s93, 0
    s_cbranch_scc1 L_HLOC
SPOLL_54:
    s_load_dword s24, s[32:33], s13 offset:1276 glc
    s_load_dword s25, s[32:33], s13 offset:3324 glc
    s_load_dword s26, s[32:33], s13 offset:5372 glc
    s_load_dword s27, s[32:33], s13 offset:7420 glc
SCHK_55:
    s_add_u32 s5, s5, 1
    s_cmp_ge_u32 s5, 300000
    s_waitcnt lgkmcnt(0)
    s_cbranch_scc1 SDONE_56
    s_cmp_lg_u32 s24, s4
    s_cbranch_scc1 SPOLL_54
    s_cmp_lg_u32 s25, s4
    s_cbranch_scc1 SPOLL_54
    s_cmp_lg_u32 s26, s4
    s_cbranch_scc1 SPOLL_54
    s_cmp_lg_u32 s27, s4
    s_cbranch_scc1 SPOLL_54
SDONE_56:
L_HLOC:
    buffer_load_dwordx4 v[204:207], v4, s[32:35], s13 offen sc1
    buffer_load_dwordx4 v[208:211], v4, s[32:35], s13 offen offset:1024 sc1
    s_waitcnt vmcnt(0)
    v_bitop3_b32 v6, v205, v207, s4 bitop3:0x7e
    v_bitop3_b32 v6, v6, v209, s4 bitop3:0xf6
    v_bitop3_b32 v6, v6, v211, s4 bitop3:0xf6
    v_cmp_ne_u32 vcc, 0, v6
    s_cbranch_vccz TOK_58
POLL_59:
    buffer_load_dwordx4 v[204:207], v4, s[32:35], s13 offen sc1
    buffer_load_dwordx4 v[208:211], v4, s[32:35], s13 offen offset:1024 sc1
    s_waitcnt vmcnt(0)
    v_bitop3_b32 v6, v205, v207, s4 bitop3:0x7e
    v_bitop3_b32 v6, v6, v209, s4 bitop3:0xf6
    v_bitop3_b32 v6, v6, v211, s4 bitop3:0xf6
    v_cmp_ne_u32 vcc, 0, v6
    s_cbranch_vccz PDONE_60
    s_add_u32 s5, s5, 1
    s_cmp_lt_u32 s5, 300000
    s_cbranch_scc1 POLL_59
PDONE_60:
TOK_58:
    v_permlane32_swap_b32 v204, v206
    v_permlane32_swap_b32 v208, v210
    v_add_f32 v204, v204, v206
    v_add_f32 v208, v208, v210
    v_mov_b32 v206, v204
    v_mov_b32 v210, v208
    s_nop 0
    v_permlane16_swap_b32 v204, v206
    v_permlane16_swap_b32 v208, v210
    v_add_f32 v204, v204, v206
    v_add_f32 v208, v208, v210
    v_cvt_pk_bf16_f32 v204, 0, v204
    v_cvt_pk_bf16_f32 v208, 0, v208
    v_mul_f32 v6, s7, v204
    v_exp_f32 v6, -v6
    s_nop 0
    v_add_f32 v6, 1.0, v6
    v_rcp_f32 v6, v6
    s_nop 0
    v_mul_f32 v204, v204, v6
    v_cvt_pk_bf16_f32 v204, 0, v204
    v_mul_f32 v204, v204, v208
    v_cvt_pk_bf16_f32 v204, v204, v204
    ds_write_b16 v5, v204
L_NOH:
    v_bfe_u32 v4, v1, 2, 1
    v_lshlrev_b32 v4, 7, v4
    v_lshrrev_b32 v9, 5, v1
    v_lshl_add_u32 v4, v9, 4, v4
    v_add_u32 v4, 138752, v4
    v_lshrrev_b32 v5, 4, v1
    v_mul_u32_u24 v5, 7168, v5
    v_and_b32 v9, 15, v1
    v_lshl_add_u32 v5, v9, 3, v5
    v_and_b32 v6, 1, v1
    v_lshlrev_b32 v6, 18, v6
    v_bfe_u32 v9, v1, 1, 1
    v_lshl_add_u32 v6, v9, 13, v6
    s_lshl3_add_u32 s96, s75, s3
    s_mul_i32 s97, s96, 28672
    s_lshl_b32 s98, s74, 7
    s_add_u32 s99, s97, s98
    s_add_u32 s13, s99, 22020096
    s_lshr_b32 s96, s9, 2
    s_and_b32 s97, s75, 1
    s_lshr_b32 s98, s3, 1
    s_lshl2_add_u32 s99, s97, s98
    s_and_b32 s97, s3, 1
    s_lshl_b32 s98, s97, 2
    s_lshl3_add_u32 s97, s99, s98
    s_lshr_b32 s99, s75, 1
    s_add_u32 s98, s97, s99
    s_lshl_b32 s97, s98, 12
    s_lshl_b32 s99, s8, 6
    s_add_u32 s98, s97, s99
    s_lshl2_add_u32 s97, s96, s98
    s_add_u32 s99, s97, 1048576
    s_add_u32 s14, s99, 3072
    s_waitcnt vmcnt(0)
    s_waitcnt lgkmcnt(0)
    s_barrier
    ds_read_b128 v[204:207], v4
    ds_read_b64_tr_b16 v[188:189], v55
    ds_read_b64_tr_b16 v[190:191], v55 offset:1024
    ds_read_b128 v[208:211], v4 offset:32
    ds_read_b64_tr_b16 v[192:193], v55 offset:8192
    ds_read_b64_tr_b16 v[194:195], v55 offset:9216
    ds_read_b128 v[212:215], v4 offset:64
    ds_read_b64_tr_b16 v[196:197], v55 offset:16384
    ds_read_b64_tr_b16 v[198:199], v55 offset:17408
    ds_read_b128 v[216:219], v4 offset:96
    ds_read_b64_tr_b16 v[200:201], v55 offset:24576
    ds_read_b64_tr_b16 v[202:203], v55 offset:25600
    s_waitcnt lgkmcnt(9)
    v_mfma_f32_32x32x16_bf16 v[220:235], v[204:207], v[188:191], 0
    s_waitcnt lgkmcnt(6)
    v_mfma_f32_32x32x16_bf16 v[220:235], v[208:211], v[192:195], v[220:235]
    s_waitcnt lgkmcnt(3)
    v_mfma_f32_32x32x16_bf16 v[220:235], v[212:215], v[196:199], v[220:235]
    s_waitcnt lgkmcnt(0)
    v_mfma_f32_32x32x16_bf16 v[220:235], v[216:219], v[200:203], v[220:235]
    s_nop 11
    v_mov_b32 v221, s4
    buffer_store_dwordx2 v[220:221], v5, s[32:35], s13 offen sc1
    s_mov_b64 exec, 15
    buffer_store_dword v221, v6, s[32:35], s14 offen sc1
    s_mov_b64 exec, -1
    s_waitcnt lgkmcnt(0)
L_GSEC:
    s_lshl_b32 s96, s21, 7
    s_lshl4_add_u32 s13, s3, s96
    v_lshrrev_b32 v22, 3, v1
    v_lshl_add_u32 v22, v22, 0, s13
    s_lshl_b32 s96, s13, 11
    s_lshl_b32 s97, s12, 7
    s_add_u32 s15, s96, s97
    s_add_u32 s16, s15, 16384
    v_lshrrev_b32 v25, 3, v1
    v_lshlrev_b32 v25, 11, v25
    v_and_b32 v9, 7, v1
    v_lshl_add_u32 v25, v9, 4, v25
    v_cmp_ne_u32 vcc, s70, v22
    v_cmp_ne_u32 s[22:23], s71, v22
    s_nop 0
    s_and_b64 exec, vcc, s[22:23]
    buffer_store_dwordx4 v[44:47], v25, s[64:67], s15 offen sc1
    s_mov_b64 exec, -1
    v_add_u32 v22, 8, v22
    v_cmp_ne_u32 vcc, s70, v22
    v_cmp_ne_u32 s[22:23], s71, v22
    s_nop 0
    s_and_b64 exec, vcc, s[22:23]
    buffer_store_dwordx4 v[48:51], v25, s[64:67], s16 offen sc1
    s_mov_b64 exec, -1
    s_cmp_lt_u32 s9, 16
    s_cbranch_scc1 L_GF
    s_cmp_ge_u32 s9, 28
    s_cbranch_scc1 L_FIN
    s_waitcnt vmcnt(0)
    s_mov_b32 exec_lo, 0xffff
    s_mov_b32 exec_hi, 0xffff
    buffer_store_dwordx2 v[72:73], v74, s[32:35], 0 offen sc1
    s_mov_b64 exec, -1
    s_branch L_FIN
L_GF:
SPOLL_61:
    s_load_dwordx8 s[24:31], s[32:33], s92 offset:3072 glc
SCHK_62:
    s_add_u32 s5, s5, 1
    s_cmp_ge_u32 s5, 300000
    s_waitcnt lgkmcnt(0)
    s_cbranch_scc1 SDONE_63
    s_cmp_lg_u32 s24, s4
    s_cbranch_scc1 SPOLL_61
    s_cmp_lg_u32 s25, s4
    s_cbranch_scc1 SPOLL_61
    s_cmp_lg_u32 s26, s4
    s_cbranch_scc1 SPOLL_61
    s_cmp_lg_u32 s27, s4
    s_cbranch_scc1 SPOLL_61
    s_cmp_lg_u32 s28, s4
    s_cbranch_scc1 SPOLL_61
    s_cmp_lg_u32 s29, s4
    s_cbranch_scc1 SPOLL_61
    s_cmp_lg_u32 s30, s4
    s_cbranch_scc1 SPOLL_61
SDONE_63:
    s_barrier
    s_cmp_eq_u32 s3, 7
    s_cbranch_scc1 L_G7
    s_barrier
    s_mov_b32 exec_lo, 0xffff
    s_mov_b32 exec_hi, 0xffff
    buffer_store_dwordx2 v[72:73], v74, s[32:35], 0 offen sc1
    s_mov_b64 exec, -1
    s_branch L_FIN
L_G7:
    s_cmp_lg_u32 s3, 7
    s_cbranch_scc1 L_FIN
    s_add_u32 s13, s20, 4096
POLL_64:
    buffer_load_dwordx4 v[204:207], v2, s[32:35], s20 offen sc1
    buffer_load_dwordx4 v[208:211], v2, s[32:35], s20 offen offset:1024 sc1
    buffer_load_dwordx4 v[212:215], v2, s[32:35], s20 offen offset:2048 sc1
    buffer_load_dwordx4 v[216:219], v2, s[32:35], s20 offen offset:3072 sc1
    buffer_load_dwordx4 v[140:143], v2, s[32:35], s13 offen sc1
    buffer_load_dwordx4 v[144:147], v2, s[32:35], s13 offen offset:1024 sc1
    buffer_load_dwordx4 v[148:151], v2, s[32:35], s13 offen offset:2048 sc1
    s_waitcnt vmcnt(0)
    v_bitop3_b32 v4, v205, v207, s4 bitop3:0x7e
    v_bitop3_b32 v4, v4, v209, s4 bitop3:0xf6
    v_bitop3_b32 v4, v4, v211, s4 bitop3:0xf6
    v_bitop3_b32 v4, v4, v213, s4 bitop3:0xf6
    v_bitop3_b32 v4, v4, v215, s4 bitop3:0xf6
    v_bitop3_b32 v4, v4, v217, s4 bitop3:0xf6
    v_bitop3_b32 v4, v4, v219, s4 bitop3:0xf6
    v_bitop3_b32 v4, v4, v141, s4 bitop3:0xf6
    v_bitop3_b32 v4, v4, v143, s4 bitop3:0xf6
    v_bitop3_b32 v4, v4, v145, s4 bitop3:0xf6
    v_bitop3_b32 v4, v4, v147, s4 bitop3:0xf6
    v_bitop3_b32 v4, v4, v149, s4 bitop3:0xf6
    v_bitop3_b32 v4, v4, v151, s4 bitop3:0xf6
    v_cmp_ne_u32 vcc, 0, v4
    s_cbranch_vccz PDONE_65
    s_add_u32 s5, s5, 1
    s_cmp_lt_u32 s5, 300000
    s_cbranch_scc1 POLL_64
PDONE_65:
    v_bitop3_b32 v4, v21, v237, s4 bitop3:0x7e
    v_cmp_ne_u32 vcc, 0, v4
    s_cbranch_vccz TOK_66
POLL_67:
    buffer_load_dwordx2 v[20:21], v11, s[32:35], s68 offen sc1
    buffer_load_dwordx2 v[236:237], v11, s[32:35], s69 offen sc1
    s_waitcnt vmcnt(0)
    v_bitop3_b32 v4, v21, v237, s4 bitop3:0x7e
    v_cmp_ne_u32 vcc, 0, v4
    s_cbranch_vccz PDONE_68
    s_add_u32 s5, s5, 1
    s_cmp_lt_u32 s5, 300000
    s_cbranch_scc1 POLL_67
PDONE_68:
TOK_66:
    s_barrier
    v_add_f32 v204, v204, v208
    v_add_f32 v206, v206, v210
    v_add_f32 v204, v204, v212
    v_add_f32 v206, v206, v214
    v_add_f32 v204, v204, v216
    v_add_f32 v206, v206, v218
    v_add_f32 v204, v204, v140
    v_add_f32 v206, v206, v142
    v_add_f32 v204, v204, v144
    v_add_f32 v206, v206, v146
    v_add_f32 v204, v204, v148
    v_add_f32 v206, v206, v150
    v_mov_b32 v205, v206
    v_add_f32_dpp v204, v204, v204 row_ror:8 row_mask:0xf bank_mask:0xf
    s_nop 0
    v_add_f32_dpp v205, v205, v205 row_ror:8 row_mask:0xf bank_mask:0xf
    v_mov_b32 v206, v204
    v_mov_b32 v207, v205
    s_nop 0
    v_permlane16_swap_b32 v204, v206
    v_permlane16_swap_b32 v205, v207
    v_pk_add_f32 v[204:205], v[204:205], v[206:207]
    v_mov_b32 v206, v204
    v_mov_b32 v207, v205
    s_nop 0
    v_permlane32_swap_b32 v204, v206
    v_permlane32_swap_b32 v205, v207
    v_pk_add_f32 v[204:205], v[204:205], v[206:207]
    v_cvt_pk_bf16_f32 v204, 0, v204
    v_cvt_pk_bf16_f32 v205, 0, v205
    v_pk_mul_f32 v[204:205], v[204:205], v[238:239] op_sel:[0,1]
    v_lshlrev_b32 v4, 16, v20
    v_and_b32 v5, s6, v20
    v_cvt_pk_bf16_f32 v204, 0, v204
    v_cvt_pk_bf16_f32 v205, 0, v205
    v_pk_add_f32 v[204:205], v[204:205], v[4:5]
    v_lshlrev_b32 v4, 16, v238
    v_and_b32 v5, s6, v238
    v_cvt_pk_bf16_f32 v204, 0, v204
    v_cvt_pk_bf16_f32 v205, 0, v205
    v_pk_mul_f32 v[204:205], v[204:205], v[4:5]
    v_lshlrev_b32 v4, 16, v236
    v_and_b32 v5, s6, v236
    v_cvt_pk_bf16_f32 v204, 0, v204
    v_cvt_pk_bf16_f32 v205, 0, v205
    v_pk_add_f32 v[204:205], v[204:205], v[4:5]
    v_cvt_pk_bf16_f32 v204, v204, v205
    s_mov_b64 exec, 0xff
    buffer_store_dword v204, v10, s[64:67], s82 offen sc1
    s_mov_b64 exec, -1
    s_mov_b32 exec_lo, 0xffff
    s_mov_b32 exec_hi, 0xffff
    buffer_store_dwordx2 v[72:73], v74, s[32:35], 0 offen sc1
    s_mov_b64 exec, -1
L_FIN:
L_END:
    s_endpgm
.p2align 10
.fill 768, 4, 0xbf800000
.section .rodata,"a"
.p2align 6
.amdhsa_kernel adaLN_cond__linear_kernel_hedgehog__moe_arch_mod__prompt_kernel
  .amdhsa_next_free_vgpr 256
  .amdhsa_next_free_sgpr 102
  .amdhsa_accum_offset 256
  .amdhsa_group_segment_fixed_size 0
  .amdhsa_kernarg_size 112
  .amdhsa_user_sgpr_count 2
  .amdhsa_user_sgpr_kernarg_segment_ptr 1
  .amdhsa_system_sgpr_workgroup_id_x 1
  .amdhsa_float_denorm_mode_32 3
  .amdhsa_float_denorm_mode_16_64 3
.end_amdhsa_kernel
```

```asm
; @launch grid=(256,1,1) block=(512,1,1) lds=163840
.amdgcn_target "amdgcn-amd-amdhsa--gfx950"
.text
.globl adaLN_cond__linear_kernel_hedgehog__moe_arch_mod__prompt_kernel
.p2align 8
.type adaLN_cond__linear_kernel_hedgehog__moe_arch_mod__prompt_kernel,@function
adaLN_cond__linear_kernel_hedgehog__moe_arch_mod__prompt_kernel:
    s_load_dwordx16 s[68:83], s[0:1], 0
    s_load_dwordx8 s[84:91], s[0:1], 64
    s_load_dwordx2 s[32:33], s[0:1], 104
    s_load_dwordx2 s[30:31], s[0:1], 96
    s_cmp_ge_u32 s2, 256
    s_cbranch_scc1 L_END
    v_lshrrev_b32 v4, 6, v0
    v_and_b32 v1, 63, v0
    v_mov_b32 v3, 0
    v_readfirstlane_b32 s3, v4
    v_lshlrev_b32 v2, 4, v1
    s_and_b32 s8, s2, 7
    s_lshr_b32 s9, s2, 3
    s_lshl2_add_u32 s96, s8, s3
    s_lshl_b32 s15, s96, 6
    s_mul_i32 s96, s15, 6144
    s_xor_b32 s97, s9, 1
    s_lshl_b32 s98, s97, 7
    s_add_u32 s13, s96, s98
    v_lshrrev_b32 v60, 3, v1
    v_mul_u32_u24 v60, 49152, v60
    v_and_b32 v9, 7, v1
    v_lshl_add_u32 v60, v9, 4, v60
    v_lshrrev_b32 v61, 3, v1
    v_lshl_add_u32 v61, v61, 3, s15
    s_lshl_b32 s96, s8, 5
    s_add_u32 s97, s96, s9
    s_lshl2_add_u32 s98, s97, s3
    s_sub_u32 s99, s98, 4
    s_lshl_b32 s16, s99, 12
    s_mov_b32 s50, 12582912
    s_mov_b32 s51, 0x20000
    s_mov_b32 s38, 4194304
    s_mov_b32 s39, 0x20000
    s_mov_b32 s34, 268435456
    s_mov_b32 s35, 0x20000
    s_getreg_b32 s94, hwreg(HW_REG_XCC_ID, 0, 3)
    s_getpc_b64 s[22:23]
    s_mul_i32 s96, s9, 7
    s_add_u32 s97, s96, s3
    s_lshl_b32 s19, s97, 7
    v_lshrrev_b32 v10, 5, v1
    v_mul_u32_u24 v10, 28672, v10
    v_add_u32 v10, s19, v10
    v_min_u32 v10, 44032, v10
    s_cmp_ge_u32 s3, 4
    s_waitcnt lgkmcnt(0)
    s_mov_b64 s[48:49], s[88:89]
    s_mov_b64 s[36:37], s[68:69]
    s_load_dword s4, s[32:33], 0
    s_cbranch_scc1 L_FS
    global_load_dwordx2 v[96:97], v61, s[86:87]
    buffer_load_dwordx4 v[80:83], v60, s[48:51], s13 offen nt
    s_add_u32 s13, s13, 12288
    buffer_load_dwordx4 v[84:87], v60, s[48:51], s13 offen nt
    s_add_u32 s13, s13, 12288
    buffer_load_dwordx4 v[88:91], v60, s[48:51], s13 offen nt
    s_add_u32 s13, s13, 12288
    buffer_load_dwordx4 v[92:95], v60, s[48:51], s13 offen nt
    s_barrier
    s_barrier
    s_and_b32 s22, s22, 0xfffffc00
    global_load_dword v78, v10, s[22:23]
    s_mov_b32 s42, 6291456
    s_mov_b32 s43, 0x20000
    s_mov_b32 s46, 2097152
    s_mov_b32 s47, 0x20000
    s_mov_b32 s54, 7340032
    s_mov_b32 s55, 0x20000
    s_mov_b32 s58, 7340032
    s_mov_b32 s59, 0x20000
    s_mov_b32 s62, 7340032
    s_mov_b32 s63, 0x20000
    s_mov_b32 s66, 4194304
    s_mov_b32 s67, 0x20000
    s_mov_b64 s[40:41], s[70:71]
    s_mov_b64 s[44:45], s[74:75]
    s_mov_b64 s[52:53], s[80:81]
    s_mov_b64 s[56:57], s[82:83]
    s_mov_b64 s[60:61], s[84:85]
    s_mov_b64 s[64:65], s[90:91]
    s_mov_b32 s5, 0
    s_mov_b32 s6, 0xffff0000
    s_mov_b32 s7, 0x3fb8aa3b
    s_lshr_b32 s76, s3, 2
    v_bfe_u32 v6, v1, 4, 1
    v_lshlrev_b32 v6, 6, v6
    v_and_b32 v62, 7, v1
    v_lshlrev_b32 v62, 4, v62
    v_xor_b32 v62, v62, v6
    v_lshrrev_b32 v6, 3, v1
    v_mul_u32_u24 v6, 6144, v6
    v_add_u32 v62, v62, v6
    v_lshlrev_b32 v63, 3, v1
    v_add_u32 v64, 149760, v2
    s_and_b32 s96, s3, 3
    s_lshl2_add_u32 s13, s96, 149760
    v_lshrrev_b32 v65, 4, v1
    v_lshl_add_u32 v65, v65, 5, s13
    v_and_b32 v9, 7, v1
    v_lshl_add_u32 v65, v9, 7, v65
    v_bfe_u32 v9, v1, 3, 1
    v_lshl_add_u32 v65, v9, 4, v65
    s_and_b32 s96, s8, 6
    s_and_b32 s97, s8, 1
    s_lshr_b32 s98, s9, 4
    s_lshl1_add_u32 s99, s97, s98
    s_lshl_b32 s97, s99, 6
    s_add_u32 s98, s96, s97
    s_lshl3_add_u32 s99, s3, s98
    s_lshl_b32 s96, s99, 10
    s_and_b32 s97, s9, 15
    s_lshl_b32 s98, s97, 6
    s_add_u32 s99, s96, s98
    s_add_u32 s14, s99, 262144
    s_xor_b32 s96, s9, 1
    s_and_b32 s97, s96, 15
    s_lshl4_add_u32 s98, s3, s97
    s_lshr_b32 s99, s9, 4
    s_lshl1_add_u32 s96, s98, s99
    s_lshl3_add_u32 s97, s96, s8
    s_lshl_b32 s98, s97, 9
    s_add_u32 s13, s98, 524288
    s_lshr_b32 s96, s9, 4
    s_xor_b32 s97, s9, 1
    s_and_b32 s98, s97, 7
    s_lshl_b32 s99, s3, 1
    s_lshl3_add_u32 s97, s98, s99
    s_bfe_u32 s98, s9, 65539
    s_add_u32 s99, s97, s98
    s_lshl_b32 s97, s99, 9
    s_lshl_b32 s98, s8, 6
    s_add_u32 s99, s97, s98
    s_lshl2_add_u32 s97, s96, s99
    s_add_u32 s15, s97, 2097152
    v_and_b32 v10, 3, v1
    v_lshlrev_b32 v10, 15, v10
    s_waitcnt vmcnt(5)
    v_lshlrev_b32 v98, 16, v97
    v_and_b32 v99, s6, v97
    v_and_b32 v97, s6, v96
    v_lshlrev_b32 v96, 16, v96
    v_mul_f32 v4, s7, v96
    v_exp_f32 v4, -v4
    s_nop 0
    v_add_f32 v4, 1.0, v4
    v_rcp_f32 v4, v4
    s_nop 0
    v_mul_f32 v96, v96, v4
    v_cvt_pk_bf16_f32 v96, 0, v96
    v_mul_f32 v5, s7, v97
    v_exp_f32 v5, -v5
    s_nop 0
    v_add_f32 v5, 1.0, v5
    v_rcp_f32 v5, v5
    s_nop 0
    v_mul_f32 v97, v97, v5
    v_cvt_pk_bf16_f32 v97, 0, v97
    v_mul_f32 v4, s7, v98
    v_exp_f32 v4, -v4
    s_nop 0
    v_add_f32 v4, 1.0, v4
    v_rcp_f32 v4, v4
    s_nop 0
    v_mul_f32 v98, v98, v4
    v_cvt_pk_bf16_f32 v98, 0, v98
    v_mul_f32 v5, s7, v99
    v_exp_f32 v5, -v5
    s_nop 0
    v_add_f32 v5, 1.0, v5
    v_rcp_f32 v5, v5
    s_nop 0
    v_mul_f32 v99, v99, v5
    v_cvt_pk_bf16_f32 v99, 0, v99
    s_waitcnt vmcnt(4)
    v_lshlrev_b32 v4, 16, v80
    v_and_b32 v5, s6, v80
    v_pk_mul_f32 v[20:21], v[4:5], v[96:97] op_sel:[0,0] op_sel_hi:[1,0]
    v_lshlrev_b32 v6, 16, v81
    v_and_b32 v7, s6, v81
    v_pk_mul_f32 v[22:23], v[6:7], v[96:97] op_sel:[0,0] op_sel_hi:[1,0]
    v_lshlrev_b32 v4, 16, v82
    v_and_b32 v5, s6, v82
    v_pk_mul_f32 v[24:25], v[4:5], v[96:97] op_sel:[0,0] op_sel_hi:[1,0]
    v_lshlrev_b32 v6, 16, v83
    v_and_b32 v7, s6, v83
    v_pk_mul_f32 v[26:27], v[6:7], v[96:97] op_sel:[0,0] op_sel_hi:[1,0]
    s_waitcnt vmcnt(3)
    v_lshlrev_b32 v4, 16, v84
    v_and_b32 v5, s6, v84
    v_pk_fma_f32 v[20:21], v[4:5], v[96:97], v[20:21] op_sel:[0,1,0] op_sel_hi:[1,1,1]
    v_lshlrev_b32 v6, 16, v85
    v_and_b32 v7, s6, v85
    v_pk_fma_f32 v[22:23], v[6:7], v[96:97], v[22:23] op_sel:[0,1,0] op_sel_hi:[1,1,1]
    v_lshlrev_b32 v4, 16, v86
    v_and_b32 v5, s6, v86
    v_pk_fma_f32 v[24:25], v[4:5], v[96:97], v[24:25] op_sel:[0,1,0] op_sel_hi:[1,1,1]
    v_lshlrev_b32 v6, 16, v87
    v_and_b32 v7, s6, v87
    v_pk_fma_f32 v[26:27], v[6:7], v[96:97], v[26:27] op_sel:[0,1,0] op_sel_hi:[1,1,1]
    s_waitcnt vmcnt(2)
    v_lshlrev_b32 v4, 16, v88
    v_and_b32 v5, s6, v88
    v_pk_fma_f32 v[20:21], v[4:5], v[98:99], v[20:21] op_sel:[0,0,0] op_sel_hi:[1,0,1]
    v_lshlrev_b32 v6, 16, v89
    v_and_b32 v7, s6, v89
    v_pk_fma_f32 v[22:23], v[6:7], v[98:99], v[22:23] op_sel:[0,0,0] op_sel_hi:[1,0,1]
    v_lshlrev_b32 v4, 16, v90
    v_and_b32 v5, s6, v90
    v_pk_fma_f32 v[24:25], v[4:5], v[98:99], v[24:25] op_sel:[0,0,0] op_sel_hi:[1,0,1]
    v_lshlrev_b32 v6, 16, v91
    v_and_b32 v7, s6, v91
    v_pk_fma_f32 v[26:27], v[6:7], v[98:99], v[26:27] op_sel:[0,0,0] op_sel_hi:[1,0,1]
    s_waitcnt vmcnt(1)
    v_lshlrev_b32 v4, 16, v92
    v_and_b32 v5, s6, v92
    v_pk_fma_f32 v[20:21], v[4:5], v[98:99], v[20:21] op_sel:[0,1,0] op_sel_hi:[1,1,1]
    v_lshlrev_b32 v6, 16, v93
    v_and_b32 v7, s6, v93
    v_pk_fma_f32 v[22:23], v[6:7], v[98:99], v[22:23] op_sel:[0,1,0] op_sel_hi:[1,1,1]
    v_lshlrev_b32 v4, 16, v94
    v_and_b32 v5, s6, v94
    v_pk_fma_f32 v[24:25], v[4:5], v[98:99], v[24:25] op_sel:[0,1,0] op_sel_hi:[1,1,1]
    v_lshlrev_b32 v6, 16, v95
    v_and_b32 v7, s6, v95
    v_pk_fma_f32 v[26:27], v[6:7], v[98:99], v[26:27] op_sel:[0,1,0] op_sel_hi:[1,1,1]
    v_permlane32_swap_b32 v20, v24
    v_permlane32_swap_b32 v21, v25
    v_permlane32_swap_b32 v22, v26
    v_permlane32_swap_b32 v23, v27
    v_add_f32 v20, v20, v24
    v_add_f32 v21, v21, v25
    v_add_f32 v22, v22, v26
    v_add_f32 v23, v23, v27
    s_nop 0
    v_permlane16_swap_b32 v20, v22
    v_permlane16_swap_b32 v21, v23
    v_add_f32 v20, v20, v22
    v_add_f32 v21, v21, v23
    s_nop 0
    v_add_f32_dpp v20, v20, v20 row_ror:8 row_mask:0xf bank_mask:0xf
    v_add_f32_dpp v21, v21, v21 row_ror:8 row_mask:0xf bank_mask:0xf
    s_nop 1
    v_mov_b32_dpp v20, v21 quad_perm:[0,1,2,3] row_mask:0xf bank_mask:0xc
    ds_write_b32 v65, v20
    s_waitcnt lgkmcnt(0)
    s_barrier
    ds_read_b128 v[20:23], v64 offset:0
    s_mul_i32 s4, s4, 0x9e3779b1
    s_add_u32 s4, s4, 0x7f4a7c15
    s_waitcnt lgkmcnt(0)
    v_pk_add_f32 v[20:21], v[20:21], v[22:23]
    v_add_f32 v20, v20, v21
    v_mov_b32 v21, s4
    buffer_store_dwordx2 v[20:21], v63, s[32:35], s13 offen sc1
    s_mov_b64 exec, 15
    buffer_store_dword v21, v10, s[32:35], s15 offen sc1
    s_mov_b64 exec, -1
    s_lshl2_add_u32 s96, s2, s3
    s_mul_i32 s13, s96, 6144
    s_branch L_FJ
L_FS:
    s_barrier
    buffer_load_dwordx4 v[80:83], v2, s[36:39], s16 offen
    buffer_load_dwordx4 v[84:87], v2, s[36:39], s16 offen offset:1024
    buffer_load_dwordx4 v[88:91], v2, s[36:39], s16 offen offset:2048
    buffer_load_dwordx4 v[92:95], v2, s[36:39], s16 offen offset:3072
    s_lshl2_add_u32 s96, s2, s3
    s_sub_u32 s97, s96, 4
    s_lshl_b32 s98, s97, 7
    s_add_u32 s17, s98, 2097152
    s_load_dword s24, s[32:33], s17 offset:0 glc
    s_load_dword s25, s[32:33], s17 offset:64 glc
    s_lshl_b32 s96, s2, 5
    s_add_u32 s97, s96, s3
    s_sub_u32 s98, s97, 4
    s_lshl_b32 s99, s98, 7
    s_add_u32 s17, s99, 1048576
    s_load_dword s24, s[32:33], s17 offset:0 glc
    s_load_dword s25, s[32:33], s17 offset:64 glc
    s_lshl_b32 s19, s94, 5
    v_mov_b32 v78, 1
    v_mov_b32 v79, s19
    s_barrier
    s_cmp_lg_u32 s3, 7
    s_cbranch_scc1 L_NOTK
    s_mov_b64 exec, 1
    global_atomic_add v78, v79, v78, s[30:31] sc0 sc1
    s_mov_b64 exec, -1
    s_branch L_TK0
L_NOTK:
    s_and_b32 s22, s22, 0xfffffc00
    global_load_dword v78, v10, s[22:23]
L_TK0:
    s_mov_b32 s42, 6291456
    s_mov_b32 s43, 0x20000
    s_mov_b32 s46, 2097152
    s_mov_b32 s47, 0x20000
    s_mov_b32 s54, 7340032
    s_mov_b32 s55, 0x20000
    s_mov_b32 s58, 7340032
    s_mov_b32 s59, 0x20000
    s_mov_b32 s62, 7340032
    s_mov_b32 s63, 0x20000
    s_mov_b32 s66, 4194304
    s_mov_b32 s67, 0x20000
    s_mov_b64 s[40:41], s[70:71]
    s_mov_b64 s[44:45], s[74:75]
    s_mov_b64 s[52:53], s[80:81]
    s_mov_b64 s[56:57], s[82:83]
    s_mov_b64 s[60:61], s[84:85]
    s_mov_b64 s[64:65], s[90:91]
    s_mov_b32 s5, 0
    s_mov_b32 s6, 0xffff0000
    s_mov_b32 s7, 0x3fb8aa3b
    s_lshr_b32 s76, s3, 2
    v_bfe_u32 v6, v1, 4, 1
    v_lshlrev_b32 v6, 6, v6
    v_and_b32 v62, 7, v1
    v_lshlrev_b32 v62, 4, v62
    v_xor_b32 v62, v62, v6
    v_lshrrev_b32 v6, 3, v1
    v_mul_u32_u24 v6, 6144, v6
    v_add_u32 v62, v62, v6
    v_lshlrev_b32 v63, 3, v1
    v_add_u32 v64, 149760, v2
    s_and_b32 s96, s3, 3
    s_lshl2_add_u32 s13, s96, 149760
    v_lshrrev_b32 v65, 4, v1
    v_lshl_add_u32 v65, v65, 5, s13
    v_and_b32 v9, 7, v1
    v_lshl_add_u32 v65, v9, 7, v65
    v_bfe_u32 v9, v1, 3, 1
    v_lshl_add_u32 v65, v9, 4, v65
    s_and_b32 s96, s8, 6
    s_and_b32 s97, s8, 1
    s_lshr_b32 s98, s9, 4
    s_lshl1_add_u32 s99, s97, s98
    s_lshl_b32 s97, s99, 6
    s_add_u32 s98, s96, s97
    s_lshl3_add_u32 s99, s3, s98
    s_lshl_b32 s96, s99, 10
    s_and_b32 s97, s9, 15
    s_lshl_b32 s98, s97, 6
    s_add_u32 s99, s96, s98
    s_add_u32 s14, s99, 262144
    s_sub_u32 s96, s3, 4
    s_lshl4_add_u32 s13, s96, 151808
    v_lshrrev_b32 v10, 5, v1
    v_lshl_add_u32 v10, v10, 3, s13
    s_barrier
    s_waitcnt vmcnt(1)
    s_waitcnt lgkmcnt(0)
    s_mul_i32 s4, s4, 0x9e3779b1
    s_add_u32 s4, s4, 0x7f4a7c15
    v_mov_b32 v104, 0x3f803f80
    v_dot2_f32_bf16 v100, v80, v104, 0
    v_dot2_f32_bf16 v102, v80, v80, 0
    v_dot2_f32_bf16 v101, v88, v104, 0
    v_dot2_f32_bf16 v103, v88, v88, 0
    v_dot2_f32_bf16 v100, v81, v104, v100
    v_dot2_f32_bf16 v102, v81, v81, v102
    v_dot2_f32_bf16 v101, v89, v104, v101
    v_dot2_f32_bf16 v103, v89, v89, v103
    v_dot2_f32_bf16 v100, v82, v104, v100
    v_dot2_f32_bf16 v102, v82, v82, v102
    v_dot2_f32_bf16 v101, v90, v104, v101
    v_dot2_f32_bf16 v103, v90, v90, v103
    v_dot2_f32_bf16 v100, v83, v104, v100
    v_dot2_f32_bf16 v102, v83, v83, v102
    v_dot2_f32_bf16 v101, v91, v104, v101
    v_dot2_f32_bf16 v103, v91, v91, v103
    v_dot2_f32_bf16 v100, v84, v104, v100
    v_dot2_f32_bf16 v102, v84, v84, v102
    v_dot2_f32_bf16 v101, v92, v104, v101
    v_dot2_f32_bf16 v103, v92, v92, v103
    v_dot2_f32_bf16 v100, v85, v104, v100
    v_dot2_f32_bf16 v102, v85, v85, v102
    v_dot2_f32_bf16 v101, v93, v104, v101
    v_dot2_f32_bf16 v103, v93, v93, v103
    v_dot2_f32_bf16 v100, v86, v104, v100
    v_dot2_f32_bf16 v102, v86, v86, v102
    v_dot2_f32_bf16 v101, v94, v104, v101
    v_dot2_f32_bf16 v103, v94, v94, v103
    v_dot2_f32_bf16 v100, v87, v104, v100
    v_dot2_f32_bf16 v102, v87, v87, v102
    v_dot2_f32_bf16 v101, v95, v104, v101
    v_dot2_f32_bf16 v103, v95, v95, v103
    s_nop 1
    v_permlane32_swap_b32 v100, v101
    v_permlane32_swap_b32 v102, v103
    v_add_f32 v100, v100, v101
    v_add_f32 v102, v102, v103
    s_nop 1
    v_permlane16_swap_b32 v100, v102
    v_add_f32 v100, v100, v102
    s_nop 1
    v_add_f32_dpp v100, v100, v100 quad_perm:[1,0,3,2] row_mask:0xf bank_mask:0xf
    s_nop 1
    v_add_f32_dpp v100, v100, v100 quad_perm:[2,3,0,1] row_mask:0xf bank_mask:0xf
    s_nop 1
    v_add_f32_dpp v100, v100, v100 row_half_mirror row_mask:0xf bank_mask:0xf
    s_nop 1
    v_add_f32_dpp v100, v100, v100 row_ror:8 row_mask:0xf bank_mask:0xf
    v_mul_f32 v102, 0x3a800000, v100
    v_mul_f32 v100, 0x3a800000, v100
    s_nop 1
    v_permlane16_swap_b32 v100, v102
    v_fma_f32 v117, -v100, v100, v102
    v_cvt_pk_bf16_f32 v116, 0, v100
    v_max_f32 v117, 0, v117
    v_cvt_pk_bf16_f32 v117, 0, v117
    v_add_f32 v117, 0x3727c5ac, v117
    v_cvt_pk_bf16_f32 v117, 0, v117
    v_sqrt_f32 v117, v117
    s_nop 0
    v_cvt_pk_bf16_f32 v117, 0, v117
    v_lshrrev_b32 v116, 16, v116
    v_or_b32 v116, v116, v117
    v_mov_b32 v117, s4
    ds_write_b64 v10, v[116:117]
L_FJ:
    v_and_b32 v5, 3, v1
    v_lshlrev_b32 v5, 4, v5
    v_add_u32 v5, 151808, v5
    v_and_b32 v4, 3, v1
    v_lshlrev_b32 v4, 4, v4
    v_bfe_u32 v9, v1, 2, 1
    v_lshl_add_u32 v4, v9, 10, v4
    v_and_b32 v10, 31, v1
    v_lshlrev_b32 v10, 11, v10
    v_lshrrev_b32 v9, 5, v1
    v_lshl_add_u32 v10, v9, 5, v10
    v_and_b32 v6, 1, v1
    v_lshlrev_b32 v6, 9, v6
    v_bfe_u32 v9, v1, 1, 1
    v_lshl_add_u32 v6, v9, 8, v6
    s_and_b32 s96, s9, 3
    s_and_b32 s97, s8, 6
    s_and_b32 s98, s8, 1
    s_lshr_b32 s99, s9, 4
    s_lshl1_add_u32 s98, s98, s99
    s_lshl_b32 s99, s98, 6
    s_add_u32 s98, s97, s99
    s_lshl3_add_u32 s97, s3, s98
    s_lshl_b32 s99, s97, 9
    s_bfe_u32 s98, s9, 131074
    s_lshl_b32 s97, s98, 6
    s_add_u32 s98, s99, s97
    s_lshl2_add_u32 s99, s96, s98
    s_add_u32 s97, s99, 16
    s_add_u32 s15, s97, 2097152
    s_waitcnt lgkmcnt(0)
    s_barrier
    ds_read_b128 v[116:119], v5
    s_waitcnt lgkmcnt(0)
    s_mov_b64 exec, 0xff
    buffer_store_dwordx4 v[116:119], v4, s[32:35], s14 offen sc1
    s_mov_b64 exec, 15
    buffer_store_dword v117, v6, s[32:35], s15 offen sc1
    s_mov_b64 exec, -1
    s_cmp_lg_u32 s3, 7
    s_cbranch_scc1 L_NOTK2
    s_mov_b32 s13, 0
    s_waitcnt vmcnt(2)
L_TK:
    v_readfirstlane_b32 s15, v78
    s_nop 0
    s_cmp_lt_u32 s15, 32
    s_cbranch_scc1 L_TKOK
    v_mov_b32 v78, s4
    s_mov_b64 exec, 1
    buffer_store_dword v78, v3, s[32:35], 0 offen offset:256 sc1
    s_mov_b64 exec, -1
    s_add_u32 s13, s13, 1
    s_cmp_lt_u32 s13, 8
    s_cbranch_scc0 L_TKNO
    s_add_u32 s94, s94, 1
    s_and_b32 s94, s94, 7
    s_lshl_b32 s19, s94, 5
    v_mov_b32 v78, 1
    v_mov_b32 v79, s19
    s_mov_b64 exec, 1
    global_atomic_add v78, v79, v78, s[30:31] sc0 sc1
    s_mov_b64 exec, -1
    s_waitcnt vmcnt(0)
    s_branch L_TK
L_TKNO:
    s_and_b32 s94, s2, 7
    s_lshr_b32 s15, s2, 3
L_TKOK:
    s_lshl3_add_u32 s15, s15, s94
    v_mov_b32 v78, s15
    ds_write_b32 v5, v78 offset:64
L_NOTK2:
    s_waitcnt lgkmcnt(0)
    s_barrier
    ds_read_b32 v120, v5 offset:64
    s_waitcnt lgkmcnt(0)
    v_readfirstlane_b32 s2, v120
    s_nop 0
    s_and_b32 s8, s2, 7
    s_lshr_b32 s9, s2, 3
    s_and_b32 s96, s8, 1
    s_and_b32 s97, s9, 7
    s_lshl3_add_u32 s12, s96, s97
    s_lshr_b32 s96, s8, 1
    s_lshr_b32 s97, s9, 3
    s_lshl2_add_u32 s21, s96, s97
    s_and_b32 s96, s3, 3
    s_lshl2_add_u32 s94, s21, s96
    s_lshl1_add_u32 s95, s12, s76
    s_lshl_b32 s96, s94, 16
    s_lshl_b32 s97, s95, 6
    s_add_u32 s18, s96, s97
    buffer_load_dwordx4 v[12:15], v10, s[36:39], s18 offen
    buffer_load_dwordx4 v[16:19], v10, s[36:39], s18 offen offset:16
    s_lshr_b32 s96, s8, 1
    s_lshl4_add_u32 s97, s96, s12
    s_lshl4_add_u32 s98, s97, s3
    s_lshl_b32 s99, s98, 9
    s_add_u32 s13, s99, 524288
    s_lshl3_add_u32 s96, s2, s3
    s_lshl_b32 s97, s96, 6
    s_add_u32 s15, s97, 2097152
    s_and_b32 s96, s3, 3
    s_lshl2_add_u32 s97, s2, s96
    s_lshl_b32 s98, s97, 8
    s_add_u32 s14, s98, 262144
    s_load_dwordx8 s[24:31], s[32:33], s15 offset:0 glc
    s_and_b32 s10, s9, 15
    s_lshr_b32 s96, s8, 2
    s_and_b32 s97, s8, 1
    s_lshl1_add_u32 s98, s96, s97
    s_and_b32 s99, s8, 2
    s_lshl2_add_u32 s96, s98, s99
    s_lshr_b32 s97, s9, 4
    s_add_u32 s11, s96, s97
    s_and_b32 s85, s9, 12
    s_lshl_b32 s96, s2, 6
    s_add_u32 s97, s96, s3
    s_lshl_b32 s98, s97, 6
    s_add_u32 s92, s98, 1048576
    s_lshr_b32 s96, s9, 4
    s_xor_b32 s77, s76, s96
    s_lshr_b32 s96, s9, 3
    s_xor_b32 s97, s96, s9
    s_and_b32 s98, s97, 1
    s_lshl_b32 s83, s98, 2
    s_mul_i32 s96, s8, 7
    s_lshr_b32 s97, s9, 2
    s_add_u32 s74, s96, s97
    s_and_b32 s75, s9, 3
    v_and_b32 v8, 31, v1
    v_lshlrev_b32 v8, 3, v8
    v_and_b32 v4, 31, v1
    v_lshlrev_b32 v4, 4, v4
    v_lshrrev_b32 v9, 5, v1
    v_lshl_add_u32 v4, v9, 12, v4
    s_lshl2_add_u32 s16, s3, 152320
    v_lshl_add_u32 v5, v1, 6, s16
    s_lshl_b32 s96, s76, 10
    s_add_u32 s16, s96, 152320
    v_and_b32 v6, 15, v1
    v_lshl_add_u32 v6, v6, 5, s16
    v_lshrrev_b32 v9, 5, v1
    v_lshl_add_u32 v6, v9, 9, v6
    s_branch SCHK_2
SPOLL_1:
    s_load_dwordx8 s[24:31], s[32:33], s15 offset:0 glc
SCHK_2:
    s_add_u32 s5, s5, 1
    s_cmp_ge_u32 s5, 300000
    s_waitcnt lgkmcnt(0)
    s_cbranch_scc1 SDONE_3
    s_cmp_lg_u32 s24, s4
    s_cbranch_scc1 SPOLL_1
    s_cmp_lg_u32 s25, s4
    s_cbranch_scc1 SPOLL_1
    s_cmp_lg_u32 s28, s4
    s_cbranch_scc1 SPOLL_1
    s_cmp_lg_u32 s29, s4
    s_cbranch_scc1 SPOLL_1
    s_cmp_lg_u32 s30, s4
    s_cbranch_scc1 SPOLL_1
    s_cmp_lg_u32 s31, s4
    s_cbranch_scc1 SPOLL_1
SDONE_3:
    buffer_load_dwordx4 v[120:123], v4, s[32:35], s13 offen sc1
    buffer_load_dwordx2 v[116:117], v8, s[32:35], s14 offen sc1
    s_barrier
    s_lshl_b32 s96, s11, 12
    s_lshl_b32 s97, s3, 9
    s_add_u32 s16, s96, s97
    v_add_u32 v10, s16, v2
    s_lshl_b32 s96, s3, 9
    s_add_u32 m0, s96, 156416
    s_mov_b32 exec_hi, 0
    global_load_lds_dwordx4 v10, s[72:73]
    s_mov_b32 exec_hi, -1
    s_and_b32 s20, s9, 3
    s_add_u32 s96, s20, s85
    s_and_b32 s97, s96, 15
    s_lshl3_add_u32 s98, s97, s3
    s_mul_i32 s99, s98, 49152
    s_lshl_b32 s96, s11, 7
    s_add_u32 s82, s99, s96
    s_mul_i32 s96, s20, 24960
    s_lshr_b32 s97, s3, 1
    s_mul_i32 s98, s97, 2080
    s_add_u32 s99, s96, s98
    s_and_b32 s97, s3, 1
    s_mul_i32 s96, s97, 1056
    s_add_u32 s20, s99, s96
    s_mov_b32 m0, s20
    s_nop 0
    buffer_load_dwordx4 v62, s[40:43], s82 offen lds
    s_add_u32 s82, s82, 2048
    s_add_u32 m0, s20, 8320
    s_nop 0
    buffer_load_dwordx4 v62, s[40:43], s82 offen lds
    s_add_u32 s82, s82, 2048
    s_add_u32 m0, s20, 16640
    s_nop 0
    buffer_load_dwordx4 v62, s[40:43], s82 offen lds
    s_waitcnt vmcnt(5)
    v_bitop3_b32 v7, v121, v123, s4 bitop3:0x7e
    v_cmp_ne_u32 vcc, 0, v7
    s_cbranch_vccz TOK_5
POLL_6:
    buffer_load_dwordx4 v[120:123], v4, s[32:35], s13 offen sc1
    s_waitcnt vmcnt(0)
    v_bitop3_b32 v7, v121, v123, s4 bitop3:0x7e
    v_cmp_ne_u32 vcc, 0, v7
    s_cbranch_vccz PDONE_7
    s_add_u32 s5, s5, 1
    s_cmp_lt_u32 s5, 300000
    s_cbranch_scc1 POLL_6
PDONE_7:
TOK_5:
    ds_write2_b32 v5, v120, v122 offset0:0 offset1:8
    v_lshlrev_b32 v100, 16, v12
    v_and_b32 v101, s6, v12
    v_lshlrev_b32 v102, 16, v13
    v_and_b32 v103, s6, v13
    v_lshlrev_b32 v104, 16, v14
    v_and_b32 v105, s6, v14
    v_lshlrev_b32 v106, 16, v15
    v_and_b32 v107, s6, v15
    v_lshlrev_b32 v108, 16, v16
    v_and_b32 v109, s6, v16
    v_lshlrev_b32 v110, 16, v17
    v_and_b32 v111, s6, v17
    v_lshlrev_b32 v112, 16, v18
    v_and_b32 v113, s6, v18
    v_lshlrev_b32 v114, 16, v19
    v_and_b32 v115, s6, v19
    s_waitcnt lgkmcnt(0)
    s_barrier
    ds_read_b128 v[88:91], v6 offset:2048
    ds_read_b128 v[92:95], v6 offset:2064
    ds_read_b128 v[80:83], v6
    ds_read_b128 v[84:87], v6 offset:16
    s_waitcnt vmcnt(4)
    v_cmp_ne_u32 vcc, s4, v117
    s_cbranch_vccz TOK_8
POLL_9:
    buffer_load_dwordx2 v[116:117], v8, s[32:35], s14 offen sc1
    s_waitcnt vmcnt(0)
    v_cmp_ne_u32 vcc, s4, v117
    s_cbranch_vccz PDONE_10
    s_add_u32 s5, s5, 1
    s_cmp_lt_u32 s5, 300000
    s_cbranch_scc1 POLL_9
PDONE_10:
TOK_8:
    v_lshlrev_b32 v117, 16, v116
    v_and_b32 v116, s6, v116
    v_rcp_f32 v116, v116
    s_nop 0
    v_pk_add_f32 v[100:101], v[100:101], v[116:117] op_sel:[0,1] neg_lo:[0,1] neg_hi:[0,1]
    v_pk_add_f32 v[102:103], v[102:103], v[116:117] op_sel:[0,1] neg_lo:[0,1] neg_hi:[0,1]
    v_pk_add_f32 v[104:105], v[104:105], v[116:117] op_sel:[0,1] neg_lo:[0,1] neg_hi:[0,1]
    v_pk_add_f32 v[106:107], v[106:107], v[116:117] op_sel:[0,1] neg_lo:[0,1] neg_hi:[0,1]
    v_pk_add_f32 v[108:109], v[108:109], v[116:117] op_sel:[0,1] neg_lo:[0,1] neg_hi:[0,1]
    v_pk_add_f32 v[110:111], v[110:111], v[116:117] op_sel:[0,1] neg_lo:[0,1] neg_hi:[0,1]
    v_pk_add_f32 v[112:113], v[112:113], v[116:117] op_sel:[0,1] neg_lo:[0,1] neg_hi:[0,1]
    v_pk_add_f32 v[114:115], v[114:115], v[116:117] op_sel:[0,1] neg_lo:[0,1] neg_hi:[0,1]
    s_lshl4_add_u32 s96, s21, s12
    s_and_b32 s97, s3, 3
    s_lshl2_add_u32 s98, s96, s97
    s_lshl1_add_u32 s99, s98, s76
    s_lshl_b32 s96, s99, 11
    s_add_u32 s13, s96, 4194304
    v_and_b32 v8, 15, v1
    v_lshlrev_b32 v8, 4, v8
    v_bfe_u32 v9, v1, 4, 1
    v_lshl_add_u32 v8, v9, 10, v8
    v_lshrrev_b32 v9, 5, v1
    v_lshl_add_u32 v8, v9, 9, v8
    s_waitcnt lgkmcnt(2)
    v_pk_add_f32 v[88:89], v[88:89], v[90:91]
    v_pk_add_f32 v[92:93], v[92:93], v[94:95]
    v_pk_add_f32 v[88:89], v[88:89], v[92:93]
    v_add_f32 v88, v88, v89
    v_cvt_pk_bf16_f32 v88, 0, v88
    s_waitcnt lgkmcnt(0)
    v_pk_add_f32 v[80:81], v[80:81], v[82:83]
    v_pk_add_f32 v[84:85], v[84:85], v[86:87]
    v_pk_add_f32 v[80:81], v[80:81], v[84:85]
    v_add_f32 v80, v80, v81
    v_add_f32 v88, 1.0, v88
    v_cvt_pk_bf16_f32 v88, 0, v88
    v_cvt_pk_bf16_f32 v80, 0, v80
    s_lshl_b32 s96, s3, 8
    s_add_u32 s16, s96, 160512
    v_and_b32 v4, 15, v1
    v_lshl_add_u32 v4, v4, 2, s16
    v_lshrrev_b32 v9, 5, v1
    v_lshl_add_u32 v4, v9, 6, v4
    v_lshrrev_b32 v5, 5, v1
    v_lshl_add_u32 v5, v5, 6, s16
    ds_write2_b32 v4, v88, v80 offset0:0 offset1:32
    ds_read_b128 v[132:135], v5
    ds_read_b128 v[136:139], v5 offset:16
    ds_read_b128 v[140:143], v5 offset:32
    ds_read_b128 v[144:147], v5 offset:48
    ds_read_b128 v[148:151], v5 offset:128
    ds_read_b128 v[152:155], v5 offset:144
    ds_read_b128 v[156:159], v5 offset:160
    ds_read_b128 v[160:163], v5 offset:176
    v_cvt_pk_bf16_f32 v100, 0, v100
    v_cvt_pk_bf16_f32 v101, 0, v101
    v_cvt_pk_bf16_f32 v102, 0, v102
    v_cvt_pk_bf16_f32 v103, 0, v103
    v_cvt_pk_bf16_f32 v104, 0, v104
    v_cvt_pk_bf16_f32 v105, 0, v105
    v_cvt_pk_bf16_f32 v106, 0, v106
    v_cvt_pk_bf16_f32 v107, 0, v107
    v_pk_mul_f32 v[100:101], v[100:101], v[116:117] op_sel_hi:[1,0]
    v_pk_mul_f32 v[102:103], v[102:103], v[116:117] op_sel_hi:[1,0]
    v_pk_mul_f32 v[104:105], v[104:105], v[116:117] op_sel_hi:[1,0]
    v_pk_mul_f32 v[106:107], v[106:107], v[116:117] op_sel_hi:[1,0]
    v_cvt_pk_bf16_f32 v100, 0, v100
    v_cvt_pk_bf16_f32 v101, 0, v101
    v_cvt_pk_bf16_f32 v102, 0, v102
    v_cvt_pk_bf16_f32 v103, 0, v103
    v_cvt_pk_bf16_f32 v104, 0, v104
    v_cvt_pk_bf16_f32 v105, 0, v105
    v_cvt_pk_bf16_f32 v106, 0, v106
    v_cvt_pk_bf16_f32 v107, 0, v107
    v_cvt_pk_bf16_f32 v108, 0, v108
    v_cvt_pk_bf16_f32 v109, 0, v109
    v_cvt_pk_bf16_f32 v110, 0, v110
    v_cvt_pk_bf16_f32 v111, 0, v111
    v_cvt_pk_bf16_f32 v112, 0, v112
    v_cvt_pk_bf16_f32 v113, 0, v113
    v_cvt_pk_bf16_f32 v114, 0, v114
    v_cvt_pk_bf16_f32 v115, 0, v115
    v_pk_mul_f32 v[108:109], v[108:109], v[116:117] op_sel_hi:[1,0]
    v_pk_mul_f32 v[110:111], v[110:111], v[116:117] op_sel_hi:[1,0]
    v_pk_mul_f32 v[112:113], v[112:113], v[116:117] op_sel_hi:[1,0]
    v_pk_mul_f32 v[114:115], v[114:115], v[116:117] op_sel_hi:[1,0]
    v_cvt_pk_bf16_f32 v108, 0, v108
    v_cvt_pk_bf16_f32 v109, 0, v109
    v_cvt_pk_bf16_f32 v110, 0, v110
    v_cvt_pk_bf16_f32 v111, 0, v111
    v_cvt_pk_bf16_f32 v112, 0, v112
    v_cvt_pk_bf16_f32 v113, 0, v113
    v_cvt_pk_bf16_f32 v114, 0, v114
    v_cvt_pk_bf16_f32 v115, 0, v115
    s_waitcnt lgkmcnt(6)
    v_pk_mul_f32 v[100:101], v[100:101], v[132:133]
    v_pk_mul_f32 v[102:103], v[102:103], v[134:135]
    v_pk_mul_f32 v[104:105], v[104:105], v[136:137]
    v_pk_mul_f32 v[106:107], v[106:107], v[138:139]
    v_cvt_pk_bf16_f32 v100, 0, v100
    v_cvt_pk_bf16_f32 v101, 0, v101
    v_cvt_pk_bf16_f32 v102, 0, v102
    v_cvt_pk_bf16_f32 v103, 0, v103
    v_cvt_pk_bf16_f32 v104, 0, v104
    v_cvt_pk_bf16_f32 v105, 0, v105
    v_cvt_pk_bf16_f32 v106, 0, v106
    v_cvt_pk_bf16_f32 v107, 0, v107
    s_waitcnt lgkmcnt(2)
    v_pk_add_f32 v[100:101], v[100:101], v[148:149]
    v_pk_add_f32 v[102:103], v[102:103], v[150:151]
    v_pk_add_f32 v[104:105], v[104:105], v[152:153]
    v_pk_add_f32 v[106:107], v[106:107], v[154:155]
    v_cvt_pk_bf16_f32 v124, v100, v101
    v_cvt_pk_bf16_f32 v125, v102, v103
    v_cvt_pk_bf16_f32 v126, v104, v105
    v_cvt_pk_bf16_f32 v127, v106, v107
    buffer_store_dwordx4 v[124:127], v8, s[32:35], s13 offen sc1
    v_pk_mul_f32 v[108:109], v[108:109], v[140:141]
    v_pk_mul_f32 v[110:111], v[110:111], v[142:143]
    v_pk_mul_f32 v[112:113], v[112:113], v[144:145]
    v_pk_mul_f32 v[114:115], v[114:115], v[146:147]
    v_cvt_pk_bf16_f32 v108, 0, v108
    v_cvt_pk_bf16_f32 v109, 0, v109
    v_cvt_pk_bf16_f32 v110, 0, v110
    v_cvt_pk_bf16_f32 v111, 0, v111
    v_cvt_pk_bf16_f32 v112, 0, v112
    v_cvt_pk_bf16_f32 v113, 0, v113
    v_cvt_pk_bf16_f32 v114, 0, v114
    v_cvt_pk_bf16_f32 v115, 0, v115
    s_waitcnt lgkmcnt(0)
    v_pk_add_f32 v[108:109], v[108:109], v[156:157]
    v_pk_add_f32 v[110:111], v[110:111], v[158:159]
    v_pk_add_f32 v[112:113], v[112:113], v[160:161]
    v_pk_add_f32 v[114:115], v[114:115], v[162:163]
    v_cvt_pk_bf16_f32 v128, v108, v109
    v_cvt_pk_bf16_f32 v129, v110, v111
    v_cvt_pk_bf16_f32 v130, v112, v113
    v_cvt_pk_bf16_f32 v131, v114, v115
    buffer_store_dwordx4 v[128:131], v8, s[32:35], s13 offen offset:256 sc1
    v_lshrrev_b32 v66, 5, v1
    v_mul_u32_u24 v66, 2080, v66
    v_bfe_u32 v9, v1, 2, 2
    v_lshl_add_u32 v66, v9, 7, v66
    v_bfe_u32 v9, v1, 3, 1
    v_lshl_add_u32 v66, v9, 6, v66
    v_and_b32 v9, 3, v1
    v_lshl_add_u32 v66, v9, 3, v66
    v_bfe_u32 v67, v1, 4, 1
    v_mul_u32_u24 v67, 1056, v67
    v_bfe_u32 v68, v1, 3, 1
    v_lshlrev_b32 v68, 7, v68
    v_add_u32 v66, v66, v67
    v_sub_u32 v67, v66, v68
    v_add_u32 v67, 64, v67
    v_add_u32 v68, 49920, v66
    v_add_u32 v69, 49920, v67
    v_add_u32 v70, 99840, v66
    v_add_u32 v71, 99840, v67
    s_lshl_b32 s96, s76, 11
    s_add_u32 s14, s96, 156416
    v_bfe_u32 v4, v1, 2, 2
    v_lshl_add_u32 v4, v4, 6, s14
    v_bfe_u32 v9, v1, 4, 1
    v_lshl_add_u32 v4, v9, 5, v4
    v_and_b32 v9, 3, v1
    v_lshl_add_u32 v4, v9, 3, v4
    v_lshrrev_b32 v9, 5, v1
    v_lshl_add_u32 v4, v9, 9, v4
    v_and_b32 v5, 7, v1
    v_lshlrev_b32 v5, 12, v5
    v_bfe_u32 v9, v1, 3, 1
    v_lshl_add_u32 v5, v9, 19, v5
    s_and_b32 s96, s12, 1
    s_lshl_b32 s97, s21, 15
    s_lshr_b32 s98, s12, 1
    s_lshl_b32 s99, s98, 6
    s_add_u32 s98, s97, s99
    s_lshl2_add_u32 s97, s96, s98
    s_add_u32 s13, s97, 1048576
    v_bfe_u32 v6, v1, 4, 1
    v_lshlrev_b32 v6, 6, v6
    v_lshrrev_b32 v9, 5, v1
    v_lshl_add_u32 v6, v9, 4, v6
    v_and_b32 v74, 7, v1
    v_lshlrev_b32 v74, 4, v74
    v_xor_b32 v74, v74, v6
    v_lshrrev_b32 v6, 3, v1
    v_lshlrev_b32 v6, 11, v6
    v_add_u32 v74, v74, v6
    s_and_b32 s96, s3, 2
    s_lshl_b32 s14, s96, 5
    v_bfe_u32 v6, v1, 4, 1
    v_lshl_add_u32 v6, v6, 5, s14
    v_and_b32 v72, 7, v1
    v_lshlrev_b32 v72, 4, v72
    v_xor_b32 v72, v72, v6
    v_lshrrev_b32 v6, 3, v1
    v_mul_u32_u24 v6, 7168, v6
    v_add_u32 v72, v72, v6
    s_and_b32 s96, s3, 1
    s_lshl_b32 s14, s96, 7
    v_lshrrev_b32 v6, 5, v1
    v_lshl_add_u32 v6, v6, 6, s14
    v_and_b32 v73, 31, v1
    v_lshlrev_b32 v73, 4, v73
    v_lshrrev_b32 v9, 5, v1
    v_lshl_add_u32 v73, v9, 11, v73
    v_xor_b32 v73, v73, v6
    s_lshl3_add_u32 s96, s75, s3
    s_mul_i32 s97, s96, 229376
    s_lshl_b32 s98, s74, 7
    s_add_u32 s80, s97, s98
    s_lshl3_add_u32 s96, s74, s3
    s_lshl_b32 s97, s96, 14
    s_lshl_b32 s98, s75, 9
    s_add_u32 s81, s97, s98
    s_cmp_ge_u32 s9, 28
    s_cselect_b32 s54, 0, s54
    s_cselect_b32 s58, 0, s58
    s_cselect_b32 s62, 0, s62
    s_waitcnt vmcnt(0)
    s_barrier
    s_cmp_lg_u32 s3, 0
    s_cbranch_scc1 L_PB
    v_mov_b32 v6, s4
    s_mov_b32 exec_hi, 0
    s_mov_b32 exec_lo, 65535
    buffer_store_dword v6, v5, s[32:35], s13 offen sc1
    s_mov_b64 exec, -1
L_PB:
    s_and_b32 s20, s9, 3
    s_cmp_le_u32 s20, 0
    s_cselect_b32 s20, 1, 0
    s_add_u32 s96, s20, s85
    s_and_b32 s97, s96, 15
    s_lshl3_add_u32 s98, s97, s3
    s_mul_i32 s99, s98, 49152
    s_lshl_b32 s96, s11, 7
    s_add_u32 s82, s99, s96
    s_mul_i32 s96, s20, 24960
    s_lshr_b32 s97, s3, 1
    s_mul_i32 s98, s97, 2080
    s_add_u32 s99, s96, s98
    s_and_b32 s97, s3, 1
    s_mul_i32 s96, s97, 1056
    s_add_u32 s20, s99, s96
    s_mov_b32 m0, s20
    s_nop 0
    buffer_load_dwordx4 v62, s[40:43], s82 offen lds
    s_add_u32 s82, s82, 2048
    s_add_u32 m0, s20, 8320
    s_nop 0
    buffer_load_dwordx4 v62, s[40:43], s82 offen lds
    s_add_u32 s82, s82, 2048
    s_add_u32 m0, s20, 16640
    s_nop 0
    buffer_load_dwordx4 v62, s[40:43], s82 offen lds
    s_and_b32 s20, s9, 3
    s_cmp_le_u32 s20, 1
    s_cselect_b32 s20, 2, 1
    s_add_u32 s96, s20, s85
    s_and_b32 s97, s96, 15
    s_lshl3_add_u32 s98, s97, s3
    s_mul_i32 s99, s98, 49152
    s_lshl_b32 s96, s11, 7
    s_add_u32 s82, s99, s96
    s_mul_i32 s96, s20, 24960
    s_lshr_b32 s97, s3, 1
    s_mul_i32 s98, s97, 2080
    s_add_u32 s99, s96, s98
    s_and_b32 s97, s3, 1
    s_mul_i32 s96, s97, 1056
    s_add_u32 s20, s99, s96
    s_mov_b32 m0, s20
    s_nop 0
    buffer_load_dwordx4 v62, s[40:43], s82 offen lds
    s_add_u32 s82, s82, 2048
    s_add_u32 m0, s20, 8320
    s_nop 0
    buffer_load_dwordx4 v62, s[40:43], s82 offen lds
    s_add_u32 s82, s82, 2048
    s_add_u32 m0, s20, 16640
    s_nop 0
    buffer_load_dwordx4 v62, s[40:43], s82 offen lds
    ds_read_b64_tr_b16 v[28:29], v4
    ds_read_b64_tr_b16 v[30:31], v4 offset:256
    ds_read_b64_tr_b16 v[32:33], v4 offset:1024
    ds_read_b64_tr_b16 v[34:35], v4 offset:1280
    s_lshl_b32 s96, s10, 6
    s_add_u32 s97, s96, s3
    s_lshl_b32 s98, s97, 12
    s_add_u32 s15, s98, 4194304
    s_and_b32 s96, s3, 3
    s_lshl_b32 s97, s96, 12
    s_add_u32 s13, s97, 147456
    v_add_u32 v76, s13, v2
    v_and_b32 v77, 15, v1
    v_lshl_add_u32 v77, v77, 4, s13
    v_lshrrev_b32 v9, 5, v1
    v_lshl_add_u32 v77, v9, 9, v77
    v_bfe_u32 v9, v1, 4, 1
    v_lshl_add_u32 v77, v9, 3, v77
    s_and_b32 s96, s3, 3
    s_lshl_b32 s97, s96, 10
    s_add_u32 s13, s97, 32768
    v_and_b32 v78, 15, v1
    v_lshl_add_u32 v78, v78, 5, s13
    v_lshrrev_b32 v9, 4, v1
    v_lshl_add_u32 v78, v9, 3, v78
    s_and_b32 s96, s3, 3
    s_lshl_b32 s97, s96, 10
    s_lshl_b32 s98, s76, 14
    s_add_u32 s13, s97, s98
    v_and_b32 v75, 31, v1
    v_lshl_add_u32 v75, v75, 5, s13
    v_lshrrev_b32 v9, 5, v1
    v_lshl_add_u32 v75, v9, 4, v75
    s_lshl_b32 s84, s3, 14
    s_lshr_b32 s96, s9, 4
    s_lshl_b32 s97, s96, 20
    s_lshl_b32 s98, s12, 7
    s_add_u32 s88, s97, s98
    s_lshl_b32 s89, s3, 10
    s_load_dwordx2 s[24:25], s[32:33], s92 offset:0 glc
    s_and_b32 s20, s9, 3
    s_cmp_le_u32 s20, 2
    s_cselect_b32 s20, 3, 2
    s_add_u32 s96, s20, s85
    s_and_b32 s97, s96, 15
    s_lshl3_add_u32 s98, s97, s3
    s_mul_i32 s99, s98, 49152
    s_lshl_b32 s96, s11, 7
    s_add_u32 s82, s99, s96
    s_mul_i32 s96, s20, 24960
    s_lshr_b32 s97, s3, 1
    s_mul_i32 s98, s97, 2080
    s_add_u32 s99, s96, s98
    s_and_b32 s97, s3, 1
    s_mul_i32 s96, s97, 1056
    s_add_u32 s20, s99, s96
    s_mov_b32 m0, s20
    s_nop 0
    buffer_load_dwordx4 v62, s[40:43], s82 offen lds
    s_add_u32 s82, s82, 2048
    s_add_u32 m0, s20, 8320
    s_nop 0
    buffer_load_dwordx4 v62, s[40:43], s82 offen lds
    s_add_u32 s82, s82, 2048
    s_add_u32 m0, s20, 16640
    s_nop 0
    buffer_load_dwordx4 v62, s[40:43], s82 offen lds
    s_add_u32 s96, s85, 4
    s_and_b32 s97, s96, 15
    s_lshl3_add_u32 s98, s97, s3
    s_mul_i32 s99, s98, 49152
    s_lshl_b32 s96, s11, 7
    s_add_u32 s82, s99, s96
    s_lshr_b32 s96, s3, 1
    s_mul_i32 s97, s96, 2080
    s_and_b32 s98, s3, 1
    s_mul_i32 s99, s98, 1056
    s_add_u32 s96, s97, s99
    s_add_u32 s20, s96, 99840
    s_mov_b32 m0, s20
    s_nop 0
    buffer_load_dwordx4 v62, s[40:43], s82 offen lds
    s_add_u32 s82, s82, 2048
    s_add_u32 m0, s20, 8320
    s_nop 0
    buffer_load_dwordx4 v62, s[40:43], s82 offen lds
    s_add_u32 s82, s82, 2048
    s_add_u32 m0, s20, 16640
    s_nop 0
    buffer_load_dwordx4 v62, s[40:43], s82 offen lds
    s_branch SCHK_12
SPOLL_11:
    s_load_dwordx2 s[24:25], s[32:33], s92 offset:0 glc
SCHK_12:
    s_add_u32 s5, s5, 1
    s_cmp_ge_u32 s5, 300000
    s_waitcnt lgkmcnt(0)
    s_cbranch_scc1 SDONE_13
    s_cmp_lg_u32 s24, s4
    s_cbranch_scc1 SPOLL_11
    s_cmp_lg_u32 s25, s4
    s_cbranch_scc1 SPOLL_11
SDONE_13:
    s_waitcnt vmcnt(9)
    s_barrier
    s_cmp_ge_u32 s3, 4
    s_cbranch_scc1 L_HELP
    s_setprio 2
    s_and_b32 s96, s85, 15
    s_lshl_b32 s97, s96, 14
    s_add_u32 s16, s97, s15
    buffer_load_dwordx4 v[176:179], v2, s[32:35], s16 offen sc1
    buffer_load_dwordx4 v[180:183], v2, s[32:35], s16 offen offset:1024 sc1
    ds_read_b64_tr_b16 v[224:225], v67 offset:8320
    ds_read_b64_tr_b16 v[226:227], v67 offset:8832
    ds_read_b64_tr_b16 v[228:229], v67 offset:8352
    ds_read_b64_tr_b16 v[230:231], v67 offset:8864
    ds_read_b64_tr_b16 v[232:233], v66 offset:8320
    ds_read_b64_tr_b16 v[234:235], v66 offset:8832
    ds_read_b64_tr_b16 v[236:237], v66 offset:8352
    ds_read_b64_tr_b16 v[238:239], v66 offset:8864
    ds_read_b64_tr_b16 v[240:241], v66
    ds_read_b64_tr_b16 v[242:243], v66 offset:512
    ds_read_b64_tr_b16 v[244:245], v66 offset:32
    ds_read_b64_tr_b16 v[246:247], v66 offset:544
    buffer_load_dwordx4 v[184:187], v2, s[32:35], s16 offen offset:2048 sc1
    buffer_load_dwordx4 v[188:191], v2, s[32:35], s16 offen offset:3072 sc1
    s_waitcnt lgkmcnt(8)
    s_waitcnt vmcnt(3)
    v_mfma_f32_16x16x32_bf16 v[128:131], v[224:227], v[176:179], 0
    ds_read_b64_tr_b16 v[248:249], v67
    s_waitcnt vmcnt(2)
    v_mfma_f32_16x16x32_bf16 v[132:135], v[224:227], v[180:183], 0
    ds_read_b64_tr_b16 v[250:251], v67 offset:512
    s_add_u32 s96, s85, 1
    s_and_b32 s97, s96, 15
    s_lshl_b32 s98, s97, 14
    s_add_u32 s16, s98, s15
    buffer_load_dwordx4 v[192:195], v2, s[32:35], s16 offen sc1
    v_mfma_f32_16x16x32_bf16 v[136:139], v[228:231], v[176:179], 0
    ds_read_b64_tr_b16 v[224:225], v67 offset:32
    v_mfma_f32_16x16x32_bf16 v[140:143], v[228:231], v[180:183], 0
    ds_read_b64_tr_b16 v[226:227], v67 offset:544
    s_waitcnt lgkmcnt(8)
    v_mfma_f32_16x16x32_bf16 v[112:115], v[232:235], v[176:179], 0
    ds_read_b64_tr_b16 v[228:229], v66 offset:16640
    v_mfma_f32_16x16x32_bf16 v[116:119], v[232:235], v[180:183], 0
    ds_read_b64_tr_b16 v[230:231], v66 offset:17152
    v_mfma_f32_16x16x32_bf16 v[120:123], v[236:239], v[176:179], 0
    ds_read_b64_tr_b16 v[232:233], v66 offset:16672
    v_mfma_f32_16x16x32_bf16 v[124:127], v[236:239], v[180:183], 0
    ds_read_b64_tr_b16 v[234:235], v66 offset:17184
    buffer_load_dwordx4 v[196:199], v2, s[32:35], s16 offen offset:1024 sc1
    s_waitcnt lgkmcnt(8)
    v_mfma_f32_16x16x32_bf16 v[80:83], v[240:243], v[176:179], 0
    ds_read_b64_tr_b16 v[236:237], v67 offset:16640
    v_mfma_f32_16x16x32_bf16 v[84:87], v[240:243], v[180:183], 0
    ds_read_b64_tr_b16 v[238:239], v67 offset:17152
    v_mfma_f32_16x16x32_bf16 v[88:91], v[244:247], v[176:179], 0
    ds_read_b64_tr_b16 v[240:241], v67 offset:16672
    v_mfma_f32_16x16x32_bf16 v[92:95], v[244:247], v[180:183], 0
    ds_read_b64_tr_b16 v[242:243], v67 offset:17184
    s_waitcnt lgkmcnt(8)
    v_mfma_f32_16x16x32_bf16 v[96:99], v[248:251], v[176:179], 0
    ds_read_b64_tr_b16 v[244:245], v67 offset:12480
    v_mfma_f32_16x16x32_bf16 v[100:103], v[248:251], v[180:183], 0
    ds_read_b64_tr_b16 v[246:247], v67 offset:12992
    buffer_load_dwordx4 v[200:203], v2, s[32:35], s16 offen offset:2048 sc1
    v_mfma_f32_16x16x32_bf16 v[104:107], v[224:227], v[176:179], 0
    ds_read_b64_tr_b16 v[248:249], v67 offset:12512
    v_mfma_f32_16x16x32_bf16 v[108:111], v[224:227], v[180:183], 0
    ds_read_b64_tr_b16 v[250:251], v67 offset:13024
    s_waitcnt lgkmcnt(8)
    v_mfma_f32_16x16x32_bf16 v[144:147], v[228:231], v[176:179], 0
    ds_read_b64_tr_b16 v[224:225], v66 offset:12480
    v_mfma_f32_16x16x32_bf16 v[148:151], v[228:231], v[180:183], 0
    ds_read_b64_tr_b16 v[226:227], v66 offset:12992
    v_mfma_f32_16x16x32_bf16 v[152:155], v[232:235], v[176:179], 0
    ds_read_b64_tr_b16 v[228:229], v66 offset:12512
    v_mfma_f32_16x16x32_bf16 v[156:159], v[232:235], v[180:183], 0
    ds_read_b64_tr_b16 v[230:231], v66 offset:13024
    buffer_load_dwordx4 v[204:207], v2, s[32:35], s16 offen offset:3072 sc1
    s_waitcnt lgkmcnt(8)
    v_mfma_f32_16x16x32_bf16 v[160:163], v[236:239], v[176:179], 0
    ds_read_b64_tr_b16 v[232:233], v66 offset:4160
    v_mfma_f32_16x16x32_bf16 v[164:167], v[236:239], v[180:183], 0
    ds_read_b64_tr_b16 v[234:235], v66 offset:4672
    v_mfma_f32_16x16x32_bf16 v[168:171], v[240:243], v[176:179], 0
    ds_read_b64_tr_b16 v[236:237], v66 offset:4192
    v_mfma_f32_16x16x32_bf16 v[172:175], v[240:243], v[180:183], 0
    ds_read_b64_tr_b16 v[238:239], v66 offset:4704
    s_waitcnt lgkmcnt(8)
    s_waitcnt vmcnt(5)
    v_mfma_f32_16x16x32_bf16 v[128:131], v[244:247], v[184:187], v[128:131]
    ds_read_b64_tr_b16 v[240:241], v67 offset:4160
    s_waitcnt vmcnt(4)
    v_mfma_f32_16x16x32_bf16 v[132:135], v[244:247], v[188:191], v[132:135]
    ds_read_b64_tr_b16 v[242:243], v67 offset:4672
    s_add_u32 s96, s85, 2
    s_and_b32 s97, s96, 15
    s_lshl_b32 s98, s97, 14
    s_add_u32 s16, s98, s15
    buffer_load_dwordx4 v[208:211], v2, s[32:35], s16 offen sc1
    v_mfma_f32_16x16x32_bf16 v[136:139], v[248:251], v[184:187], v[136:139]
    ds_read_b64_tr_b16 v[244:245], v67 offset:4192
    v_mfma_f32_16x16x32_bf16 v[140:143], v[248:251], v[188:191], v[140:143]
    ds_read_b64_tr_b16 v[246:247], v67 offset:4704
    s_waitcnt lgkmcnt(8)
    v_mfma_f32_16x16x32_bf16 v[112:115], v[224:227], v[184:187], v[112:115]
    ds_read_b64_tr_b16 v[248:249], v66 offset:20800
    v_mfma_f32_16x16x32_bf16 v[116:119], v[224:227], v[188:191], v[116:119]
    ds_read_b64_tr_b16 v[250:251], v66 offset:21312
    v_mfma_f32_16x16x32_bf16 v[120:123], v[228:231], v[184:187], v[120:123]
    ds_read_b64_tr_b16 v[224:225], v66 offset:20832
    v_mfma_f32_16x16x32_bf16 v[124:127], v[228:231], v[188:191], v[124:127]
    ds_read_b64_tr_b16 v[226:227], v66 offset:21344
    buffer_load_dwordx4 v[212:215], v2, s[32:35], s16 offen offset:1024 sc1
    s_waitcnt lgkmcnt(8)
    v_mfma_f32_16x16x32_bf16 v[80:83], v[232:235], v[184:187], v[80:83]
    ds_read_b64_tr_b16 v[228:229], v67 offset:20800
    v_mfma_f32_16x16x32_bf16 v[84:87], v[232:235], v[188:191], v[84:87]
    ds_read_b64_tr_b16 v[230:231], v67 offset:21312
    v_mfma_f32_16x16x32_bf16 v[88:91], v[236:239], v[184:187], v[88:91]
    ds_read_b64_tr_b16 v[232:233], v67 offset:20832
    v_mfma_f32_16x16x32_bf16 v[92:95], v[236:239], v[188:191], v[92:95]
    ds_read_b64_tr_b16 v[234:235], v67 offset:21344
    s_waitcnt lgkmcnt(8)
    v_mfma_f32_16x16x32_bf16 v[96:99], v[240:243], v[184:187], v[96:99]
    s_barrier
    ds_read_b64_tr_b16 v[236:237], v67 offset:33280
    v_mfma_f32_16x16x32_bf16 v[100:103], v[240:243], v[188:191], v[100:103]
    ds_read_b64_tr_b16 v[238:239], v67 offset:33792
    buffer_load_dwordx4 v[216:219], v2, s[32:35], s16 offen offset:2048 sc1
    v_mfma_f32_16x16x32_bf16 v[104:107], v[244:247], v[184:187], v[104:107]
    ds_read_b64_tr_b16 v[240:241], v67 offset:33312
    v_mfma_f32_16x16x32_bf16 v[108:111], v[244:247], v[188:191], v[108:111]
    ds_read_b64_tr_b16 v[242:243], v67 offset:33824
    s_waitcnt lgkmcnt(8)
    v_mfma_f32_16x16x32_bf16 v[144:147], v[248:251], v[184:187], v[144:147]
    ds_read_b64_tr_b16 v[244:245], v66 offset:33280
    v_mfma_f32_16x16x32_bf16 v[148:151], v[248:251], v[188:191], v[148:151]
    ds_read_b64_tr_b16 v[246:247], v66 offset:33792
    v_mfma_f32_16x16x32_bf16 v[152:155], v[224:227], v[184:187], v[152:155]
    ds_read_b64_tr_b16 v[248:249], v66 offset:33312
    v_mfma_f32_16x16x32_bf16 v[156:159], v[224:227], v[188:191], v[156:159]
    ds_read_b64_tr_b16 v[250:251], v66 offset:33824
    buffer_load_dwordx4 v[220:223], v2, s[32:35], s16 offen offset:3072 sc1
    s_waitcnt lgkmcnt(8)
    v_mfma_f32_16x16x32_bf16 v[160:163], v[228:231], v[184:187], v[160:163]
    ds_read_b64_tr_b16 v[224:225], v66 offset:24960
    v_mfma_f32_16x16x32_bf16 v[164:167], v[228:231], v[188:191], v[164:167]
    ds_read_b64_tr_b16 v[226:227], v66 offset:25472
    v_mfma_f32_16x16x32_bf16 v[168:171], v[232:235], v[184:187], v[168:171]
    ds_read_b64_tr_b16 v[228:229], v66 offset:24992
    v_mfma_f32_16x16x32_bf16 v[172:175], v[232:235], v[188:191], v[172:175]
    ds_read_b64_tr_b16 v[230:231], v66 offset:25504
    s_waitcnt lgkmcnt(8)
    s_waitcnt vmcnt(6)
    v_mfma_f32_16x16x32_bf16 v[128:131], v[236:239], v[192:195], v[128:131]
    ds_read_b64_tr_b16 v[232:233], v67 offset:24960
    v_mfma_f32_16x16x32_bf16 v[132:135], v[236:239], v[196:199], v[132:135]
    ds_read_b64_tr_b16 v[234:235], v67 offset:25472
    s_add_u32 s96, s85, 3
    s_and_b32 s97, s96, 15
    s_lshl_b32 s98, s97, 14
    s_add_u32 s16, s98, s15
    buffer_load_dwordx4 v[176:179], v2, s[32:35], s16 offen sc1
    v_mfma_f32_16x16x32_bf16 v[136:139], v[240:243], v[192:195], v[136:139]
    ds_read_b64_tr_b16 v[236:237], v67 offset:24992
    v_mfma_f32_16x16x32_bf16 v[140:143], v[240:243], v[196:199], v[140:143]
    ds_read_b64_tr_b16 v[238:239], v67 offset:25504
    s_waitcnt lgkmcnt(8)
    v_mfma_f32_16x16x32_bf16 v[112:115], v[244:247], v[192:195], v[112:115]
    ds_read_b64_tr_b16 v[240:241], v66 offset:41600
    v_mfma_f32_16x16x32_bf16 v[116:119], v[244:247], v[196:199], v[116:119]
    ds_read_b64_tr_b16 v[242:243], v66 offset:42112
    v_mfma_f32_16x16x32_bf16 v[120:123], v[248:251], v[192:195], v[120:123]
    ds_read_b64_tr_b16 v[244:245], v66 offset:41632
    v_mfma_f32_16x16x32_bf16 v[124:127], v[248:251], v[196:199], v[124:127]
    ds_read_b64_tr_b16 v[246:247], v66 offset:42144
    buffer_load_dwordx4 v[180:183], v2, s[32:35], s16 offen offset:1024 sc1
    s_waitcnt lgkmcnt(8)
    v_mfma_f32_16x16x32_bf16 v[80:83], v[224:227], v[192:195], v[80:83]
    ds_read_b64_tr_b16 v[248:249], v67 offset:41600
    v_mfma_f32_16x16x32_bf16 v[84:87], v[224:227], v[196:199], v[84:87]
    ds_read_b64_tr_b16 v[250:251], v67 offset:42112
    v_mfma_f32_16x16x32_bf16 v[88:91], v[228:231], v[192:195], v[88:91]
    ds_read_b64_tr_b16 v[224:225], v67 offset:41632
    v_mfma_f32_16x16x32_bf16 v[92:95], v[228:231], v[196:199], v[92:95]
    ds_read_b64_tr_b16 v[226:227], v67 offset:42144
    s_waitcnt lgkmcnt(8)
    v_mfma_f32_16x16x32_bf16 v[96:99], v[232:235], v[192:195], v[96:99]
    ds_read_b64_tr_b16 v[228:229], v67 offset:37440
    v_mfma_f32_16x16x32_bf16 v[100:103], v[232:235], v[196:199], v[100:103]
    ds_read_b64_tr_b16 v[230:231], v67 offset:37952
    buffer_load_dwordx4 v[184:187], v2, s[32:35], s16 offen offset:2048 sc1
    v_mfma_f32_16x16x32_bf16 v[104:107], v[236:239], v[192:195], v[104:107]
    ds_read_b64_tr_b16 v[232:233], v67 offset:37472
    v_mfma_f32_16x16x32_bf16 v[108:111], v[236:239], v[196:199], v[108:111]
    ds_read_b64_tr_b16 v[234:235], v67 offset:37984
    s_waitcnt lgkmcnt(8)
    v_mfma_f32_16x16x32_bf16 v[144:147], v[240:243], v[192:195], v[144:147]
    ds_read_b64_tr_b16 v[236:237], v66 offset:37440
    v_mfma_f32_16x16x32_bf16 v[148:151], v[240:243], v[196:199], v[148:151]
    ds_read_b64_tr_b16 v[238:239], v66 offset:37952
    v_mfma_f32_16x16x32_bf16 v[152:155], v[244:247], v[192:195], v[152:155]
    ds_read_b64_tr_b16 v[240:241], v66 offset:37472
    v_mfma_f32_16x16x32_bf16 v[156:159], v[244:247], v[196:199], v[156:159]
    ds_read_b64_tr_b16 v[242:243], v66 offset:37984
    buffer_load_dwordx4 v[188:191], v2, s[32:35], s16 offen offset:3072 sc1
    s_waitcnt lgkmcnt(8)
    v_mfma_f32_16x16x32_bf16 v[160:163], v[248:251], v[192:195], v[160:163]
    ds_read_b64_tr_b16 v[244:245], v66 offset:29120
    v_mfma_f32_16x16x32_bf16 v[164:167], v[248:251], v[196:199], v[164:167]
    ds_read_b64_tr_b16 v[246:247], v66 offset:29632
    v_mfma_f32_16x16x32_bf16 v[168:171], v[224:227], v[192:195], v[168:171]
    ds_read_b64_tr_b16 v[248:249], v66 offset:29152
    v_mfma_f32_16x16x32_bf16 v[172:175], v[224:227], v[196:199], v[172:175]
    ds_read_b64_tr_b16 v[250:251], v66 offset:29664
    s_waitcnt lgkmcnt(8)
    s_waitcnt vmcnt(8)
    v_mfma_f32_16x16x32_bf16 v[128:131], v[228:231], v[200:203], v[128:131]
    ds_read_b64_tr_b16 v[224:225], v67 offset:29120
    v_mfma_f32_16x16x32_bf16 v[132:135], v[228:231], v[204:207], v[132:135]
    ds_read_b64_tr_b16 v[226:227], v67 offset:29632
    s_add_u32 s96, s85, 4
    s_and_b32 s97, s96, 15
    s_lshl_b32 s98, s97, 14
    s_add_u32 s16, s98, s15
    buffer_load_dwordx4 v[192:195], v2, s[32:35], s16 offen sc1
    v_mfma_f32_16x16x32_bf16 v[136:139], v[232:235], v[200:203], v[136:139]
    ds_read_b64_tr_b16 v[228:229], v67 offset:29152
    v_mfma_f32_16x16x32_bf16 v[140:143], v[232:235], v[204:207], v[140:143]
    ds_read_b64_tr_b16 v[230:231], v67 offset:29664
    s_waitcnt lgkmcnt(8)
    v_mfma_f32_16x16x32_bf16 v[112:115], v[236:239], v[200:203], v[112:115]
    ds_read_b64_tr_b16 v[232:233], v66 offset:45760
    v_mfma_f32_16x16x32_bf16 v[116:119], v[236:239], v[204:207], v[116:119]
    ds_read_b64_tr_b16 v[234:235], v66 offset:46272
    v_mfma_f32_16x16x32_bf16 v[120:123], v[240:243], v[200:203], v[120:123]
    ds_read_b64_tr_b16 v[236:237], v66 offset:45792
    v_mfma_f32_16x16x32_bf16 v[124:127], v[240:243], v[204:207], v[124:127]
    ds_read_b64_tr_b16 v[238:239], v66 offset:46304
    buffer_load_dwordx4 v[196:199], v2, s[32:35], s16 offen offset:1024 sc1
    s_waitcnt lgkmcnt(8)
    v_mfma_f32_16x16x32_bf16 v[80:83], v[244:247], v[200:203], v[80:83]
    ds_read_b64_tr_b16 v[240:241], v67 offset:45760
    v_mfma_f32_16x16x32_bf16 v[84:87], v[244:247], v[204:207], v[84:87]
    ds_read_b64_tr_b16 v[242:243], v67 offset:46272
    v_mfma_f32_16x16x32_bf16 v[88:91], v[248:251], v[200:203], v[88:91]
    ds_read_b64_tr_b16 v[244:245], v67 offset:45792
    v_mfma_f32_16x16x32_bf16 v[92:95], v[248:251], v[204:207], v[92:95]
    ds_read_b64_tr_b16 v[246:247], v67 offset:46304
    s_waitcnt lgkmcnt(8)
    v_mfma_f32_16x16x32_bf16 v[96:99], v[224:227], v[200:203], v[96:99]
    s_barrier
    ds_read_b64_tr_b16 v[248:249], v69 offset:8320
    v_mfma_f32_16x16x32_bf16 v[100:103], v[224:227], v[204:207], v[100:103]
    ds_read_b64_tr_b16 v[250:251], v69 offset:8832
    v_mfma_f32_16x16x32_bf16 v[104:107], v[228:231], v[200:203], v[104:107]
    ds_read_b64_tr_b16 v[224:225], v69 offset:8352
    v_mfma_f32_16x16x32_bf16 v[108:111], v[228:231], v[204:207], v[108:111]
    ds_read_b64_tr_b16 v[226:227], v69 offset:8864
    s_waitcnt lgkmcnt(8)
    v_mfma_f32_16x16x32_bf16 v[144:147], v[232:235], v[200:203], v[144:147]
    ds_read_b64_tr_b16 v[228:229], v68 offset:8320
    v_mfma_f32_16x16x32_bf16 v[148:151], v[232:235], v[204:207], v[148:151]
    ds_read_b64_tr_b16 v[230:231], v68 offset:8832
    v_mfma_f32_16x16x32_bf16 v[152:155], v[236:239], v[200:203], v[152:155]
    ds_read_b64_tr_b16 v[232:233], v68 offset:8352
    v_mfma_f32_16x16x32_bf16 v[156:159], v[236:239], v[204:207], v[156:159]
    ds_read_b64_tr_b16 v[234:235], v68 offset:8864
    s_waitcnt lgkmcnt(8)
    v_mfma_f32_16x16x32_bf16 v[160:163], v[240:243], v[200:203], v[160:163]
    ds_read_b64_tr_b16 v[236:237], v68
    v_mfma_f32_16x16x32_bf16 v[164:167], v[240:243], v[204:207], v[164:167]
    ds_read_b64_tr_b16 v[238:239], v68 offset:512
    v_mfma_f32_16x16x32_bf16 v[168:171], v[244:247], v[200:203], v[168:171]
    ds_read_b64_tr_b16 v[240:241], v68 offset:32
    v_mfma_f32_16x16x32_bf16 v[172:175], v[244:247], v[204:207], v[172:175]
    ds_read_b64_tr_b16 v[242:243], v68 offset:544
    s_waitcnt lgkmcnt(8)
    s_waitcnt vmcnt(8)
    v_mfma_f32_16x16x32_bf16 v[128:131], v[248:251], v[208:211], v[128:131]
    ds_read_b64_tr_b16 v[244:245], v69
    v_mfma_f32_16x16x32_bf16 v[132:135], v[248:251], v[212:215], v[132:135]
    ds_read_b64_tr_b16 v[246:247], v69 offset:512
    buffer_load_dwordx4 v[200:203], v2, s[32:35], s16 offen offset:2048 sc1
    v_mfma_f32_16x16x32_bf16 v[136:139], v[224:227], v[208:211], v[136:139]
    ds_read_b64_tr_b16 v[248:249], v69 offset:32
    v_mfma_f32_16x16x32_bf16 v[140:143], v[224:227], v[212:215], v[140:143]
    ds_read_b64_tr_b16 v[250:251], v69 offset:544
    s_waitcnt lgkmcnt(8)
    v_mfma_f32_16x16x32_bf16 v[112:115], v[228:231], v[208:211], v[112:115]
    ds_read_b64_tr_b16 v[224:225], v68 offset:16640
    v_mfma_f32_16x16x32_bf16 v[116:119], v[228:231], v[212:215], v[116:119]
    ds_read_b64_tr_b16 v[226:227], v68 offset:17152
    v_mfma_f32_16x16x32_bf16 v[120:123], v[232:235], v[208:211], v[120:123]
    ds_read_b64_tr_b16 v[228:229], v68 offset:16672
    v_mfma_f32_16x16x32_bf16 v[124:127], v[232:235], v[212:215], v[124:127]
    ds_read_b64_tr_b16 v[230:231], v68 offset:17184
    buffer_load_dwordx4 v[204:207], v2, s[32:35], s16 offen offset:3072 sc1
    s_waitcnt lgkmcnt(8)
    v_mfma_f32_16x16x32_bf16 v[80:83], v[236:239], v[208:211], v[80:83]
    ds_read_b64_tr_b16 v[232:233], v69 offset:16640
    v_mfma_f32_16x16x32_bf16 v[84:87], v[236:239], v[212:215], v[84:87]
    ds_read_b64_tr_b16 v[234:235], v69 offset:17152
    v_mfma_f32_16x16x32_bf16 v[88:91], v[240:243], v[208:211], v[88:91]
    ds_read_b64_tr_b16 v[236:237], v69 offset:16672
    v_mfma_f32_16x16x32_bf16 v[92:95], v[240:243], v[212:215], v[92:95]
    ds_read_b64_tr_b16 v[238:239], v69 offset:17184
    s_waitcnt lgkmcnt(8)
    v_mfma_f32_16x16x32_bf16 v[96:99], v[244:247], v[208:211], v[96:99]
    ds_read_b64_tr_b16 v[240:241], v69 offset:12480
    v_mfma_f32_16x16x32_bf16 v[100:103], v[244:247], v[212:215], v[100:103]
    ds_read_b64_tr_b16 v[242:243], v69 offset:12992
    v_mfma_f32_16x16x32_bf16 v[104:107], v[248:251], v[208:211], v[104:107]
    ds_read_b64_tr_b16 v[244:245], v69 offset:12512
    v_mfma_f32_16x16x32_bf16 v[108:111], v[248:251], v[212:215], v[108:111]
    ds_read_b64_tr_b16 v[246:247], v69 offset:13024
    s_waitcnt lgkmcnt(8)
    v_mfma_f32_16x16x32_bf16 v[144:147], v[224:227], v[208:211], v[144:147]
    ds_read_b64_tr_b16 v[248:249], v68 offset:12480
    v_mfma_f32_16x16x32_bf16 v[148:151], v[224:227], v[212:215], v[148:151]
    ds_read_b64_tr_b16 v[250:251], v68 offset:12992
    v_mfma_f32_16x16x32_bf16 v[152:155], v[228:231], v[208:211], v[152:155]
    ds_read_b64_tr_b16 v[224:225], v68 offset:12512
    v_mfma_f32_16x16x32_bf16 v[156:159], v[228:231], v[212:215], v[156:159]
    ds_read_b64_tr_b16 v[226:227], v68 offset:13024
    s_waitcnt lgkmcnt(8)
    v_mfma_f32_16x16x32_bf16 v[160:163], v[232:235], v[208:211], v[160:163]
    ds_read_b64_tr_b16 v[228:229], v68 offset:4160
    v_mfma_f32_16x16x32_bf16 v[164:167], v[232:235], v[212:215], v[164:167]
    ds_read_b64_tr_b16 v[230:231], v68 offset:4672
    v_mfma_f32_16x16x32_bf16 v[168:171], v[236:239], v[208:211], v[168:171]
    ds_read_b64_tr_b16 v[232:233], v68 offset:4192
    v_mfma_f32_16x16x32_bf16 v[172:175], v[236:239], v[212:215], v[172:175]
    ds_read_b64_tr_b16 v[234:235], v68 offset:4704
    s_waitcnt lgkmcnt(8)
    s_waitcnt vmcnt(8)
    v_mfma_f32_16x16x32_bf16 v[128:131], v[240:243], v[216:219], v[128:131]
    ds_read_b64_tr_b16 v[236:237], v69 offset:4160
    v_mfma_f32_16x16x32_bf16 v[132:135], v[240:243], v[220:223], v[132:135]
    ds_read_b64_tr_b16 v[238:239], v69 offset:4672
    s_add_u32 s96, s85, 5
    s_and_b32 s97, s96, 15
    s_lshl_b32 s98, s97, 14
    s_add_u32 s16, s98, s15
    buffer_load_dwordx4 v[208:211], v2, s[32:35], s16 offen sc1
    v_mfma_f32_16x16x32_bf16 v[136:139], v[244:247], v[216:219], v[136:139]
    ds_read_b64_tr_b16 v[240:241], v69 offset:4192
    v_mfma_f32_16x16x32_bf16 v[140:143], v[244:247], v[220:223], v[140:143]
    ds_read_b64_tr_b16 v[242:243], v69 offset:4704
    s_waitcnt lgkmcnt(8)
    v_mfma_f32_16x16x32_bf16 v[112:115], v[248:251], v[216:219], v[112:115]
    ds_read_b64_tr_b16 v[244:245], v68 offset:20800
    v_mfma_f32_16x16x32_bf16 v[116:119], v[248:251], v[220:223], v[116:119]
    ds_read_b64_tr_b16 v[246:247], v68 offset:21312
    v_mfma_f32_16x16x32_bf16 v[120:123], v[224:227], v[216:219], v[120:123]
    ds_read_b64_tr_b16 v[248:249], v68 offset:20832
    v_mfma_f32_16x16x32_bf16 v[124:127], v[224:227], v[220:223], v[124:127]
    ds_read_b64_tr_b16 v[250:251], v68 offset:21344
    buffer_load_dwordx4 v[212:215], v2, s[32:35], s16 offen offset:1024 sc1
    s_waitcnt lgkmcnt(8)
    v_mfma_f32_16x16x32_bf16 v[80:83], v[228:231], v[216:219], v[80:83]
    ds_read_b64_tr_b16 v[224:225], v69 offset:20800
    v_mfma_f32_16x16x32_bf16 v[84:87], v[228:231], v[220:223], v[84:87]
    ds_read_b64_tr_b16 v[226:227], v69 offset:21312
    v_mfma_f32_16x16x32_bf16 v[88:91], v[232:235], v[216:219], v[88:91]
    ds_read_b64_tr_b16 v[228:229], v69 offset:20832
    v_mfma_f32_16x16x32_bf16 v[92:95], v[232:235], v[220:223], v[92:95]
    ds_read_b64_tr_b16 v[230:231], v69 offset:21344
    s_waitcnt lgkmcnt(8)
    v_mfma_f32_16x16x32_bf16 v[96:99], v[236:239], v[216:219], v[96:99]
    s_barrier
    ds_read_b64_tr_b16 v[232:233], v69 offset:33280
    v_mfma_f32_16x16x32_bf16 v[100:103], v[236:239], v[220:223], v[100:103]
    ds_read_b64_tr_b16 v[234:235], v69 offset:33792
    v_mfma_f32_16x16x32_bf16 v[104:107], v[240:243], v[216:219], v[104:107]
    ds_read_b64_tr_b16 v[236:237], v69 offset:33312
    v_mfma_f32_16x16x32_bf16 v[108:111], v[240:243], v[220:223], v[108:111]
    ds_read_b64_tr_b16 v[238:239], v69 offset:33824
    s_waitcnt lgkmcnt(8)
    v_mfma_f32_16x16x32_bf16 v[144:147], v[244:247], v[216:219], v[144:147]
    ds_read_b64_tr_b16 v[240:241], v68 offset:33280
    v_mfma_f32_16x16x32_bf16 v[148:151], v[244:247], v[220:223], v[148:151]
    ds_read_b64_tr_b16 v[242:243], v68 offset:33792
    v_mfma_f32_16x16x32_bf16 v[152:155], v[248:251], v[216:219], v[152:155]
    ds_read_b64_tr_b16 v[244:245], v68 offset:33312
    v_mfma_f32_16x16x32_bf16 v[156:159], v[248:251], v[220:223], v[156:159]
    ds_read_b64_tr_b16 v[246:247], v68 offset:33824
    s_waitcnt lgkmcnt(8)
    v_mfma_f32_16x16x32_bf16 v[160:163], v[224:227], v[216:219], v[160:163]
    ds_read_b64_tr_b16 v[248:249], v68 offset:24960
    v_mfma_f32_16x16x32_bf16 v[164:167], v[224:227], v[220:223], v[164:167]
    ds_read_b64_tr_b16 v[250:251], v68 offset:25472
    v_mfma_f32_16x16x32_bf16 v[168:171], v[228:231], v[216:219], v[168:171]
    ds_read_b64_tr_b16 v[224:225], v68 offset:24992
    v_mfma_f32_16x16x32_bf16 v[172:175], v[228:231], v[220:223], v[172:175]
    ds_read_b64_tr_b16 v[226:227], v68 offset:25504
    s_waitcnt lgkmcnt(8)
    s_waitcnt vmcnt(8)
    v_mfma_f32_16x16x32_bf16 v[128:131], v[232:235], v[176:179], v[128:131]
    ds_read_b64_tr_b16 v[228:229], v69 offset:24960
    v_mfma_f32_16x16x32_bf16 v[132:135], v[232:235], v[180:183], v[132:135]
    ds_read_b64_tr_b16 v[230:231], v69 offset:25472
    buffer_load_dwordx4 v[216:219], v2, s[32:35], s16 offen offset:2048 sc1
    v_mfma_f32_16x16x32_bf16 v[136:139], v[236:239], v[176:179], v[136:139]
    ds_read_b64_tr_b16 v[232:233], v69 offset:24992
    v_mfma_f32_16x16x32_bf16 v[140:143], v[236:239], v[180:183], v[140:143]
    ds_read_b64_tr_b16 v[234:235], v69 offset:25504
    s_waitcnt lgkmcnt(8)
    v_mfma_f32_16x16x32_bf16 v[112:115], v[240:243], v[176:179], v[112:115]
    ds_read_b64_tr_b16 v[236:237], v68 offset:41600
    v_mfma_f32_16x16x32_bf16 v[116:119], v[240:243], v[180:183], v[116:119]
    ds_read_b64_tr_b16 v[238:239], v68 offset:42112
    v_mfma_f32_16x16x32_bf16 v[120:123], v[244:247], v[176:179], v[120:123]
    ds_read_b64_tr_b16 v[240:241], v68 offset:41632
    v_mfma_f32_16x16x32_bf16 v[124:127], v[244:247], v[180:183], v[124:127]
    ds_read_b64_tr_b16 v[242:243], v68 offset:42144
    buffer_load_dwordx4 v[220:223], v2, s[32:35], s16 offen offset:3072 sc1
    s_waitcnt lgkmcnt(8)
    v_mfma_f32_16x16x32_bf16 v[80:83], v[248:251], v[176:179], v[80:83]
    ds_read_b64_tr_b16 v[244:245], v69 offset:41600
    v_mfma_f32_16x16x32_bf16 v[84:87], v[248:251], v[180:183], v[84:87]
    ds_read_b64_tr_b16 v[246:247], v69 offset:42112
    v_mfma_f32_16x16x32_bf16 v[88:91], v[224:227], v[176:179], v[88:91]
    ds_read_b64_tr_b16 v[248:249], v69 offset:41632
    v_mfma_f32_16x16x32_bf16 v[92:95], v[224:227], v[180:183], v[92:95]
    ds_read_b64_tr_b16 v[250:251], v69 offset:42144
    s_waitcnt lgkmcnt(8)
    v_mfma_f32_16x16x32_bf16 v[96:99], v[228:231], v[176:179], v[96:99]
    ds_read_b64_tr_b16 v[224:225], v69 offset:37440
    v_mfma_f32_16x16x32_bf16 v[100:103], v[228:231], v[180:183], v[100:103]
    ds_read_b64_tr_b16 v[226:227], v69 offset:37952
    v_mfma_f32_16x16x32_bf16 v[104:107], v[232:235], v[176:179], v[104:107]
    ds_read_b64_tr_b16 v[228:229], v69 offset:37472
    v_mfma_f32_16x16x32_bf16 v[108:111], v[232:235], v[180:183], v[108:111]
    ds_read_b64_tr_b16 v[230:231], v69 offset:37984
    s_waitcnt lgkmcnt(8)
    v_mfma_f32_16x16x32_bf16 v[144:147], v[236:239], v[176:179], v[144:147]
    ds_read_b64_tr_b16 v[232:233], v68 offset:37440
    v_mfma_f32_16x16x32_bf16 v[148:151], v[236:239], v[180:183], v[148:151]
    ds_read_b64_tr_b16 v[234:235], v68 offset:37952
    v_mfma_f32_16x16x32_bf16 v[152:155], v[240:243], v[176:179], v[152:155]
    ds_read_b64_tr_b16 v[236:237], v68 offset:37472
    v_mfma_f32_16x16x32_bf16 v[156:159], v[240:243], v[180:183], v[156:159]
    ds_read_b64_tr_b16 v[238:239], v68 offset:37984
    s_waitcnt lgkmcnt(8)
    v_mfma_f32_16x16x32_bf16 v[160:163], v[244:247], v[176:179], v[160:163]
    ds_read_b64_tr_b16 v[240:241], v68 offset:29120
    v_mfma_f32_16x16x32_bf16 v[164:167], v[244:247], v[180:183], v[164:167]
    ds_read_b64_tr_b16 v[242:243], v68 offset:29632
    v_mfma_f32_16x16x32_bf16 v[168:171], v[248:251], v[176:179], v[168:171]
    ds_read_b64_tr_b16 v[244:245], v68 offset:29152
    v_mfma_f32_16x16x32_bf16 v[172:175], v[248:251], v[180:183], v[172:175]
    ds_read_b64_tr_b16 v[246:247], v68 offset:29664
    s_waitcnt lgkmcnt(8)
    s_waitcnt vmcnt(8)
    v_mfma_f32_16x16x32_bf16 v[128:131], v[224:227], v[184:187], v[128:131]
    ds_read_b64_tr_b16 v[248:249], v69 offset:29120
    v_mfma_f32_16x16x32_bf16 v[132:135], v[224:227], v[188:191], v[132:135]
    ds_read_b64_tr_b16 v[250:251], v69 offset:29632
    s_add_u32 s96, s85, 6
    s_and_b32 s97, s96, 15
    s_lshl_b32 s98, s97, 14
    s_add_u32 s16, s98, s15
    buffer_load_dwordx4 v[176:179], v2, s[32:35], s16 offen sc1
    v_mfma_f32_16x16x32_bf16 v[136:139], v[228:231], v[184:187], v[136:139]
    ds_read_b64_tr_b16 v[224:225], v69 offset:29152
    v_mfma_f32_16x16x32_bf16 v[140:143], v[228:231], v[188:191], v[140:143]
    ds_read_b64_tr_b16 v[226:227], v69 offset:29664
    s_waitcnt lgkmcnt(8)
    v_mfma_f32_16x16x32_bf16 v[112:115], v[232:235], v[184:187], v[112:115]
    ds_read_b64_tr_b16 v[228:229], v68 offset:45760
    v_mfma_f32_16x16x32_bf16 v[116:119], v[232:235], v[188:191], v[116:119]
    ds_read_b64_tr_b16 v[230:231], v68 offset:46272
    v_mfma_f32_16x16x32_bf16 v[120:123], v[236:239], v[184:187], v[120:123]
    ds_read_b64_tr_b16 v[232:233], v68 offset:45792
    v_mfma_f32_16x16x32_bf16 v[124:127], v[236:239], v[188:191], v[124:127]
    ds_read_b64_tr_b16 v[234:235], v68 offset:46304
    buffer_load_dwordx4 v[180:183], v2, s[32:35], s16 offen offset:1024 sc1
    s_waitcnt lgkmcnt(8)
    v_mfma_f32_16x16x32_bf16 v[80:83], v[240:243], v[184:187], v[80:83]
    ds_read_b64_tr_b16 v[236:237], v69 offset:45760
    v_mfma_f32_16x16x32_bf16 v[84:87], v[240:243], v[188:191], v[84:87]
    ds_read_b64_tr_b16 v[238:239], v69 offset:46272
    v_mfma_f32_16x16x32_bf16 v[88:91], v[244:247], v[184:187], v[88:91]
    ds_read_b64_tr_b16 v[240:241], v69 offset:45792
    v_mfma_f32_16x16x32_bf16 v[92:95], v[244:247], v[188:191], v[92:95]
    ds_read_b64_tr_b16 v[242:243], v69 offset:46304
    s_waitcnt lgkmcnt(8)
    v_mfma_f32_16x16x32_bf16 v[96:99], v[248:251], v[184:187], v[96:99]
    s_barrier
    ds_read_b64_tr_b16 v[244:245], v71 offset:8320
    v_mfma_f32_16x16x32_bf16 v[100:103], v[248:251], v[188:191], v[100:103]
    ds_read_b64_tr_b16 v[246:247], v71 offset:8832
    v_mfma_f32_16x16x32_bf16 v[104:107], v[224:227], v[184:187], v[104:107]
    ds_read_b64_tr_b16 v[248:249], v71 offset:8352
    v_mfma_f32_16x16x32_bf16 v[108:111], v[224:227], v[188:191], v[108:111]
    ds_read_b64_tr_b16 v[250:251], v71 offset:8864
    s_waitcnt lgkmcnt(8)
    v_mfma_f32_16x16x32_bf16 v[144:147], v[228:231], v[184:187], v[144:147]
    ds_read_b64_tr_b16 v[224:225], v70 offset:8320
    v_mfma_f32_16x16x32_bf16 v[148:151], v[228:231], v[188:191], v[148:151]
    ds_read_b64_tr_b16 v[226:227], v70 offset:8832
    v_mfma_f32_16x16x32_bf16 v[152:155], v[232:235], v[184:187], v[152:155]
    ds_read_b64_tr_b16 v[228:229], v70 offset:8352
    v_mfma_f32_16x16x32_bf16 v[156:159], v[232:235], v[188:191], v[156:159]
    ds_read_b64_tr_b16 v[230:231], v70 offset:8864
    s_waitcnt lgkmcnt(8)
    v_mfma_f32_16x16x32_bf16 v[160:163], v[236:239], v[184:187], v[160:163]
    ds_read_b64_tr_b16 v[232:233], v70
    v_mfma_f32_16x16x32_bf16 v[164:167], v[236:239], v[188:191], v[164:167]
    ds_read_b64_tr_b16 v[234:235], v70 offset:512
    v_mfma_f32_16x16x32_bf16 v[168:171], v[240:243], v[184:187], v[168:171]
    ds_read_b64_tr_b16 v[236:237], v70 offset:32
    v_mfma_f32_16x16x32_bf16 v[172:175], v[240:243], v[188:191], v[172:175]
    ds_read_b64_tr_b16 v[238:239], v70 offset:544
    s_waitcnt lgkmcnt(8)
    s_waitcnt vmcnt(8)
    v_mfma_f32_16x16x32_bf16 v[128:131], v[244:247], v[192:195], v[128:131]
    ds_read_b64_tr_b16 v[240:241], v71
    v_mfma_f32_16x16x32_bf16 v[132:135], v[244:247], v[196:199], v[132:135]
    ds_read_b64_tr_b16 v[242:243], v71 offset:512
    buffer_load_dwordx4 v[184:187], v2, s[32:35], s16 offen offset:2048 sc1
    v_mfma_f32_16x16x32_bf16 v[136:139], v[248:251], v[192:195], v[136:139]
    ds_read_b64_tr_b16 v[244:245], v71 offset:32
    v_mfma_f32_16x16x32_bf16 v[140:143], v[248:251], v[196:199], v[140:143]
    ds_read_b64_tr_b16 v[246:247], v71 offset:544
    s_waitcnt lgkmcnt(8)
    v_mfma_f32_16x16x32_bf16 v[112:115], v[224:227], v[192:195], v[112:115]
    ds_read_b64_tr_b16 v[248:249], v70 offset:16640
    v_mfma_f32_16x16x32_bf16 v[116:119], v[224:227], v[196:199], v[116:119]
    ds_read_b64_tr_b16 v[250:251], v70 offset:17152
    v_mfma_f32_16x16x32_bf16 v[120:123], v[228:231], v[192:195], v[120:123]
    ds_read_b64_tr_b16 v[224:225], v70 offset:16672
    v_mfma_f32_16x16x32_bf16 v[124:127], v[228:231], v[196:199], v[124:127]
    ds_read_b64_tr_b16 v[226:227], v70 offset:17184
    buffer_load_dwordx4 v[188:191], v2, s[32:35], s16 offen offset:3072 sc1
    s_waitcnt lgkmcnt(8)
    v_mfma_f32_16x16x32_bf16 v[80:83], v[232:235], v[192:195], v[80:83]
    ds_read_b64_tr_b16 v[228:229], v71 offset:16640
    v_mfma_f32_16x16x32_bf16 v[84:87], v[232:235], v[196:199], v[84:87]
    ds_read_b64_tr_b16 v[230:231], v71 offset:17152
    v_mfma_f32_16x16x32_bf16 v[88:91], v[236:239], v[192:195], v[88:91]
    ds_read_b64_tr_b16 v[232:233], v71 offset:16672
    v_mfma_f32_16x16x32_bf16 v[92:95], v[236:239], v[196:199], v[92:95]
    ds_read_b64_tr_b16 v[234:235], v71 offset:17184
    s_waitcnt lgkmcnt(8)
    v_mfma_f32_16x16x32_bf16 v[96:99], v[240:243], v[192:195], v[96:99]
    ds_read_b64_tr_b16 v[236:237], v71 offset:12480
    v_mfma_f32_16x16x32_bf16 v[100:103], v[240:243], v[196:199], v[100:103]
    ds_read_b64_tr_b16 v[238:239], v71 offset:12992
    v_mfma_f32_16x16x32_bf16 v[104:107], v[244:247], v[192:195], v[104:107]
    ds_read_b64_tr_b16 v[240:241], v71 offset:12512
    v_mfma_f32_16x16x32_bf16 v[108:111], v[244:247], v[196:199], v[108:111]
    ds_read_b64_tr_b16 v[242:243], v71 offset:13024
    s_waitcnt lgkmcnt(8)
    v_mfma_f32_16x16x32_bf16 v[144:147], v[248:251], v[192:195], v[144:147]
    ds_read_b64_tr_b16 v[244:245], v70 offset:12480
    v_mfma_f32_16x16x32_bf16 v[148:151], v[248:251], v[196:199], v[148:151]
    ds_read_b64_tr_b16 v[246:247], v70 offset:12992
    v_mfma_f32_16x16x32_bf16 v[152:155], v[224:227], v[192:195], v[152:155]
    ds_read_b64_tr_b16 v[248:249], v70 offset:12512
    v_mfma_f32_16x16x32_bf16 v[156:159], v[224:227], v[196:199], v[156:159]
    ds_read_b64_tr_b16 v[250:251], v70 offset:13024
    s_waitcnt lgkmcnt(8)
    v_mfma_f32_16x16x32_bf16 v[160:163], v[228:231], v[192:195], v[160:163]
    ds_read_b64_tr_b16 v[224:225], v70 offset:4160
    v_mfma_f32_16x16x32_bf16 v[164:167], v[228:231], v[196:199], v[164:167]
    ds_read_b64_tr_b16 v[226:227], v70 offset:4672
    v_mfma_f32_16x16x32_bf16 v[168:171], v[232:235], v[192:195], v[168:171]
    ds_read_b64_tr_b16 v[228:229], v70 offset:4192
    v_mfma_f32_16x16x32_bf16 v[172:175], v[232:235], v[196:199], v[172:175]
    ds_read_b64_tr_b16 v[230:231], v70 offset:4704
    s_waitcnt lgkmcnt(8)
    s_waitcnt vmcnt(8)
    v_mfma_f32_16x16x32_bf16 v[128:131], v[236:239], v[200:203], v[128:131]
    ds_read_b64_tr_b16 v[232:233], v71 offset:4160
    v_mfma_f32_16x16x32_bf16 v[132:135], v[236:239], v[204:207], v[132:135]
    ds_read_b64_tr_b16 v[234:235], v71 offset:4672
    s_add_u32 s96, s85, 7
    s_and_b32 s97, s96, 15
    s_lshl_b32 s98, s97, 14
    s_add_u32 s16, s98, s15
    buffer_load_dwordx4 v[192:195], v2, s[32:35], s16 offen sc1
    v_mfma_f32_16x16x32_bf16 v[136:139], v[240:243], v[200:203], v[136:139]
    ds_read_b64_tr_b16 v[236:237], v71 offset:4192
    v_mfma_f32_16x16x32_bf16 v[140:143], v[240:243], v[204:207], v[140:143]
    ds_read_b64_tr_b16 v[238:239], v71 offset:4704
    s_waitcnt lgkmcnt(8)
    v_mfma_f32_16x16x32_bf16 v[112:115], v[244:247], v[200:203], v[112:115]
    ds_read_b64_tr_b16 v[240:241], v70 offset:20800
    v_mfma_f32_16x16x32_bf16 v[116:119], v[244:247], v[204:207], v[116:119]
    ds_read_b64_tr_b16 v[242:243], v70 offset:21312
    v_mfma_f32_16x16x32_bf16 v[120:123], v[248:251], v[200:203], v[120:123]
    ds_read_b64_tr_b16 v[244:245], v70 offset:20832
    v_mfma_f32_16x16x32_bf16 v[124:127], v[248:251], v[204:207], v[124:127]
    ds_read_b64_tr_b16 v[246:247], v70 offset:21344
    buffer_load_dwordx4 v[196:199], v2, s[32:35], s16 offen offset:1024 sc1
    s_waitcnt lgkmcnt(8)
    v_mfma_f32_16x16x32_bf16 v[80:83], v[224:227], v[200:203], v[80:83]
    ds_read_b64_tr_b16 v[248:249], v71 offset:20800
    v_mfma_f32_16x16x32_bf16 v[84:87], v[224:227], v[204:207], v[84:87]
    ds_read_b64_tr_b16 v[250:251], v71 offset:21312
    v_mfma_f32_16x16x32_bf16 v[88:91], v[228:231], v[200:203], v[88:91]
    ds_read_b64_tr_b16 v[224:225], v71 offset:20832
    v_mfma_f32_16x16x32_bf16 v[92:95], v[228:231], v[204:207], v[92:95]
    ds_read_b64_tr_b16 v[226:227], v71 offset:21344
    s_waitcnt lgkmcnt(8)
    v_mfma_f32_16x16x32_bf16 v[96:99], v[232:235], v[200:203], v[96:99]
    s_barrier
    ds_read_b64_tr_b16 v[228:229], v71 offset:33280
    v_mfma_f32_16x16x32_bf16 v[100:103], v[232:235], v[204:207], v[100:103]
    ds_read_b64_tr_b16 v[230:231], v71 offset:33792
    v_mfma_f32_16x16x32_bf16 v[104:107], v[236:239], v[200:203], v[104:107]
    ds_read_b64_tr_b16 v[232:233], v71 offset:33312
    v_mfma_f32_16x16x32_bf16 v[108:111], v[236:239], v[204:207], v[108:111]
    ds_read_b64_tr_b16 v[234:235], v71 offset:33824
    s_waitcnt lgkmcnt(8)
    v_mfma_f32_16x16x32_bf16 v[144:147], v[240:243], v[200:203], v[144:147]
    ds_read_b64_tr_b16 v[236:237], v70 offset:33280
    v_mfma_f32_16x16x32_bf16 v[148:151], v[240:243], v[204:207], v[148:151]
    ds_read_b64_tr_b16 v[238:239], v70 offset:33792
    v_mfma_f32_16x16x32_bf16 v[152:155], v[244:247], v[200:203], v[152:155]
    ds_read_b64_tr_b16 v[240:241], v70 offset:33312
    v_mfma_f32_16x16x32_bf16 v[156:159], v[244:247], v[204:207], v[156:159]
    ds_read_b64_tr_b16 v[242:243], v70 offset:33824
    s_waitcnt lgkmcnt(8)
    v_mfma_f32_16x16x32_bf16 v[160:163], v[248:251], v[200:203], v[160:163]
    ds_read_b64_tr_b16 v[244:245], v70 offset:24960
    v_mfma_f32_16x16x32_bf16 v[164:167], v[248:251], v[204:207], v[164:167]
    ds_read_b64_tr_b16 v[246:247], v70 offset:25472
    v_mfma_f32_16x16x32_bf16 v[168:171], v[224:227], v[200:203], v[168:171]
    ds_read_b64_tr_b16 v[248:249], v70 offset:24992
    v_mfma_f32_16x16x32_bf16 v[172:175], v[224:227], v[204:207], v[172:175]
    ds_read_b64_tr_b16 v[250:251], v70 offset:25504
    s_waitcnt lgkmcnt(8)
    s_waitcnt vmcnt(8)
    v_mfma_f32_16x16x32_bf16 v[128:131], v[228:231], v[208:211], v[128:131]
    ds_read_b64_tr_b16 v[224:225], v71 offset:24960
    v_mfma_f32_16x16x32_bf16 v[132:135], v[228:231], v[212:215], v[132:135]
    ds_read_b64_tr_b16 v[226:227], v71 offset:25472
    buffer_load_dwordx4 v[200:203], v2, s[32:35], s16 offen offset:2048 sc1
    v_mfma_f32_16x16x32_bf16 v[136:139], v[232:235], v[208:211], v[136:139]
    ds_read_b64_tr_b16 v[228:229], v71 offset:24992
    v_mfma_f32_16x16x32_bf16 v[140:143], v[232:235], v[212:215], v[140:143]
    ds_read_b64_tr_b16 v[230:231], v71 offset:25504
    s_waitcnt lgkmcnt(8)
    v_mfma_f32_16x16x32_bf16 v[112:115], v[236:239], v[208:211], v[112:115]
    ds_read_b64_tr_b16 v[232:233], v70 offset:41600
    v_mfma_f32_16x16x32_bf16 v[116:119], v[236:239], v[212:215], v[116:119]
    ds_read_b64_tr_b16 v[234:235], v70 offset:42112
    v_mfma_f32_16x16x32_bf16 v[120:123], v[240:243], v[208:211], v[120:123]
    ds_read_b64_tr_b16 v[236:237], v70 offset:41632
    v_mfma_f32_16x16x32_bf16 v[124:127], v[240:243], v[212:215], v[124:127]
    ds_read_b64_tr_b16 v[238:239], v70 offset:42144
    buffer_load_dwordx4 v[204:207], v2, s[32:35], s16 offen offset:3072 sc1
    s_waitcnt lgkmcnt(8)
    v_mfma_f32_16x16x32_bf16 v[80:83], v[244:247], v[208:211], v[80:83]
    ds_read_b64_tr_b16 v[240:241], v71 offset:41600
    v_mfma_f32_16x16x32_bf16 v[84:87], v[244:247], v[212:215], v[84:87]
    ds_read_b64_tr_b16 v[242:243], v71 offset:42112
    v_mfma_f32_16x16x32_bf16 v[88:91], v[248:251], v[208:211], v[88:91]
    ds_read_b64_tr_b16 v[244:245], v71 offset:41632
    v_mfma_f32_16x16x32_bf16 v[92:95], v[248:251], v[212:215], v[92:95]
    ds_read_b64_tr_b16 v[246:247], v71 offset:42144
    s_waitcnt lgkmcnt(8)
    v_mfma_f32_16x16x32_bf16 v[96:99], v[224:227], v[208:211], v[96:99]
    ds_read_b64_tr_b16 v[248:249], v71 offset:37440
    v_mfma_f32_16x16x32_bf16 v[100:103], v[224:227], v[212:215], v[100:103]
    ds_read_b64_tr_b16 v[250:251], v71 offset:37952
    v_mfma_f32_16x16x32_bf16 v[104:107], v[228:231], v[208:211], v[104:107]
    ds_read_b64_tr_b16 v[224:225], v71 offset:37472
    v_mfma_f32_16x16x32_bf16 v[108:111], v[228:231], v[212:215], v[108:111]
    ds_read_b64_tr_b16 v[226:227], v71 offset:37984
    s_waitcnt lgkmcnt(8)
    v_mfma_f32_16x16x32_bf16 v[144:147], v[232:235], v[208:211], v[144:147]
    ds_read_b64_tr_b16 v[228:229], v70 offset:37440
    v_mfma_f32_16x16x32_bf16 v[148:151], v[232:235], v[212:215], v[148:151]
    ds_read_b64_tr_b16 v[230:231], v70 offset:37952
    v_mfma_f32_16x16x32_bf16 v[152:155], v[236:239], v[208:211], v[152:155]
    ds_read_b64_tr_b16 v[232:233], v70 offset:37472
    v_mfma_f32_16x16x32_bf16 v[156:159], v[236:239], v[212:215], v[156:159]
    ds_read_b64_tr_b16 v[234:235], v70 offset:37984
    s_waitcnt lgkmcnt(8)
    v_mfma_f32_16x16x32_bf16 v[160:163], v[240:243], v[208:211], v[160:163]
    ds_read_b64_tr_b16 v[236:237], v70 offset:29120
    v_mfma_f32_16x16x32_bf16 v[164:167], v[240:243], v[212:215], v[164:167]
    ds_read_b64_tr_b16 v[238:239], v70 offset:29632
    v_mfma_f32_16x16x32_bf16 v[168:171], v[244:247], v[208:211], v[168:171]
    ds_read_b64_tr_b16 v[240:241], v70 offset:29152
    v_mfma_f32_16x16x32_bf16 v[172:175], v[244:247], v[212:215], v[172:175]
    ds_read_b64_tr_b16 v[242:243], v70 offset:29664
    s_waitcnt lgkmcnt(8)
    s_waitcnt vmcnt(8)
    v_mfma_f32_16x16x32_bf16 v[128:131], v[248:251], v[216:219], v[128:131]
    ds_read_b64_tr_b16 v[244:245], v71 offset:29120
    v_mfma_f32_16x16x32_bf16 v[132:135], v[248:251], v[220:223], v[132:135]
    ds_read_b64_tr_b16 v[246:247], v71 offset:29632
    s_add_u32 s96, s85, 8
    s_and_b32 s97, s96, 15
    s_lshl_b32 s98, s97, 14
    s_add_u32 s16, s98, s15
    buffer_load_dwordx4 v[208:211], v2, s[32:35], s16 offen sc1
    v_mfma_f32_16x16x32_bf16 v[136:139], v[224:227], v[216:219], v[136:139]
    ds_read_b64_tr_b16 v[248:249], v71 offset:29152
    v_mfma_f32_16x16x32_bf16 v[140:143], v[224:227], v[220:223], v[140:143]
    ds_read_b64_tr_b16 v[250:251], v71 offset:29664
    s_waitcnt lgkmcnt(8)
    v_mfma_f32_16x16x32_bf16 v[112:115], v[228:231], v[216:219], v[112:115]
    ds_read_b64_tr_b16 v[224:225], v70 offset:45760
    v_mfma_f32_16x16x32_bf16 v[116:119], v[228:231], v[220:223], v[116:119]
    ds_read_b64_tr_b16 v[226:227], v70 offset:46272
    v_mfma_f32_16x16x32_bf16 v[120:123], v[232:235], v[216:219], v[120:123]
    ds_read_b64_tr_b16 v[228:229], v70 offset:45792
    v_mfma_f32_16x16x32_bf16 v[124:127], v[232:235], v[220:223], v[124:127]
    ds_read_b64_tr_b16 v[230:231], v70 offset:46304
    buffer_load_dwordx4 v[212:215], v2, s[32:35], s16 offen offset:1024 sc1
    s_waitcnt lgkmcnt(8)
    v_mfma_f32_16x16x32_bf16 v[80:83], v[236:239], v[216:219], v[80:83]
    ds_read_b64_tr_b16 v[232:233], v71 offset:45760
    v_mfma_f32_16x16x32_bf16 v[84:87], v[236:239], v[220:223], v[84:87]
    ds_read_b64_tr_b16 v[234:235], v71 offset:46272
    v_mfma_f32_16x16x32_bf16 v[88:91], v[240:243], v[216:219], v[88:91]
    ds_read_b64_tr_b16 v[236:237], v71 offset:45792
    v_mfma_f32_16x16x32_bf16 v[92:95], v[240:243], v[220:223], v[92:95]
    ds_read_b64_tr_b16 v[238:239], v71 offset:46304
    s_waitcnt lgkmcnt(8)
    v_mfma_f32_16x16x32_bf16 v[96:99], v[244:247], v[216:219], v[96:99]
    s_barrier
    ds_read_b64_tr_b16 v[240:241], v67 offset:8320
    v_mfma_f32_16x16x32_bf16 v[100:103], v[244:247], v[220:223], v[100:103]
    ds_read_b64_tr_b16 v[242:243], v67 offset:8832
    v_mfma_f32_16x16x32_bf16 v[104:107], v[248:251], v[216:219], v[104:107]
    ds_read_b64_tr_b16 v[244:245], v67 offset:8352
    v_mfma_f32_16x16x32_bf16 v[108:111], v[248:251], v[220:223], v[108:111]
    ds_read_b64_tr_b16 v[246:247], v67 offset:8864
    s_waitcnt lgkmcnt(8)
    v_mfma_f32_16x16x32_bf16 v[144:147], v[224:227], v[216:219], v[144:147]
    ds_read_b64_tr_b16 v[248:249], v66 offset:8320
    v_mfma_f32_16x16x32_bf16 v[148:151], v[224:227], v[220:223], v[148:151]
    ds_read_b64_tr_b16 v[250:251], v66 offset:8832
    v_mfma_f32_16x16x32_bf16 v[152:155], v[228:231], v[216:219], v[152:155]
    ds_read_b64_tr_b16 v[224:225], v66 offset:8352
    v_mfma_f32_16x16x32_bf16 v[156:159], v[228:231], v[220:223], v[156:159]
    ds_read_b64_tr_b16 v[226:227], v66 offset:8864
    s_waitcnt lgkmcnt(8)
    v_mfma_f32_16x16x32_bf16 v[160:163], v[232:235], v[216:219], v[160:163]
    ds_read_b64_tr_b16 v[228:229], v66
    v_mfma_f32_16x16x32_bf16 v[164:167], v[232:235], v[220:223], v[164:167]
    ds_read_b64_tr_b16 v[230:231], v66 offset:512
    v_mfma_f32_16x16x32_bf16 v[168:171], v[236:239], v[216:219], v[168:171]
    ds_read_b64_tr_b16 v[232:233], v66 offset:32
    v_mfma_f32_16x16x32_bf16 v[172:175], v[236:239], v[220:223], v[172:175]
    ds_read_b64_tr_b16 v[234:235], v66 offset:544
    s_waitcnt lgkmcnt(8)
    s_waitcnt vmcnt(8)
    v_mfma_f32_16x16x32_bf16 v[128:131], v[240:243], v[176:179], v[128:131]
    ds_read_b64_tr_b16 v[236:237], v67
    v_mfma_f32_16x16x32_bf16 v[132:135], v[240:243], v[180:183], v[132:135]
    ds_read_b64_tr_b16 v[238:239], v67 offset:512
    buffer_load_dwordx4 v[216:219], v2, s[32:35], s16 offen offset:2048 sc1
    v_mfma_f32_16x16x32_bf16 v[136:139], v[244:247], v[176:179], v[136:139]
    ds_read_b64_tr_b16 v[240:241], v67 offset:32
    v_mfma_f32_16x16x32_bf16 v[140:143], v[244:247], v[180:183], v[140:143]
    ds_read_b64_tr_b16 v[242:243], v67 offset:544
    s_waitcnt lgkmcnt(8)
    v_mfma_f32_16x16x32_bf16 v[112:115], v[248:251], v[176:179], v[112:115]
    ds_read_b64_tr_b16 v[244:245], v66 offset:16640
    v_mfma_f32_16x16x32_bf16 v[116:119], v[248:251], v[180:183], v[116:119]
    ds_read_b64_tr_b16 v[246:247], v66 offset:17152
    v_mfma_f32_16x16x32_bf16 v[120:123], v[224:227], v[176:179], v[120:123]
    ds_read_b64_tr_b16 v[248:249], v66 offset:16672
    v_mfma_f32_16x16x32_bf16 v[124:127], v[224:227], v[180:183], v[124:127]
    ds_read_b64_tr_b16 v[250:251], v66 offset:17184
    buffer_load_dwordx4 v[220:223], v2, s[32:35], s16 offen offset:3072 sc1
    s_waitcnt lgkmcnt(8)
    v_mfma_f32_16x16x32_bf16 v[80:83], v[228:231], v[176:179], v[80:83]
    ds_read_b64_tr_b16 v[224:225], v67 offset:16640
    v_mfma_f32_16x16x32_bf16 v[84:87], v[228:231], v[180:183], v[84:87]
    ds_read_b64_tr_b16 v[226:227], v67 offset:17152
    v_mfma_f32_16x16x32_bf16 v[88:91], v[232:235], v[176:179], v[88:91]
    ds_read_b64_tr_b16 v[228:229], v67 offset:16672
    v_mfma_f32_16x16x32_bf16 v[92:95], v[232:235], v[180:183], v[92:95]
    ds_read_b64_tr_b16 v[230:231], v67 offset:17184
    s_waitcnt lgkmcnt(8)
    v_mfma_f32_16x16x32_bf16 v[96:99], v[236:239], v[176:179], v[96:99]
    ds_read_b64_tr_b16 v[232:233], v67 offset:12480
    v_mfma_f32_16x16x32_bf16 v[100:103], v[236:239], v[180:183], v[100:103]
    ds_read_b64_tr_b16 v[234:235], v67 offset:12992
    v_mfma_f32_16x16x32_bf16 v[104:107], v[240:243], v[176:179], v[104:107]
    ds_read_b64_tr_b16 v[236:237], v67 offset:12512
    v_mfma_f32_16x16x32_bf16 v[108:111], v[240:243], v[180:183], v[108:111]
    ds_read_b64_tr_b16 v[238:239], v67 offset:13024
    s_waitcnt lgkmcnt(8)
    v_mfma_f32_16x16x32_bf16 v[144:147], v[244:247], v[176:179], v[144:147]
    ds_read_b64_tr_b16 v[240:241], v66 offset:12480
    v_mfma_f32_16x16x32_bf16 v[148:151], v[244:247], v[180:183], v[148:151]
    ds_read_b64_tr_b16 v[242:243], v66 offset:12992
    v_mfma_f32_16x16x32_bf16 v[152:155], v[248:251], v[176:179], v[152:155]
    ds_read_b64_tr_b16 v[244:245], v66 offset:12512
    v_mfma_f32_16x16x32_bf16 v[156:159], v[248:251], v[180:183], v[156:159]
    ds_read_b64_tr_b16 v[246:247], v66 offset:13024
    s_waitcnt lgkmcnt(8)
    v_mfma_f32_16x16x32_bf16 v[160:163], v[224:227], v[176:179], v[160:163]
    ds_read_b64_tr_b16 v[248:249], v66 offset:4160
    v_mfma_f32_16x16x32_bf16 v[164:167], v[224:227], v[180:183], v[164:167]
    ds_read_b64_tr_b16 v[250:251], v66 offset:4672
    v_mfma_f32_16x16x32_bf16 v[168:171], v[228:231], v[176:179], v[168:171]
    ds_read_b64_tr_b16 v[224:225], v66 offset:4192
    v_mfma_f32_16x16x32_bf16 v[172:175], v[228:231], v[180:183], v[172:175]
    ds_read_b64_tr_b16 v[226:227], v66 offset:4704
    s_waitcnt lgkmcnt(8)
    s_waitcnt vmcnt(8)
    v_mfma_f32_16x16x32_bf16 v[128:131], v[232:235], v[184:187], v[128:131]
    ds_read_b64_tr_b16 v[228:229], v67 offset:4160
    v_mfma_f32_16x16x32_bf16 v[132:135], v[232:235], v[188:191], v[132:135]
    ds_read_b64_tr_b16 v[230:231], v67 offset:4672
    s_add_u32 s96, s85, 9
    s_and_b32 s97, s96, 15
    s_lshl_b32 s98, s97, 14
    s_add_u32 s16, s98, s15
    buffer_load_dwordx4 v[176:179], v2, s[32:35], s16 offen sc1
    v_mfma_f32_16x16x32_bf16 v[136:139], v[236:239], v[184:187], v[136:139]
    ds_read_b64_tr_b16 v[232:233], v67 offset:4192
    v_mfma_f32_16x16x32_bf16 v[140:143], v[236:239], v[188:191], v[140:143]
    ds_read_b64_tr_b16 v[234:235], v67 offset:4704
    s_waitcnt lgkmcnt(8)
    v_mfma_f32_16x16x32_bf16 v[112:115], v[240:243], v[184:187], v[112:115]
    ds_read_b64_tr_b16 v[236:237], v66 offset:20800
    v_mfma_f32_16x16x32_bf16 v[116:119], v[240:243], v[188:191], v[116:119]
    ds_read_b64_tr_b16 v[238:239], v66 offset:21312
    v_mfma_f32_16x16x32_bf16 v[120:123], v[244:247], v[184:187], v[120:123]
    ds_read_b64_tr_b16 v[240:241], v66 offset:20832
    v_mfma_f32_16x16x32_bf16 v[124:127], v[244:247], v[188:191], v[124:127]
    ds_read_b64_tr_b16 v[242:243], v66 offset:21344
    buffer_load_dwordx4 v[180:183], v2, s[32:35], s16 offen offset:1024 sc1
    s_waitcnt lgkmcnt(8)
    v_mfma_f32_16x16x32_bf16 v[80:83], v[248:251], v[184:187], v[80:83]
    ds_read_b64_tr_b16 v[244:245], v67 offset:20800
    v_mfma_f32_16x16x32_bf16 v[84:87], v[248:251], v[188:191], v[84:87]
    ds_read_b64_tr_b16 v[246:247], v67 offset:21312
    v_mfma_f32_16x16x32_bf16 v[88:91], v[224:227], v[184:187], v[88:91]
    ds_read_b64_tr_b16 v[248:249], v67 offset:20832
    v_mfma_f32_16x16x32_bf16 v[92:95], v[224:227], v[188:191], v[92:95]
    ds_read_b64_tr_b16 v[250:251], v67 offset:21344
    s_waitcnt lgkmcnt(8)
    v_mfma_f32_16x16x32_bf16 v[96:99], v[228:231], v[184:187], v[96:99]
    s_barrier
    ds_read_b64_tr_b16 v[224:225], v67 offset:33280
    v_mfma_f32_16x16x32_bf16 v[100:103], v[228:231], v[188:191], v[100:103]
    ds_read_b64_tr_b16 v[226:227], v67 offset:33792
    v_mfma_f32_16x16x32_bf16 v[104:107], v[232:235], v[184:187], v[104:107]
    ds_read_b64_tr_b16 v[228:229], v67 offset:33312
    v_mfma_f32_16x16x32_bf16 v[108:111], v[232:235], v[188:191], v[108:111]
    ds_read_b64_tr_b16 v[230:231], v67 offset:33824
    s_waitcnt lgkmcnt(8)
    v_mfma_f32_16x16x32_bf16 v[144:147], v[236:239], v[184:187], v[144:147]
    ds_read_b64_tr_b16 v[232:233], v66 offset:33280
    v_mfma_f32_16x16x32_bf16 v[148:151], v[236:239], v[188:191], v[148:151]
    ds_read_b64_tr_b16 v[234:235], v66 offset:33792
    v_mfma_f32_16x16x32_bf16 v[152:155], v[240:243], v[184:187], v[152:155]
    ds_read_b64_tr_b16 v[236:237], v66 offset:33312
    v_mfma_f32_16x16x32_bf16 v[156:159], v[240:243], v[188:191], v[156:159]
    ds_read_b64_tr_b16 v[238:239], v66 offset:33824
    s_waitcnt lgkmcnt(8)
    v_mfma_f32_16x16x32_bf16 v[160:163], v[244:247], v[184:187], v[160:163]
    ds_read_b64_tr_b16 v[240:241], v66 offset:24960
    v_mfma_f32_16x16x32_bf16 v[164:167], v[244:247], v[188:191], v[164:167]
    ds_read_b64_tr_b16 v[242:243], v66 offset:25472
    v_mfma_f32_16x16x32_bf16 v[168:171], v[248:251], v[184:187], v[168:171]
    ds_read_b64_tr_b16 v[244:245], v66 offset:24992
    v_mfma_f32_16x16x32_bf16 v[172:175], v[248:251], v[188:191], v[172:175]
    ds_read_b64_tr_b16 v[246:247], v66 offset:25504
    s_waitcnt lgkmcnt(8)
    s_waitcnt vmcnt(8)
    v_mfma_f32_16x16x32_bf16 v[128:131], v[224:227], v[192:195], v[128:131]
    ds_read_b64_tr_b16 v[248:249], v67 offset:24960
    v_mfma_f32_16x16x32_bf16 v[132:135], v[224:227], v[196:199], v[132:135]
    ds_read_b64_tr_b16 v[250:251], v67 offset:25472
    buffer_load_dwordx4 v[184:187], v2, s[32:35], s16 offen offset:2048 sc1
    v_mfma_f32_16x16x32_bf16 v[136:139], v[228:231], v[192:195], v[136:139]
    ds_read_b64_tr_b16 v[224:225], v67 offset:24992
    v_mfma_f32_16x16x32_bf16 v[140:143], v[228:231], v[196:199], v[140:143]
    ds_read_b64_tr_b16 v[226:227], v67 offset:25504
    s_waitcnt lgkmcnt(8)
    v_mfma_f32_16x16x32_bf16 v[112:115], v[232:235], v[192:195], v[112:115]
    ds_read_b64_tr_b16 v[228:229], v66 offset:41600
    v_mfma_f32_16x16x32_bf16 v[116:119], v[232:235], v[196:199], v[116:119]
    ds_read_b64_tr_b16 v[230:231], v66 offset:42112
    v_mfma_f32_16x16x32_bf16 v[120:123], v[236:239], v[192:195], v[120:123]
    ds_read_b64_tr_b16 v[232:233], v66 offset:41632
    v_mfma_f32_16x16x32_bf16 v[124:127], v[236:239], v[196:199], v[124:127]
    ds_read_b64_tr_b16 v[234:235], v66 offset:42144
    buffer_load_dwordx4 v[188:191], v2, s[32:35], s16 offen offset:3072 sc1
    s_waitcnt lgkmcnt(8)
    v_mfma_f32_16x16x32_bf16 v[80:83], v[240:243], v[192:195], v[80:83]
    ds_read_b64_tr_b16 v[236:237], v67 offset:41600
    v_mfma_f32_16x16x32_bf16 v[84:87], v[240:243], v[196:199], v[84:87]
    ds_read_b64_tr_b16 v[238:239], v67 offset:42112
    v_mfma_f32_16x16x32_bf16 v[88:91], v[244:247], v[192:195], v[88:91]
    ds_read_b64_tr_b16 v[240:241], v67 offset:41632
    v_mfma_f32_16x16x32_bf16 v[92:95], v[244:247], v[196:199], v[92:95]
    ds_read_b64_tr_b16 v[242:243], v67 offset:42144
    s_waitcnt lgkmcnt(8)
    v_mfma_f32_16x16x32_bf16 v[96:99], v[248:251], v[192:195], v[96:99]
    ds_read_b64_tr_b16 v[244:245], v67 offset:37440
    v_mfma_f32_16x16x32_bf16 v[100:103], v[248:251], v[196:199], v[100:103]
    ds_read_b64_tr_b16 v[246:247], v67 offset:37952
    v_mfma_f32_16x16x32_bf16 v[104:107], v[224:227], v[192:195], v[104:107]
    ds_read_b64_tr_b16 v[248:249], v67 offset:37472
    v_mfma_f32_16x16x32_bf16 v[108:111], v[224:227], v[196:199], v[108:111]
    ds_read_b64_tr_b16 v[250:251], v67 offset:37984
    s_waitcnt lgkmcnt(8)
    v_mfma_f32_16x16x32_bf16 v[144:147], v[228:231], v[192:195], v[144:147]
    ds_read_b64_tr_b16 v[224:225], v66 offset:37440
    v_mfma_f32_16x16x32_bf16 v[148:151], v[228:231], v[196:199], v[148:151]
    ds_read_b64_tr_b16 v[226:227], v66 offset:37952
    v_mfma_f32_16x16x32_bf16 v[152:155], v[232:235], v[192:195], v[152:155]
    ds_read_b64_tr_b16 v[228:229], v66 offset:37472
    v_mfma_f32_16x16x32_bf16 v[156:159], v[232:235], v[196:199], v[156:159]
    ds_read_b64_tr_b16 v[230:231], v66 offset:37984
    s_waitcnt lgkmcnt(8)
    v_mfma_f32_16x16x32_bf16 v[160:163], v[236:239], v[192:195], v[160:163]
    ds_read_b64_tr_b16 v[232:233], v66 offset:29120
    v_mfma_f32_16x16x32_bf16 v[164:167], v[236:239], v[196:199], v[164:167]
    ds_read_b64_tr_b16 v[234:235], v66 offset:29632
    v_mfma_f32_16x16x32_bf16 v[168:171], v[240:243], v[192:195], v[168:171]
    ds_read_b64_tr_b16 v[236:237], v66 offset:29152
    v_mfma_f32_16x16x32_bf16 v[172:175], v[240:243], v[196:199], v[172:175]
    ds_read_b64_tr_b16 v[238:239], v66 offset:29664
    s_waitcnt lgkmcnt(8)
    s_waitcnt vmcnt(8)
    v_mfma_f32_16x16x32_bf16 v[128:131], v[244:247], v[200:203], v[128:131]
    ds_read_b64_tr_b16 v[240:241], v67 offset:29120
    v_mfma_f32_16x16x32_bf16 v[132:135], v[244:247], v[204:207], v[132:135]
    ds_read_b64_tr_b16 v[242:243], v67 offset:29632
    s_add_u32 s96, s85, 10
    s_and_b32 s97, s96, 15
    s_lshl_b32 s98, s97, 14
    s_add_u32 s16, s98, s15
    buffer_load_dwordx4 v[192:195], v2, s[32:35], s16 offen sc1
    v_mfma_f32_16x16x32_bf16 v[136:139], v[248:251], v[200:203], v[136:139]
    ds_read_b64_tr_b16 v[244:245], v67 offset:29152
    v_mfma_f32_16x16x32_bf16 v[140:143], v[248:251], v[204:207], v[140:143]
    ds_read_b64_tr_b16 v[246:247], v67 offset:29664
    s_waitcnt lgkmcnt(8)
    v_mfma_f32_16x16x32_bf16 v[112:115], v[224:227], v[200:203], v[112:115]
    ds_read_b64_tr_b16 v[248:249], v66 offset:45760
    v_mfma_f32_16x16x32_bf16 v[116:119], v[224:227], v[204:207], v[116:119]
    ds_read_b64_tr_b16 v[250:251], v66 offset:46272
    v_mfma_f32_16x16x32_bf16 v[120:123], v[228:231], v[200:203], v[120:123]
    ds_read_b64_tr_b16 v[224:225], v66 offset:45792
    v_mfma_f32_16x16x32_bf16 v[124:127], v[228:231], v[204:207], v[124:127]
    ds_read_b64_tr_b16 v[226:227], v66 offset:46304
    buffer_load_dwordx4 v[196:199], v2, s[32:35], s16 offen offset:1024 sc1
    s_waitcnt lgkmcnt(8)
    v_mfma_f32_16x16x32_bf16 v[80:83], v[232:235], v[200:203], v[80:83]
    ds_read_b64_tr_b16 v[228:229], v67 offset:45760
    v_mfma_f32_16x16x32_bf16 v[84:87], v[232:235], v[204:207], v[84:87]
    ds_read_b64_tr_b16 v[230:231], v67 offset:46272
    v_mfma_f32_16x16x32_bf16 v[88:91], v[236:239], v[200:203], v[88:91]
    ds_read_b64_tr_b16 v[232:233], v67 offset:45792
    v_mfma_f32_16x16x32_bf16 v[92:95], v[236:239], v[204:207], v[92:95]
    ds_read_b64_tr_b16 v[234:235], v67 offset:46304
    s_waitcnt lgkmcnt(8)
    v_mfma_f32_16x16x32_bf16 v[96:99], v[240:243], v[200:203], v[96:99]
    s_barrier
    ds_read_b64_tr_b16 v[236:237], v69 offset:8320
    v_mfma_f32_16x16x32_bf16 v[100:103], v[240:243], v[204:207], v[100:103]
    ds_read_b64_tr_b16 v[238:239], v69 offset:8832
    v_mfma_f32_16x16x32_bf16 v[104:107], v[244:247], v[200:203], v[104:107]
    ds_read_b64_tr_b16 v[240:241], v69 offset:8352
    v_mfma_f32_16x16x32_bf16 v[108:111], v[244:247], v[204:207], v[108:111]
    ds_read_b64_tr_b16 v[242:243], v69 offset:8864
    s_waitcnt lgkmcnt(8)
    v_mfma_f32_16x16x32_bf16 v[144:147], v[248:251], v[200:203], v[144:147]
    ds_read_b64_tr_b16 v[244:245], v68 offset:8320
    v_mfma_f32_16x16x32_bf16 v[148:151], v[248:251], v[204:207], v[148:151]
    ds_read_b64_tr_b16 v[246:247], v68 offset:8832
    v_mfma_f32_16x16x32_bf16 v[152:155], v[224:227], v[200:203], v[152:155]
    ds_read_b64_tr_b16 v[248:249], v68 offset:8352
    v_mfma_f32_16x16x32_bf16 v[156:159], v[224:227], v[204:207], v[156:159]
    ds_read_b64_tr_b16 v[250:251], v68 offset:8864
    s_waitcnt lgkmcnt(8)
    v_mfma_f32_16x16x32_bf16 v[160:163], v[228:231], v[200:203], v[160:163]
    ds_read_b64_tr_b16 v[224:225], v68
    v_mfma_f32_16x16x32_bf16 v[164:167], v[228:231], v[204:207], v[164:167]
    ds_read_b64_tr_b16 v[226:227], v68 offset:512
    v_mfma_f32_16x16x32_bf16 v[168:171], v[232:235], v[200:203], v[168:171]
    ds_read_b64_tr_b16 v[228:229], v68 offset:32
    v_mfma_f32_16x16x32_bf16 v[172:175], v[232:235], v[204:207], v[172:175]
    ds_read_b64_tr_b16 v[230:231], v68 offset:544
    s_waitcnt lgkmcnt(8)
    s_waitcnt vmcnt(8)
    v_mfma_f32_16x16x32_bf16 v[128:131], v[236:239], v[208:211], v[128:131]
    ds_read_b64_tr_b16 v[232:233], v69
    v_mfma_f32_16x16x32_bf16 v[132:135], v[236:239], v[212:215], v[132:135]
    ds_read_b64_tr_b16 v[234:235], v69 offset:512
    buffer_load_dwordx4 v[200:203], v2, s[32:35], s16 offen offset:2048 sc1
    v_mfma_f32_16x16x32_bf16 v[136:139], v[240:243], v[208:211], v[136:139]
    ds_read_b64_tr_b16 v[236:237], v69 offset:32
    v_mfma_f32_16x16x32_bf16 v[140:143], v[240:243], v[212:215], v[140:143]
    ds_read_b64_tr_b16 v[238:239], v69 offset:544
    s_waitcnt lgkmcnt(8)
    v_mfma_f32_16x16x32_bf16 v[112:115], v[244:247], v[208:211], v[112:115]
    ds_read_b64_tr_b16 v[240:241], v68 offset:16640
    v_mfma_f32_16x16x32_bf16 v[116:119], v[244:247], v[212:215], v[116:119]
    ds_read_b64_tr_b16 v[242:243], v68 offset:17152
    v_mfma_f32_16x16x32_bf16 v[120:123], v[248:251], v[208:211], v[120:123]
    ds_read_b64_tr_b16 v[244:245], v68 offset:16672
    v_mfma_f32_16x16x32_bf16 v[124:127], v[248:251], v[212:215], v[124:127]
    ds_read_b64_tr_b16 v[246:247], v68 offset:17184
    buffer_load_dwordx4 v[204:207], v2, s[32:35], s16 offen offset:3072 sc1
    s_waitcnt lgkmcnt(8)
    v_mfma_f32_16x16x32_bf16 v[80:83], v[224:227], v[208:211], v[80:83]
    ds_read_b64_tr_b16 v[248:249], v69 offset:16640
    v_mfma_f32_16x16x32_bf16 v[84:87], v[224:227], v[212:215], v[84:87]
    ds_read_b64_tr_b16 v[250:251], v69 offset:17152
    v_mfma_f32_16x16x32_bf16 v[88:91], v[228:231], v[208:211], v[88:91]
    ds_read_b64_tr_b16 v[224:225], v69 offset:16672
    v_mfma_f32_16x16x32_bf16 v[92:95], v[228:231], v[212:215], v[92:95]
    ds_read_b64_tr_b16 v[226:227], v69 offset:17184
    s_waitcnt lgkmcnt(8)
    v_mfma_f32_16x16x32_bf16 v[96:99], v[232:235], v[208:211], v[96:99]
    ds_read_b64_tr_b16 v[228:229], v69 offset:12480
    v_mfma_f32_16x16x32_bf16 v[100:103], v[232:235], v[212:215], v[100:103]
    ds_read_b64_tr_b16 v[230:231], v69 offset:12992
    v_mfma_f32_16x16x32_bf16 v[104:107], v[236:239], v[208:211], v[104:107]
    ds_read_b64_tr_b16 v[232:233], v69 offset:12512
    v_mfma_f32_16x16x32_bf16 v[108:111], v[236:239], v[212:215], v[108:111]
    ds_read_b64_tr_b16 v[234:235], v69 offset:13024
    s_waitcnt lgkmcnt(8)
    v_mfma_f32_16x16x32_bf16 v[144:147], v[240:243], v[208:211], v[144:147]
    ds_read_b64_tr_b16 v[236:237], v68 offset:12480
    v_mfma_f32_16x16x32_bf16 v[148:151], v[240:243], v[212:215], v[148:151]
    ds_read_b64_tr_b16 v[238:239], v68 offset:12992
    v_mfma_f32_16x16x32_bf16 v[152:155], v[244:247], v[208:211], v[152:155]
    ds_read_b64_tr_b16 v[240:241], v68 offset:12512
    v_mfma_f32_16x16x32_bf16 v[156:159], v[244:247], v[212:215], v[156:159]
    ds_read_b64_tr_b16 v[242:243], v68 offset:13024
    s_waitcnt lgkmcnt(8)
    v_mfma_f32_16x16x32_bf16 v[160:163], v[248:251], v[208:211], v[160:163]
    ds_read_b64_tr_b16 v[244:245], v68 offset:4160
    v_mfma_f32_16x16x32_bf16 v[164:167], v[248:251], v[212:215], v[164:167]
    ds_read_b64_tr_b16 v[246:247], v68 offset:4672
    v_mfma_f32_16x16x32_bf16 v[168:171], v[224:227], v[208:211], v[168:171]
    ds_read_b64_tr_b16 v[248:249], v68 offset:4192
    v_mfma_f32_16x16x32_bf16 v[172:175], v[224:227], v[212:215], v[172:175]
    ds_read_b64_tr_b16 v[250:251], v68 offset:4704
    s_waitcnt lgkmcnt(8)
    s_waitcnt vmcnt(8)
    v_mfma_f32_16x16x32_bf16 v[128:131], v[228:231], v[216:219], v[128:131]
    ds_read_b64_tr_b16 v[224:225], v69 offset:4160
    v_mfma_f32_16x16x32_bf16 v[132:135], v[228:231], v[220:223], v[132:135]
    ds_read_b64_tr_b16 v[226:227], v69 offset:4672
    s_add_u32 s96, s85, 11
    s_and_b32 s97, s96, 15
    s_lshl_b32 s98, s97, 14
    s_add_u32 s16, s98, s15
    buffer_load_dwordx4 v[208:211], v2, s[32:35], s16 offen sc1
    v_mfma_f32_16x16x32_bf16 v[136:139], v[232:235], v[216:219], v[136:139]
    ds_read_b64_tr_b16 v[228:229], v69 offset:4192
    v_mfma_f32_16x16x32_bf16 v[140:143], v[232:235], v[220:223], v[140:143]
    ds_read_b64_tr_b16 v[230:231], v69 offset:4704
    s_waitcnt lgkmcnt(8)
    v_mfma_f32_16x16x32_bf16 v[112:115], v[236:239], v[216:219], v[112:115]
    ds_read_b64_tr_b16 v[232:233], v68 offset:20800
    v_mfma_f32_16x16x32_bf16 v[116:119], v[236:239], v[220:223], v[116:119]
    ds_read_b64_tr_b16 v[234:235], v68 offset:21312
    v_mfma_f32_16x16x32_bf16 v[120:123], v[240:243], v[216:219], v[120:123]
    ds_read_b64_tr_b16 v[236:237], v68 offset:20832
    v_mfma_f32_16x16x32_bf16 v[124:127], v[240:243], v[220:223], v[124:127]
    ds_read_b64_tr_b16 v[238:239], v68 offset:21344
    buffer_load_dwordx4 v[212:215], v2, s[32:35], s16 offen offset:1024 sc1
    s_waitcnt lgkmcnt(8)
    v_mfma_f32_16x16x32_bf16 v[80:83], v[244:247], v[216:219], v[80:83]
    ds_read_b64_tr_b16 v[240:241], v69 offset:20800
    v_mfma_f32_16x16x32_bf16 v[84:87], v[244:247], v[220:223], v[84:87]
    ds_read_b64_tr_b16 v[242:243], v69 offset:21312
    v_mfma_f32_16x16x32_bf16 v[88:91], v[248:251], v[216:219], v[88:91]
    ds_read_b64_tr_b16 v[244:245], v69 offset:20832
    v_mfma_f32_16x16x32_bf16 v[92:95], v[248:251], v[220:223], v[92:95]
    ds_read_b64_tr_b16 v[246:247], v69 offset:21344
    s_waitcnt lgkmcnt(8)
    v_mfma_f32_16x16x32_bf16 v[96:99], v[224:227], v[216:219], v[96:99]
    s_barrier
    ds_read_b64_tr_b16 v[248:249], v69 offset:33280
    v_mfma_f32_16x16x32_bf16 v[100:103], v[224:227], v[220:223], v[100:103]
    ds_read_b64_tr_b16 v[250:251], v69 offset:33792
    v_mfma_f32_16x16x32_bf16 v[104:107], v[228:231], v[216:219], v[104:107]
    ds_read_b64_tr_b16 v[224:225], v69 offset:33312
    v_mfma_f32_16x16x32_bf16 v[108:111], v[228:231], v[220:223], v[108:111]
    ds_read_b64_tr_b16 v[226:227], v69 offset:33824
    s_waitcnt lgkmcnt(8)
    v_mfma_f32_16x16x32_bf16 v[144:147], v[232:235], v[216:219], v[144:147]
    ds_read_b64_tr_b16 v[228:229], v68 offset:33280
    v_mfma_f32_16x16x32_bf16 v[148:151], v[232:235], v[220:223], v[148:151]
    ds_read_b64_tr_b16 v[230:231], v68 offset:33792
    v_mfma_f32_16x16x32_bf16 v[152:155], v[236:239], v[216:219], v[152:155]
    ds_read_b64_tr_b16 v[232:233], v68 offset:33312
    v_mfma_f32_16x16x32_bf16 v[156:159], v[236:239], v[220:223], v[156:159]
    ds_read_b64_tr_b16 v[234:235], v68 offset:33824
    s_waitcnt lgkmcnt(8)
    v_mfma_f32_16x16x32_bf16 v[160:163], v[240:243], v[216:219], v[160:163]
    ds_read_b64_tr_b16 v[236:237], v68 offset:24960
    v_mfma_f32_16x16x32_bf16 v[164:167], v[240:243], v[220:223], v[164:167]
    ds_read_b64_tr_b16 v[238:239], v68 offset:25472
    v_mfma_f32_16x16x32_bf16 v[168:171], v[244:247], v[216:219], v[168:171]
    ds_read_b64_tr_b16 v[240:241], v68 offset:24992
    v_mfma_f32_16x16x32_bf16 v[172:175], v[244:247], v[220:223], v[172:175]
    ds_read_b64_tr_b16 v[242:243], v68 offset:25504
    s_waitcnt lgkmcnt(8)
    s_waitcnt vmcnt(8)
    v_mfma_f32_16x16x32_bf16 v[128:131], v[248:251], v[176:179], v[128:131]
    ds_read_b64_tr_b16 v[244:245], v69 offset:24960
    v_mfma_f32_16x16x32_bf16 v[132:135], v[248:251], v[180:183], v[132:135]
    ds_read_b64_tr_b16 v[246:247], v69 offset:25472
    buffer_load_dwordx4 v[216:219], v2, s[32:35], s16 offen offset:2048 sc1
    v_mfma_f32_16x16x32_bf16 v[136:139], v[224:227], v[176:179], v[136:139]
    ds_read_b64_tr_b16 v[248:249], v69 offset:24992
    v_mfma_f32_16x16x32_bf16 v[140:143], v[224:227], v[180:183], v[140:143]
    ds_read_b64_tr_b16 v[250:251], v69 offset:25504
    s_waitcnt lgkmcnt(8)
    v_mfma_f32_16x16x32_bf16 v[112:115], v[228:231], v[176:179], v[112:115]
    ds_read_b64_tr_b16 v[224:225], v68 offset:41600
    v_mfma_f32_16x16x32_bf16 v[116:119], v[228:231], v[180:183], v[116:119]
    ds_read_b64_tr_b16 v[226:227], v68 offset:42112
    v_mfma_f32_16x16x32_bf16 v[120:123], v[232:235], v[176:179], v[120:123]
    ds_read_b64_tr_b16 v[228:229], v68 offset:41632
    v_mfma_f32_16x16x32_bf16 v[124:127], v[232:235], v[180:183], v[124:127]
    ds_read_b64_tr_b16 v[230:231], v68 offset:42144
    buffer_load_dwordx4 v[220:223], v2, s[32:35], s16 offen offset:3072 sc1
    s_waitcnt lgkmcnt(8)
    v_mfma_f32_16x16x32_bf16 v[80:83], v[236:239], v[176:179], v[80:83]
    ds_read_b64_tr_b16 v[232:233], v69 offset:41600
    v_mfma_f32_16x16x32_bf16 v[84:87], v[236:239], v[180:183], v[84:87]
    ds_read_b64_tr_b16 v[234:235], v69 offset:42112
    v_mfma_f32_16x16x32_bf16 v[88:91], v[240:243], v[176:179], v[88:91]
    ds_read_b64_tr_b16 v[236:237], v69 offset:41632
    v_mfma_f32_16x16x32_bf16 v[92:95], v[240:243], v[180:183], v[92:95]
    ds_read_b64_tr_b16 v[238:239], v69 offset:42144
    s_waitcnt lgkmcnt(8)
    v_mfma_f32_16x16x32_bf16 v[96:99], v[244:247], v[176:179], v[96:99]
    ds_read_b64_tr_b16 v[240:241], v69 offset:37440
    v_mfma_f32_16x16x32_bf16 v[100:103], v[244:247], v[180:183], v[100:103]
    ds_read_b64_tr_b16 v[242:243], v69 offset:37952
    v_mfma_f32_16x16x32_bf16 v[104:107], v[248:251], v[176:179], v[104:107]
    ds_read_b64_tr_b16 v[244:245], v69 offset:37472
    v_mfma_f32_16x16x32_bf16 v[108:111], v[248:251], v[180:183], v[108:111]
    ds_read_b64_tr_b16 v[246:247], v69 offset:37984
    s_waitcnt lgkmcnt(8)
    v_mfma_f32_16x16x32_bf16 v[144:147], v[224:227], v[176:179], v[144:147]
    ds_read_b64_tr_b16 v[248:249], v68 offset:37440
    v_mfma_f32_16x16x32_bf16 v[148:151], v[224:227], v[180:183], v[148:151]
    ds_read_b64_tr_b16 v[250:251], v68 offset:37952
    v_mfma_f32_16x16x32_bf16 v[152:155], v[228:231], v[176:179], v[152:155]
    ds_read_b64_tr_b16 v[224:225], v68 offset:37472
    v_mfma_f32_16x16x32_bf16 v[156:159], v[228:231], v[180:183], v[156:159]
    ds_read_b64_tr_b16 v[226:227], v68 offset:37984
    s_waitcnt lgkmcnt(8)
    v_mfma_f32_16x16x32_bf16 v[160:163], v[232:235], v[176:179], v[160:163]
    ds_read_b64_tr_b16 v[228:229], v68 offset:29120
    v_mfma_f32_16x16x32_bf16 v[164:167], v[232:235], v[180:183], v[164:167]
    ds_read_b64_tr_b16 v[230:231], v68 offset:29632
    v_mfma_f32_16x16x32_bf16 v[168:171], v[236:239], v[176:179], v[168:171]
    ds_read_b64_tr_b16 v[232:233], v68 offset:29152
    v_mfma_f32_16x16x32_bf16 v[172:175], v[236:239], v[180:183], v[172:175]
    ds_read_b64_tr_b16 v[234:235], v68 offset:29664
    s_waitcnt lgkmcnt(8)
    s_waitcnt vmcnt(8)
    v_mfma_f32_16x16x32_bf16 v[128:131], v[240:243], v[184:187], v[128:131]
    ds_read_b64_tr_b16 v[236:237], v69 offset:29120
    v_mfma_f32_16x16x32_bf16 v[132:135], v[240:243], v[188:191], v[132:135]
    ds_read_b64_tr_b16 v[238:239], v69 offset:29632
    s_add_u32 s96, s85, 12
    s_and_b32 s97, s96, 15
    s_lshl_b32 s98, s97, 14
    s_add_u32 s16, s98, s15
    buffer_load_dwordx4 v[176:179], v2, s[32:35], s16 offen sc1
    v_mfma_f32_16x16x32_bf16 v[136:139], v[244:247], v[184:187], v[136:139]
    ds_read_b64_tr_b16 v[240:241], v69 offset:29152
    v_mfma_f32_16x16x32_bf16 v[140:143], v[244:247], v[188:191], v[140:143]
    ds_read_b64_tr_b16 v[242:243], v69 offset:29664
    s_waitcnt lgkmcnt(8)
    v_mfma_f32_16x16x32_bf16 v[112:115], v[248:251], v[184:187], v[112:115]
    ds_read_b64_tr_b16 v[244:245], v68 offset:45760
    v_mfma_f32_16x16x32_bf16 v[116:119], v[248:251], v[188:191], v[116:119]
    ds_read_b64_tr_b16 v[246:247], v68 offset:46272
    v_mfma_f32_16x16x32_bf16 v[120:123], v[224:227], v[184:187], v[120:123]
    ds_read_b64_tr_b16 v[248:249], v68 offset:45792
    v_mfma_f32_16x16x32_bf16 v[124:127], v[224:227], v[188:191], v[124:127]
    ds_read_b64_tr_b16 v[250:251], v68 offset:46304
    buffer_load_dwordx4 v[180:183], v2, s[32:35], s16 offen offset:1024 sc1
    s_waitcnt lgkmcnt(8)
    v_mfma_f32_16x16x32_bf16 v[80:83], v[228:231], v[184:187], v[80:83]
    ds_read_b64_tr_b16 v[224:225], v69 offset:45760
    v_mfma_f32_16x16x32_bf16 v[84:87], v[228:231], v[188:191], v[84:87]
    ds_read_b64_tr_b16 v[226:227], v69 offset:46272
    v_mfma_f32_16x16x32_bf16 v[88:91], v[232:235], v[184:187], v[88:91]
    ds_read_b64_tr_b16 v[228:229], v69 offset:45792
    v_mfma_f32_16x16x32_bf16 v[92:95], v[232:235], v[188:191], v[92:95]
    ds_read_b64_tr_b16 v[230:231], v69 offset:46304
    s_waitcnt lgkmcnt(8)
    v_mfma_f32_16x16x32_bf16 v[96:99], v[236:239], v[184:187], v[96:99]
    s_barrier
    ds_read_b64_tr_b16 v[232:233], v71 offset:8320
    v_mfma_f32_16x16x32_bf16 v[100:103], v[236:239], v[188:191], v[100:103]
    ds_read_b64_tr_b16 v[234:235], v71 offset:8832
    v_mfma_f32_16x16x32_bf16 v[104:107], v[240:243], v[184:187], v[104:107]
    ds_read_b64_tr_b16 v[236:237], v71 offset:8352
    v_mfma_f32_16x16x32_bf16 v[108:111], v[240:243], v[188:191], v[108:111]
    ds_read_b64_tr_b16 v[238:239], v71 offset:8864
    s_waitcnt lgkmcnt(8)
    v_mfma_f32_16x16x32_bf16 v[144:147], v[244:247], v[184:187], v[144:147]
    ds_read_b64_tr_b16 v[240:241], v70 offset:8320
    v_mfma_f32_16x16x32_bf16 v[148:151], v[244:247], v[188:191], v[148:151]
    ds_read_b64_tr_b16 v[242:243], v70 offset:8832
    v_mfma_f32_16x16x32_bf16 v[152:155], v[248:251], v[184:187], v[152:155]
    ds_read_b64_tr_b16 v[244:245], v70 offset:8352
    v_mfma_f32_16x16x32_bf16 v[156:159], v[248:251], v[188:191], v[156:159]
    ds_read_b64_tr_b16 v[246:247], v70 offset:8864
    s_waitcnt lgkmcnt(8)
    v_mfma_f32_16x16x32_bf16 v[160:163], v[224:227], v[184:187], v[160:163]
    ds_read_b64_tr_b16 v[248:249], v70
    v_mfma_f32_16x16x32_bf16 v[164:167], v[224:227], v[188:191], v[164:167]
    ds_read_b64_tr_b16 v[250:251], v70 offset:512
    v_mfma_f32_16x16x32_bf16 v[168:171], v[228:231], v[184:187], v[168:171]
    ds_read_b64_tr_b16 v[224:225], v70 offset:32
    v_mfma_f32_16x16x32_bf16 v[172:175], v[228:231], v[188:191], v[172:175]
    ds_read_b64_tr_b16 v[226:227], v70 offset:544
    s_waitcnt lgkmcnt(8)
    s_waitcnt vmcnt(8)
    v_mfma_f32_16x16x32_bf16 v[128:131], v[232:235], v[192:195], v[128:131]
    ds_read_b64_tr_b16 v[228:229], v71
    v_mfma_f32_16x16x32_bf16 v[132:135], v[232:235], v[196:199], v[132:135]
    ds_read_b64_tr_b16 v[230:231], v71 offset:512
    buffer_load_dwordx4 v[184:187], v2, s[32:35], s16 offen offset:2048 sc1
    v_mfma_f32_16x16x32_bf16 v[136:139], v[236:239], v[192:195], v[136:139]
    ds_read_b64_tr_b16 v[232:233], v71 offset:32
    v_mfma_f32_16x16x32_bf16 v[140:143], v[236:239], v[196:199], v[140:143]
    ds_read_b64_tr_b16 v[234:235], v71 offset:544
    s_waitcnt lgkmcnt(8)
    v_mfma_f32_16x16x32_bf16 v[112:115], v[240:243], v[192:195], v[112:115]
    ds_read_b64_tr_b16 v[236:237], v70 offset:16640
    v_mfma_f32_16x16x32_bf16 v[116:119], v[240:243], v[196:199], v[116:119]
    ds_read_b64_tr_b16 v[238:239], v70 offset:17152
    v_mfma_f32_16x16x32_bf16 v[120:123], v[244:247], v[192:195], v[120:123]
    ds_read_b64_tr_b16 v[240:241], v70 offset:16672
    v_mfma_f32_16x16x32_bf16 v[124:127], v[244:247], v[196:199], v[124:127]
    ds_read_b64_tr_b16 v[242:243], v70 offset:17184
    buffer_load_dwordx4 v[188:191], v2, s[32:35], s16 offen offset:3072 sc1
    s_waitcnt lgkmcnt(8)
    v_mfma_f32_16x16x32_bf16 v[80:83], v[248:251], v[192:195], v[80:83]
    ds_read_b64_tr_b16 v[244:245], v71 offset:16640
    v_mfma_f32_16x16x32_bf16 v[84:87], v[248:251], v[196:199], v[84:87]
    ds_read_b64_tr_b16 v[246:247], v71 offset:17152
    v_mfma_f32_16x16x32_bf16 v[88:91], v[224:227], v[192:195], v[88:91]
    ds_read_b64_tr_b16 v[248:249], v71 offset:16672
    v_mfma_f32_16x16x32_bf16 v[92:95], v[224:227], v[196:199], v[92:95]
    ds_read_b64_tr_b16 v[250:251], v71 offset:17184
    s_waitcnt lgkmcnt(8)
    v_mfma_f32_16x16x32_bf16 v[96:99], v[228:231], v[192:195], v[96:99]
    ds_read_b64_tr_b16 v[224:225], v71 offset:12480
    v_mfma_f32_16x16x32_bf16 v[100:103], v[228:231], v[196:199], v[100:103]
    ds_read_b64_tr_b16 v[226:227], v71 offset:12992
    v_mfma_f32_16x16x32_bf16 v[104:107], v[232:235], v[192:195], v[104:107]
    ds_read_b64_tr_b16 v[228:229], v71 offset:12512
    v_mfma_f32_16x16x32_bf16 v[108:111], v[232:235], v[196:199], v[108:111]
    ds_read_b64_tr_b16 v[230:231], v71 offset:13024
    s_waitcnt lgkmcnt(8)
    v_mfma_f32_16x16x32_bf16 v[144:147], v[236:239], v[192:195], v[144:147]
    ds_read_b64_tr_b16 v[232:233], v70 offset:12480
    v_mfma_f32_16x16x32_bf16 v[148:151], v[236:239], v[196:199], v[148:151]
    ds_read_b64_tr_b16 v[234:235], v70 offset:12992
    v_mfma_f32_16x16x32_bf16 v[152:155], v[240:243], v[192:195], v[152:155]
    ds_read_b64_tr_b16 v[236:237], v70 offset:12512
    v_mfma_f32_16x16x32_bf16 v[156:159], v[240:243], v[196:199], v[156:159]
    ds_read_b64_tr_b16 v[238:239], v70 offset:13024
    s_waitcnt lgkmcnt(8)
    v_mfma_f32_16x16x32_bf16 v[160:163], v[244:247], v[192:195], v[160:163]
    ds_read_b64_tr_b16 v[240:241], v70 offset:4160
    v_mfma_f32_16x16x32_bf16 v[164:167], v[244:247], v[196:199], v[164:167]
    ds_read_b64_tr_b16 v[242:243], v70 offset:4672
    v_mfma_f32_16x16x32_bf16 v[168:171], v[248:251], v[192:195], v[168:171]
    ds_read_b64_tr_b16 v[244:245], v70 offset:4192
    v_mfma_f32_16x16x32_bf16 v[172:175], v[248:251], v[196:199], v[172:175]
    ds_read_b64_tr_b16 v[246:247], v70 offset:4704
    s_waitcnt lgkmcnt(8)
    s_waitcnt vmcnt(8)
    v_mfma_f32_16x16x32_bf16 v[128:131], v[224:227], v[200:203], v[128:131]
    ds_read_b64_tr_b16 v[248:249], v71 offset:4160
    v_mfma_f32_16x16x32_bf16 v[132:135], v[224:227], v[204:207], v[132:135]
    ds_read_b64_tr_b16 v[250:251], v71 offset:4672
    s_add_u32 s96, s85, 13
    s_and_b32 s97, s96, 15
    s_lshl_b32 s98, s97, 14
    s_add_u32 s16, s98, s15
    buffer_load_dwordx4 v[192:195], v2, s[32:35], s16 offen sc1
    v_mfma_f32_16x16x32_bf16 v[136:139], v[228:231], v[200:203], v[136:139]
    ds_read_b64_tr_b16 v[224:225], v71 offset:4192
    v_mfma_f32_16x16x32_bf16 v[140:143], v[228:231], v[204:207], v[140:143]
    ds_read_b64_tr_b16 v[226:227], v71 offset:4704
    s_waitcnt lgkmcnt(8)
    v_mfma_f32_16x16x32_bf16 v[112:115], v[232:235], v[200:203], v[112:115]
    ds_read_b64_tr_b16 v[228:229], v70 offset:20800
    v_mfma_f32_16x16x32_bf16 v[116:119], v[232:235], v[204:207], v[116:119]
    ds_read_b64_tr_b16 v[230:231], v70 offset:21312
    v_mfma_f32_16x16x32_bf16 v[120:123], v[236:239], v[200:203], v[120:123]
    ds_read_b64_tr_b16 v[232:233], v70 offset:20832
    v_mfma_f32_16x16x32_bf16 v[124:127], v[236:239], v[204:207], v[124:127]
    ds_read_b64_tr_b16 v[234:235], v70 offset:21344
    buffer_load_dwordx4 v[196:199], v2, s[32:35], s16 offen offset:1024 sc1
    s_waitcnt lgkmcnt(8)
    v_mfma_f32_16x16x32_bf16 v[80:83], v[240:243], v[200:203], v[80:83]
    ds_read_b64_tr_b16 v[236:237], v71 offset:20800
    v_mfma_f32_16x16x32_bf16 v[84:87], v[240:243], v[204:207], v[84:87]
    ds_read_b64_tr_b16 v[238:239], v71 offset:21312
    v_mfma_f32_16x16x32_bf16 v[88:91], v[244:247], v[200:203], v[88:91]
    ds_read_b64_tr_b16 v[240:241], v71 offset:20832
    v_mfma_f32_16x16x32_bf16 v[92:95], v[244:247], v[204:207], v[92:95]
    ds_read_b64_tr_b16 v[242:243], v71 offset:21344
    s_waitcnt lgkmcnt(8)
    v_mfma_f32_16x16x32_bf16 v[96:99], v[248:251], v[200:203], v[96:99]
    s_barrier
    ds_read_b64_tr_b16 v[244:245], v71 offset:33280
    v_mfma_f32_16x16x32_bf16 v[100:103], v[248:251], v[204:207], v[100:103]
    ds_read_b64_tr_b16 v[246:247], v71 offset:33792
    v_mfma_f32_16x16x32_bf16 v[104:107], v[224:227], v[200:203], v[104:107]
    ds_read_b64_tr_b16 v[248:249], v71 offset:33312
    v_mfma_f32_16x16x32_bf16 v[108:111], v[224:227], v[204:207], v[108:111]
    ds_read_b64_tr_b16 v[250:251], v71 offset:33824
    s_waitcnt lgkmcnt(8)
    v_mfma_f32_16x16x32_bf16 v[144:147], v[228:231], v[200:203], v[144:147]
    ds_read_b64_tr_b16 v[224:225], v70 offset:33280
    v_mfma_f32_16x16x32_bf16 v[148:151], v[228:231], v[204:207], v[148:151]
    ds_read_b64_tr_b16 v[226:227], v70 offset:33792
    v_mfma_f32_16x16x32_bf16 v[152:155], v[232:235], v[200:203], v[152:155]
    ds_read_b64_tr_b16 v[228:229], v70 offset:33312
    v_mfma_f32_16x16x32_bf16 v[156:159], v[232:235], v[204:207], v[156:159]
    ds_read_b64_tr_b16 v[230:231], v70 offset:33824
    s_waitcnt lgkmcnt(8)
    v_mfma_f32_16x16x32_bf16 v[160:163], v[236:239], v[200:203], v[160:163]
    ds_read_b64_tr_b16 v[232:233], v70 offset:24960
    v_mfma_f32_16x16x32_bf16 v[164:167], v[236:239], v[204:207], v[164:167]
    ds_read_b64_tr_b16 v[234:235], v70 offset:25472
    v_mfma_f32_16x16x32_bf16 v[168:171], v[240:243], v[200:203], v[168:171]
    ds_read_b64_tr_b16 v[236:237], v70 offset:24992
    v_mfma_f32_16x16x32_bf16 v[172:175], v[240:243], v[204:207], v[172:175]
    ds_read_b64_tr_b16 v[238:239], v70 offset:25504
    s_waitcnt lgkmcnt(8)
    s_waitcnt vmcnt(8)
    v_mfma_f32_16x16x32_bf16 v[128:131], v[244:247], v[208:211], v[128:131]
    ds_read_b64_tr_b16 v[240:241], v71 offset:24960
    v_mfma_f32_16x16x32_bf16 v[132:135], v[244:247], v[212:215], v[132:135]
    ds_read_b64_tr_b16 v[242:243], v71 offset:25472
    buffer_load_dwordx4 v[200:203], v2, s[32:35], s16 offen offset:2048 sc1
    v_mfma_f32_16x16x32_bf16 v[136:139], v[248:251], v[208:211], v[136:139]
    ds_read_b64_tr_b16 v[244:245], v71 offset:24992
    v_mfma_f32_16x16x32_bf16 v[140:143], v[248:251], v[212:215], v[140:143]
    ds_read_b64_tr_b16 v[246:247], v71 offset:25504
    s_waitcnt lgkmcnt(8)
    v_mfma_f32_16x16x32_bf16 v[112:115], v[224:227], v[208:211], v[112:115]
    ds_read_b64_tr_b16 v[248:249], v70 offset:41600
    v_mfma_f32_16x16x32_bf16 v[116:119], v[224:227], v[212:215], v[116:119]
    ds_read_b64_tr_b16 v[250:251], v70 offset:42112
    v_mfma_f32_16x16x32_bf16 v[120:123], v[228:231], v[208:211], v[120:123]
    ds_read_b64_tr_b16 v[224:225], v70 offset:41632
    v_mfma_f32_16x16x32_bf16 v[124:127], v[228:231], v[212:215], v[124:127]
    ds_read_b64_tr_b16 v[226:227], v70 offset:42144
    buffer_load_dwordx4 v[204:207], v2, s[32:35], s16 offen offset:3072 sc1
    s_waitcnt lgkmcnt(8)
    v_mfma_f32_16x16x32_bf16 v[80:83], v[232:235], v[208:211], v[80:83]
    ds_read_b64_tr_b16 v[228:229], v71 offset:41600
    v_mfma_f32_16x16x32_bf16 v[84:87], v[232:235], v[212:215], v[84:87]
    ds_read_b64_tr_b16 v[230:231], v71 offset:42112
    v_mfma_f32_16x16x32_bf16 v[88:91], v[236:239], v[208:211], v[88:91]
    ds_read_b64_tr_b16 v[232:233], v71 offset:41632
    v_mfma_f32_16x16x32_bf16 v[92:95], v[236:239], v[212:215], v[92:95]
    ds_read_b64_tr_b16 v[234:235], v71 offset:42144
    s_waitcnt lgkmcnt(8)
    v_mfma_f32_16x16x32_bf16 v[96:99], v[240:243], v[208:211], v[96:99]
    ds_read_b64_tr_b16 v[236:237], v71 offset:37440
    v_mfma_f32_16x16x32_bf16 v[100:103], v[240:243], v[212:215], v[100:103]
    ds_read_b64_tr_b16 v[238:239], v71 offset:37952
    v_mfma_f32_16x16x32_bf16 v[104:107], v[244:247], v[208:211], v[104:107]
    ds_read_b64_tr_b16 v[240:241], v71 offset:37472
    v_mfma_f32_16x16x32_bf16 v[108:111], v[244:247], v[212:215], v[108:111]
    ds_read_b64_tr_b16 v[242:243], v71 offset:37984
    s_waitcnt lgkmcnt(8)
    v_mfma_f32_16x16x32_bf16 v[144:147], v[248:251], v[208:211], v[144:147]
    ds_read_b64_tr_b16 v[244:245], v70 offset:37440
    v_mfma_f32_16x16x32_bf16 v[148:151], v[248:251], v[212:215], v[148:151]
    ds_read_b64_tr_b16 v[246:247], v70 offset:37952
    v_mfma_f32_16x16x32_bf16 v[152:155], v[224:227], v[208:211], v[152:155]
    ds_read_b64_tr_b16 v[248:249], v70 offset:37472
    v_mfma_f32_16x16x32_bf16 v[156:159], v[224:227], v[212:215], v[156:159]
    ds_read_b64_tr_b16 v[250:251], v70 offset:37984
    s_waitcnt lgkmcnt(8)
    v_mfma_f32_16x16x32_bf16 v[160:163], v[228:231], v[208:211], v[160:163]
    ds_read_b64_tr_b16 v[224:225], v70 offset:29120
    v_mfma_f32_16x16x32_bf16 v[164:167], v[228:231], v[212:215], v[164:167]
    ds_read_b64_tr_b16 v[226:227], v70 offset:29632
    v_mfma_f32_16x16x32_bf16 v[168:171], v[232:235], v[208:211], v[168:171]
    ds_read_b64_tr_b16 v[228:229], v70 offset:29152
    v_mfma_f32_16x16x32_bf16 v[172:175], v[232:235], v[212:215], v[172:175]
    ds_read_b64_tr_b16 v[230:231], v70 offset:29664
    s_waitcnt lgkmcnt(8)
    s_waitcnt vmcnt(8)
    v_mfma_f32_16x16x32_bf16 v[128:131], v[236:239], v[216:219], v[128:131]
    ds_read_b64_tr_b16 v[232:233], v71 offset:29120
    v_mfma_f32_16x16x32_bf16 v[132:135], v[236:239], v[220:223], v[132:135]
    ds_read_b64_tr_b16 v[234:235], v71 offset:29632
    s_add_u32 s96, s85, 14
    s_and_b32 s97, s96, 15
    s_lshl_b32 s98, s97, 14
    s_add_u32 s16, s98, s15
    buffer_load_dwordx4 v[208:211], v2, s[32:35], s16 offen sc1
    v_mfma_f32_16x16x32_bf16 v[136:139], v[240:243], v[216:219], v[136:139]
    ds_read_b64_tr_b16 v[236:237], v71 offset:29152
    v_mfma_f32_16x16x32_bf16 v[140:143], v[240:243], v[220:223], v[140:143]
    ds_read_b64_tr_b16 v[238:239], v71 offset:29664
    s_waitcnt lgkmcnt(8)
    v_mfma_f32_16x16x32_bf16 v[112:115], v[244:247], v[216:219], v[112:115]
    ds_read_b64_tr_b16 v[240:241], v70 offset:45760
    v_mfma_f32_16x16x32_bf16 v[116:119], v[244:247], v[220:223], v[116:119]
    ds_read_b64_tr_b16 v[242:243], v70 offset:46272
    v_mfma_f32_16x16x32_bf16 v[120:123], v[248:251], v[216:219], v[120:123]
    ds_read_b64_tr_b16 v[244:245], v70 offset:45792
    v_mfma_f32_16x16x32_bf16 v[124:127], v[248:251], v[220:223], v[124:127]
    ds_read_b64_tr_b16 v[246:247], v70 offset:46304
    buffer_load_dwordx4 v[212:215], v2, s[32:35], s16 offen offset:1024 sc1
    s_waitcnt lgkmcnt(8)
    v_mfma_f32_16x16x32_bf16 v[80:83], v[224:227], v[216:219], v[80:83]
    ds_read_b64_tr_b16 v[248:249], v71 offset:45760
    v_mfma_f32_16x16x32_bf16 v[84:87], v[224:227], v[220:223], v[84:87]
    ds_read_b64_tr_b16 v[250:251], v71 offset:46272
    v_mfma_f32_16x16x32_bf16 v[88:91], v[228:231], v[216:219], v[88:91]
    ds_read_b64_tr_b16 v[224:225], v71 offset:45792
    v_mfma_f32_16x16x32_bf16 v[92:95], v[228:231], v[220:223], v[92:95]
    ds_read_b64_tr_b16 v[226:227], v71 offset:46304
    s_waitcnt lgkmcnt(8)
    v_mfma_f32_16x16x32_bf16 v[96:99], v[232:235], v[216:219], v[96:99]
    s_barrier
    ds_read_b64_tr_b16 v[228:229], v67 offset:8320
    v_mfma_f32_16x16x32_bf16 v[100:103], v[232:235], v[220:223], v[100:103]
    ds_read_b64_tr_b16 v[230:231], v67 offset:8832
    v_mfma_f32_16x16x32_bf16 v[104:107], v[236:239], v[216:219], v[104:107]
    ds_read_b64_tr_b16 v[232:233], v67 offset:8352
    v_mfma_f32_16x16x32_bf16 v[108:111], v[236:239], v[220:223], v[108:111]
    ds_read_b64_tr_b16 v[234:235], v67 offset:8864
    s_waitcnt lgkmcnt(8)
    v_mfma_f32_16x16x32_bf16 v[144:147], v[240:243], v[216:219], v[144:147]
    ds_read_b64_tr_b16 v[236:237], v66 offset:8320
    v_mfma_f32_16x16x32_bf16 v[148:151], v[240:243], v[220:223], v[148:151]
    ds_read_b64_tr_b16 v[238:239], v66 offset:8832
    v_mfma_f32_16x16x32_bf16 v[152:155], v[244:247], v[216:219], v[152:155]
    ds_read_b64_tr_b16 v[240:241], v66 offset:8352
    v_mfma_f32_16x16x32_bf16 v[156:159], v[244:247], v[220:223], v[156:159]
    ds_read_b64_tr_b16 v[242:243], v66 offset:8864
    s_waitcnt lgkmcnt(8)
    v_mfma_f32_16x16x32_bf16 v[160:163], v[248:251], v[216:219], v[160:163]
    ds_read_b64_tr_b16 v[244:245], v66
    v_mfma_f32_16x16x32_bf16 v[164:167], v[248:251], v[220:223], v[164:167]
    ds_read_b64_tr_b16 v[246:247], v66 offset:512
    v_mfma_f32_16x16x32_bf16 v[168:171], v[224:227], v[216:219], v[168:171]
    ds_read_b64_tr_b16 v[248:249], v66 offset:32
    v_mfma_f32_16x16x32_bf16 v[172:175], v[224:227], v[220:223], v[172:175]
    ds_read_b64_tr_b16 v[250:251], v66 offset:544
    s_waitcnt lgkmcnt(8)
    s_waitcnt vmcnt(8)
    v_mfma_f32_16x16x32_bf16 v[128:131], v[228:231], v[176:179], v[128:131]
    ds_read_b64_tr_b16 v[224:225], v67
    v_mfma_f32_16x16x32_bf16 v[132:135], v[228:231], v[180:183], v[132:135]
    ds_read_b64_tr_b16 v[226:227], v67 offset:512
    buffer_load_dwordx4 v[216:219], v2, s[32:35], s16 offen offset:2048 sc1
    v_mfma_f32_16x16x32_bf16 v[136:139], v[232:235], v[176:179], v[136:139]
    ds_read_b64_tr_b16 v[228:229], v67 offset:32
    v_mfma_f32_16x16x32_bf16 v[140:143], v[232:235], v[180:183], v[140:143]
    ds_read_b64_tr_b16 v[230:231], v67 offset:544
    s_waitcnt lgkmcnt(8)
    v_mfma_f32_16x16x32_bf16 v[112:115], v[236:239], v[176:179], v[112:115]
    ds_read_b64_tr_b16 v[232:233], v66 offset:16640
    v_mfma_f32_16x16x32_bf16 v[116:119], v[236:239], v[180:183], v[116:119]
    ds_read_b64_tr_b16 v[234:235], v66 offset:17152
    v_mfma_f32_16x16x32_bf16 v[120:123], v[240:243], v[176:179], v[120:123]
    ds_read_b64_tr_b16 v[236:237], v66 offset:16672
    v_mfma_f32_16x16x32_bf16 v[124:127], v[240:243], v[180:183], v[124:127]
    ds_read_b64_tr_b16 v[238:239], v66 offset:17184
    buffer_load_dwordx4 v[220:223], v2, s[32:35], s16 offen offset:3072 sc1
    s_waitcnt lgkmcnt(8)
    v_mfma_f32_16x16x32_bf16 v[80:83], v[244:247], v[176:179], v[80:83]
    ds_read_b64_tr_b16 v[240:241], v67 offset:16640
    v_mfma_f32_16x16x32_bf16 v[84:87], v[244:247], v[180:183], v[84:87]
    ds_read_b64_tr_b16 v[242:243], v67 offset:17152
    v_mfma_f32_16x16x32_bf16 v[88:91], v[248:251], v[176:179], v[88:91]
    ds_read_b64_tr_b16 v[244:245], v67 offset:16672
    v_mfma_f32_16x16x32_bf16 v[92:95], v[248:251], v[180:183], v[92:95]
    ds_read_b64_tr_b16 v[246:247], v67 offset:17184
    s_waitcnt lgkmcnt(8)
    v_mfma_f32_16x16x32_bf16 v[96:99], v[224:227], v[176:179], v[96:99]
    ds_read_b64_tr_b16 v[248:249], v67 offset:12480
    v_mfma_f32_16x16x32_bf16 v[100:103], v[224:227], v[180:183], v[100:103]
    ds_read_b64_tr_b16 v[250:251], v67 offset:12992
    v_mfma_f32_16x16x32_bf16 v[104:107], v[228:231], v[176:179], v[104:107]
    ds_read_b64_tr_b16 v[224:225], v67 offset:12512
    v_mfma_f32_16x16x32_bf16 v[108:111], v[228:231], v[180:183], v[108:111]
    ds_read_b64_tr_b16 v[226:227], v67 offset:13024
    s_waitcnt lgkmcnt(8)
    v_mfma_f32_16x16x32_bf16 v[144:147], v[232:235], v[176:179], v[144:147]
    ds_read_b64_tr_b16 v[228:229], v66 offset:12480
    v_mfma_f32_16x16x32_bf16 v[148:151], v[232:235], v[180:183], v[148:151]
    ds_read_b64_tr_b16 v[230:231], v66 offset:12992
    v_mfma_f32_16x16x32_bf16 v[152:155], v[236:239], v[176:179], v[152:155]
    ds_read_b64_tr_b16 v[232:233], v66 offset:12512
    v_mfma_f32_16x16x32_bf16 v[156:159], v[236:239], v[180:183], v[156:159]
    ds_read_b64_tr_b16 v[234:235], v66 offset:13024
    s_waitcnt lgkmcnt(8)
    v_mfma_f32_16x16x32_bf16 v[160:163], v[240:243], v[176:179], v[160:163]
    ds_read_b64_tr_b16 v[236:237], v66 offset:4160
    v_mfma_f32_16x16x32_bf16 v[164:167], v[240:243], v[180:183], v[164:167]
    ds_read_b64_tr_b16 v[238:239], v66 offset:4672
    v_mfma_f32_16x16x32_bf16 v[168:171], v[244:247], v[176:179], v[168:171]
    ds_read_b64_tr_b16 v[240:241], v66 offset:4192
    v_mfma_f32_16x16x32_bf16 v[172:175], v[244:247], v[180:183], v[172:175]
    ds_read_b64_tr_b16 v[242:243], v66 offset:4704
    s_waitcnt lgkmcnt(8)
    s_waitcnt vmcnt(8)
    v_mfma_f32_16x16x32_bf16 v[128:131], v[248:251], v[184:187], v[128:131]
    ds_read_b64_tr_b16 v[244:245], v67 offset:4160
    v_mfma_f32_16x16x32_bf16 v[132:135], v[248:251], v[188:191], v[132:135]
    ds_read_b64_tr_b16 v[246:247], v67 offset:4672
    s_add_u32 s96, s85, 15
    s_and_b32 s97, s96, 15
    s_lshl_b32 s98, s97, 14
    s_add_u32 s16, s98, s15
    buffer_load_dwordx4 v[176:179], v2, s[32:35], s16 offen sc1
    v_mfma_f32_16x16x32_bf16 v[136:139], v[224:227], v[184:187], v[136:139]
    ds_read_b64_tr_b16 v[248:249], v67 offset:4192
    v_mfma_f32_16x16x32_bf16 v[140:143], v[224:227], v[188:191], v[140:143]
    ds_read_b64_tr_b16 v[250:251], v67 offset:4704
    s_waitcnt lgkmcnt(8)
    v_mfma_f32_16x16x32_bf16 v[112:115], v[228:231], v[184:187], v[112:115]
    ds_read_b64_tr_b16 v[224:225], v66 offset:20800
    v_mfma_f32_16x16x32_bf16 v[116:119], v[228:231], v[188:191], v[116:119]
    ds_read_b64_tr_b16 v[226:227], v66 offset:21312
    v_mfma_f32_16x16x32_bf16 v[120:123], v[232:235], v[184:187], v[120:123]
    ds_read_b64_tr_b16 v[228:229], v66 offset:20832
    v_mfma_f32_16x16x32_bf16 v[124:127], v[232:235], v[188:191], v[124:127]
    ds_read_b64_tr_b16 v[230:231], v66 offset:21344
    buffer_load_dwordx4 v[180:183], v2, s[32:35], s16 offen offset:1024 sc1
    s_waitcnt lgkmcnt(8)
    v_mfma_f32_16x16x32_bf16 v[80:83], v[236:239], v[184:187], v[80:83]
    ds_read_b64_tr_b16 v[232:233], v67 offset:20800
    v_mfma_f32_16x16x32_bf16 v[84:87], v[236:239], v[188:191], v[84:87]
    ds_read_b64_tr_b16 v[234:235], v67 offset:21312
    v_mfma_f32_16x16x32_bf16 v[88:91], v[240:243], v[184:187], v[88:91]
    ds_read_b64_tr_b16 v[236:237], v67 offset:20832
    v_mfma_f32_16x16x32_bf16 v[92:95], v[240:243], v[188:191], v[92:95]
    ds_read_b64_tr_b16 v[238:239], v67 offset:21344
    s_waitcnt lgkmcnt(8)
    v_mfma_f32_16x16x32_bf16 v[96:99], v[244:247], v[184:187], v[96:99]
    s_barrier
    ds_read_b64_tr_b16 v[240:241], v67 offset:33280
    v_mfma_f32_16x16x32_bf16 v[100:103], v[244:247], v[188:191], v[100:103]
    ds_read_b64_tr_b16 v[242:243], v67 offset:33792
    v_mfma_f32_16x16x32_bf16 v[104:107], v[248:251], v[184:187], v[104:107]
    ds_read_b64_tr_b16 v[244:245], v67 offset:33312
    v_mfma_f32_16x16x32_bf16 v[108:111], v[248:251], v[188:191], v[108:111]
    ds_read_b64_tr_b16 v[246:247], v67 offset:33824
    s_waitcnt lgkmcnt(8)
    v_mfma_f32_16x16x32_bf16 v[144:147], v[224:227], v[184:187], v[144:147]
    ds_read_b64_tr_b16 v[248:249], v66 offset:33280
    v_mfma_f32_16x16x32_bf16 v[148:151], v[224:227], v[188:191], v[148:151]
    ds_read_b64_tr_b16 v[250:251], v66 offset:33792
    v_mfma_f32_16x16x32_bf16 v[152:155], v[228:231], v[184:187], v[152:155]
    ds_read_b64_tr_b16 v[224:225], v66 offset:33312
    v_mfma_f32_16x16x32_bf16 v[156:159], v[228:231], v[188:191], v[156:159]
    ds_read_b64_tr_b16 v[226:227], v66 offset:33824
    s_waitcnt lgkmcnt(8)
    v_mfma_f32_16x16x32_bf16 v[160:163], v[232:235], v[184:187], v[160:163]
    ds_read_b64_tr_b16 v[228:229], v66 offset:24960
    v_mfma_f32_16x16x32_bf16 v[164:167], v[232:235], v[188:191], v[164:167]
    ds_read_b64_tr_b16 v[230:231], v66 offset:25472
    v_mfma_f32_16x16x32_bf16 v[168:171], v[236:239], v[184:187], v[168:171]
    ds_read_b64_tr_b16 v[232:233], v66 offset:24992
    v_mfma_f32_16x16x32_bf16 v[172:175], v[236:239], v[188:191], v[172:175]
    ds_read_b64_tr_b16 v[234:235], v66 offset:25504
    s_waitcnt lgkmcnt(8)
    s_waitcnt vmcnt(8)
    v_mfma_f32_16x16x32_bf16 v[128:131], v[240:243], v[192:195], v[128:131]
    ds_read_b64_tr_b16 v[236:237], v67 offset:24960
    v_mfma_f32_16x16x32_bf16 v[132:135], v[240:243], v[196:199], v[132:135]
    ds_read_b64_tr_b16 v[238:239], v67 offset:25472
    buffer_load_dwordx4 v[184:187], v2, s[32:35], s16 offen offset:2048 sc1
    v_mfma_f32_16x16x32_bf16 v[136:139], v[244:247], v[192:195], v[136:139]
    ds_read_b64_tr_b16 v[240:241], v67 offset:24992
    v_mfma_f32_16x16x32_bf16 v[140:143], v[244:247], v[196:199], v[140:143]
    ds_read_b64_tr_b16 v[242:243], v67 offset:25504
    s_waitcnt lgkmcnt(8)
    v_mfma_f32_16x16x32_bf16 v[112:115], v[248:251], v[192:195], v[112:115]
    ds_read_b64_tr_b16 v[244:245], v66 offset:41600
    v_mfma_f32_16x16x32_bf16 v[116:119], v[248:251], v[196:199], v[116:119]
    ds_read_b64_tr_b16 v[246:247], v66 offset:42112
    v_mfma_f32_16x16x32_bf16 v[120:123], v[224:227], v[192:195], v[120:123]
    ds_read_b64_tr_b16 v[248:249], v66 offset:41632
    v_mfma_f32_16x16x32_bf16 v[124:127], v[224:227], v[196:199], v[124:127]
    ds_read_b64_tr_b16 v[250:251], v66 offset:42144
    buffer_load_dwordx4 v[188:191], v2, s[32:35], s16 offen offset:3072 sc1
    s_barrier
    s_waitcnt lgkmcnt(8)
    v_mfma_f32_16x16x32_bf16 v[80:83], v[228:231], v[192:195], v[80:83]
    ds_read_b64_tr_b16 v[224:225], v67 offset:41600
    v_mfma_f32_16x16x32_bf16 v[84:87], v[228:231], v[196:199], v[84:87]
    ds_read_b64_tr_b16 v[226:227], v67 offset:42112
    v_mfma_f32_16x16x32_bf16 v[88:91], v[232:235], v[192:195], v[88:91]
    ds_read_b64_tr_b16 v[228:229], v67 offset:41632
    v_mfma_f32_16x16x32_bf16 v[92:95], v[232:235], v[196:199], v[92:95]
    ds_read_b64_tr_b16 v[230:231], v67 offset:42144
    s_waitcnt lgkmcnt(8)
    v_mfma_f32_16x16x32_bf16 v[96:99], v[236:239], v[192:195], v[96:99]
    ds_read_b64_tr_b16 v[232:233], v67 offset:37440
    v_mfma_f32_16x16x32_bf16 v[100:103], v[236:239], v[196:199], v[100:103]
    ds_read_b64_tr_b16 v[234:235], v67 offset:37952
    v_mfma_f32_16x16x32_bf16 v[104:107], v[240:243], v[192:195], v[104:107]
    ds_read_b64_tr_b16 v[236:237], v67 offset:37472
    v_mfma_f32_16x16x32_bf16 v[108:111], v[240:243], v[196:199], v[108:111]
    ds_read_b64_tr_b16 v[238:239], v67 offset:37984
    s_waitcnt lgkmcnt(8)
    v_mfma_f32_16x16x32_bf16 v[144:147], v[244:247], v[192:195], v[144:147]
    ds_read_b64_tr_b16 v[240:241], v66 offset:37440
    v_mfma_f32_16x16x32_bf16 v[148:151], v[244:247], v[196:199], v[148:151]
    ds_read_b64_tr_b16 v[242:243], v66 offset:37952
    v_mfma_f32_16x16x32_bf16 v[152:155], v[248:251], v[192:195], v[152:155]
    ds_read_b64_tr_b16 v[244:245], v66 offset:37472
    v_mfma_f32_16x16x32_bf16 v[156:159], v[248:251], v[196:199], v[156:159]
    ds_read_b64_tr_b16 v[246:247], v66 offset:37984
    s_waitcnt lgkmcnt(8)
    v_mfma_f32_16x16x32_bf16 v[160:163], v[224:227], v[192:195], v[160:163]
    ds_read_b64_tr_b16 v[248:249], v66 offset:29120
    v_mfma_f32_16x16x32_bf16 v[164:167], v[224:227], v[196:199], v[164:167]
    ds_read_b64_tr_b16 v[250:251], v66 offset:29632
    v_mfma_f32_16x16x32_bf16 v[168:171], v[228:231], v[192:195], v[168:171]
    ds_read_b64_tr_b16 v[224:225], v66 offset:29152
    v_mfma_f32_16x16x32_bf16 v[172:175], v[228:231], v[196:199], v[172:175]
    ds_read_b64_tr_b16 v[226:227], v66 offset:29664
    s_waitcnt lgkmcnt(8)
    s_waitcnt vmcnt(8)
    v_mfma_f32_16x16x32_bf16 v[128:131], v[232:235], v[200:203], v[128:131]
    ds_read_b64_tr_b16 v[228:229], v67 offset:29120
    v_mfma_f32_16x16x32_bf16 v[132:135], v[232:235], v[204:207], v[132:135]
    ds_read_b64_tr_b16 v[230:231], v67 offset:29632
    v_mfma_f32_16x16x32_bf16 v[136:139], v[236:239], v[200:203], v[136:139]
    ds_read_b64_tr_b16 v[232:233], v67 offset:29152
    v_mfma_f32_16x16x32_bf16 v[140:143], v[236:239], v[204:207], v[140:143]
    ds_read_b64_tr_b16 v[234:235], v67 offset:29664
    s_waitcnt lgkmcnt(8)
    v_mfma_f32_16x16x32_bf16 v[112:115], v[240:243], v[200:203], v[112:115]
    ds_read_b64_tr_b16 v[236:237], v66 offset:45760
    v_mfma_f32_16x16x32_bf16 v[116:119], v[240:243], v[204:207], v[116:119]
    ds_read_b64_tr_b16 v[238:239], v66 offset:46272
    v_mfma_f32_16x16x32_bf16 v[120:123], v[244:247], v[200:203], v[120:123]
    ds_read_b64_tr_b16 v[240:241], v66 offset:45792
    v_mfma_f32_16x16x32_bf16 v[124:127], v[244:247], v[204:207], v[124:127]
    ds_read_b64_tr_b16 v[242:243], v66 offset:46304
    s_waitcnt lgkmcnt(8)
    v_mfma_f32_16x16x32_bf16 v[80:83], v[248:251], v[200:203], v[80:83]
    ds_read_b64_tr_b16 v[244:245], v67 offset:45760
    v_mfma_f32_16x16x32_bf16 v[84:87], v[248:251], v[204:207], v[84:87]
    ds_read_b64_tr_b16 v[246:247], v67 offset:46272
    v_mfma_f32_16x16x32_bf16 v[88:91], v[224:227], v[200:203], v[88:91]
    ds_read_b64_tr_b16 v[248:249], v67 offset:45792
    v_mfma_f32_16x16x32_bf16 v[92:95], v[224:227], v[204:207], v[92:95]
    ds_read_b64_tr_b16 v[250:251], v67 offset:46304
    s_waitcnt lgkmcnt(8)
    v_mfma_f32_16x16x32_bf16 v[96:99], v[228:231], v[200:203], v[96:99]
    ds_read_b64_tr_b16 v[224:225], v69 offset:8320
    v_mfma_f32_16x16x32_bf16 v[100:103], v[228:231], v[204:207], v[100:103]
    ds_read_b64_tr_b16 v[226:227], v69 offset:8832
    v_mfma_f32_16x16x32_bf16 v[104:107], v[232:235], v[200:203], v[104:107]
    ds_read_b64_tr_b16 v[228:229], v69 offset:8352
    v_mfma_f32_16x16x32_bf16 v[108:111], v[232:235], v[204:207], v[108:111]
    ds_read_b64_tr_b16 v[230:231], v69 offset:8864
    s_waitcnt lgkmcnt(8)
    v_mfma_f32_16x16x32_bf16 v[144:147], v[236:239], v[200:203], v[144:147]
    ds_read_b64_tr_b16 v[232:233], v68 offset:8320
    v_mfma_f32_16x16x32_bf16 v[148:151], v[236:239], v[204:207], v[148:151]
    ds_read_b64_tr_b16 v[234:235], v68 offset:8832
    v_mfma_f32_16x16x32_bf16 v[152:155], v[240:243], v[200:203], v[152:155]
    ds_read_b64_tr_b16 v[236:237], v68 offset:8352
    v_mfma_f32_16x16x32_bf16 v[156:159], v[240:243], v[204:207], v[156:159]
    ds_read_b64_tr_b16 v[238:239], v68 offset:8864
    s_waitcnt lgkmcnt(8)
    v_mfma_f32_16x16x32_bf16 v[160:163], v[244:247], v[200:203], v[160:163]
    ds_read_b64_tr_b16 v[240:241], v68
    v_mfma_f32_16x16x32_bf16 v[164:167], v[244:247], v[204:207], v[164:167]
    ds_read_b64_tr_b16 v[242:243], v68 offset:512
    v_mfma_f32_16x16x32_bf16 v[168:171], v[248:251], v[200:203], v[168:171]
    ds_read_b64_tr_b16 v[244:245], v68 offset:32
    v_mfma_f32_16x16x32_bf16 v[172:175], v[248:251], v[204:207], v[172:175]
    ds_read_b64_tr_b16 v[246:247], v68 offset:544
    s_waitcnt lgkmcnt(8)
    s_waitcnt vmcnt(6)
    v_mfma_f32_16x16x32_bf16 v[128:131], v[224:227], v[208:211], v[128:131]
    ds_read_b64_tr_b16 v[248:249], v69
    v_mfma_f32_16x16x32_bf16 v[132:135], v[224:227], v[212:215], v[132:135]
    ds_read_b64_tr_b16 v[250:251], v69 offset:512
    v_mfma_f32_16x16x32_bf16 v[136:139], v[228:231], v[208:211], v[136:139]
    ds_read_b64_tr_b16 v[224:225], v69 offset:32
    v_mfma_f32_16x16x32_bf16 v[140:143], v[228:231], v[212:215], v[140:143]
    ds_read_b64_tr_b16 v[226:227], v69 offset:544
    s_waitcnt lgkmcnt(8)
    v_mfma_f32_16x16x32_bf16 v[112:115], v[232:235], v[208:211], v[112:115]
    ds_read_b64_tr_b16 v[228:229], v68 offset:16640
    v_mfma_f32_16x16x32_bf16 v[116:119], v[232:235], v[212:215], v[116:119]
    ds_read_b64_tr_b16 v[230:231], v68 offset:17152
    v_mfma_f32_16x16x32_bf16 v[120:123], v[236:239], v[208:211], v[120:123]
    ds_read_b64_tr_b16 v[232:233], v68 offset:16672
    v_mfma_f32_16x16x32_bf16 v[124:127], v[236:239], v[212:215], v[124:127]
    ds_read_b64_tr_b16 v[234:235], v68 offset:17184
    s_waitcnt lgkmcnt(8)
    v_mfma_f32_16x16x32_bf16 v[80:83], v[240:243], v[208:211], v[80:83]
    ds_read_b64_tr_b16 v[236:237], v69 offset:16640
    v_mfma_f32_16x16x32_bf16 v[84:87], v[240:243], v[212:215], v[84:87]
    ds_read_b64_tr_b16 v[238:239], v69 offset:17152
    v_mfma_f32_16x16x32_bf16 v[88:91], v[244:247], v[208:211], v[88:91]
    ds_read_b64_tr_b16 v[240:241], v69 offset:16672
    v_mfma_f32_16x16x32_bf16 v[92:95], v[244:247], v[212:215], v[92:95]
    ds_read_b64_tr_b16 v[242:243], v69 offset:17184
    s_waitcnt lgkmcnt(8)
    v_mfma_f32_16x16x32_bf16 v[96:99], v[248:251], v[208:211], v[96:99]
    ds_read_b64_tr_b16 v[244:245], v69 offset:12480
    v_mfma_f32_16x16x32_bf16 v[100:103], v[248:251], v[212:215], v[100:103]
    ds_read_b64_tr_b16 v[246:247], v69 offset:12992
    v_mfma_f32_16x16x32_bf16 v[104:107], v[224:227], v[208:211], v[104:107]
    ds_read_b64_tr_b16 v[248:249], v69 offset:12512
    v_mfma_f32_16x16x32_bf16 v[108:111], v[224:227], v[212:215], v[108:111]
    ds_read_b64_tr_b16 v[250:251], v69 offset:13024
    s_waitcnt lgkmcnt(8)
    v_mfma_f32_16x16x32_bf16 v[144:147], v[228:231], v[208:211], v[144:147]
    ds_read_b64_tr_b16 v[224:225], v68 offset:12480
    v_mfma_f32_16x16x32_bf16 v[148:151], v[228:231], v[212:215], v[148:151]
    ds_read_b64_tr_b16 v[226:227], v68 offset:12992
    v_mfma_f32_16x16x32_bf16 v[152:155], v[232:235], v[208:211], v[152:155]
    ds_read_b64_tr_b16 v[228:229], v68 offset:12512
    v_mfma_f32_16x16x32_bf16 v[156:159], v[232:235], v[212:215], v[156:159]
    ds_read_b64_tr_b16 v[230:231], v68 offset:13024
    s_waitcnt lgkmcnt(8)
    v_mfma_f32_16x16x32_bf16 v[160:163], v[236:239], v[208:211], v[160:163]
    ds_read_b64_tr_b16 v[232:233], v68 offset:4160
    v_mfma_f32_16x16x32_bf16 v[164:167], v[236:239], v[212:215], v[164:167]
    ds_read_b64_tr_b16 v[234:235], v68 offset:4672
    v_mfma_f32_16x16x32_bf16 v[168:171], v[240:243], v[208:211], v[168:171]
    ds_read_b64_tr_b16 v[236:237], v68 offset:4192
    v_mfma_f32_16x16x32_bf16 v[172:175], v[240:243], v[212:215], v[172:175]
    ds_read_b64_tr_b16 v[238:239], v68 offset:4704
    s_waitcnt lgkmcnt(8)
    s_waitcnt vmcnt(4)
    v_mfma_f32_16x16x32_bf16 v[128:131], v[244:247], v[216:219], v[128:131]
    ds_read_b64_tr_b16 v[240:241], v69 offset:4160
    v_mfma_f32_16x16x32_bf16 v[132:135], v[244:247], v[220:223], v[132:135]
    ds_read_b64_tr_b16 v[242:243], v69 offset:4672
    v_mfma_f32_16x16x32_bf16 v[136:139], v[248:251], v[216:219], v[136:139]
    ds_read_b64_tr_b16 v[244:245], v69 offset:4192
    v_mfma_f32_16x16x32_bf16 v[140:143], v[248:251], v[220:223], v[140:143]
    ds_read_b64_tr_b16 v[246:247], v69 offset:4704
    s_waitcnt lgkmcnt(8)
    v_mfma_f32_16x16x32_bf16 v[112:115], v[224:227], v[216:219], v[112:115]
    ds_read_b64_tr_b16 v[248:249], v68 offset:20800
    v_mfma_f32_16x16x32_bf16 v[116:119], v[224:227], v[220:223], v[116:119]
    ds_read_b64_tr_b16 v[250:251], v68 offset:21312
    v_mfma_f32_16x16x32_bf16 v[120:123], v[228:231], v[216:219], v[120:123]
    ds_read_b64_tr_b16 v[224:225], v68 offset:20832
    v_mfma_f32_16x16x32_bf16 v[124:127], v[228:231], v[220:223], v[124:127]
    ds_read_b64_tr_b16 v[226:227], v68 offset:21344
    s_waitcnt lgkmcnt(8)
    v_mfma_f32_16x16x32_bf16 v[80:83], v[232:235], v[216:219], v[80:83]
    ds_read_b64_tr_b16 v[228:229], v69 offset:20800
    v_mfma_f32_16x16x32_bf16 v[84:87], v[232:235], v[220:223], v[84:87]
    ds_read_b64_tr_b16 v[230:231], v69 offset:21312
    v_mfma_f32_16x16x32_bf16 v[88:91], v[236:239], v[216:219], v[88:91]
    ds_read_b64_tr_b16 v[232:233], v69 offset:20832
    v_mfma_f32_16x16x32_bf16 v[92:95], v[236:239], v[220:223], v[92:95]
    ds_read_b64_tr_b16 v[234:235], v69 offset:21344
    s_waitcnt lgkmcnt(8)
    v_mfma_f32_16x16x32_bf16 v[96:99], v[240:243], v[216:219], v[96:99]
    ds_read_b64_tr_b16 v[236:237], v69 offset:33280
    v_mfma_f32_16x16x32_bf16 v[100:103], v[240:243], v[220:223], v[100:103]
    ds_read_b64_tr_b16 v[238:239], v69 offset:33792
    v_mfma_f32_16x16x32_bf16 v[104:107], v[244:247], v[216:219], v[104:107]
    ds_read_b64_tr_b16 v[240:241], v69 offset:33312
    v_mfma_f32_16x16x32_bf16 v[108:111], v[244:247], v[220:223], v[108:111]
    ds_read_b64_tr_b16 v[242:243], v69 offset:33824
    s_waitcnt lgkmcnt(8)
    v_mfma_f32_16x16x32_bf16 v[144:147], v[248:251], v[216:219], v[144:147]
    ds_read_b64_tr_b16 v[244:245], v68 offset:33280
    v_mfma_f32_16x16x32_bf16 v[148:151], v[248:251], v[220:223], v[148:151]
    ds_read_b64_tr_b16 v[246:247], v68 offset:33792
    v_mfma_f32_16x16x32_bf16 v[152:155], v[224:227], v[216:219], v[152:155]
    ds_read_b64_tr_b16 v[248:249], v68 offset:33312
    v_mfma_f32_16x16x32_bf16 v[156:159], v[224:227], v[220:223], v[156:159]
    ds_read_b64_tr_b16 v[250:251], v68 offset:33824
    s_waitcnt lgkmcnt(8)
    v_mfma_f32_16x16x32_bf16 v[160:163], v[228:231], v[216:219], v[160:163]
    ds_read_b64_tr_b16 v[224:225], v68 offset:24960
    v_mfma_f32_16x16x32_bf16 v[164:167], v[228:231], v[220:223], v[164:167]
    ds_read_b64_tr_b16 v[226:227], v68 offset:25472
    v_mfma_f32_16x16x32_bf16 v[168:171], v[232:235], v[216:219], v[168:171]
    ds_read_b64_tr_b16 v[228:229], v68 offset:24992
    v_mfma_f32_16x16x32_bf16 v[172:175], v[232:235], v[220:223], v[172:175]
    ds_read_b64_tr_b16 v[230:231], v68 offset:25504
    s_waitcnt lgkmcnt(8)
    s_waitcnt vmcnt(2)
    v_mfma_f32_16x16x32_bf16 v[128:131], v[236:239], v[176:179], v[128:131]
    ds_read_b64_tr_b16 v[232:233], v69 offset:24960
    v_mfma_f32_16x16x32_bf16 v[132:135], v[236:239], v[180:183], v[132:135]
    ds_read_b64_tr_b16 v[234:235], v69 offset:25472
    v_mfma_f32_16x16x32_bf16 v[136:139], v[240:243], v[176:179], v[136:139]
    ds_read_b64_tr_b16 v[236:237], v69 offset:24992
    v_mfma_f32_16x16x32_bf16 v[140:143], v[240:243], v[180:183], v[140:143]
    ds_read_b64_tr_b16 v[238:239], v69 offset:25504
    s_waitcnt lgkmcnt(8)
    v_mfma_f32_16x16x32_bf16 v[112:115], v[244:247], v[176:179], v[112:115]
    ds_read_b64_tr_b16 v[240:241], v68 offset:41600
    v_mfma_f32_16x16x32_bf16 v[116:119], v[244:247], v[180:183], v[116:119]
    ds_read_b64_tr_b16 v[242:243], v68 offset:42112
    v_mfma_f32_16x16x32_bf16 v[120:123], v[248:251], v[176:179], v[120:123]
    ds_read_b64_tr_b16 v[244:245], v68 offset:41632
    v_mfma_f32_16x16x32_bf16 v[124:127], v[248:251], v[180:183], v[124:127]
    ds_read_b64_tr_b16 v[246:247], v68 offset:42144
    s_waitcnt lgkmcnt(8)
    v_mfma_f32_16x16x32_bf16 v[80:83], v[224:227], v[176:179], v[80:83]
    ds_read_b64_tr_b16 v[248:249], v69 offset:41600
    v_mfma_f32_16x16x32_bf16 v[84:87], v[224:227], v[180:183], v[84:87]
    ds_read_b64_tr_b16 v[250:251], v69 offset:42112
    v_mfma_f32_16x16x32_bf16 v[88:91], v[228:231], v[176:179], v[88:91]
    ds_read_b64_tr_b16 v[224:225], v69 offset:41632
    v_mfma_f32_16x16x32_bf16 v[92:95], v[228:231], v[180:183], v[92:95]
    ds_read_b64_tr_b16 v[226:227], v69 offset:42144
    s_waitcnt lgkmcnt(8)
    v_mfma_f32_16x16x32_bf16 v[96:99], v[232:235], v[176:179], v[96:99]
    ds_read_b64_tr_b16 v[228:229], v69 offset:37440
    v_mfma_f32_16x16x32_bf16 v[100:103], v[232:235], v[180:183], v[100:103]
    ds_read_b64_tr_b16 v[230:231], v69 offset:37952
    v_mfma_f32_16x16x32_bf16 v[104:107], v[236:239], v[176:179], v[104:107]
    ds_read_b64_tr_b16 v[232:233], v69 offset:37472
    v_mfma_f32_16x16x32_bf16 v[108:111], v[236:239], v[180:183], v[108:111]
    ds_read_b64_tr_b16 v[234:235], v69 offset:37984
    s_waitcnt lgkmcnt(8)
    v_mfma_f32_16x16x32_bf16 v[144:147], v[240:243], v[176:179], v[144:147]
    ds_read_b64_tr_b16 v[236:237], v68 offset:37440
    v_mfma_f32_16x16x32_bf16 v[148:151], v[240:243], v[180:183], v[148:151]
    ds_read_b64_tr_b16 v[238:239], v68 offset:37952
    v_mfma_f32_16x16x32_bf16 v[152:155], v[244:247], v[176:179], v[152:155]
    ds_read_b64_tr_b16 v[240:241], v68 offset:37472
    v_mfma_f32_16x16x32_bf16 v[156:159], v[244:247], v[180:183], v[156:159]
    ds_read_b64_tr_b16 v[242:243], v68 offset:37984
    s_waitcnt lgkmcnt(8)
    v_mfma_f32_16x16x32_bf16 v[160:163], v[248:251], v[176:179], v[160:163]
    ds_read_b64_tr_b16 v[244:245], v68 offset:29120
    v_mfma_f32_16x16x32_bf16 v[164:167], v[248:251], v[180:183], v[164:167]
    ds_read_b64_tr_b16 v[246:247], v68 offset:29632
    v_mfma_f32_16x16x32_bf16 v[168:171], v[224:227], v[176:179], v[168:171]
    ds_read_b64_tr_b16 v[248:249], v68 offset:29152
    v_mfma_f32_16x16x32_bf16 v[172:175], v[224:227], v[180:183], v[172:175]
    ds_read_b64_tr_b16 v[250:251], v68 offset:29664
    s_waitcnt lgkmcnt(8)
    s_waitcnt vmcnt(0)
    v_mfma_f32_16x16x32_bf16 v[128:131], v[228:231], v[184:187], v[128:131]
    ds_read_b64_tr_b16 v[224:225], v69 offset:29120
    v_mfma_f32_16x16x32_bf16 v[132:135], v[228:231], v[188:191], v[132:135]
    ds_read_b64_tr_b16 v[226:227], v69 offset:29632
    v_mfma_f32_16x16x32_bf16 v[136:139], v[232:235], v[184:187], v[136:139]
    ds_read_b64_tr_b16 v[228:229], v69 offset:29152
    v_mfma_f32_16x16x32_bf16 v[140:143], v[232:235], v[188:191], v[140:143]
    ds_read_b64_tr_b16 v[230:231], v69 offset:29664
    s_waitcnt lgkmcnt(8)
    v_mfma_f32_16x16x32_bf16 v[112:115], v[236:239], v[184:187], v[112:115]
    ds_read_b64_tr_b16 v[232:233], v68 offset:45760
    v_mfma_f32_16x16x32_bf16 v[116:119], v[236:239], v[188:191], v[116:119]
    ds_read_b64_tr_b16 v[234:235], v68 offset:46272
    v_mfma_f32_16x16x32_bf16 v[120:123], v[240:243], v[184:187], v[120:123]
    ds_read_b64_tr_b16 v[236:237], v68 offset:45792
    v_mfma_f32_16x16x32_bf16 v[124:127], v[240:243], v[188:191], v[124:127]
    ds_read_b64_tr_b16 v[238:239], v68 offset:46304
    s_waitcnt lgkmcnt(8)
    v_mfma_f32_16x16x32_bf16 v[80:83], v[244:247], v[184:187], v[80:83]
    ds_read_b64_tr_b16 v[240:241], v69 offset:45760
    v_mfma_f32_16x16x32_bf16 v[84:87], v[244:247], v[188:191], v[84:87]
    ds_read_b64_tr_b16 v[242:243], v69 offset:46272
    v_mfma_f32_16x16x32_bf16 v[88:91], v[248:251], v[184:187], v[88:91]
    ds_read_b64_tr_b16 v[244:245], v69 offset:45792
    v_mfma_f32_16x16x32_bf16 v[92:95], v[248:251], v[188:191], v[92:95]
    ds_read_b64_tr_b16 v[246:247], v69 offset:46304
    s_waitcnt lgkmcnt(8)
    v_mfma_f32_16x16x32_bf16 v[96:99], v[224:227], v[184:187], v[96:99]
    v_mfma_f32_16x16x32_bf16 v[100:103], v[224:227], v[188:191], v[100:103]
    v_mfma_f32_16x16x32_bf16 v[104:107], v[228:231], v[184:187], v[104:107]
    v_mfma_f32_16x16x32_bf16 v[108:111], v[228:231], v[188:191], v[108:111]
    s_waitcnt lgkmcnt(4)
    v_mfma_f32_16x16x32_bf16 v[144:147], v[232:235], v[184:187], v[144:147]
    v_mfma_f32_16x16x32_bf16 v[148:151], v[232:235], v[188:191], v[148:151]
    v_mfma_f32_16x16x32_bf16 v[152:155], v[236:239], v[184:187], v[152:155]
    v_mfma_f32_16x16x32_bf16 v[156:159], v[236:239], v[188:191], v[156:159]
    s_waitcnt lgkmcnt(0)
    v_mfma_f32_16x16x32_bf16 v[160:163], v[240:243], v[184:187], v[160:163]
    v_mfma_f32_16x16x32_bf16 v[164:167], v[240:243], v[188:191], v[164:167]
    v_mfma_f32_16x16x32_bf16 v[168:171], v[244:247], v[184:187], v[168:171]
    v_mfma_f32_16x16x32_bf16 v[172:175], v[244:247], v[188:191], v[172:175]
    v_cvt_pk_bf16_f32 v52, v128, v129
    v_cvt_pk_bf16_f32 v53, v130, v131
    v_cvt_pk_bf16_f32 v54, v132, v133
    v_cvt_pk_bf16_f32 v55, v134, v135
    v_cvt_pk_bf16_f32 v56, v136, v137
    v_cvt_pk_bf16_f32 v57, v138, v139
    v_cvt_pk_bf16_f32 v58, v140, v141
    v_cvt_pk_bf16_f32 v59, v142, v143
    ds_write_b64 v77, v[52:53]
    ds_write_b64 v77, v[54:55] offset:256
    ds_write_b64 v77, v[56:57] offset:1024
    ds_write_b64 v77, v[58:59] offset:1280
    v_cvt_pk_bf16_f32 v36, v112, v113
    v_cvt_pk_bf16_f32 v37, v114, v115
    v_cvt_pk_bf16_f32 v38, v116, v117
    v_cvt_pk_bf16_f32 v39, v118, v119
    v_cvt_pk_bf16_f32 v40, v120, v121
    v_cvt_pk_bf16_f32 v41, v122, v123
    v_cvt_pk_bf16_f32 v42, v124, v125
    v_cvt_pk_bf16_f32 v43, v126, v127
    v_permlane16_swap_b32 v36, v38
    v_permlane16_swap_b32 v37, v39
    v_permlane16_swap_b32 v40, v42
    v_permlane16_swap_b32 v41, v43
    s_waitcnt lgkmcnt(0)
    s_barrier
    s_setprio 0
    v_mfma_f32_32x32x16_bf16 v[112:127], v[28:31], v[36:39], 0
    v_mfma_f32_32x32x16_bf16 v[112:127], v[32:35], v[40:43], v[112:127]
    v_cvt_pk_bf16_f32 v52, v144, v145
    v_cvt_pk_bf16_f32 v53, v146, v147
    v_cvt_pk_bf16_f32 v54, v148, v149
    v_cvt_pk_bf16_f32 v55, v150, v151
    v_cvt_pk_bf16_f32 v56, v152, v153
    v_cvt_pk_bf16_f32 v57, v154, v155
    v_cvt_pk_bf16_f32 v58, v156, v157
    v_cvt_pk_bf16_f32 v59, v158, v159
    ds_write_b64 v78, v[52:53]
    ds_write_b64 v78, v[54:55] offset:512
    ds_write_b64 v78, v[56:57] offset:4096
    ds_write_b64 v78, v[58:59] offset:4608
    v_cvt_pk_bf16_f32 v44, v160, v161
    v_cvt_pk_bf16_f32 v45, v162, v163
    v_cvt_pk_bf16_f32 v46, v164, v165
    v_cvt_pk_bf16_f32 v47, v166, v167
    v_cvt_pk_bf16_f32 v48, v168, v169
    v_cvt_pk_bf16_f32 v49, v170, v171
    v_cvt_pk_bf16_f32 v50, v172, v173
    v_cvt_pk_bf16_f32 v51, v174, v175
    ds_write_b64 v78, v[44:45] offset:8192
    ds_write_b64 v78, v[46:47] offset:8704
    ds_write_b64 v78, v[48:49] offset:12288
    ds_write_b64 v78, v[50:51] offset:12800
    v_cvt_pk_bf16_f32 v36, v96, v97
    v_cvt_pk_bf16_f32 v37, v98, v99
    v_cvt_pk_bf16_f32 v38, v100, v101
    v_cvt_pk_bf16_f32 v39, v102, v103
    v_cvt_pk_bf16_f32 v40, v104, v105
    v_cvt_pk_bf16_f32 v41, v106, v107
    v_cvt_pk_bf16_f32 v42, v108, v109
    v_cvt_pk_bf16_f32 v43, v110, v111
    ds_write_b64 v77, v[36:37] offset:2048
    ds_write_b64 v77, v[38:39] offset:2304
    ds_write_b64 v77, v[40:41] offset:3072
    ds_write_b64 v77, v[42:43] offset:3328
    v_cvt_pk_bf16_f32 v44, v80, v81
    v_cvt_pk_bf16_f32 v45, v82, v83
    v_cvt_pk_bf16_f32 v46, v84, v85
    v_cvt_pk_bf16_f32 v47, v86, v87
    v_cvt_pk_bf16_f32 v48, v88, v89
    v_cvt_pk_bf16_f32 v49, v90, v91
    v_cvt_pk_bf16_f32 v50, v92, v93
    v_cvt_pk_bf16_f32 v51, v94, v95
    v_permlane16_swap_b32 v44, v46
    v_permlane16_swap_b32 v45, v47
    v_permlane16_swap_b32 v48, v50
    v_permlane16_swap_b32 v49, v51
    s_branch L_JOIN
L_HELP:
    s_add_u32 s96, s85, 5
    s_and_b32 s97, s96, 15
    s_lshl3_add_u32 s98, s97, s3
    s_sub_u32 s99, s98, 4
    s_mul_i32 s96, s99, 49152
    s_lshl_b32 s97, s11, 7
    s_add_u32 s82, s96, s97
    s_sub_u32 s96, s3, 4
    s_lshr_b32 s97, s96, 1
    s_mul_i32 s98, s97, 2080
    s_sub_u32 s99, s3, 4
    s_and_b32 s96, s99, 1
    s_mul_i32 s97, s96, 1056
    s_add_u32 s99, s98, s97
    s_add_u32 s20, s99, 124800
    s_mov_b32 m0, s20
    s_nop 0
    buffer_load_dwordx4 v62, s[40:43], s82 offen lds
    s_add_u32 s82, s82, 2048
    s_add_u32 m0, s20, 8320
    s_nop 0
    buffer_load_dwordx4 v62, s[40:43], s82 offen lds
    s_add_u32 s82, s82, 2048
    s_add_u32 m0, s20, 16640
    s_nop 0
    buffer_load_dwordx4 v62, s[40:43], s82 offen lds
    s_add_u32 s96, s85, 5
    s_and_b32 s97, s96, 15
    s_lshl3_add_u32 s98, s97, s3
    s_mul_i32 s99, s98, 49152
    s_lshl_b32 s96, s11, 7
    s_add_u32 s82, s99, s96
    s_lshr_b32 s96, s3, 1
    s_mul_i32 s97, s96, 2080
    s_and_b32 s98, s3, 1
    s_mul_i32 s99, s98, 1056
    s_add_u32 s96, s97, s99
    s_add_u32 s20, s96, 124800
    s_mov_b32 m0, s20
    s_nop 0
    buffer_load_dwordx4 v62, s[40:43], s82 offen lds
    s_add_u32 s82, s82, 2048
    s_add_u32 m0, s20, 8320
    s_nop 0
    buffer_load_dwordx4 v62, s[40:43], s82 offen lds
    s_add_u32 s82, s82, 2048
    s_add_u32 m0, s20, 16640
    s_nop 0
    buffer_load_dwordx4 v62, s[40:43], s82 offen lds
    s_and_b32 s96, s9, 3
    s_lshl2_add_u32 s97, s96, s3
    s_sub_u32 s98, s97, 4
    s_lshl_b32 s13, s98, 7
    v_lshrrev_b32 v61, 3, v1
    v_lshl_add_u32 v61, v61, 4, s13
    v_lshrrev_b32 v60, 3, v1
    v_mul_u32_u24 v60, 98304, v60
    v_and_b32 v9, 7, v1
    v_lshl_add_u32 v60, v9, 4, v60
    s_mul_i32 s96, s13, 6144
    s_bfe_u32 s97, s9, 131074
    s_lshl_b32 s98, s8, 1
    s_lshl4_add_u32 s99, s97, s98
    s_lshr_b32 s97, s9, 4
    s_add_u32 s98, s99, s97
    s_lshl_b32 s99, s98, 7
    s_add_u32 s97, s96, s99
    s_add_u32 s17, s97, 4096
    global_load_dwordx4 v[120:123], v61, s[86:87]
    s_waitcnt vmcnt(13)
    s_barrier
    buffer_load_dwordx4 v[80:83], v60, s[48:51], s17 offen nt
    s_add_u32 s17, s17, 12288
    buffer_load_dwordx4 v[84:87], v60, s[48:51], s17 offen nt
    s_add_u32 s17, s17, 12288
    s_waitcnt lgkmcnt(0)
    s_load_dword s24, s[32:33], s92 offset:512 glc
    s_load_dword s25, s[32:33], s92 offset:256 glc
    s_load_dword s26, s[32:33], s92 offset:1024 glc
    s_load_dword s27, s[32:33], s92 offset:768 glc
    s_waitcnt vmcnt(12)
    s_barrier
    s_add_u32 s96, s85, 6
    s_and_b32 s97, s96, 15
    s_lshl3_add_u32 s98, s97, s3
    s_sub_u32 s99, s98, 4
    s_mul_i32 s96, s99, 49152
    s_lshl_b32 s97, s11, 7
    s_add_u32 s82, s96, s97
    s_sub_u32 s96, s3, 4
    s_lshr_b32 s97, s96, 1
    s_mul_i32 s98, s97, 2080
    s_sub_u32 s99, s3, 4
    s_and_b32 s96, s99, 1
    s_mul_i32 s97, s96, 1056
    s_add_u32 s20, s98, s97
    s_mov_b32 m0, s20
    s_nop 0
    buffer_load_dwordx4 v62, s[40:43], s82 offen lds
    s_add_u32 s82, s82, 2048
    s_add_u32 m0, s20, 8320
    s_nop 0
    buffer_load_dwordx4 v62, s[40:43], s82 offen lds
    s_add_u32 s82, s82, 2048
    s_add_u32 m0, s20, 16640
    s_nop 0
    buffer_load_dwordx4 v62, s[40:43], s82 offen lds
    s_add_u32 s96, s85, 6
    s_and_b32 s97, s96, 15
    s_lshl3_add_u32 s98, s97, s3
    s_mul_i32 s99, s98, 49152
    s_lshl_b32 s96, s11, 7
    s_add_u32 s82, s99, s96
    s_lshr_b32 s96, s3, 1
    s_mul_i32 s97, s96, 2080
    s_and_b32 s98, s3, 1
    s_mul_i32 s99, s98, 1056
    s_add_u32 s20, s97, s99
    s_mov_b32 m0, s20
    s_nop 0
    buffer_load_dwordx4 v62, s[40:43], s82 offen lds
    s_add_u32 s82, s82, 2048
    s_add_u32 m0, s20, 8320
    s_nop 0
    buffer_load_dwordx4 v62, s[40:43], s82 offen lds
    s_add_u32 s82, s82, 2048
    s_add_u32 m0, s20, 16640
    s_nop 0
    buffer_load_dwordx4 v62, s[40:43], s82 offen lds
    s_waitcnt vmcnt(8)
    v_lshlrev_b32 v112, 16, v120
    v_mul_f32 v4, s7, v112
    v_exp_f32 v4, -v4
    s_nop 0
    v_add_f32 v4, 1.0, v4
    v_rcp_f32 v4, v4
    s_nop 0
    v_mul_f32 v112, v112, v4
    v_cvt_pk_bf16_f32 v112, 0, v112
    v_and_b32 v113, s6, v120
    v_mul_f32 v5, s7, v113
    v_exp_f32 v5, -v5
    s_nop 0
    v_add_f32 v5, 1.0, v5
    v_rcp_f32 v5, v5
    s_nop 0
    v_mul_f32 v113, v113, v5
    v_cvt_pk_bf16_f32 v113, 0, v113
    v_lshlrev_b32 v114, 16, v121
    v_mul_f32 v4, s7, v114
    v_exp_f32 v4, -v4
    s_nop 0
    v_add_f32 v4, 1.0, v4
    v_rcp_f32 v4, v4
    s_nop 0
    v_mul_f32 v114, v114, v4
    v_cvt_pk_bf16_f32 v114, 0, v114
    v_and_b32 v115, s6, v121
    v_mul_f32 v5, s7, v115
    v_exp_f32 v5, -v5
    s_nop 0
    v_add_f32 v5, 1.0, v5
    v_rcp_f32 v5, v5
    s_nop 0
    v_mul_f32 v115, v115, v5
    v_cvt_pk_bf16_f32 v115, 0, v115
    s_barrier
    s_add_u32 s96, s85, 7
    s_and_b32 s97, s96, 15
    s_lshl3_add_u32 s98, s97, s3
    s_sub_u32 s99, s98, 4
    s_mul_i32 s96, s99, 49152
    s_lshl_b32 s97, s11, 7
    s_add_u32 s82, s96, s97
    s_sub_u32 s96, s3, 4
    s_lshr_b32 s97, s96, 1
    s_mul_i32 s98, s97, 2080
    s_sub_u32 s99, s3, 4
    s_and_b32 s96, s99, 1
    s_mul_i32 s97, s96, 1056
    s_add_u32 s99, s98, s97
    s_add_u32 s20, s99, 24960
    s_mov_b32 m0, s20
    s_nop 0
    buffer_load_dwordx4 v62, s[40:43], s82 offen lds
    s_add_u32 s82, s82, 2048
    s_add_u32 m0, s20, 8320
    s_nop 0
    buffer_load_dwordx4 v62, s[40:43], s82 offen lds
    s_add_u32 s82, s82, 2048
    s_add_u32 m0, s20, 16640
    s_nop 0
    buffer_load_dwordx4 v62, s[40:43], s82 offen lds
    s_add_u32 s96, s85, 7
    s_and_b32 s97, s96, 15
    s_lshl3_add_u32 s98, s97, s3
    s_mul_i32 s99, s98, 49152
    s_lshl_b32 s96, s11, 7
    s_add_u32 s82, s99, s96
    s_lshr_b32 s96, s3, 1
    s_mul_i32 s97, s96, 2080
    s_and_b32 s98, s3, 1
    s_mul_i32 s99, s98, 1056
    s_add_u32 s96, s97, s99
    s_add_u32 s20, s96, 24960
    s_mov_b32 m0, s20
    s_nop 0
    buffer_load_dwordx4 v62, s[40:43], s82 offen lds
    s_add_u32 s82, s82, 2048
    s_add_u32 m0, s20, 8320
    s_nop 0
    buffer_load_dwordx4 v62, s[40:43], s82 offen lds
    s_add_u32 s82, s82, 2048
    s_add_u32 m0, s20, 16640
    s_nop 0
    buffer_load_dwordx4 v62, s[40:43], s82 offen lds
    buffer_load_dwordx4 v[88:91], v60, s[48:51], s17 offen nt
    s_add_u32 s17, s17, 12288
    buffer_load_dwordx4 v[92:95], v60, s[48:51], s17 offen nt
    s_add_u32 s17, s17, 12288
    v_lshlrev_b32 v116, 16, v122
    v_mul_f32 v4, s7, v116
    v_exp_f32 v4, -v4
    s_nop 0
    v_add_f32 v4, 1.0, v4
    v_rcp_f32 v4, v4
    s_nop 0
    v_mul_f32 v116, v116, v4
    v_cvt_pk_bf16_f32 v116, 0, v116
    v_and_b32 v117, s6, v122
    v_mul_f32 v5, s7, v117
    v_exp_f32 v5, -v5
    s_nop 0
    v_add_f32 v5, 1.0, v5
    v_rcp_f32 v5, v5
    s_nop 0
    v_mul_f32 v117, v117, v5
    v_cvt_pk_bf16_f32 v117, 0, v117
    v_lshlrev_b32 v118, 16, v123
    v_mul_f32 v4, s7, v118
    v_exp_f32 v4, -v4
    s_nop 0
    v_add_f32 v4, 1.0, v4
    v_rcp_f32 v4, v4
    s_nop 0
    v_mul_f32 v118, v118, v4
    v_cvt_pk_bf16_f32 v118, 0, v118
    v_and_b32 v119, s6, v123
    v_mul_f32 v5, s7, v119
    v_exp_f32 v5, -v5
    s_nop 0
    v_add_f32 v5, 1.0, v5
    v_rcp_f32 v5, v5
    s_nop 0
    v_mul_f32 v119, v119, v5
    v_cvt_pk_bf16_f32 v119, 0, v119
    s_barrier
    s_add_u32 s96, s85, 8
    s_and_b32 s97, s96, 15
    s_lshl3_add_u32 s98, s97, s3
    s_sub_u32 s99, s98, 4
    s_mul_i32 s96, s99, 49152
    s_lshl_b32 s97, s11, 7
    s_add_u32 s82, s96, s97
    s_sub_u32 s96, s3, 4
    s_lshr_b32 s97, s96, 1
    s_mul_i32 s98, s97, 2080
    s_sub_u32 s99, s3, 4
    s_and_b32 s96, s99, 1
    s_mul_i32 s97, s96, 1056
    s_add_u32 s99, s98, s97
    s_add_u32 s20, s99, 49920
    s_mov_b32 m0, s20
    s_nop 0
    buffer_load_dwordx4 v62, s[40:43], s82 offen lds
    s_add_u32 s82, s82, 2048
    s_add_u32 m0, s20, 8320
    s_nop 0
    buffer_load_dwordx4 v62, s[40:43], s82 offen lds
    s_add_u32 s82, s82, 2048
    s_add_u32 m0, s20, 16640
    s_nop 0
    buffer_load_dwordx4 v62, s[40:43], s82 offen lds
    s_add_u32 s96, s85, 8
    s_and_b32 s97, s96, 15
    s_lshl3_add_u32 s98, s97, s3
    s_mul_i32 s99, s98, 49152
    s_lshl_b32 s96, s11, 7
    s_add_u32 s82, s99, s96
    s_lshr_b32 s96, s3, 1
    s_mul_i32 s97, s96, 2080
    s_and_b32 s98, s3, 1
    s_mul_i32 s99, s98, 1056
    s_add_u32 s96, s97, s99
    s_add_u32 s20, s96, 49920
    s_mov_b32 m0, s20
    s_nop 0
    buffer_load_dwordx4 v62, s[40:43], s82 offen lds
    s_add_u32 s82, s82, 2048
    s_add_u32 m0, s20, 8320
    s_nop 0
    buffer_load_dwordx4 v62, s[40:43], s82 offen lds
    s_add_u32 s82, s82, 2048
    s_add_u32 m0, s20, 16640
    s_nop 0
    buffer_load_dwordx4 v62, s[40:43], s82 offen lds
    s_waitcnt lgkmcnt(0)
    s_load_dword s24, s[32:33], s92 offset:1536 glc
    s_load_dword s25, s[32:33], s92 offset:1280 glc
    s_load_dword s26, s[32:33], s92 offset:2048 glc
    s_load_dword s27, s[32:33], s92 offset:1792 glc
    s_waitcnt vmcnt(21)
    v_lshlrev_b32 v4, 16, v80
    v_and_b32 v5, s6, v80
    v_mul_f32 v20, v4, v112
    v_mul_f32 v21, v5, v112
    v_lshlrev_b32 v6, 16, v81
    v_and_b32 v7, s6, v81
    v_mul_f32 v22, v6, v112
    v_mul_f32 v23, v7, v112
    v_lshlrev_b32 v4, 16, v82
    v_and_b32 v5, s6, v82
    v_mul_f32 v24, v4, v112
    v_mul_f32 v25, v5, v112
    v_lshlrev_b32 v6, 16, v83
    v_and_b32 v7, s6, v83
    v_mul_f32 v26, v6, v112
    v_mul_f32 v27, v7, v112
    s_barrier
    s_add_u32 s96, s85, 9
    s_and_b32 s97, s96, 15
    s_lshl3_add_u32 s98, s97, s3
    s_sub_u32 s99, s98, 4
    s_mul_i32 s96, s99, 49152
    s_lshl_b32 s97, s11, 7
    s_add_u32 s82, s96, s97
    s_sub_u32 s96, s3, 4
    s_lshr_b32 s97, s96, 1
    s_mul_i32 s98, s97, 2080
    s_sub_u32 s99, s3, 4
    s_and_b32 s96, s99, 1
    s_mul_i32 s97, s96, 1056
    s_add_u32 s99, s98, s97
    s_add_u32 s20, s99, 74880
    s_mov_b32 m0, s20
    s_nop 0
    buffer_load_dwordx4 v62, s[40:43], s82 offen lds
    s_add_u32 s82, s82, 2048
    s_add_u32 m0, s20, 8320
    s_nop 0
    buffer_load_dwordx4 v62, s[40:43], s82 offen lds
    s_add_u32 s82, s82, 2048
    s_add_u32 m0, s20, 16640
    s_nop 0
    buffer_load_dwordx4 v62, s[40:43], s82 offen lds
    s_add_u32 s96, s85, 9
    s_and_b32 s97, s96, 15
    s_lshl3_add_u32 s98, s97, s3
    s_mul_i32 s99, s98, 49152
    s_lshl_b32 s96, s11, 7
    s_add_u32 s82, s99, s96
    s_lshr_b32 s96, s3, 1
    s_mul_i32 s97, s96, 2080
    s_and_b32 s98, s3, 1
    s_mul_i32 s99, s98, 1056
    s_add_u32 s96, s97, s99
    s_add_u32 s20, s96, 74880
    s_mov_b32 m0, s20
    s_nop 0
    buffer_load_dwordx4 v62, s[40:43], s82 offen lds
    s_add_u32 s82, s82, 2048
    s_add_u32 m0, s20, 8320
    s_nop 0
    buffer_load_dwordx4 v62, s[40:43], s82 offen lds
    s_add_u32 s82, s82, 2048
    s_add_u32 m0, s20, 16640
    s_nop 0
    buffer_load_dwordx4 v62, s[40:43], s82 offen lds
    buffer_load_dwordx4 v[96:99], v60, s[48:51], s17 offen nt
    s_add_u32 s17, s17, 12288
    buffer_load_dwordx4 v[100:103], v60, s[48:51], s17 offen nt
    s_add_u32 s17, s17, 12288
    s_waitcnt vmcnt(28)
    v_lshlrev_b32 v4, 16, v84
    v_and_b32 v5, s6, v84
    v_fmac_f32 v20, v4, v113
    v_fmac_f32 v21, v5, v113
    v_lshlrev_b32 v6, 16, v85
    v_and_b32 v7, s6, v85
    v_fmac_f32 v22, v6, v113
    v_fmac_f32 v23, v7, v113
    v_lshlrev_b32 v4, 16, v86
    v_and_b32 v5, s6, v86
    v_fmac_f32 v24, v4, v113
    v_fmac_f32 v25, v5, v113
    v_lshlrev_b32 v6, 16, v87
    v_and_b32 v7, s6, v87
    v_fmac_f32 v26, v6, v113
    v_fmac_f32 v27, v7, v113
    s_waitcnt vmcnt(22)
    s_barrier
    s_add_u32 s96, s85, 10
    s_and_b32 s97, s96, 15
    s_lshl3_add_u32 s98, s97, s3
    s_sub_u32 s99, s98, 4
    s_mul_i32 s96, s99, 49152
    s_lshl_b32 s97, s11, 7
    s_add_u32 s82, s96, s97
    s_sub_u32 s96, s3, 4
    s_lshr_b32 s97, s96, 1
    s_mul_i32 s98, s97, 2080
    s_sub_u32 s99, s3, 4
    s_and_b32 s96, s99, 1
    s_mul_i32 s97, s96, 1056
    s_add_u32 s99, s98, s97
    s_add_u32 s20, s99, 99840
    s_mov_b32 m0, s20
    s_nop 0
    buffer_load_dwordx4 v62, s[40:43], s82 offen lds
    s_add_u32 s82, s82, 2048
    s_add_u32 m0, s20, 8320
    s_nop 0
    buffer_load_dwordx4 v62, s[40:43], s82 offen lds
    s_add_u32 s82, s82, 2048
    s_add_u32 m0, s20, 16640
    s_nop 0
    buffer_load_dwordx4 v62, s[40:43], s82 offen lds
    s_add_u32 s96, s85, 10
    s_and_b32 s97, s96, 15
    s_lshl3_add_u32 s98, s97, s3
    s_mul_i32 s99, s98, 49152
    s_lshl_b32 s96, s11, 7
    s_add_u32 s82, s99, s96
    s_lshr_b32 s96, s3, 1
    s_mul_i32 s97, s96, 2080
    s_and_b32 s98, s3, 1
    s_mul_i32 s99, s98, 1056
    s_add_u32 s96, s97, s99
    s_add_u32 s20, s96, 99840
    s_mov_b32 m0, s20
    s_nop 0
    buffer_load_dwordx4 v62, s[40:43], s82 offen lds
    s_add_u32 s82, s82, 2048
    s_add_u32 m0, s20, 8320
    s_nop 0
    buffer_load_dwordx4 v62, s[40:43], s82 offen lds
    s_add_u32 s82, s82, 2048
    s_add_u32 m0, s20, 16640
    s_nop 0
    buffer_load_dwordx4 v62, s[40:43], s82 offen lds
    s_waitcnt vmcnt(21)
    v_lshlrev_b32 v4, 16, v88
    v_and_b32 v5, s6, v88
    v_fmac_f32 v20, v4, v114
    v_fmac_f32 v21, v5, v114
    v_lshlrev_b32 v6, 16, v89
    v_and_b32 v7, s6, v89
    v_fmac_f32 v22, v6, v114
    v_fmac_f32 v23, v7, v114
    v_lshlrev_b32 v4, 16, v90
    v_and_b32 v5, s6, v90
    v_fmac_f32 v24, v4, v114
    v_fmac_f32 v25, v5, v114
    v_lshlrev_b32 v6, 16, v91
    v_and_b32 v7, s6, v91
    v_fmac_f32 v26, v6, v114
    v_fmac_f32 v27, v7, v114
    s_barrier
    s_add_u32 s96, s85, 11
    s_and_b32 s97, s96, 15
    s_lshl3_add_u32 s98, s97, s3
    s_sub_u32 s99, s98, 4
    s_mul_i32 s96, s99, 49152
    s_lshl_b32 s97, s11, 7
    s_add_u32 s82, s96, s97
    s_sub_u32 s96, s3, 4
    s_lshr_b32 s97, s96, 1
    s_mul_i32 s98, s97, 2080
    s_sub_u32 s99, s3, 4
    s_and_b32 s96, s99, 1
    s_mul_i32 s97, s96, 1056
    s_add_u32 s99, s98, s97
    s_add_u32 s20, s99, 124800
    s_mov_b32 m0, s20
    s_nop 0
    buffer_load_dwordx4 v62, s[40:43], s82 offen lds
    s_add_u32 s82, s82, 2048
    s_add_u32 m0, s20, 8320
    s_nop 0
    buffer_load_dwordx4 v62, s[40:43], s82 offen lds
    s_add_u32 s82, s82, 2048
    s_add_u32 m0, s20, 16640
    s_nop 0
    buffer_load_dwordx4 v62, s[40:43], s82 offen lds
    s_add_u32 s96, s85, 11
    s_and_b32 s97, s96, 15
    s_lshl3_add_u32 s98, s97, s3
    s_mul_i32 s99, s98, 49152
    s_lshl_b32 s96, s11, 7
    s_add_u32 s82, s99, s96
    s_lshr_b32 s96, s3, 1
    s_mul_i32 s97, s96, 2080
    s_and_b32 s98, s3, 1
    s_mul_i32 s99, s98, 1056
    s_add_u32 s96, s97, s99
    s_add_u32 s20, s96, 124800
    s_mov_b32 m0, s20
    s_nop 0
    buffer_load_dwordx4 v62, s[40:43], s82 offen lds
    s_add_u32 s82, s82, 2048
    s_add_u32 m0, s20, 8320
    s_nop 0
    buffer_load_dwordx4 v62, s[40:43], s82 offen lds
    s_add_u32 s82, s82, 2048
    s_add_u32 m0, s20, 16640
    s_nop 0
    buffer_load_dwordx4 v62, s[40:43], s82 offen lds
    buffer_load_dwordx4 v[104:107], v60, s[48:51], s17 offen nt
    s_add_u32 s17, s17, 12288
    buffer_load_dwordx4 v[108:111], v60, s[48:51], s17 offen nt
    s_lshl2_add_u32 s96, s74, s75
    s_lshl_b32 s97, s96, 11
    s_and_b32 s98, s3, 1
    s_lshl_b32 s99, s98, 10
    s_add_u32 s96, s97, s99
    s_add_u32 s13, s96, 20971520
    s_lshl4_add_u32 s96, s21, s12
    s_lshl_b32 s97, s96, 11
    s_and_b32 s98, s3, 1
    s_lshl_b32 s99, s98, 10
    s_add_u32 s96, s97, s99
    s_add_u32 s14, s96, 12582912
    buffer_load_dwordx4 v[124:127], v2, s[32:35], s13 offen
    s_waitcnt vmcnt(29)
    v_lshlrev_b32 v4, 16, v92
    v_and_b32 v5, s6, v92
    v_fmac_f32 v20, v4, v115
    v_fmac_f32 v21, v5, v115
    v_lshlrev_b32 v6, 16, v93
    v_and_b32 v7, s6, v93
    v_fmac_f32 v22, v6, v115
    v_fmac_f32 v23, v7, v115
    v_lshlrev_b32 v4, 16, v94
    v_and_b32 v5, s6, v94
    v_fmac_f32 v24, v4, v115
    v_fmac_f32 v25, v5, v115
    v_lshlrev_b32 v6, 16, v95
    v_and_b32 v7, s6, v95
    v_fmac_f32 v26, v6, v115
    v_fmac_f32 v27, v7, v115
    s_waitcnt lgkmcnt(0)
    s_load_dword s24, s[32:33], s92 offset:2560 glc
    s_load_dword s25, s[32:33], s92 offset:2304 glc
    s_load_dword s26, s[32:33], s92 offset:3072 glc
    s_load_dword s27, s[32:33], s92 offset:2816 glc
    s_load_dword s28, s[32:33], s92 offset:3584 glc
    s_load_dword s29, s[32:33], s92 offset:3328 glc
    s_waitcnt vmcnt(23)
    s_barrier
    s_add_u32 s96, s85, 12
    s_and_b32 s97, s96, 15
    s_lshl3_add_u32 s98, s97, s3
    s_sub_u32 s99, s98, 4
    s_mul_i32 s96, s99, 49152
    s_lshl_b32 s97, s11, 7
    s_add_u32 s82, s96, s97
    s_sub_u32 s96, s3, 4
    s_lshr_b32 s97, s96, 1
    s_mul_i32 s98, s97, 2080
    s_sub_u32 s99, s3, 4
    s_and_b32 s96, s99, 1
    s_mul_i32 s97, s96, 1056
    s_add_u32 s20, s98, s97
    s_mov_b32 m0, s20
    s_nop 0
    buffer_load_dwordx4 v62, s[40:43], s82 offen lds
    s_add_u32 s82, s82, 2048
    s_add_u32 m0, s20, 8320
    s_nop 0
    buffer_load_dwordx4 v62, s[40:43], s82 offen lds
    s_add_u32 s82, s82, 2048
    s_add_u32 m0, s20, 16640
    s_nop 0
    buffer_load_dwordx4 v62, s[40:43], s82 offen lds
    s_add_u32 s96, s85, 12
    s_and_b32 s97, s96, 15
    s_lshl3_add_u32 s98, s97, s3
    s_mul_i32 s99, s98, 49152
    s_lshl_b32 s96, s11, 7
    s_add_u32 s82, s99, s96
    s_lshr_b32 s96, s3, 1
    s_mul_i32 s97, s96, 2080
    s_and_b32 s98, s3, 1
    s_mul_i32 s99, s98, 1056
    s_add_u32 s20, s97, s99
    s_mov_b32 m0, s20
    s_nop 0
    buffer_load_dwordx4 v62, s[40:43], s82 offen lds
    s_add_u32 s82, s82, 2048
    s_add_u32 m0, s20, 8320
    s_nop 0
    buffer_load_dwordx4 v62, s[40:43], s82 offen lds
    s_add_u32 s82, s82, 2048
    s_add_u32 m0, s20, 16640
    s_nop 0
    buffer_load_dwordx4 v62, s[40:43], s82 offen lds
    s_waitcnt vmcnt(22)
    v_lshlrev_b32 v4, 16, v96
    v_and_b32 v5, s6, v96
    v_fmac_f32 v20, v4, v116
    v_fmac_f32 v21, v5, v116
    v_lshlrev_b32 v6, 16, v97
    v_and_b32 v7, s6, v97
    v_fmac_f32 v22, v6, v116
    v_fmac_f32 v23, v7, v116
    v_lshlrev_b32 v4, 16, v98
    v_and_b32 v5, s6, v98
    v_fmac_f32 v24, v4, v116
    v_fmac_f32 v25, v5, v116
    v_lshlrev_b32 v6, 16, v99
    v_and_b32 v7, s6, v99
    v_fmac_f32 v26, v6, v116
    v_fmac_f32 v27, v7, v116
    s_waitcnt vmcnt(21)
    v_lshlrev_b32 v4, 16, v100
    v_and_b32 v5, s6, v100
    v_fmac_f32 v20, v4, v117
    v_fmac_f32 v21, v5, v117
    v_lshlrev_b32 v6, 16, v101
    v_and_b32 v7, s6, v101
    v_fmac_f32 v22, v6, v117
    v_fmac_f32 v23, v7, v117
    v_lshlrev_b32 v4, 16, v102
    v_and_b32 v5, s6, v102
    v_fmac_f32 v24, v4, v117
    v_fmac_f32 v25, v5, v117
    v_lshlrev_b32 v6, 16, v103
    v_and_b32 v7, s6, v103
    v_fmac_f32 v26, v6, v117
    v_fmac_f32 v27, v7, v117
    s_barrier
    s_add_u32 s96, s85, 13
    s_and_b32 s97, s96, 15
    s_lshl3_add_u32 s98, s97, s3
    s_sub_u32 s99, s98, 4
    s_mul_i32 s96, s99, 49152
    s_lshl_b32 s97, s11, 7
    s_add_u32 s82, s96, s97
    s_sub_u32 s96, s3, 4
    s_lshr_b32 s97, s96, 1
    s_mul_i32 s98, s97, 2080
    s_sub_u32 s99, s3, 4
    s_and_b32 s96, s99, 1
    s_mul_i32 s97, s96, 1056
    s_add_u32 s99, s98, s97
    s_add_u32 s20, s99, 24960
    s_mov_b32 m0, s20
    s_nop 0
    buffer_load_dwordx4 v62, s[40:43], s82 offen lds
    s_add_u32 s82, s82, 2048
    s_add_u32 m0, s20, 8320
    s_nop 0
    buffer_load_dwordx4 v62, s[40:43], s82 offen lds
    s_add_u32 s82, s82, 2048
    s_add_u32 m0, s20, 16640
    s_nop 0
    buffer_load_dwordx4 v62, s[40:43], s82 offen lds
    s_add_u32 s96, s85, 13
    s_and_b32 s97, s96, 15
    s_lshl3_add_u32 s98, s97, s3
    s_mul_i32 s99, s98, 49152
    s_lshl_b32 s96, s11, 7
    s_add_u32 s82, s99, s96
    s_lshr_b32 s96, s3, 1
    s_mul_i32 s97, s96, 2080
    s_and_b32 s98, s3, 1
    s_mul_i32 s99, s98, 1056
    s_add_u32 s96, s97, s99
    s_add_u32 s20, s96, 24960
    s_mov_b32 m0, s20
    s_nop 0
    buffer_load_dwordx4 v62, s[40:43], s82 offen lds
    s_add_u32 s82, s82, 2048
    s_add_u32 m0, s20, 8320
    s_nop 0
    buffer_load_dwordx4 v62, s[40:43], s82 offen lds
    s_add_u32 s82, s82, 2048
    s_add_u32 m0, s20, 16640
    s_nop 0
    buffer_load_dwordx4 v62, s[40:43], s82 offen lds
    s_waitcnt vmcnt(14)
    v_lshlrev_b32 v4, 16, v104
    v_and_b32 v5, s6, v104
    v_fmac_f32 v20, v4, v118
    v_fmac_f32 v21, v5, v118
    v_lshlrev_b32 v6, 16, v105
    v_and_b32 v7, s6, v105
    v_fmac_f32 v22, v6, v118
    v_fmac_f32 v23, v7, v118
    v_lshlrev_b32 v4, 16, v106
    v_and_b32 v5, s6, v106
    v_fmac_f32 v24, v4, v118
    v_fmac_f32 v25, v5, v118
    v_lshlrev_b32 v6, 16, v107
    v_and_b32 v7, s6, v107
    v_fmac_f32 v26, v6, v118
    v_fmac_f32 v27, v7, v118
    s_waitcnt vmcnt(13)
    v_lshlrev_b32 v4, 16, v108
    v_and_b32 v5, s6, v108
    v_fmac_f32 v20, v4, v119
    v_fmac_f32 v21, v5, v119
    v_lshlrev_b32 v6, 16, v109
    v_and_b32 v7, s6, v109
    v_fmac_f32 v22, v6, v119
    v_fmac_f32 v23, v7, v119
    v_lshlrev_b32 v4, 16, v110
    v_and_b32 v5, s6, v110
    v_fmac_f32 v24, v4, v119
    v_fmac_f32 v25, v5, v119
    v_lshlrev_b32 v6, 16, v111
    v_and_b32 v7, s6, v111
    v_fmac_f32 v26, v6, v119
    v_fmac_f32 v27, v7, v119
    v_permlane32_swap_b32 v20, v24
    v_permlane32_swap_b32 v21, v25
    v_permlane32_swap_b32 v22, v26
    v_permlane32_swap_b32 v23, v27
    v_add_f32 v20, v20, v24
    v_add_f32 v21, v21, v25
    v_add_f32 v22, v22, v26
    v_add_f32 v23, v23, v27
    s_nop 0
    v_permlane16_swap_b32 v20, v22
    v_permlane16_swap_b32 v21, v23
    v_add_f32 v20, v20, v22
    v_add_f32 v21, v21, v23
    s_nop 0
    v_add_f32_dpp v20, v20, v20 row_ror:8 row_mask:0xf bank_mask:0xf
    v_add_f32_dpp v21, v21, v21 row_ror:8 row_mask:0xf bank_mask:0xf
    s_nop 1
    v_mov_b32_dpp v20, v21 quad_perm:[0,1,2,3] row_mask:0xf bank_mask:0xc
    ds_write_b32 v65, v20 offset:1024
    s_waitcnt lgkmcnt(0)
    s_barrier
    s_add_u32 s96, s85, 14
    s_and_b32 s97, s96, 15
    s_lshl3_add_u32 s98, s97, s3
    s_sub_u32 s99, s98, 4
    s_mul_i32 s96, s99, 49152
    s_lshl_b32 s97, s11, 7
    s_add_u32 s82, s96, s97
    s_sub_u32 s96, s3, 4
    s_lshr_b32 s97, s96, 1
    s_mul_i32 s98, s97, 2080
    s_sub_u32 s99, s3, 4
    s_and_b32 s96, s99, 1
    s_mul_i32 s97, s96, 1056
    s_add_u32 s99, s98, s97
    s_add_u32 s20, s99, 49920
    s_mov_b32 m0, s20
    s_nop 0
    buffer_load_dwordx4 v62, s[40:43], s82 offen lds
    s_add_u32 s82, s82, 2048
    s_add_u32 m0, s20, 8320
    s_nop 0
    buffer_load_dwordx4 v62, s[40:43], s82 offen lds
    s_add_u32 s82, s82, 2048
    s_add_u32 m0, s20, 16640
    s_nop 0
    buffer_load_dwordx4 v62, s[40:43], s82 offen lds
    s_add_u32 s96, s85, 14
    s_and_b32 s97, s96, 15
    s_lshl3_add_u32 s98, s97, s3
    s_mul_i32 s99, s98, 49152
    s_lshl_b32 s96, s11, 7
    s_add_u32 s82, s99, s96
    s_lshr_b32 s96, s3, 1
    s_mul_i32 s97, s96, 2080
    s_and_b32 s98, s3, 1
    s_mul_i32 s99, s98, 1056
    s_add_u32 s96, s97, s99
    s_add_u32 s20, s96, 49920
    s_mov_b32 m0, s20
    s_nop 0
    buffer_load_dwordx4 v62, s[40:43], s82 offen lds
    s_add_u32 s82, s82, 2048
    s_add_u32 m0, s20, 8320
    s_nop 0
    buffer_load_dwordx4 v62, s[40:43], s82 offen lds
    s_add_u32 s82, s82, 2048
    s_add_u32 m0, s20, 16640
    s_nop 0
    buffer_load_dwordx4 v62, s[40:43], s82 offen lds
    s_cmp_lg_u32 s3, 4
    s_cbranch_scc1 L_M2F
    ds_read_b128 v[20:23], v64 offset:1024
    s_bfe_u32 s96, s9, 131074
    s_lshl_b32 s97, s8, 1
    s_lshl4_add_u32 s98, s96, s97
    s_lshr_b32 s99, s9, 4
    s_add_u32 s96, s98, s99
    s_and_b32 s97, s9, 3
    s_lshl2_add_u32 s98, s96, s97
    s_lshl_b32 s99, s98, 9
    s_add_u32 s13, s99, 131072
    s_waitcnt lgkmcnt(0)
    v_add_f32 v20, v20, v21
    v_add_f32 v22, v22, v23
    v_mov_b32 v21, s4
    v_add_f32 v20, v20, v22
    buffer_store_dwordx2 v[20:21], v63, s[32:35], s13 offen sc1
L_M2F:
    s_barrier
    s_add_u32 s96, s85, 15
    s_and_b32 s97, s96, 15
    s_lshl3_add_u32 s98, s97, s3
    s_sub_u32 s99, s98, 4
    s_mul_i32 s96, s99, 49152
    s_lshl_b32 s97, s11, 7
    s_add_u32 s82, s96, s97
    s_sub_u32 s96, s3, 4
    s_lshr_b32 s97, s96, 1
    s_mul_i32 s98, s97, 2080
    s_sub_u32 s99, s3, 4
    s_and_b32 s96, s99, 1
    s_mul_i32 s97, s96, 1056
    s_add_u32 s99, s98, s97
    s_add_u32 s20, s99, 74880
    s_mov_b32 m0, s20
    s_nop 0
    buffer_load_dwordx4 v62, s[40:43], s82 offen lds
    s_add_u32 s82, s82, 2048
    s_add_u32 m0, s20, 8320
    s_nop 0
    buffer_load_dwordx4 v62, s[40:43], s82 offen lds
    s_add_u32 s82, s82, 2048
    s_add_u32 m0, s20, 16640
    s_nop 0
    buffer_load_dwordx4 v62, s[40:43], s82 offen lds
    s_add_u32 s96, s85, 15
    s_and_b32 s97, s96, 15
    s_lshl3_add_u32 s98, s97, s3
    s_mul_i32 s99, s98, 49152
    s_lshl_b32 s96, s11, 7
    s_add_u32 s82, s99, s96
    s_lshr_b32 s96, s3, 1
    s_mul_i32 s97, s96, 2080
    s_and_b32 s98, s3, 1
    s_mul_i32 s99, s98, 1056
    s_add_u32 s96, s97, s99
    s_add_u32 s20, s96, 74880
    s_mov_b32 m0, s20
    s_nop 0
    buffer_load_dwordx4 v62, s[40:43], s82 offen lds
    s_add_u32 s82, s82, 2048
    s_add_u32 m0, s20, 8320
    s_nop 0
    buffer_load_dwordx4 v62, s[40:43], s82 offen lds
    s_add_u32 s82, s82, 2048
    s_add_u32 m0, s20, 16640
    s_nop 0
    buffer_load_dwordx4 v62, s[40:43], s82 offen lds
    s_mov_b32 s13, s80
    buffer_load_dwordx4 v[176:179], v72, s[52:55], s13 offen nt
    s_add_u32 s13, s80, 4294049792
    buffer_load_dwordx4 v[180:183], v72, s[52:55], s13 offen nt
    s_waitcnt vmcnt(20)
    s_barrier
    s_waitcnt vmcnt(14)
    s_waitcnt vmcnt(8)
    s_waitcnt vmcnt(2)
    s_barrier
    v_and_b32 v89, 31, v1
    v_lshlrev_b32 v89, 4, v89
    v_lshrrev_b32 v9, 5, v1
    v_lshl_add_u32 v89, v9, 9, v89
    s_and_b32 s96, s3, 3
    s_lshl4_add_u32 s97, s96, s12
    s_lshl_b32 s98, s97, 11
    s_add_u32 s18, s98, 131072
    s_lshl_b32 s13, s12, 7
    v_and_b32 v4, 31, v1
    v_lshl_add_u32 v4, v4, 2, s13
    global_load_dword v88, v4, s[78:79]
    buffer_load_dwordx4 v[80:83], v89, s[32:35], s18 offen sc1
    buffer_load_dwordx4 v[84:87], v89, s[32:35], s18 offen offset:1024 sc1
    s_barrier
    s_lshl4_add_u32 s96, s11, s10
    s_lshl_b32 s97, s96, 10
    s_and_b32 s98, s3, 3
    s_lshl_b32 s99, s98, 8
    s_add_u32 s96, s97, s99
    s_add_u32 s13, s96, 29360128
    s_lshl_b32 s96, s11, 7
    s_add_u32 s14, s96, 32768
    v_lshlrev_b32 v60, 7, v1
    s_mov_b64 exec, 3
    buffer_load_dword v60, v60, s[32:35], s13 offen
    buffer_load_dword v61, v3, s[32:35], s14 offen
    s_mov_b64 exec, -1
    s_add_u32 s96, s84, 1114112
    s_and_b32 s97, s96, 1048575
    s_lshl_b32 s98, s83, 16
    s_xor_b32 s99, s97, s98
    s_xor_b32 s96, s88, 1048576
    s_add_u32 s13, s99, s96
    s_add_u32 m0, s89, 102400
    s_nop 0
    buffer_load_dwordx4 v74, s[44:47], s13 offen lds
    s_add_u32 s96, s84, 1179648
    s_and_b32 s97, s96, 1048575
    s_lshl_b32 s98, s83, 16
    s_xor_b32 s99, s97, s98
    s_xor_b32 s96, s88, 1048576
    s_add_u32 s13, s99, s96
    s_add_u32 m0, s89, 106496
    s_nop 0
    buffer_load_dwordx4 v74, s[44:47], s13 offen lds
    s_add_u32 s96, s84, 1245184
    s_and_b32 s97, s96, 1048575
    s_lshl_b32 s98, s83, 16
    s_xor_b32 s99, s97, s98
    s_xor_b32 s96, s88, 1048576
    s_add_u32 s13, s99, s96
    s_add_u32 m0, s89, 110592
    s_nop 0
    buffer_load_dwordx4 v74, s[44:47], s13 offen lds
    s_add_u32 s96, s84, 1310720
    s_and_b32 s97, s96, 1048575
    s_lshl_b32 s98, s83, 16
    s_xor_b32 s99, s97, s98
    s_xor_b32 s96, s88, 1048576
    s_add_u32 s13, s99, s96
    s_add_u32 m0, s89, 114688
    s_nop 0
    buffer_load_dwordx4 v74, s[44:47], s13 offen lds
    s_add_u32 s96, s84, 1376256
    s_and_b32 s97, s96, 1048575
    s_lshl_b32 s98, s83, 16
    s_xor_b32 s99, s97, s98
    s_xor_b32 s96, s88, 1048576
    s_add_u32 s13, s99, s96
    s_add_u32 m0, s89, 118784
    s_nop 0
    buffer_load_dwordx4 v74, s[44:47], s13 offen lds
    s_add_u32 s96, s84, 1441792
    s_and_b32 s97, s96, 1048575
    s_lshl_b32 s98, s83, 16
    s_xor_b32 s99, s97, s98
    s_xor_b32 s96, s88, 1048576
    s_add_u32 s13, s99, s96
    s_add_u32 m0, s89, 122880
    s_nop 0
    buffer_load_dwordx4 v74, s[44:47], s13 offen lds
    s_add_u32 s96, s84, 1507328
    s_and_b32 s97, s96, 1048575
    s_lshl_b32 s98, s83, 16
    s_xor_b32 s99, s97, s98
    s_xor_b32 s96, s88, 1048576
    s_add_u32 s13, s99, s96
    s_add_u32 m0, s89, 126976
    s_nop 0
    buffer_load_dwordx4 v74, s[44:47], s13 offen lds
    s_add_u32 s96, s84, 1572864
    s_and_b32 s97, s96, 1048575
    s_lshl_b32 s98, s83, 16
    s_xor_b32 s99, s97, s98
    s_xor_b32 s96, s88, 1048576
    s_add_u32 s13, s99, s96
    s_add_u32 m0, s89, 131072
    s_nop 0
    buffer_load_dwordx4 v74, s[44:47], s13 offen lds
    s_add_u32 s13, s80, 57344
    buffer_load_dwordx4 v[184:187], v72, s[52:55], s13 offen nt
    s_add_u32 s13, s80, 4294107136
    buffer_load_dwordx4 v[188:191], v72, s[52:55], s13 offen nt
    s_add_u32 s13, s80, 114688
    buffer_load_dwordx4 v[192:195], v72, s[52:55], s13 offen nt
    s_add_u32 s13, s80, 4294164480
    buffer_load_dwordx4 v[196:199], v72, s[52:55], s13 offen nt
    s_add_u32 s13, s80, 172032
    buffer_load_dwordx4 v[200:203], v72, s[52:55], s13 offen nt
    s_add_u32 s13, s80, 4294221824
    buffer_load_dwordx4 v[204:207], v72, s[52:55], s13 offen nt
    s_mov_b32 s13, s80
    buffer_load_dwordx4 v[208:211], v72, s[56:59], s13 offen nt
    s_add_u32 s13, s80, 4294049792
    buffer_load_dwordx4 v[212:215], v72, s[56:59], s13 offen nt
    s_waitcnt vmcnt(18)
    v_bitop3_b32 v4, v81, v83, s4 bitop3:0x7e
    v_bitop3_b32 v4, v4, v85, s4 bitop3:0xf6
    v_bitop3_b32 v4, v4, v87, s4 bitop3:0xf6
    v_cmp_ne_u32 vcc, 0, v4
    s_cbranch_vccz TOK_14
POLL_15:
    buffer_load_dwordx4 v[80:83], v89, s[32:35], s18 offen sc1
    buffer_load_dwordx4 v[84:87], v89, s[32:35], s18 offen offset:1024 sc1
    s_waitcnt vmcnt(0)
    v_bitop3_b32 v4, v81, v83, s4 bitop3:0x7e
    v_bitop3_b32 v4, v4, v85, s4 bitop3:0xf6
    v_bitop3_b32 v4, v4, v87, s4 bitop3:0xf6
    v_cmp_ne_u32 vcc, 0, v4
    s_cbranch_vccz PDONE_16
    s_add_u32 s5, s5, 1
    s_cmp_lt_u32 s5, 300000
    s_cbranch_scc1 POLL_15
PDONE_16:
TOK_14:
    s_and_b32 s96, s3, 3
    s_lshl_b32 s97, s96, 7
    s_add_u32 s13, s97, 139264
    v_and_b32 v4, 31, v1
    v_lshl_add_u32 v4, v4, 2, s13
    s_and_b32 s14, s3, 3
    v_add_f32 v80, v80, v84
    v_add_f32 v81, v82, v86
    v_mov_b32 v82, v80
    v_mov_b32 v83, v81
    s_cmp_eq_u32 s14, 2
    s_cselect_b32 s15, 1.0, 0
    v_permlane32_swap_b32 v80, v82
    v_permlane32_swap_b32 v81, v83
    v_pk_add_f32 v[80:81], v[80:81], v[82:83]
    v_cvt_pk_bf16_f32 v80, 0, v80
    v_cvt_pk_bf16_f32 v81, 0, v81
    v_add_f32 v80, s15, v80
    v_add_f32 v81, s15, v81
    v_cvt_pk_bf16_f32 v82, v80, v81
    ds_write_b32 v4, v82
    s_cbranch_scc0 L_NOG
    v_lshlrev_b32 v80, 16, v82
    v_and_b32 v81, s6, v82
    v_lshlrev_b32 v84, 16, v88
    v_and_b32 v85, s6, v88
    v_pk_mul_f32 v[84:85], v[84:85], v[80:81]
    v_cvt_pk_bf16_f32 v86, v84, v85
    v_lshlrev_b32 v80, 16, v86
    v_and_b32 v81, s6, v86
    v_pk_add_f32 v[80:81], v[84:85], v[80:81] neg_lo:[0,1] neg_hi:[0,1]
    v_cvt_pk_bf16_f32 v87, v80, v81
    v_add_f32 v80, v84, v85
    ds_write2_b32 v4, v86, v87 offset0:64 offset1:96
    ds_write_b32 v4, v88 offset:512
    v_add_f32_dpp v80, v80, v80 quad_perm:[1,0,3,2] row_mask:0xf bank_mask:0xf
    s_nop 1
    v_add_f32_dpp v80, v80, v80 quad_perm:[2,3,0,1] row_mask:0xf bank_mask:0xf
    s_nop 1
    v_add_f32_dpp v80, v80, v80 row_half_mirror row_mask:0xf bank_mask:0xf
    s_nop 1
    v_add_f32_dpp v80, v80, v80 row_ror:8 row_mask:0xf bank_mask:0xf
    s_lshl4_add_u32 s96, s21, s12
    s_lshl3_add_u32 s13, s96, 65536
    v_mov_b32 v82, v80
    v_mov_b32 v81, s4
    s_nop 0
    v_permlane16_swap_b32 v80, v82
    v_add_f32 v80, v80, v82
    s_mov_b64 exec, 1
    buffer_store_dwordx2 v[80:81], v3, s[32:35], s13 offen sc1
    s_mov_b64 exec, -1
L_NOG:
    s_waitcnt lgkmcnt(0)
    s_barrier
    ds_read_b128 v[36:39], v76
    ds_read_b128 v[40:43], v76 offset:1024
    s_waitcnt lgkmcnt(0)
    v_mfma_f32_32x32x16_bf16 v[112:127], v[28:31], v[36:39], 0
    v_mfma_f32_32x32x16_bf16 v[112:127], v[32:35], v[40:43], v[112:127]
    s_add_u32 s13, s80, 57344
    buffer_load_dwordx4 v[216:219], v72, s[56:59], s13 offen nt
    s_add_u32 s13, s80, 4294107136
    buffer_load_dwordx4 v[220:223], v72, s[56:59], s13 offen nt
L_JOIN:
    s_nop 7
    v_cvt_pk_bf16_f32 v112, 0, v112
    v_cvt_pk_bf16_f32 v113, 0, v113
    v_cvt_pk_bf16_f32 v114, 0, v114
    v_cvt_pk_bf16_f32 v115, 0, v115
    v_cvt_pk_bf16_f32 v116, 0, v116
    v_cvt_pk_bf16_f32 v117, 0, v117
    v_cvt_pk_bf16_f32 v118, 0, v118
    v_cvt_pk_bf16_f32 v119, 0, v119
    v_cvt_pk_bf16_f32 v120, 0, v120
    v_cvt_pk_bf16_f32 v121, 0, v121
    v_cvt_pk_bf16_f32 v122, 0, v122
    v_cvt_pk_bf16_f32 v123, 0, v123
    v_cvt_pk_bf16_f32 v124, 0, v124
    v_cvt_pk_bf16_f32 v125, 0, v125
    v_cvt_pk_bf16_f32 v126, 0, v126
    v_cvt_pk_bf16_f32 v127, 0, v127
    v_max3_f32 v4, v112, v113, v114
    v_min3_f32 v5, v112, v113, v114
    v_max3_f32 v4, v4, v115, v116
    v_min3_f32 v5, v5, v115, v116
    v_max3_f32 v4, v4, v117, v118
    v_min3_f32 v5, v5, v117, v118
    v_max3_f32 v4, v4, v119, v120
    v_min3_f32 v5, v5, v119, v120
    v_max3_f32 v4, v4, v121, v122
    v_min3_f32 v5, v5, v121, v122
    v_max3_f32 v4, v4, v123, v124
    v_min3_f32 v5, v5, v123, v124
    v_max3_f32 v4, v4, v125, v126
    v_min3_f32 v5, v5, v125, v126
    v_max_f32 v6, v4, v127
    v_min_f32 v7, v5, v127
    v_max_f32 v4, v4, v127
    v_min_f32 v5, v5, v127
    s_nop 0
    v_permlane32_swap_b32 v4, v6
    v_permlane32_swap_b32 v5, v7
    v_max_f32 v4, v4, v6
    v_min_f32 v5, v5, v7
    v_pk_mul_f32 v[4:5], v[4:5], s[6:7] op_sel:[0,1]
    v_pk_fma_f32 v[128:129], v[112:113], s[6:7], v[4:5] op_sel:[0,1,0] op_sel_hi:[1,1,0] neg_lo:[0,0,1] neg_hi:[0,0,1]
    v_pk_fma_f32 v[112:113], v[112:113], s[6:7], v[4:5] op_sel:[0,1,1] neg_lo:[1,0,0] neg_hi:[1,0,0]
    v_pk_fma_f32 v[130:131], v[114:115], s[6:7], v[4:5] op_sel:[0,1,0] op_sel_hi:[1,1,0] neg_lo:[0,0,1] neg_hi:[0,0,1]
    v_pk_fma_f32 v[114:115], v[114:115], s[6:7], v[4:5] op_sel:[0,1,1] neg_lo:[1,0,0] neg_hi:[1,0,0]
    v_pk_fma_f32 v[132:133], v[116:117], s[6:7], v[4:5] op_sel:[0,1,0] op_sel_hi:[1,1,0] neg_lo:[0,0,1] neg_hi:[0,0,1]
    v_pk_fma_f32 v[116:117], v[116:117], s[6:7], v[4:5] op_sel:[0,1,1] neg_lo:[1,0,0] neg_hi:[1,0,0]
    v_pk_fma_f32 v[134:135], v[118:119], s[6:7], v[4:5] op_sel:[0,1,0] op_sel_hi:[1,1,0] neg_lo:[0,0,1] neg_hi:[0,0,1]
    v_pk_fma_f32 v[118:119], v[118:119], s[6:7], v[4:5] op_sel:[0,1,1] neg_lo:[1,0,0] neg_hi:[1,0,0]
    v_pk_fma_f32 v[136:137], v[120:121], s[6:7], v[4:5] op_sel:[0,1,0] op_sel_hi:[1,1,0] neg_lo:[0,0,1] neg_hi:[0,0,1]
    v_pk_fma_f32 v[120:121], v[120:121], s[6:7], v[4:5] op_sel:[0,1,1] neg_lo:[1,0,0] neg_hi:[1,0,0]
    v_pk_fma_f32 v[138:139], v[122:123], s[6:7], v[4:5] op_sel:[0,1,0] op_sel_hi:[1,1,0] neg_lo:[0,0,1] neg_hi:[0,0,1]
    v_pk_fma_f32 v[122:123], v[122:123], s[6:7], v[4:5] op_sel:[0,1,1] neg_lo:[1,0,0] neg_hi:[1,0,0]
    v_pk_fma_f32 v[140:141], v[124:125], s[6:7], v[4:5] op_sel:[0,1,0] op_sel_hi:[1,1,0] neg_lo:[0,0,1] neg_hi:[0,0,1]
    v_pk_fma_f32 v[124:125], v[124:125], s[6:7], v[4:5] op_sel:[0,1,1] neg_lo:[1,0,0] neg_hi:[1,0,0]
    v_pk_fma_f32 v[142:143], v[126:127], s[6:7], v[4:5] op_sel:[0,1,0] op_sel_hi:[1,1,0] neg_lo:[0,0,1] neg_hi:[0,0,1]
    v_pk_fma_f32 v[126:127], v[126:127], s[6:7], v[4:5] op_sel:[0,1,1] neg_lo:[1,0,0] neg_hi:[1,0,0]
    v_exp_f32 v128, v128
    v_exp_f32 v112, v112
    v_exp_f32 v129, v129
    v_exp_f32 v113, v113
    v_exp_f32 v130, v130
    v_exp_f32 v114, v114
    v_exp_f32 v131, v131
    v_exp_f32 v115, v115
    v_exp_f32 v132, v132
    v_exp_f32 v116, v116
    v_exp_f32 v133, v133
    v_exp_f32 v117, v117
    v_exp_f32 v134, v134
    v_exp_f32 v118, v118
    v_exp_f32 v135, v135
    v_exp_f32 v119, v119
    v_exp_f32 v136, v136
    v_exp_f32 v120, v120
    v_exp_f32 v137, v137
    v_exp_f32 v121, v121
    v_exp_f32 v138, v138
    v_exp_f32 v122, v122
    v_exp_f32 v139, v139
    v_exp_f32 v123, v123
    v_exp_f32 v140, v140
    v_exp_f32 v124, v124
    v_exp_f32 v141, v141
    v_exp_f32 v125, v125
    v_exp_f32 v142, v142
    v_exp_f32 v126, v126
    v_exp_f32 v143, v143
    v_exp_f32 v127, v127
    v_pk_add_f32 v[8:9], v[128:129], v[130:131]
    v_pk_add_f32 v[10:11], v[112:113], v[114:115]
    v_pk_add_f32 v[8:9], v[8:9], v[132:133]
    v_pk_add_f32 v[10:11], v[10:11], v[116:117]
    v_pk_add_f32 v[8:9], v[8:9], v[134:135]
    v_pk_add_f32 v[10:11], v[10:11], v[118:119]
    v_pk_add_f32 v[8:9], v[8:9], v[136:137]
    v_pk_add_f32 v[10:11], v[10:11], v[120:121]
    v_pk_add_f32 v[8:9], v[8:9], v[138:139]
    v_pk_add_f32 v[10:11], v[10:11], v[122:123]
    v_pk_add_f32 v[8:9], v[8:9], v[140:141]
    v_pk_add_f32 v[10:11], v[10:11], v[124:125]
    v_pk_add_f32 v[8:9], v[8:9], v[142:143]
    v_pk_add_f32 v[10:11], v[10:11], v[126:127]
    v_add_f32 v6, v8, v9
    v_add_f32 v7, v10, v11
    v_add_f32 v4, v8, v9
    v_add_f32 v5, v10, v11
    s_nop 0
    v_permlane32_swap_b32 v4, v6
    v_permlane32_swap_b32 v5, v7
    v_pk_add_f32 v[4:5], v[4:5], v[6:7]
    v_rcp_f32 v4, v4
    v_rcp_f32 v5, v5
    s_nop 0
    v_pk_mul_f32 v[128:129], v[128:129], v[4:5] op_sel_hi:[1,0]
    v_pk_mul_f32 v[112:113], v[112:113], v[4:5] op_sel:[0,1]
    v_pk_mul_f32 v[130:131], v[130:131], v[4:5] op_sel_hi:[1,0]
    v_pk_mul_f32 v[114:115], v[114:115], v[4:5] op_sel:[0,1]
    v_pk_mul_f32 v[132:133], v[132:133], v[4:5] op_sel_hi:[1,0]
    v_pk_mul_f32 v[116:117], v[116:117], v[4:5] op_sel:[0,1]
    v_pk_mul_f32 v[134:135], v[134:135], v[4:5] op_sel_hi:[1,0]
    v_pk_mul_f32 v[118:119], v[118:119], v[4:5] op_sel:[0,1]
    v_pk_mul_f32 v[136:137], v[136:137], v[4:5] op_sel_hi:[1,0]
    v_pk_mul_f32 v[120:121], v[120:121], v[4:5] op_sel:[0,1]
    v_pk_mul_f32 v[138:139], v[138:139], v[4:5] op_sel_hi:[1,0]
    v_pk_mul_f32 v[122:123], v[122:123], v[4:5] op_sel:[0,1]
    v_pk_mul_f32 v[140:141], v[140:141], v[4:5] op_sel_hi:[1,0]
    v_pk_mul_f32 v[124:125], v[124:125], v[4:5] op_sel:[0,1]
    v_pk_mul_f32 v[142:143], v[142:143], v[4:5] op_sel_hi:[1,0]
    v_pk_mul_f32 v[126:127], v[126:127], v[4:5] op_sel:[0,1]
    v_cvt_pk_bf16_f32 v80, v128, v129
    v_cvt_pk_bf16_f32 v88, v112, v113
    v_cvt_pk_bf16_f32 v81, v130, v131
    v_cvt_pk_bf16_f32 v89, v114, v115
    v_cvt_pk_bf16_f32 v82, v132, v133
    v_cvt_pk_bf16_f32 v90, v116, v117
    v_cvt_pk_bf16_f32 v83, v134, v135
    v_cvt_pk_bf16_f32 v91, v118, v119
    v_cvt_pk_bf16_f32 v84, v136, v137
    v_cvt_pk_bf16_f32 v92, v120, v121
    v_cvt_pk_bf16_f32 v85, v138, v139
    v_cvt_pk_bf16_f32 v93, v122, v123
    v_cvt_pk_bf16_f32 v86, v140, v141
    v_cvt_pk_bf16_f32 v94, v124, v125
    v_cvt_pk_bf16_f32 v87, v142, v143
    v_cvt_pk_bf16_f32 v95, v126, v127
    ds_write_b128 v75, v[80:83]
    ds_write_b128 v75, v[84:87] offset:4096
    ds_write_b128 v75, v[88:91] offset:8192
    ds_write_b128 v75, v[92:95] offset:12288
    s_lshl_b32 s13, s3, 12
    v_add_u32 v20, s13, v63
    s_lshl_b32 s96, s76, 13
    s_add_u32 s13, s96, 32768
    v_add_u32 v21, s13, v63
    v_mov_b32 v36, 0x3f803f80
    v_mov_b32 v37, 0x3f803f80
    v_mov_b32 v38, 0x3f803f80
    v_mov_b32 v39, 0x3f803f80
    s_lshl3_add_u32 s96, s11, s3
    s_lshl_b32 s97, s96, 5
    s_add_u32 s98, s97, s10
    s_lshl_b32 s99, s98, 10
    s_add_u32 s13, s99, 25165824
    s_add_u32 s15, s13, 16384
    s_lshl3_add_u32 s96, s11, s3
    s_lshl_b32 s97, s96, 10
    s_add_u32 s16, s97, 21495808
    s_lshl_b32 s96, s10, 6
    s_add_u32 s14, s96, s16
    s_waitcnt lgkmcnt(0)
    s_barrier
    s_lshl_b32 s96, s76, 6
    s_add_u32 s18, s96, 139264
    v_and_b32 v67, 7, v1
    v_lshl_add_u32 v67, v67, 2, s18
    v_lshrrev_b32 v9, 5, v1
    v_lshl_add_u32 v67, v9, 5, v67
    ds_read_b32 v64, v67
    ds_read_b32 v65, v67 offset:512
    ds_read_b32 v66, v67 offset:640
    ds_read_b32 v68, v67 offset:128
    ds_read_b32 v69, v67 offset:256
    ds_read_b32 v70, v67 offset:384
    ds_read_b32 v71, v67 offset:768
    ds_read_b64_tr_b16 v[128:129], v20
    ds_read_b64_tr_b16 v[130:131], v20 offset:512
    ds_read_b64_tr_b16 v[144:145], v21
    ds_read_b64_tr_b16 v[146:147], v21 offset:512
    ds_read_b64_tr_b16 v[148:149], v21 offset:4096
    ds_read_b64_tr_b16 v[150:151], v21 offset:4608
    ds_read_b64_tr_b16 v[132:133], v20 offset:1024
    ds_read_b64_tr_b16 v[134:135], v20 offset:1536
    ds_read_b64_tr_b16 v[152:153], v21 offset:1024
    ds_read_b64_tr_b16 v[154:155], v21 offset:1536
    ds_read_b64_tr_b16 v[156:157], v21 offset:5120
    ds_read_b64_tr_b16 v[158:159], v21 offset:5632
    ds_read_b64_tr_b16 v[136:137], v20 offset:2048
    ds_read_b64_tr_b16 v[138:139], v20 offset:2560
    ds_read_b64_tr_b16 v[160:161], v21 offset:2048
    ds_read_b64_tr_b16 v[162:163], v21 offset:2560
    ds_read_b64_tr_b16 v[164:165], v21 offset:6144
    ds_read_b64_tr_b16 v[166:167], v21 offset:6656
    s_waitcnt lgkmcnt(12)
    v_mfma_f32_16x16x32_bf16 v[52:55], v[128:131], v[144:147], 0
    v_mfma_f32_16x16x32_bf16 v[56:59], v[128:131], v[148:151], 0
    v_mfma_f32_16x16x32_bf16 v[40:43], v[128:131], v[36:39], 0
    ds_read_b64_tr_b16 v[140:141], v20 offset:3072
    ds_read_b64_tr_b16 v[142:143], v20 offset:3584
    ds_read_b64_tr_b16 v[168:169], v21 offset:3072
    ds_read_b64_tr_b16 v[170:171], v21 offset:3584
    ds_read_b64_tr_b16 v[172:173], v21 offset:7168
    ds_read_b64_tr_b16 v[174:175], v21 offset:7680
    s_waitcnt lgkmcnt(12)
    v_mfma_f32_16x16x32_bf16 v[52:55], v[132:135], v[152:155], v[52:55]
    v_mfma_f32_16x16x32_bf16 v[56:59], v[132:135], v[156:159], v[56:59]
    v_mfma_f32_16x16x32_bf16 v[40:43], v[132:135], v[36:39], v[40:43]
    v_and_b32 v75, 15, v1
    v_lshlrev_b32 v75, 15, v75
    s_and_b32 s96, s10, 1
    s_and_b32 s97, s2, 135
    s_lshl_b32 s98, s97, 12
    s_lshr_b32 s99, s10, 1
    s_lshl_b32 s97, s99, 6
    s_add_u32 s99, s98, s97
    s_lshl2_add_u32 s98, s96, s99
    s_add_u32 s97, s98, 1048576
    s_add_u32 s17, s97, 512
    s_waitcnt lgkmcnt(6)
    v_mfma_f32_16x16x32_bf16 v[52:55], v[136:139], v[160:163], v[52:55]
    v_mfma_f32_16x16x32_bf16 v[56:59], v[136:139], v[164:167], v[56:59]
    v_mfma_f32_16x16x32_bf16 v[40:43], v[136:139], v[36:39], v[40:43]
    s_waitcnt lgkmcnt(0)
    v_mfma_f32_16x16x32_bf16 v[52:55], v[140:143], v[168:171], v[52:55]
    v_mfma_f32_16x16x32_bf16 v[56:59], v[140:143], v[172:175], v[56:59]
    v_mfma_f32_16x16x32_bf16 v[40:43], v[140:143], v[36:39], v[40:43]
    s_cmp_lt_u32 s3, 4
    s_cbranch_scc1 L_NOQX
    ds_read_b128 v[44:47], v76 offset:2048
    ds_read_b128 v[48:51], v76 offset:3072
L_NOQX:
    s_nop 3
    buffer_store_dwordx4 v[52:55], v2, s[32:35], s13 offen sc1
    buffer_store_dwordx4 v[56:59], v2, s[32:35], s15 offen sc1
    s_mov_b32 exec_lo, 0x00010001
    s_mov_b32 exec_hi, 0x00010001
    buffer_store_dwordx4 v[40:43], v1, s[32:35], s14 offen sc1
    s_mov_b64 exec, -1
    s_waitcnt lgkmcnt(0)
    v_mfma_f32_32x32x16_bf16 v[112:127], v[28:31], v[44:47], 0
    v_mfma_f32_32x32x16_bf16 v[112:127], v[32:35], v[48:51], v[112:127]
    v_lshrrev_b32 v22, 3, v1
    v_lshlrev_b32 v22, 10, v22
    v_and_b32 v9, 7, v1
    v_lshl_add_u32 v22, v9, 4, v22
    v_and_b32 v76, 7, v1
    v_lshlrev_b32 v76, 4, v76
    v_lshrrev_b32 v9, 5, v1
    v_lshl_add_u32 v76, v9, 3, v76
    s_nop 3
    v_cvt_pk_bf16_f32 v112, 0, v112
    v_cvt_pk_bf16_f32 v113, 0, v113
    v_cvt_pk_bf16_f32 v114, 0, v114
    v_cvt_pk_bf16_f32 v115, 0, v115
    v_cvt_pk_bf16_f32 v116, 0, v116
    v_cvt_pk_bf16_f32 v117, 0, v117
    v_cvt_pk_bf16_f32 v118, 0, v118
    v_cvt_pk_bf16_f32 v119, 0, v119
    v_cvt_pk_bf16_f32 v120, 0, v120
    v_cvt_pk_bf16_f32 v121, 0, v121
    v_cvt_pk_bf16_f32 v122, 0, v122
    v_cvt_pk_bf16_f32 v123, 0, v123
    v_cvt_pk_bf16_f32 v124, 0, v124
    v_cvt_pk_bf16_f32 v125, 0, v125
    v_cvt_pk_bf16_f32 v126, 0, v126
    v_cvt_pk_bf16_f32 v127, 0, v127
    v_max3_f32 v52, v112, v113, v114
    v_min3_f32 v53, v112, v113, v114
    v_max3_f32 v52, v52, v115, v116
    v_min3_f32 v53, v53, v115, v116
    v_max3_f32 v52, v52, v117, v118
    v_min3_f32 v53, v53, v117, v118
    v_max3_f32 v52, v52, v119, v120
    v_min3_f32 v53, v53, v119, v120
    v_max3_f32 v52, v52, v121, v122
    v_min3_f32 v53, v53, v121, v122
    v_max3_f32 v52, v52, v123, v124
    v_min3_f32 v53, v53, v123, v124
    v_max3_f32 v52, v52, v125, v126
    v_min3_f32 v53, v53, v125, v126
    v_max_f32 v54, v52, v127
    v_min_f32 v55, v53, v127
    v_max_f32 v52, v52, v127
    v_min_f32 v53, v53, v127
    s_nop 0
    v_permlane32_swap_b32 v52, v54
    v_permlane32_swap_b32 v53, v55
    v_max_f32 v52, v52, v54
    v_min_f32 v53, v53, v55
    v_pk_mul_f32 v[52:53], v[52:53], s[6:7] op_sel:[0,1]
    v_pk_fma_f32 v[128:129], v[112:113], s[6:7], v[52:53] op_sel:[0,1,0] op_sel_hi:[1,1,0] neg_lo:[0,0,1] neg_hi:[0,0,1]
    v_pk_fma_f32 v[112:113], v[112:113], s[6:7], v[52:53] op_sel:[0,1,1] neg_lo:[1,0,0] neg_hi:[1,0,0]
    v_pk_fma_f32 v[130:131], v[114:115], s[6:7], v[52:53] op_sel:[0,1,0] op_sel_hi:[1,1,0] neg_lo:[0,0,1] neg_hi:[0,0,1]
    v_pk_fma_f32 v[114:115], v[114:115], s[6:7], v[52:53] op_sel:[0,1,1] neg_lo:[1,0,0] neg_hi:[1,0,0]
    v_pk_fma_f32 v[132:133], v[116:117], s[6:7], v[52:53] op_sel:[0,1,0] op_sel_hi:[1,1,0] neg_lo:[0,0,1] neg_hi:[0,0,1]
    v_pk_fma_f32 v[116:117], v[116:117], s[6:7], v[52:53] op_sel:[0,1,1] neg_lo:[1,0,0] neg_hi:[1,0,0]
    v_pk_fma_f32 v[134:135], v[118:119], s[6:7], v[52:53] op_sel:[0,1,0] op_sel_hi:[1,1,0] neg_lo:[0,0,1] neg_hi:[0,0,1]
    v_pk_fma_f32 v[118:119], v[118:119], s[6:7], v[52:53] op_sel:[0,1,1] neg_lo:[1,0,0] neg_hi:[1,0,0]
    v_pk_fma_f32 v[136:137], v[120:121], s[6:7], v[52:53] op_sel:[0,1,0] op_sel_hi:[1,1,0] neg_lo:[0,0,1] neg_hi:[0,0,1]
    v_pk_fma_f32 v[120:121], v[120:121], s[6:7], v[52:53] op_sel:[0,1,1] neg_lo:[1,0,0] neg_hi:[1,0,0]
    v_pk_fma_f32 v[138:139], v[122:123], s[6:7], v[52:53] op_sel:[0,1,0] op_sel_hi:[1,1,0] neg_lo:[0,0,1] neg_hi:[0,0,1]
    v_pk_fma_f32 v[122:123], v[122:123], s[6:7], v[52:53] op_sel:[0,1,1] neg_lo:[1,0,0] neg_hi:[1,0,0]
    v_pk_fma_f32 v[140:141], v[124:125], s[6:7], v[52:53] op_sel:[0,1,0] op_sel_hi:[1,1,0] neg_lo:[0,0,1] neg_hi:[0,0,1]
    v_pk_fma_f32 v[124:125], v[124:125], s[6:7], v[52:53] op_sel:[0,1,1] neg_lo:[1,0,0] neg_hi:[1,0,0]
    v_pk_fma_f32 v[142:143], v[126:127], s[6:7], v[52:53] op_sel:[0,1,0] op_sel_hi:[1,1,0] neg_lo:[0,0,1] neg_hi:[0,0,1]
    v_pk_fma_f32 v[126:127], v[126:127], s[6:7], v[52:53] op_sel:[0,1,1] neg_lo:[1,0,0] neg_hi:[1,0,0]
    v_exp_f32 v128, v128
    v_exp_f32 v112, v112
    v_exp_f32 v129, v129
    s_lshl_b32 s96, s11, 7
    s_add_u32 s18, s96, 32768
    s_lshl3_add_u32 s14, s10, s18
    v_and_b32 v23, 15, v1
    v_lshlrev_b32 v23, 3, v23
    s_waitcnt vmcnt(0)
    s_barrier
    s_cmp_lg_u32 s3, 0
    s_cbranch_scc1 L_PC
    v_mov_b32 v21, s4
    s_mov_b32 exec_hi, 0
    s_mov_b32 exec_lo, 65535
    buffer_store_dword v21, v75, s[32:35], s17 offen sc1
    s_mov_b64 exec, -1
L_PC:
    buffer_load_dword v67, v3, s[32:35], 0 offen offset:256 sc1
    s_lshl4_add_u32 s96, s11, s10
    s_lshl_b32 s97, s96, 14
    s_lshl_b32 s98, s3, 7
    s_add_u32 s99, s97, s98
    s_add_u32 s13, s99, 25165824
    s_lshl4_add_u32 s96, s11, s10
    s_lshl_b32 s97, s96, 10
    s_lshl_b32 s98, s3, 7
    s_add_u32 s99, s97, s98
    s_add_u32 s15, s99, 29360128
    s_add_u32 s17, s17, 3072
    s_load_dwordx2 s[24:25], s[32:33], s92 offset:512 glc
    s_add_u32 s96, s84, 262144
    s_and_b32 s97, s96, 1048575
    s_lshl_b32 s98, s83, 16
    s_xor_b32 s99, s97, s98
    s_add_u32 s19, s99, s88
    s_add_u32 m0, s89, 49152
    s_nop 0
    buffer_load_dwordx4 v74, s[44:47], s19 offen lds
    v_exp_f32 v113, v113
    v_exp_f32 v130, v130
    v_exp_f32 v114, v114
    v_exp_f32 v131, v131
    v_exp_f32 v115, v115
    v_exp_f32 v132, v132
    v_exp_f32 v116, v116
    v_exp_f32 v133, v133
    v_exp_f32 v117, v117
    v_exp_f32 v134, v134
    s_add_u32 s96, s84, 393216
    s_and_b32 s97, s96, 1048575
    s_lshl_b32 s98, s83, 16
    s_xor_b32 s99, s97, s98
    s_add_u32 s19, s99, s88
    s_add_u32 m0, s89, 57344
    s_nop 0
    buffer_load_dwordx4 v74, s[44:47], s19 offen lds
    v_exp_f32 v118, v118
    v_exp_f32 v135, v135
    v_exp_f32 v119, v119
    v_exp_f32 v136, v136
    v_exp_f32 v120, v120
    v_exp_f32 v137, v137
    v_exp_f32 v121, v121
    v_exp_f32 v138, v138
    v_exp_f32 v122, v122
    s_add_u32 s96, s84, 524288
    s_and_b32 s97, s96, 1048575
    s_lshl_b32 s98, s83, 16
    s_xor_b32 s99, s97, s98
    s_add_u32 s19, s99, s88
    s_add_u32 m0, s89, 65536
    s_nop 0
    buffer_load_dwordx4 v74, s[44:47], s19 offen lds
    v_exp_f32 v139, v139
    v_exp_f32 v123, v123
    v_exp_f32 v140, v140
    v_exp_f32 v124, v124
    v_exp_f32 v141, v141
    v_exp_f32 v125, v125
    v_exp_f32 v142, v142
    v_exp_f32 v126, v126
    v_exp_f32 v143, v143
    v_exp_f32 v127, v127
    s_add_u32 s96, s84, 655360
    s_and_b32 s97, s96, 1048575
    s_lshl_b32 s98, s83, 16
    s_xor_b32 s99, s97, s98
    s_add_u32 s19, s99, s88
    s_add_u32 m0, s89, 73728
    s_nop 0
    buffer_load_dwordx4 v74, s[44:47], s19 offen lds
    v_pk_add_f32 v[56:57], v[128:129], v[130:131]
    v_pk_add_f32 v[58:59], v[112:113], v[114:115]
    v_pk_add_f32 v[56:57], v[56:57], v[132:133]
    v_pk_add_f32 v[58:59], v[58:59], v[116:117]
    v_pk_add_f32 v[56:57], v[56:57], v[134:135]
    v_pk_add_f32 v[58:59], v[58:59], v[118:119]
    v_pk_add_f32 v[56:57], v[56:57], v[136:137]
    v_pk_add_f32 v[58:59], v[58:59], v[120:121]
    v_pk_add_f32 v[56:57], v[56:57], v[138:139]
    s_add_u32 s96, s84, 786432
    s_and_b32 s97, s96, 1048575
    s_lshl_b32 s98, s83, 16
    s_xor_b32 s99, s97, s98
    s_add_u32 s19, s99, s88
    s_add_u32 m0, s89, 81920
    s_nop 0
    buffer_load_dwordx4 v74, s[44:47], s19 offen lds
    v_pk_add_f32 v[58:59], v[58:59], v[122:123]
    v_pk_add_f32 v[56:57], v[56:57], v[140:141]
    v_pk_add_f32 v[58:59], v[58:59], v[124:125]
    v_pk_add_f32 v[56:57], v[56:57], v[142:143]
    v_pk_add_f32 v[58:59], v[58:59], v[126:127]
    v_add_f32 v54, v56, v57
    v_add_f32 v55, v58, v59
    v_add_f32 v52, v56, v57
    v_add_f32 v53, v58, v59
    s_nop 0
    v_permlane32_swap_b32 v52, v54
    s_add_u32 s96, s84, 917504
    s_and_b32 s97, s96, 1048575
    s_lshl_b32 s98, s83, 16
    s_xor_b32 s99, s97, s98
    s_add_u32 s19, s99, s88
    s_add_u32 m0, s89, 90112
    s_nop 0
    buffer_load_dwordx4 v74, s[44:47], s19 offen lds
    v_permlane32_swap_b32 v53, v55
    v_pk_add_f32 v[52:53], v[52:53], v[54:55]
    v_rcp_f32 v52, v52
    v_rcp_f32 v53, v53
    s_nop 0
    v_pk_mul_f32 v[128:129], v[128:129], v[52:53] op_sel_hi:[1,0]
    v_pk_mul_f32 v[112:113], v[112:113], v[52:53] op_sel:[0,1]
    v_pk_mul_f32 v[130:131], v[130:131], v[52:53] op_sel_hi:[1,0]
    v_pk_mul_f32 v[114:115], v[114:115], v[52:53] op_sel:[0,1]
    v_pk_mul_f32 v[132:133], v[132:133], v[52:53] op_sel_hi:[1,0]
    s_branch SCHK_18
SPOLL_17:
    s_load_dwordx2 s[24:25], s[32:33], s92 offset:512 glc
SCHK_18:
    s_add_u32 s5, s5, 1
    s_cmp_ge_u32 s5, 300000
    s_waitcnt lgkmcnt(0)
    s_cbranch_scc1 SDONE_19
    s_cmp_lg_u32 s24, s4
    s_cbranch_scc1 SPOLL_17
    s_cmp_lg_u32 s25, s4
    s_cbranch_scc1 SPOLL_17
SDONE_19:
    s_barrier
    s_add_u32 s18, s13, 8192
    buffer_load_dwordx4 v[144:147], v22, s[32:35], s13 offen sc1
    buffer_load_dwordx4 v[148:151], v22, s[32:35], s18 offen sc1
    buffer_load_dwordx4 v[160:163], v2, s[32:35], s16 offen sc1
    s_lshl_b32 s96, s3, 5
    s_add_u32 s14, s96, 8192
    v_and_b32 v6, 3, v1
    v_lshl_add_u32 v6, v6, 3, s14
    v_lshrrev_b32 v9, 5, v1
    v_lshl_add_u32 v6, v9, 2, v6
    s_lshl_b32 s14, s3, 10
    v_and_b32 v5, 15, v1
    v_lshl_add_u32 v5, v5, 4, s14
    v_lshrrev_b32 v9, 5, v1
    v_lshl_add_u32 v5, v9, 9, v5
    v_bfe_u32 v9, v1, 4, 1
    v_lshl_add_u32 v5, v9, 3, v5
    s_lshl_b32 s96, s76, 7
    s_add_u32 s14, s96, 8192
    v_lshrrev_b32 v7, 5, v1
    v_lshl_add_u32 v7, v7, 4, s14
    s_lshl_b32 s14, s76, 12
    v_add_u32 v20, s14, v2
    v_pk_mul_f32 v[116:117], v[116:117], v[52:53] op_sel:[0,1]
    v_pk_mul_f32 v[134:135], v[134:135], v[52:53] op_sel_hi:[1,0]
    v_pk_mul_f32 v[118:119], v[118:119], v[52:53] op_sel:[0,1]
    v_pk_mul_f32 v[136:137], v[136:137], v[52:53] op_sel_hi:[1,0]
    v_pk_mul_f32 v[120:121], v[120:121], v[52:53] op_sel:[0,1]
    v_pk_mul_f32 v[138:139], v[138:139], v[52:53] op_sel_hi:[1,0]
    v_pk_mul_f32 v[122:123], v[122:123], v[52:53] op_sel:[0,1]
    v_pk_mul_f32 v[140:141], v[140:141], v[52:53] op_sel_hi:[1,0]
    v_pk_mul_f32 v[124:125], v[124:125], v[52:53] op_sel:[0,1]
    v_pk_mul_f32 v[142:143], v[142:143], v[52:53] op_sel_hi:[1,0]
    v_pk_mul_f32 v[126:127], v[126:127], v[52:53] op_sel:[0,1]
    v_cvt_pk_bf16_f32 v80, v128, v129
    v_cvt_pk_bf16_f32 v88, v112, v113
    v_cvt_pk_bf16_f32 v81, v130, v131
    v_cvt_pk_bf16_f32 v89, v114, v115
    v_cvt_pk_bf16_f32 v82, v132, v133
    v_cvt_pk_bf16_f32 v90, v116, v117
    v_cvt_pk_bf16_f32 v83, v134, v135
    v_cvt_pk_bf16_f32 v91, v118, v119
    v_cvt_pk_bf16_f32 v84, v136, v137
    v_cvt_pk_bf16_f32 v92, v120, v121
    v_cvt_pk_bf16_f32 v85, v138, v139
    v_cvt_pk_bf16_f32 v93, v122, v123
    v_cvt_pk_bf16_f32 v86, v140, v141
    v_cvt_pk_bf16_f32 v94, v124, v125
    v_cvt_pk_bf16_f32 v87, v142, v143
    v_cvt_pk_bf16_f32 v95, v126, v127
    s_waitcnt vmcnt(1)
    v_cmp_eq_u32 vcc, s4, v67
    s_nop 0
    s_cmp_eq_u32 vcc_lo, 0
    s_cselect_b32 s93, 1, 0
    v_pk_add_f32 v[144:145], v[144:145], v[148:149]
    v_pk_add_f32 v[146:147], v[146:147], v[150:151]
    s_nop 1
    v_permlane32_swap_b32 v144, v146
    v_permlane32_swap_b32 v145, v147
    v_pk_add_f32 v[144:145], v[144:145], v[146:147]
    s_nop 1
    v_add_f32_dpp v144, v144, v144 row_ror:8 row_mask:0xf bank_mask:0xf
    v_add_f32_dpp v145, v145, v145 row_ror:8 row_mask:0xf bank_mask:0xf
    v_mov_b32 v146, v144
    v_mov_b32 v147, v145
    s_nop 0
    v_permlane16_swap_b32 v144, v146
    v_permlane16_swap_b32 v145, v147
    v_pk_add_f32 v[144:145], v[144:145], v[146:147]
    v_cvt_pk_bf16_f32 v144, v144, v145
    v_mov_b32 v145, s4
    s_mov_b32 exec_lo, 0xff
    s_mov_b32 exec_hi, 0xff
    s_cmp_lg_u32 s93, 0
    s_cbranch_scc1 LOC_20
    buffer_store_dwordx2 v[144:145], v76, s[32:35], s15 offen sc1
    s_branch LOCD_21
LOC_20:
    buffer_store_dwordx2 v[144:145], v76, s[32:35], s15 offen
LOCD_21:
    s_mov_b64 exec, -1
    v_mov_b32 v224, v144
    v_mov_b32 v225, v145
    v_add_u32 v226, s15, v76
    s_cbranch_scc1 L_PC2
    s_barrier
    s_cmp_lg_u32 s3, 0
    s_cbranch_scc1 L_PC2
    v_mov_b32 v21, s4
    s_mov_b32 exec_hi, 0
    s_mov_b32 exec_lo, 65535
    buffer_store_dword v21, v75, s[32:35], s17 offen sc1
    s_mov_b64 exec, -1
L_PC2:
    s_lshl3_add_u32 s96, s11, s3
    s_lshl_b32 s97, s96, 11
    s_add_u32 s13, s97, 29360128
    s_waitcnt vmcnt(0)
    v_permlane32_swap_b32 v160, v162
    v_permlane32_swap_b32 v161, v163
    v_pk_add_f32 v[160:161], v[160:161], v[162:163]
    s_nop 1
    v_add_f32_dpp v160, v160, v160 row_ror:4 row_mask:0xf bank_mask:0xf
    v_add_f32_dpp v161, v161, v161 row_ror:4 row_mask:0xf bank_mask:0xf
    s_nop 0
    v_add_f32_dpp v160, v160, v160 row_ror:8 row_mask:0xf bank_mask:0xf
    v_add_f32_dpp v161, v161, v161 row_ror:8 row_mask:0xf bank_mask:0xf
    v_mov_b32 v162, v160
    v_mov_b32 v163, v161
    s_nop 0
    v_permlane16_swap_b32 v160, v162
    v_permlane16_swap_b32 v161, v163
    v_pk_add_f32 v[160:161], v[160:161], v[162:163]
    v_cvt_pk_bf16_f32 v160, v160, v161
    ds_write_b32 v6, v160
    s_cmp_lg_u32 s93, 0
    s_cbranch_scc1 L_C2L
SPOLL_22:
    s_load_dwordx2 s[24:25], s[32:33], s92 offset:3584 glc
SCHK_23:
    s_add_u32 s5, s5, 1
    s_cmp_ge_u32 s5, 300000
    s_waitcnt lgkmcnt(0)
    s_cbranch_scc1 SDONE_24
    s_cmp_lg_u32 s24, s4
    s_cbranch_scc1 SPOLL_22
    s_cmp_lg_u32 s25, s4
    s_cbranch_scc1 SPOLL_22
SDONE_24:
L_C2L:
    buffer_load_dwordx4 v[152:155], v2, s[32:35], s13 offen sc1
    buffer_load_dwordx4 v[156:159], v2, s[32:35], s13 offen offset:1024 sc1
    s_waitcnt vmcnt(0)
    v_bitop3_b32 v4, v153, v155, s4 bitop3:0x7e
    v_bitop3_b32 v4, v4, v157, s4 bitop3:0xf6
    v_bitop3_b32 v4, v4, v159, s4 bitop3:0xf6
    v_cmp_ne_u32 vcc, 0, v4
    s_cbranch_vccz TOK_26
POLL_27:
    buffer_load_dwordx4 v[152:155], v2, s[32:35], s13 offen sc1
    buffer_load_dwordx4 v[156:159], v2, s[32:35], s13 offen offset:1024 sc1
    s_waitcnt vmcnt(0)
    v_bitop3_b32 v4, v153, v155, s4 bitop3:0x7e
    v_bitop3_b32 v4, v4, v157, s4 bitop3:0xf6
    v_bitop3_b32 v4, v4, v159, s4 bitop3:0xf6
    v_cmp_ne_u32 vcc, 0, v4
    s_cbranch_vccz PDONE_28
    s_add_u32 s5, s5, 1
    s_cmp_lt_u32 s5, 300000
    s_cbranch_scc1 POLL_27
PDONE_28:
TOK_26:
    ds_write2_b32 v5, v152, v154 offset0:0 offset1:1
    ds_write2_b32 v5, v156, v158 offset0:64 offset1:65
    s_waitcnt lgkmcnt(0)
    s_barrier
    ds_read_b128 v[160:163], v7
    ds_read_b128 v[164:167], v7 offset:32
    ds_read_b128 v[168:171], v7 offset:64
    ds_read_b128 v[172:175], v7 offset:96
    ds_read_b128 v[144:147], v20
    ds_read_b128 v[148:151], v20 offset:1024
    ds_read_b128 v[152:155], v20 offset:2048
    ds_read_b128 v[156:159], v20 offset:3072
    s_add_u32 s96, s84, 1048576
    s_and_b32 s97, s96, 1048575
    s_lshl_b32 s98, s83, 16
    s_xor_b32 s99, s97, s98
    s_xor_b32 s96, s88, 1048576
    s_add_u32 s19, s99, s96
    s_add_u32 m0, s89, 98304
    s_nop 0
    buffer_load_dwordx4 v74, s[44:47], s19 offen lds
    s_add_u32 s96, s84, 1703936
    s_and_b32 s97, s96, 1048575
    s_lshl_b32 s98, s83, 16
    s_xor_b32 s99, s97, s98
    s_xor_b32 s96, s88, 1048576
    s_add_u32 s19, s99, s96
    s_add_u32 m0, s89, 139264
    s_nop 0
    buffer_load_dwordx4 v74, s[44:47], s19 offen lds
    s_add_u32 s96, s84, 1835008
    s_and_b32 s97, s96, 1048575
    s_lshl_b32 s98, s83, 16
    s_xor_b32 s99, s97, s98
    s_xor_b32 s96, s88, 1048576
    s_add_u32 s19, s99, s96
    s_add_u32 m0, s89, 147456
    s_nop 0
    buffer_load_dwordx4 v74, s[44:47], s19 offen lds
    s_and_b32 s96, s3, 3
    s_lshl2_add_u32 s97, s10, s96
    s_lshl4_add_u32 s98, s97, s11
    s_lshl1_add_u32 s99, s98, s76
    s_lshl_b32 s96, s99, 11
    s_add_u32 s13, s96, 8388608
    v_and_b32 v8, 15, v1
    v_lshlrev_b32 v8, 4, v8
    v_bfe_u32 v9, v1, 4, 1
    v_lshl_add_u32 v8, v9, 10, v8
    v_lshrrev_b32 v9, 5, v1
    v_lshl_add_u32 v8, v9, 8, v8
    s_waitcnt lgkmcnt(7)
    v_mfma_f32_32x32x16_bf16 v[128:143], v[160:163], v[80:83], 0
    s_waitcnt lgkmcnt(6)
    v_mfma_f32_32x32x16_bf16 v[128:143], v[164:167], v[84:87], v[128:143]
    s_waitcnt lgkmcnt(5)
    v_mfma_f32_32x32x16_bf16 v[128:143], v[168:171], v[88:91], v[128:143]
    s_waitcnt lgkmcnt(4)
    v_mfma_f32_32x32x16_bf16 v[128:143], v[172:175], v[92:95], v[128:143]
    s_waitcnt lgkmcnt(3)
    v_mfma_f32_32x32x16_bf16 v[112:127], v[144:147], v[80:83], 0
    s_waitcnt lgkmcnt(2)
    v_mfma_f32_32x32x16_bf16 v[112:127], v[148:151], v[84:87], v[112:127]
    s_waitcnt lgkmcnt(1)
    v_mfma_f32_32x32x16_bf16 v[112:127], v[152:155], v[88:91], v[112:127]
    s_waitcnt lgkmcnt(0)
    v_mfma_f32_32x32x16_bf16 v[112:127], v[156:159], v[92:95], v[112:127]
    s_nop 3
    v_cvt_pk_bf16_f32 v128, 0, v128
    v_add_f32 v128, 0x358637bd, v128
    v_cvt_pk_bf16_f32 v128, 0, v128
    v_rcp_f32 v128, v128
    s_nop 3
    v_cvt_pk_bf16_f32 v112, 0, v112
    v_cvt_pk_bf16_f32 v113, 0, v113
    v_cvt_pk_bf16_f32 v114, 0, v114
    v_cvt_pk_bf16_f32 v115, 0, v115
    v_cvt_pk_bf16_f32 v116, 0, v116
    v_cvt_pk_bf16_f32 v117, 0, v117
    v_cvt_pk_bf16_f32 v118, 0, v118
    v_cvt_pk_bf16_f32 v119, 0, v119
    v_pk_mul_f32 v[112:113], v[112:113], v[128:129] op_sel_hi:[1,0]
    v_pk_mul_f32 v[114:115], v[114:115], v[128:129] op_sel_hi:[1,0]
    v_pk_mul_f32 v[116:117], v[116:117], v[128:129] op_sel_hi:[1,0]
    v_pk_mul_f32 v[118:119], v[118:119], v[128:129] op_sel_hi:[1,0]
    v_cvt_pk_bf16_f32 v44, v112, v113
    v_cvt_pk_bf16_f32 v45, v114, v115
    v_cvt_pk_bf16_f32 v46, v116, v117
    v_cvt_pk_bf16_f32 v47, v118, v119
    buffer_store_dwordx4 v[44:47], v8, s[32:35], s13 offen sc1
    v_cvt_pk_bf16_f32 v120, 0, v120
    v_cvt_pk_bf16_f32 v121, 0, v121
    v_cvt_pk_bf16_f32 v122, 0, v122
    v_cvt_pk_bf16_f32 v123, 0, v123
    v_cvt_pk_bf16_f32 v124, 0, v124
    v_cvt_pk_bf16_f32 v125, 0, v125
    v_cvt_pk_bf16_f32 v126, 0, v126
    v_cvt_pk_bf16_f32 v127, 0, v127
    v_pk_mul_f32 v[120:121], v[120:121], v[128:129] op_sel_hi:[1,0]
    v_pk_mul_f32 v[122:123], v[122:123], v[128:129] op_sel_hi:[1,0]
    v_pk_mul_f32 v[124:125], v[124:125], v[128:129] op_sel_hi:[1,0]
    v_pk_mul_f32 v[126:127], v[126:127], v[128:129] op_sel_hi:[1,0]
    v_cvt_pk_bf16_f32 v48, v120, v121
    v_cvt_pk_bf16_f32 v49, v122, v123
    v_cvt_pk_bf16_f32 v50, v124, v125
    v_cvt_pk_bf16_f32 v51, v126, v127
    buffer_store_dwordx4 v[48:51], v8, s[32:35], s13 offen offset:512 sc1
    s_mul_i32 s96, s76, 65600
    s_add_u32 s17, s96, 32768
    v_lshrrev_b32 v20, 5, v1
    v_lshlrev_b32 v20, 11, v20
    v_bfe_u32 v9, v1, 4, 1
    v_lshl_add_u32 v20, v9, 9, v20
    v_bfe_u32 v9, v1, 2, 2
    v_lshl_add_u32 v20, v9, 7, v20
    v_bfe_u32 v9, v1, 3, 1
    v_lshl_add_u32 v20, v9, 6, v20
    v_bfe_u32 v9, v1, 1, 1
    v_lshl_add_u32 v20, v9, 5, v20
    v_bfe_u32 v9, v1, 4, 1
    v_lshl_add_u32 v20, v9, 4, v20
    v_and_b32 v9, 1, v1
    v_lshl_add_u32 v20, v9, 3, v20
    v_xor_b32 v20, s17, v20
    v_xor_b32 v21, 16, v20
    v_xor_b32 v22, 64, v20
    v_xor_b32 v23, 80, v20
    v_and_b32 v5, 7, v1
    v_lshlrev_b32 v5, 15, v5
    v_bfe_u32 v9, v1, 3, 1
    v_lshl_add_u32 v5, v9, 12, v5
    s_bfe_u32 s96, s11, 65538
    s_lshr_b32 s97, s10, 2
    s_and_b32 s98, s10, 3
    s_lshl_b32 s99, s98, 6
    s_lshl1_add_u32 s98, s97, s99
    s_lshl_b32 s97, s98, 12
    s_lshr_b32 s99, s11, 3
    s_and_b32 s98, s11, 3
    s_lshl2_add_u32 s99, s99, s98
    s_lshl_b32 s98, s99, 6
    s_add_u32 s99, s97, s98
    s_lshl2_add_u32 s97, s96, s99
    s_add_u32 s98, s97, 1048576
    s_add_u32 s15, s98, 1024
    v_mov_b32 v52, 0x10000
    v_mov_b32 v53, s6
    v_lshlrev_b32 v28, 16, v12
    v_and_b32 v29, s6, v12
    v_lshlrev_b32 v30, 16, v13
    v_and_b32 v31, s6, v13
    v_lshlrev_b32 v32, 16, v14
    v_and_b32 v33, s6, v14
    v_lshlrev_b32 v34, 16, v15
    v_and_b32 v35, s6, v15
    v_lshlrev_b32 v36, 16, v16
    v_and_b32 v37, s6, v16
    v_lshlrev_b32 v38, 16, v17
    v_and_b32 v39, s6, v17
    v_lshlrev_b32 v40, 16, v18
    v_and_b32 v41, s6, v18
    v_lshlrev_b32 v42, 16, v19
    v_and_b32 v43, s6, v19
    v_mul_u32_u24_dpp v76, v64, v52 row_newbcast:0 row_mask:0xf bank_mask:0xf
    v_and_b32_dpp v77, v64, v53 row_newbcast:0 row_mask:0xf bank_mask:0xf
    v_mul_u32_u24_dpp v78, v64, v52 row_newbcast:1 row_mask:0xf bank_mask:0xf
    v_and_b32_dpp v79, v64, v53 row_newbcast:1 row_mask:0xf bank_mask:0xf
    v_mul_u32_u24_dpp v80, v64, v52 row_newbcast:2 row_mask:0xf bank_mask:0xf
    v_and_b32_dpp v81, v64, v53 row_newbcast:2 row_mask:0xf bank_mask:0xf
    v_mul_u32_u24_dpp v82, v64, v52 row_newbcast:3 row_mask:0xf bank_mask:0xf
    v_and_b32_dpp v83, v64, v53 row_newbcast:3 row_mask:0xf bank_mask:0xf
    v_mul_u32_u24_dpp v84, v64, v52 row_newbcast:4 row_mask:0xf bank_mask:0xf
    v_and_b32_dpp v85, v64, v53 row_newbcast:4 row_mask:0xf bank_mask:0xf
    v_mul_u32_u24_dpp v86, v64, v52 row_newbcast:5 row_mask:0xf bank_mask:0xf
    v_and_b32_dpp v87, v64, v53 row_newbcast:5 row_mask:0xf bank_mask:0xf
    v_mul_u32_u24_dpp v88, v64, v52 row_newbcast:6 row_mask:0xf bank_mask:0xf
    v_and_b32_dpp v89, v64, v53 row_newbcast:6 row_mask:0xf bank_mask:0xf
    v_mul_u32_u24_dpp v90, v64, v52 row_newbcast:7 row_mask:0xf bank_mask:0xf
    v_and_b32_dpp v91, v64, v53 row_newbcast:7 row_mask:0xf bank_mask:0xf
    s_lshl1_add_u32 s96, s94, s77
    s_lshl_b32 s97, s96, 15
    s_add_u32 s19, s97, 8388608
    v_and_b32 v25, 15, v1
    v_lshlrev_b32 v25, 3, v25
    s_waitcnt vmcnt(0)
    s_waitcnt lgkmcnt(0)
    s_barrier
    s_cmp_lg_u32 s3, 0
    s_cbranch_scc1 L_PD
    v_mov_b32 v6, s4
    s_mov_b32 exec_hi, 0
    s_mov_b32 exec_lo, 65535
    buffer_store_dword v6, v5, s[32:35], s15 offen sc1
    s_mov_b64 exec, -1
L_PD:
    s_add_u32 s96, s84, 1966080
    s_and_b32 s97, s96, 1048575
    s_lshl_b32 s98, s83, 16
    s_xor_b32 s99, s97, s98
    s_xor_b32 s96, s88, 1048576
    s_add_u32 s13, s99, s96
    s_add_u32 m0, s89, 155648
    s_nop 0
    buffer_load_dwordx4 v74, s[44:47], s13 offen lds
    s_and_b32 s96, s84, 1048575
    s_lshl_b32 s97, s83, 16
    s_xor_b32 s98, s96, s97
    s_add_u32 s13, s98, s88
    s_add_u32 m0, s89, 32768
    s_nop 0
    buffer_load_dwordx4 v74, s[44:47], s13 offen lds
    s_add_u32 s96, s84, 131072
    s_and_b32 s97, s96, 1048575
    s_lshl_b32 s98, s83, 16
    s_xor_b32 s99, s97, s98
    s_add_u32 s13, s99, s88
    s_add_u32 m0, s89, 40960
    s_nop 0
    buffer_load_dwordx4 v74, s[44:47], s13 offen lds
    s_load_dwordx2 s[24:25], s[32:33], s92 offset:1024 glc
    v_mov_b32_dpp v92, v65 row_newbcast:0 row_mask:0xf bank_mask:0xf
    v_mov_b32_dpp v93, v65 row_newbcast:1 row_mask:0xf bank_mask:0xf
    v_mov_b32_dpp v94, v65 row_newbcast:2 row_mask:0xf bank_mask:0xf
    v_mov_b32_dpp v95, v65 row_newbcast:3 row_mask:0xf bank_mask:0xf
    v_mov_b32_dpp v96, v65 row_newbcast:4 row_mask:0xf bank_mask:0xf
    v_mov_b32_dpp v97, v65 row_newbcast:5 row_mask:0xf bank_mask:0xf
    v_mov_b32_dpp v98, v65 row_newbcast:6 row_mask:0xf bank_mask:0xf
    v_mov_b32_dpp v99, v65 row_newbcast:7 row_mask:0xf bank_mask:0xf
    v_mov_b32_dpp v100, v66 row_newbcast:0 row_mask:0xf bank_mask:0xf
    v_mov_b32_dpp v101, v66 row_newbcast:1 row_mask:0xf bank_mask:0xf
    v_mov_b32_dpp v102, v66 row_newbcast:2 row_mask:0xf bank_mask:0xf
    v_mov_b32_dpp v103, v66 row_newbcast:3 row_mask:0xf bank_mask:0xf
    v_mov_b32_dpp v104, v66 row_newbcast:4 row_mask:0xf bank_mask:0xf
    v_mov_b32_dpp v105, v66 row_newbcast:5 row_mask:0xf bank_mask:0xf
    v_mov_b32_dpp v106, v66 row_newbcast:6 row_mask:0xf bank_mask:0xf
    v_mov_b32_dpp v107, v66 row_newbcast:7 row_mask:0xf bank_mask:0xf
    v_and_b32 v4, 3, v1
    v_cmp_eq_u32 vcc, 1, v4
    v_cmp_eq_u32 s[22:23], 0, v4
    v_mov_b32 v5, 0x3f803f80
    v_cndmask_b32 v92, v100, v92, vcc
    v_cndmask_b32 v93, v101, v93, vcc
    v_cndmask_b32 v94, v102, v94, vcc
    v_cndmask_b32 v95, v103, v95, vcc
    v_cndmask_b32 v96, v104, v96, vcc
    v_cndmask_b32 v97, v105, v97, vcc
    v_cndmask_b32 v98, v106, v98, vcc
    v_cndmask_b32 v99, v107, v99, vcc
    v_cndmask_b32 v92, v92, v5, s[22:23]
    v_cndmask_b32 v93, v93, v5, s[22:23]
    v_cndmask_b32 v94, v94, v5, s[22:23]
    v_cndmask_b32 v95, v95, v5, s[22:23]
    v_cndmask_b32 v96, v96, v5, s[22:23]
    v_cndmask_b32 v97, v97, v5, s[22:23]
    v_cndmask_b32 v98, v98, v5, s[22:23]
    v_cndmask_b32 v99, v99, v5, s[22:23]
    s_waitcnt vmcnt(0)
    s_branch SCHK_30
SPOLL_29:
    s_load_dwordx2 s[24:25], s[32:33], s92 offset:1024 glc
SCHK_30:
    s_add_u32 s5, s5, 1
    s_cmp_ge_u32 s5, 300000
    s_waitcnt lgkmcnt(0)
    s_cbranch_scc1 SDONE_31
    s_cmp_lg_u32 s24, s4
    s_cbranch_scc1 SPOLL_29
SDONE_31:
    s_barrier
    s_cmp_lt_u32 s3, 4
    s_cbranch_scc1 L_P2
    s_setprio 1
L_P2:
    s_lshl_b32 s96, s21, 7
    s_add_u32 s18, s96, 65536
    s_lshl_b32 s96, s83, 11
    s_add_u32 s20, s96, s19
    buffer_load_dwordx4 v[140:143], v2, s[32:35], s20 offen sc1
    buffer_load_dwordx4 v[144:147], v2, s[32:35], s20 offen offset:1024 sc1
    ds_read_b64_tr_b16 v[228:229], v22
    ds_read_b64_tr_b16 v[230:231], v22 offset:1024
    ds_read_b64_tr_b16 v[232:233], v23
    ds_read_b64_tr_b16 v[234:235], v23 offset:1024
    ds_read_b64_tr_b16 v[236:237], v20
    ds_read_b64_tr_b16 v[238:239], v20 offset:1024
    ds_read_b64_tr_b16 v[240:241], v21
    ds_read_b64_tr_b16 v[242:243], v21 offset:1024
    s_xor_b32 s96, s83, 1
    s_lshl_b32 s97, s96, 11
    s_add_u32 s20, s97, s19
    buffer_load_dwordx4 v[148:151], v2, s[32:35], s20 offen sc1
    buffer_load_dwordx4 v[152:155], v2, s[32:35], s20 offen offset:1024 sc1
    s_xor_b32 s96, s83, 2
    s_lshl_b32 s97, s96, 11
    s_add_u32 s20, s97, s19
    buffer_load_dwordx4 v[156:159], v2, s[32:35], s20 offen sc1
    buffer_load_dwordx4 v[160:163], v2, s[32:35], s20 offen offset:1024 sc1
    s_waitcnt lgkmcnt(6)
    s_waitcnt vmcnt(5)
    v_mfma_f32_16x16x32_bf16 v[124:127], v[228:231], v[140:143], 0
    ds_read_b64_tr_b16 v[244:245], v22 offset:4096
    s_waitcnt vmcnt(4)
    v_mfma_f32_16x16x32_bf16 v[128:131], v[228:231], v[144:147], 0
    ds_read_b64_tr_b16 v[246:247], v22 offset:5120
    s_xor_b32 s96, s83, 3
    s_lshl_b32 s97, s96, 11
    s_add_u32 s20, s97, s19
    buffer_load_dwordx4 v[164:167], v2, s[32:35], s20 offen sc1
    s_waitcnt lgkmcnt(6)
    v_mfma_f32_16x16x32_bf16 v[132:135], v[232:235], v[140:143], 0
    ds_read_b64_tr_b16 v[228:229], v23 offset:4096
    v_mfma_f32_16x16x32_bf16 v[136:139], v[232:235], v[144:147], 0
    ds_read_b64_tr_b16 v[230:231], v23 offset:5120
    buffer_load_dwordx4 v[168:171], v2, s[32:35], s20 offen offset:1024 sc1
    s_waitcnt lgkmcnt(6)
    v_mfma_f32_16x16x32_bf16 v[108:111], v[236:239], v[140:143], 0
    ds_read_b64_tr_b16 v[232:233], v20 offset:4096
    v_mfma_f32_16x16x32_bf16 v[112:115], v[236:239], v[144:147], 0
    ds_read_b64_tr_b16 v[234:235], v20 offset:5120
    s_waitcnt lgkmcnt(6)
    v_mfma_f32_16x16x32_bf16 v[116:119], v[240:243], v[140:143], 0
    ds_read_b64_tr_b16 v[236:237], v21 offset:4096
    v_mfma_f32_16x16x32_bf16 v[120:123], v[240:243], v[144:147], 0
    ds_read_b64_tr_b16 v[238:239], v21 offset:5120
    s_waitcnt lgkmcnt(6)
    s_waitcnt vmcnt(4)
    v_mfma_f32_16x16x32_bf16 v[124:127], v[244:247], v[148:151], v[124:127]
    ds_read_b64_tr_b16 v[240:241], v22 offset:8192
    v_mfma_f32_16x16x32_bf16 v[128:131], v[244:247], v[152:155], v[128:131]
    ds_read_b64_tr_b16 v[242:243], v22 offset:9216
    s_xor_b32 s96, s83, 4
    s_lshl_b32 s97, s96, 11
    s_add_u32 s20, s97, s19
    buffer_load_dwordx4 v[140:143], v2, s[32:35], s20 offen sc1
    s_waitcnt lgkmcnt(6)
    v_mfma_f32_16x16x32_bf16 v[132:135], v[228:231], v[148:151], v[132:135]
    ds_read_b64_tr_b16 v[244:245], v23 offset:8192
    v_mfma_f32_16x16x32_bf16 v[136:139], v[228:231], v[152:155], v[136:139]
    ds_read_b64_tr_b16 v[246:247], v23 offset:9216
    buffer_load_dwordx4 v[144:147], v2, s[32:35], s20 offen offset:1024 sc1
    s_waitcnt lgkmcnt(6)
    v_mfma_f32_16x16x32_bf16 v[108:111], v[232:235], v[148:151], v[108:111]
    ds_read_b64_tr_b16 v[228:229], v20 offset:8192
    v_mfma_f32_16x16x32_bf16 v[112:115], v[232:235], v[152:155], v[112:115]
    ds_read_b64_tr_b16 v[230:231], v20 offset:9216
    s_waitcnt lgkmcnt(6)
    v_mfma_f32_16x16x32_bf16 v[116:119], v[236:239], v[148:151], v[116:119]
    ds_read_b64_tr_b16 v[232:233], v21 offset:8192
    v_mfma_f32_16x16x32_bf16 v[120:123], v[236:239], v[152:155], v[120:123]
    ds_read_b64_tr_b16 v[234:235], v21 offset:9216
    s_waitcnt lgkmcnt(6)
    s_waitcnt vmcnt(4)
    v_mfma_f32_16x16x32_bf16 v[124:127], v[240:243], v[156:159], v[124:127]
    ds_read_b64_tr_b16 v[236:237], v22 offset:12288
    v_mfma_f32_16x16x32_bf16 v[128:131], v[240:243], v[160:163], v[128:131]
    ds_read_b64_tr_b16 v[238:239], v22 offset:13312
    s_xor_b32 s96, s83, 5
    s_lshl_b32 s97, s96, 11
    s_add_u32 s20, s97, s19
    buffer_load_dwordx4 v[148:151], v2, s[32:35], s20 offen sc1
    s_waitcnt lgkmcnt(6)
    v_mfma_f32_16x16x32_bf16 v[132:135], v[244:247], v[156:159], v[132:135]
    ds_read_b64_tr_b16 v[240:241], v23 offset:12288
    v_mfma_f32_16x16x32_bf16 v[136:139], v[244:247], v[160:163], v[136:139]
    ds_read_b64_tr_b16 v[242:243], v23 offset:13312
    buffer_load_dwordx4 v[152:155], v2, s[32:35], s20 offen offset:1024 sc1
    s_waitcnt lgkmcnt(6)
    v_mfma_f32_16x16x32_bf16 v[108:111], v[228:231], v[156:159], v[108:111]
    ds_read_b64_tr_b16 v[244:245], v20 offset:12288
    v_mfma_f32_16x16x32_bf16 v[112:115], v[228:231], v[160:163], v[112:115]
    ds_read_b64_tr_b16 v[246:247], v20 offset:13312
    s_waitcnt lgkmcnt(6)
    v_mfma_f32_16x16x32_bf16 v[116:119], v[232:235], v[156:159], v[116:119]
    ds_read_b64_tr_b16 v[228:229], v21 offset:12288
    v_mfma_f32_16x16x32_bf16 v[120:123], v[232:235], v[160:163], v[120:123]
    ds_read_b64_tr_b16 v[230:231], v21 offset:13312
    s_waitcnt lgkmcnt(6)
    s_waitcnt vmcnt(4)
    v_mfma_f32_16x16x32_bf16 v[124:127], v[236:239], v[164:167], v[124:127]
    ds_read_b64_tr_b16 v[232:233], v22 offset:16384
    v_mfma_f32_16x16x32_bf16 v[128:131], v[236:239], v[168:171], v[128:131]
    ds_read_b64_tr_b16 v[234:235], v22 offset:17408
    s_xor_b32 s96, s83, 6
    s_lshl_b32 s97, s96, 11
    s_add_u32 s20, s97, s19
    buffer_load_dwordx4 v[156:159], v2, s[32:35], s20 offen sc1
    s_waitcnt lgkmcnt(6)
    v_mfma_f32_16x16x32_bf16 v[132:135], v[240:243], v[164:167], v[132:135]
    ds_read_b64_tr_b16 v[236:237], v23 offset:16384
    v_mfma_f32_16x16x32_bf16 v[136:139], v[240:243], v[168:171], v[136:139]
    ds_read_b64_tr_b16 v[238:239], v23 offset:17408
    buffer_load_dwordx4 v[160:163], v2, s[32:35], s20 offen offset:1024 sc1
    s_waitcnt lgkmcnt(6)
    v_mfma_f32_16x16x32_bf16 v[108:111], v[244:247], v[164:167], v[108:111]
    ds_read_b64_tr_b16 v[240:241], v20 offset:16384
    v_mfma_f32_16x16x32_bf16 v[112:115], v[244:247], v[168:171], v[112:115]
    ds_read_b64_tr_b16 v[242:243], v20 offset:17408
    s_waitcnt lgkmcnt(6)
    v_mfma_f32_16x16x32_bf16 v[116:119], v[228:231], v[164:167], v[116:119]
    ds_read_b64_tr_b16 v[244:245], v21 offset:16384
    v_mfma_f32_16x16x32_bf16 v[120:123], v[228:231], v[168:171], v[120:123]
    ds_read_b64_tr_b16 v[246:247], v21 offset:17408
    s_waitcnt lgkmcnt(6)
    s_waitcnt vmcnt(4)
    v_mfma_f32_16x16x32_bf16 v[124:127], v[232:235], v[140:143], v[124:127]
    ds_read_b64_tr_b16 v[228:229], v22 offset:20480
    v_mfma_f32_16x16x32_bf16 v[128:131], v[232:235], v[144:147], v[128:131]
    ds_read_b64_tr_b16 v[230:231], v22 offset:21504
    s_xor_b32 s96, s83, 7
    s_lshl_b32 s97, s96, 11
    s_add_u32 s20, s97, s19
    buffer_load_dwordx4 v[164:167], v2, s[32:35], s20 offen sc1
    s_waitcnt lgkmcnt(6)
    v_mfma_f32_16x16x32_bf16 v[132:135], v[236:239], v[140:143], v[132:135]
    ds_read_b64_tr_b16 v[232:233], v23 offset:20480
    v_mfma_f32_16x16x32_bf16 v[136:139], v[236:239], v[144:147], v[136:139]
    ds_read_b64_tr_b16 v[234:235], v23 offset:21504
    buffer_load_dwordx4 v[168:171], v2, s[32:35], s20 offen offset:1024 sc1
    s_waitcnt lgkmcnt(6)
    v_mfma_f32_16x16x32_bf16 v[108:111], v[240:243], v[140:143], v[108:111]
    ds_read_b64_tr_b16 v[236:237], v20 offset:20480
    v_mfma_f32_16x16x32_bf16 v[112:115], v[240:243], v[144:147], v[112:115]
    ds_read_b64_tr_b16 v[238:239], v20 offset:21504
    s_setprio 0
    s_waitcnt lgkmcnt(6)
    v_mfma_f32_16x16x32_bf16 v[116:119], v[244:247], v[140:143], v[116:119]
    ds_read_b64_tr_b16 v[240:241], v21 offset:20480
    v_mfma_f32_16x16x32_bf16 v[120:123], v[244:247], v[144:147], v[120:123]
    ds_read_b64_tr_b16 v[242:243], v21 offset:21504
    s_waitcnt lgkmcnt(6)
    s_waitcnt vmcnt(4)
    v_mfma_f32_16x16x32_bf16 v[124:127], v[228:231], v[148:151], v[124:127]
    ds_read_b64_tr_b16 v[244:245], v22 offset:24576
    v_mfma_f32_16x16x32_bf16 v[128:131], v[228:231], v[152:155], v[128:131]
    ds_read_b64_tr_b16 v[246:247], v22 offset:25600
    s_cmp_eq_u32 s25, s4
    s_cbranch_scc1 L_D2
SPOLL_32:
    s_load_dwordx2 s[24:25], s[32:33], s92 offset:1024 glc
SCHK_33:
    s_add_u32 s5, s5, 1
    s_cmp_ge_u32 s5, 300000
    s_waitcnt lgkmcnt(0)
    s_cbranch_scc1 SDONE_34
    s_cmp_lg_u32 s25, s4
    s_cbranch_scc1 SPOLL_32
SDONE_34:
L_D2:
    s_barrier
    s_xor_b32 s96, s83, 8
    s_lshl_b32 s97, s96, 11
    s_add_u32 s20, s97, s19
    buffer_load_dwordx4 v[140:143], v2, s[32:35], s20 offen sc1
    s_waitcnt lgkmcnt(6)
    v_mfma_f32_16x16x32_bf16 v[132:135], v[232:235], v[148:151], v[132:135]
    ds_read_b64_tr_b16 v[228:229], v23 offset:24576
    v_mfma_f32_16x16x32_bf16 v[136:139], v[232:235], v[152:155], v[136:139]
    ds_read_b64_tr_b16 v[230:231], v23 offset:25600
    buffer_load_dwordx4 v[144:147], v2, s[32:35], s20 offen offset:1024 sc1
    s_waitcnt lgkmcnt(6)
    v_mfma_f32_16x16x32_bf16 v[108:111], v[236:239], v[148:151], v[108:111]
    ds_read_b64_tr_b16 v[232:233], v20 offset:24576
    v_mfma_f32_16x16x32_bf16 v[112:115], v[236:239], v[152:155], v[112:115]
    ds_read_b64_tr_b16 v[234:235], v20 offset:25600
    s_waitcnt lgkmcnt(6)
    v_mfma_f32_16x16x32_bf16 v[116:119], v[240:243], v[148:151], v[116:119]
    ds_read_b64_tr_b16 v[236:237], v21 offset:24576
    v_mfma_f32_16x16x32_bf16 v[120:123], v[240:243], v[152:155], v[120:123]
    ds_read_b64_tr_b16 v[238:239], v21 offset:25600
    s_waitcnt lgkmcnt(6)
    s_waitcnt vmcnt(4)
    v_mfma_f32_16x16x32_bf16 v[124:127], v[244:247], v[156:159], v[124:127]
    ds_read_b64_tr_b16 v[240:241], v22 offset:28672
    v_mfma_f32_16x16x32_bf16 v[128:131], v[244:247], v[160:163], v[128:131]
    ds_read_b64_tr_b16 v[242:243], v22 offset:29696
    s_xor_b32 s96, s83, 9
    s_lshl_b32 s97, s96, 11
    s_add_u32 s20, s97, s19
    buffer_load_dwordx4 v[148:151], v2, s[32:35], s20 offen sc1
    s_waitcnt lgkmcnt(6)
    v_mfma_f32_16x16x32_bf16 v[132:135], v[228:231], v[156:159], v[132:135]
    ds_read_b64_tr_b16 v[244:245], v23 offset:28672
    v_mfma_f32_16x16x32_bf16 v[136:139], v[228:231], v[160:163], v[136:139]
    ds_read_b64_tr_b16 v[246:247], v23 offset:29696
    buffer_load_dwordx4 v[152:155], v2, s[32:35], s20 offen offset:1024 sc1
    s_waitcnt lgkmcnt(6)
    v_mfma_f32_16x16x32_bf16 v[108:111], v[232:235], v[156:159], v[108:111]
    ds_read_b64_tr_b16 v[228:229], v20 offset:28672
    v_mfma_f32_16x16x32_bf16 v[112:115], v[232:235], v[160:163], v[112:115]
    ds_read_b64_tr_b16 v[230:231], v20 offset:29696
    s_waitcnt lgkmcnt(6)
    v_mfma_f32_16x16x32_bf16 v[116:119], v[236:239], v[156:159], v[116:119]
    ds_read_b64_tr_b16 v[232:233], v21 offset:28672
    v_mfma_f32_16x16x32_bf16 v[120:123], v[236:239], v[160:163], v[120:123]
    ds_read_b64_tr_b16 v[234:235], v21 offset:29696
    s_waitcnt lgkmcnt(6)
    s_waitcnt vmcnt(4)
    v_mfma_f32_16x16x32_bf16 v[124:127], v[240:243], v[164:167], v[124:127]
    ds_read_b64_tr_b16 v[236:237], v22 offset:32768
    v_mfma_f32_16x16x32_bf16 v[128:131], v[240:243], v[168:171], v[128:131]
    ds_read_b64_tr_b16 v[238:239], v22 offset:33792
    s_xor_b32 s96, s83, 10
    s_lshl_b32 s97, s96, 11
    s_add_u32 s20, s97, s19
    buffer_load_dwordx4 v[156:159], v2, s[32:35], s20 offen sc1
    s_waitcnt lgkmcnt(6)
    v_mfma_f32_16x16x32_bf16 v[132:135], v[244:247], v[164:167], v[132:135]
    ds_read_b64_tr_b16 v[240:241], v23 offset:32768
    v_mfma_f32_16x16x32_bf16 v[136:139], v[244:247], v[168:171], v[136:139]
    ds_read_b64_tr_b16 v[242:243], v23 offset:33792
    buffer_load_dwordx4 v[160:163], v2, s[32:35], s20 offen offset:1024 sc1
    s_waitcnt lgkmcnt(6)
    v_mfma_f32_16x16x32_bf16 v[108:111], v[228:231], v[164:167], v[108:111]
    ds_read_b64_tr_b16 v[244:245], v20 offset:32768
    v_mfma_f32_16x16x32_bf16 v[112:115], v[228:231], v[168:171], v[112:115]
    ds_read_b64_tr_b16 v[246:247], v20 offset:33792
    s_waitcnt lgkmcnt(6)
    v_mfma_f32_16x16x32_bf16 v[116:119], v[232:235], v[164:167], v[116:119]
    ds_read_b64_tr_b16 v[228:229], v21 offset:32768
    v_mfma_f32_16x16x32_bf16 v[120:123], v[232:235], v[168:171], v[120:123]
    ds_read_b64_tr_b16 v[230:231], v21 offset:33792
    s_waitcnt lgkmcnt(6)
    s_waitcnt vmcnt(4)
    v_mfma_f32_16x16x32_bf16 v[124:127], v[236:239], v[140:143], v[124:127]
    ds_read_b64_tr_b16 v[232:233], v22 offset:36864
    v_mfma_f32_16x16x32_bf16 v[128:131], v[236:239], v[144:147], v[128:131]
    ds_read_b64_tr_b16 v[234:235], v22 offset:37888
    s_xor_b32 s96, s83, 11
    s_lshl_b32 s97, s96, 11
    s_add_u32 s20, s97, s19
    buffer_load_dwordx4 v[164:167], v2, s[32:35], s20 offen sc1
    s_waitcnt lgkmcnt(6)
    v_mfma_f32_16x16x32_bf16 v[132:135], v[240:243], v[140:143], v[132:135]
    ds_read_b64_tr_b16 v[236:237], v23 offset:36864
    v_mfma_f32_16x16x32_bf16 v[136:139], v[240:243], v[144:147], v[136:139]
    ds_read_b64_tr_b16 v[238:239], v23 offset:37888
    buffer_load_dwordx4 v[168:171], v2, s[32:35], s20 offen offset:1024 sc1
    s_waitcnt lgkmcnt(6)
    v_mfma_f32_16x16x32_bf16 v[108:111], v[244:247], v[140:143], v[108:111]
    ds_read_b64_tr_b16 v[240:241], v20 offset:36864
    v_mfma_f32_16x16x32_bf16 v[112:115], v[244:247], v[144:147], v[112:115]
    ds_read_b64_tr_b16 v[242:243], v20 offset:37888
    s_waitcnt lgkmcnt(6)
    v_mfma_f32_16x16x32_bf16 v[116:119], v[228:231], v[140:143], v[116:119]
    ds_read_b64_tr_b16 v[244:245], v21 offset:36864
    v_mfma_f32_16x16x32_bf16 v[120:123], v[228:231], v[144:147], v[120:123]
    ds_read_b64_tr_b16 v[246:247], v21 offset:37888
    s_waitcnt lgkmcnt(6)
    s_waitcnt vmcnt(4)
    v_mfma_f32_16x16x32_bf16 v[124:127], v[232:235], v[148:151], v[124:127]
    ds_read_b64_tr_b16 v[228:229], v22 offset:40960
    v_mfma_f32_16x16x32_bf16 v[128:131], v[232:235], v[152:155], v[128:131]
    ds_read_b64_tr_b16 v[230:231], v22 offset:41984
    s_xor_b32 s96, s83, 12
    s_lshl_b32 s97, s96, 11
    s_add_u32 s20, s97, s19
    buffer_load_dwordx4 v[140:143], v2, s[32:35], s20 offen sc1
    s_waitcnt lgkmcnt(6)
    v_mfma_f32_16x16x32_bf16 v[132:135], v[236:239], v[148:151], v[132:135]
    ds_read_b64_tr_b16 v[232:233], v23 offset:40960
    v_mfma_f32_16x16x32_bf16 v[136:139], v[236:239], v[152:155], v[136:139]
    ds_read_b64_tr_b16 v[234:235], v23 offset:41984
    buffer_load_dwordx4 v[144:147], v2, s[32:35], s20 offen offset:1024 sc1
    s_waitcnt lgkmcnt(6)
    v_mfma_f32_16x16x32_bf16 v[108:111], v[240:243], v[148:151], v[108:111]
    ds_read_b64_tr_b16 v[236:237], v20 offset:40960
    v_mfma_f32_16x16x32_bf16 v[112:115], v[240:243], v[152:155], v[112:115]
    ds_read_b64_tr_b16 v[238:239], v20 offset:41984
    s_waitcnt lgkmcnt(6)
    v_mfma_f32_16x16x32_bf16 v[116:119], v[244:247], v[148:151], v[116:119]
    ds_read_b64_tr_b16 v[240:241], v21 offset:40960
    v_mfma_f32_16x16x32_bf16 v[120:123], v[244:247], v[152:155], v[120:123]
    ds_read_b64_tr_b16 v[242:243], v21 offset:41984
    s_waitcnt lgkmcnt(6)
    s_waitcnt vmcnt(4)
    v_mfma_f32_16x16x32_bf16 v[124:127], v[228:231], v[156:159], v[124:127]
    ds_read_b64_tr_b16 v[244:245], v22 offset:45056
    v_mfma_f32_16x16x32_bf16 v[128:131], v[228:231], v[160:163], v[128:131]
    ds_read_b64_tr_b16 v[246:247], v22 offset:46080
    s_xor_b32 s96, s83, 13
    s_lshl_b32 s97, s96, 11
    s_add_u32 s20, s97, s19
    buffer_load_dwordx4 v[148:151], v2, s[32:35], s20 offen sc1
    s_waitcnt lgkmcnt(6)
    v_mfma_f32_16x16x32_bf16 v[132:135], v[232:235], v[156:159], v[132:135]
    ds_read_b64_tr_b16 v[228:229], v23 offset:45056
    v_mfma_f32_16x16x32_bf16 v[136:139], v[232:235], v[160:163], v[136:139]
    ds_read_b64_tr_b16 v[230:231], v23 offset:46080
    buffer_load_dwordx4 v[152:155], v2, s[32:35], s20 offen offset:1024 sc1
    s_waitcnt lgkmcnt(6)
    v_mfma_f32_16x16x32_bf16 v[108:111], v[236:239], v[156:159], v[108:111]
    ds_read_b64_tr_b16 v[232:233], v20 offset:45056
    v_mfma_f32_16x16x32_bf16 v[112:115], v[236:239], v[160:163], v[112:115]
    ds_read_b64_tr_b16 v[234:235], v20 offset:46080
    s_waitcnt lgkmcnt(6)
    v_mfma_f32_16x16x32_bf16 v[116:119], v[240:243], v[156:159], v[116:119]
    ds_read_b64_tr_b16 v[236:237], v21 offset:45056
    v_mfma_f32_16x16x32_bf16 v[120:123], v[240:243], v[160:163], v[120:123]
    ds_read_b64_tr_b16 v[238:239], v21 offset:46080
    s_waitcnt lgkmcnt(6)
    s_waitcnt vmcnt(4)
    v_mfma_f32_16x16x32_bf16 v[124:127], v[244:247], v[164:167], v[124:127]
    ds_read_b64_tr_b16 v[240:241], v22 offset:49152
    v_mfma_f32_16x16x32_bf16 v[128:131], v[244:247], v[168:171], v[128:131]
    ds_read_b64_tr_b16 v[242:243], v22 offset:50176
    s_xor_b32 s96, s83, 14
    s_lshl_b32 s97, s96, 11
    s_add_u32 s20, s97, s19
    buffer_load_dwordx4 v[156:159], v2, s[32:35], s20 offen sc1
    s_waitcnt lgkmcnt(6)
    v_mfma_f32_16x16x32_bf16 v[132:135], v[228:231], v[164:167], v[132:135]
    ds_read_b64_tr_b16 v[244:245], v23 offset:49152
    v_mfma_f32_16x16x32_bf16 v[136:139], v[228:231], v[168:171], v[136:139]
    ds_read_b64_tr_b16 v[246:247], v23 offset:50176
    buffer_load_dwordx4 v[160:163], v2, s[32:35], s20 offen offset:1024 sc1
    s_waitcnt lgkmcnt(6)
    v_mfma_f32_16x16x32_bf16 v[108:111], v[232:235], v[164:167], v[108:111]
    ds_read_b64_tr_b16 v[228:229], v20 offset:49152
    v_mfma_f32_16x16x32_bf16 v[112:115], v[232:235], v[168:171], v[112:115]
    ds_read_b64_tr_b16 v[230:231], v20 offset:50176
    s_waitcnt lgkmcnt(6)
    v_mfma_f32_16x16x32_bf16 v[116:119], v[236:239], v[164:167], v[116:119]
    ds_read_b64_tr_b16 v[232:233], v21 offset:49152
    v_mfma_f32_16x16x32_bf16 v[120:123], v[236:239], v[168:171], v[120:123]
    ds_read_b64_tr_b16 v[234:235], v21 offset:50176
    s_waitcnt lgkmcnt(6)
    s_waitcnt vmcnt(4)
    v_mfma_f32_16x16x32_bf16 v[124:127], v[240:243], v[140:143], v[124:127]
    ds_read_b64_tr_b16 v[236:237], v22 offset:53248
    v_mfma_f32_16x16x32_bf16 v[128:131], v[240:243], v[144:147], v[128:131]
    ds_read_b64_tr_b16 v[238:239], v22 offset:54272
    s_xor_b32 s96, s83, 15
    s_lshl_b32 s97, s96, 11
    s_add_u32 s20, s97, s19
    buffer_load_dwordx4 v[164:167], v2, s[32:35], s20 offen sc1
    s_waitcnt lgkmcnt(6)
    v_mfma_f32_16x16x32_bf16 v[132:135], v[244:247], v[140:143], v[132:135]
    ds_read_b64_tr_b16 v[240:241], v23 offset:53248
    v_mfma_f32_16x16x32_bf16 v[136:139], v[244:247], v[144:147], v[136:139]
    ds_read_b64_tr_b16 v[242:243], v23 offset:54272
    buffer_load_dwordx4 v[168:171], v2, s[32:35], s20 offen offset:1024 sc1
    buffer_load_dwordx2 v[26:27], v25, s[32:35], s18 offen sc1
    s_waitcnt lgkmcnt(6)
    v_mfma_f32_16x16x32_bf16 v[108:111], v[228:231], v[140:143], v[108:111]
    ds_read_b64_tr_b16 v[244:245], v20 offset:53248
    v_mfma_f32_16x16x32_bf16 v[112:115], v[228:231], v[144:147], v[112:115]
    ds_read_b64_tr_b16 v[246:247], v20 offset:54272
    s_waitcnt lgkmcnt(6)
    v_mfma_f32_16x16x32_bf16 v[116:119], v[232:235], v[140:143], v[116:119]
    ds_read_b64_tr_b16 v[228:229], v21 offset:53248
    v_mfma_f32_16x16x32_bf16 v[120:123], v[232:235], v[144:147], v[120:123]
    ds_read_b64_tr_b16 v[230:231], v21 offset:54272
    s_waitcnt lgkmcnt(6)
    s_waitcnt vmcnt(5)
    v_mfma_f32_16x16x32_bf16 v[124:127], v[236:239], v[148:151], v[124:127]
    ds_read_b64_tr_b16 v[232:233], v22 offset:57344
    v_mfma_f32_16x16x32_bf16 v[128:131], v[236:239], v[152:155], v[128:131]
    ds_read_b64_tr_b16 v[234:235], v22 offset:58368
    s_waitcnt lgkmcnt(6)
    v_mfma_f32_16x16x32_bf16 v[132:135], v[240:243], v[148:151], v[132:135]
    ds_read_b64_tr_b16 v[236:237], v23 offset:57344
    v_mfma_f32_16x16x32_bf16 v[136:139], v[240:243], v[152:155], v[136:139]
    ds_read_b64_tr_b16 v[238:239], v23 offset:58368
    s_waitcnt lgkmcnt(6)
    v_mfma_f32_16x16x32_bf16 v[108:111], v[244:247], v[148:151], v[108:111]
    ds_read_b64_tr_b16 v[240:241], v20 offset:57344
    v_mfma_f32_16x16x32_bf16 v[112:115], v[244:247], v[152:155], v[112:115]
    ds_read_b64_tr_b16 v[242:243], v20 offset:58368
    s_waitcnt lgkmcnt(6)
    v_mfma_f32_16x16x32_bf16 v[116:119], v[228:231], v[148:151], v[116:119]
    ds_read_b64_tr_b16 v[244:245], v21 offset:57344
    v_mfma_f32_16x16x32_bf16 v[120:123], v[228:231], v[152:155], v[120:123]
    ds_read_b64_tr_b16 v[246:247], v21 offset:58368
    s_waitcnt lgkmcnt(6)
    s_waitcnt vmcnt(3)
    v_mfma_f32_16x16x32_bf16 v[124:127], v[232:235], v[156:159], v[124:127]
    ds_read_b64_tr_b16 v[228:229], v22 offset:61440
    v_mfma_f32_16x16x32_bf16 v[128:131], v[232:235], v[160:163], v[128:131]
    ds_read_b64_tr_b16 v[230:231], v22 offset:62464
    s_waitcnt lgkmcnt(6)
    v_mfma_f32_16x16x32_bf16 v[132:135], v[236:239], v[156:159], v[132:135]
    ds_read_b64_tr_b16 v[232:233], v23 offset:61440
    v_mfma_f32_16x16x32_bf16 v[136:139], v[236:239], v[160:163], v[136:139]
    ds_read_b64_tr_b16 v[234:235], v23 offset:62464
    s_waitcnt lgkmcnt(6)
    v_mfma_f32_16x16x32_bf16 v[108:111], v[240:243], v[156:159], v[108:111]
    ds_read_b64_tr_b16 v[236:237], v20 offset:61440
    v_mfma_f32_16x16x32_bf16 v[112:115], v[240:243], v[160:163], v[112:115]
    ds_read_b64_tr_b16 v[238:239], v20 offset:62464
    s_waitcnt lgkmcnt(6)
    v_mfma_f32_16x16x32_bf16 v[116:119], v[244:247], v[156:159], v[116:119]
    ds_read_b64_tr_b16 v[240:241], v21 offset:61440
    v_mfma_f32_16x16x32_bf16 v[120:123], v[244:247], v[160:163], v[120:123]
    ds_read_b64_tr_b16 v[242:243], v21 offset:62464
    s_waitcnt lgkmcnt(6)
    s_waitcnt vmcnt(1)
    v_mfma_f32_16x16x32_bf16 v[124:127], v[228:231], v[164:167], v[124:127]
    v_mfma_f32_16x16x32_bf16 v[128:131], v[228:231], v[168:171], v[128:131]
    s_waitcnt lgkmcnt(4)
    v_mfma_f32_16x16x32_bf16 v[132:135], v[232:235], v[164:167], v[132:135]
    v_mfma_f32_16x16x32_bf16 v[136:139], v[232:235], v[168:171], v[136:139]
    s_waitcnt lgkmcnt(2)
    v_mfma_f32_16x16x32_bf16 v[108:111], v[236:239], v[164:167], v[108:111]
    v_mfma_f32_16x16x32_bf16 v[112:115], v[236:239], v[168:171], v[112:115]
    s_waitcnt lgkmcnt(0)
    v_mfma_f32_16x16x32_bf16 v[116:119], v[240:243], v[164:167], v[116:119]
    v_mfma_f32_16x16x32_bf16 v[120:123], v[240:243], v[168:171], v[120:123]
    s_setprio 0
    s_lshl_b32 s13, s3, 12
    v_add_u32 v4, s13, v2
    ds_write_b128 v4, v[124:127]
    ds_write_b128 v4, v[128:131] offset:1024
    ds_write_b128 v4, v[132:135] offset:2048
    ds_write_b128 v4, v[136:139] offset:3072
    v_permlane16_swap_b32 v108, v112
    v_permlane16_swap_b32 v109, v113
    v_permlane16_swap_b32 v110, v114
    v_permlane16_swap_b32 v111, v115
    v_permlane16_swap_b32 v116, v120
    v_permlane16_swap_b32 v117, v121
    v_permlane16_swap_b32 v118, v122
    v_permlane16_swap_b32 v119, v123
    s_xor_b32 s96, s3, 4
    s_lshl_b32 s13, s96, 12
    v_and_b32 v5, 15, v1
    v_lshl_add_u32 v5, v5, 4, s13
    v_bfe_u32 v9, v1, 4, 1
    v_lshl_add_u32 v5, v9, 10, v5
    v_lshrrev_b32 v9, 5, v1
    v_lshl_add_u32 v5, v9, 9, v5
    s_lshl_b32 s96, s76, 11
    s_and_b32 s97, s3, 3
    s_lshl_b32 s98, s97, 9
    s_add_u32 s99, s96, s98
    s_add_u32 s13, s99, 131072
    v_and_b32 v6, 31, v1
    v_lshl_add_u32 v6, v6, 4, s13
    v_lshrrev_b32 v9, 5, v1
    v_lshl_add_u32 v6, v9, 3, v6
    s_lshl_b32 s96, s76, 6
    s_add_u32 s13, s96, 139008
    v_and_b32 v7, 7, v1
    v_lshl_add_u32 v7, v7, 2, s13
    v_lshrrev_b32 v9, 5, v1
    v_lshl_add_u32 v7, v9, 5, v7
    s_lshl_b32 s96, s21, 15
    s_lshl_b32 s97, s3, 8
    s_add_u32 s98, s96, s97
    s_add_u32 s19, s98, 12582912
    v_and_b32 v44, 15, v1
    v_lshlrev_b32 v44, 4, v44
    v_lshrrev_b32 v9, 4, v1
    v_lshl_add_u32 v44, v9, 11, v44
    v_mov_b32 v232, 0x3f803f80
    s_waitcnt lgkmcnt(0)
    s_barrier
    ds_read_b128 v[124:127], v5
    ds_read_b128 v[128:131], v5 offset:256
    ds_read_b128 v[132:135], v5 offset:2048
    ds_read_b128 v[136:139], v5 offset:2304
    s_add_u32 s14, s80, 114688
    s_lshl2_add_u32 m0, s89, 67584
    s_nop 0
    buffer_load_dwordx4 v72, s[56:59], s14 offen nt lds
    s_add_u32 s14, s80, 172032
    s_lshl2_add_u32 m0, s89, 68608
    s_nop 0
    buffer_load_dwordx4 v72, s[56:59], s14 offen nt lds
    s_mov_b32 s14, s81
    s_lshl2_add_u32 m0, s89, 98304
    s_nop 0
    buffer_load_dwordx4 v73, s[60:63], s14 offen nt lds
    s_waitcnt lgkmcnt(3)
    v_pk_add_f32 v[108:109], v[108:109], v[124:125]
    v_pk_add_f32 v[110:111], v[110:111], v[126:127]
    s_waitcnt lgkmcnt(2)
    v_pk_add_f32 v[112:113], v[112:113], v[128:129]
    v_pk_add_f32 v[114:115], v[114:115], v[130:131]
    v_cvt_pk_bf16_f32 v108, 0, v108
    v_cvt_pk_bf16_f32 v109, 0, v109
    v_cvt_pk_bf16_f32 v110, 0, v110
    v_cvt_pk_bf16_f32 v111, 0, v111
    v_cvt_pk_bf16_f32 v112, 0, v112
    v_cvt_pk_bf16_f32 v113, 0, v113
    v_cvt_pk_bf16_f32 v114, 0, v114
    v_cvt_pk_bf16_f32 v115, 0, v115
    v_pk_mul_f32 v[108:109], v[108:109], v[76:77]
    v_pk_mul_f32 v[110:111], v[110:111], v[78:79]
    v_pk_mul_f32 v[112:113], v[112:113], v[80:81]
    v_pk_mul_f32 v[114:115], v[114:115], v[82:83]
    v_cvt_pk_bf16_f32 v108, 0, v108
    v_cvt_pk_bf16_f32 v109, 0, v109
    v_cvt_pk_bf16_f32 v110, 0, v110
    v_cvt_pk_bf16_f32 v111, 0, v111
    v_cvt_pk_bf16_f32 v112, 0, v112
    v_cvt_pk_bf16_f32 v113, 0, v113
    v_cvt_pk_bf16_f32 v114, 0, v114
    v_cvt_pk_bf16_f32 v115, 0, v115
    v_pk_add_f32 v[108:109], v[108:109], v[28:29]
    v_pk_add_f32 v[110:111], v[110:111], v[30:31]
    v_pk_add_f32 v[112:113], v[112:113], v[32:33]
    v_pk_add_f32 v[114:115], v[114:115], v[34:35]
    v_cvt_pk_bf16_f32 v12, v108, v109
    v_cvt_pk_bf16_f32 v13, v110, v111
    v_cvt_pk_bf16_f32 v14, v112, v113
    v_cvt_pk_bf16_f32 v15, v114, v115
    s_waitcnt lgkmcnt(1)
    v_pk_add_f32 v[116:117], v[116:117], v[132:133]
    v_pk_add_f32 v[118:119], v[118:119], v[134:135]
    s_waitcnt lgkmcnt(0)
    v_pk_add_f32 v[120:121], v[120:121], v[136:137]
    v_pk_add_f32 v[122:123], v[122:123], v[138:139]
    v_cvt_pk_bf16_f32 v116, 0, v116
    v_cvt_pk_bf16_f32 v117, 0, v117
    v_cvt_pk_bf16_f32 v118, 0, v118
    v_cvt_pk_bf16_f32 v119, 0, v119
    v_cvt_pk_bf16_f32 v120, 0, v120
    v_cvt_pk_bf16_f32 v121, 0, v121
    v_cvt_pk_bf16_f32 v122, 0, v122
    v_cvt_pk_bf16_f32 v123, 0, v123
    v_pk_mul_f32 v[116:117], v[116:117], v[84:85]
    v_pk_mul_f32 v[118:119], v[118:119], v[86:87]
    v_pk_mul_f32 v[120:121], v[120:121], v[88:89]
    v_pk_mul_f32 v[122:123], v[122:123], v[90:91]
    v_cvt_pk_bf16_f32 v116, 0, v116
    v_cvt_pk_bf16_f32 v117, 0, v117
    v_cvt_pk_bf16_f32 v118, 0, v118
    v_cvt_pk_bf16_f32 v119, 0, v119
    v_cvt_pk_bf16_f32 v120, 0, v120
    v_cvt_pk_bf16_f32 v121, 0, v121
    v_cvt_pk_bf16_f32 v122, 0, v122
    v_cvt_pk_bf16_f32 v123, 0, v123
    v_pk_add_f32 v[116:117], v[116:117], v[36:37]
    v_pk_add_f32 v[118:119], v[118:119], v[38:39]
    v_pk_add_f32 v[120:121], v[120:121], v[40:41]
    v_pk_add_f32 v[122:123], v[122:123], v[42:43]
    v_cvt_pk_bf16_f32 v16, v116, v117
    v_cvt_pk_bf16_f32 v17, v118, v119
    v_cvt_pk_bf16_f32 v18, v120, v121
    v_cvt_pk_bf16_f32 v19, v122, v123
    v_mfma_f32_32x32x16_bf16 v[124:139], v[92:95], v[12:15], 0
    s_nop 0
    v_mfma_f32_32x32x16_bf16 v[124:139], v[96:99], v[16:19], v[124:139]
    v_dot2_f32_bf16 v228, v12, v12, 0
    v_dot2_f32_bf16 v229, v13, v13, 0
    v_dot2_f32_bf16 v228, v14, v14, v228
    v_dot2_f32_bf16 v229, v15, v15, v229
    v_dot2_f32_bf16 v228, v16, v16, v228
    v_dot2_f32_bf16 v229, v17, v17, v229
    v_dot2_f32_bf16 v228, v18, v18, v228
    v_dot2_f32_bf16 v229, v19, v19, v229
    s_nop 2
    v_add_f32 v230, v228, v229
    v_add_f32 v228, v228, v229
    s_nop 1
    v_permlane32_swap_b32 v228, v230
    s_mov_b32 exec_lo, 0
    v_add_f32 v124, v228, v230
    v_mov_b32 v125, v126
    s_mov_b32 exec_lo, -1
    ds_write_b64 v6, v[124:125]
    ds_write_b32 v7, v68
    ds_write_b32 v7, v69 offset:128
    ds_write_b32 v7, v70 offset:256
    ds_write_b32 v7, v71 offset:384
    v_add_u32 v4, 131072, v2
    v_and_b32 v5, 7, v1
    v_lshlrev_b32 v5, 15, v5
    v_bfe_u32 v9, v1, 3, 1
    v_lshl_add_u32 v5, v9, 12, v5
    s_lshl4_add_u32 s96, s21, s12
    s_lshl_b32 s97, s96, 11
    s_add_u32 s13, s97, 12582912
    s_and_b32 s96, s12, 1
    s_lshr_b32 s97, s21, 2
    s_and_b32 s98, s21, 3
    s_lshl_b32 s99, s98, 6
    s_lshl1_add_u32 s98, s97, s99
    s_lshl_b32 s97, s98, 12
    s_lshr_b32 s99, s12, 1
    s_lshl_b32 s98, s99, 6
    s_add_u32 s99, s97, s98
    s_lshl2_add_u32 s97, s96, s99
    s_add_u32 s98, s97, 1048576
    s_add_u32 s16, s98, 1536
    s_waitcnt lgkmcnt(0)
    s_barrier
    s_cmp_lg_u32 s3, 0
    s_cbranch_scc1 L_PE
    ds_read_b128 v[124:127], v4 offset:0
    ds_read_b128 v[128:131], v4 offset:2048
    ds_read_b128 v[132:135], v4 offset:1024
    ds_read_b128 v[136:139], v4 offset:3072
    s_waitcnt lgkmcnt(2)
    v_pk_add_f32 v[124:125], v[124:125], v[128:129]
    v_pk_add_f32 v[126:127], v[126:127], v[130:131]
    v_add_f32 v125, v125, v127
    v_mov_b32 v127, s4
    s_waitcnt lgkmcnt(0)
    v_pk_add_f32 v[132:133], v[132:133], v[136:137]
    v_pk_add_f32 v[134:135], v[134:135], v[138:139]
    v_add_f32 v133, v133, v135
    v_mov_b32 v135, s4
    buffer_store_dwordx4 v[124:127], v2, s[32:35], s13 offen sc1
    buffer_store_dwordx4 v[132:135], v2, s[32:35], s13 offen offset:1024 sc1
    s_mov_b64 exec, 0xffff
    buffer_store_dword v127, v5, s[32:35], s16 offen sc1
    s_mov_b64 exec, -1
L_PE:
    s_load_dwordx2 s[24:25], s[32:33], s92 offset:1536 glc
    s_and_b32 s96, s3, 3
    s_mul_i32 s97, s96, 4608
    s_lshl_b32 s98, s76, 6
    s_add_u32 s16, s97, s98
    v_and_b32 v23, 31, v1
    v_mul_u32_u24 v23, 144, v23
    v_lshrrev_b32 v9, 5, v1
    v_lshl_add_u32 v23, v9, 5, v23
    v_add_u32 v23, s16, v23
    ds_write_b128 v23, v[12:15]
    ds_write_b128 v23, v[16:19] offset:16
    v_add_u32 v23, 139776, v23
    s_lshl3_add_u32 s96, s21, s3
    s_lshl_b32 s97, s96, 5
    s_sub_u32 s15, 4094, s97
    v_and_b32 v22, 15, v1
    v_lshlrev_b32 v22, 1, v22
    v_sub_u32 v22, s15, v22
    s_lshl_b32 s96, s3, 7
    s_add_u32 s15, s96, 135168
    v_and_b32 v8, 15, v1
    v_lshl_add_u32 v8, v8, 3, s15
    s_and_b32 s96, s3, 3
    s_lshl_b32 s97, s96, 8
    s_add_u32 s15, s97, 135168
    v_and_b32 v10, 31, v1
    v_lshl_add_u32 v10, v10, 3, s15
    v_and_b32 v11, 7, v1
    v_lshlrev_b32 v11, 3, v11
    v_add_u32 v11, 136192, v11
    s_waitcnt vmcnt(3)
    v_cmp_ne_u32 vcc, s4, v27
    s_cbranch_vccz TOK_38
POLL_39:
    buffer_load_dwordx2 v[26:27], v25, s[32:35], s18 offen sc1
    s_waitcnt vmcnt(0)
    v_cmp_ne_u32 vcc, s4, v27
    s_cbranch_vccz PDONE_40
    s_add_u32 s5, s5, 1
    s_cmp_lt_u32 s5, 300000
    s_cbranch_scc1 POLL_39
PDONE_40:
TOK_38:
    v_add_f32_dpp v26, v26, v26 quad_perm:[1,0,3,2] row_mask:0xf bank_mask:0xf
    s_nop 1
    v_add_f32_dpp v26, v26, v26 quad_perm:[2,3,0,1] row_mask:0xf bank_mask:0xf
    s_nop 1
    v_add_f32_dpp v26, v26, v26 row_half_mirror row_mask:0xf bank_mask:0xf
    s_nop 1
    v_add_f32_dpp v26, v26, v26 row_ror:8 row_mask:0xf bank_mask:0xf
    s_cmp_lg_u32 s3, 1
    s_cbranch_scc1 L_NOCT
    v_and_b32 v5, 15, v1
    v_lshlrev_b32 v5, 3, v5
    v_add_u32 v5, 139008, v5
    ds_read_b64 v[150:151], v5
    ds_read_b64 v[154:155], v5 offset:128
    ds_read_b64 v[156:157], v5 offset:384
    s_waitcnt lgkmcnt(0)
    v_lshlrev_b32 v148, 16, v150
    v_and_b32 v149, s6, v150
    v_lshlrev_b32 v150, 16, v151
    v_and_b32 v151, s6, v151
    v_lshlrev_b32 v152, 16, v154
    v_and_b32 v153, s6, v154
    v_lshlrev_b32 v154, 16, v155
    v_and_b32 v155, s6, v155
L_NOCT:
    s_cmp_lt_u32 s3, 4
    s_cbranch_scc1 L_NOST
    s_sub_u32 s96, s3, 4
    s_lshl_b32 s97, s96, 12
    s_add_u32 s13, s97, 32768
    v_add_u32 v4, s13, v2
    v_add_u32 v7, 65536, v4
    ds_write_b128 v4, v[176:179] offset:16384
    ds_write_b128 v4, v[180:183]
    ds_write_b128 v4, v[184:187] offset:17408
    ds_write_b128 v4, v[188:191] offset:1024
    ds_write_b128 v4, v[192:195] offset:18432
    ds_write_b128 v4, v[196:199] offset:2048
    ds_write_b128 v4, v[200:203] offset:19456
    ds_write_b128 v4, v[204:207] offset:3072
    ds_write_b128 v4, v[208:211] offset:49152
    ds_write_b128 v4, v[212:215] offset:32768
    ds_write_b128 v4, v[216:219] offset:50176
    ds_write_b128 v4, v[220:223] offset:33792
L_NOST:
    s_branch SCHK_36
SPOLL_35:
    s_load_dwordx2 s[24:25], s[32:33], s92 offset:1536 glc
SCHK_36:
    s_add_u32 s5, s5, 1
    s_cmp_ge_u32 s5, 300000
    s_waitcnt lgkmcnt(0)
    s_cbranch_scc1 SDONE_37
    s_cmp_lg_u32 s24, s4
    s_cbranch_scc1 SPOLL_35
    s_cmp_lg_u32 s25, s4
    s_cbranch_scc1 SPOLL_35
SDONE_37:
    s_barrier
    s_mov_b32 s13, s19
    buffer_load_dwordx4 v[124:127], v44, s[32:35], s13 offen sc1
    s_add_u32 s13, s19, 8192
    buffer_load_dwordx4 v[128:131], v44, s[32:35], s13 offen sc1
    s_add_u32 s13, s19, 16384
    buffer_load_dwordx4 v[132:135], v44, s[32:35], s13 offen sc1
    s_add_u32 s13, s19, 24576
    buffer_load_dwordx4 v[136:139], v44, s[32:35], s13 offen sc1
    v_lshlrev_b32 v28, 16, v12
    v_and_b32 v29, s6, v12
    v_lshlrev_b32 v30, 16, v13
    v_and_b32 v31, s6, v13
    v_lshlrev_b32 v32, 16, v14
    v_and_b32 v33, s6, v14
    v_lshlrev_b32 v34, 16, v15
    v_and_b32 v35, s6, v15
    v_lshlrev_b32 v36, 16, v16
    v_and_b32 v37, s6, v16
    v_lshlrev_b32 v38, 16, v17
    v_and_b32 v39, s6, v17
    v_lshlrev_b32 v40, 16, v18
    v_and_b32 v41, s6, v18
    v_lshlrev_b32 v42, 16, v19
    v_and_b32 v43, s6, v19
    v_mul_u32_u24_dpp v92, v68, v52 row_newbcast:0 row_mask:0xf bank_mask:0xf
    v_and_b32_dpp v93, v68, v53 row_newbcast:0 row_mask:0xf bank_mask:0xf
    v_mul_u32_u24_dpp v94, v68, v52 row_newbcast:1 row_mask:0xf bank_mask:0xf
    v_and_b32_dpp v95, v68, v53 row_newbcast:1 row_mask:0xf bank_mask:0xf
    v_mul_u32_u24_dpp v96, v68, v52 row_newbcast:2 row_mask:0xf bank_mask:0xf
    v_and_b32_dpp v97, v68, v53 row_newbcast:2 row_mask:0xf bank_mask:0xf
    v_mul_u32_u24_dpp v98, v68, v52 row_newbcast:3 row_mask:0xf bank_mask:0xf
    v_and_b32_dpp v99, v68, v53 row_newbcast:3 row_mask:0xf bank_mask:0xf
    v_mul_u32_u24_dpp v100, v68, v52 row_newbcast:4 row_mask:0xf bank_mask:0xf
    v_and_b32_dpp v101, v68, v53 row_newbcast:4 row_mask:0xf bank_mask:0xf
    v_mul_u32_u24_dpp v102, v68, v52 row_newbcast:5 row_mask:0xf bank_mask:0xf
    v_and_b32_dpp v103, v68, v53 row_newbcast:5 row_mask:0xf bank_mask:0xf
    v_mul_u32_u24_dpp v104, v68, v52 row_newbcast:6 row_mask:0xf bank_mask:0xf
    v_and_b32_dpp v105, v68, v53 row_newbcast:6 row_mask:0xf bank_mask:0xf
    v_mul_u32_u24_dpp v106, v68, v52 row_newbcast:7 row_mask:0xf bank_mask:0xf
    v_and_b32_dpp v107, v68, v53 row_newbcast:7 row_mask:0xf bank_mask:0xf
    v_mul_u32_u24_dpp v108, v69, v52 row_newbcast:0 row_mask:0xf bank_mask:0xf
    v_and_b32_dpp v109, v69, v53 row_newbcast:0 row_mask:0xf bank_mask:0xf
    v_mul_u32_u24_dpp v110, v69, v52 row_newbcast:1 row_mask:0xf bank_mask:0xf
    v_and_b32_dpp v111, v69, v53 row_newbcast:1 row_mask:0xf bank_mask:0xf
    v_mul_u32_u24_dpp v112, v69, v52 row_newbcast:2 row_mask:0xf bank_mask:0xf
    v_and_b32_dpp v113, v69, v53 row_newbcast:2 row_mask:0xf bank_mask:0xf
    v_mul_u32_u24_dpp v114, v69, v52 row_newbcast:3 row_mask:0xf bank_mask:0xf
    v_and_b32_dpp v115, v69, v53 row_newbcast:3 row_mask:0xf bank_mask:0xf
    v_mul_u32_u24_dpp v116, v69, v52 row_newbcast:4 row_mask:0xf bank_mask:0xf
    v_and_b32_dpp v117, v69, v53 row_newbcast:4 row_mask:0xf bank_mask:0xf
    v_mul_u32_u24_dpp v118, v69, v52 row_newbcast:5 row_mask:0xf bank_mask:0xf
    v_and_b32_dpp v119, v69, v53 row_newbcast:5 row_mask:0xf bank_mask:0xf
    v_mul_u32_u24_dpp v120, v69, v52 row_newbcast:6 row_mask:0xf bank_mask:0xf
    v_and_b32_dpp v121, v69, v53 row_newbcast:6 row_mask:0xf bank_mask:0xf
    v_mul_u32_u24_dpp v122, v69, v52 row_newbcast:7 row_mask:0xf bank_mask:0xf
    v_and_b32_dpp v123, v69, v53 row_newbcast:7 row_mask:0xf bank_mask:0xf
    s_waitcnt vmcnt(0)
    v_bitop3_b32 v4, v127, v131, s4 bitop3:0x7e
    v_bitop3_b32 v4, v4, v135, s4 bitop3:0xf6
    v_bitop3_b32 v4, v4, v139, s4 bitop3:0xf6
    v_cmp_ne_u32 vcc, 0, v4
    s_cbranch_vccz TOK_42
POLL_43:
    s_mov_b32 s13, s19
    buffer_load_dwordx4 v[124:127], v44, s[32:35], s13 offen sc1
    s_add_u32 s13, s19, 8192
    buffer_load_dwordx4 v[128:131], v44, s[32:35], s13 offen sc1
    s_add_u32 s13, s19, 16384
    buffer_load_dwordx4 v[132:135], v44, s[32:35], s13 offen sc1
    s_add_u32 s13, s19, 24576
    buffer_load_dwordx4 v[136:139], v44, s[32:35], s13 offen sc1
    s_waitcnt vmcnt(0)
    v_bitop3_b32 v4, v127, v131, s4 bitop3:0x7e
    v_bitop3_b32 v4, v4, v135, s4 bitop3:0xf6
    v_bitop3_b32 v4, v4, v139, s4 bitop3:0xf6
    v_cmp_ne_u32 vcc, 0, v4
    s_cbranch_vccz PDONE_44
    s_add_u32 s5, s5, 1
    s_cmp_lt_u32 s5, 300000
    s_cbranch_scc1 POLL_43
PDONE_44:
TOK_42:
    s_lshl2_add_u32 s96, s74, s75
    s_lshl_b32 s97, s96, 11
    s_lshl_b32 s98, s3, 8
    s_add_u32 s99, s97, s98
    s_add_u32 s15, s99, 20971520
    v_lshlrev_b32 v44, 7, v1
    s_mov_b64 exec, 3
    buffer_load_dword v44, v44, s[32:35], s15 offen
    s_mov_b64 exec, -1
    v_pk_add_f32 v[124:125], v[124:125], v[128:129]
    v_pk_add_f32 v[132:133], v[132:133], v[136:137]
    v_add_f32 v126, v126, v130
    v_add_f32 v134, v134, v138
    v_pk_add_f32 v[124:125], v[124:125], v[132:133]
    v_add_f32 v126, v126, v134
    v_mov_b32 v127, v125
    s_nop 0
    v_permlane32_swap_b32 v124, v126
    v_permlane32_swap_b32 v125, v127
    v_add_f32 v124, v124, v126
    v_add_f32 v125, v125, v127
    s_nop 1
    v_permlane16_swap_b32 v124, v125
    v_add_f32 v127, v124, v125
    v_add_f32 v124, v124, v125
    s_nop 1
    v_permlane16_swap_b32 v124, v127
    v_mul_f32 v126, 0x3a800000, v124
    v_mul_f32 v124, 0x3a800000, v124
    s_nop 1
    v_permlane32_swap_b32 v124, v126
    v_fma_f32 v21, -v124, v124, v126
    v_cvt_pk_bf16_f32 v20, 0, v124
    v_max_f32 v21, 0, v21
    v_cvt_pk_bf16_f32 v21, 0, v21
    v_add_f32 v21, 0x3727c5ac, v21
    v_cvt_pk_bf16_f32 v21, 0, v21
    v_sqrt_f32 v21, v21
    s_nop 0
    v_cvt_pk_bf16_f32 v21, 0, v21
    s_lshl3_add_u32 s13, s3, 136192
    v_rcp_f32 v21, v21
    v_fma_f32 v127, -v20, v26, v127
    v_mov_b32 v5, s13
    v_mul_f32 v127, v127, v21
    ds_write_b64 v8, v[20:21]
    s_movk_i32 s13, 0xfff
    v_ashrrev_i32 v124, 31, v127
    v_or_b32 v124, 0x80000000, v124
    v_xor_b32 v124, v124, v127
    v_bfi_b32 v48, s13, v22, v124
    s_nop 1
    v_min_u32_dpp v49, v48, v48 row_ror:8 row_mask:0xf bank_mask:0xf
    v_max_u32_dpp v48, v48, v48 row_ror:8 row_mask:0xf bank_mask:0xf
    s_nop 1
    v_min_u32_dpp v50, v48, v48 row_ror:4 row_mask:0xf bank_mask:0xf
    v_max_u32_dpp v49, v49, v49 row_ror:4 row_mask:0xf bank_mask:0xf
    v_max_u32_dpp v48, v48, v48 row_ror:4 row_mask:0xf bank_mask:0xf
    v_max_u32 v49, v49, v50
    s_nop 0
    v_min_u32_dpp v50, v48, v48 row_ror:2 row_mask:0xf bank_mask:0xf
    v_max_u32_dpp v49, v49, v49 row_ror:2 row_mask:0xf bank_mask:0xf
    v_max_u32_dpp v48, v48, v48 row_ror:2 row_mask:0xf bank_mask:0xf
    v_max_u32 v49, v49, v50
    s_nop 0
    v_min_u32_dpp v50, v48, v48 row_ror:1 row_mask:0xf bank_mask:0xf
    v_max_u32_dpp v49, v49, v49 row_ror:1 row_mask:0xf bank_mask:0xf
    v_max_u32_dpp v48, v48, v48 row_ror:1 row_mask:0xf bank_mask:0xf
    v_max_u32 v49, v49, v50
    ds_write_b64 v5, v[48:49]
    v_and_b32 v6, 3, v1
    v_lshlrev_b32 v6, 18, v6
    v_bfe_u32 v9, v1, 2, 2
    v_lshl_add_u32 v6, v9, 13, v6
    s_and_b32 s96, s21, 1
    s_and_b32 s97, s12, 7
    s_lshr_b32 s98, s12, 3
    s_lshl3_add_u32 s99, s97, s98
    s_lshl_b32 s97, s99, 12
    s_lshr_b32 s98, s21, 1
    s_lshl_b32 s99, s98, 6
    s_add_u32 s98, s97, s99
    s_lshl4_add_u32 s97, s96, s98
    s_add_u32 s99, s97, 1048576
    s_add_u32 s14, s99, 2560
    s_waitcnt lgkmcnt(0)
    s_barrier
    ds_read_b64 v[48:49], v11
    ds_read_b64 v[20:21], v10
    s_waitcnt lgkmcnt(1)
    v_min_u32_dpp v50, v48, v48 quad_perm:[1,0,3,2] row_mask:0xf bank_mask:0xf
    v_max_u32_dpp v49, v49, v49 quad_perm:[1,0,3,2] row_mask:0xf bank_mask:0xf
    v_max_u32_dpp v48, v48, v48 quad_perm:[1,0,3,2] row_mask:0xf bank_mask:0xf
    v_max_u32 v49, v49, v50
    s_nop 0
    v_min_u32_dpp v50, v48, v48 quad_perm:[2,3,0,1] row_mask:0xf bank_mask:0xf
    v_max_u32_dpp v49, v49, v49 quad_perm:[2,3,0,1] row_mask:0xf bank_mask:0xf
    v_max_u32_dpp v48, v48, v48 quad_perm:[2,3,0,1] row_mask:0xf bank_mask:0xf
    v_max_u32 v49, v49, v50
    s_nop 0
    v_min_u32_dpp v50, v48, v48 row_half_mirror row_mask:0xf bank_mask:0xf
    v_max_u32_dpp v49, v49, v49 row_half_mirror row_mask:0xf bank_mask:0xf
    v_max_u32_dpp v48, v48, v48 row_half_mirror row_mask:0xf bank_mask:0xf
    v_max_u32 v49, v49, v50
    v_or_b32 v50, 1, v49
    v_mov_b32 v49, s4
    v_mov_b32 v51, s4
    s_cmp_lg_u32 s3, 0
    s_cbranch_scc1 L_NOF
    s_mov_b64 exec, 0xffff
    buffer_store_dwordx4 v[48:51], v6, s[32:35], s14 offen sc1
    s_mov_b64 exec, -1
L_NOF:
    s_cmp_lg_u32 s3, 1
    s_cbranch_scc1 L_NOC
    v_and_b32 v4, 16, v1
    v_cmp_eq_u32 vcc, 0, v4
    s_nop 1
    v_cndmask_b32 v4, v50, v48, vcc
    v_not_b32 v4, v4
    v_bfe_u32 v4, v4, 1, 7
    v_lshlrev_b32 v6, 3, v4
    v_mul_u32_u24 v4, 144, v4
    v_add_u32 v6, 135168, v6
    v_and_b32 v5, 15, v1
    v_lshlrev_b32 v5, 3, v5
    v_add_u32 v4, v4, v5
    ds_read_b64 v[128:129], v6
    ds_read_b64 v[124:125], v4 offset:0
    v_and_b32 v6, 15, v1
    v_lshlrev_b32 v6, 4, v6
    v_bfe_u32 v9, v1, 4, 1
    v_lshl_add_u32 v6, v9, 14, v6
    v_lshrrev_b32 v9, 5, v1
    v_lshl_add_u32 v6, v9, 12, v6
    v_bfe_u32 v7, v1, 4, 1
    v_lshlrev_b32 v7, 14, v7
    s_lshl_b32 s96, s21, 15
    s_lshl_b32 s97, s12, 8
    s_add_u32 s98, s96, s97
    s_add_u32 s13, s98, 33554432
    s_lshl_b32 s96, s21, 15
    s_lshl3_add_u32 s97, s12, s96
    s_add_u32 s98, s97, 8192
    s_add_u32 s16, s98, 33554432
    v_mov_b32 v127, s4
    s_waitcnt lgkmcnt(0)
    v_lshlrev_b32 v132, 16, v124
    v_and_b32 v133, s6, v124
    v_lshlrev_b32 v134, 16, v125
    v_and_b32 v135, s6, v125
    v_pk_add_f32 v[132:133], v[132:133], v[128:129] op_sel_hi:[1,0] neg_lo:[0,1] neg_hi:[0,1]
    v_pk_add_f32 v[134:135], v[134:135], v[128:129] op_sel_hi:[1,0] neg_lo:[0,1] neg_hi:[0,1]
    v_cvt_pk_bf16_f32 v132, 0, v132
    v_cvt_pk_bf16_f32 v133, 0, v133
    v_cvt_pk_bf16_f32 v134, 0, v134
    v_cvt_pk_bf16_f32 v135, 0, v135
    v_pk_mul_f32 v[132:133], v[132:133], v[128:129] op_sel:[0,1]
    v_pk_mul_f32 v[134:135], v[134:135], v[128:129] op_sel:[0,1]
    v_cvt_pk_bf16_f32 v132, 0, v132
    v_cvt_pk_bf16_f32 v133, 0, v133
    v_cvt_pk_bf16_f32 v134, 0, v134
    v_cvt_pk_bf16_f32 v135, 0, v135
    v_pk_mul_f32 v[132:133], v[132:133], v[152:153]
    v_pk_mul_f32 v[134:135], v[134:135], v[154:155]
    v_cvt_pk_bf16_f32 v132, 0, v132
    v_cvt_pk_bf16_f32 v133, 0, v133
    v_cvt_pk_bf16_f32 v134, 0, v134
    v_cvt_pk_bf16_f32 v135, 0, v135
    v_pk_add_f32 v[132:133], v[132:133], v[148:149]
    v_pk_add_f32 v[134:135], v[134:135], v[150:151]
    v_mov_b32 v126, v125
    v_mov_b32 v125, s4
    s_mov_b32 exec_hi, 0
    v_cvt_pk_bf16_f32 v124, v132, v133
    v_cvt_pk_bf16_f32 v126, v134, v135
    s_mov_b32 exec_hi, -1
    v_dot2_f32_bf16 v128, v124, v156, 0
    v_mov_b32 v129, s4
    v_dot2_f32_bf16 v128, v126, v157, v128
    buffer_store_dwordx4 v[124:127], v6, s[32:35], s13 offen sc1
    s_nop 1
    v_add_f32_dpp v128, v128, v128 quad_perm:[1,0,3,2] row_mask:0xf bank_mask:0xf
    s_nop 1
    v_add_f32_dpp v128, v128, v128 quad_perm:[2,3,0,1] row_mask:0xf bank_mask:0xf
    s_nop 1
    v_add_f32_dpp v128, v128, v128 row_half_mirror row_mask:0xf bank_mask:0xf
    s_nop 1
    v_add_f32_dpp v128, v128, v128 row_ror:8 row_mask:0xf bank_mask:0xf
    s_mov_b64 exec, 0x10001
    buffer_store_dwordx2 v[128:129], v7, s[32:35], s16 offen sc1
    s_mov_b64 exec, -1
L_NOC:
    s_waitcnt lgkmcnt(0)
    s_mov_b32 exec_lo, 0xff
    s_mov_b32 exec_hi, 0xff
    buffer_store_dwordx2 v[224:225], v226, s[32:35], 0 offen sc1
    s_mov_b64 exec, -1
    s_add_u32 s13, s81, 4096
    s_lshl2_add_u32 m0, s89, 99328
    s_nop 0
    buffer_load_dwordx4 v73, s[60:63], s13 offen nt lds
    s_add_u32 s13, s81, 8192
    s_lshl2_add_u32 m0, s89, 100352
    s_nop 0
    buffer_load_dwordx4 v73, s[60:63], s13 offen nt lds
    s_add_u32 s13, s81, 12288
    s_lshl2_add_u32 m0, s89, 101376
    s_nop 0
    buffer_load_dwordx4 v73, s[60:63], s13 offen nt lds
    s_load_dwordx8 s[24:31], s[32:33], s92 offset:2560 glc
    v_pk_add_f32 v[76:77], v[28:29], v[20:21] op_sel_hi:[1,0] neg_lo:[0,1] neg_hi:[0,1]
    v_pk_add_f32 v[78:79], v[30:31], v[20:21] op_sel_hi:[1,0] neg_lo:[0,1] neg_hi:[0,1]
    v_pk_add_f32 v[80:81], v[32:33], v[20:21] op_sel_hi:[1,0] neg_lo:[0,1] neg_hi:[0,1]
    v_pk_add_f32 v[82:83], v[34:35], v[20:21] op_sel_hi:[1,0] neg_lo:[0,1] neg_hi:[0,1]
    v_pk_add_f32 v[84:85], v[36:37], v[20:21] op_sel_hi:[1,0] neg_lo:[0,1] neg_hi:[0,1]
    v_pk_add_f32 v[86:87], v[38:39], v[20:21] op_sel_hi:[1,0] neg_lo:[0,1] neg_hi:[0,1]
    v_pk_add_f32 v[88:89], v[40:41], v[20:21] op_sel_hi:[1,0] neg_lo:[0,1] neg_hi:[0,1]
    v_pk_add_f32 v[90:91], v[42:43], v[20:21] op_sel_hi:[1,0] neg_lo:[0,1] neg_hi:[0,1]
    v_cvt_pk_bf16_f32 v76, 0, v76
    v_cvt_pk_bf16_f32 v77, 0, v77
    v_cvt_pk_bf16_f32 v78, 0, v78
    v_cvt_pk_bf16_f32 v79, 0, v79
    v_cvt_pk_bf16_f32 v80, 0, v80
    v_cvt_pk_bf16_f32 v81, 0, v81
    v_cvt_pk_bf16_f32 v82, 0, v82
    v_cvt_pk_bf16_f32 v83, 0, v83
    v_cvt_pk_bf16_f32 v84, 0, v84
    v_cvt_pk_bf16_f32 v85, 0, v85
    v_cvt_pk_bf16_f32 v86, 0, v86
    v_cvt_pk_bf16_f32 v87, 0, v87
    v_cvt_pk_bf16_f32 v88, 0, v88
    v_cvt_pk_bf16_f32 v89, 0, v89
    v_cvt_pk_bf16_f32 v90, 0, v90
    v_cvt_pk_bf16_f32 v91, 0, v91
    v_pk_mul_f32 v[76:77], v[76:77], v[20:21] op_sel:[0,1]
    v_pk_mul_f32 v[78:79], v[78:79], v[20:21] op_sel:[0,1]
    v_pk_mul_f32 v[80:81], v[80:81], v[20:21] op_sel:[0,1]
    v_pk_mul_f32 v[82:83], v[82:83], v[20:21] op_sel:[0,1]
    v_pk_mul_f32 v[84:85], v[84:85], v[20:21] op_sel:[0,1]
    v_pk_mul_f32 v[86:87], v[86:87], v[20:21] op_sel:[0,1]
    v_pk_mul_f32 v[88:89], v[88:89], v[20:21] op_sel:[0,1]
    v_pk_mul_f32 v[90:91], v[90:91], v[20:21] op_sel:[0,1]
    v_cvt_pk_bf16_f32 v76, 0, v76
    v_cvt_pk_bf16_f32 v77, 0, v77
    v_cvt_pk_bf16_f32 v78, 0, v78
    v_cvt_pk_bf16_f32 v79, 0, v79
    v_cvt_pk_bf16_f32 v80, 0, v80
    v_cvt_pk_bf16_f32 v81, 0, v81
    v_cvt_pk_bf16_f32 v82, 0, v82
    v_cvt_pk_bf16_f32 v83, 0, v83
    v_cvt_pk_bf16_f32 v84, 0, v84
    v_cvt_pk_bf16_f32 v85, 0, v85
    v_cvt_pk_bf16_f32 v86, 0, v86
    v_cvt_pk_bf16_f32 v87, 0, v87
    v_cvt_pk_bf16_f32 v88, 0, v88
    v_cvt_pk_bf16_f32 v89, 0, v89
    v_cvt_pk_bf16_f32 v90, 0, v90
    v_cvt_pk_bf16_f32 v91, 0, v91
    v_pk_mul_f32 v[76:77], v[76:77], v[108:109]
    v_pk_mul_f32 v[78:79], v[78:79], v[110:111]
    v_pk_mul_f32 v[80:81], v[80:81], v[112:113]
    v_pk_mul_f32 v[82:83], v[82:83], v[114:115]
    v_pk_mul_f32 v[84:85], v[84:85], v[116:117]
    v_pk_mul_f32 v[86:87], v[86:87], v[118:119]
    v_pk_mul_f32 v[88:89], v[88:89], v[120:121]
    v_pk_mul_f32 v[90:91], v[90:91], v[122:123]
    v_cvt_pk_bf16_f32 v76, 0, v76
    v_cvt_pk_bf16_f32 v77, 0, v77
    v_cvt_pk_bf16_f32 v78, 0, v78
    v_cvt_pk_bf16_f32 v79, 0, v79
    v_cvt_pk_bf16_f32 v80, 0, v80
    v_cvt_pk_bf16_f32 v81, 0, v81
    v_cvt_pk_bf16_f32 v82, 0, v82
    v_cvt_pk_bf16_f32 v83, 0, v83
    v_cvt_pk_bf16_f32 v84, 0, v84
    v_cvt_pk_bf16_f32 v85, 0, v85
    v_cvt_pk_bf16_f32 v86, 0, v86
    v_cvt_pk_bf16_f32 v87, 0, v87
    v_cvt_pk_bf16_f32 v88, 0, v88
    v_cvt_pk_bf16_f32 v89, 0, v89
    v_cvt_pk_bf16_f32 v90, 0, v90
    v_cvt_pk_bf16_f32 v91, 0, v91
    v_pk_add_f32 v[76:77], v[76:77], v[92:93]
    v_pk_add_f32 v[78:79], v[78:79], v[94:95]
    v_pk_add_f32 v[80:81], v[80:81], v[96:97]
    v_pk_add_f32 v[82:83], v[82:83], v[98:99]
    v_pk_add_f32 v[84:85], v[84:85], v[100:101]
    v_pk_add_f32 v[86:87], v[86:87], v[102:103]
    v_pk_add_f32 v[88:89], v[88:89], v[104:105]
    v_pk_add_f32 v[90:91], v[90:91], v[106:107]
    v_cvt_pk_bf16_f32 v76, 0, v76
    v_cvt_pk_bf16_f32 v77, 0, v77
    v_cvt_pk_bf16_f32 v78, 0, v78
    v_cvt_pk_bf16_f32 v79, 0, v79
    v_cvt_pk_bf16_f32 v80, 0, v80
    v_cvt_pk_bf16_f32 v81, 0, v81
    v_cvt_pk_bf16_f32 v82, 0, v82
    v_cvt_pk_bf16_f32 v83, 0, v83
    v_cvt_pk_bf16_f32 v84, 0, v84
    v_cvt_pk_bf16_f32 v85, 0, v85
    v_cvt_pk_bf16_f32 v86, 0, v86
    v_cvt_pk_bf16_f32 v87, 0, v87
    v_cvt_pk_bf16_f32 v88, 0, v88
    v_cvt_pk_bf16_f32 v89, 0, v89
    v_cvt_pk_bf16_f32 v90, 0, v90
    v_cvt_pk_bf16_f32 v91, 0, v91
    s_lshr_b32 s96, s3, 2
    s_lshl_b32 s97, s96, 15
    s_and_b32 s98, s3, 3
    s_lshl_b32 s99, s98, 5
    s_add_u32 s96, s97, s99
    s_add_u32 s13, s96, 32768
    v_lshrrev_b32 v24, 4, v1
    v_lshlrev_b32 v24, 13, v24
    v_bfe_u32 v9, v1, 2, 2
    v_lshl_add_u32 v24, v9, 7, v24
    v_bfe_u32 v9, v1, 3, 2
    v_lshl_add_u32 v24, v9, 5, v24
    v_and_b32 v9, 3, v1
    v_lshl_add_u32 v24, v9, 3, v24
    v_xor_b32 v24, s13, v24
    s_lshl_b32 s13, s3, 6
    v_bfe_u32 v45, v1, 2, 1
    v_lshlrev_b32 v45, 9, v45
    v_bfe_u32 v9, v1, 3, 1
    v_lshl_add_u32 v45, v9, 12, v45
    v_lshrrev_b32 v9, 5, v1
    v_lshl_add_u32 v45, v9, 11, v45
    v_bfe_u32 v9, v1, 2, 2
    v_lshl_add_u32 v45, v9, 6, v45
    v_bfe_u32 v9, v1, 4, 1
    v_lshl_add_u32 v45, v9, 5, v45
    v_and_b32 v9, 3, v1
    v_lshl_add_u32 v45, v9, 3, v45
    v_xor_b32 v45, s13, v45
    v_add_u32 v45, 98304, v45
    v_and_b32 v46, 7, v1
    v_lshlrev_b32 v46, 4, v46
    v_lshrrev_b32 v9, 4, v1
    v_lshl_add_u32 v46, v9, 7, v46
    v_add_u32 v46, 136704, v46
    s_lshl4_add_u32 s13, s3, 136256
    v_mov_b32 v4, s13
    v_and_b32 v5, 7, v1
    v_lshlrev_b32 v5, 4, v5
    v_add_u32 v5, 136256, v5
    v_and_b32 v8, 8, v1
    v_cmp_eq_u32 s[22:23], 0, v8
    s_branch SCHK_46
SPOLL_45:
    s_load_dwordx8 s[24:31], s[32:33], s92 offset:2560 glc
SCHK_46:
    s_add_u32 s5, s5, 1
    s_cmp_ge_u32 s5, 300000
    s_waitcnt lgkmcnt(0)
    s_cbranch_scc1 SDONE_47
    s_cmp_lg_u32 s25, s4
    s_cbranch_scc1 SPOLL_45
    s_cmp_lg_u32 s27, s4
    s_cbranch_scc1 SPOLL_45
    s_cmp_lg_u32 s29, s4
    s_cbranch_scc1 SPOLL_45
    s_cmp_lg_u32 s31, s4
    s_cbranch_scc1 SPOLL_45
SDONE_47:
    s_min_u32 s25, s24, s28
    s_max_u32 s24, s24, s28
    s_max_u32 s27, s26, s30
    s_min_u32 s26, s26, s30
    s_max_u32 s28, s25, s27
    s_min_u32 s25, s25, s27
    v_mov_b32 v148, s24
    v_mov_b32 v151, s26
    v_mov_b32 v149, s28
    v_mov_b32 v150, s25
    ds_write_b128 v4, v[148:151]
    s_waitcnt lgkmcnt(0)
    s_barrier
    s_cmp_lt_u32 s3, 4
    s_cbranch_scc1 L_CSEL
    ds_read_b64_tr_b16 v[164:165], v24
    ds_read_b64_tr_b16 v[166:167], v24 offset:512
    ds_read_b64_tr_b16 v[168:169], v24 offset:1024
    ds_read_b64_tr_b16 v[170:171], v24 offset:1536
    ds_read_b64_tr_b16 v[172:173], v24 offset:2048
    ds_read_b64_tr_b16 v[174:175], v24 offset:2560
    ds_read_b64_tr_b16 v[176:177], v24 offset:3072
    ds_read_b64_tr_b16 v[178:179], v24 offset:3584
    ds_read_b64_tr_b16 v[180:181], v24 offset:4096
    ds_read_b64_tr_b16 v[182:183], v24 offset:4608
    ds_read_b64_tr_b16 v[184:185], v24 offset:5120
    ds_read_b64_tr_b16 v[186:187], v24 offset:5632
    ds_read_b64_tr_b16 v[188:189], v24 offset:6144
    ds_read_b64_tr_b16 v[190:191], v24 offset:6656
    ds_read_b64_tr_b16 v[192:193], v24 offset:7168
    ds_read_b64_tr_b16 v[194:195], v24 offset:7680
    v_mul_u32_u24_dpp v92, v70, v52 row_newbcast:0 row_mask:0xf bank_mask:0xf
    v_and_b32_dpp v93, v70, v53 row_newbcast:0 row_mask:0xf bank_mask:0xf
    v_mul_u32_u24_dpp v94, v70, v52 row_newbcast:1 row_mask:0xf bank_mask:0xf
    v_and_b32_dpp v95, v70, v53 row_newbcast:1 row_mask:0xf bank_mask:0xf
    v_mul_u32_u24_dpp v96, v70, v52 row_newbcast:2 row_mask:0xf bank_mask:0xf
    v_and_b32_dpp v97, v70, v53 row_newbcast:2 row_mask:0xf bank_mask:0xf
    v_mul_u32_u24_dpp v98, v70, v52 row_newbcast:3 row_mask:0xf bank_mask:0xf
    v_and_b32_dpp v99, v70, v53 row_newbcast:3 row_mask:0xf bank_mask:0xf
    v_mul_u32_u24_dpp v100, v70, v52 row_newbcast:4 row_mask:0xf bank_mask:0xf
    v_and_b32_dpp v101, v70, v53 row_newbcast:4 row_mask:0xf bank_mask:0xf
    v_mul_u32_u24_dpp v102, v70, v52 row_newbcast:5 row_mask:0xf bank_mask:0xf
    v_and_b32_dpp v103, v70, v53 row_newbcast:5 row_mask:0xf bank_mask:0xf
    v_mul_u32_u24_dpp v104, v70, v52 row_newbcast:6 row_mask:0xf bank_mask:0xf
    v_and_b32_dpp v105, v70, v53 row_newbcast:6 row_mask:0xf bank_mask:0xf
    v_mul_u32_u24_dpp v106, v70, v52 row_newbcast:7 row_mask:0xf bank_mask:0xf
    v_and_b32_dpp v107, v70, v53 row_newbcast:7 row_mask:0xf bank_mask:0xf
    v_pk_mul_f32 v[76:77], v[76:77], v[92:93]
    v_pk_mul_f32 v[78:79], v[78:79], v[94:95]
    v_pk_mul_f32 v[80:81], v[80:81], v[96:97]
    v_pk_mul_f32 v[82:83], v[82:83], v[98:99]
    v_pk_mul_f32 v[84:85], v[84:85], v[100:101]
    v_pk_mul_f32 v[86:87], v[86:87], v[102:103]
    v_pk_mul_f32 v[88:89], v[88:89], v[104:105]
    v_pk_mul_f32 v[90:91], v[90:91], v[106:107]
    v_cvt_pk_bf16_f32 v76, 0, v76
    v_cvt_pk_bf16_f32 v77, 0, v77
    v_cvt_pk_bf16_f32 v78, 0, v78
    v_cvt_pk_bf16_f32 v79, 0, v79
    v_cvt_pk_bf16_f32 v80, 0, v80
    v_cvt_pk_bf16_f32 v81, 0, v81
    v_cvt_pk_bf16_f32 v82, 0, v82
    v_cvt_pk_bf16_f32 v83, 0, v83
    v_cvt_pk_bf16_f32 v84, 0, v84
    v_cvt_pk_bf16_f32 v85, 0, v85
    v_cvt_pk_bf16_f32 v86, 0, v86
    v_cvt_pk_bf16_f32 v87, 0, v87
    v_cvt_pk_bf16_f32 v88, 0, v88
    v_cvt_pk_bf16_f32 v89, 0, v89
    v_cvt_pk_bf16_f32 v90, 0, v90
    v_cvt_pk_bf16_f32 v91, 0, v91
    v_pk_add_f32 v[76:77], v[76:77], v[28:29]
    v_pk_add_f32 v[78:79], v[78:79], v[30:31]
    v_pk_add_f32 v[80:81], v[80:81], v[32:33]
    v_pk_add_f32 v[82:83], v[82:83], v[34:35]
    v_pk_add_f32 v[84:85], v[84:85], v[36:37]
    v_pk_add_f32 v[86:87], v[86:87], v[38:39]
    v_pk_add_f32 v[88:89], v[88:89], v[40:41]
    v_pk_add_f32 v[90:91], v[90:91], v[42:43]
    v_cvt_pk_bf16_f32 v140, v76, v77
    v_cvt_pk_bf16_f32 v141, v78, v79
    v_cvt_pk_bf16_f32 v142, v80, v81
    v_cvt_pk_bf16_f32 v143, v82, v83
    v_cvt_pk_bf16_f32 v144, v84, v85
    v_cvt_pk_bf16_f32 v145, v86, v87
    v_cvt_pk_bf16_f32 v146, v88, v89
    v_cvt_pk_bf16_f32 v147, v90, v91
    ds_write_b128 v23, v[140:143]
    ds_write_b128 v23, v[144:147] offset:16
    s_mul_i32 s96, s3, 2304
    s_add_u32 s16, s96, 139776
    v_lshrrev_b32 v23, 3, v1
    v_mul_u32_u24 v23, 144, v23
    v_and_b32 v9, 7, v1
    v_lshl_add_u32 v23, v9, 4, v23
    v_add_u32 v23, s16, v23
    s_branch L_CSELD
L_CSEL:
    ds_read_b128 v[148:151], v5
    s_lshl_b32 s96, s3, 9
    s_add_u32 s13, s96, 136704
    v_add_u32 v6, s13, v63
    s_lshl2_add_u32 s13, s3, 136384
    v_mov_b32 v7, s13
    s_waitcnt lgkmcnt(0)
    v_max_u32_dpp v152, v151, v148 quad_perm:[1,0,3,2] row_mask:0xf bank_mask:0xf
    v_max_u32_dpp v153, v150, v149 quad_perm:[1,0,3,2] row_mask:0xf bank_mask:0xf
    v_max_u32_dpp v154, v149, v150 quad_perm:[1,0,3,2] row_mask:0xf bank_mask:0xf
    v_max_u32_dpp v155, v148, v151 quad_perm:[1,0,3,2] row_mask:0xf bank_mask:0xf
    v_max_u32 v156, v152, v154
    v_max_u32 v157, v153, v155
    v_min_u32 v158, v152, v154
    v_min_u32 v159, v153, v155
    v_max_u32 v148, v156, v157
    v_min_u32 v149, v156, v157
    v_max_u32 v150, v158, v159
    v_min_u32 v151, v158, v159
    s_nop 1
    v_max_u32_dpp v152, v151, v148 quad_perm:[2,3,0,1] row_mask:0xf bank_mask:0xf
    v_max_u32_dpp v153, v150, v149 quad_perm:[2,3,0,1] row_mask:0xf bank_mask:0xf
    v_max_u32_dpp v154, v149, v150 quad_perm:[2,3,0,1] row_mask:0xf bank_mask:0xf
    v_max_u32_dpp v155, v148, v151 quad_perm:[2,3,0,1] row_mask:0xf bank_mask:0xf
    v_max_u32 v156, v152, v154
    v_max_u32 v157, v153, v155
    v_min_u32 v158, v152, v154
    v_min_u32 v159, v153, v155
    v_max_u32 v148, v156, v157
    v_min_u32 v149, v156, v157
    v_max_u32 v150, v158, v159
    v_min_u32 v151, v158, v159
    s_nop 1
    v_max_u32_dpp v152, v151, v148 row_half_mirror row_mask:0xf bank_mask:0xf
    v_max_u32_dpp v153, v150, v149 row_half_mirror row_mask:0xf bank_mask:0xf
    v_max_u32_dpp v154, v149, v150 row_half_mirror row_mask:0xf bank_mask:0xf
    v_max_u32_dpp v155, v148, v151 row_half_mirror row_mask:0xf bank_mask:0xf
    v_readfirstlane_b32 s24, v152
    v_readfirstlane_b32 s25, v153
    v_readfirstlane_b32 s26, v154
    v_readfirstlane_b32 s27, v155
    s_bitcmp1_b32 s3, 0
    s_cselect_b32 s24, s25, s24
    s_cselect_b32 s26, s27, s26
    s_bitcmp1_b32 s3, 1
    s_cselect_b32 s24, s26, s24
    s_and_b32 s15, s24, 4095
    s_lshr_b32 s96, s15, 8
    s_sub_u32 s97, 15, s96
    s_and_b32 s98, s15, 1
    s_lshl1_add_u32 s99, s97, s98
    s_lshl_b32 s96, s99, 14
    s_add_u32 s13, s96, 33554432
    s_lshl_b32 s96, s75, 10
    s_add_u32 s14, s96, s13
    s_add_u32 s13, s13, 8192
    v_and_b32 v10, 15, v1
    v_lshlrev_b32 v10, 3, v10
    buffer_load_dwordx2 v[152:153], v10, s[32:35], s13 offen sc1
    buffer_load_dwordx4 v[148:151], v2, s[32:35], s14 offen sc1
    ds_read_b64_tr_b16 v[164:165], v24
    ds_read_b64_tr_b16 v[166:167], v24 offset:512
    ds_read_b64_tr_b16 v[168:169], v24 offset:1024
    ds_read_b64_tr_b16 v[170:171], v24 offset:1536
    ds_read_b64_tr_b16 v[172:173], v24 offset:2048
    ds_read_b64_tr_b16 v[174:175], v24 offset:2560
    ds_read_b64_tr_b16 v[176:177], v24 offset:3072
    ds_read_b64_tr_b16 v[178:179], v24 offset:3584
    ds_read_b64_tr_b16 v[180:181], v24 offset:4096
    ds_read_b64_tr_b16 v[182:183], v24 offset:4608
    ds_read_b64_tr_b16 v[184:185], v24 offset:5120
    ds_read_b64_tr_b16 v[186:187], v24 offset:5632
    ds_read_b64_tr_b16 v[188:189], v24 offset:6144
    ds_read_b64_tr_b16 v[190:191], v24 offset:6656
    ds_read_b64_tr_b16 v[192:193], v24 offset:7168
    ds_read_b64_tr_b16 v[194:195], v24 offset:7680
    v_mul_u32_u24_dpp v92, v70, v52 row_newbcast:0 row_mask:0xf bank_mask:0xf
    v_and_b32_dpp v93, v70, v53 row_newbcast:0 row_mask:0xf bank_mask:0xf
    v_mul_u32_u24_dpp v94, v70, v52 row_newbcast:1 row_mask:0xf bank_mask:0xf
    v_and_b32_dpp v95, v70, v53 row_newbcast:1 row_mask:0xf bank_mask:0xf
    v_mul_u32_u24_dpp v96, v70, v52 row_newbcast:2 row_mask:0xf bank_mask:0xf
    v_and_b32_dpp v97, v70, v53 row_newbcast:2 row_mask:0xf bank_mask:0xf
    v_mul_u32_u24_dpp v98, v70, v52 row_newbcast:3 row_mask:0xf bank_mask:0xf
    v_and_b32_dpp v99, v70, v53 row_newbcast:3 row_mask:0xf bank_mask:0xf
    v_mul_u32_u24_dpp v100, v70, v52 row_newbcast:4 row_mask:0xf bank_mask:0xf
    v_and_b32_dpp v101, v70, v53 row_newbcast:4 row_mask:0xf bank_mask:0xf
    v_mul_u32_u24_dpp v102, v70, v52 row_newbcast:5 row_mask:0xf bank_mask:0xf
    v_and_b32_dpp v103, v70, v53 row_newbcast:5 row_mask:0xf bank_mask:0xf
    v_mul_u32_u24_dpp v104, v70, v52 row_newbcast:6 row_mask:0xf bank_mask:0xf
    v_and_b32_dpp v105, v70, v53 row_newbcast:6 row_mask:0xf bank_mask:0xf
    v_mul_u32_u24_dpp v106, v70, v52 row_newbcast:7 row_mask:0xf bank_mask:0xf
    v_and_b32_dpp v107, v70, v53 row_newbcast:7 row_mask:0xf bank_mask:0xf
    v_pk_mul_f32 v[76:77], v[76:77], v[92:93]
    v_pk_mul_f32 v[78:79], v[78:79], v[94:95]
    v_pk_mul_f32 v[80:81], v[80:81], v[96:97]
    v_pk_mul_f32 v[82:83], v[82:83], v[98:99]
    v_pk_mul_f32 v[84:85], v[84:85], v[100:101]
    v_pk_mul_f32 v[86:87], v[86:87], v[102:103]
    v_pk_mul_f32 v[88:89], v[88:89], v[104:105]
    v_pk_mul_f32 v[90:91], v[90:91], v[106:107]
    v_cvt_pk_bf16_f32 v76, 0, v76
    v_cvt_pk_bf16_f32 v77, 0, v77
    v_cvt_pk_bf16_f32 v78, 0, v78
    v_cvt_pk_bf16_f32 v79, 0, v79
    v_cvt_pk_bf16_f32 v80, 0, v80
    v_cvt_pk_bf16_f32 v81, 0, v81
    v_cvt_pk_bf16_f32 v82, 0, v82
    v_cvt_pk_bf16_f32 v83, 0, v83
    v_cvt_pk_bf16_f32 v84, 0, v84
    v_cvt_pk_bf16_f32 v85, 0, v85
    v_cvt_pk_bf16_f32 v86, 0, v86
    v_cvt_pk_bf16_f32 v87, 0, v87
    v_cvt_pk_bf16_f32 v88, 0, v88
    v_cvt_pk_bf16_f32 v89, 0, v89
    v_cvt_pk_bf16_f32 v90, 0, v90
    v_cvt_pk_bf16_f32 v91, 0, v91
    v_pk_add_f32 v[76:77], v[76:77], v[28:29]
    v_pk_add_f32 v[78:79], v[78:79], v[30:31]
    v_pk_add_f32 v[80:81], v[80:81], v[32:33]
    v_pk_add_f32 v[82:83], v[82:83], v[34:35]
    v_pk_add_f32 v[84:85], v[84:85], v[36:37]
    v_pk_add_f32 v[86:87], v[86:87], v[38:39]
    v_pk_add_f32 v[88:89], v[88:89], v[40:41]
    v_pk_add_f32 v[90:91], v[90:91], v[42:43]
    v_cvt_pk_bf16_f32 v140, v76, v77
    v_cvt_pk_bf16_f32 v141, v78, v79
    v_cvt_pk_bf16_f32 v142, v80, v81
    v_cvt_pk_bf16_f32 v143, v82, v83
    v_cvt_pk_bf16_f32 v144, v84, v85
    v_cvt_pk_bf16_f32 v145, v86, v87
    v_cvt_pk_bf16_f32 v146, v88, v89
    v_cvt_pk_bf16_f32 v147, v90, v91
    ds_write_b128 v23, v[140:143]
    ds_write_b128 v23, v[144:147] offset:16
    s_mul_i32 s96, s3, 2304
    s_add_u32 s16, s96, 139776
    v_lshrrev_b32 v23, 3, v1
    v_mul_u32_u24 v23, 144, v23
    v_and_b32 v9, 7, v1
    v_lshl_add_u32 v23, v9, 4, v23
    v_add_u32 v23, s16, v23
    s_lshl2_add_u32 s15, s15, s3
    s_waitcnt vmcnt(0)
    v_bitop3_b32 v8, v149, v151, s4 bitop3:0x7e
    v_bitop3_b32 v8, v8, v153, s4 bitop3:0xf6
    v_cmp_ne_u32 vcc, 0, v8
    s_cbranch_vccz TOK_49
POLL_50:
    buffer_load_dwordx2 v[152:153], v10, s[32:35], s13 offen sc1
    buffer_load_dwordx4 v[148:151], v2, s[32:35], s14 offen sc1
    s_waitcnt vmcnt(0)
    v_bitop3_b32 v8, v149, v151, s4 bitop3:0x7e
    v_bitop3_b32 v8, v8, v153, s4 bitop3:0xf6
    v_cmp_ne_u32 vcc, 0, v8
    s_cbranch_vccz PDONE_51
    s_add_u32 s5, s5, 1
    s_cmp_lt_u32 s5, 300000
    s_cbranch_scc1 POLL_50
PDONE_51:
TOK_49:
    ds_write2_b32 v6, v148, v150 offset0:0 offset1:1
    v_add_f32_dpp v152, v152, v152 quad_perm:[1,0,3,2] row_mask:0xf bank_mask:0xf
    s_nop 1
    v_add_f32_dpp v152, v152, v152 quad_perm:[2,3,0,1] row_mask:0xf bank_mask:0xf
    s_nop 1
    v_add_f32_dpp v152, v152, v152 row_half_mirror row_mask:0xf bank_mask:0xf
    s_nop 1
    v_add_f32_dpp v152, v152, v152 row_ror:8 row_mask:0xf bank_mask:0xf
    v_cvt_pk_bf16_f32 v152, 0, v152
    v_ashrrev_i32 v153, 31, v152
    v_or_b32 v153, 0x80000000, v153
    v_xor_b32 v152, v152, v153
    v_and_b32 v152, s6, v152
    v_or_b32 v152, s15, v152
    ds_write_b32 v7, v152
L_CSELD:
    v_mov_b32 v4, 136384
    v_and_b32 v8, 15, v1
    v_lshlrev_b32 v8, 4, v8
    v_lshrrev_b32 v9, 5, v1
    v_lshl_add_u32 v8, v9, 3, v8
    s_lshl_b32 s96, s74, 13
    s_add_u32 s14, s96, 20971520
    s_lshl3_add_u32 s96, s75, s3
    s_lshl_b32 s97, s96, 8
    s_add_u32 s20, s97, s14
    s_waitcnt lgkmcnt(0)
    s_barrier
    ds_read_b128 v[148:151], v4
    s_waitcnt lgkmcnt(0)
    v_max_u32 v152, v148, v149
    v_max_u32 v153, v150, v151
    v_min_u32 v154, v148, v149
    v_min_u32 v155, v150, v151
    v_min_u32 v149, v152, v153
    v_max_u32 v148, v152, v153
    v_max3_u32 v149, v149, v154, v155
    v_cndmask_b32 v4, v149, v148, s[22:23]
    v_readfirstlane_b32 s68, v148
    v_and_b32 v4, 3, v4
    v_readfirstlane_b32 s69, v149
    v_lshl_add_u32 v4, v4, 9, v46
    ds_read_b128 v[152:155], v4
    ds_read_b128 v[140:143], v23
    ds_read_b128 v[144:147], v23 offset:1152
    s_bfe_u32 s70, s68, 720899
    s_bfe_u32 s71, s69, 720899
    s_sub_u32 s70, 2047, s70
    s_sub_u32 s71, 2047, s71
    s_waitcnt lgkmcnt(2)
    v_mfma_f32_16x16x32_bf16 v[212:215], v[152:155], v[164:167], 0
    v_mfma_f32_16x16x32_bf16 v[216:219], v[152:155], v[168:171], 0
    v_mfma_f32_16x16x32_bf16 v[220:223], v[152:155], v[172:175], 0
    v_mfma_f32_16x16x32_bf16 v[224:227], v[152:155], v[176:179], 0
    v_mfma_f32_16x16x32_bf16 v[228:231], v[152:155], v[180:183], 0
    v_mfma_f32_16x16x32_bf16 v[232:235], v[152:155], v[184:187], 0
    v_mfma_f32_16x16x32_bf16 v[236:239], v[152:155], v[188:191], 0
    v_mfma_f32_16x16x32_bf16 v[240:243], v[152:155], v[192:195], 0
    s_nop 1
    v_add_f32 v148, v212, v217
    s_nop 0
    v_add_f32 v149, v222, v227
    s_nop 0
    v_add_f32 v150, v228, v233
    s_nop 0
    v_add_f32 v151, v238, v243
    v_add_f32 v148, v148, v149
    v_add_f32 v150, v150, v151
    v_mov_b32 v149, s4
    s_nop 0
    v_permlane16_swap_b32 v150, v151
    s_cmp_ge_u32 s9, 28
    s_cbranch_scc1 L_NOHP
    v_add_f32 v148, v148, v151
    s_mov_b32 exec_lo, 0xffff
    s_mov_b32 exec_hi, 0xffff
    s_cmp_lg_u32 s93, 0
    s_cbranch_scc1 LOC_52
    buffer_store_dwordx2 v[148:149], v8, s[32:35], s20 offen sc1
    s_branch LOCD_53
LOC_52:
    buffer_store_dwordx2 v[148:149], v8, s[32:35], s20 offen
LOCD_53:
    s_mov_b64 exec, -1
L_NOHP:
    v_mov_b32 v56, v148
    v_mov_b32 v57, v149
    v_add_u32 v58, s20, v8
    s_waitcnt lgkmcnt(0)
    s_bitcmp1_b32 s21, 2
    s_cselect_b32 s17, s71, s70
    s_cselect_b32 s18, s69, s68
    s_cmp_lg_u32 s3, 7
    s_cbranch_scc1 L_NOFZ
    s_cmp_lg_u32 s2, 0
    s_cbranch_scc1 L_NONON
    v_mov_b32 v6, s4
    s_mov_b64 exec, 1
    buffer_store_dword v6, v3, s[32:35], 0 offen sc1
    s_mov_b64 exec, -1
L_NONON:
    s_lshr_b32 s96, s21, 3
    s_and_b32 s97, s21, 1
    s_lshl1_add_u32 s19, s96, s97
    s_lshr_b32 s96, s21, 2
    s_lshl_b32 s97, s96, 1
    s_lshl3_add_u32 s98, s12, s97
    s_and_b32 s99, s21, 1
    s_add_u32 s96, s98, s99
    s_mul_i32 s97, s96, 7168
    s_add_u32 s20, s97, 22020096
    s_lshl_b32 s96, s17, 11
    s_lshl_b32 s97, s12, 7
    s_add_u32 s98, s96, s97
    s_lshl_b32 s99, s19, 5
    s_add_u32 s82, s98, s99
    v_and_b32 v10, 7, v1
    v_lshlrev_b32 v10, 2, v10
    s_lshl_b32 s96, s19, 5
    s_add_u32 s13, s96, 139264
    v_add_u32 v5, s13, v10
    ds_read_b32 v74, v5
    s_lshr_b32 s96, s17, 7
    s_bfe_u32 s97, s18, 65538
    s_lshl1_add_u32 s98, s96, s97
    s_lshl_b32 s99, s98, 14
    s_lshl_b32 s96, s12, 8
    s_add_u32 s97, s99, s96
    s_lshl_b32 s98, s19, 6
    s_add_u32 s99, s97, s98
    s_add_u32 s68, s99, 33554432
    s_add_u32 s69, s68, 4096
    v_and_b32 v11, 7, v1
    v_lshlrev_b32 v11, 3, v11
    buffer_load_dwordx2 v[20:21], v11, s[32:35], s68 offen sc1
    buffer_load_dwordx2 v[72:73], v11, s[32:35], s69 offen sc1
    s_and_b32 s13, s18, s6
    s_ashr_i32 s15, s13, 31
    s_andn2_b32 s15, 0x7fff0000, s15
    s_or_b32 s15, s15, 0x80000000
    s_xor_b32 s13, s13, s15
    v_mov_b32 v75, s13
    v_mul_f32 v75, s7, v75
    v_exp_f32 v75, -v75
    s_nop 0
    v_add_f32 v75, 1.0, v75
    v_rcp_f32 v75, v75
    s_nop 0
    v_cvt_pk_bf16_f32 v75, 0, v75
L_NOFZ:
    s_cmp_lt_u32 s9, 28
    s_cbranch_scc1 L_HSEC
    s_branch L_GSEC
L_HSEC:
    s_cmp_lt_u32 s3, 4
    s_cbranch_scc1 L_HW
    s_branch L_NOH
L_HW:
    s_lshl_b32 s96, s3, 8
    s_add_u32 s13, s96, s14
    v_lshrrev_b32 v4, 4, v1
    v_lshlrev_b32 v4, 11, v4
    v_and_b32 v9, 15, v1
    v_lshl_add_u32 v4, v9, 4, v4
    s_lshl_b32 s96, s3, 5
    s_add_u32 s15, s96, 138752
    v_lshrrev_b32 v5, 5, v1
    v_lshl_add_u32 v5, v5, 7, s15
    v_bfe_u32 v9, v1, 2, 1
    v_lshl_add_u32 v5, v9, 4, v5
    v_bfe_u32 v9, v1, 1, 1
    v_lshl_add_u32 v5, v9, 3, v5
    v_bfe_u32 v9, v1, 3, 1
    v_lshl_add_u32 v5, v9, 2, v5
    v_and_b32 v9, 1, v1
    v_lshl_add_u32 v5, v9, 1, v5
    s_cmp_lg_u32 s93, 0
    s_cbranch_scc1 L_HLOC
SPOLL_54:
    s_load_dword s24, s[32:33], s13 offset:1276 glc
    s_load_dword s25, s[32:33], s13 offset:3324 glc
    s_load_dword s26, s[32:33], s13 offset:5372 glc
    s_load_dword s27, s[32:33], s13 offset:7420 glc
SCHK_55:
    s_add_u32 s5, s5, 1
    s_cmp_ge_u32 s5, 300000
    s_waitcnt lgkmcnt(0)
    s_cbranch_scc1 SDONE_56
    s_cmp_lg_u32 s24, s4
    s_cbranch_scc1 SPOLL_54
    s_cmp_lg_u32 s25, s4
    s_cbranch_scc1 SPOLL_54
    s_cmp_lg_u32 s26, s4
    s_cbranch_scc1 SPOLL_54
    s_cmp_lg_u32 s27, s4
    s_cbranch_scc1 SPOLL_54
SDONE_56:
L_HLOC:
    buffer_load_dwordx4 v[212:215], v4, s[32:35], s13 offen sc1
    buffer_load_dwordx4 v[216:219], v4, s[32:35], s13 offen offset:1024 sc1
    s_waitcnt vmcnt(0)
    v_bitop3_b32 v6, v213, v215, s4 bitop3:0x7e
    v_bitop3_b32 v6, v6, v217, s4 bitop3:0xf6
    v_bitop3_b32 v6, v6, v219, s4 bitop3:0xf6
    v_cmp_ne_u32 vcc, 0, v6
    s_cbranch_vccz TOK_58
POLL_59:
    buffer_load_dwordx4 v[212:215], v4, s[32:35], s13 offen sc1
    buffer_load_dwordx4 v[216:219], v4, s[32:35], s13 offen offset:1024 sc1
    s_waitcnt vmcnt(0)
    v_bitop3_b32 v6, v213, v215, s4 bitop3:0x7e
    v_bitop3_b32 v6, v6, v217, s4 bitop3:0xf6
    v_bitop3_b32 v6, v6, v219, s4 bitop3:0xf6
    v_cmp_ne_u32 vcc, 0, v6
    s_cbranch_vccz PDONE_60
    s_add_u32 s5, s5, 1
    s_cmp_lt_u32 s5, 300000
    s_cbranch_scc1 POLL_59
PDONE_60:
TOK_58:
    v_permlane32_swap_b32 v212, v214
    v_permlane32_swap_b32 v216, v218
    v_add_f32 v212, v212, v214
    v_add_f32 v216, v216, v218
    v_mov_b32 v214, v212
    v_mov_b32 v218, v216
    s_nop 0
    v_permlane16_swap_b32 v212, v214
    v_permlane16_swap_b32 v216, v218
    v_add_f32 v212, v212, v214
    v_add_f32 v216, v216, v218
    v_cvt_pk_bf16_f32 v212, 0, v212
    v_cvt_pk_bf16_f32 v216, 0, v216
    v_mul_f32 v6, s7, v212
    v_exp_f32 v6, -v6
    s_nop 0
    v_add_f32 v6, 1.0, v6
    v_rcp_f32 v6, v6
    s_nop 0
    v_mul_f32 v212, v212, v6
    v_cvt_pk_bf16_f32 v212, 0, v212
    v_mul_f32 v212, v212, v216
    v_cvt_pk_bf16_f32 v212, v212, v212
    ds_write_b16 v5, v212
L_NOH:
    v_bfe_u32 v4, v1, 2, 1
    v_lshlrev_b32 v4, 7, v4
    v_lshrrev_b32 v9, 5, v1
    v_lshl_add_u32 v4, v9, 4, v4
    v_add_u32 v4, 138752, v4
    v_lshrrev_b32 v5, 4, v1
    v_mul_u32_u24 v5, 7168, v5
    v_and_b32 v9, 15, v1
    v_lshl_add_u32 v5, v9, 3, v5
    v_and_b32 v6, 1, v1
    v_lshlrev_b32 v6, 18, v6
    v_bfe_u32 v9, v1, 1, 1
    v_lshl_add_u32 v6, v9, 13, v6
    s_lshl3_add_u32 s96, s75, s3
    s_mul_i32 s97, s96, 28672
    s_lshl_b32 s98, s74, 7
    s_add_u32 s99, s97, s98
    s_add_u32 s13, s99, 22020096
    s_lshr_b32 s96, s9, 2
    s_and_b32 s97, s75, 1
    s_lshr_b32 s98, s3, 1
    s_lshl2_add_u32 s99, s97, s98
    s_and_b32 s97, s3, 1
    s_lshl_b32 s98, s97, 2
    s_lshl3_add_u32 s97, s99, s98
    s_lshr_b32 s99, s75, 1
    s_add_u32 s98, s97, s99
    s_lshl_b32 s97, s98, 12
    s_lshl_b32 s99, s8, 6
    s_add_u32 s98, s97, s99
    s_lshl2_add_u32 s97, s96, s98
    s_add_u32 s99, s97, 1048576
    s_add_u32 s14, s99, 3072
    s_waitcnt vmcnt(0)
    s_waitcnt lgkmcnt(0)
    s_barrier
    ds_read_b128 v[212:215], v4
    ds_read_b64_tr_b16 v[196:197], v45
    ds_read_b64_tr_b16 v[198:199], v45 offset:1024
    ds_read_b128 v[216:219], v4 offset:32
    ds_read_b64_tr_b16 v[200:201], v45 offset:8192
    ds_read_b64_tr_b16 v[202:203], v45 offset:9216
    ds_read_b128 v[220:223], v4 offset:64
    ds_read_b64_tr_b16 v[204:205], v45 offset:16384
    ds_read_b64_tr_b16 v[206:207], v45 offset:17408
    ds_read_b128 v[224:227], v4 offset:96
    ds_read_b64_tr_b16 v[208:209], v45 offset:24576
    ds_read_b64_tr_b16 v[210:211], v45 offset:25600
    s_waitcnt lgkmcnt(9)
    v_mfma_f32_32x32x16_bf16 v[228:243], v[212:215], v[196:199], 0
    s_waitcnt lgkmcnt(6)
    v_mfma_f32_32x32x16_bf16 v[228:243], v[216:219], v[200:203], v[228:243]
    s_waitcnt lgkmcnt(3)
    v_mfma_f32_32x32x16_bf16 v[228:243], v[220:223], v[204:207], v[228:243]
    s_waitcnt lgkmcnt(0)
    v_mfma_f32_32x32x16_bf16 v[228:243], v[224:227], v[208:211], v[228:243]
    s_nop 11
    v_mov_b32 v229, s4
    buffer_store_dwordx2 v[228:229], v5, s[32:35], s13 offen sc1
    s_mov_b64 exec, 15
    buffer_store_dword v229, v6, s[32:35], s14 offen sc1
    s_mov_b64 exec, -1
    s_waitcnt lgkmcnt(0)
L_GSEC:
    s_lshl_b32 s96, s21, 7
    s_lshl4_add_u32 s13, s3, s96
    v_lshrrev_b32 v22, 3, v1
    v_lshl_add_u32 v22, v22, 0, s13
    s_lshl_b32 s96, s13, 11
    s_lshl_b32 s97, s12, 7
    s_add_u32 s15, s96, s97
    s_add_u32 s16, s15, 16384
    v_lshrrev_b32 v25, 3, v1
    v_lshlrev_b32 v25, 11, v25
    v_and_b32 v9, 7, v1
    v_lshl_add_u32 v25, v9, 4, v25
    v_cmp_ne_u32 vcc, s70, v22
    v_cmp_ne_u32 s[22:23], s71, v22
    s_nop 0
    s_and_b64 exec, vcc, s[22:23]
    buffer_store_dwordx4 v[140:143], v25, s[64:67], s15 offen sc1
    s_mov_b64 exec, -1
    v_add_u32 v22, 8, v22
    v_cmp_ne_u32 vcc, s70, v22
    v_cmp_ne_u32 s[22:23], s71, v22
    s_nop 0
    s_and_b64 exec, vcc, s[22:23]
    buffer_store_dwordx4 v[144:147], v25, s[64:67], s16 offen sc1
    s_mov_b64 exec, -1
    s_cmp_lt_u32 s9, 16
    s_cbranch_scc1 L_GF
    s_cmp_ge_u32 s9, 28
    s_cbranch_scc1 L_FIN
    s_waitcnt vmcnt(0)
    s_mov_b32 exec_lo, 0xffff
    s_mov_b32 exec_hi, 0xffff
    buffer_store_dwordx2 v[56:57], v58, s[32:35], 0 offen sc1
    s_mov_b64 exec, -1
    s_branch L_FIN
L_GF:
SPOLL_61:
    s_load_dwordx8 s[24:31], s[32:33], s92 offset:3072 glc
SCHK_62:
    s_add_u32 s5, s5, 1
    s_cmp_ge_u32 s5, 300000
    s_waitcnt lgkmcnt(0)
    s_cbranch_scc1 SDONE_63
    s_cmp_lg_u32 s24, s4
    s_cbranch_scc1 SPOLL_61
    s_cmp_lg_u32 s25, s4
    s_cbranch_scc1 SPOLL_61
    s_cmp_lg_u32 s26, s4
    s_cbranch_scc1 SPOLL_61
    s_cmp_lg_u32 s27, s4
    s_cbranch_scc1 SPOLL_61
    s_cmp_lg_u32 s28, s4
    s_cbranch_scc1 SPOLL_61
    s_cmp_lg_u32 s29, s4
    s_cbranch_scc1 SPOLL_61
    s_cmp_lg_u32 s30, s4
    s_cbranch_scc1 SPOLL_61
SDONE_63:
    s_barrier
    s_cmp_eq_u32 s3, 7
    s_cbranch_scc1 L_G7
    s_barrier
    s_mov_b32 exec_lo, 0xffff
    s_mov_b32 exec_hi, 0xffff
    buffer_store_dwordx2 v[56:57], v58, s[32:35], 0 offen sc1
    s_mov_b64 exec, -1
    s_branch L_FIN
L_G7:
    s_cmp_lg_u32 s3, 7
    s_cbranch_scc1 L_FIN
    s_add_u32 s13, s20, 4096
POLL_64:
    buffer_load_dwordx4 v[212:215], v2, s[32:35], s20 offen sc1
    buffer_load_dwordx4 v[216:219], v2, s[32:35], s20 offen offset:1024 sc1
    buffer_load_dwordx4 v[220:223], v2, s[32:35], s20 offen offset:2048 sc1
    buffer_load_dwordx4 v[224:227], v2, s[32:35], s20 offen offset:3072 sc1
    buffer_load_dwordx4 v[148:151], v2, s[32:35], s13 offen sc1
    buffer_load_dwordx4 v[152:155], v2, s[32:35], s13 offen offset:1024 sc1
    buffer_load_dwordx4 v[156:159], v2, s[32:35], s13 offen offset:2048 sc1
    s_waitcnt vmcnt(0)
    v_bitop3_b32 v4, v213, v215, s4 bitop3:0x7e
    v_bitop3_b32 v4, v4, v217, s4 bitop3:0xf6
    v_bitop3_b32 v4, v4, v219, s4 bitop3:0xf6
    v_bitop3_b32 v4, v4, v221, s4 bitop3:0xf6
    v_bitop3_b32 v4, v4, v223, s4 bitop3:0xf6
    v_bitop3_b32 v4, v4, v225, s4 bitop3:0xf6
    v_bitop3_b32 v4, v4, v227, s4 bitop3:0xf6
    v_bitop3_b32 v4, v4, v149, s4 bitop3:0xf6
    v_bitop3_b32 v4, v4, v151, s4 bitop3:0xf6
    v_bitop3_b32 v4, v4, v153, s4 bitop3:0xf6
    v_bitop3_b32 v4, v4, v155, s4 bitop3:0xf6
    v_bitop3_b32 v4, v4, v157, s4 bitop3:0xf6
    v_bitop3_b32 v4, v4, v159, s4 bitop3:0xf6
    v_cmp_ne_u32 vcc, 0, v4
    s_cbranch_vccz PDONE_65
    s_add_u32 s5, s5, 1
    s_cmp_lt_u32 s5, 300000
    s_cbranch_scc1 POLL_64
PDONE_65:
    v_bitop3_b32 v4, v21, v73, s4 bitop3:0x7e
    v_cmp_ne_u32 vcc, 0, v4
    s_cbranch_vccz TOK_66
POLL_67:
    buffer_load_dwordx2 v[20:21], v11, s[32:35], s68 offen sc1
    buffer_load_dwordx2 v[72:73], v11, s[32:35], s69 offen sc1
    s_waitcnt vmcnt(0)
    v_bitop3_b32 v4, v21, v73, s4 bitop3:0x7e
    v_cmp_ne_u32 vcc, 0, v4
    s_cbranch_vccz PDONE_68
    s_add_u32 s5, s5, 1
    s_cmp_lt_u32 s5, 300000
    s_cbranch_scc1 POLL_67
PDONE_68:
TOK_66:
    s_barrier
    v_add_f32 v212, v212, v216
    v_add_f32 v214, v214, v218
    v_add_f32 v220, v220, v224
    v_add_f32 v222, v222, v226
    v_add_f32 v148, v148, v152
    v_add_f32 v150, v150, v154
    v_add_f32 v212, v212, v220
    v_add_f32 v214, v214, v222
    v_add_f32 v148, v148, v156
    v_add_f32 v150, v150, v158
    v_add_f32 v212, v212, v148
    v_add_f32 v214, v214, v150
    v_mov_b32 v213, v214
    v_add_f32_dpp v212, v212, v212 row_ror:8 row_mask:0xf bank_mask:0xf
    s_nop 0
    v_add_f32_dpp v213, v213, v213 row_ror:8 row_mask:0xf bank_mask:0xf
    v_mov_b32 v214, v212
    v_mov_b32 v215, v213
    s_nop 0
    v_permlane16_swap_b32 v212, v214
    v_permlane16_swap_b32 v213, v215
    v_pk_add_f32 v[212:213], v[212:213], v[214:215]
    v_mov_b32 v214, v212
    v_mov_b32 v215, v213
    s_nop 0
    v_permlane32_swap_b32 v212, v214
    v_permlane32_swap_b32 v213, v215
    v_pk_add_f32 v[212:213], v[212:213], v[214:215]
    v_cvt_pk_bf16_f32 v212, 0, v212
    v_cvt_pk_bf16_f32 v213, 0, v213
    v_pk_mul_f32 v[212:213], v[212:213], v[74:75] op_sel:[0,1]
    v_lshlrev_b32 v4, 16, v20
    v_and_b32 v5, s6, v20
    v_cvt_pk_bf16_f32 v212, 0, v212
    v_cvt_pk_bf16_f32 v213, 0, v213
    v_pk_add_f32 v[212:213], v[212:213], v[4:5]
    v_lshlrev_b32 v4, 16, v74
    v_and_b32 v5, s6, v74
    v_cvt_pk_bf16_f32 v212, 0, v212
    v_cvt_pk_bf16_f32 v213, 0, v213
    v_pk_mul_f32 v[212:213], v[212:213], v[4:5]
    v_lshlrev_b32 v4, 16, v72
    v_and_b32 v5, s6, v72
    v_cvt_pk_bf16_f32 v212, 0, v212
    v_cvt_pk_bf16_f32 v213, 0, v213
    v_pk_add_f32 v[212:213], v[212:213], v[4:5]
    v_cvt_pk_bf16_f32 v212, v212, v213
    s_mov_b64 exec, 0xff
    buffer_store_dword v212, v10, s[64:67], s82 offen sc1
    s_mov_b64 exec, -1
    s_mov_b32 exec_lo, 0xffff
    s_mov_b32 exec_hi, 0xffff
    buffer_store_dwordx2 v[56:57], v58, s[32:35], 0 offen sc1
    s_mov_b64 exec, -1
L_FIN:
L_END:
    s_endpgm
.p2align 10
.fill 768, 4, 0xbf800000
.section .rodata,"a"
.p2align 6
.amdhsa_kernel adaLN_cond__linear_kernel_hedgehog__moe_arch_mod__prompt_kernel
  .amdhsa_next_free_vgpr 256
  .amdhsa_next_free_sgpr 102
  .amdhsa_accum_offset 256
  .amdhsa_group_segment_fixed_size 0
  .amdhsa_kernarg_size 112
  .amdhsa_user_sgpr_count 2
  .amdhsa_user_sgpr_kernarg_segment_ptr 1
  .amdhsa_system_sgpr_workgroup_id_x 1
  .amdhsa_float_denorm_mode_32 3
  .amdhsa_float_denorm_mode_16_64 3
.end_amdhsa_kernel
```

```asm
; @launch grid=(256,1,1) block=(512,1,1) lds=163840
.amdgcn_target "amdgcn-amd-amdhsa--gfx950"
.text
.globl adaLN_cond__linear_kernel_hedgehog__moe_arch_mod__prompt_kernel
.p2align 8
.type adaLN_cond__linear_kernel_hedgehog__moe_arch_mod__prompt_kernel,@function
adaLN_cond__linear_kernel_hedgehog__moe_arch_mod__prompt_kernel:
    s_load_dwordx16 s[68:83], s[0:1], 0
    s_load_dwordx8 s[84:91], s[0:1], 64
    s_load_dwordx2 s[32:33], s[0:1], 104
    s_load_dwordx2 s[30:31], s[0:1], 96
    s_cmp_ge_u32 s2, 256
    s_cbranch_scc1 L_END
    v_lshrrev_b32 v4, 6, v0
    v_and_b32 v1, 63, v0
    v_mov_b32 v3, 0
    v_readfirstlane_b32 s3, v4
    v_lshlrev_b32 v2, 4, v1
    s_and_b32 s8, s2, 7
    s_lshr_b32 s9, s2, 3
    s_lshl2_add_u32 s96, s8, s3
    s_lshl_b32 s15, s96, 6
    s_mul_i32 s96, s15, 6144
    s_xor_b32 s97, s9, 1
    s_lshl_b32 s98, s97, 7
    s_add_u32 s13, s96, s98
    v_lshrrev_b32 v60, 3, v1
    v_mul_u32_u24 v60, 49152, v60
    v_and_b32 v9, 7, v1
    v_lshl_add_u32 v60, v9, 4, v60
    v_lshrrev_b32 v61, 3, v1
    v_lshl_add_u32 v61, v61, 3, s15
    s_lshl_b32 s96, s8, 5
    s_add_u32 s97, s96, s9
    s_lshl2_add_u32 s98, s97, s3
    s_sub_u32 s99, s98, 4
    s_lshl_b32 s16, s99, 12
    s_mov_b32 s50, 12582912
    s_mov_b32 s51, 0x20000
    s_mov_b32 s38, 4194304
    s_mov_b32 s39, 0x20000
    s_mov_b32 s34, 268435456
    s_mov_b32 s35, 0x20000
    s_getreg_b32 s94, hwreg(HW_REG_XCC_ID, 0, 3)
    s_getpc_b64 s[22:23]
    s_mul_i32 s96, s9, 7
    s_add_u32 s97, s96, s3
    s_lshl_b32 s19, s97, 7
    v_lshrrev_b32 v10, 5, v1
    v_mul_u32_u24 v10, 28672, v10
    v_add_u32 v10, s19, v10
    v_min_u32 v10, 44032, v10
    s_cmp_ge_u32 s3, 4
    s_waitcnt lgkmcnt(0)
    s_mov_b64 s[48:49], s[88:89]
    s_mov_b64 s[36:37], s[68:69]
    s_load_dword s4, s[32:33], 0
    s_cbranch_scc1 L_FS
    global_load_dwordx2 v[96:97], v61, s[86:87]
    buffer_load_dwordx4 v[80:83], v60, s[48:51], s13 offen nt
    s_add_u32 s13, s13, 12288
    buffer_load_dwordx4 v[84:87], v60, s[48:51], s13 offen nt
    s_add_u32 s13, s13, 12288
    buffer_load_dwordx4 v[88:91], v60, s[48:51], s13 offen nt
    s_add_u32 s13, s13, 12288
    buffer_load_dwordx4 v[92:95], v60, s[48:51], s13 offen nt
    s_barrier
    s_barrier
    s_and_b32 s22, s22, 0xfffffc00
    global_load_dword v78, v10, s[22:23]
    s_mov_b32 s42, 6291456
    s_mov_b32 s43, 0x20000
    s_mov_b32 s46, 2097152
    s_mov_b32 s47, 0x20000
    s_mov_b32 s54, 7340032
    s_mov_b32 s55, 0x20000
    s_mov_b32 s58, 7340032
    s_mov_b32 s59, 0x20000
    s_mov_b32 s62, 7340032
    s_mov_b32 s63, 0x20000
    s_mov_b32 s66, 4194304
    s_mov_b32 s67, 0x20000
    s_mov_b64 s[40:41], s[70:71]
    s_mov_b64 s[44:45], s[74:75]
    s_mov_b64 s[52:53], s[80:81]
    s_mov_b64 s[56:57], s[82:83]
    s_mov_b64 s[60:61], s[84:85]
    s_mov_b64 s[64:65], s[90:91]
    s_mov_b32 s5, 0
    s_mov_b32 s6, 0xffff0000
    s_mov_b32 s7, 0x3fb8aa3b
    s_lshr_b32 s76, s3, 2
    v_bfe_u32 v6, v1, 4, 1
    v_lshlrev_b32 v6, 6, v6
    v_and_b32 v62, 7, v1
    v_lshlrev_b32 v62, 4, v62
    v_xor_b32 v62, v62, v6
    v_lshrrev_b32 v6, 3, v1
    v_mul_u32_u24 v6, 6144, v6
    v_add_u32 v62, v62, v6
    v_lshlrev_b32 v63, 3, v1
    v_add_u32 v64, 149760, v2
    s_and_b32 s96, s3, 3
    s_lshl2_add_u32 s13, s96, 149760
    v_lshrrev_b32 v65, 4, v1
    v_lshl_add_u32 v65, v65, 5, s13
    v_and_b32 v9, 7, v1
    v_lshl_add_u32 v65, v9, 7, v65
    v_bfe_u32 v9, v1, 3, 1
    v_lshl_add_u32 v65, v9, 4, v65
    s_and_b32 s96, s8, 6
    s_and_b32 s97, s8, 1
    s_lshr_b32 s98, s9, 4
    s_lshl1_add_u32 s99, s97, s98
    s_lshl_b32 s97, s99, 6
    s_add_u32 s98, s96, s97
    s_lshl3_add_u32 s99, s3, s98
    s_lshl_b32 s96, s99, 10
    s_and_b32 s97, s9, 15
    s_lshl_b32 s98, s97, 6
    s_add_u32 s99, s96, s98
    s_add_u32 s14, s99, 262144
    s_xor_b32 s96, s9, 1
    s_and_b32 s97, s96, 15
    s_lshl4_add_u32 s98, s3, s97
    s_lshr_b32 s99, s9, 4
    s_lshl1_add_u32 s96, s98, s99
    s_lshl3_add_u32 s97, s96, s8
    s_lshl_b32 s98, s97, 9
    s_add_u32 s13, s98, 524288
    s_lshr_b32 s96, s9, 4
    s_xor_b32 s97, s9, 1
    s_and_b32 s98, s97, 7
    s_lshl_b32 s99, s3, 1
    s_lshl3_add_u32 s97, s98, s99
    s_bfe_u32 s98, s9, 65539
    s_add_u32 s99, s97, s98
    s_lshl_b32 s97, s99, 9
    s_lshl_b32 s98, s8, 6
    s_add_u32 s99, s97, s98
    s_lshl2_add_u32 s97, s96, s99
    s_add_u32 s15, s97, 2097152
    v_and_b32 v10, 3, v1
    v_lshlrev_b32 v10, 15, v10
    s_waitcnt vmcnt(5)
    v_lshlrev_b32 v98, 16, v97
    v_and_b32 v99, s6, v97
    v_and_b32 v97, s6, v96
    v_lshlrev_b32 v96, 16, v96
    v_mul_f32 v4, s7, v96
    v_exp_f32 v4, -v4
    s_nop 0
    v_add_f32 v4, 1.0, v4
    v_rcp_f32 v4, v4
    s_nop 0
    v_mul_f32 v96, v96, v4
    v_cvt_pk_bf16_f32 v96, 0, v96
    v_mul_f32 v5, s7, v97
    v_exp_f32 v5, -v5
    s_nop 0
    v_add_f32 v5, 1.0, v5
    v_rcp_f32 v5, v5
    s_nop 0
    v_mul_f32 v97, v97, v5
    v_cvt_pk_bf16_f32 v97, 0, v97
    v_mul_f32 v4, s7, v98
    v_exp_f32 v4, -v4
    s_nop 0
    v_add_f32 v4, 1.0, v4
    v_rcp_f32 v4, v4
    s_nop 0
    v_mul_f32 v98, v98, v4
    v_cvt_pk_bf16_f32 v98, 0, v98
    v_mul_f32 v5, s7, v99
    v_exp_f32 v5, -v5
    s_nop 0
    v_add_f32 v5, 1.0, v5
    v_rcp_f32 v5, v5
    s_nop 0
    v_mul_f32 v99, v99, v5
    v_cvt_pk_bf16_f32 v99, 0, v99
    s_waitcnt vmcnt(4)
    v_lshlrev_b32 v4, 16, v80
    v_and_b32 v5, s6, v80
    v_pk_mul_f32 v[20:21], v[4:5], v[96:97] op_sel:[0,0] op_sel_hi:[1,0]
    v_lshlrev_b32 v6, 16, v81
    v_and_b32 v7, s6, v81
    v_pk_mul_f32 v[22:23], v[6:7], v[96:97] op_sel:[0,0] op_sel_hi:[1,0]
    v_lshlrev_b32 v4, 16, v82
    v_and_b32 v5, s6, v82
    v_pk_mul_f32 v[24:25], v[4:5], v[96:97] op_sel:[0,0] op_sel_hi:[1,0]
    v_lshlrev_b32 v6, 16, v83
    v_and_b32 v7, s6, v83
    v_pk_mul_f32 v[26:27], v[6:7], v[96:97] op_sel:[0,0] op_sel_hi:[1,0]
    s_waitcnt vmcnt(3)
    v_lshlrev_b32 v4, 16, v84
    v_and_b32 v5, s6, v84
    v_pk_fma_f32 v[20:21], v[4:5], v[96:97], v[20:21] op_sel:[0,1,0] op_sel_hi:[1,1,1]
    v_lshlrev_b32 v6, 16, v85
    v_and_b32 v7, s6, v85
    v_pk_fma_f32 v[22:23], v[6:7], v[96:97], v[22:23] op_sel:[0,1,0] op_sel_hi:[1,1,1]
    v_lshlrev_b32 v4, 16, v86
    v_and_b32 v5, s6, v86
    v_pk_fma_f32 v[24:25], v[4:5], v[96:97], v[24:25] op_sel:[0,1,0] op_sel_hi:[1,1,1]
    v_lshlrev_b32 v6, 16, v87
    v_and_b32 v7, s6, v87
    v_pk_fma_f32 v[26:27], v[6:7], v[96:97], v[26:27] op_sel:[0,1,0] op_sel_hi:[1,1,1]
    s_waitcnt vmcnt(2)
    v_lshlrev_b32 v4, 16, v88
    v_and_b32 v5, s6, v88
    v_pk_fma_f32 v[20:21], v[4:5], v[98:99], v[20:21] op_sel:[0,0,0] op_sel_hi:[1,0,1]
    v_lshlrev_b32 v6, 16, v89
    v_and_b32 v7, s6, v89
    v_pk_fma_f32 v[22:23], v[6:7], v[98:99], v[22:23] op_sel:[0,0,0] op_sel_hi:[1,0,1]
    v_lshlrev_b32 v4, 16, v90
    v_and_b32 v5, s6, v90
    v_pk_fma_f32 v[24:25], v[4:5], v[98:99], v[24:25] op_sel:[0,0,0] op_sel_hi:[1,0,1]
    v_lshlrev_b32 v6, 16, v91
    v_and_b32 v7, s6, v91
    v_pk_fma_f32 v[26:27], v[6:7], v[98:99], v[26:27] op_sel:[0,0,0] op_sel_hi:[1,0,1]
    s_waitcnt vmcnt(1)
    v_lshlrev_b32 v4, 16, v92
    v_and_b32 v5, s6, v92
    v_pk_fma_f32 v[20:21], v[4:5], v[98:99], v[20:21] op_sel:[0,1,0] op_sel_hi:[1,1,1]
    v_lshlrev_b32 v6, 16, v93
    v_and_b32 v7, s6, v93
    v_pk_fma_f32 v[22:23], v[6:7], v[98:99], v[22:23] op_sel:[0,1,0] op_sel_hi:[1,1,1]
    v_lshlrev_b32 v4, 16, v94
    v_and_b32 v5, s6, v94
    v_pk_fma_f32 v[24:25], v[4:5], v[98:99], v[24:25] op_sel:[0,1,0] op_sel_hi:[1,1,1]
    v_lshlrev_b32 v6, 16, v95
    v_and_b32 v7, s6, v95
    v_pk_fma_f32 v[26:27], v[6:7], v[98:99], v[26:27] op_sel:[0,1,0] op_sel_hi:[1,1,1]
    v_permlane32_swap_b32 v20, v24
    v_permlane32_swap_b32 v21, v25
    v_permlane32_swap_b32 v22, v26
    v_permlane32_swap_b32 v23, v27
    v_add_f32 v20, v20, v24
    v_add_f32 v21, v21, v25
    v_add_f32 v22, v22, v26
    v_add_f32 v23, v23, v27
    s_nop 0
    v_permlane16_swap_b32 v20, v22
    v_permlane16_swap_b32 v21, v23
    v_add_f32 v20, v20, v22
    v_add_f32 v21, v21, v23
    s_nop 0
    v_add_f32_dpp v20, v20, v20 row_ror:8 row_mask:0xf bank_mask:0xf
    v_add_f32_dpp v21, v21, v21 row_ror:8 row_mask:0xf bank_mask:0xf
    s_nop 1
    v_mov_b32_dpp v20, v21 quad_perm:[0,1,2,3] row_mask:0xf bank_mask:0xc
    ds_write_b32 v65, v20
    s_waitcnt lgkmcnt(0)
    s_barrier
    ds_read_b128 v[20:23], v64 offset:0
    s_mul_i32 s4, s4, 0x9e3779b1
    s_add_u32 s4, s4, 0x7f4a7c15
    s_waitcnt lgkmcnt(0)
    v_pk_add_f32 v[20:21], v[20:21], v[22:23]
    v_add_f32 v20, v20, v21
    v_mov_b32 v21, s4
    buffer_store_dwordx2 v[20:21], v63, s[32:35], s13 offen sc1
    s_mov_b64 exec, 15
    buffer_store_dword v21, v10, s[32:35], s15 offen sc1
    s_mov_b64 exec, -1
    s_lshl2_add_u32 s96, s2, s3
    s_mul_i32 s13, s96, 6144
    s_branch L_FJ
L_FS:
    s_barrier
    buffer_load_dwordx4 v[80:83], v2, s[36:39], s16 offen
    buffer_load_dwordx4 v[84:87], v2, s[36:39], s16 offen offset:1024
    buffer_load_dwordx4 v[88:91], v2, s[36:39], s16 offen offset:2048
    buffer_load_dwordx4 v[92:95], v2, s[36:39], s16 offen offset:3072
    s_lshl2_add_u32 s96, s2, s3
    s_sub_u32 s97, s96, 4
    s_lshl_b32 s98, s97, 7
    s_add_u32 s17, s98, 2097152
    s_load_dword s24, s[32:33], s17 offset:0 glc
    s_load_dword s25, s[32:33], s17 offset:64 glc
    s_lshl_b32 s96, s2, 5
    s_add_u32 s97, s96, s3
    s_sub_u32 s98, s97, 4
    s_lshl_b32 s99, s98, 7
    s_add_u32 s17, s99, 1048576
    s_load_dword s24, s[32:33], s17 offset:0 glc
    s_load_dword s25, s[32:33], s17 offset:64 glc
    s_lshl_b32 s19, s94, 5
    v_mov_b32 v78, 1
    v_mov_b32 v79, s19
    s_barrier
    s_cmp_lg_u32 s3, 7
    s_cbranch_scc1 L_NOTK
    s_mov_b64 exec, 1
    global_atomic_add v78, v79, v78, s[30:31] sc0 sc1
    s_mov_b64 exec, -1
    s_branch L_TK0
L_NOTK:
    s_and_b32 s22, s22, 0xfffffc00
    global_load_dword v78, v10, s[22:23]
L_TK0:
    s_mov_b32 s42, 6291456
    s_mov_b32 s43, 0x20000
    s_mov_b32 s46, 2097152
    s_mov_b32 s47, 0x20000
    s_mov_b32 s54, 7340032
    s_mov_b32 s55, 0x20000
    s_mov_b32 s58, 7340032
    s_mov_b32 s59, 0x20000
    s_mov_b32 s62, 7340032
    s_mov_b32 s63, 0x20000
    s_mov_b32 s66, 4194304
    s_mov_b32 s67, 0x20000
    s_mov_b64 s[40:41], s[70:71]
    s_mov_b64 s[44:45], s[74:75]
    s_mov_b64 s[52:53], s[80:81]
    s_mov_b64 s[56:57], s[82:83]
    s_mov_b64 s[60:61], s[84:85]
    s_mov_b64 s[64:65], s[90:91]
    s_mov_b32 s5, 0
    s_mov_b32 s6, 0xffff0000
    s_mov_b32 s7, 0x3fb8aa3b
    s_lshr_b32 s76, s3, 2
    v_bfe_u32 v6, v1, 4, 1
    v_lshlrev_b32 v6, 6, v6
    v_and_b32 v62, 7, v1
    v_lshlrev_b32 v62, 4, v62
    v_xor_b32 v62, v62, v6
    v_lshrrev_b32 v6, 3, v1
    v_mul_u32_u24 v6, 6144, v6
    v_add_u32 v62, v62, v6
    v_lshlrev_b32 v63, 3, v1
    v_add_u32 v64, 149760, v2
    s_and_b32 s96, s3, 3
    s_lshl2_add_u32 s13, s96, 149760
    v_lshrrev_b32 v65, 4, v1
    v_lshl_add_u32 v65, v65, 5, s13
    v_and_b32 v9, 7, v1
    v_lshl_add_u32 v65, v9, 7, v65
    v_bfe_u32 v9, v1, 3, 1
    v_lshl_add_u32 v65, v9, 4, v65
    s_and_b32 s96, s8, 6
    s_and_b32 s97, s8, 1
    s_lshr_b32 s98, s9, 4
    s_lshl1_add_u32 s99, s97, s98
    s_lshl_b32 s97, s99, 6
    s_add_u32 s98, s96, s97
    s_lshl3_add_u32 s99, s3, s98
    s_lshl_b32 s96, s99, 10
    s_and_b32 s97, s9, 15
    s_lshl_b32 s98, s97, 6
    s_add_u32 s99, s96, s98
    s_add_u32 s14, s99, 262144
    s_sub_u32 s96, s3, 4
    s_lshl4_add_u32 s13, s96, 151808
    v_lshrrev_b32 v10, 5, v1
    v_lshl_add_u32 v10, v10, 3, s13
    s_barrier
    s_waitcnt vmcnt(1)
    s_waitcnt lgkmcnt(0)
    s_mul_i32 s4, s4, 0x9e3779b1
    s_add_u32 s4, s4, 0x7f4a7c15
    v_mov_b32 v104, 0x3f803f80
    v_dot2_f32_bf16 v100, v80, v104, 0
    v_dot2_f32_bf16 v102, v80, v80, 0
    v_dot2_f32_bf16 v101, v88, v104, 0
    v_dot2_f32_bf16 v103, v88, v88, 0
    v_dot2_f32_bf16 v100, v81, v104, v100
    v_dot2_f32_bf16 v102, v81, v81, v102
    v_dot2_f32_bf16 v101, v89, v104, v101
    v_dot2_f32_bf16 v103, v89, v89, v103
    v_dot2_f32_bf16 v100, v82, v104, v100
    v_dot2_f32_bf16 v102, v82, v82, v102
    v_dot2_f32_bf16 v101, v90, v104, v101
    v_dot2_f32_bf16 v103, v90, v90, v103
    v_dot2_f32_bf16 v100, v83, v104, v100
    v_dot2_f32_bf16 v102, v83, v83, v102
    v_dot2_f32_bf16 v101, v91, v104, v101
    v_dot2_f32_bf16 v103, v91, v91, v103
    v_dot2_f32_bf16 v100, v84, v104, v100
    v_dot2_f32_bf16 v102, v84, v84, v102
    v_dot2_f32_bf16 v101, v92, v104, v101
    v_dot2_f32_bf16 v103, v92, v92, v103
    v_dot2_f32_bf16 v100, v85, v104, v100
    v_dot2_f32_bf16 v102, v85, v85, v102
    v_dot2_f32_bf16 v101, v93, v104, v101
    v_dot2_f32_bf16 v103, v93, v93, v103
    v_dot2_f32_bf16 v100, v86, v104, v100
    v_dot2_f32_bf16 v102, v86, v86, v102
    v_dot2_f32_bf16 v101, v94, v104, v101
    v_dot2_f32_bf16 v103, v94, v94, v103
    v_dot2_f32_bf16 v100, v87, v104, v100
    v_dot2_f32_bf16 v102, v87, v87, v102
    v_dot2_f32_bf16 v101, v95, v104, v101
    v_dot2_f32_bf16 v103, v95, v95, v103
    s_nop 1
    v_permlane32_swap_b32 v100, v101
    v_permlane32_swap_b32 v102, v103
    v_add_f32 v100, v100, v101
    v_add_f32 v102, v102, v103
    s_nop 1
    v_permlane16_swap_b32 v100, v102
    v_add_f32 v100, v100, v102
    s_nop 1
    v_add_f32_dpp v100, v100, v100 quad_perm:[1,0,3,2] row_mask:0xf bank_mask:0xf
    s_nop 1
    v_add_f32_dpp v100, v100, v100 quad_perm:[2,3,0,1] row_mask:0xf bank_mask:0xf
    s_nop 1
    v_add_f32_dpp v100, v100, v100 row_half_mirror row_mask:0xf bank_mask:0xf
    s_nop 1
    v_add_f32_dpp v100, v100, v100 row_ror:8 row_mask:0xf bank_mask:0xf
    v_mul_f32 v102, 0x3a800000, v100
    v_mul_f32 v100, 0x3a800000, v100
    s_nop 1
    v_permlane16_swap_b32 v100, v102
    v_fma_f32 v117, -v100, v100, v102
    v_cvt_pk_bf16_f32 v116, 0, v100
    v_max_f32 v117, 0, v117
    v_cvt_pk_bf16_f32 v117, 0, v117
    v_add_f32 v117, 0x3727c5ac, v117
    v_cvt_pk_bf16_f32 v117, 0, v117
    v_sqrt_f32 v117, v117
    s_nop 0
    v_cvt_pk_bf16_f32 v117, 0, v117
    v_lshrrev_b32 v116, 16, v116
    v_or_b32 v116, v116, v117
    v_mov_b32 v117, s4
    ds_write_b64 v10, v[116:117]
L_FJ:
    v_and_b32 v5, 3, v1
    v_lshlrev_b32 v5, 4, v5
    v_add_u32 v5, 151808, v5
    v_and_b32 v4, 3, v1
    v_lshlrev_b32 v4, 4, v4
    v_bfe_u32 v9, v1, 2, 1
    v_lshl_add_u32 v4, v9, 10, v4
    v_and_b32 v10, 31, v1
    v_lshlrev_b32 v10, 11, v10
    v_lshrrev_b32 v9, 5, v1
    v_lshl_add_u32 v10, v9, 5, v10
    v_and_b32 v6, 1, v1
    v_lshlrev_b32 v6, 9, v6
    v_bfe_u32 v9, v1, 1, 1
    v_lshl_add_u32 v6, v9, 8, v6
    s_and_b32 s96, s9, 3
    s_and_b32 s97, s8, 6
    s_and_b32 s98, s8, 1
    s_lshr_b32 s99, s9, 4
    s_lshl1_add_u32 s98, s98, s99
    s_lshl_b32 s99, s98, 6
    s_add_u32 s98, s97, s99
    s_lshl3_add_u32 s97, s3, s98
    s_lshl_b32 s99, s97, 9
    s_bfe_u32 s98, s9, 131074
    s_lshl_b32 s97, s98, 6
    s_add_u32 s98, s99, s97
    s_lshl2_add_u32 s99, s96, s98
    s_add_u32 s97, s99, 16
    s_add_u32 s15, s97, 2097152
    s_waitcnt lgkmcnt(0)
    s_barrier
    ds_read_b128 v[116:119], v5
    s_waitcnt lgkmcnt(0)
    s_mov_b64 exec, 0xff
    buffer_store_dwordx4 v[116:119], v4, s[32:35], s14 offen sc1
    s_mov_b64 exec, 15
    buffer_store_dword v117, v6, s[32:35], s15 offen sc1
    s_mov_b64 exec, -1
    s_cmp_lg_u32 s3, 7
    s_cbranch_scc1 L_NOTK2
    s_mov_b32 s13, 0
    s_waitcnt vmcnt(2)
L_TK:
    v_readfirstlane_b32 s15, v78
    s_nop 0
    s_cmp_lt_u32 s15, 32
    s_cbranch_scc1 L_TKOK
    v_mov_b32 v78, s4
    s_mov_b64 exec, 1
    buffer_store_dword v78, v3, s[32:35], 0 offen offset:256 sc1
    s_mov_b64 exec, -1
    s_add_u32 s13, s13, 1
    s_cmp_lt_u32 s13, 8
    s_cbranch_scc0 L_TKNO
    s_add_u32 s94, s94, 1
    s_and_b32 s94, s94, 7
    s_lshl_b32 s19, s94, 5
    v_mov_b32 v78, 1
    v_mov_b32 v79, s19
    s_mov_b64 exec, 1
    global_atomic_add v78, v79, v78, s[30:31] sc0 sc1
    s_mov_b64 exec, -1
    s_waitcnt vmcnt(0)
    s_branch L_TK
L_TKNO:
    s_and_b32 s94, s2, 7
    s_lshr_b32 s15, s2, 3
L_TKOK:
    s_lshl3_add_u32 s15, s15, s94
    v_mov_b32 v78, s15
    ds_write_b32 v5, v78 offset:64
L_NOTK2:
    s_waitcnt lgkmcnt(0)
    s_barrier
    ds_read_b32 v120, v5 offset:64
    s_waitcnt lgkmcnt(0)
    v_readfirstlane_b32 s2, v120
    s_nop 0
    s_and_b32 s8, s2, 7
    s_lshr_b32 s9, s2, 3
    s_and_b32 s96, s8, 1
    s_and_b32 s97, s9, 7
    s_lshl3_add_u32 s12, s96, s97
    s_lshr_b32 s96, s8, 1
    s_lshr_b32 s97, s9, 3
    s_lshl2_add_u32 s21, s96, s97
    s_and_b32 s96, s3, 3
    s_lshl2_add_u32 s94, s21, s96
    s_lshl1_add_u32 s95, s12, s76
    s_lshl_b32 s96, s94, 16
    s_lshl_b32 s97, s95, 6
    s_add_u32 s18, s96, s97
    buffer_load_dwordx4 v[12:15], v10, s[36:39], s18 offen
    buffer_load_dwordx4 v[16:19], v10, s[36:39], s18 offen offset:16
    s_lshr_b32 s96, s8, 1
    s_lshl4_add_u32 s97, s96, s12
    s_lshl4_add_u32 s98, s97, s3
    s_lshl_b32 s99, s98, 9
    s_add_u32 s13, s99, 524288
    s_lshl3_add_u32 s96, s2, s3
    s_lshl_b32 s97, s96, 6
    s_add_u32 s15, s97, 2097152
    s_and_b32 s96, s3, 3
    s_lshl2_add_u32 s97, s2, s96
    s_lshl_b32 s98, s97, 8
    s_add_u32 s14, s98, 262144
    s_load_dwordx8 s[24:31], s[32:33], s15 offset:0 glc
    s_and_b32 s10, s9, 15
    s_lshr_b32 s96, s8, 2
    s_and_b32 s97, s8, 1
    s_lshl1_add_u32 s98, s96, s97
    s_and_b32 s99, s8, 2
    s_lshl2_add_u32 s96, s98, s99
    s_lshr_b32 s97, s9, 4
    s_add_u32 s11, s96, s97
    s_and_b32 s85, s9, 12
    s_lshl_b32 s96, s2, 6
    s_add_u32 s97, s96, s3
    s_lshl_b32 s98, s97, 6
    s_add_u32 s92, s98, 1048576
    s_lshr_b32 s96, s9, 4
    s_xor_b32 s77, s76, s96
    s_lshr_b32 s96, s9, 3
    s_xor_b32 s97, s96, s9
    s_and_b32 s98, s97, 1
    s_lshl_b32 s83, s98, 2
    s_mul_i32 s96, s8, 7
    s_lshr_b32 s97, s9, 2
    s_add_u32 s74, s96, s97
    s_and_b32 s75, s9, 3
    v_and_b32 v8, 31, v1
    v_lshlrev_b32 v8, 3, v8
    v_and_b32 v4, 31, v1
    v_lshlrev_b32 v4, 4, v4
    v_lshrrev_b32 v9, 5, v1
    v_lshl_add_u32 v4, v9, 12, v4
    s_lshl2_add_u32 s16, s3, 152320
    v_lshl_add_u32 v5, v1, 6, s16
    s_lshl_b32 s96, s76, 10
    s_add_u32 s16, s96, 152320
    v_and_b32 v6, 15, v1
    v_lshl_add_u32 v6, v6, 5, s16
    v_lshrrev_b32 v9, 5, v1
    v_lshl_add_u32 v6, v9, 9, v6
    s_branch SCHK_2
SPOLL_1:
    s_load_dwordx8 s[24:31], s[32:33], s15 offset:0 glc
SCHK_2:
    s_add_u32 s5, s5, 1
    s_cmp_ge_u32 s5, 300000
    s_waitcnt lgkmcnt(0)
    s_cbranch_scc1 SDONE_3
    s_cmp_lg_u32 s24, s4
    s_cbranch_scc1 SPOLL_1
    s_cmp_lg_u32 s25, s4
    s_cbranch_scc1 SPOLL_1
    s_cmp_lg_u32 s28, s4
    s_cbranch_scc1 SPOLL_1
    s_cmp_lg_u32 s29, s4
    s_cbranch_scc1 SPOLL_1
    s_cmp_lg_u32 s30, s4
    s_cbranch_scc1 SPOLL_1
    s_cmp_lg_u32 s31, s4
    s_cbranch_scc1 SPOLL_1
SDONE_3:
    buffer_load_dwordx4 v[120:123], v4, s[32:35], s13 offen sc1
    buffer_load_dwordx2 v[116:117], v8, s[32:35], s14 offen sc1
    s_barrier
    s_lshl_b32 s96, s11, 12
    s_lshl_b32 s97, s3, 9
    s_add_u32 s16, s96, s97
    v_add_u32 v10, s16, v2
    s_lshl_b32 s96, s3, 9
    s_add_u32 m0, s96, 156416
    s_mov_b32 exec_hi, 0
    global_load_lds_dwordx4 v10, s[72:73]
    s_mov_b32 exec_hi, -1
    s_and_b32 s20, s9, 3
    s_add_u32 s96, s20, s85
    s_and_b32 s97, s96, 15
    s_lshl3_add_u32 s98, s97, s3
    s_mul_i32 s99, s98, 49152
    s_lshl_b32 s96, s11, 7
    s_add_u32 s82, s99, s96
    s_mul_i32 s96, s20, 24960
    s_lshr_b32 s97, s3, 1
    s_mul_i32 s98, s97, 2080
    s_add_u32 s99, s96, s98
    s_and_b32 s97, s3, 1
    s_mul_i32 s96, s97, 1056
    s_add_u32 s20, s99, s96
    s_mov_b32 m0, s20
    s_nop 0
    buffer_load_dwordx4 v62, s[40:43], s82 offen lds
    s_add_u32 s82, s82, 2048
    s_add_u32 m0, s20, 8320
    s_nop 0
    buffer_load_dwordx4 v62, s[40:43], s82 offen lds
    s_add_u32 s82, s82, 2048
    s_add_u32 m0, s20, 16640
    s_nop 0
    buffer_load_dwordx4 v62, s[40:43], s82 offen lds
    s_waitcnt vmcnt(5)
    v_bitop3_b32 v7, v121, v123, s4 bitop3:0x7e
    v_cmp_ne_u32 vcc, 0, v7
    s_cbranch_vccz TOK_5
POLL_6:
    buffer_load_dwordx4 v[120:123], v4, s[32:35], s13 offen sc1
    s_waitcnt vmcnt(0)
    v_bitop3_b32 v7, v121, v123, s4 bitop3:0x7e
    v_cmp_ne_u32 vcc, 0, v7
    s_cbranch_vccz PDONE_7
    s_add_u32 s5, s5, 1
    s_cmp_lt_u32 s5, 300000
    s_cbranch_scc1 POLL_6
PDONE_7:
TOK_5:
    ds_write2_b32 v5, v120, v122 offset0:0 offset1:8
    v_lshlrev_b32 v100, 16, v12
    v_and_b32 v101, s6, v12
    v_lshlrev_b32 v102, 16, v13
    v_and_b32 v103, s6, v13
    v_lshlrev_b32 v104, 16, v14
    v_and_b32 v105, s6, v14
    v_lshlrev_b32 v106, 16, v15
    v_and_b32 v107, s6, v15
    v_lshlrev_b32 v108, 16, v16
    v_and_b32 v109, s6, v16
    v_lshlrev_b32 v110, 16, v17
    v_and_b32 v111, s6, v17
    v_lshlrev_b32 v112, 16, v18
    v_and_b32 v113, s6, v18
    v_lshlrev_b32 v114, 16, v19
    v_and_b32 v115, s6, v19
    s_waitcnt lgkmcnt(0)
    s_barrier
    ds_read_b128 v[88:91], v6 offset:2048
    ds_read_b128 v[92:95], v6 offset:2064
    ds_read_b128 v[80:83], v6
    ds_read_b128 v[84:87], v6 offset:16
    s_waitcnt vmcnt(4)
    v_cmp_ne_u32 vcc, s4, v117
    s_cbranch_vccz TOK_8
POLL_9:
    buffer_load_dwordx2 v[116:117], v8, s[32:35], s14 offen sc1
    s_waitcnt vmcnt(0)
    v_cmp_ne_u32 vcc, s4, v117
    s_cbranch_vccz PDONE_10
    s_add_u32 s5, s5, 1
    s_cmp_lt_u32 s5, 300000
    s_cbranch_scc1 POLL_9
PDONE_10:
TOK_8:
    v_lshlrev_b32 v117, 16, v116
    v_and_b32 v116, s6, v116
    v_rcp_f32 v116, v116
    s_nop 0
    v_pk_add_f32 v[100:101], v[100:101], v[116:117] op_sel:[0,1] neg_lo:[0,1] neg_hi:[0,1]
    v_pk_add_f32 v[102:103], v[102:103], v[116:117] op_sel:[0,1] neg_lo:[0,1] neg_hi:[0,1]
    v_pk_add_f32 v[104:105], v[104:105], v[116:117] op_sel:[0,1] neg_lo:[0,1] neg_hi:[0,1]
    v_pk_add_f32 v[106:107], v[106:107], v[116:117] op_sel:[0,1] neg_lo:[0,1] neg_hi:[0,1]
    v_pk_add_f32 v[108:109], v[108:109], v[116:117] op_sel:[0,1] neg_lo:[0,1] neg_hi:[0,1]
    v_pk_add_f32 v[110:111], v[110:111], v[116:117] op_sel:[0,1] neg_lo:[0,1] neg_hi:[0,1]
    v_pk_add_f32 v[112:113], v[112:113], v[116:117] op_sel:[0,1] neg_lo:[0,1] neg_hi:[0,1]
    v_pk_add_f32 v[114:115], v[114:115], v[116:117] op_sel:[0,1] neg_lo:[0,1] neg_hi:[0,1]
    s_lshl4_add_u32 s96, s21, s12
    s_and_b32 s97, s3, 3
    s_lshl2_add_u32 s98, s96, s97
    s_lshl1_add_u32 s99, s98, s76
    s_lshl_b32 s96, s99, 11
    s_add_u32 s13, s96, 4194304
    v_and_b32 v8, 15, v1
    v_lshlrev_b32 v8, 4, v8
    v_bfe_u32 v9, v1, 4, 1
    v_lshl_add_u32 v8, v9, 10, v8
    v_lshrrev_b32 v9, 5, v1
    v_lshl_add_u32 v8, v9, 9, v8
    s_waitcnt lgkmcnt(2)
    v_pk_add_f32 v[88:89], v[88:89], v[90:91]
    v_pk_add_f32 v[92:93], v[92:93], v[94:95]
    v_pk_add_f32 v[88:89], v[88:89], v[92:93]
    v_add_f32 v88, v88, v89
    v_cvt_pk_bf16_f32 v88, 0, v88
    s_waitcnt lgkmcnt(0)
    v_pk_add_f32 v[80:81], v[80:81], v[82:83]
    v_pk_add_f32 v[84:85], v[84:85], v[86:87]
    v_pk_add_f32 v[80:81], v[80:81], v[84:85]
    v_add_f32 v80, v80, v81
    v_add_f32 v88, 1.0, v88
    v_cvt_pk_bf16_f32 v88, 0, v88
    v_cvt_pk_bf16_f32 v80, 0, v80
    s_lshl_b32 s96, s3, 8
    s_add_u32 s16, s96, 160512
    v_and_b32 v4, 15, v1
    v_lshl_add_u32 v4, v4, 2, s16
    v_lshrrev_b32 v9, 5, v1
    v_lshl_add_u32 v4, v9, 6, v4
    v_lshrrev_b32 v5, 5, v1
    v_lshl_add_u32 v5, v5, 6, s16
    ds_write2_b32 v4, v88, v80 offset0:0 offset1:32
    ds_read_b128 v[132:135], v5
    ds_read_b128 v[136:139], v5 offset:16
    ds_read_b128 v[140:143], v5 offset:32
    ds_read_b128 v[144:147], v5 offset:48
    ds_read_b128 v[148:151], v5 offset:128
    ds_read_b128 v[152:155], v5 offset:144
    ds_read_b128 v[156:159], v5 offset:160
    ds_read_b128 v[160:163], v5 offset:176
    v_cvt_pk_bf16_f32 v100, 0, v100
    v_cvt_pk_bf16_f32 v101, 0, v101
    v_cvt_pk_bf16_f32 v102, 0, v102
    v_cvt_pk_bf16_f32 v103, 0, v103
    v_cvt_pk_bf16_f32 v104, 0, v104
    v_cvt_pk_bf16_f32 v105, 0, v105
    v_cvt_pk_bf16_f32 v106, 0, v106
    v_cvt_pk_bf16_f32 v107, 0, v107
    v_pk_mul_f32 v[100:101], v[100:101], v[116:117] op_sel_hi:[1,0]
    v_pk_mul_f32 v[102:103], v[102:103], v[116:117] op_sel_hi:[1,0]
    v_pk_mul_f32 v[104:105], v[104:105], v[116:117] op_sel_hi:[1,0]
    v_pk_mul_f32 v[106:107], v[106:107], v[116:117] op_sel_hi:[1,0]
    v_cvt_pk_bf16_f32 v100, 0, v100
    v_cvt_pk_bf16_f32 v101, 0, v101
    v_cvt_pk_bf16_f32 v102, 0, v102
    v_cvt_pk_bf16_f32 v103, 0, v103
    v_cvt_pk_bf16_f32 v104, 0, v104
    v_cvt_pk_bf16_f32 v105, 0, v105
    v_cvt_pk_bf16_f32 v106, 0, v106
    v_cvt_pk_bf16_f32 v107, 0, v107
    v_cvt_pk_bf16_f32 v108, 0, v108
    v_cvt_pk_bf16_f32 v109, 0, v109
    v_cvt_pk_bf16_f32 v110, 0, v110
    v_cvt_pk_bf16_f32 v111, 0, v111
    v_cvt_pk_bf16_f32 v112, 0, v112
    v_cvt_pk_bf16_f32 v113, 0, v113
    v_cvt_pk_bf16_f32 v114, 0, v114
    v_cvt_pk_bf16_f32 v115, 0, v115
    v_pk_mul_f32 v[108:109], v[108:109], v[116:117] op_sel_hi:[1,0]
    v_pk_mul_f32 v[110:111], v[110:111], v[116:117] op_sel_hi:[1,0]
    v_pk_mul_f32 v[112:113], v[112:113], v[116:117] op_sel_hi:[1,0]
    v_pk_mul_f32 v[114:115], v[114:115], v[116:117] op_sel_hi:[1,0]
    v_cvt_pk_bf16_f32 v108, 0, v108
    v_cvt_pk_bf16_f32 v109, 0, v109
    v_cvt_pk_bf16_f32 v110, 0, v110
    v_cvt_pk_bf16_f32 v111, 0, v111
    v_cvt_pk_bf16_f32 v112, 0, v112
    v_cvt_pk_bf16_f32 v113, 0, v113
    v_cvt_pk_bf16_f32 v114, 0, v114
    v_cvt_pk_bf16_f32 v115, 0, v115
    s_waitcnt lgkmcnt(6)
    v_pk_mul_f32 v[100:101], v[100:101], v[132:133]
    v_pk_mul_f32 v[102:103], v[102:103], v[134:135]
    v_pk_mul_f32 v[104:105], v[104:105], v[136:137]
    v_pk_mul_f32 v[106:107], v[106:107], v[138:139]
    v_cvt_pk_bf16_f32 v100, 0, v100
    v_cvt_pk_bf16_f32 v101, 0, v101
    v_cvt_pk_bf16_f32 v102, 0, v102
    v_cvt_pk_bf16_f32 v103, 0, v103
    v_cvt_pk_bf16_f32 v104, 0, v104
    v_cvt_pk_bf16_f32 v105, 0, v105
    v_cvt_pk_bf16_f32 v106, 0, v106
    v_cvt_pk_bf16_f32 v107, 0, v107
    s_waitcnt lgkmcnt(2)
    v_pk_add_f32 v[100:101], v[100:101], v[148:149]
    v_pk_add_f32 v[102:103], v[102:103], v[150:151]
    v_pk_add_f32 v[104:105], v[104:105], v[152:153]
    v_pk_add_f32 v[106:107], v[106:107], v[154:155]
    v_cvt_pk_bf16_f32 v124, v100, v101
    v_cvt_pk_bf16_f32 v125, v102, v103
    v_cvt_pk_bf16_f32 v126, v104, v105
    v_cvt_pk_bf16_f32 v127, v106, v107
    buffer_store_dwordx4 v[124:127], v8, s[32:35], s13 offen sc1
    v_pk_mul_f32 v[108:109], v[108:109], v[140:141]
    v_pk_mul_f32 v[110:111], v[110:111], v[142:143]
    v_pk_mul_f32 v[112:113], v[112:113], v[144:145]
    v_pk_mul_f32 v[114:115], v[114:115], v[146:147]
    v_cvt_pk_bf16_f32 v108, 0, v108
    v_cvt_pk_bf16_f32 v109, 0, v109
    v_cvt_pk_bf16_f32 v110, 0, v110
    v_cvt_pk_bf16_f32 v111, 0, v111
    v_cvt_pk_bf16_f32 v112, 0, v112
    v_cvt_pk_bf16_f32 v113, 0, v113
    v_cvt_pk_bf16_f32 v114, 0, v114
    v_cvt_pk_bf16_f32 v115, 0, v115
    s_waitcnt lgkmcnt(0)
    v_pk_add_f32 v[108:109], v[108:109], v[156:157]
    v_pk_add_f32 v[110:111], v[110:111], v[158:159]
    v_pk_add_f32 v[112:113], v[112:113], v[160:161]
    v_pk_add_f32 v[114:115], v[114:115], v[162:163]
    v_cvt_pk_bf16_f32 v128, v108, v109
    v_cvt_pk_bf16_f32 v129, v110, v111
    v_cvt_pk_bf16_f32 v130, v112, v113
    v_cvt_pk_bf16_f32 v131, v114, v115
    buffer_store_dwordx4 v[128:131], v8, s[32:35], s13 offen offset:256 sc1
    v_lshrrev_b32 v66, 5, v1
    v_mul_u32_u24 v66, 2080, v66
    v_bfe_u32 v9, v1, 2, 2
    v_lshl_add_u32 v66, v9, 7, v66
    v_bfe_u32 v9, v1, 3, 1
    v_lshl_add_u32 v66, v9, 6, v66
    v_and_b32 v9, 3, v1
    v_lshl_add_u32 v66, v9, 3, v66
    v_bfe_u32 v67, v1, 4, 1
    v_mul_u32_u24 v67, 1056, v67
    v_bfe_u32 v68, v1, 3, 1
    v_lshlrev_b32 v68, 7, v68
    v_add_u32 v66, v66, v67
    v_sub_u32 v67, v66, v68
    v_add_u32 v67, 64, v67
    v_add_u32 v68, 49920, v66
    v_add_u32 v69, 49920, v67
    v_add_u32 v70, 99840, v66
    v_add_u32 v71, 99840, v67
    s_lshl_b32 s96, s76, 11
    s_add_u32 s14, s96, 156416
    v_bfe_u32 v4, v1, 2, 2
    v_lshl_add_u32 v4, v4, 6, s14
    v_bfe_u32 v9, v1, 4, 1
    v_lshl_add_u32 v4, v9, 5, v4
    v_and_b32 v9, 3, v1
    v_lshl_add_u32 v4, v9, 3, v4
    v_lshrrev_b32 v9, 5, v1
    v_lshl_add_u32 v4, v9, 9, v4
    v_and_b32 v5, 7, v1
    v_lshlrev_b32 v5, 12, v5
    v_bfe_u32 v9, v1, 3, 1
    v_lshl_add_u32 v5, v9, 19, v5
    s_and_b32 s96, s12, 1
    s_lshl_b32 s97, s21, 15
    s_lshr_b32 s98, s12, 1
    s_lshl_b32 s99, s98, 6
    s_add_u32 s98, s97, s99
    s_lshl2_add_u32 s97, s96, s98
    s_add_u32 s13, s97, 1048576
    v_bfe_u32 v6, v1, 4, 1
    v_lshlrev_b32 v6, 6, v6
    v_lshrrev_b32 v9, 5, v1
    v_lshl_add_u32 v6, v9, 4, v6
    v_and_b32 v74, 7, v1
    v_lshlrev_b32 v74, 4, v74
    v_xor_b32 v74, v74, v6
    v_lshrrev_b32 v6, 3, v1
    v_lshlrev_b32 v6, 11, v6
    v_add_u32 v74, v74, v6
    s_and_b32 s96, s3, 2
    s_lshl_b32 s14, s96, 5
    v_bfe_u32 v6, v1, 4, 1
    v_lshl_add_u32 v6, v6, 5, s14
    v_and_b32 v72, 7, v1
    v_lshlrev_b32 v72, 4, v72
    v_xor_b32 v72, v72, v6
    v_lshrrev_b32 v6, 3, v1
    v_mul_u32_u24 v6, 7168, v6
    v_add_u32 v72, v72, v6
    s_and_b32 s96, s3, 1
    s_lshl_b32 s14, s96, 7
    v_lshrrev_b32 v6, 5, v1
    v_lshl_add_u32 v6, v6, 6, s14
    v_and_b32 v73, 31, v1
    v_lshlrev_b32 v73, 4, v73
    v_lshrrev_b32 v9, 5, v1
    v_lshl_add_u32 v73, v9, 11, v73
    v_xor_b32 v73, v73, v6
    s_lshl3_add_u32 s96, s75, s3
    s_mul_i32 s97, s96, 229376
    s_lshl_b32 s98, s74, 7
    s_add_u32 s80, s97, s98
    s_lshl3_add_u32 s96, s74, s3
    s_lshl_b32 s97, s96, 14
    s_lshl_b32 s98, s75, 9
    s_add_u32 s81, s97, s98
    s_cmp_ge_u32 s9, 28
    s_cselect_b32 s54, 0, s54
    s_cselect_b32 s58, 0, s58
    s_cselect_b32 s62, 0, s62
    s_waitcnt vmcnt(0)
    s_barrier
    s_cmp_lg_u32 s3, 0
    s_cbranch_scc1 L_PB
    v_mov_b32 v6, s4
    s_mov_b32 exec_hi, 0
    s_mov_b32 exec_lo, 65535
    buffer_store_dword v6, v5, s[32:35], s13 offen sc1
    s_mov_b64 exec, -1
L_PB:
    s_and_b32 s20, s9, 3
    s_cmp_le_u32 s20, 0
    s_cselect_b32 s20, 1, 0
    s_add_u32 s96, s20, s85
    s_and_b32 s97, s96, 15
    s_lshl3_add_u32 s98, s97, s3
    s_mul_i32 s99, s98, 49152
    s_lshl_b32 s96, s11, 7
    s_add_u32 s82, s99, s96
    s_mul_i32 s96, s20, 24960
    s_lshr_b32 s97, s3, 1
    s_mul_i32 s98, s97, 2080
    s_add_u32 s99, s96, s98
    s_and_b32 s97, s3, 1
    s_mul_i32 s96, s97, 1056
    s_add_u32 s20, s99, s96
    s_mov_b32 m0, s20
    s_nop 0
    buffer_load_dwordx4 v62, s[40:43], s82 offen lds
    s_add_u32 s82, s82, 2048
    s_add_u32 m0, s20, 8320
    s_nop 0
    buffer_load_dwordx4 v62, s[40:43], s82 offen lds
    s_add_u32 s82, s82, 2048
    s_add_u32 m0, s20, 16640
    s_nop 0
    buffer_load_dwordx4 v62, s[40:43], s82 offen lds
    s_and_b32 s20, s9, 3
    s_cmp_le_u32 s20, 1
    s_cselect_b32 s20, 2, 1
    s_add_u32 s96, s20, s85
    s_and_b32 s97, s96, 15
    s_lshl3_add_u32 s98, s97, s3
    s_mul_i32 s99, s98, 49152
    s_lshl_b32 s96, s11, 7
    s_add_u32 s82, s99, s96
    s_mul_i32 s96, s20, 24960
    s_lshr_b32 s97, s3, 1
    s_mul_i32 s98, s97, 2080
    s_add_u32 s99, s96, s98
    s_and_b32 s97, s3, 1
    s_mul_i32 s96, s97, 1056
    s_add_u32 s20, s99, s96
    s_mov_b32 m0, s20
    s_nop 0
    buffer_load_dwordx4 v62, s[40:43], s82 offen lds
    s_add_u32 s82, s82, 2048
    s_add_u32 m0, s20, 8320
    s_nop 0
    buffer_load_dwordx4 v62, s[40:43], s82 offen lds
    s_add_u32 s82, s82, 2048
    s_add_u32 m0, s20, 16640
    s_nop 0
    buffer_load_dwordx4 v62, s[40:43], s82 offen lds
    ds_read_b64_tr_b16 v[28:29], v4
    ds_read_b64_tr_b16 v[30:31], v4 offset:256
    ds_read_b64_tr_b16 v[32:33], v4 offset:1024
    ds_read_b64_tr_b16 v[34:35], v4 offset:1280
    s_lshl_b32 s96, s10, 6
    s_add_u32 s97, s96, s3
    s_lshl_b32 s98, s97, 12
    s_add_u32 s15, s98, 4194304
    s_and_b32 s96, s3, 3
    s_lshl_b32 s97, s96, 12
    s_add_u32 s13, s97, 147456
    v_add_u32 v76, s13, v2
    v_and_b32 v77, 15, v1
    v_lshl_add_u32 v77, v77, 4, s13
    v_lshrrev_b32 v9, 5, v1
    v_lshl_add_u32 v77, v9, 9, v77
    v_bfe_u32 v9, v1, 4, 1
    v_lshl_add_u32 v77, v9, 3, v77
    s_and_b32 s96, s3, 3
    s_lshl_b32 s97, s96, 10
    s_add_u32 s13, s97, 32768
    v_and_b32 v78, 15, v1
    v_lshl_add_u32 v78, v78, 5, s13
    v_lshrrev_b32 v9, 4, v1
    v_lshl_add_u32 v78, v9, 3, v78
    s_and_b32 s96, s3, 3
    s_lshl_b32 s97, s96, 10
    s_lshl_b32 s98, s76, 14
    s_add_u32 s13, s97, s98
    v_and_b32 v75, 31, v1
    v_lshl_add_u32 v75, v75, 5, s13
    v_lshrrev_b32 v9, 5, v1
    v_lshl_add_u32 v75, v9, 4, v75
    s_lshl_b32 s84, s3, 14
    s_lshr_b32 s96, s9, 4
    s_lshl_b32 s97, s96, 20
    s_lshl_b32 s98, s12, 7
    s_add_u32 s88, s97, s98
    s_lshl_b32 s89, s3, 10
    s_load_dwordx2 s[24:25], s[32:33], s92 offset:0 glc
    s_and_b32 s20, s9, 3
    s_cmp_le_u32 s20, 2
    s_cselect_b32 s20, 3, 2
    s_add_u32 s96, s20, s85
    s_and_b32 s97, s96, 15
    s_lshl3_add_u32 s98, s97, s3
    s_mul_i32 s99, s98, 49152
    s_lshl_b32 s96, s11, 7
    s_add_u32 s82, s99, s96
    s_mul_i32 s96, s20, 24960
    s_lshr_b32 s97, s3, 1
    s_mul_i32 s98, s97, 2080
    s_add_u32 s99, s96, s98
    s_and_b32 s97, s3, 1
    s_mul_i32 s96, s97, 1056
    s_add_u32 s20, s99, s96
    s_mov_b32 m0, s20
    s_nop 0
    buffer_load_dwordx4 v62, s[40:43], s82 offen lds
    s_add_u32 s82, s82, 2048
    s_add_u32 m0, s20, 8320
    s_nop 0
    buffer_load_dwordx4 v62, s[40:43], s82 offen lds
    s_add_u32 s82, s82, 2048
    s_add_u32 m0, s20, 16640
    s_nop 0
    buffer_load_dwordx4 v62, s[40:43], s82 offen lds
    s_add_u32 s96, s85, 4
    s_and_b32 s97, s96, 15
    s_lshl3_add_u32 s98, s97, s3
    s_mul_i32 s99, s98, 49152
    s_lshl_b32 s96, s11, 7
    s_add_u32 s82, s99, s96
    s_lshr_b32 s96, s3, 1
    s_mul_i32 s97, s96, 2080
    s_and_b32 s98, s3, 1
    s_mul_i32 s99, s98, 1056
    s_add_u32 s96, s97, s99
    s_add_u32 s20, s96, 99840
    s_mov_b32 m0, s20
    s_nop 0
    buffer_load_dwordx4 v62, s[40:43], s82 offen lds
    s_add_u32 s82, s82, 2048
    s_add_u32 m0, s20, 8320
    s_nop 0
    buffer_load_dwordx4 v62, s[40:43], s82 offen lds
    s_add_u32 s82, s82, 2048
    s_add_u32 m0, s20, 16640
    s_nop 0
    buffer_load_dwordx4 v62, s[40:43], s82 offen lds
    s_branch SCHK_12
SPOLL_11:
    s_load_dwordx2 s[24:25], s[32:33], s92 offset:0 glc
SCHK_12:
    s_add_u32 s5, s5, 1
    s_cmp_ge_u32 s5, 300000
    s_waitcnt lgkmcnt(0)
    s_cbranch_scc1 SDONE_13
    s_cmp_lg_u32 s24, s4
    s_cbranch_scc1 SPOLL_11
    s_cmp_lg_u32 s25, s4
    s_cbranch_scc1 SPOLL_11
SDONE_13:
    s_waitcnt vmcnt(9)
    s_barrier
    s_cmp_ge_u32 s3, 4
    s_cbranch_scc1 L_HELP
    s_setprio 2
    s_and_b32 s96, s85, 15
    s_lshl_b32 s97, s96, 14
    s_add_u32 s16, s97, s15
    buffer_load_dwordx4 v[176:179], v2, s[32:35], s16 offen sc1
    buffer_load_dwordx4 v[180:183], v2, s[32:35], s16 offen offset:1024 sc1
    ds_read_b64_tr_b16 v[224:225], v67 offset:8320
    ds_read_b64_tr_b16 v[226:227], v67 offset:8832
    ds_read_b64_tr_b16 v[228:229], v67 offset:8352
    ds_read_b64_tr_b16 v[230:231], v67 offset:8864
    ds_read_b64_tr_b16 v[232:233], v66 offset:8320
    ds_read_b64_tr_b16 v[234:235], v66 offset:8832
    ds_read_b64_tr_b16 v[236:237], v66 offset:8352
    ds_read_b64_tr_b16 v[238:239], v66 offset:8864
    ds_read_b64_tr_b16 v[240:241], v66
    ds_read_b64_tr_b16 v[242:243], v66 offset:512
    ds_read_b64_tr_b16 v[244:245], v66 offset:32
    ds_read_b64_tr_b16 v[246:247], v66 offset:544
    buffer_load_dwordx4 v[184:187], v2, s[32:35], s16 offen offset:2048 sc1
    buffer_load_dwordx4 v[188:191], v2, s[32:35], s16 offen offset:3072 sc1
    s_waitcnt lgkmcnt(8)
    s_waitcnt vmcnt(3)
    v_mfma_f32_16x16x32_bf16 v[128:131], v[224:227], v[176:179], 0
    ds_read_b64_tr_b16 v[248:249], v67
    s_waitcnt vmcnt(2)
    v_mfma_f32_16x16x32_bf16 v[132:135], v[224:227], v[180:183], 0
    ds_read_b64_tr_b16 v[250:251], v67 offset:512
    s_add_u32 s96, s85, 1
    s_and_b32 s97, s96, 15
    s_lshl_b32 s98, s97, 14
    s_add_u32 s16, s98, s15
    buffer_load_dwordx4 v[192:195], v2, s[32:35], s16 offen sc1
    v_mfma_f32_16x16x32_bf16 v[136:139], v[228:231], v[176:179], 0
    ds_read_b64_tr_b16 v[224:225], v67 offset:32
    v_mfma_f32_16x16x32_bf16 v[140:143], v[228:231], v[180:183], 0
    ds_read_b64_tr_b16 v[226:227], v67 offset:544
    s_waitcnt lgkmcnt(8)
    v_mfma_f32_16x16x32_bf16 v[112:115], v[232:235], v[176:179], 0
    ds_read_b64_tr_b16 v[228:229], v66 offset:16640
    v_mfma_f32_16x16x32_bf16 v[116:119], v[232:235], v[180:183], 0
    ds_read_b64_tr_b16 v[230:231], v66 offset:17152
    v_mfma_f32_16x16x32_bf16 v[120:123], v[236:239], v[176:179], 0
    ds_read_b64_tr_b16 v[232:233], v66 offset:16672
    v_mfma_f32_16x16x32_bf16 v[124:127], v[236:239], v[180:183], 0
    ds_read_b64_tr_b16 v[234:235], v66 offset:17184
    buffer_load_dwordx4 v[196:199], v2, s[32:35], s16 offen offset:1024 sc1
    s_waitcnt lgkmcnt(8)
    v_mfma_f32_16x16x32_bf16 v[80:83], v[240:243], v[176:179], 0
    ds_read_b64_tr_b16 v[236:237], v67 offset:16640
    v_mfma_f32_16x16x32_bf16 v[84:87], v[240:243], v[180:183], 0
    ds_read_b64_tr_b16 v[238:239], v67 offset:17152
    v_mfma_f32_16x16x32_bf16 v[88:91], v[244:247], v[176:179], 0
    ds_read_b64_tr_b16 v[240:241], v67 offset:16672
    v_mfma_f32_16x16x32_bf16 v[92:95], v[244:247], v[180:183], 0
    ds_read_b64_tr_b16 v[242:243], v67 offset:17184
    s_waitcnt lgkmcnt(8)
    v_mfma_f32_16x16x32_bf16 v[96:99], v[248:251], v[176:179], 0
    ds_read_b64_tr_b16 v[244:245], v67 offset:12480
    v_mfma_f32_16x16x32_bf16 v[100:103], v[248:251], v[180:183], 0
    ds_read_b64_tr_b16 v[246:247], v67 offset:12992
    buffer_load_dwordx4 v[200:203], v2, s[32:35], s16 offen offset:2048 sc1
    v_mfma_f32_16x16x32_bf16 v[104:107], v[224:227], v[176:179], 0
    ds_read_b64_tr_b16 v[248:249], v67 offset:12512
    v_mfma_f32_16x16x32_bf16 v[108:111], v[224:227], v[180:183], 0
    ds_read_b64_tr_b16 v[250:251], v67 offset:13024
    s_waitcnt lgkmcnt(8)
    v_mfma_f32_16x16x32_bf16 v[144:147], v[228:231], v[176:179], 0
    ds_read_b64_tr_b16 v[224:225], v66 offset:12480
    v_mfma_f32_16x16x32_bf16 v[148:151], v[228:231], v[180:183], 0
    ds_read_b64_tr_b16 v[226:227], v66 offset:12992
    v_mfma_f32_16x16x32_bf16 v[152:155], v[232:235], v[176:179], 0
    ds_read_b64_tr_b16 v[228:229], v66 offset:12512
    v_mfma_f32_16x16x32_bf16 v[156:159], v[232:235], v[180:183], 0
    ds_read_b64_tr_b16 v[230:231], v66 offset:13024
    buffer_load_dwordx4 v[204:207], v2, s[32:35], s16 offen offset:3072 sc1
    s_waitcnt lgkmcnt(8)
    v_mfma_f32_16x16x32_bf16 v[160:163], v[236:239], v[176:179], 0
    ds_read_b64_tr_b16 v[232:233], v66 offset:4160
    v_mfma_f32_16x16x32_bf16 v[164:167], v[236:239], v[180:183], 0
    ds_read_b64_tr_b16 v[234:235], v66 offset:4672
    v_mfma_f32_16x16x32_bf16 v[168:171], v[240:243], v[176:179], 0
    ds_read_b64_tr_b16 v[236:237], v66 offset:4192
    v_mfma_f32_16x16x32_bf16 v[172:175], v[240:243], v[180:183], 0
    ds_read_b64_tr_b16 v[238:239], v66 offset:4704
    s_waitcnt lgkmcnt(8)
    s_waitcnt vmcnt(5)
    v_mfma_f32_16x16x32_bf16 v[128:131], v[244:247], v[184:187], v[128:131]
    ds_read_b64_tr_b16 v[240:241], v67 offset:4160
    s_waitcnt vmcnt(4)
    v_mfma_f32_16x16x32_bf16 v[132:135], v[244:247], v[188:191], v[132:135]
    ds_read_b64_tr_b16 v[242:243], v67 offset:4672
    s_add_u32 s96, s85, 2
    s_and_b32 s97, s96, 15
    s_lshl_b32 s98, s97, 14
    s_add_u32 s16, s98, s15
    buffer_load_dwordx4 v[208:211], v2, s[32:35], s16 offen sc1
    v_mfma_f32_16x16x32_bf16 v[136:139], v[248:251], v[184:187], v[136:139]
    ds_read_b64_tr_b16 v[244:245], v67 offset:4192
    v_mfma_f32_16x16x32_bf16 v[140:143], v[248:251], v[188:191], v[140:143]
    ds_read_b64_tr_b16 v[246:247], v67 offset:4704
    s_waitcnt lgkmcnt(8)
    v_mfma_f32_16x16x32_bf16 v[112:115], v[224:227], v[184:187], v[112:115]
    ds_read_b64_tr_b16 v[248:249], v66 offset:20800
    v_mfma_f32_16x16x32_bf16 v[116:119], v[224:227], v[188:191], v[116:119]
    ds_read_b64_tr_b16 v[250:251], v66 offset:21312
    v_mfma_f32_16x16x32_bf16 v[120:123], v[228:231], v[184:187], v[120:123]
    ds_read_b64_tr_b16 v[224:225], v66 offset:20832
    v_mfma_f32_16x16x32_bf16 v[124:127], v[228:231], v[188:191], v[124:127]
    ds_read_b64_tr_b16 v[226:227], v66 offset:21344
    buffer_load_dwordx4 v[212:215], v2, s[32:35], s16 offen offset:1024 sc1
    s_waitcnt lgkmcnt(8)
    v_mfma_f32_16x16x32_bf16 v[80:83], v[232:235], v[184:187], v[80:83]
    ds_read_b64_tr_b16 v[228:229], v67 offset:20800
    v_mfma_f32_16x16x32_bf16 v[84:87], v[232:235], v[188:191], v[84:87]
    ds_read_b64_tr_b16 v[230:231], v67 offset:21312
    v_mfma_f32_16x16x32_bf16 v[88:91], v[236:239], v[184:187], v[88:91]
    ds_read_b64_tr_b16 v[232:233], v67 offset:20832
    v_mfma_f32_16x16x32_bf16 v[92:95], v[236:239], v[188:191], v[92:95]
    ds_read_b64_tr_b16 v[234:235], v67 offset:21344
    s_waitcnt lgkmcnt(8)
    v_mfma_f32_16x16x32_bf16 v[96:99], v[240:243], v[184:187], v[96:99]
    s_barrier
    ds_read_b64_tr_b16 v[236:237], v67 offset:33280
    v_mfma_f32_16x16x32_bf16 v[100:103], v[240:243], v[188:191], v[100:103]
    ds_read_b64_tr_b16 v[238:239], v67 offset:33792
    buffer_load_dwordx4 v[216:219], v2, s[32:35], s16 offen offset:2048 sc1
    v_mfma_f32_16x16x32_bf16 v[104:107], v[244:247], v[184:187], v[104:107]
    ds_read_b64_tr_b16 v[240:241], v67 offset:33312
    v_mfma_f32_16x16x32_bf16 v[108:111], v[244:247], v[188:191], v[108:111]
    ds_read_b64_tr_b16 v[242:243], v67 offset:33824
    s_waitcnt lgkmcnt(8)
    v_mfma_f32_16x16x32_bf16 v[144:147], v[248:251], v[184:187], v[144:147]
    ds_read_b64_tr_b16 v[244:245], v66 offset:33280
    v_mfma_f32_16x16x32_bf16 v[148:151], v[248:251], v[188:191], v[148:151]
    ds_read_b64_tr_b16 v[246:247], v66 offset:33792
    v_mfma_f32_16x16x32_bf16 v[152:155], v[224:227], v[184:187], v[152:155]
    ds_read_b64_tr_b16 v[248:249], v66 offset:33312
    v_mfma_f32_16x16x32_bf16 v[156:159], v[224:227], v[188:191], v[156:159]
    ds_read_b64_tr_b16 v[250:251], v66 offset:33824
    buffer_load_dwordx4 v[220:223], v2, s[32:35], s16 offen offset:3072 sc1
    s_waitcnt lgkmcnt(8)
    v_mfma_f32_16x16x32_bf16 v[160:163], v[228:231], v[184:187], v[160:163]
    ds_read_b64_tr_b16 v[224:225], v66 offset:24960
    v_mfma_f32_16x16x32_bf16 v[164:167], v[228:231], v[188:191], v[164:167]
    ds_read_b64_tr_b16 v[226:227], v66 offset:25472
    v_mfma_f32_16x16x32_bf16 v[168:171], v[232:235], v[184:187], v[168:171]
    ds_read_b64_tr_b16 v[228:229], v66 offset:24992
    v_mfma_f32_16x16x32_bf16 v[172:175], v[232:235], v[188:191], v[172:175]
    ds_read_b64_tr_b16 v[230:231], v66 offset:25504
    s_waitcnt lgkmcnt(8)
    s_waitcnt vmcnt(6)
    v_mfma_f32_16x16x32_bf16 v[128:131], v[236:239], v[192:195], v[128:131]
    ds_read_b64_tr_b16 v[232:233], v67 offset:24960
    v_mfma_f32_16x16x32_bf16 v[132:135], v[236:239], v[196:199], v[132:135]
    ds_read_b64_tr_b16 v[234:235], v67 offset:25472
    s_add_u32 s96, s85, 3
    s_and_b32 s97, s96, 15
    s_lshl_b32 s98, s97, 14
    s_add_u32 s16, s98, s15
    buffer_load_dwordx4 v[176:179], v2, s[32:35], s16 offen sc1
    v_mfma_f32_16x16x32_bf16 v[136:139], v[240:243], v[192:195], v[136:139]
    ds_read_b64_tr_b16 v[236:237], v67 offset:24992
    v_mfma_f32_16x16x32_bf16 v[140:143], v[240:243], v[196:199], v[140:143]
    ds_read_b64_tr_b16 v[238:239], v67 offset:25504
    s_waitcnt lgkmcnt(8)
    v_mfma_f32_16x16x32_bf16 v[112:115], v[244:247], v[192:195], v[112:115]
    ds_read_b64_tr_b16 v[240:241], v66 offset:41600
    v_mfma_f32_16x16x32_bf16 v[116:119], v[244:247], v[196:199], v[116:119]
    ds_read_b64_tr_b16 v[242:243], v66 offset:42112
    v_mfma_f32_16x16x32_bf16 v[120:123], v[248:251], v[192:195], v[120:123]
    ds_read_b64_tr_b16 v[244:245], v66 offset:41632
    v_mfma_f32_16x16x32_bf16 v[124:127], v[248:251], v[196:199], v[124:127]
    ds_read_b64_tr_b16 v[246:247], v66 offset:42144
    buffer_load_dwordx4 v[180:183], v2, s[32:35], s16 offen offset:1024 sc1
    s_waitcnt lgkmcnt(8)
    v_mfma_f32_16x16x32_bf16 v[80:83], v[224:227], v[192:195], v[80:83]
    ds_read_b64_tr_b16 v[248:249], v67 offset:41600
    v_mfma_f32_16x16x32_bf16 v[84:87], v[224:227], v[196:199], v[84:87]
    ds_read_b64_tr_b16 v[250:251], v67 offset:42112
    v_mfma_f32_16x16x32_bf16 v[88:91], v[228:231], v[192:195], v[88:91]
    ds_read_b64_tr_b16 v[224:225], v67 offset:41632
    v_mfma_f32_16x16x32_bf16 v[92:95], v[228:231], v[196:199], v[92:95]
    ds_read_b64_tr_b16 v[226:227], v67 offset:42144
    s_waitcnt lgkmcnt(8)
    v_mfma_f32_16x16x32_bf16 v[96:99], v[232:235], v[192:195], v[96:99]
    ds_read_b64_tr_b16 v[228:229], v67 offset:37440
    v_mfma_f32_16x16x32_bf16 v[100:103], v[232:235], v[196:199], v[100:103]
    ds_read_b64_tr_b16 v[230:231], v67 offset:37952
    buffer_load_dwordx4 v[184:187], v2, s[32:35], s16 offen offset:2048 sc1
    v_mfma_f32_16x16x32_bf16 v[104:107], v[236:239], v[192:195], v[104:107]
    ds_read_b64_tr_b16 v[232:233], v67 offset:37472
    v_mfma_f32_16x16x32_bf16 v[108:111], v[236:239], v[196:199], v[108:111]
    ds_read_b64_tr_b16 v[234:235], v67 offset:37984
    s_waitcnt lgkmcnt(8)
    v_mfma_f32_16x16x32_bf16 v[144:147], v[240:243], v[192:195], v[144:147]
    ds_read_b64_tr_b16 v[236:237], v66 offset:37440
    v_mfma_f32_16x16x32_bf16 v[148:151], v[240:243], v[196:199], v[148:151]
    ds_read_b64_tr_b16 v[238:239], v66 offset:37952
    v_mfma_f32_16x16x32_bf16 v[152:155], v[244:247], v[192:195], v[152:155]
    ds_read_b64_tr_b16 v[240:241], v66 offset:37472
    v_mfma_f32_16x16x32_bf16 v[156:159], v[244:247], v[196:199], v[156:159]
    ds_read_b64_tr_b16 v[242:243], v66 offset:37984
    buffer_load_dwordx4 v[188:191], v2, s[32:35], s16 offen offset:3072 sc1
    s_waitcnt lgkmcnt(8)
    v_mfma_f32_16x16x32_bf16 v[160:163], v[248:251], v[192:195], v[160:163]
    ds_read_b64_tr_b16 v[244:245], v66 offset:29120
    v_mfma_f32_16x16x32_bf16 v[164:167], v[248:251], v[196:199], v[164:167]
    ds_read_b64_tr_b16 v[246:247], v66 offset:29632
    v_mfma_f32_16x16x32_bf16 v[168:171], v[224:227], v[192:195], v[168:171]
    ds_read_b64_tr_b16 v[248:249], v66 offset:29152
    v_mfma_f32_16x16x32_bf16 v[172:175], v[224:227], v[196:199], v[172:175]
    ds_read_b64_tr_b16 v[250:251], v66 offset:29664
    s_waitcnt lgkmcnt(8)
    s_waitcnt vmcnt(8)
    v_mfma_f32_16x16x32_bf16 v[128:131], v[228:231], v[200:203], v[128:131]
    ds_read_b64_tr_b16 v[224:225], v67 offset:29120
    v_mfma_f32_16x16x32_bf16 v[132:135], v[228:231], v[204:207], v[132:135]
    ds_read_b64_tr_b16 v[226:227], v67 offset:29632
    s_add_u32 s96, s85, 4
    s_and_b32 s97, s96, 15
    s_lshl_b32 s98, s97, 14
    s_add_u32 s16, s98, s15
    buffer_load_dwordx4 v[192:195], v2, s[32:35], s16 offen sc1
    v_mfma_f32_16x16x32_bf16 v[136:139], v[232:235], v[200:203], v[136:139]
    ds_read_b64_tr_b16 v[228:229], v67 offset:29152
    v_mfma_f32_16x16x32_bf16 v[140:143], v[232:235], v[204:207], v[140:143]
    ds_read_b64_tr_b16 v[230:231], v67 offset:29664
    s_waitcnt lgkmcnt(8)
    v_mfma_f32_16x16x32_bf16 v[112:115], v[236:239], v[200:203], v[112:115]
    ds_read_b64_tr_b16 v[232:233], v66 offset:45760
    v_mfma_f32_16x16x32_bf16 v[116:119], v[236:239], v[204:207], v[116:119]
    ds_read_b64_tr_b16 v[234:235], v66 offset:46272
    v_mfma_f32_16x16x32_bf16 v[120:123], v[240:243], v[200:203], v[120:123]
    ds_read_b64_tr_b16 v[236:237], v66 offset:45792
    v_mfma_f32_16x16x32_bf16 v[124:127], v[240:243], v[204:207], v[124:127]
    ds_read_b64_tr_b16 v[238:239], v66 offset:46304
    buffer_load_dwordx4 v[196:199], v2, s[32:35], s16 offen offset:1024 sc1
    s_waitcnt lgkmcnt(8)
    v_mfma_f32_16x16x32_bf16 v[80:83], v[244:247], v[200:203], v[80:83]
    ds_read_b64_tr_b16 v[240:241], v67 offset:45760
    v_mfma_f32_16x16x32_bf16 v[84:87], v[244:247], v[204:207], v[84:87]
    ds_read_b64_tr_b16 v[242:243], v67 offset:46272
    v_mfma_f32_16x16x32_bf16 v[88:91], v[248:251], v[200:203], v[88:91]
    ds_read_b64_tr_b16 v[244:245], v67 offset:45792
    v_mfma_f32_16x16x32_bf16 v[92:95], v[248:251], v[204:207], v[92:95]
    ds_read_b64_tr_b16 v[246:247], v67 offset:46304
    s_waitcnt lgkmcnt(8)
    v_mfma_f32_16x16x32_bf16 v[96:99], v[224:227], v[200:203], v[96:99]
    s_barrier
    ds_read_b64_tr_b16 v[248:249], v69 offset:8320
    v_mfma_f32_16x16x32_bf16 v[100:103], v[224:227], v[204:207], v[100:103]
    ds_read_b64_tr_b16 v[250:251], v69 offset:8832
    v_mfma_f32_16x16x32_bf16 v[104:107], v[228:231], v[200:203], v[104:107]
    ds_read_b64_tr_b16 v[224:225], v69 offset:8352
    v_mfma_f32_16x16x32_bf16 v[108:111], v[228:231], v[204:207], v[108:111]
    ds_read_b64_tr_b16 v[226:227], v69 offset:8864
    s_waitcnt lgkmcnt(8)
    v_mfma_f32_16x16x32_bf16 v[144:147], v[232:235], v[200:203], v[144:147]
    ds_read_b64_tr_b16 v[228:229], v68 offset:8320
    v_mfma_f32_16x16x32_bf16 v[148:151], v[232:235], v[204:207], v[148:151]
    ds_read_b64_tr_b16 v[230:231], v68 offset:8832
    v_mfma_f32_16x16x32_bf16 v[152:155], v[236:239], v[200:203], v[152:155]
    ds_read_b64_tr_b16 v[232:233], v68 offset:8352
    v_mfma_f32_16x16x32_bf16 v[156:159], v[236:239], v[204:207], v[156:159]
    ds_read_b64_tr_b16 v[234:235], v68 offset:8864
    s_waitcnt lgkmcnt(8)
    v_mfma_f32_16x16x32_bf16 v[160:163], v[240:243], v[200:203], v[160:163]
    ds_read_b64_tr_b16 v[236:237], v68
    v_mfma_f32_16x16x32_bf16 v[164:167], v[240:243], v[204:207], v[164:167]
    ds_read_b64_tr_b16 v[238:239], v68 offset:512
    v_mfma_f32_16x16x32_bf16 v[168:171], v[244:247], v[200:203], v[168:171]
    ds_read_b64_tr_b16 v[240:241], v68 offset:32
    v_mfma_f32_16x16x32_bf16 v[172:175], v[244:247], v[204:207], v[172:175]
    ds_read_b64_tr_b16 v[242:243], v68 offset:544
    s_waitcnt lgkmcnt(8)
    s_waitcnt vmcnt(8)
    v_mfma_f32_16x16x32_bf16 v[128:131], v[248:251], v[208:211], v[128:131]
    ds_read_b64_tr_b16 v[244:245], v69
    v_mfma_f32_16x16x32_bf16 v[132:135], v[248:251], v[212:215], v[132:135]
    ds_read_b64_tr_b16 v[246:247], v69 offset:512
    buffer_load_dwordx4 v[200:203], v2, s[32:35], s16 offen offset:2048 sc1
    v_mfma_f32_16x16x32_bf16 v[136:139], v[224:227], v[208:211], v[136:139]
    ds_read_b64_tr_b16 v[248:249], v69 offset:32
    v_mfma_f32_16x16x32_bf16 v[140:143], v[224:227], v[212:215], v[140:143]
    ds_read_b64_tr_b16 v[250:251], v69 offset:544
    s_waitcnt lgkmcnt(8)
    v_mfma_f32_16x16x32_bf16 v[112:115], v[228:231], v[208:211], v[112:115]
    ds_read_b64_tr_b16 v[224:225], v68 offset:16640
    v_mfma_f32_16x16x32_bf16 v[116:119], v[228:231], v[212:215], v[116:119]
    ds_read_b64_tr_b16 v[226:227], v68 offset:17152
    v_mfma_f32_16x16x32_bf16 v[120:123], v[232:235], v[208:211], v[120:123]
    ds_read_b64_tr_b16 v[228:229], v68 offset:16672
    v_mfma_f32_16x16x32_bf16 v[124:127], v[232:235], v[212:215], v[124:127]
    ds_read_b64_tr_b16 v[230:231], v68 offset:17184
    buffer_load_dwordx4 v[204:207], v2, s[32:35], s16 offen offset:3072 sc1
    s_waitcnt lgkmcnt(8)
    v_mfma_f32_16x16x32_bf16 v[80:83], v[236:239], v[208:211], v[80:83]
    ds_read_b64_tr_b16 v[232:233], v69 offset:16640
    v_mfma_f32_16x16x32_bf16 v[84:87], v[236:239], v[212:215], v[84:87]
    ds_read_b64_tr_b16 v[234:235], v69 offset:17152
    v_mfma_f32_16x16x32_bf16 v[88:91], v[240:243], v[208:211], v[88:91]
    ds_read_b64_tr_b16 v[236:237], v69 offset:16672
    v_mfma_f32_16x16x32_bf16 v[92:95], v[240:243], v[212:215], v[92:95]
    ds_read_b64_tr_b16 v[238:239], v69 offset:17184
    s_waitcnt lgkmcnt(8)
    v_mfma_f32_16x16x32_bf16 v[96:99], v[244:247], v[208:211], v[96:99]
    ds_read_b64_tr_b16 v[240:241], v69 offset:12480
    v_mfma_f32_16x16x32_bf16 v[100:103], v[244:247], v[212:215], v[100:103]
    ds_read_b64_tr_b16 v[242:243], v69 offset:12992
    v_mfma_f32_16x16x32_bf16 v[104:107], v[248:251], v[208:211], v[104:107]
    ds_read_b64_tr_b16 v[244:245], v69 offset:12512
    v_mfma_f32_16x16x32_bf16 v[108:111], v[248:251], v[212:215], v[108:111]
    ds_read_b64_tr_b16 v[246:247], v69 offset:13024
    s_waitcnt lgkmcnt(8)
    v_mfma_f32_16x16x32_bf16 v[144:147], v[224:227], v[208:211], v[144:147]
    ds_read_b64_tr_b16 v[248:249], v68 offset:12480
    v_mfma_f32_16x16x32_bf16 v[148:151], v[224:227], v[212:215], v[148:151]
    ds_read_b64_tr_b16 v[250:251], v68 offset:12992
    v_mfma_f32_16x16x32_bf16 v[152:155], v[228:231], v[208:211], v[152:155]
    ds_read_b64_tr_b16 v[224:225], v68 offset:12512
    v_mfma_f32_16x16x32_bf16 v[156:159], v[228:231], v[212:215], v[156:159]
    ds_read_b64_tr_b16 v[226:227], v68 offset:13024
    s_waitcnt lgkmcnt(8)
    v_mfma_f32_16x16x32_bf16 v[160:163], v[232:235], v[208:211], v[160:163]
    ds_read_b64_tr_b16 v[228:229], v68 offset:4160
    v_mfma_f32_16x16x32_bf16 v[164:167], v[232:235], v[212:215], v[164:167]
    ds_read_b64_tr_b16 v[230:231], v68 offset:4672
    v_mfma_f32_16x16x32_bf16 v[168:171], v[236:239], v[208:211], v[168:171]
    ds_read_b64_tr_b16 v[232:233], v68 offset:4192
    v_mfma_f32_16x16x32_bf16 v[172:175], v[236:239], v[212:215], v[172:175]
    ds_read_b64_tr_b16 v[234:235], v68 offset:4704
    s_waitcnt lgkmcnt(8)
    s_waitcnt vmcnt(8)
    v_mfma_f32_16x16x32_bf16 v[128:131], v[240:243], v[216:219], v[128:131]
    ds_read_b64_tr_b16 v[236:237], v69 offset:4160
    v_mfma_f32_16x16x32_bf16 v[132:135], v[240:243], v[220:223], v[132:135]
    ds_read_b64_tr_b16 v[238:239], v69 offset:4672
    s_add_u32 s96, s85, 5
    s_and_b32 s97, s96, 15
    s_lshl_b32 s98, s97, 14
    s_add_u32 s16, s98, s15
    buffer_load_dwordx4 v[208:211], v2, s[32:35], s16 offen sc1
    v_mfma_f32_16x16x32_bf16 v[136:139], v[244:247], v[216:219], v[136:139]
    ds_read_b64_tr_b16 v[240:241], v69 offset:4192
    v_mfma_f32_16x16x32_bf16 v[140:143], v[244:247], v[220:223], v[140:143]
    ds_read_b64_tr_b16 v[242:243], v69 offset:4704
    s_waitcnt lgkmcnt(8)
    v_mfma_f32_16x16x32_bf16 v[112:115], v[248:251], v[216:219], v[112:115]
    ds_read_b64_tr_b16 v[244:245], v68 offset:20800
    v_mfma_f32_16x16x32_bf16 v[116:119], v[248:251], v[220:223], v[116:119]
    ds_read_b64_tr_b16 v[246:247], v68 offset:21312
    v_mfma_f32_16x16x32_bf16 v[120:123], v[224:227], v[216:219], v[120:123]
    ds_read_b64_tr_b16 v[248:249], v68 offset:20832
    v_mfma_f32_16x16x32_bf16 v[124:127], v[224:227], v[220:223], v[124:127]
    ds_read_b64_tr_b16 v[250:251], v68 offset:21344
    buffer_load_dwordx4 v[212:215], v2, s[32:35], s16 offen offset:1024 sc1
    s_waitcnt lgkmcnt(8)
    v_mfma_f32_16x16x32_bf16 v[80:83], v[228:231], v[216:219], v[80:83]
    ds_read_b64_tr_b16 v[224:225], v69 offset:20800
    v_mfma_f32_16x16x32_bf16 v[84:87], v[228:231], v[220:223], v[84:87]
    ds_read_b64_tr_b16 v[226:227], v69 offset:21312
    v_mfma_f32_16x16x32_bf16 v[88:91], v[232:235], v[216:219], v[88:91]
    ds_read_b64_tr_b16 v[228:229], v69 offset:20832
    v_mfma_f32_16x16x32_bf16 v[92:95], v[232:235], v[220:223], v[92:95]
    ds_read_b64_tr_b16 v[230:231], v69 offset:21344
    s_waitcnt lgkmcnt(8)
    v_mfma_f32_16x16x32_bf16 v[96:99], v[236:239], v[216:219], v[96:99]
    s_barrier
    ds_read_b64_tr_b16 v[232:233], v69 offset:33280
    v_mfma_f32_16x16x32_bf16 v[100:103], v[236:239], v[220:223], v[100:103]
    ds_read_b64_tr_b16 v[234:235], v69 offset:33792
    v_mfma_f32_16x16x32_bf16 v[104:107], v[240:243], v[216:219], v[104:107]
    ds_read_b64_tr_b16 v[236:237], v69 offset:33312
    v_mfma_f32_16x16x32_bf16 v[108:111], v[240:243], v[220:223], v[108:111]
    ds_read_b64_tr_b16 v[238:239], v69 offset:33824
    s_waitcnt lgkmcnt(8)
    v_mfma_f32_16x16x32_bf16 v[144:147], v[244:247], v[216:219], v[144:147]
    ds_read_b64_tr_b16 v[240:241], v68 offset:33280
    v_mfma_f32_16x16x32_bf16 v[148:151], v[244:247], v[220:223], v[148:151]
    ds_read_b64_tr_b16 v[242:243], v68 offset:33792
    v_mfma_f32_16x16x32_bf16 v[152:155], v[248:251], v[216:219], v[152:155]
    ds_read_b64_tr_b16 v[244:245], v68 offset:33312
    v_mfma_f32_16x16x32_bf16 v[156:159], v[248:251], v[220:223], v[156:159]
    ds_read_b64_tr_b16 v[246:247], v68 offset:33824
    s_waitcnt lgkmcnt(8)
    v_mfma_f32_16x16x32_bf16 v[160:163], v[224:227], v[216:219], v[160:163]
    ds_read_b64_tr_b16 v[248:249], v68 offset:24960
    v_mfma_f32_16x16x32_bf16 v[164:167], v[224:227], v[220:223], v[164:167]
    ds_read_b64_tr_b16 v[250:251], v68 offset:25472
    v_mfma_f32_16x16x32_bf16 v[168:171], v[228:231], v[216:219], v[168:171]
    ds_read_b64_tr_b16 v[224:225], v68 offset:24992
    v_mfma_f32_16x16x32_bf16 v[172:175], v[228:231], v[220:223], v[172:175]
    ds_read_b64_tr_b16 v[226:227], v68 offset:25504
    s_waitcnt lgkmcnt(8)
    s_waitcnt vmcnt(8)
    v_mfma_f32_16x16x32_bf16 v[128:131], v[232:235], v[176:179], v[128:131]
    ds_read_b64_tr_b16 v[228:229], v69 offset:24960
    v_mfma_f32_16x16x32_bf16 v[132:135], v[232:235], v[180:183], v[132:135]
    ds_read_b64_tr_b16 v[230:231], v69 offset:25472
    buffer_load_dwordx4 v[216:219], v2, s[32:35], s16 offen offset:2048 sc1
    v_mfma_f32_16x16x32_bf16 v[136:139], v[236:239], v[176:179], v[136:139]
    ds_read_b64_tr_b16 v[232:233], v69 offset:24992
    v_mfma_f32_16x16x32_bf16 v[140:143], v[236:239], v[180:183], v[140:143]
    ds_read_b64_tr_b16 v[234:235], v69 offset:25504
    s_waitcnt lgkmcnt(8)
    v_mfma_f32_16x16x32_bf16 v[112:115], v[240:243], v[176:179], v[112:115]
    ds_read_b64_tr_b16 v[236:237], v68 offset:41600
    v_mfma_f32_16x16x32_bf16 v[116:119], v[240:243], v[180:183], v[116:119]
    ds_read_b64_tr_b16 v[238:239], v68 offset:42112
    v_mfma_f32_16x16x32_bf16 v[120:123], v[244:247], v[176:179], v[120:123]
    ds_read_b64_tr_b16 v[240:241], v68 offset:41632
    v_mfma_f32_16x16x32_bf16 v[124:127], v[244:247], v[180:183], v[124:127]
    ds_read_b64_tr_b16 v[242:243], v68 offset:42144
    buffer_load_dwordx4 v[220:223], v2, s[32:35], s16 offen offset:3072 sc1
    s_waitcnt lgkmcnt(8)
    v_mfma_f32_16x16x32_bf16 v[80:83], v[248:251], v[176:179], v[80:83]
    ds_read_b64_tr_b16 v[244:245], v69 offset:41600
    v_mfma_f32_16x16x32_bf16 v[84:87], v[248:251], v[180:183], v[84:87]
    ds_read_b64_tr_b16 v[246:247], v69 offset:42112
    v_mfma_f32_16x16x32_bf16 v[88:91], v[224:227], v[176:179], v[88:91]
    ds_read_b64_tr_b16 v[248:249], v69 offset:41632
    v_mfma_f32_16x16x32_bf16 v[92:95], v[224:227], v[180:183], v[92:95]
    ds_read_b64_tr_b16 v[250:251], v69 offset:42144
    s_waitcnt lgkmcnt(8)
    v_mfma_f32_16x16x32_bf16 v[96:99], v[228:231], v[176:179], v[96:99]
    ds_read_b64_tr_b16 v[224:225], v69 offset:37440
    v_mfma_f32_16x16x32_bf16 v[100:103], v[228:231], v[180:183], v[100:103]
    ds_read_b64_tr_b16 v[226:227], v69 offset:37952
    v_mfma_f32_16x16x32_bf16 v[104:107], v[232:235], v[176:179], v[104:107]
    ds_read_b64_tr_b16 v[228:229], v69 offset:37472
    v_mfma_f32_16x16x32_bf16 v[108:111], v[232:235], v[180:183], v[108:111]
    ds_read_b64_tr_b16 v[230:231], v69 offset:37984
    s_waitcnt lgkmcnt(8)
    v_mfma_f32_16x16x32_bf16 v[144:147], v[236:239], v[176:179], v[144:147]
    ds_read_b64_tr_b16 v[232:233], v68 offset:37440
    v_mfma_f32_16x16x32_bf16 v[148:151], v[236:239], v[180:183], v[148:151]
    ds_read_b64_tr_b16 v[234:235], v68 offset:37952
    v_mfma_f32_16x16x32_bf16 v[152:155], v[240:243], v[176:179], v[152:155]
    ds_read_b64_tr_b16 v[236:237], v68 offset:37472
    v_mfma_f32_16x16x32_bf16 v[156:159], v[240:243], v[180:183], v[156:159]
    ds_read_b64_tr_b16 v[238:239], v68 offset:37984
    s_waitcnt lgkmcnt(8)
    v_mfma_f32_16x16x32_bf16 v[160:163], v[244:247], v[176:179], v[160:163]
    ds_read_b64_tr_b16 v[240:241], v68 offset:29120
    v_mfma_f32_16x16x32_bf16 v[164:167], v[244:247], v[180:183], v[164:167]
    ds_read_b64_tr_b16 v[242:243], v68 offset:29632
    v_mfma_f32_16x16x32_bf16 v[168:171], v[248:251], v[176:179], v[168:171]
    ds_read_b64_tr_b16 v[244:245], v68 offset:29152
    v_mfma_f32_16x16x32_bf16 v[172:175], v[248:251], v[180:183], v[172:175]
    ds_read_b64_tr_b16 v[246:247], v68 offset:29664
    s_waitcnt lgkmcnt(8)
    s_waitcnt vmcnt(8)
    v_mfma_f32_16x16x32_bf16 v[128:131], v[224:227], v[184:187], v[128:131]
    ds_read_b64_tr_b16 v[248:249], v69 offset:29120
    v_mfma_f32_16x16x32_bf16 v[132:135], v[224:227], v[188:191], v[132:135]
    ds_read_b64_tr_b16 v[250:251], v69 offset:29632
    s_add_u32 s96, s85, 6
    s_and_b32 s97, s96, 15
    s_lshl_b32 s98, s97, 14
    s_add_u32 s16, s98, s15
    buffer_load_dwordx4 v[176:179], v2, s[32:35], s16 offen sc1
    v_mfma_f32_16x16x32_bf16 v[136:139], v[228:231], v[184:187], v[136:139]
    ds_read_b64_tr_b16 v[224:225], v69 offset:29152
    v_mfma_f32_16x16x32_bf16 v[140:143], v[228:231], v[188:191], v[140:143]
    ds_read_b64_tr_b16 v[226:227], v69 offset:29664
    s_waitcnt lgkmcnt(8)
    v_mfma_f32_16x16x32_bf16 v[112:115], v[232:235], v[184:187], v[112:115]
    ds_read_b64_tr_b16 v[228:229], v68 offset:45760
    v_mfma_f32_16x16x32_bf16 v[116:119], v[232:235], v[188:191], v[116:119]
    ds_read_b64_tr_b16 v[230:231], v68 offset:46272
    v_mfma_f32_16x16x32_bf16 v[120:123], v[236:239], v[184:187], v[120:123]
    ds_read_b64_tr_b16 v[232:233], v68 offset:45792
    v_mfma_f32_16x16x32_bf16 v[124:127], v[236:239], v[188:191], v[124:127]
    ds_read_b64_tr_b16 v[234:235], v68 offset:46304
    buffer_load_dwordx4 v[180:183], v2, s[32:35], s16 offen offset:1024 sc1
    s_waitcnt lgkmcnt(8)
    v_mfma_f32_16x16x32_bf16 v[80:83], v[240:243], v[184:187], v[80:83]
    ds_read_b64_tr_b16 v[236:237], v69 offset:45760
    v_mfma_f32_16x16x32_bf16 v[84:87], v[240:243], v[188:191], v[84:87]
    ds_read_b64_tr_b16 v[238:239], v69 offset:46272
    v_mfma_f32_16x16x32_bf16 v[88:91], v[244:247], v[184:187], v[88:91]
    ds_read_b64_tr_b16 v[240:241], v69 offset:45792
    v_mfma_f32_16x16x32_bf16 v[92:95], v[244:247], v[188:191], v[92:95]
    ds_read_b64_tr_b16 v[242:243], v69 offset:46304
    s_waitcnt lgkmcnt(8)
    v_mfma_f32_16x16x32_bf16 v[96:99], v[248:251], v[184:187], v[96:99]
    s_barrier
    ds_read_b64_tr_b16 v[244:245], v71 offset:8320
    v_mfma_f32_16x16x32_bf16 v[100:103], v[248:251], v[188:191], v[100:103]
    ds_read_b64_tr_b16 v[246:247], v71 offset:8832
    v_mfma_f32_16x16x32_bf16 v[104:107], v[224:227], v[184:187], v[104:107]
    ds_read_b64_tr_b16 v[248:249], v71 offset:8352
    v_mfma_f32_16x16x32_bf16 v[108:111], v[224:227], v[188:191], v[108:111]
    ds_read_b64_tr_b16 v[250:251], v71 offset:8864
    s_waitcnt lgkmcnt(8)
    v_mfma_f32_16x16x32_bf16 v[144:147], v[228:231], v[184:187], v[144:147]
    ds_read_b64_tr_b16 v[224:225], v70 offset:8320
    v_mfma_f32_16x16x32_bf16 v[148:151], v[228:231], v[188:191], v[148:151]
    ds_read_b64_tr_b16 v[226:227], v70 offset:8832
    v_mfma_f32_16x16x32_bf16 v[152:155], v[232:235], v[184:187], v[152:155]
    ds_read_b64_tr_b16 v[228:229], v70 offset:8352
    v_mfma_f32_16x16x32_bf16 v[156:159], v[232:235], v[188:191], v[156:159]
    ds_read_b64_tr_b16 v[230:231], v70 offset:8864
    s_waitcnt lgkmcnt(8)
    v_mfma_f32_16x16x32_bf16 v[160:163], v[236:239], v[184:187], v[160:163]
    ds_read_b64_tr_b16 v[232:233], v70
    v_mfma_f32_16x16x32_bf16 v[164:167], v[236:239], v[188:191], v[164:167]
    ds_read_b64_tr_b16 v[234:235], v70 offset:512
    v_mfma_f32_16x16x32_bf16 v[168:171], v[240:243], v[184:187], v[168:171]
    ds_read_b64_tr_b16 v[236:237], v70 offset:32
    v_mfma_f32_16x16x32_bf16 v[172:175], v[240:243], v[188:191], v[172:175]
    ds_read_b64_tr_b16 v[238:239], v70 offset:544
    s_waitcnt lgkmcnt(8)
    s_waitcnt vmcnt(8)
    v_mfma_f32_16x16x32_bf16 v[128:131], v[244:247], v[192:195], v[128:131]
    ds_read_b64_tr_b16 v[240:241], v71
    v_mfma_f32_16x16x32_bf16 v[132:135], v[244:247], v[196:199], v[132:135]
    ds_read_b64_tr_b16 v[242:243], v71 offset:512
    buffer_load_dwordx4 v[184:187], v2, s[32:35], s16 offen offset:2048 sc1
    v_mfma_f32_16x16x32_bf16 v[136:139], v[248:251], v[192:195], v[136:139]
    ds_read_b64_tr_b16 v[244:245], v71 offset:32
    v_mfma_f32_16x16x32_bf16 v[140:143], v[248:251], v[196:199], v[140:143]
    ds_read_b64_tr_b16 v[246:247], v71 offset:544
    s_waitcnt lgkmcnt(8)
    v_mfma_f32_16x16x32_bf16 v[112:115], v[224:227], v[192:195], v[112:115]
    ds_read_b64_tr_b16 v[248:249], v70 offset:16640
    v_mfma_f32_16x16x32_bf16 v[116:119], v[224:227], v[196:199], v[116:119]
    ds_read_b64_tr_b16 v[250:251], v70 offset:17152
    v_mfma_f32_16x16x32_bf16 v[120:123], v[228:231], v[192:195], v[120:123]
    ds_read_b64_tr_b16 v[224:225], v70 offset:16672
    v_mfma_f32_16x16x32_bf16 v[124:127], v[228:231], v[196:199], v[124:127]
    ds_read_b64_tr_b16 v[226:227], v70 offset:17184
    buffer_load_dwordx4 v[188:191], v2, s[32:35], s16 offen offset:3072 sc1
    s_waitcnt lgkmcnt(8)
    v_mfma_f32_16x16x32_bf16 v[80:83], v[232:235], v[192:195], v[80:83]
    ds_read_b64_tr_b16 v[228:229], v71 offset:16640
    v_mfma_f32_16x16x32_bf16 v[84:87], v[232:235], v[196:199], v[84:87]
    ds_read_b64_tr_b16 v[230:231], v71 offset:17152
    v_mfma_f32_16x16x32_bf16 v[88:91], v[236:239], v[192:195], v[88:91]
    ds_read_b64_tr_b16 v[232:233], v71 offset:16672
    v_mfma_f32_16x16x32_bf16 v[92:95], v[236:239], v[196:199], v[92:95]
    ds_read_b64_tr_b16 v[234:235], v71 offset:17184
    s_waitcnt lgkmcnt(8)
    v_mfma_f32_16x16x32_bf16 v[96:99], v[240:243], v[192:195], v[96:99]
    ds_read_b64_tr_b16 v[236:237], v71 offset:12480
    v_mfma_f32_16x16x32_bf16 v[100:103], v[240:243], v[196:199], v[100:103]
    ds_read_b64_tr_b16 v[238:239], v71 offset:12992
    v_mfma_f32_16x16x32_bf16 v[104:107], v[244:247], v[192:195], v[104:107]
    ds_read_b64_tr_b16 v[240:241], v71 offset:12512
    v_mfma_f32_16x16x32_bf16 v[108:111], v[244:247], v[196:199], v[108:111]
    ds_read_b64_tr_b16 v[242:243], v71 offset:13024
    s_waitcnt lgkmcnt(8)
    v_mfma_f32_16x16x32_bf16 v[144:147], v[248:251], v[192:195], v[144:147]
    ds_read_b64_tr_b16 v[244:245], v70 offset:12480
    v_mfma_f32_16x16x32_bf16 v[148:151], v[248:251], v[196:199], v[148:151]
    ds_read_b64_tr_b16 v[246:247], v70 offset:12992
    v_mfma_f32_16x16x32_bf16 v[152:155], v[224:227], v[192:195], v[152:155]
    ds_read_b64_tr_b16 v[248:249], v70 offset:12512
    v_mfma_f32_16x16x32_bf16 v[156:159], v[224:227], v[196:199], v[156:159]
    ds_read_b64_tr_b16 v[250:251], v70 offset:13024
    s_waitcnt lgkmcnt(8)
    v_mfma_f32_16x16x32_bf16 v[160:163], v[228:231], v[192:195], v[160:163]
    ds_read_b64_tr_b16 v[224:225], v70 offset:4160
    v_mfma_f32_16x16x32_bf16 v[164:167], v[228:231], v[196:199], v[164:167]
    ds_read_b64_tr_b16 v[226:227], v70 offset:4672
    v_mfma_f32_16x16x32_bf16 v[168:171], v[232:235], v[192:195], v[168:171]
    ds_read_b64_tr_b16 v[228:229], v70 offset:4192
    v_mfma_f32_16x16x32_bf16 v[172:175], v[232:235], v[196:199], v[172:175]
    ds_read_b64_tr_b16 v[230:231], v70 offset:4704
    s_waitcnt lgkmcnt(8)
    s_waitcnt vmcnt(8)
    v_mfma_f32_16x16x32_bf16 v[128:131], v[236:239], v[200:203], v[128:131]
    ds_read_b64_tr_b16 v[232:233], v71 offset:4160
    v_mfma_f32_16x16x32_bf16 v[132:135], v[236:239], v[204:207], v[132:135]
    ds_read_b64_tr_b16 v[234:235], v71 offset:4672
    s_add_u32 s96, s85, 7
    s_and_b32 s97, s96, 15
    s_lshl_b32 s98, s97, 14
    s_add_u32 s16, s98, s15
    buffer_load_dwordx4 v[192:195], v2, s[32:35], s16 offen sc1
    v_mfma_f32_16x16x32_bf16 v[136:139], v[240:243], v[200:203], v[136:139]
    ds_read_b64_tr_b16 v[236:237], v71 offset:4192
    v_mfma_f32_16x16x32_bf16 v[140:143], v[240:243], v[204:207], v[140:143]
    ds_read_b64_tr_b16 v[238:239], v71 offset:4704
    s_waitcnt lgkmcnt(8)
    v_mfma_f32_16x16x32_bf16 v[112:115], v[244:247], v[200:203], v[112:115]
    ds_read_b64_tr_b16 v[240:241], v70 offset:20800
    v_mfma_f32_16x16x32_bf16 v[116:119], v[244:247], v[204:207], v[116:119]
    ds_read_b64_tr_b16 v[242:243], v70 offset:21312
    v_mfma_f32_16x16x32_bf16 v[120:123], v[248:251], v[200:203], v[120:123]
    ds_read_b64_tr_b16 v[244:245], v70 offset:20832
    v_mfma_f32_16x16x32_bf16 v[124:127], v[248:251], v[204:207], v[124:127]
    ds_read_b64_tr_b16 v[246:247], v70 offset:21344
    buffer_load_dwordx4 v[196:199], v2, s[32:35], s16 offen offset:1024 sc1
    s_waitcnt lgkmcnt(8)
    v_mfma_f32_16x16x32_bf16 v[80:83], v[224:227], v[200:203], v[80:83]
    ds_read_b64_tr_b16 v[248:249], v71 offset:20800
    v_mfma_f32_16x16x32_bf16 v[84:87], v[224:227], v[204:207], v[84:87]
    ds_read_b64_tr_b16 v[250:251], v71 offset:21312
    v_mfma_f32_16x16x32_bf16 v[88:91], v[228:231], v[200:203], v[88:91]
    ds_read_b64_tr_b16 v[224:225], v71 offset:20832
    v_mfma_f32_16x16x32_bf16 v[92:95], v[228:231], v[204:207], v[92:95]
    ds_read_b64_tr_b16 v[226:227], v71 offset:21344
    s_waitcnt lgkmcnt(8)
    v_mfma_f32_16x16x32_bf16 v[96:99], v[232:235], v[200:203], v[96:99]
    s_barrier
    ds_read_b64_tr_b16 v[228:229], v71 offset:33280
    v_mfma_f32_16x16x32_bf16 v[100:103], v[232:235], v[204:207], v[100:103]
    ds_read_b64_tr_b16 v[230:231], v71 offset:33792
    v_mfma_f32_16x16x32_bf16 v[104:107], v[236:239], v[200:203], v[104:107]
    ds_read_b64_tr_b16 v[232:233], v71 offset:33312
    v_mfma_f32_16x16x32_bf16 v[108:111], v[236:239], v[204:207], v[108:111]
    ds_read_b64_tr_b16 v[234:235], v71 offset:33824
    s_waitcnt lgkmcnt(8)
    v_mfma_f32_16x16x32_bf16 v[144:147], v[240:243], v[200:203], v[144:147]
    ds_read_b64_tr_b16 v[236:237], v70 offset:33280
    v_mfma_f32_16x16x32_bf16 v[148:151], v[240:243], v[204:207], v[148:151]
    ds_read_b64_tr_b16 v[238:239], v70 offset:33792
    v_mfma_f32_16x16x32_bf16 v[152:155], v[244:247], v[200:203], v[152:155]
    ds_read_b64_tr_b16 v[240:241], v70 offset:33312
    v_mfma_f32_16x16x32_bf16 v[156:159], v[244:247], v[204:207], v[156:159]
    ds_read_b64_tr_b16 v[242:243], v70 offset:33824
    s_waitcnt lgkmcnt(8)
    v_mfma_f32_16x16x32_bf16 v[160:163], v[248:251], v[200:203], v[160:163]
    ds_read_b64_tr_b16 v[244:245], v70 offset:24960
    v_mfma_f32_16x16x32_bf16 v[164:167], v[248:251], v[204:207], v[164:167]
    ds_read_b64_tr_b16 v[246:247], v70 offset:25472
    v_mfma_f32_16x16x32_bf16 v[168:171], v[224:227], v[200:203], v[168:171]
    ds_read_b64_tr_b16 v[248:249], v70 offset:24992
    v_mfma_f32_16x16x32_bf16 v[172:175], v[224:227], v[204:207], v[172:175]
    ds_read_b64_tr_b16 v[250:251], v70 offset:25504
    s_waitcnt lgkmcnt(8)
    s_waitcnt vmcnt(8)
    v_mfma_f32_16x16x32_bf16 v[128:131], v[228:231], v[208:211], v[128:131]
    ds_read_b64_tr_b16 v[224:225], v71 offset:24960
    v_mfma_f32_16x16x32_bf16 v[132:135], v[228:231], v[212:215], v[132:135]
    ds_read_b64_tr_b16 v[226:227], v71 offset:25472
    buffer_load_dwordx4 v[200:203], v2, s[32:35], s16 offen offset:2048 sc1
    v_mfma_f32_16x16x32_bf16 v[136:139], v[232:235], v[208:211], v[136:139]
    ds_read_b64_tr_b16 v[228:229], v71 offset:24992
    v_mfma_f32_16x16x32_bf16 v[140:143], v[232:235], v[212:215], v[140:143]
    ds_read_b64_tr_b16 v[230:231], v71 offset:25504
    s_waitcnt lgkmcnt(8)
    v_mfma_f32_16x16x32_bf16 v[112:115], v[236:239], v[208:211], v[112:115]
    ds_read_b64_tr_b16 v[232:233], v70 offset:41600
    v_mfma_f32_16x16x32_bf16 v[116:119], v[236:239], v[212:215], v[116:119]
    ds_read_b64_tr_b16 v[234:235], v70 offset:42112
    v_mfma_f32_16x16x32_bf16 v[120:123], v[240:243], v[208:211], v[120:123]
    ds_read_b64_tr_b16 v[236:237], v70 offset:41632
    v_mfma_f32_16x16x32_bf16 v[124:127], v[240:243], v[212:215], v[124:127]
    ds_read_b64_tr_b16 v[238:239], v70 offset:42144
    buffer_load_dwordx4 v[204:207], v2, s[32:35], s16 offen offset:3072 sc1
    s_waitcnt lgkmcnt(8)
    v_mfma_f32_16x16x32_bf16 v[80:83], v[244:247], v[208:211], v[80:83]
    ds_read_b64_tr_b16 v[240:241], v71 offset:41600
    v_mfma_f32_16x16x32_bf16 v[84:87], v[244:247], v[212:215], v[84:87]
    ds_read_b64_tr_b16 v[242:243], v71 offset:42112
    v_mfma_f32_16x16x32_bf16 v[88:91], v[248:251], v[208:211], v[88:91]
    ds_read_b64_tr_b16 v[244:245], v71 offset:41632
    v_mfma_f32_16x16x32_bf16 v[92:95], v[248:251], v[212:215], v[92:95]
    ds_read_b64_tr_b16 v[246:247], v71 offset:42144
    s_waitcnt lgkmcnt(8)
    v_mfma_f32_16x16x32_bf16 v[96:99], v[224:227], v[208:211], v[96:99]
    ds_read_b64_tr_b16 v[248:249], v71 offset:37440
    v_mfma_f32_16x16x32_bf16 v[100:103], v[224:227], v[212:215], v[100:103]
    ds_read_b64_tr_b16 v[250:251], v71 offset:37952
    v_mfma_f32_16x16x32_bf16 v[104:107], v[228:231], v[208:211], v[104:107]
    ds_read_b64_tr_b16 v[224:225], v71 offset:37472
    v_mfma_f32_16x16x32_bf16 v[108:111], v[228:231], v[212:215], v[108:111]
    ds_read_b64_tr_b16 v[226:227], v71 offset:37984
    s_waitcnt lgkmcnt(8)
    v_mfma_f32_16x16x32_bf16 v[144:147], v[232:235], v[208:211], v[144:147]
    ds_read_b64_tr_b16 v[228:229], v70 offset:37440
    v_mfma_f32_16x16x32_bf16 v[148:151], v[232:235], v[212:215], v[148:151]
    ds_read_b64_tr_b16 v[230:231], v70 offset:37952
    v_mfma_f32_16x16x32_bf16 v[152:155], v[236:239], v[208:211], v[152:155]
    ds_read_b64_tr_b16 v[232:233], v70 offset:37472
    v_mfma_f32_16x16x32_bf16 v[156:159], v[236:239], v[212:215], v[156:159]
    ds_read_b64_tr_b16 v[234:235], v70 offset:37984
    s_waitcnt lgkmcnt(8)
    v_mfma_f32_16x16x32_bf16 v[160:163], v[240:243], v[208:211], v[160:163]
    ds_read_b64_tr_b16 v[236:237], v70 offset:29120
    v_mfma_f32_16x16x32_bf16 v[164:167], v[240:243], v[212:215], v[164:167]
    ds_read_b64_tr_b16 v[238:239], v70 offset:29632
    v_mfma_f32_16x16x32_bf16 v[168:171], v[244:247], v[208:211], v[168:171]
    ds_read_b64_tr_b16 v[240:241], v70 offset:29152
    v_mfma_f32_16x16x32_bf16 v[172:175], v[244:247], v[212:215], v[172:175]
    ds_read_b64_tr_b16 v[242:243], v70 offset:29664
    s_waitcnt lgkmcnt(8)
    s_waitcnt vmcnt(8)
    v_mfma_f32_16x16x32_bf16 v[128:131], v[248:251], v[216:219], v[128:131]
    ds_read_b64_tr_b16 v[244:245], v71 offset:29120
    v_mfma_f32_16x16x32_bf16 v[132:135], v[248:251], v[220:223], v[132:135]
    ds_read_b64_tr_b16 v[246:247], v71 offset:29632
    s_add_u32 s96, s85, 8
    s_and_b32 s97, s96, 15
    s_lshl_b32 s98, s97, 14
    s_add_u32 s16, s98, s15
    buffer_load_dwordx4 v[208:211], v2, s[32:35], s16 offen sc1
    v_mfma_f32_16x16x32_bf16 v[136:139], v[224:227], v[216:219], v[136:139]
    ds_read_b64_tr_b16 v[248:249], v71 offset:29152
    v_mfma_f32_16x16x32_bf16 v[140:143], v[224:227], v[220:223], v[140:143]
    ds_read_b64_tr_b16 v[250:251], v71 offset:29664
    s_waitcnt lgkmcnt(8)
    v_mfma_f32_16x16x32_bf16 v[112:115], v[228:231], v[216:219], v[112:115]
    ds_read_b64_tr_b16 v[224:225], v70 offset:45760
    v_mfma_f32_16x16x32_bf16 v[116:119], v[228:231], v[220:223], v[116:119]
    ds_read_b64_tr_b16 v[226:227], v70 offset:46272
    v_mfma_f32_16x16x32_bf16 v[120:123], v[232:235], v[216:219], v[120:123]
    ds_read_b64_tr_b16 v[228:229], v70 offset:45792
    v_mfma_f32_16x16x32_bf16 v[124:127], v[232:235], v[220:223], v[124:127]
    ds_read_b64_tr_b16 v[230:231], v70 offset:46304
    buffer_load_dwordx4 v[212:215], v2, s[32:35], s16 offen offset:1024 sc1
    s_waitcnt lgkmcnt(8)
    v_mfma_f32_16x16x32_bf16 v[80:83], v[236:239], v[216:219], v[80:83]
    ds_read_b64_tr_b16 v[232:233], v71 offset:45760
    v_mfma_f32_16x16x32_bf16 v[84:87], v[236:239], v[220:223], v[84:87]
    ds_read_b64_tr_b16 v[234:235], v71 offset:46272
    v_mfma_f32_16x16x32_bf16 v[88:91], v[240:243], v[216:219], v[88:91]
    ds_read_b64_tr_b16 v[236:237], v71 offset:45792
    v_mfma_f32_16x16x32_bf16 v[92:95], v[240:243], v[220:223], v[92:95]
    ds_read_b64_tr_b16 v[238:239], v71 offset:46304
    s_waitcnt lgkmcnt(8)
    v_mfma_f32_16x16x32_bf16 v[96:99], v[244:247], v[216:219], v[96:99]
    s_barrier
    ds_read_b64_tr_b16 v[240:241], v67 offset:8320
    v_mfma_f32_16x16x32_bf16 v[100:103], v[244:247], v[220:223], v[100:103]
    ds_read_b64_tr_b16 v[242:243], v67 offset:8832
    v_mfma_f32_16x16x32_bf16 v[104:107], v[248:251], v[216:219], v[104:107]
    ds_read_b64_tr_b16 v[244:245], v67 offset:8352
    v_mfma_f32_16x16x32_bf16 v[108:111], v[248:251], v[220:223], v[108:111]
    ds_read_b64_tr_b16 v[246:247], v67 offset:8864
    s_waitcnt lgkmcnt(8)
    v_mfma_f32_16x16x32_bf16 v[144:147], v[224:227], v[216:219], v[144:147]
    ds_read_b64_tr_b16 v[248:249], v66 offset:8320
    v_mfma_f32_16x16x32_bf16 v[148:151], v[224:227], v[220:223], v[148:151]
    ds_read_b64_tr_b16 v[250:251], v66 offset:8832
    v_mfma_f32_16x16x32_bf16 v[152:155], v[228:231], v[216:219], v[152:155]
    ds_read_b64_tr_b16 v[224:225], v66 offset:8352
    v_mfma_f32_16x16x32_bf16 v[156:159], v[228:231], v[220:223], v[156:159]
    ds_read_b64_tr_b16 v[226:227], v66 offset:8864
    s_waitcnt lgkmcnt(8)
    v_mfma_f32_16x16x32_bf16 v[160:163], v[232:235], v[216:219], v[160:163]
    ds_read_b64_tr_b16 v[228:229], v66
    v_mfma_f32_16x16x32_bf16 v[164:167], v[232:235], v[220:223], v[164:167]
    ds_read_b64_tr_b16 v[230:231], v66 offset:512
    v_mfma_f32_16x16x32_bf16 v[168:171], v[236:239], v[216:219], v[168:171]
    ds_read_b64_tr_b16 v[232:233], v66 offset:32
    v_mfma_f32_16x16x32_bf16 v[172:175], v[236:239], v[220:223], v[172:175]
    ds_read_b64_tr_b16 v[234:235], v66 offset:544
    s_waitcnt lgkmcnt(8)
    s_waitcnt vmcnt(8)
    v_mfma_f32_16x16x32_bf16 v[128:131], v[240:243], v[176:179], v[128:131]
    ds_read_b64_tr_b16 v[236:237], v67
    v_mfma_f32_16x16x32_bf16 v[132:135], v[240:243], v[180:183], v[132:135]
    ds_read_b64_tr_b16 v[238:239], v67 offset:512
    buffer_load_dwordx4 v[216:219], v2, s[32:35], s16 offen offset:2048 sc1
    v_mfma_f32_16x16x32_bf16 v[136:139], v[244:247], v[176:179], v[136:139]
    ds_read_b64_tr_b16 v[240:241], v67 offset:32
    v_mfma_f32_16x16x32_bf16 v[140:143], v[244:247], v[180:183], v[140:143]
    ds_read_b64_tr_b16 v[242:243], v67 offset:544
    s_waitcnt lgkmcnt(8)
    v_mfma_f32_16x16x32_bf16 v[112:115], v[248:251], v[176:179], v[112:115]
    ds_read_b64_tr_b16 v[244:245], v66 offset:16640
    v_mfma_f32_16x16x32_bf16 v[116:119], v[248:251], v[180:183], v[116:119]
    ds_read_b64_tr_b16 v[246:247], v66 offset:17152
    v_mfma_f32_16x16x32_bf16 v[120:123], v[224:227], v[176:179], v[120:123]
    ds_read_b64_tr_b16 v[248:249], v66 offset:16672
    v_mfma_f32_16x16x32_bf16 v[124:127], v[224:227], v[180:183], v[124:127]
    ds_read_b64_tr_b16 v[250:251], v66 offset:17184
    buffer_load_dwordx4 v[220:223], v2, s[32:35], s16 offen offset:3072 sc1
    s_waitcnt lgkmcnt(8)
    v_mfma_f32_16x16x32_bf16 v[80:83], v[228:231], v[176:179], v[80:83]
    ds_read_b64_tr_b16 v[224:225], v67 offset:16640
    v_mfma_f32_16x16x32_bf16 v[84:87], v[228:231], v[180:183], v[84:87]
    ds_read_b64_tr_b16 v[226:227], v67 offset:17152
    v_mfma_f32_16x16x32_bf16 v[88:91], v[232:235], v[176:179], v[88:91]
    ds_read_b64_tr_b16 v[228:229], v67 offset:16672
    v_mfma_f32_16x16x32_bf16 v[92:95], v[232:235], v[180:183], v[92:95]
    ds_read_b64_tr_b16 v[230:231], v67 offset:17184
    s_waitcnt lgkmcnt(8)
    v_mfma_f32_16x16x32_bf16 v[96:99], v[236:239], v[176:179], v[96:99]
    ds_read_b64_tr_b16 v[232:233], v67 offset:12480
    v_mfma_f32_16x16x32_bf16 v[100:103], v[236:239], v[180:183], v[100:103]
    ds_read_b64_tr_b16 v[234:235], v67 offset:12992
    v_mfma_f32_16x16x32_bf16 v[104:107], v[240:243], v[176:179], v[104:107]
    ds_read_b64_tr_b16 v[236:237], v67 offset:12512
    v_mfma_f32_16x16x32_bf16 v[108:111], v[240:243], v[180:183], v[108:111]
    ds_read_b64_tr_b16 v[238:239], v67 offset:13024
    s_waitcnt lgkmcnt(8)
    v_mfma_f32_16x16x32_bf16 v[144:147], v[244:247], v[176:179], v[144:147]
    ds_read_b64_tr_b16 v[240:241], v66 offset:12480
    v_mfma_f32_16x16x32_bf16 v[148:151], v[244:247], v[180:183], v[148:151]
    ds_read_b64_tr_b16 v[242:243], v66 offset:12992
    v_mfma_f32_16x16x32_bf16 v[152:155], v[248:251], v[176:179], v[152:155]
    ds_read_b64_tr_b16 v[244:245], v66 offset:12512
    v_mfma_f32_16x16x32_bf16 v[156:159], v[248:251], v[180:183], v[156:159]
    ds_read_b64_tr_b16 v[246:247], v66 offset:13024
    s_waitcnt lgkmcnt(8)
    v_mfma_f32_16x16x32_bf16 v[160:163], v[224:227], v[176:179], v[160:163]
    ds_read_b64_tr_b16 v[248:249], v66 offset:4160
    v_mfma_f32_16x16x32_bf16 v[164:167], v[224:227], v[180:183], v[164:167]
    ds_read_b64_tr_b16 v[250:251], v66 offset:4672
    v_mfma_f32_16x16x32_bf16 v[168:171], v[228:231], v[176:179], v[168:171]
    ds_read_b64_tr_b16 v[224:225], v66 offset:4192
    v_mfma_f32_16x16x32_bf16 v[172:175], v[228:231], v[180:183], v[172:175]
    ds_read_b64_tr_b16 v[226:227], v66 offset:4704
    s_waitcnt lgkmcnt(8)
    s_waitcnt vmcnt(8)
    v_mfma_f32_16x16x32_bf16 v[128:131], v[232:235], v[184:187], v[128:131]
    ds_read_b64_tr_b16 v[228:229], v67 offset:4160
    v_mfma_f32_16x16x32_bf16 v[132:135], v[232:235], v[188:191], v[132:135]
    ds_read_b64_tr_b16 v[230:231], v67 offset:4672
    s_add_u32 s96, s85, 9
    s_and_b32 s97, s96, 15
    s_lshl_b32 s98, s97, 14
    s_add_u32 s16, s98, s15
    buffer_load_dwordx4 v[176:179], v2, s[32:35], s16 offen sc1
    v_mfma_f32_16x16x32_bf16 v[136:139], v[236:239], v[184:187], v[136:139]
    ds_read_b64_tr_b16 v[232:233], v67 offset:4192
    v_mfma_f32_16x16x32_bf16 v[140:143], v[236:239], v[188:191], v[140:143]
    ds_read_b64_tr_b16 v[234:235], v67 offset:4704
    s_waitcnt lgkmcnt(8)
    v_mfma_f32_16x16x32_bf16 v[112:115], v[240:243], v[184:187], v[112:115]
    ds_read_b64_tr_b16 v[236:237], v66 offset:20800
    v_mfma_f32_16x16x32_bf16 v[116:119], v[240:243], v[188:191], v[116:119]
    ds_read_b64_tr_b16 v[238:239], v66 offset:21312
    v_mfma_f32_16x16x32_bf16 v[120:123], v[244:247], v[184:187], v[120:123]
    ds_read_b64_tr_b16 v[240:241], v66 offset:20832
    v_mfma_f32_16x16x32_bf16 v[124:127], v[244:247], v[188:191], v[124:127]
    ds_read_b64_tr_b16 v[242:243], v66 offset:21344
    buffer_load_dwordx4 v[180:183], v2, s[32:35], s16 offen offset:1024 sc1
    s_waitcnt lgkmcnt(8)
    v_mfma_f32_16x16x32_bf16 v[80:83], v[248:251], v[184:187], v[80:83]
    ds_read_b64_tr_b16 v[244:245], v67 offset:20800
    v_mfma_f32_16x16x32_bf16 v[84:87], v[248:251], v[188:191], v[84:87]
    ds_read_b64_tr_b16 v[246:247], v67 offset:21312
    v_mfma_f32_16x16x32_bf16 v[88:91], v[224:227], v[184:187], v[88:91]
    ds_read_b64_tr_b16 v[248:249], v67 offset:20832
    v_mfma_f32_16x16x32_bf16 v[92:95], v[224:227], v[188:191], v[92:95]
    ds_read_b64_tr_b16 v[250:251], v67 offset:21344
    s_waitcnt lgkmcnt(8)
    v_mfma_f32_16x16x32_bf16 v[96:99], v[228:231], v[184:187], v[96:99]
    s_barrier
    ds_read_b64_tr_b16 v[224:225], v67 offset:33280
    v_mfma_f32_16x16x32_bf16 v[100:103], v[228:231], v[188:191], v[100:103]
    ds_read_b64_tr_b16 v[226:227], v67 offset:33792
    v_mfma_f32_16x16x32_bf16 v[104:107], v[232:235], v[184:187], v[104:107]
    ds_read_b64_tr_b16 v[228:229], v67 offset:33312
    v_mfma_f32_16x16x32_bf16 v[108:111], v[232:235], v[188:191], v[108:111]
    ds_read_b64_tr_b16 v[230:231], v67 offset:33824
    s_waitcnt lgkmcnt(8)
    v_mfma_f32_16x16x32_bf16 v[144:147], v[236:239], v[184:187], v[144:147]
    ds_read_b64_tr_b16 v[232:233], v66 offset:33280
    v_mfma_f32_16x16x32_bf16 v[148:151], v[236:239], v[188:191], v[148:151]
    ds_read_b64_tr_b16 v[234:235], v66 offset:33792
    v_mfma_f32_16x16x32_bf16 v[152:155], v[240:243], v[184:187], v[152:155]
    ds_read_b64_tr_b16 v[236:237], v66 offset:33312
    v_mfma_f32_16x16x32_bf16 v[156:159], v[240:243], v[188:191], v[156:159]
    ds_read_b64_tr_b16 v[238:239], v66 offset:33824
    s_waitcnt lgkmcnt(8)
    v_mfma_f32_16x16x32_bf16 v[160:163], v[244:247], v[184:187], v[160:163]
    ds_read_b64_tr_b16 v[240:241], v66 offset:24960
    v_mfma_f32_16x16x32_bf16 v[164:167], v[244:247], v[188:191], v[164:167]
    ds_read_b64_tr_b16 v[242:243], v66 offset:25472
    v_mfma_f32_16x16x32_bf16 v[168:171], v[248:251], v[184:187], v[168:171]
    ds_read_b64_tr_b16 v[244:245], v66 offset:24992
    v_mfma_f32_16x16x32_bf16 v[172:175], v[248:251], v[188:191], v[172:175]
    ds_read_b64_tr_b16 v[246:247], v66 offset:25504
    s_waitcnt lgkmcnt(8)
    s_waitcnt vmcnt(8)
    v_mfma_f32_16x16x32_bf16 v[128:131], v[224:227], v[192:195], v[128:131]
    ds_read_b64_tr_b16 v[248:249], v67 offset:24960
    v_mfma_f32_16x16x32_bf16 v[132:135], v[224:227], v[196:199], v[132:135]
    ds_read_b64_tr_b16 v[250:251], v67 offset:25472
    buffer_load_dwordx4 v[184:187], v2, s[32:35], s16 offen offset:2048 sc1
    v_mfma_f32_16x16x32_bf16 v[136:139], v[228:231], v[192:195], v[136:139]
    ds_read_b64_tr_b16 v[224:225], v67 offset:24992
    v_mfma_f32_16x16x32_bf16 v[140:143], v[228:231], v[196:199], v[140:143]
    ds_read_b64_tr_b16 v[226:227], v67 offset:25504
    s_waitcnt lgkmcnt(8)
    v_mfma_f32_16x16x32_bf16 v[112:115], v[232:235], v[192:195], v[112:115]
    ds_read_b64_tr_b16 v[228:229], v66 offset:41600
    v_mfma_f32_16x16x32_bf16 v[116:119], v[232:235], v[196:199], v[116:119]
    ds_read_b64_tr_b16 v[230:231], v66 offset:42112
    v_mfma_f32_16x16x32_bf16 v[120:123], v[236:239], v[192:195], v[120:123]
    ds_read_b64_tr_b16 v[232:233], v66 offset:41632
    v_mfma_f32_16x16x32_bf16 v[124:127], v[236:239], v[196:199], v[124:127]
    ds_read_b64_tr_b16 v[234:235], v66 offset:42144
    buffer_load_dwordx4 v[188:191], v2, s[32:35], s16 offen offset:3072 sc1
    s_waitcnt lgkmcnt(8)
    v_mfma_f32_16x16x32_bf16 v[80:83], v[240:243], v[192:195], v[80:83]
    ds_read_b64_tr_b16 v[236:237], v67 offset:41600
    v_mfma_f32_16x16x32_bf16 v[84:87], v[240:243], v[196:199], v[84:87]
    ds_read_b64_tr_b16 v[238:239], v67 offset:42112
    v_mfma_f32_16x16x32_bf16 v[88:91], v[244:247], v[192:195], v[88:91]
    ds_read_b64_tr_b16 v[240:241], v67 offset:41632
    v_mfma_f32_16x16x32_bf16 v[92:95], v[244:247], v[196:199], v[92:95]
    ds_read_b64_tr_b16 v[242:243], v67 offset:42144
    s_waitcnt lgkmcnt(8)
    v_mfma_f32_16x16x32_bf16 v[96:99], v[248:251], v[192:195], v[96:99]
    ds_read_b64_tr_b16 v[244:245], v67 offset:37440
    v_mfma_f32_16x16x32_bf16 v[100:103], v[248:251], v[196:199], v[100:103]
    ds_read_b64_tr_b16 v[246:247], v67 offset:37952
    v_mfma_f32_16x16x32_bf16 v[104:107], v[224:227], v[192:195], v[104:107]
    ds_read_b64_tr_b16 v[248:249], v67 offset:37472
    v_mfma_f32_16x16x32_bf16 v[108:111], v[224:227], v[196:199], v[108:111]
    ds_read_b64_tr_b16 v[250:251], v67 offset:37984
    s_waitcnt lgkmcnt(8)
    v_mfma_f32_16x16x32_bf16 v[144:147], v[228:231], v[192:195], v[144:147]
    ds_read_b64_tr_b16 v[224:225], v66 offset:37440
    v_mfma_f32_16x16x32_bf16 v[148:151], v[228:231], v[196:199], v[148:151]
    ds_read_b64_tr_b16 v[226:227], v66 offset:37952
    v_mfma_f32_16x16x32_bf16 v[152:155], v[232:235], v[192:195], v[152:155]
    ds_read_b64_tr_b16 v[228:229], v66 offset:37472
    v_mfma_f32_16x16x32_bf16 v[156:159], v[232:235], v[196:199], v[156:159]
    ds_read_b64_tr_b16 v[230:231], v66 offset:37984
    s_waitcnt lgkmcnt(8)
    v_mfma_f32_16x16x32_bf16 v[160:163], v[236:239], v[192:195], v[160:163]
    ds_read_b64_tr_b16 v[232:233], v66 offset:29120
    v_mfma_f32_16x16x32_bf16 v[164:167], v[236:239], v[196:199], v[164:167]
    ds_read_b64_tr_b16 v[234:235], v66 offset:29632
    v_mfma_f32_16x16x32_bf16 v[168:171], v[240:243], v[192:195], v[168:171]
    ds_read_b64_tr_b16 v[236:237], v66 offset:29152
    v_mfma_f32_16x16x32_bf16 v[172:175], v[240:243], v[196:199], v[172:175]
    ds_read_b64_tr_b16 v[238:239], v66 offset:29664
    s_waitcnt lgkmcnt(8)
    s_waitcnt vmcnt(8)
    v_mfma_f32_16x16x32_bf16 v[128:131], v[244:247], v[200:203], v[128:131]
    ds_read_b64_tr_b16 v[240:241], v67 offset:29120
    v_mfma_f32_16x16x32_bf16 v[132:135], v[244:247], v[204:207], v[132:135]
    ds_read_b64_tr_b16 v[242:243], v67 offset:29632
    s_add_u32 s96, s85, 10
    s_and_b32 s97, s96, 15
    s_lshl_b32 s98, s97, 14
    s_add_u32 s16, s98, s15
    buffer_load_dwordx4 v[192:195], v2, s[32:35], s16 offen sc1
    v_mfma_f32_16x16x32_bf16 v[136:139], v[248:251], v[200:203], v[136:139]
    ds_read_b64_tr_b16 v[244:245], v67 offset:29152
    v_mfma_f32_16x16x32_bf16 v[140:143], v[248:251], v[204:207], v[140:143]
    ds_read_b64_tr_b16 v[246:247], v67 offset:29664
    s_waitcnt lgkmcnt(8)
    v_mfma_f32_16x16x32_bf16 v[112:115], v[224:227], v[200:203], v[112:115]
    ds_read_b64_tr_b16 v[248:249], v66 offset:45760
    v_mfma_f32_16x16x32_bf16 v[116:119], v[224:227], v[204:207], v[116:119]
    ds_read_b64_tr_b16 v[250:251], v66 offset:46272
    v_mfma_f32_16x16x32_bf16 v[120:123], v[228:231], v[200:203], v[120:123]
    ds_read_b64_tr_b16 v[224:225], v66 offset:45792
    v_mfma_f32_16x16x32_bf16 v[124:127], v[228:231], v[204:207], v[124:127]
    ds_read_b64_tr_b16 v[226:227], v66 offset:46304
    buffer_load_dwordx4 v[196:199], v2, s[32:35], s16 offen offset:1024 sc1
    s_waitcnt lgkmcnt(8)
    v_mfma_f32_16x16x32_bf16 v[80:83], v[232:235], v[200:203], v[80:83]
    ds_read_b64_tr_b16 v[228:229], v67 offset:45760
    v_mfma_f32_16x16x32_bf16 v[84:87], v[232:235], v[204:207], v[84:87]
    ds_read_b64_tr_b16 v[230:231], v67 offset:46272
    v_mfma_f32_16x16x32_bf16 v[88:91], v[236:239], v[200:203], v[88:91]
    ds_read_b64_tr_b16 v[232:233], v67 offset:45792
    v_mfma_f32_16x16x32_bf16 v[92:95], v[236:239], v[204:207], v[92:95]
    ds_read_b64_tr_b16 v[234:235], v67 offset:46304
    s_waitcnt lgkmcnt(8)
    v_mfma_f32_16x16x32_bf16 v[96:99], v[240:243], v[200:203], v[96:99]
    s_barrier
    ds_read_b64_tr_b16 v[236:237], v69 offset:8320
    v_mfma_f32_16x16x32_bf16 v[100:103], v[240:243], v[204:207], v[100:103]
    ds_read_b64_tr_b16 v[238:239], v69 offset:8832
    v_mfma_f32_16x16x32_bf16 v[104:107], v[244:247], v[200:203], v[104:107]
    ds_read_b64_tr_b16 v[240:241], v69 offset:8352
    v_mfma_f32_16x16x32_bf16 v[108:111], v[244:247], v[204:207], v[108:111]
    ds_read_b64_tr_b16 v[242:243], v69 offset:8864
    s_waitcnt lgkmcnt(8)
    v_mfma_f32_16x16x32_bf16 v[144:147], v[248:251], v[200:203], v[144:147]
    ds_read_b64_tr_b16 v[244:245], v68 offset:8320
    v_mfma_f32_16x16x32_bf16 v[148:151], v[248:251], v[204:207], v[148:151]
    ds_read_b64_tr_b16 v[246:247], v68 offset:8832
    v_mfma_f32_16x16x32_bf16 v[152:155], v[224:227], v[200:203], v[152:155]
    ds_read_b64_tr_b16 v[248:249], v68 offset:8352
    v_mfma_f32_16x16x32_bf16 v[156:159], v[224:227], v[204:207], v[156:159]
    ds_read_b64_tr_b16 v[250:251], v68 offset:8864
    s_waitcnt lgkmcnt(8)
    v_mfma_f32_16x16x32_bf16 v[160:163], v[228:231], v[200:203], v[160:163]
    ds_read_b64_tr_b16 v[224:225], v68
    v_mfma_f32_16x16x32_bf16 v[164:167], v[228:231], v[204:207], v[164:167]
    ds_read_b64_tr_b16 v[226:227], v68 offset:512
    v_mfma_f32_16x16x32_bf16 v[168:171], v[232:235], v[200:203], v[168:171]
    ds_read_b64_tr_b16 v[228:229], v68 offset:32
    v_mfma_f32_16x16x32_bf16 v[172:175], v[232:235], v[204:207], v[172:175]
    ds_read_b64_tr_b16 v[230:231], v68 offset:544
    s_waitcnt lgkmcnt(8)
    s_waitcnt vmcnt(8)
    v_mfma_f32_16x16x32_bf16 v[128:131], v[236:239], v[208:211], v[128:131]
    ds_read_b64_tr_b16 v[232:233], v69
    v_mfma_f32_16x16x32_bf16 v[132:135], v[236:239], v[212:215], v[132:135]
    ds_read_b64_tr_b16 v[234:235], v69 offset:512
    buffer_load_dwordx4 v[200:203], v2, s[32:35], s16 offen offset:2048 sc1
    v_mfma_f32_16x16x32_bf16 v[136:139], v[240:243], v[208:211], v[136:139]
    ds_read_b64_tr_b16 v[236:237], v69 offset:32
    v_mfma_f32_16x16x32_bf16 v[140:143], v[240:243], v[212:215], v[140:143]
    ds_read_b64_tr_b16 v[238:239], v69 offset:544
    s_waitcnt lgkmcnt(8)
    v_mfma_f32_16x16x32_bf16 v[112:115], v[244:247], v[208:211], v[112:115]
    ds_read_b64_tr_b16 v[240:241], v68 offset:16640
    v_mfma_f32_16x16x32_bf16 v[116:119], v[244:247], v[212:215], v[116:119]
    ds_read_b64_tr_b16 v[242:243], v68 offset:17152
    v_mfma_f32_16x16x32_bf16 v[120:123], v[248:251], v[208:211], v[120:123]
    ds_read_b64_tr_b16 v[244:245], v68 offset:16672
    v_mfma_f32_16x16x32_bf16 v[124:127], v[248:251], v[212:215], v[124:127]
    ds_read_b64_tr_b16 v[246:247], v68 offset:17184
    buffer_load_dwordx4 v[204:207], v2, s[32:35], s16 offen offset:3072 sc1
    s_waitcnt lgkmcnt(8)
    v_mfma_f32_16x16x32_bf16 v[80:83], v[224:227], v[208:211], v[80:83]
    ds_read_b64_tr_b16 v[248:249], v69 offset:16640
    v_mfma_f32_16x16x32_bf16 v[84:87], v[224:227], v[212:215], v[84:87]
    ds_read_b64_tr_b16 v[250:251], v69 offset:17152
    v_mfma_f32_16x16x32_bf16 v[88:91], v[228:231], v[208:211], v[88:91]
    ds_read_b64_tr_b16 v[224:225], v69 offset:16672
    v_mfma_f32_16x16x32_bf16 v[92:95], v[228:231], v[212:215], v[92:95]
    ds_read_b64_tr_b16 v[226:227], v69 offset:17184
    s_waitcnt lgkmcnt(8)
    v_mfma_f32_16x16x32_bf16 v[96:99], v[232:235], v[208:211], v[96:99]
    ds_read_b64_tr_b16 v[228:229], v69 offset:12480
    v_mfma_f32_16x16x32_bf16 v[100:103], v[232:235], v[212:215], v[100:103]
    ds_read_b64_tr_b16 v[230:231], v69 offset:12992
    v_mfma_f32_16x16x32_bf16 v[104:107], v[236:239], v[208:211], v[104:107]
    ds_read_b64_tr_b16 v[232:233], v69 offset:12512
    v_mfma_f32_16x16x32_bf16 v[108:111], v[236:239], v[212:215], v[108:111]
    ds_read_b64_tr_b16 v[234:235], v69 offset:13024
    s_waitcnt lgkmcnt(8)
    v_mfma_f32_16x16x32_bf16 v[144:147], v[240:243], v[208:211], v[144:147]
    ds_read_b64_tr_b16 v[236:237], v68 offset:12480
    v_mfma_f32_16x16x32_bf16 v[148:151], v[240:243], v[212:215], v[148:151]
    ds_read_b64_tr_b16 v[238:239], v68 offset:12992
    v_mfma_f32_16x16x32_bf16 v[152:155], v[244:247], v[208:211], v[152:155]
    ds_read_b64_tr_b16 v[240:241], v68 offset:12512
    v_mfma_f32_16x16x32_bf16 v[156:159], v[244:247], v[212:215], v[156:159]
    ds_read_b64_tr_b16 v[242:243], v68 offset:13024
    s_waitcnt lgkmcnt(8)
    v_mfma_f32_16x16x32_bf16 v[160:163], v[248:251], v[208:211], v[160:163]
    ds_read_b64_tr_b16 v[244:245], v68 offset:4160
    v_mfma_f32_16x16x32_bf16 v[164:167], v[248:251], v[212:215], v[164:167]
    ds_read_b64_tr_b16 v[246:247], v68 offset:4672
    v_mfma_f32_16x16x32_bf16 v[168:171], v[224:227], v[208:211], v[168:171]
    ds_read_b64_tr_b16 v[248:249], v68 offset:4192
    v_mfma_f32_16x16x32_bf16 v[172:175], v[224:227], v[212:215], v[172:175]
    ds_read_b64_tr_b16 v[250:251], v68 offset:4704
    s_waitcnt lgkmcnt(8)
    s_waitcnt vmcnt(8)
    v_mfma_f32_16x16x32_bf16 v[128:131], v[228:231], v[216:219], v[128:131]
    ds_read_b64_tr_b16 v[224:225], v69 offset:4160
    v_mfma_f32_16x16x32_bf16 v[132:135], v[228:231], v[220:223], v[132:135]
    ds_read_b64_tr_b16 v[226:227], v69 offset:4672
    s_add_u32 s96, s85, 11
    s_and_b32 s97, s96, 15
    s_lshl_b32 s98, s97, 14
    s_add_u32 s16, s98, s15
    buffer_load_dwordx4 v[208:211], v2, s[32:35], s16 offen sc1
    v_mfma_f32_16x16x32_bf16 v[136:139], v[232:235], v[216:219], v[136:139]
    ds_read_b64_tr_b16 v[228:229], v69 offset:4192
    v_mfma_f32_16x16x32_bf16 v[140:143], v[232:235], v[220:223], v[140:143]
    ds_read_b64_tr_b16 v[230:231], v69 offset:4704
    s_waitcnt lgkmcnt(8)
    v_mfma_f32_16x16x32_bf16 v[112:115], v[236:239], v[216:219], v[112:115]
    ds_read_b64_tr_b16 v[232:233], v68 offset:20800
    v_mfma_f32_16x16x32_bf16 v[116:119], v[236:239], v[220:223], v[116:119]
    ds_read_b64_tr_b16 v[234:235], v68 offset:21312
    v_mfma_f32_16x16x32_bf16 v[120:123], v[240:243], v[216:219], v[120:123]
    ds_read_b64_tr_b16 v[236:237], v68 offset:20832
    v_mfma_f32_16x16x32_bf16 v[124:127], v[240:243], v[220:223], v[124:127]
    ds_read_b64_tr_b16 v[238:239], v68 offset:21344
    buffer_load_dwordx4 v[212:215], v2, s[32:35], s16 offen offset:1024 sc1
    s_waitcnt lgkmcnt(8)
    v_mfma_f32_16x16x32_bf16 v[80:83], v[244:247], v[216:219], v[80:83]
    ds_read_b64_tr_b16 v[240:241], v69 offset:20800
    v_mfma_f32_16x16x32_bf16 v[84:87], v[244:247], v[220:223], v[84:87]
    ds_read_b64_tr_b16 v[242:243], v69 offset:21312
    v_mfma_f32_16x16x32_bf16 v[88:91], v[248:251], v[216:219], v[88:91]
    ds_read_b64_tr_b16 v[244:245], v69 offset:20832
    v_mfma_f32_16x16x32_bf16 v[92:95], v[248:251], v[220:223], v[92:95]
    ds_read_b64_tr_b16 v[246:247], v69 offset:21344
    s_waitcnt lgkmcnt(8)
    v_mfma_f32_16x16x32_bf16 v[96:99], v[224:227], v[216:219], v[96:99]
    s_barrier
    ds_read_b64_tr_b16 v[248:249], v69 offset:33280
    v_mfma_f32_16x16x32_bf16 v[100:103], v[224:227], v[220:223], v[100:103]
    ds_read_b64_tr_b16 v[250:251], v69 offset:33792
    v_mfma_f32_16x16x32_bf16 v[104:107], v[228:231], v[216:219], v[104:107]
    ds_read_b64_tr_b16 v[224:225], v69 offset:33312
    v_mfma_f32_16x16x32_bf16 v[108:111], v[228:231], v[220:223], v[108:111]
    ds_read_b64_tr_b16 v[226:227], v69 offset:33824
    s_waitcnt lgkmcnt(8)
    v_mfma_f32_16x16x32_bf16 v[144:147], v[232:235], v[216:219], v[144:147]
    ds_read_b64_tr_b16 v[228:229], v68 offset:33280
    v_mfma_f32_16x16x32_bf16 v[148:151], v[232:235], v[220:223], v[148:151]
    ds_read_b64_tr_b16 v[230:231], v68 offset:33792
    v_mfma_f32_16x16x32_bf16 v[152:155], v[236:239], v[216:219], v[152:155]
    ds_read_b64_tr_b16 v[232:233], v68 offset:33312
    v_mfma_f32_16x16x32_bf16 v[156:159], v[236:239], v[220:223], v[156:159]
    ds_read_b64_tr_b16 v[234:235], v68 offset:33824
    s_waitcnt lgkmcnt(8)
    v_mfma_f32_16x16x32_bf16 v[160:163], v[240:243], v[216:219], v[160:163]
    ds_read_b64_tr_b16 v[236:237], v68 offset:24960
    v_mfma_f32_16x16x32_bf16 v[164:167], v[240:243], v[220:223], v[164:167]
    ds_read_b64_tr_b16 v[238:239], v68 offset:25472
    v_mfma_f32_16x16x32_bf16 v[168:171], v[244:247], v[216:219], v[168:171]
    ds_read_b64_tr_b16 v[240:241], v68 offset:24992
    v_mfma_f32_16x16x32_bf16 v[172:175], v[244:247], v[220:223], v[172:175]
    ds_read_b64_tr_b16 v[242:243], v68 offset:25504
    s_waitcnt lgkmcnt(8)
    s_waitcnt vmcnt(8)
    v_mfma_f32_16x16x32_bf16 v[128:131], v[248:251], v[176:179], v[128:131]
    ds_read_b64_tr_b16 v[244:245], v69 offset:24960
    v_mfma_f32_16x16x32_bf16 v[132:135], v[248:251], v[180:183], v[132:135]
    ds_read_b64_tr_b16 v[246:247], v69 offset:25472
    buffer_load_dwordx4 v[216:219], v2, s[32:35], s16 offen offset:2048 sc1
    v_mfma_f32_16x16x32_bf16 v[136:139], v[224:227], v[176:179], v[136:139]
    ds_read_b64_tr_b16 v[248:249], v69 offset:24992
    v_mfma_f32_16x16x32_bf16 v[140:143], v[224:227], v[180:183], v[140:143]
    ds_read_b64_tr_b16 v[250:251], v69 offset:25504
    s_waitcnt lgkmcnt(8)
    v_mfma_f32_16x16x32_bf16 v[112:115], v[228:231], v[176:179], v[112:115]
    ds_read_b64_tr_b16 v[224:225], v68 offset:41600
    v_mfma_f32_16x16x32_bf16 v[116:119], v[228:231], v[180:183], v[116:119]
    ds_read_b64_tr_b16 v[226:227], v68 offset:42112
    v_mfma_f32_16x16x32_bf16 v[120:123], v[232:235], v[176:179], v[120:123]
    ds_read_b64_tr_b16 v[228:229], v68 offset:41632
    v_mfma_f32_16x16x32_bf16 v[124:127], v[232:235], v[180:183], v[124:127]
    ds_read_b64_tr_b16 v[230:231], v68 offset:42144
    buffer_load_dwordx4 v[220:223], v2, s[32:35], s16 offen offset:3072 sc1
    s_waitcnt lgkmcnt(8)
    v_mfma_f32_16x16x32_bf16 v[80:83], v[236:239], v[176:179], v[80:83]
    ds_read_b64_tr_b16 v[232:233], v69 offset:41600
    v_mfma_f32_16x16x32_bf16 v[84:87], v[236:239], v[180:183], v[84:87]
    ds_read_b64_tr_b16 v[234:235], v69 offset:42112
    v_mfma_f32_16x16x32_bf16 v[88:91], v[240:243], v[176:179], v[88:91]
    ds_read_b64_tr_b16 v[236:237], v69 offset:41632
    v_mfma_f32_16x16x32_bf16 v[92:95], v[240:243], v[180:183], v[92:95]
    ds_read_b64_tr_b16 v[238:239], v69 offset:42144
    s_waitcnt lgkmcnt(8)
    v_mfma_f32_16x16x32_bf16 v[96:99], v[244:247], v[176:179], v[96:99]
    ds_read_b64_tr_b16 v[240:241], v69 offset:37440
    v_mfma_f32_16x16x32_bf16 v[100:103], v[244:247], v[180:183], v[100:103]
    ds_read_b64_tr_b16 v[242:243], v69 offset:37952
    v_mfma_f32_16x16x32_bf16 v[104:107], v[248:251], v[176:179], v[104:107]
    ds_read_b64_tr_b16 v[244:245], v69 offset:37472
    v_mfma_f32_16x16x32_bf16 v[108:111], v[248:251], v[180:183], v[108:111]
    ds_read_b64_tr_b16 v[246:247], v69 offset:37984
    s_waitcnt lgkmcnt(8)
    v_mfma_f32_16x16x32_bf16 v[144:147], v[224:227], v[176:179], v[144:147]
    ds_read_b64_tr_b16 v[248:249], v68 offset:37440
    v_mfma_f32_16x16x32_bf16 v[148:151], v[224:227], v[180:183], v[148:151]
    ds_read_b64_tr_b16 v[250:251], v68 offset:37952
    v_mfma_f32_16x16x32_bf16 v[152:155], v[228:231], v[176:179], v[152:155]
    ds_read_b64_tr_b16 v[224:225], v68 offset:37472
    v_mfma_f32_16x16x32_bf16 v[156:159], v[228:231], v[180:183], v[156:159]
    ds_read_b64_tr_b16 v[226:227], v68 offset:37984
    s_waitcnt lgkmcnt(8)
    v_mfma_f32_16x16x32_bf16 v[160:163], v[232:235], v[176:179], v[160:163]
    ds_read_b64_tr_b16 v[228:229], v68 offset:29120
    v_mfma_f32_16x16x32_bf16 v[164:167], v[232:235], v[180:183], v[164:167]
    ds_read_b64_tr_b16 v[230:231], v68 offset:29632
    v_mfma_f32_16x16x32_bf16 v[168:171], v[236:239], v[176:179], v[168:171]
    ds_read_b64_tr_b16 v[232:233], v68 offset:29152
    v_mfma_f32_16x16x32_bf16 v[172:175], v[236:239], v[180:183], v[172:175]
    ds_read_b64_tr_b16 v[234:235], v68 offset:29664
    s_waitcnt lgkmcnt(8)
    s_waitcnt vmcnt(8)
    v_mfma_f32_16x16x32_bf16 v[128:131], v[240:243], v[184:187], v[128:131]
    ds_read_b64_tr_b16 v[236:237], v69 offset:29120
    v_mfma_f32_16x16x32_bf16 v[132:135], v[240:243], v[188:191], v[132:135]
    ds_read_b64_tr_b16 v[238:239], v69 offset:29632
    s_add_u32 s96, s85, 12
    s_and_b32 s97, s96, 15
    s_lshl_b32 s98, s97, 14
    s_add_u32 s16, s98, s15
    buffer_load_dwordx4 v[176:179], v2, s[32:35], s16 offen sc1
    v_mfma_f32_16x16x32_bf16 v[136:139], v[244:247], v[184:187], v[136:139]
    ds_read_b64_tr_b16 v[240:241], v69 offset:29152
    v_mfma_f32_16x16x32_bf16 v[140:143], v[244:247], v[188:191], v[140:143]
    ds_read_b64_tr_b16 v[242:243], v69 offset:29664
    s_waitcnt lgkmcnt(8)
    v_mfma_f32_16x16x32_bf16 v[112:115], v[248:251], v[184:187], v[112:115]
    ds_read_b64_tr_b16 v[244:245], v68 offset:45760
    v_mfma_f32_16x16x32_bf16 v[116:119], v[248:251], v[188:191], v[116:119]
    ds_read_b64_tr_b16 v[246:247], v68 offset:46272
    v_mfma_f32_16x16x32_bf16 v[120:123], v[224:227], v[184:187], v[120:123]
    ds_read_b64_tr_b16 v[248:249], v68 offset:45792
    v_mfma_f32_16x16x32_bf16 v[124:127], v[224:227], v[188:191], v[124:127]
    ds_read_b64_tr_b16 v[250:251], v68 offset:46304
    buffer_load_dwordx4 v[180:183], v2, s[32:35], s16 offen offset:1024 sc1
    s_waitcnt lgkmcnt(8)
    v_mfma_f32_16x16x32_bf16 v[80:83], v[228:231], v[184:187], v[80:83]
    ds_read_b64_tr_b16 v[224:225], v69 offset:45760
    v_mfma_f32_16x16x32_bf16 v[84:87], v[228:231], v[188:191], v[84:87]
    ds_read_b64_tr_b16 v[226:227], v69 offset:46272
    v_mfma_f32_16x16x32_bf16 v[88:91], v[232:235], v[184:187], v[88:91]
    ds_read_b64_tr_b16 v[228:229], v69 offset:45792
    v_mfma_f32_16x16x32_bf16 v[92:95], v[232:235], v[188:191], v[92:95]
    ds_read_b64_tr_b16 v[230:231], v69 offset:46304
    s_waitcnt lgkmcnt(8)
    v_mfma_f32_16x16x32_bf16 v[96:99], v[236:239], v[184:187], v[96:99]
    s_barrier
    ds_read_b64_tr_b16 v[232:233], v71 offset:8320
    v_mfma_f32_16x16x32_bf16 v[100:103], v[236:239], v[188:191], v[100:103]
    ds_read_b64_tr_b16 v[234:235], v71 offset:8832
    v_mfma_f32_16x16x32_bf16 v[104:107], v[240:243], v[184:187], v[104:107]
    ds_read_b64_tr_b16 v[236:237], v71 offset:8352
    v_mfma_f32_16x16x32_bf16 v[108:111], v[240:243], v[188:191], v[108:111]
    ds_read_b64_tr_b16 v[238:239], v71 offset:8864
    s_waitcnt lgkmcnt(8)
    v_mfma_f32_16x16x32_bf16 v[144:147], v[244:247], v[184:187], v[144:147]
    ds_read_b64_tr_b16 v[240:241], v70 offset:8320
    v_mfma_f32_16x16x32_bf16 v[148:151], v[244:247], v[188:191], v[148:151]
    ds_read_b64_tr_b16 v[242:243], v70 offset:8832
    v_mfma_f32_16x16x32_bf16 v[152:155], v[248:251], v[184:187], v[152:155]
    ds_read_b64_tr_b16 v[244:245], v70 offset:8352
    v_mfma_f32_16x16x32_bf16 v[156:159], v[248:251], v[188:191], v[156:159]
    ds_read_b64_tr_b16 v[246:247], v70 offset:8864
    s_waitcnt lgkmcnt(8)
    v_mfma_f32_16x16x32_bf16 v[160:163], v[224:227], v[184:187], v[160:163]
    ds_read_b64_tr_b16 v[248:249], v70
    v_mfma_f32_16x16x32_bf16 v[164:167], v[224:227], v[188:191], v[164:167]
    ds_read_b64_tr_b16 v[250:251], v70 offset:512
    v_mfma_f32_16x16x32_bf16 v[168:171], v[228:231], v[184:187], v[168:171]
    ds_read_b64_tr_b16 v[224:225], v70 offset:32
    v_mfma_f32_16x16x32_bf16 v[172:175], v[228:231], v[188:191], v[172:175]
    ds_read_b64_tr_b16 v[226:227], v70 offset:544
    s_waitcnt lgkmcnt(8)
    s_waitcnt vmcnt(8)
    v_mfma_f32_16x16x32_bf16 v[128:131], v[232:235], v[192:195], v[128:131]
    ds_read_b64_tr_b16 v[228:229], v71
    v_mfma_f32_16x16x32_bf16 v[132:135], v[232:235], v[196:199], v[132:135]
    ds_read_b64_tr_b16 v[230:231], v71 offset:512
    buffer_load_dwordx4 v[184:187], v2, s[32:35], s16 offen offset:2048 sc1
    v_mfma_f32_16x16x32_bf16 v[136:139], v[236:239], v[192:195], v[136:139]
    ds_read_b64_tr_b16 v[232:233], v71 offset:32
    v_mfma_f32_16x16x32_bf16 v[140:143], v[236:239], v[196:199], v[140:143]
    ds_read_b64_tr_b16 v[234:235], v71 offset:544
    s_waitcnt lgkmcnt(8)
    v_mfma_f32_16x16x32_bf16 v[112:115], v[240:243], v[192:195], v[112:115]
    ds_read_b64_tr_b16 v[236:237], v70 offset:16640
    v_mfma_f32_16x16x32_bf16 v[116:119], v[240:243], v[196:199], v[116:119]
    ds_read_b64_tr_b16 v[238:239], v70 offset:17152
    v_mfma_f32_16x16x32_bf16 v[120:123], v[244:247], v[192:195], v[120:123]
    ds_read_b64_tr_b16 v[240:241], v70 offset:16672
    v_mfma_f32_16x16x32_bf16 v[124:127], v[244:247], v[196:199], v[124:127]
    ds_read_b64_tr_b16 v[242:243], v70 offset:17184
    buffer_load_dwordx4 v[188:191], v2, s[32:35], s16 offen offset:3072 sc1
    s_waitcnt lgkmcnt(8)
    v_mfma_f32_16x16x32_bf16 v[80:83], v[248:251], v[192:195], v[80:83]
    ds_read_b64_tr_b16 v[244:245], v71 offset:16640
    v_mfma_f32_16x16x32_bf16 v[84:87], v[248:251], v[196:199], v[84:87]
    ds_read_b64_tr_b16 v[246:247], v71 offset:17152
    v_mfma_f32_16x16x32_bf16 v[88:91], v[224:227], v[192:195], v[88:91]
    ds_read_b64_tr_b16 v[248:249], v71 offset:16672
    v_mfma_f32_16x16x32_bf16 v[92:95], v[224:227], v[196:199], v[92:95]
    ds_read_b64_tr_b16 v[250:251], v71 offset:17184
    s_waitcnt lgkmcnt(8)
    v_mfma_f32_16x16x32_bf16 v[96:99], v[228:231], v[192:195], v[96:99]
    ds_read_b64_tr_b16 v[224:225], v71 offset:12480
    v_mfma_f32_16x16x32_bf16 v[100:103], v[228:231], v[196:199], v[100:103]
    ds_read_b64_tr_b16 v[226:227], v71 offset:12992
    v_mfma_f32_16x16x32_bf16 v[104:107], v[232:235], v[192:195], v[104:107]
    ds_read_b64_tr_b16 v[228:229], v71 offset:12512
    v_mfma_f32_16x16x32_bf16 v[108:111], v[232:235], v[196:199], v[108:111]
    ds_read_b64_tr_b16 v[230:231], v71 offset:13024
    s_waitcnt lgkmcnt(8)
    v_mfma_f32_16x16x32_bf16 v[144:147], v[236:239], v[192:195], v[144:147]
    ds_read_b64_tr_b16 v[232:233], v70 offset:12480
    v_mfma_f32_16x16x32_bf16 v[148:151], v[236:239], v[196:199], v[148:151]
    ds_read_b64_tr_b16 v[234:235], v70 offset:12992
    v_mfma_f32_16x16x32_bf16 v[152:155], v[240:243], v[192:195], v[152:155]
    ds_read_b64_tr_b16 v[236:237], v70 offset:12512
    v_mfma_f32_16x16x32_bf16 v[156:159], v[240:243], v[196:199], v[156:159]
    ds_read_b64_tr_b16 v[238:239], v70 offset:13024
    s_waitcnt lgkmcnt(8)
    v_mfma_f32_16x16x32_bf16 v[160:163], v[244:247], v[192:195], v[160:163]
    ds_read_b64_tr_b16 v[240:241], v70 offset:4160
    v_mfma_f32_16x16x32_bf16 v[164:167], v[244:247], v[196:199], v[164:167]
    ds_read_b64_tr_b16 v[242:243], v70 offset:4672
    v_mfma_f32_16x16x32_bf16 v[168:171], v[248:251], v[192:195], v[168:171]
    ds_read_b64_tr_b16 v[244:245], v70 offset:4192
    v_mfma_f32_16x16x32_bf16 v[172:175], v[248:251], v[196:199], v[172:175]
    ds_read_b64_tr_b16 v[246:247], v70 offset:4704
    s_waitcnt lgkmcnt(8)
    s_waitcnt vmcnt(8)
    v_mfma_f32_16x16x32_bf16 v[128:131], v[224:227], v[200:203], v[128:131]
    ds_read_b64_tr_b16 v[248:249], v71 offset:4160
    v_mfma_f32_16x16x32_bf16 v[132:135], v[224:227], v[204:207], v[132:135]
    ds_read_b64_tr_b16 v[250:251], v71 offset:4672
    s_add_u32 s96, s85, 13
    s_and_b32 s97, s96, 15
    s_lshl_b32 s98, s97, 14
    s_add_u32 s16, s98, s15
    buffer_load_dwordx4 v[192:195], v2, s[32:35], s16 offen sc1
    v_mfma_f32_16x16x32_bf16 v[136:139], v[228:231], v[200:203], v[136:139]
    ds_read_b64_tr_b16 v[224:225], v71 offset:4192
    v_mfma_f32_16x16x32_bf16 v[140:143], v[228:231], v[204:207], v[140:143]
    ds_read_b64_tr_b16 v[226:227], v71 offset:4704
    s_waitcnt lgkmcnt(8)
    v_mfma_f32_16x16x32_bf16 v[112:115], v[232:235], v[200:203], v[112:115]
    ds_read_b64_tr_b16 v[228:229], v70 offset:20800
    v_mfma_f32_16x16x32_bf16 v[116:119], v[232:235], v[204:207], v[116:119]
    ds_read_b64_tr_b16 v[230:231], v70 offset:21312
    v_mfma_f32_16x16x32_bf16 v[120:123], v[236:239], v[200:203], v[120:123]
    ds_read_b64_tr_b16 v[232:233], v70 offset:20832
    v_mfma_f32_16x16x32_bf16 v[124:127], v[236:239], v[204:207], v[124:127]
    ds_read_b64_tr_b16 v[234:235], v70 offset:21344
    buffer_load_dwordx4 v[196:199], v2, s[32:35], s16 offen offset:1024 sc1
    s_waitcnt lgkmcnt(8)
    v_mfma_f32_16x16x32_bf16 v[80:83], v[240:243], v[200:203], v[80:83]
    ds_read_b64_tr_b16 v[236:237], v71 offset:20800
    v_mfma_f32_16x16x32_bf16 v[84:87], v[240:243], v[204:207], v[84:87]
    ds_read_b64_tr_b16 v[238:239], v71 offset:21312
    v_mfma_f32_16x16x32_bf16 v[88:91], v[244:247], v[200:203], v[88:91]
    ds_read_b64_tr_b16 v[240:241], v71 offset:20832
    v_mfma_f32_16x16x32_bf16 v[92:95], v[244:247], v[204:207], v[92:95]
    ds_read_b64_tr_b16 v[242:243], v71 offset:21344
    s_waitcnt lgkmcnt(8)
    v_mfma_f32_16x16x32_bf16 v[96:99], v[248:251], v[200:203], v[96:99]
    s_barrier
    ds_read_b64_tr_b16 v[244:245], v71 offset:33280
    v_mfma_f32_16x16x32_bf16 v[100:103], v[248:251], v[204:207], v[100:103]
    ds_read_b64_tr_b16 v[246:247], v71 offset:33792
    v_mfma_f32_16x16x32_bf16 v[104:107], v[224:227], v[200:203], v[104:107]
    ds_read_b64_tr_b16 v[248:249], v71 offset:33312
    v_mfma_f32_16x16x32_bf16 v[108:111], v[224:227], v[204:207], v[108:111]
    ds_read_b64_tr_b16 v[250:251], v71 offset:33824
    s_waitcnt lgkmcnt(8)
    v_mfma_f32_16x16x32_bf16 v[144:147], v[228:231], v[200:203], v[144:147]
    ds_read_b64_tr_b16 v[224:225], v70 offset:33280
    v_mfma_f32_16x16x32_bf16 v[148:151], v[228:231], v[204:207], v[148:151]
    ds_read_b64_tr_b16 v[226:227], v70 offset:33792
    v_mfma_f32_16x16x32_bf16 v[152:155], v[232:235], v[200:203], v[152:155]
    ds_read_b64_tr_b16 v[228:229], v70 offset:33312
    v_mfma_f32_16x16x32_bf16 v[156:159], v[232:235], v[204:207], v[156:159]
    ds_read_b64_tr_b16 v[230:231], v70 offset:33824
    s_waitcnt lgkmcnt(8)
    v_mfma_f32_16x16x32_bf16 v[160:163], v[236:239], v[200:203], v[160:163]
    ds_read_b64_tr_b16 v[232:233], v70 offset:24960
    v_mfma_f32_16x16x32_bf16 v[164:167], v[236:239], v[204:207], v[164:167]
    ds_read_b64_tr_b16 v[234:235], v70 offset:25472
    v_mfma_f32_16x16x32_bf16 v[168:171], v[240:243], v[200:203], v[168:171]
    ds_read_b64_tr_b16 v[236:237], v70 offset:24992
    v_mfma_f32_16x16x32_bf16 v[172:175], v[240:243], v[204:207], v[172:175]
    ds_read_b64_tr_b16 v[238:239], v70 offset:25504
    s_waitcnt lgkmcnt(8)
    s_waitcnt vmcnt(8)
    v_mfma_f32_16x16x32_bf16 v[128:131], v[244:247], v[208:211], v[128:131]
    ds_read_b64_tr_b16 v[240:241], v71 offset:24960
    v_mfma_f32_16x16x32_bf16 v[132:135], v[244:247], v[212:215], v[132:135]
    ds_read_b64_tr_b16 v[242:243], v71 offset:25472
    buffer_load_dwordx4 v[200:203], v2, s[32:35], s16 offen offset:2048 sc1
    v_mfma_f32_16x16x32_bf16 v[136:139], v[248:251], v[208:211], v[136:139]
    ds_read_b64_tr_b16 v[244:245], v71 offset:24992
    v_mfma_f32_16x16x32_bf16 v[140:143], v[248:251], v[212:215], v[140:143]
    ds_read_b64_tr_b16 v[246:247], v71 offset:25504
    s_waitcnt lgkmcnt(8)
    v_mfma_f32_16x16x32_bf16 v[112:115], v[224:227], v[208:211], v[112:115]
    ds_read_b64_tr_b16 v[248:249], v70 offset:41600
    v_mfma_f32_16x16x32_bf16 v[116:119], v[224:227], v[212:215], v[116:119]
    ds_read_b64_tr_b16 v[250:251], v70 offset:42112
    v_mfma_f32_16x16x32_bf16 v[120:123], v[228:231], v[208:211], v[120:123]
    ds_read_b64_tr_b16 v[224:225], v70 offset:41632
    v_mfma_f32_16x16x32_bf16 v[124:127], v[228:231], v[212:215], v[124:127]
    ds_read_b64_tr_b16 v[226:227], v70 offset:42144
    buffer_load_dwordx4 v[204:207], v2, s[32:35], s16 offen offset:3072 sc1
    s_waitcnt lgkmcnt(8)
    v_mfma_f32_16x16x32_bf16 v[80:83], v[232:235], v[208:211], v[80:83]
    ds_read_b64_tr_b16 v[228:229], v71 offset:41600
    v_mfma_f32_16x16x32_bf16 v[84:87], v[232:235], v[212:215], v[84:87]
    ds_read_b64_tr_b16 v[230:231], v71 offset:42112
    v_mfma_f32_16x16x32_bf16 v[88:91], v[236:239], v[208:211], v[88:91]
    ds_read_b64_tr_b16 v[232:233], v71 offset:41632
    v_mfma_f32_16x16x32_bf16 v[92:95], v[236:239], v[212:215], v[92:95]
    ds_read_b64_tr_b16 v[234:235], v71 offset:42144
    s_waitcnt lgkmcnt(8)
    v_mfma_f32_16x16x32_bf16 v[96:99], v[240:243], v[208:211], v[96:99]
    ds_read_b64_tr_b16 v[236:237], v71 offset:37440
    v_mfma_f32_16x16x32_bf16 v[100:103], v[240:243], v[212:215], v[100:103]
    ds_read_b64_tr_b16 v[238:239], v71 offset:37952
    v_mfma_f32_16x16x32_bf16 v[104:107], v[244:247], v[208:211], v[104:107]
    ds_read_b64_tr_b16 v[240:241], v71 offset:37472
    v_mfma_f32_16x16x32_bf16 v[108:111], v[244:247], v[212:215], v[108:111]
    ds_read_b64_tr_b16 v[242:243], v71 offset:37984
    s_waitcnt lgkmcnt(8)
    v_mfma_f32_16x16x32_bf16 v[144:147], v[248:251], v[208:211], v[144:147]
    ds_read_b64_tr_b16 v[244:245], v70 offset:37440
    v_mfma_f32_16x16x32_bf16 v[148:151], v[248:251], v[212:215], v[148:151]
    ds_read_b64_tr_b16 v[246:247], v70 offset:37952
    v_mfma_f32_16x16x32_bf16 v[152:155], v[224:227], v[208:211], v[152:155]
    ds_read_b64_tr_b16 v[248:249], v70 offset:37472
    v_mfma_f32_16x16x32_bf16 v[156:159], v[224:227], v[212:215], v[156:159]
    ds_read_b64_tr_b16 v[250:251], v70 offset:37984
    s_waitcnt lgkmcnt(8)
    v_mfma_f32_16x16x32_bf16 v[160:163], v[228:231], v[208:211], v[160:163]
    ds_read_b64_tr_b16 v[224:225], v70 offset:29120
    v_mfma_f32_16x16x32_bf16 v[164:167], v[228:231], v[212:215], v[164:167]
    ds_read_b64_tr_b16 v[226:227], v70 offset:29632
    v_mfma_f32_16x16x32_bf16 v[168:171], v[232:235], v[208:211], v[168:171]
    ds_read_b64_tr_b16 v[228:229], v70 offset:29152
    v_mfma_f32_16x16x32_bf16 v[172:175], v[232:235], v[212:215], v[172:175]
    ds_read_b64_tr_b16 v[230:231], v70 offset:29664
    s_waitcnt lgkmcnt(8)
    s_waitcnt vmcnt(8)
    v_mfma_f32_16x16x32_bf16 v[128:131], v[236:239], v[216:219], v[128:131]
    ds_read_b64_tr_b16 v[232:233], v71 offset:29120
    v_mfma_f32_16x16x32_bf16 v[132:135], v[236:239], v[220:223], v[132:135]
    ds_read_b64_tr_b16 v[234:235], v71 offset:29632
    s_add_u32 s96, s85, 14
    s_and_b32 s97, s96, 15
    s_lshl_b32 s98, s97, 14
    s_add_u32 s16, s98, s15
    buffer_load_dwordx4 v[208:211], v2, s[32:35], s16 offen sc1
    v_mfma_f32_16x16x32_bf16 v[136:139], v[240:243], v[216:219], v[136:139]
    ds_read_b64_tr_b16 v[236:237], v71 offset:29152
    v_mfma_f32_16x16x32_bf16 v[140:143], v[240:243], v[220:223], v[140:143]
    ds_read_b64_tr_b16 v[238:239], v71 offset:29664
    s_waitcnt lgkmcnt(8)
    v_mfma_f32_16x16x32_bf16 v[112:115], v[244:247], v[216:219], v[112:115]
    ds_read_b64_tr_b16 v[240:241], v70 offset:45760
    v_mfma_f32_16x16x32_bf16 v[116:119], v[244:247], v[220:223], v[116:119]
    ds_read_b64_tr_b16 v[242:243], v70 offset:46272
    v_mfma_f32_16x16x32_bf16 v[120:123], v[248:251], v[216:219], v[120:123]
    ds_read_b64_tr_b16 v[244:245], v70 offset:45792
    v_mfma_f32_16x16x32_bf16 v[124:127], v[248:251], v[220:223], v[124:127]
    ds_read_b64_tr_b16 v[246:247], v70 offset:46304
    buffer_load_dwordx4 v[212:215], v2, s[32:35], s16 offen offset:1024 sc1
    s_waitcnt lgkmcnt(8)
    v_mfma_f32_16x16x32_bf16 v[80:83], v[224:227], v[216:219], v[80:83]
    ds_read_b64_tr_b16 v[248:249], v71 offset:45760
    v_mfma_f32_16x16x32_bf16 v[84:87], v[224:227], v[220:223], v[84:87]
    ds_read_b64_tr_b16 v[250:251], v71 offset:46272
    v_mfma_f32_16x16x32_bf16 v[88:91], v[228:231], v[216:219], v[88:91]
    ds_read_b64_tr_b16 v[224:225], v71 offset:45792
    v_mfma_f32_16x16x32_bf16 v[92:95], v[228:231], v[220:223], v[92:95]
    ds_read_b64_tr_b16 v[226:227], v71 offset:46304
    s_waitcnt lgkmcnt(8)
    v_mfma_f32_16x16x32_bf16 v[96:99], v[232:235], v[216:219], v[96:99]
    s_barrier
    ds_read_b64_tr_b16 v[228:229], v67 offset:8320
    v_mfma_f32_16x16x32_bf16 v[100:103], v[232:235], v[220:223], v[100:103]
    ds_read_b64_tr_b16 v[230:231], v67 offset:8832
    v_mfma_f32_16x16x32_bf16 v[104:107], v[236:239], v[216:219], v[104:107]
    ds_read_b64_tr_b16 v[232:233], v67 offset:8352
    v_mfma_f32_16x16x32_bf16 v[108:111], v[236:239], v[220:223], v[108:111]
    ds_read_b64_tr_b16 v[234:235], v67 offset:8864
    s_waitcnt lgkmcnt(8)
    v_mfma_f32_16x16x32_bf16 v[144:147], v[240:243], v[216:219], v[144:147]
    ds_read_b64_tr_b16 v[236:237], v66 offset:8320
    v_mfma_f32_16x16x32_bf16 v[148:151], v[240:243], v[220:223], v[148:151]
    ds_read_b64_tr_b16 v[238:239], v66 offset:8832
    v_mfma_f32_16x16x32_bf16 v[152:155], v[244:247], v[216:219], v[152:155]
    ds_read_b64_tr_b16 v[240:241], v66 offset:8352
    v_mfma_f32_16x16x32_bf16 v[156:159], v[244:247], v[220:223], v[156:159]
    ds_read_b64_tr_b16 v[242:243], v66 offset:8864
    s_waitcnt lgkmcnt(8)
    v_mfma_f32_16x16x32_bf16 v[160:163], v[248:251], v[216:219], v[160:163]
    ds_read_b64_tr_b16 v[244:245], v66
    v_mfma_f32_16x16x32_bf16 v[164:167], v[248:251], v[220:223], v[164:167]
    ds_read_b64_tr_b16 v[246:247], v66 offset:512
    v_mfma_f32_16x16x32_bf16 v[168:171], v[224:227], v[216:219], v[168:171]
    ds_read_b64_tr_b16 v[248:249], v66 offset:32
    v_mfma_f32_16x16x32_bf16 v[172:175], v[224:227], v[220:223], v[172:175]
    ds_read_b64_tr_b16 v[250:251], v66 offset:544
    s_waitcnt lgkmcnt(8)
    s_waitcnt vmcnt(8)
    v_mfma_f32_16x16x32_bf16 v[128:131], v[228:231], v[176:179], v[128:131]
    ds_read_b64_tr_b16 v[224:225], v67
    v_mfma_f32_16x16x32_bf16 v[132:135], v[228:231], v[180:183], v[132:135]
    ds_read_b64_tr_b16 v[226:227], v67 offset:512
    buffer_load_dwordx4 v[216:219], v2, s[32:35], s16 offen offset:2048 sc1
    v_mfma_f32_16x16x32_bf16 v[136:139], v[232:235], v[176:179], v[136:139]
    ds_read_b64_tr_b16 v[228:229], v67 offset:32
    v_mfma_f32_16x16x32_bf16 v[140:143], v[232:235], v[180:183], v[140:143]
    ds_read_b64_tr_b16 v[230:231], v67 offset:544
    s_waitcnt lgkmcnt(8)
    v_mfma_f32_16x16x32_bf16 v[112:115], v[236:239], v[176:179], v[112:115]
    ds_read_b64_tr_b16 v[232:233], v66 offset:16640
    v_mfma_f32_16x16x32_bf16 v[116:119], v[236:239], v[180:183], v[116:119]
    ds_read_b64_tr_b16 v[234:235], v66 offset:17152
    v_mfma_f32_16x16x32_bf16 v[120:123], v[240:243], v[176:179], v[120:123]
    ds_read_b64_tr_b16 v[236:237], v66 offset:16672
    v_mfma_f32_16x16x32_bf16 v[124:127], v[240:243], v[180:183], v[124:127]
    ds_read_b64_tr_b16 v[238:239], v66 offset:17184
    buffer_load_dwordx4 v[220:223], v2, s[32:35], s16 offen offset:3072 sc1
    s_waitcnt lgkmcnt(8)
    v_mfma_f32_16x16x32_bf16 v[80:83], v[244:247], v[176:179], v[80:83]
    ds_read_b64_tr_b16 v[240:241], v67 offset:16640
    v_mfma_f32_16x16x32_bf16 v[84:87], v[244:247], v[180:183], v[84:87]
    ds_read_b64_tr_b16 v[242:243], v67 offset:17152
    v_mfma_f32_16x16x32_bf16 v[88:91], v[248:251], v[176:179], v[88:91]
    ds_read_b64_tr_b16 v[244:245], v67 offset:16672
    v_mfma_f32_16x16x32_bf16 v[92:95], v[248:251], v[180:183], v[92:95]
    ds_read_b64_tr_b16 v[246:247], v67 offset:17184
    s_waitcnt lgkmcnt(8)
    v_mfma_f32_16x16x32_bf16 v[96:99], v[224:227], v[176:179], v[96:99]
    ds_read_b64_tr_b16 v[248:249], v67 offset:12480
    v_mfma_f32_16x16x32_bf16 v[100:103], v[224:227], v[180:183], v[100:103]
    ds_read_b64_tr_b16 v[250:251], v67 offset:12992
    v_mfma_f32_16x16x32_bf16 v[104:107], v[228:231], v[176:179], v[104:107]
    ds_read_b64_tr_b16 v[224:225], v67 offset:12512
    v_mfma_f32_16x16x32_bf16 v[108:111], v[228:231], v[180:183], v[108:111]
    ds_read_b64_tr_b16 v[226:227], v67 offset:13024
    s_waitcnt lgkmcnt(8)
    v_mfma_f32_16x16x32_bf16 v[144:147], v[232:235], v[176:179], v[144:147]
    ds_read_b64_tr_b16 v[228:229], v66 offset:12480
    v_mfma_f32_16x16x32_bf16 v[148:151], v[232:235], v[180:183], v[148:151]
    ds_read_b64_tr_b16 v[230:231], v66 offset:12992
    v_mfma_f32_16x16x32_bf16 v[152:155], v[236:239], v[176:179], v[152:155]
    ds_read_b64_tr_b16 v[232:233], v66 offset:12512
    v_mfma_f32_16x16x32_bf16 v[156:159], v[236:239], v[180:183], v[156:159]
    ds_read_b64_tr_b16 v[234:235], v66 offset:13024
    s_waitcnt lgkmcnt(8)
    v_mfma_f32_16x16x32_bf16 v[160:163], v[240:243], v[176:179], v[160:163]
    ds_read_b64_tr_b16 v[236:237], v66 offset:4160
    v_mfma_f32_16x16x32_bf16 v[164:167], v[240:243], v[180:183], v[164:167]
    ds_read_b64_tr_b16 v[238:239], v66 offset:4672
    v_mfma_f32_16x16x32_bf16 v[168:171], v[244:247], v[176:179], v[168:171]
    ds_read_b64_tr_b16 v[240:241], v66 offset:4192
    v_mfma_f32_16x16x32_bf16 v[172:175], v[244:247], v[180:183], v[172:175]
    ds_read_b64_tr_b16 v[242:243], v66 offset:4704
    s_waitcnt lgkmcnt(8)
    s_waitcnt vmcnt(8)
    v_mfma_f32_16x16x32_bf16 v[128:131], v[248:251], v[184:187], v[128:131]
    ds_read_b64_tr_b16 v[244:245], v67 offset:4160
    v_mfma_f32_16x16x32_bf16 v[132:135], v[248:251], v[188:191], v[132:135]
    ds_read_b64_tr_b16 v[246:247], v67 offset:4672
    s_add_u32 s96, s85, 15
    s_and_b32 s97, s96, 15
    s_lshl_b32 s98, s97, 14
    s_add_u32 s16, s98, s15
    buffer_load_dwordx4 v[176:179], v2, s[32:35], s16 offen sc1
    v_mfma_f32_16x16x32_bf16 v[136:139], v[224:227], v[184:187], v[136:139]
    ds_read_b64_tr_b16 v[248:249], v67 offset:4192
    v_mfma_f32_16x16x32_bf16 v[140:143], v[224:227], v[188:191], v[140:143]
    ds_read_b64_tr_b16 v[250:251], v67 offset:4704
    s_waitcnt lgkmcnt(8)
    v_mfma_f32_16x16x32_bf16 v[112:115], v[228:231], v[184:187], v[112:115]
    ds_read_b64_tr_b16 v[224:225], v66 offset:20800
    v_mfma_f32_16x16x32_bf16 v[116:119], v[228:231], v[188:191], v[116:119]
    ds_read_b64_tr_b16 v[226:227], v66 offset:21312
    v_mfma_f32_16x16x32_bf16 v[120:123], v[232:235], v[184:187], v[120:123]
    ds_read_b64_tr_b16 v[228:229], v66 offset:20832
    v_mfma_f32_16x16x32_bf16 v[124:127], v[232:235], v[188:191], v[124:127]
    ds_read_b64_tr_b16 v[230:231], v66 offset:21344
    buffer_load_dwordx4 v[180:183], v2, s[32:35], s16 offen offset:1024 sc1
    s_waitcnt lgkmcnt(8)
    v_mfma_f32_16x16x32_bf16 v[80:83], v[236:239], v[184:187], v[80:83]
    ds_read_b64_tr_b16 v[232:233], v67 offset:20800
    v_mfma_f32_16x16x32_bf16 v[84:87], v[236:239], v[188:191], v[84:87]
    ds_read_b64_tr_b16 v[234:235], v67 offset:21312
    v_mfma_f32_16x16x32_bf16 v[88:91], v[240:243], v[184:187], v[88:91]
    ds_read_b64_tr_b16 v[236:237], v67 offset:20832
    v_mfma_f32_16x16x32_bf16 v[92:95], v[240:243], v[188:191], v[92:95]
    ds_read_b64_tr_b16 v[238:239], v67 offset:21344
    s_waitcnt lgkmcnt(8)
    v_mfma_f32_16x16x32_bf16 v[96:99], v[244:247], v[184:187], v[96:99]
    s_barrier
    ds_read_b64_tr_b16 v[240:241], v67 offset:33280
    v_mfma_f32_16x16x32_bf16 v[100:103], v[244:247], v[188:191], v[100:103]
    ds_read_b64_tr_b16 v[242:243], v67 offset:33792
    v_mfma_f32_16x16x32_bf16 v[104:107], v[248:251], v[184:187], v[104:107]
    ds_read_b64_tr_b16 v[244:245], v67 offset:33312
    v_mfma_f32_16x16x32_bf16 v[108:111], v[248:251], v[188:191], v[108:111]
    ds_read_b64_tr_b16 v[246:247], v67 offset:33824
    s_waitcnt lgkmcnt(8)
    v_mfma_f32_16x16x32_bf16 v[144:147], v[224:227], v[184:187], v[144:147]
    ds_read_b64_tr_b16 v[248:249], v66 offset:33280
    v_mfma_f32_16x16x32_bf16 v[148:151], v[224:227], v[188:191], v[148:151]
    ds_read_b64_tr_b16 v[250:251], v66 offset:33792
    v_mfma_f32_16x16x32_bf16 v[152:155], v[228:231], v[184:187], v[152:155]
    ds_read_b64_tr_b16 v[224:225], v66 offset:33312
    v_mfma_f32_16x16x32_bf16 v[156:159], v[228:231], v[188:191], v[156:159]
    ds_read_b64_tr_b16 v[226:227], v66 offset:33824
    s_waitcnt lgkmcnt(8)
    v_mfma_f32_16x16x32_bf16 v[160:163], v[232:235], v[184:187], v[160:163]
    ds_read_b64_tr_b16 v[228:229], v66 offset:24960
    v_mfma_f32_16x16x32_bf16 v[164:167], v[232:235], v[188:191], v[164:167]
    ds_read_b64_tr_b16 v[230:231], v66 offset:25472
    v_mfma_f32_16x16x32_bf16 v[168:171], v[236:239], v[184:187], v[168:171]
    ds_read_b64_tr_b16 v[232:233], v66 offset:24992
    v_mfma_f32_16x16x32_bf16 v[172:175], v[236:239], v[188:191], v[172:175]
    ds_read_b64_tr_b16 v[234:235], v66 offset:25504
    s_waitcnt lgkmcnt(8)
    s_waitcnt vmcnt(8)
    v_mfma_f32_16x16x32_bf16 v[128:131], v[240:243], v[192:195], v[128:131]
    ds_read_b64_tr_b16 v[236:237], v67 offset:24960
    v_mfma_f32_16x16x32_bf16 v[132:135], v[240:243], v[196:199], v[132:135]
    ds_read_b64_tr_b16 v[238:239], v67 offset:25472
    buffer_load_dwordx4 v[184:187], v2, s[32:35], s16 offen offset:2048 sc1
    v_mfma_f32_16x16x32_bf16 v[136:139], v[244:247], v[192:195], v[136:139]
    ds_read_b64_tr_b16 v[240:241], v67 offset:24992
    v_mfma_f32_16x16x32_bf16 v[140:143], v[244:247], v[196:199], v[140:143]
    ds_read_b64_tr_b16 v[242:243], v67 offset:25504
    s_waitcnt lgkmcnt(8)
    v_mfma_f32_16x16x32_bf16 v[112:115], v[248:251], v[192:195], v[112:115]
    ds_read_b64_tr_b16 v[244:245], v66 offset:41600
    v_mfma_f32_16x16x32_bf16 v[116:119], v[248:251], v[196:199], v[116:119]
    ds_read_b64_tr_b16 v[246:247], v66 offset:42112
    v_mfma_f32_16x16x32_bf16 v[120:123], v[224:227], v[192:195], v[120:123]
    ds_read_b64_tr_b16 v[248:249], v66 offset:41632
    v_mfma_f32_16x16x32_bf16 v[124:127], v[224:227], v[196:199], v[124:127]
    ds_read_b64_tr_b16 v[250:251], v66 offset:42144
    buffer_load_dwordx4 v[188:191], v2, s[32:35], s16 offen offset:3072 sc1
    s_barrier
    s_waitcnt lgkmcnt(8)
    v_mfma_f32_16x16x32_bf16 v[80:83], v[228:231], v[192:195], v[80:83]
    ds_read_b64_tr_b16 v[224:225], v67 offset:41600
    v_mfma_f32_16x16x32_bf16 v[84:87], v[228:231], v[196:199], v[84:87]
    ds_read_b64_tr_b16 v[226:227], v67 offset:42112
    v_mfma_f32_16x16x32_bf16 v[88:91], v[232:235], v[192:195], v[88:91]
    ds_read_b64_tr_b16 v[228:229], v67 offset:41632
    v_mfma_f32_16x16x32_bf16 v[92:95], v[232:235], v[196:199], v[92:95]
    ds_read_b64_tr_b16 v[230:231], v67 offset:42144
    s_waitcnt lgkmcnt(8)
    v_mfma_f32_16x16x32_bf16 v[96:99], v[236:239], v[192:195], v[96:99]
    ds_read_b64_tr_b16 v[232:233], v67 offset:37440
    v_mfma_f32_16x16x32_bf16 v[100:103], v[236:239], v[196:199], v[100:103]
    ds_read_b64_tr_b16 v[234:235], v67 offset:37952
    v_mfma_f32_16x16x32_bf16 v[104:107], v[240:243], v[192:195], v[104:107]
    ds_read_b64_tr_b16 v[236:237], v67 offset:37472
    v_mfma_f32_16x16x32_bf16 v[108:111], v[240:243], v[196:199], v[108:111]
    ds_read_b64_tr_b16 v[238:239], v67 offset:37984
    s_waitcnt lgkmcnt(8)
    v_mfma_f32_16x16x32_bf16 v[144:147], v[244:247], v[192:195], v[144:147]
    ds_read_b64_tr_b16 v[240:241], v66 offset:37440
    v_mfma_f32_16x16x32_bf16 v[148:151], v[244:247], v[196:199], v[148:151]
    ds_read_b64_tr_b16 v[242:243], v66 offset:37952
    v_mfma_f32_16x16x32_bf16 v[152:155], v[248:251], v[192:195], v[152:155]
    ds_read_b64_tr_b16 v[244:245], v66 offset:37472
    v_mfma_f32_16x16x32_bf16 v[156:159], v[248:251], v[196:199], v[156:159]
    ds_read_b64_tr_b16 v[246:247], v66 offset:37984
    s_waitcnt lgkmcnt(8)
    v_mfma_f32_16x16x32_bf16 v[160:163], v[224:227], v[192:195], v[160:163]
    ds_read_b64_tr_b16 v[248:249], v66 offset:29120
    v_mfma_f32_16x16x32_bf16 v[164:167], v[224:227], v[196:199], v[164:167]
    ds_read_b64_tr_b16 v[250:251], v66 offset:29632
    v_mfma_f32_16x16x32_bf16 v[168:171], v[228:231], v[192:195], v[168:171]
    ds_read_b64_tr_b16 v[224:225], v66 offset:29152
    v_mfma_f32_16x16x32_bf16 v[172:175], v[228:231], v[196:199], v[172:175]
    ds_read_b64_tr_b16 v[226:227], v66 offset:29664
    s_waitcnt lgkmcnt(8)
    s_waitcnt vmcnt(8)
    v_mfma_f32_16x16x32_bf16 v[128:131], v[232:235], v[200:203], v[128:131]
    ds_read_b64_tr_b16 v[228:229], v67 offset:29120
    v_mfma_f32_16x16x32_bf16 v[132:135], v[232:235], v[204:207], v[132:135]
    ds_read_b64_tr_b16 v[230:231], v67 offset:29632
    v_mfma_f32_16x16x32_bf16 v[136:139], v[236:239], v[200:203], v[136:139]
    ds_read_b64_tr_b16 v[232:233], v67 offset:29152
    v_mfma_f32_16x16x32_bf16 v[140:143], v[236:239], v[204:207], v[140:143]
    ds_read_b64_tr_b16 v[234:235], v67 offset:29664
    s_waitcnt lgkmcnt(8)
    v_mfma_f32_16x16x32_bf16 v[112:115], v[240:243], v[200:203], v[112:115]
    ds_read_b64_tr_b16 v[236:237], v66 offset:45760
    v_mfma_f32_16x16x32_bf16 v[116:119], v[240:243], v[204:207], v[116:119]
    ds_read_b64_tr_b16 v[238:239], v66 offset:46272
    v_mfma_f32_16x16x32_bf16 v[120:123], v[244:247], v[200:203], v[120:123]
    ds_read_b64_tr_b16 v[240:241], v66 offset:45792
    v_mfma_f32_16x16x32_bf16 v[124:127], v[244:247], v[204:207], v[124:127]
    ds_read_b64_tr_b16 v[242:243], v66 offset:46304
    s_waitcnt lgkmcnt(8)
    v_mfma_f32_16x16x32_bf16 v[80:83], v[248:251], v[200:203], v[80:83]
    ds_read_b64_tr_b16 v[244:245], v67 offset:45760
    v_mfma_f32_16x16x32_bf16 v[84:87], v[248:251], v[204:207], v[84:87]
    ds_read_b64_tr_b16 v[246:247], v67 offset:46272
    v_mfma_f32_16x16x32_bf16 v[88:91], v[224:227], v[200:203], v[88:91]
    ds_read_b64_tr_b16 v[248:249], v67 offset:45792
    v_mfma_f32_16x16x32_bf16 v[92:95], v[224:227], v[204:207], v[92:95]
    ds_read_b64_tr_b16 v[250:251], v67 offset:46304
    s_waitcnt lgkmcnt(8)
    v_mfma_f32_16x16x32_bf16 v[96:99], v[228:231], v[200:203], v[96:99]
    ds_read_b64_tr_b16 v[224:225], v69 offset:8320
    v_mfma_f32_16x16x32_bf16 v[100:103], v[228:231], v[204:207], v[100:103]
    ds_read_b64_tr_b16 v[226:227], v69 offset:8832
    v_mfma_f32_16x16x32_bf16 v[104:107], v[232:235], v[200:203], v[104:107]
    ds_read_b64_tr_b16 v[228:229], v69 offset:8352
    v_mfma_f32_16x16x32_bf16 v[108:111], v[232:235], v[204:207], v[108:111]
    ds_read_b64_tr_b16 v[230:231], v69 offset:8864
    s_waitcnt lgkmcnt(8)
    v_mfma_f32_16x16x32_bf16 v[144:147], v[236:239], v[200:203], v[144:147]
    ds_read_b64_tr_b16 v[232:233], v68 offset:8320
    v_mfma_f32_16x16x32_bf16 v[148:151], v[236:239], v[204:207], v[148:151]
    ds_read_b64_tr_b16 v[234:235], v68 offset:8832
    v_mfma_f32_16x16x32_bf16 v[152:155], v[240:243], v[200:203], v[152:155]
    ds_read_b64_tr_b16 v[236:237], v68 offset:8352
    v_mfma_f32_16x16x32_bf16 v[156:159], v[240:243], v[204:207], v[156:159]
    ds_read_b64_tr_b16 v[238:239], v68 offset:8864
    s_waitcnt lgkmcnt(8)
    v_mfma_f32_16x16x32_bf16 v[160:163], v[244:247], v[200:203], v[160:163]
    ds_read_b64_tr_b16 v[240:241], v68
    v_mfma_f32_16x16x32_bf16 v[164:167], v[244:247], v[204:207], v[164:167]
    ds_read_b64_tr_b16 v[242:243], v68 offset:512
    v_mfma_f32_16x16x32_bf16 v[168:171], v[248:251], v[200:203], v[168:171]
    ds_read_b64_tr_b16 v[244:245], v68 offset:32
    v_mfma_f32_16x16x32_bf16 v[172:175], v[248:251], v[204:207], v[172:175]
    ds_read_b64_tr_b16 v[246:247], v68 offset:544
    s_waitcnt lgkmcnt(8)
    s_waitcnt vmcnt(6)
    v_mfma_f32_16x16x32_bf16 v[128:131], v[224:227], v[208:211], v[128:131]
    ds_read_b64_tr_b16 v[248:249], v69
    v_mfma_f32_16x16x32_bf16 v[132:135], v[224:227], v[212:215], v[132:135]
    ds_read_b64_tr_b16 v[250:251], v69 offset:512
    v_mfma_f32_16x16x32_bf16 v[136:139], v[228:231], v[208:211], v[136:139]
    ds_read_b64_tr_b16 v[224:225], v69 offset:32
    v_mfma_f32_16x16x32_bf16 v[140:143], v[228:231], v[212:215], v[140:143]
    ds_read_b64_tr_b16 v[226:227], v69 offset:544
    s_waitcnt lgkmcnt(8)
    v_mfma_f32_16x16x32_bf16 v[112:115], v[232:235], v[208:211], v[112:115]
    ds_read_b64_tr_b16 v[228:229], v68 offset:16640
    v_mfma_f32_16x16x32_bf16 v[116:119], v[232:235], v[212:215], v[116:119]
    ds_read_b64_tr_b16 v[230:231], v68 offset:17152
    v_mfma_f32_16x16x32_bf16 v[120:123], v[236:239], v[208:211], v[120:123]
    ds_read_b64_tr_b16 v[232:233], v68 offset:16672
    v_mfma_f32_16x16x32_bf16 v[124:127], v[236:239], v[212:215], v[124:127]
    ds_read_b64_tr_b16 v[234:235], v68 offset:17184
    s_waitcnt lgkmcnt(8)
    v_mfma_f32_16x16x32_bf16 v[80:83], v[240:243], v[208:211], v[80:83]
    ds_read_b64_tr_b16 v[236:237], v69 offset:16640
    v_mfma_f32_16x16x32_bf16 v[84:87], v[240:243], v[212:215], v[84:87]
    ds_read_b64_tr_b16 v[238:239], v69 offset:17152
    v_mfma_f32_16x16x32_bf16 v[88:91], v[244:247], v[208:211], v[88:91]
    ds_read_b64_tr_b16 v[240:241], v69 offset:16672
    v_mfma_f32_16x16x32_bf16 v[92:95], v[244:247], v[212:215], v[92:95]
    ds_read_b64_tr_b16 v[242:243], v69 offset:17184
    s_waitcnt lgkmcnt(8)
    v_mfma_f32_16x16x32_bf16 v[96:99], v[248:251], v[208:211], v[96:99]
    ds_read_b64_tr_b16 v[244:245], v69 offset:12480
    v_mfma_f32_16x16x32_bf16 v[100:103], v[248:251], v[212:215], v[100:103]
    ds_read_b64_tr_b16 v[246:247], v69 offset:12992
    v_mfma_f32_16x16x32_bf16 v[104:107], v[224:227], v[208:211], v[104:107]
    ds_read_b64_tr_b16 v[248:249], v69 offset:12512
    v_mfma_f32_16x16x32_bf16 v[108:111], v[224:227], v[212:215], v[108:111]
    ds_read_b64_tr_b16 v[250:251], v69 offset:13024
    s_waitcnt lgkmcnt(8)
    v_mfma_f32_16x16x32_bf16 v[144:147], v[228:231], v[208:211], v[144:147]
    ds_read_b64_tr_b16 v[224:225], v68 offset:12480
    v_mfma_f32_16x16x32_bf16 v[148:151], v[228:231], v[212:215], v[148:151]
    ds_read_b64_tr_b16 v[226:227], v68 offset:12992
    v_mfma_f32_16x16x32_bf16 v[152:155], v[232:235], v[208:211], v[152:155]
    ds_read_b64_tr_b16 v[228:229], v68 offset:12512
    v_mfma_f32_16x16x32_bf16 v[156:159], v[232:235], v[212:215], v[156:159]
    ds_read_b64_tr_b16 v[230:231], v68 offset:13024
    s_waitcnt lgkmcnt(8)
    v_mfma_f32_16x16x32_bf16 v[160:163], v[236:239], v[208:211], v[160:163]
    ds_read_b64_tr_b16 v[232:233], v68 offset:4160
    v_mfma_f32_16x16x32_bf16 v[164:167], v[236:239], v[212:215], v[164:167]
    ds_read_b64_tr_b16 v[234:235], v68 offset:4672
    v_mfma_f32_16x16x32_bf16 v[168:171], v[240:243], v[208:211], v[168:171]
    ds_read_b64_tr_b16 v[236:237], v68 offset:4192
    v_mfma_f32_16x16x32_bf16 v[172:175], v[240:243], v[212:215], v[172:175]
    ds_read_b64_tr_b16 v[238:239], v68 offset:4704
    s_waitcnt lgkmcnt(8)
    s_waitcnt vmcnt(4)
    v_mfma_f32_16x16x32_bf16 v[128:131], v[244:247], v[216:219], v[128:131]
    ds_read_b64_tr_b16 v[240:241], v69 offset:4160
    v_mfma_f32_16x16x32_bf16 v[132:135], v[244:247], v[220:223], v[132:135]
    ds_read_b64_tr_b16 v[242:243], v69 offset:4672
    v_mfma_f32_16x16x32_bf16 v[136:139], v[248:251], v[216:219], v[136:139]
    ds_read_b64_tr_b16 v[244:245], v69 offset:4192
    v_mfma_f32_16x16x32_bf16 v[140:143], v[248:251], v[220:223], v[140:143]
    ds_read_b64_tr_b16 v[246:247], v69 offset:4704
    s_waitcnt lgkmcnt(8)
    v_mfma_f32_16x16x32_bf16 v[112:115], v[224:227], v[216:219], v[112:115]
    ds_read_b64_tr_b16 v[248:249], v68 offset:20800
    v_mfma_f32_16x16x32_bf16 v[116:119], v[224:227], v[220:223], v[116:119]
    ds_read_b64_tr_b16 v[250:251], v68 offset:21312
    v_mfma_f32_16x16x32_bf16 v[120:123], v[228:231], v[216:219], v[120:123]
    ds_read_b64_tr_b16 v[224:225], v68 offset:20832
    v_mfma_f32_16x16x32_bf16 v[124:127], v[228:231], v[220:223], v[124:127]
    ds_read_b64_tr_b16 v[226:227], v68 offset:21344
    s_waitcnt lgkmcnt(8)
    v_mfma_f32_16x16x32_bf16 v[80:83], v[232:235], v[216:219], v[80:83]
    ds_read_b64_tr_b16 v[228:229], v69 offset:20800
    v_mfma_f32_16x16x32_bf16 v[84:87], v[232:235], v[220:223], v[84:87]
    ds_read_b64_tr_b16 v[230:231], v69 offset:21312
    v_mfma_f32_16x16x32_bf16 v[88:91], v[236:239], v[216:219], v[88:91]
    ds_read_b64_tr_b16 v[232:233], v69 offset:20832
    v_mfma_f32_16x16x32_bf16 v[92:95], v[236:239], v[220:223], v[92:95]
    ds_read_b64_tr_b16 v[234:235], v69 offset:21344
    s_waitcnt lgkmcnt(8)
    v_mfma_f32_16x16x32_bf16 v[96:99], v[240:243], v[216:219], v[96:99]
    ds_read_b64_tr_b16 v[236:237], v69 offset:33280
    v_mfma_f32_16x16x32_bf16 v[100:103], v[240:243], v[220:223], v[100:103]
    ds_read_b64_tr_b16 v[238:239], v69 offset:33792
    v_mfma_f32_16x16x32_bf16 v[104:107], v[244:247], v[216:219], v[104:107]
    ds_read_b64_tr_b16 v[240:241], v69 offset:33312
    v_mfma_f32_16x16x32_bf16 v[108:111], v[244:247], v[220:223], v[108:111]
    ds_read_b64_tr_b16 v[242:243], v69 offset:33824
    s_waitcnt lgkmcnt(8)
    v_mfma_f32_16x16x32_bf16 v[144:147], v[248:251], v[216:219], v[144:147]
    ds_read_b64_tr_b16 v[244:245], v68 offset:33280
    v_mfma_f32_16x16x32_bf16 v[148:151], v[248:251], v[220:223], v[148:151]
    ds_read_b64_tr_b16 v[246:247], v68 offset:33792
    v_mfma_f32_16x16x32_bf16 v[152:155], v[224:227], v[216:219], v[152:155]
    ds_read_b64_tr_b16 v[248:249], v68 offset:33312
    v_mfma_f32_16x16x32_bf16 v[156:159], v[224:227], v[220:223], v[156:159]
    ds_read_b64_tr_b16 v[250:251], v68 offset:33824
    s_waitcnt lgkmcnt(8)
    v_mfma_f32_16x16x32_bf16 v[160:163], v[228:231], v[216:219], v[160:163]
    ds_read_b64_tr_b16 v[224:225], v68 offset:24960
    v_mfma_f32_16x16x32_bf16 v[164:167], v[228:231], v[220:223], v[164:167]
    ds_read_b64_tr_b16 v[226:227], v68 offset:25472
    v_mfma_f32_16x16x32_bf16 v[168:171], v[232:235], v[216:219], v[168:171]
    ds_read_b64_tr_b16 v[228:229], v68 offset:24992
    v_mfma_f32_16x16x32_bf16 v[172:175], v[232:235], v[220:223], v[172:175]
    ds_read_b64_tr_b16 v[230:231], v68 offset:25504
    s_waitcnt lgkmcnt(8)
    s_waitcnt vmcnt(2)
    v_mfma_f32_16x16x32_bf16 v[128:131], v[236:239], v[176:179], v[128:131]
    ds_read_b64_tr_b16 v[232:233], v69 offset:24960
    v_mfma_f32_16x16x32_bf16 v[132:135], v[236:239], v[180:183], v[132:135]
    ds_read_b64_tr_b16 v[234:235], v69 offset:25472
    v_mfma_f32_16x16x32_bf16 v[136:139], v[240:243], v[176:179], v[136:139]
    ds_read_b64_tr_b16 v[236:237], v69 offset:24992
    v_mfma_f32_16x16x32_bf16 v[140:143], v[240:243], v[180:183], v[140:143]
    ds_read_b64_tr_b16 v[238:239], v69 offset:25504
    s_waitcnt lgkmcnt(8)
    v_mfma_f32_16x16x32_bf16 v[112:115], v[244:247], v[176:179], v[112:115]
    ds_read_b64_tr_b16 v[240:241], v68 offset:41600
    v_mfma_f32_16x16x32_bf16 v[116:119], v[244:247], v[180:183], v[116:119]
    ds_read_b64_tr_b16 v[242:243], v68 offset:42112
    v_mfma_f32_16x16x32_bf16 v[120:123], v[248:251], v[176:179], v[120:123]
    ds_read_b64_tr_b16 v[244:245], v68 offset:41632
    v_mfma_f32_16x16x32_bf16 v[124:127], v[248:251], v[180:183], v[124:127]
    ds_read_b64_tr_b16 v[246:247], v68 offset:42144
    s_waitcnt lgkmcnt(8)
    v_mfma_f32_16x16x32_bf16 v[80:83], v[224:227], v[176:179], v[80:83]
    ds_read_b64_tr_b16 v[248:249], v69 offset:41600
    v_mfma_f32_16x16x32_bf16 v[84:87], v[224:227], v[180:183], v[84:87]
    ds_read_b64_tr_b16 v[250:251], v69 offset:42112
    v_mfma_f32_16x16x32_bf16 v[88:91], v[228:231], v[176:179], v[88:91]
    ds_read_b64_tr_b16 v[224:225], v69 offset:41632
    v_mfma_f32_16x16x32_bf16 v[92:95], v[228:231], v[180:183], v[92:95]
    ds_read_b64_tr_b16 v[226:227], v69 offset:42144
    s_waitcnt lgkmcnt(8)
    v_mfma_f32_16x16x32_bf16 v[96:99], v[232:235], v[176:179], v[96:99]
    ds_read_b64_tr_b16 v[228:229], v69 offset:37440
    v_mfma_f32_16x16x32_bf16 v[100:103], v[232:235], v[180:183], v[100:103]
    ds_read_b64_tr_b16 v[230:231], v69 offset:37952
    v_mfma_f32_16x16x32_bf16 v[104:107], v[236:239], v[176:179], v[104:107]
    ds_read_b64_tr_b16 v[232:233], v69 offset:37472
    v_mfma_f32_16x16x32_bf16 v[108:111], v[236:239], v[180:183], v[108:111]
    ds_read_b64_tr_b16 v[234:235], v69 offset:37984
    s_waitcnt lgkmcnt(8)
    v_mfma_f32_16x16x32_bf16 v[144:147], v[240:243], v[176:179], v[144:147]
    ds_read_b64_tr_b16 v[236:237], v68 offset:37440
    v_mfma_f32_16x16x32_bf16 v[148:151], v[240:243], v[180:183], v[148:151]
    ds_read_b64_tr_b16 v[238:239], v68 offset:37952
    v_mfma_f32_16x16x32_bf16 v[152:155], v[244:247], v[176:179], v[152:155]
    ds_read_b64_tr_b16 v[240:241], v68 offset:37472
    v_mfma_f32_16x16x32_bf16 v[156:159], v[244:247], v[180:183], v[156:159]
    ds_read_b64_tr_b16 v[242:243], v68 offset:37984
    s_waitcnt lgkmcnt(8)
    v_mfma_f32_16x16x32_bf16 v[160:163], v[248:251], v[176:179], v[160:163]
    ds_read_b64_tr_b16 v[244:245], v68 offset:29120
    v_mfma_f32_16x16x32_bf16 v[164:167], v[248:251], v[180:183], v[164:167]
    ds_read_b64_tr_b16 v[246:247], v68 offset:29632
    v_mfma_f32_16x16x32_bf16 v[168:171], v[224:227], v[176:179], v[168:171]
    ds_read_b64_tr_b16 v[248:249], v68 offset:29152
    v_mfma_f32_16x16x32_bf16 v[172:175], v[224:227], v[180:183], v[172:175]
    ds_read_b64_tr_b16 v[250:251], v68 offset:29664
    s_waitcnt lgkmcnt(8)
    s_waitcnt vmcnt(0)
    v_mfma_f32_16x16x32_bf16 v[128:131], v[228:231], v[184:187], v[128:131]
    ds_read_b64_tr_b16 v[224:225], v69 offset:29120
    v_mfma_f32_16x16x32_bf16 v[132:135], v[228:231], v[188:191], v[132:135]
    ds_read_b64_tr_b16 v[226:227], v69 offset:29632
    v_mfma_f32_16x16x32_bf16 v[136:139], v[232:235], v[184:187], v[136:139]
    ds_read_b64_tr_b16 v[228:229], v69 offset:29152
    v_mfma_f32_16x16x32_bf16 v[140:143], v[232:235], v[188:191], v[140:143]
    ds_read_b64_tr_b16 v[230:231], v69 offset:29664
    s_waitcnt lgkmcnt(8)
    v_mfma_f32_16x16x32_bf16 v[112:115], v[236:239], v[184:187], v[112:115]
    ds_read_b64_tr_b16 v[232:233], v68 offset:45760
    v_mfma_f32_16x16x32_bf16 v[116:119], v[236:239], v[188:191], v[116:119]
    ds_read_b64_tr_b16 v[234:235], v68 offset:46272
    v_mfma_f32_16x16x32_bf16 v[120:123], v[240:243], v[184:187], v[120:123]
    ds_read_b64_tr_b16 v[236:237], v68 offset:45792
    v_mfma_f32_16x16x32_bf16 v[124:127], v[240:243], v[188:191], v[124:127]
    ds_read_b64_tr_b16 v[238:239], v68 offset:46304
    s_waitcnt lgkmcnt(8)
    v_mfma_f32_16x16x32_bf16 v[80:83], v[244:247], v[184:187], v[80:83]
    ds_read_b64_tr_b16 v[240:241], v69 offset:45760
    v_mfma_f32_16x16x32_bf16 v[84:87], v[244:247], v[188:191], v[84:87]
    ds_read_b64_tr_b16 v[242:243], v69 offset:46272
    v_mfma_f32_16x16x32_bf16 v[88:91], v[248:251], v[184:187], v[88:91]
    ds_read_b64_tr_b16 v[244:245], v69 offset:45792
    v_mfma_f32_16x16x32_bf16 v[92:95], v[248:251], v[188:191], v[92:95]
    ds_read_b64_tr_b16 v[246:247], v69 offset:46304
    s_waitcnt lgkmcnt(8)
    v_mfma_f32_16x16x32_bf16 v[96:99], v[224:227], v[184:187], v[96:99]
    v_mfma_f32_16x16x32_bf16 v[100:103], v[224:227], v[188:191], v[100:103]
    v_mfma_f32_16x16x32_bf16 v[104:107], v[228:231], v[184:187], v[104:107]
    v_mfma_f32_16x16x32_bf16 v[108:111], v[228:231], v[188:191], v[108:111]
    s_waitcnt lgkmcnt(4)
    v_mfma_f32_16x16x32_bf16 v[144:147], v[232:235], v[184:187], v[144:147]
    v_mfma_f32_16x16x32_bf16 v[148:151], v[232:235], v[188:191], v[148:151]
    v_mfma_f32_16x16x32_bf16 v[152:155], v[236:239], v[184:187], v[152:155]
    v_mfma_f32_16x16x32_bf16 v[156:159], v[236:239], v[188:191], v[156:159]
    s_waitcnt lgkmcnt(0)
    v_mfma_f32_16x16x32_bf16 v[160:163], v[240:243], v[184:187], v[160:163]
    v_mfma_f32_16x16x32_bf16 v[164:167], v[240:243], v[188:191], v[164:167]
    v_mfma_f32_16x16x32_bf16 v[168:171], v[244:247], v[184:187], v[168:171]
    v_mfma_f32_16x16x32_bf16 v[172:175], v[244:247], v[188:191], v[172:175]
    v_cvt_pk_bf16_f32 v52, v128, v129
    v_cvt_pk_bf16_f32 v53, v130, v131
    v_cvt_pk_bf16_f32 v54, v132, v133
    v_cvt_pk_bf16_f32 v55, v134, v135
    v_cvt_pk_bf16_f32 v56, v136, v137
    v_cvt_pk_bf16_f32 v57, v138, v139
    v_cvt_pk_bf16_f32 v58, v140, v141
    v_cvt_pk_bf16_f32 v59, v142, v143
    ds_write_b64 v77, v[52:53]
    ds_write_b64 v77, v[54:55] offset:256
    ds_write_b64 v77, v[56:57] offset:1024
    ds_write_b64 v77, v[58:59] offset:1280
    v_cvt_pk_bf16_f32 v36, v112, v113
    v_cvt_pk_bf16_f32 v37, v114, v115
    v_cvt_pk_bf16_f32 v38, v116, v117
    v_cvt_pk_bf16_f32 v39, v118, v119
    v_cvt_pk_bf16_f32 v40, v120, v121
    v_cvt_pk_bf16_f32 v41, v122, v123
    v_cvt_pk_bf16_f32 v42, v124, v125
    v_cvt_pk_bf16_f32 v43, v126, v127
    v_permlane16_swap_b32 v36, v38
    v_permlane16_swap_b32 v37, v39
    v_permlane16_swap_b32 v40, v42
    v_permlane16_swap_b32 v41, v43
    s_waitcnt lgkmcnt(0)
    s_barrier
    s_setprio 0
    v_mfma_f32_32x32x16_bf16 v[112:127], v[28:31], v[36:39], 0
    v_mfma_f32_32x32x16_bf16 v[112:127], v[32:35], v[40:43], v[112:127]
    v_cvt_pk_bf16_f32 v52, v144, v145
    v_cvt_pk_bf16_f32 v53, v146, v147
    v_cvt_pk_bf16_f32 v54, v148, v149
    v_cvt_pk_bf16_f32 v55, v150, v151
    v_cvt_pk_bf16_f32 v56, v152, v153
    v_cvt_pk_bf16_f32 v57, v154, v155
    v_cvt_pk_bf16_f32 v58, v156, v157
    v_cvt_pk_bf16_f32 v59, v158, v159
    ds_write_b64 v78, v[52:53]
    ds_write_b64 v78, v[54:55] offset:512
    ds_write_b64 v78, v[56:57] offset:4096
    ds_write_b64 v78, v[58:59] offset:4608
    v_cvt_pk_bf16_f32 v44, v160, v161
    v_cvt_pk_bf16_f32 v45, v162, v163
    v_cvt_pk_bf16_f32 v46, v164, v165
    v_cvt_pk_bf16_f32 v47, v166, v167
    v_cvt_pk_bf16_f32 v48, v168, v169
    v_cvt_pk_bf16_f32 v49, v170, v171
    v_cvt_pk_bf16_f32 v50, v172, v173
    v_cvt_pk_bf16_f32 v51, v174, v175
    ds_write_b64 v78, v[44:45] offset:8192
    ds_write_b64 v78, v[46:47] offset:8704
    ds_write_b64 v78, v[48:49] offset:12288
    ds_write_b64 v78, v[50:51] offset:12800
    v_cvt_pk_bf16_f32 v36, v96, v97
    v_cvt_pk_bf16_f32 v37, v98, v99
    v_cvt_pk_bf16_f32 v38, v100, v101
    v_cvt_pk_bf16_f32 v39, v102, v103
    v_cvt_pk_bf16_f32 v40, v104, v105
    v_cvt_pk_bf16_f32 v41, v106, v107
    v_cvt_pk_bf16_f32 v42, v108, v109
    v_cvt_pk_bf16_f32 v43, v110, v111
    ds_write_b64 v77, v[36:37] offset:2048
    ds_write_b64 v77, v[38:39] offset:2304
    ds_write_b64 v77, v[40:41] offset:3072
    ds_write_b64 v77, v[42:43] offset:3328
    v_cvt_pk_bf16_f32 v44, v80, v81
    v_cvt_pk_bf16_f32 v45, v82, v83
    v_cvt_pk_bf16_f32 v46, v84, v85
    v_cvt_pk_bf16_f32 v47, v86, v87
    v_cvt_pk_bf16_f32 v48, v88, v89
    v_cvt_pk_bf16_f32 v49, v90, v91
    v_cvt_pk_bf16_f32 v50, v92, v93
    v_cvt_pk_bf16_f32 v51, v94, v95
    v_permlane16_swap_b32 v44, v46
    v_permlane16_swap_b32 v45, v47
    v_permlane16_swap_b32 v48, v50
    v_permlane16_swap_b32 v49, v51
    s_branch L_JOIN
L_HELP:
    s_add_u32 s96, s85, 5
    s_and_b32 s97, s96, 15
    s_lshl3_add_u32 s98, s97, s3
    s_sub_u32 s99, s98, 4
    s_mul_i32 s96, s99, 49152
    s_lshl_b32 s97, s11, 7
    s_add_u32 s82, s96, s97
    s_sub_u32 s96, s3, 4
    s_lshr_b32 s97, s96, 1
    s_mul_i32 s98, s97, 2080
    s_sub_u32 s99, s3, 4
    s_and_b32 s96, s99, 1
    s_mul_i32 s97, s96, 1056
    s_add_u32 s99, s98, s97
    s_add_u32 s20, s99, 124800
    s_mov_b32 m0, s20
    s_nop 0
    buffer_load_dwordx4 v62, s[40:43], s82 offen lds
    s_add_u32 s82, s82, 2048
    s_add_u32 m0, s20, 8320
    s_nop 0
    buffer_load_dwordx4 v62, s[40:43], s82 offen lds
    s_add_u32 s82, s82, 2048
    s_add_u32 m0, s20, 16640
    s_nop 0
    buffer_load_dwordx4 v62, s[40:43], s82 offen lds
    s_add_u32 s96, s85, 5
    s_and_b32 s97, s96, 15
    s_lshl3_add_u32 s98, s97, s3
    s_mul_i32 s99, s98, 49152
    s_lshl_b32 s96, s11, 7
    s_add_u32 s82, s99, s96
    s_lshr_b32 s96, s3, 1
    s_mul_i32 s97, s96, 2080
    s_and_b32 s98, s3, 1
    s_mul_i32 s99, s98, 1056
    s_add_u32 s96, s97, s99
    s_add_u32 s20, s96, 124800
    s_mov_b32 m0, s20
    s_nop 0
    buffer_load_dwordx4 v62, s[40:43], s82 offen lds
    s_add_u32 s82, s82, 2048
    s_add_u32 m0, s20, 8320
    s_nop 0
    buffer_load_dwordx4 v62, s[40:43], s82 offen lds
    s_add_u32 s82, s82, 2048
    s_add_u32 m0, s20, 16640
    s_nop 0
    buffer_load_dwordx4 v62, s[40:43], s82 offen lds
    s_and_b32 s96, s9, 3
    s_lshl2_add_u32 s97, s96, s3
    s_sub_u32 s98, s97, 4
    s_lshl_b32 s13, s98, 7
    v_lshrrev_b32 v61, 3, v1
    v_lshl_add_u32 v61, v61, 4, s13
    v_lshrrev_b32 v60, 3, v1
    v_mul_u32_u24 v60, 98304, v60
    v_and_b32 v9, 7, v1
    v_lshl_add_u32 v60, v9, 4, v60
    s_mul_i32 s96, s13, 6144
    s_bfe_u32 s97, s9, 131074
    s_lshl_b32 s98, s8, 1
    s_lshl4_add_u32 s99, s97, s98
    s_lshr_b32 s97, s9, 4
    s_add_u32 s98, s99, s97
    s_lshl_b32 s99, s98, 7
    s_add_u32 s97, s96, s99
    s_add_u32 s17, s97, 4096
    global_load_dwordx4 v[120:123], v61, s[86:87]
    s_waitcnt vmcnt(13)
    s_barrier
    buffer_load_dwordx4 v[80:83], v60, s[48:51], s17 offen nt
    s_add_u32 s17, s17, 12288
    buffer_load_dwordx4 v[84:87], v60, s[48:51], s17 offen nt
    s_add_u32 s17, s17, 12288
    s_waitcnt lgkmcnt(0)
    s_load_dword s24, s[32:33], s92 offset:512 glc
    s_load_dword s25, s[32:33], s92 offset:256 glc
    s_load_dword s26, s[32:33], s92 offset:1024 glc
    s_load_dword s27, s[32:33], s92 offset:768 glc
    s_waitcnt vmcnt(12)
    s_barrier
    s_add_u32 s96, s85, 6
    s_and_b32 s97, s96, 15
    s_lshl3_add_u32 s98, s97, s3
    s_sub_u32 s99, s98, 4
    s_mul_i32 s96, s99, 49152
    s_lshl_b32 s97, s11, 7
    s_add_u32 s82, s96, s97
    s_sub_u32 s96, s3, 4
    s_lshr_b32 s97, s96, 1
    s_mul_i32 s98, s97, 2080
    s_sub_u32 s99, s3, 4
    s_and_b32 s96, s99, 1
    s_mul_i32 s97, s96, 1056
    s_add_u32 s20, s98, s97
    s_mov_b32 m0, s20
    s_nop 0
    buffer_load_dwordx4 v62, s[40:43], s82 offen lds
    s_add_u32 s82, s82, 2048
    s_add_u32 m0, s20, 8320
    s_nop 0
    buffer_load_dwordx4 v62, s[40:43], s82 offen lds
    s_add_u32 s82, s82, 2048
    s_add_u32 m0, s20, 16640
    s_nop 0
    buffer_load_dwordx4 v62, s[40:43], s82 offen lds
    s_add_u32 s96, s85, 6
    s_and_b32 s97, s96, 15
    s_lshl3_add_u32 s98, s97, s3
    s_mul_i32 s99, s98, 49152
    s_lshl_b32 s96, s11, 7
    s_add_u32 s82, s99, s96
    s_lshr_b32 s96, s3, 1
    s_mul_i32 s97, s96, 2080
    s_and_b32 s98, s3, 1
    s_mul_i32 s99, s98, 1056
    s_add_u32 s20, s97, s99
    s_mov_b32 m0, s20
    s_nop 0
    buffer_load_dwordx4 v62, s[40:43], s82 offen lds
    s_add_u32 s82, s82, 2048
    s_add_u32 m0, s20, 8320
    s_nop 0
    buffer_load_dwordx4 v62, s[40:43], s82 offen lds
    s_add_u32 s82, s82, 2048
    s_add_u32 m0, s20, 16640
    s_nop 0
    buffer_load_dwordx4 v62, s[40:43], s82 offen lds
    s_waitcnt vmcnt(8)
    v_lshlrev_b32 v112, 16, v120
    v_mul_f32 v4, s7, v112
    v_exp_f32 v4, -v4
    s_nop 0
    v_add_f32 v4, 1.0, v4
    v_rcp_f32 v4, v4
    s_nop 0
    v_mul_f32 v112, v112, v4
    v_cvt_pk_bf16_f32 v112, 0, v112
    v_and_b32 v113, s6, v120
    v_mul_f32 v5, s7, v113
    v_exp_f32 v5, -v5
    s_nop 0
    v_add_f32 v5, 1.0, v5
    v_rcp_f32 v5, v5
    s_nop 0
    v_mul_f32 v113, v113, v5
    v_cvt_pk_bf16_f32 v113, 0, v113
    v_lshlrev_b32 v114, 16, v121
    v_mul_f32 v4, s7, v114
    v_exp_f32 v4, -v4
    s_nop 0
    v_add_f32 v4, 1.0, v4
    v_rcp_f32 v4, v4
    s_nop 0
    v_mul_f32 v114, v114, v4
    v_cvt_pk_bf16_f32 v114, 0, v114
    v_and_b32 v115, s6, v121
    v_mul_f32 v5, s7, v115
    v_exp_f32 v5, -v5
    s_nop 0
    v_add_f32 v5, 1.0, v5
    v_rcp_f32 v5, v5
    s_nop 0
    v_mul_f32 v115, v115, v5
    v_cvt_pk_bf16_f32 v115, 0, v115
    s_barrier
    s_add_u32 s96, s85, 7
    s_and_b32 s97, s96, 15
    s_lshl3_add_u32 s98, s97, s3
    s_sub_u32 s99, s98, 4
    s_mul_i32 s96, s99, 49152
    s_lshl_b32 s97, s11, 7
    s_add_u32 s82, s96, s97
    s_sub_u32 s96, s3, 4
    s_lshr_b32 s97, s96, 1
    s_mul_i32 s98, s97, 2080
    s_sub_u32 s99, s3, 4
    s_and_b32 s96, s99, 1
    s_mul_i32 s97, s96, 1056
    s_add_u32 s99, s98, s97
    s_add_u32 s20, s99, 24960
    s_mov_b32 m0, s20
    s_nop 0
    buffer_load_dwordx4 v62, s[40:43], s82 offen lds
    s_add_u32 s82, s82, 2048
    s_add_u32 m0, s20, 8320
    s_nop 0
    buffer_load_dwordx4 v62, s[40:43], s82 offen lds
    s_add_u32 s82, s82, 2048
    s_add_u32 m0, s20, 16640
    s_nop 0
    buffer_load_dwordx4 v62, s[40:43], s82 offen lds
    s_add_u32 s96, s85, 7
    s_and_b32 s97, s96, 15
    s_lshl3_add_u32 s98, s97, s3
    s_mul_i32 s99, s98, 49152
    s_lshl_b32 s96, s11, 7
    s_add_u32 s82, s99, s96
    s_lshr_b32 s96, s3, 1
    s_mul_i32 s97, s96, 2080
    s_and_b32 s98, s3, 1
    s_mul_i32 s99, s98, 1056
    s_add_u32 s96, s97, s99
    s_add_u32 s20, s96, 24960
    s_mov_b32 m0, s20
    s_nop 0
    buffer_load_dwordx4 v62, s[40:43], s82 offen lds
    s_add_u32 s82, s82, 2048
    s_add_u32 m0, s20, 8320
    s_nop 0
    buffer_load_dwordx4 v62, s[40:43], s82 offen lds
    s_add_u32 s82, s82, 2048
    s_add_u32 m0, s20, 16640
    s_nop 0
    buffer_load_dwordx4 v62, s[40:43], s82 offen lds
    buffer_load_dwordx4 v[88:91], v60, s[48:51], s17 offen nt
    s_add_u32 s17, s17, 12288
    buffer_load_dwordx4 v[92:95], v60, s[48:51], s17 offen nt
    s_add_u32 s17, s17, 12288
    v_lshlrev_b32 v116, 16, v122
    v_mul_f32 v4, s7, v116
    v_exp_f32 v4, -v4
    s_nop 0
    v_add_f32 v4, 1.0, v4
    v_rcp_f32 v4, v4
    s_nop 0
    v_mul_f32 v116, v116, v4
    v_cvt_pk_bf16_f32 v116, 0, v116
    v_and_b32 v117, s6, v122
    v_mul_f32 v5, s7, v117
    v_exp_f32 v5, -v5
    s_nop 0
    v_add_f32 v5, 1.0, v5
    v_rcp_f32 v5, v5
    s_nop 0
    v_mul_f32 v117, v117, v5
    v_cvt_pk_bf16_f32 v117, 0, v117
    v_lshlrev_b32 v118, 16, v123
    v_mul_f32 v4, s7, v118
    v_exp_f32 v4, -v4
    s_nop 0
    v_add_f32 v4, 1.0, v4
    v_rcp_f32 v4, v4
    s_nop 0
    v_mul_f32 v118, v118, v4
    v_cvt_pk_bf16_f32 v118, 0, v118
    v_and_b32 v119, s6, v123
    v_mul_f32 v5, s7, v119
    v_exp_f32 v5, -v5
    s_nop 0
    v_add_f32 v5, 1.0, v5
    v_rcp_f32 v5, v5
    s_nop 0
    v_mul_f32 v119, v119, v5
    v_cvt_pk_bf16_f32 v119, 0, v119
    s_barrier
    s_add_u32 s96, s85, 8
    s_and_b32 s97, s96, 15
    s_lshl3_add_u32 s98, s97, s3
    s_sub_u32 s99, s98, 4
    s_mul_i32 s96, s99, 49152
    s_lshl_b32 s97, s11, 7
    s_add_u32 s82, s96, s97
    s_sub_u32 s96, s3, 4
    s_lshr_b32 s97, s96, 1
    s_mul_i32 s98, s97, 2080
    s_sub_u32 s99, s3, 4
    s_and_b32 s96, s99, 1
    s_mul_i32 s97, s96, 1056
    s_add_u32 s99, s98, s97
    s_add_u32 s20, s99, 49920
    s_mov_b32 m0, s20
    s_nop 0
    buffer_load_dwordx4 v62, s[40:43], s82 offen lds
    s_add_u32 s82, s82, 2048
    s_add_u32 m0, s20, 8320
    s_nop 0
    buffer_load_dwordx4 v62, s[40:43], s82 offen lds
    s_add_u32 s82, s82, 2048
    s_add_u32 m0, s20, 16640
    s_nop 0
    buffer_load_dwordx4 v62, s[40:43], s82 offen lds
    s_add_u32 s96, s85, 8
    s_and_b32 s97, s96, 15
    s_lshl3_add_u32 s98, s97, s3
    s_mul_i32 s99, s98, 49152
    s_lshl_b32 s96, s11, 7
    s_add_u32 s82, s99, s96
    s_lshr_b32 s96, s3, 1
    s_mul_i32 s97, s96, 2080
    s_and_b32 s98, s3, 1
    s_mul_i32 s99, s98, 1056
    s_add_u32 s96, s97, s99
    s_add_u32 s20, s96, 49920
    s_mov_b32 m0, s20
    s_nop 0
    buffer_load_dwordx4 v62, s[40:43], s82 offen lds
    s_add_u32 s82, s82, 2048
    s_add_u32 m0, s20, 8320
    s_nop 0
    buffer_load_dwordx4 v62, s[40:43], s82 offen lds
    s_add_u32 s82, s82, 2048
    s_add_u32 m0, s20, 16640
    s_nop 0
    buffer_load_dwordx4 v62, s[40:43], s82 offen lds
    s_waitcnt lgkmcnt(0)
    s_load_dword s24, s[32:33], s92 offset:1536 glc
    s_load_dword s25, s[32:33], s92 offset:1280 glc
    s_load_dword s26, s[32:33], s92 offset:2048 glc
    s_load_dword s27, s[32:33], s92 offset:1792 glc
    s_waitcnt vmcnt(21)
    v_lshlrev_b32 v4, 16, v80
    v_and_b32 v5, s6, v80
    v_mul_f32 v20, v4, v112
    v_mul_f32 v21, v5, v112
    v_lshlrev_b32 v6, 16, v81
    v_and_b32 v7, s6, v81
    v_mul_f32 v22, v6, v112
    v_mul_f32 v23, v7, v112
    v_lshlrev_b32 v4, 16, v82
    v_and_b32 v5, s6, v82
    v_mul_f32 v24, v4, v112
    v_mul_f32 v25, v5, v112
    v_lshlrev_b32 v6, 16, v83
    v_and_b32 v7, s6, v83
    v_mul_f32 v26, v6, v112
    v_mul_f32 v27, v7, v112
    s_barrier
    s_add_u32 s96, s85, 9
    s_and_b32 s97, s96, 15
    s_lshl3_add_u32 s98, s97, s3
    s_sub_u32 s99, s98, 4
    s_mul_i32 s96, s99, 49152
    s_lshl_b32 s97, s11, 7
    s_add_u32 s82, s96, s97
    s_sub_u32 s96, s3, 4
    s_lshr_b32 s97, s96, 1
    s_mul_i32 s98, s97, 2080
    s_sub_u32 s99, s3, 4
    s_and_b32 s96, s99, 1
    s_mul_i32 s97, s96, 1056
    s_add_u32 s99, s98, s97
    s_add_u32 s20, s99, 74880
    s_mov_b32 m0, s20
    s_nop 0
    buffer_load_dwordx4 v62, s[40:43], s82 offen lds
    s_add_u32 s82, s82, 2048
    s_add_u32 m0, s20, 8320
    s_nop 0
    buffer_load_dwordx4 v62, s[40:43], s82 offen lds
    s_add_u32 s82, s82, 2048
    s_add_u32 m0, s20, 16640
    s_nop 0
    buffer_load_dwordx4 v62, s[40:43], s82 offen lds
    s_add_u32 s96, s85, 9
    s_and_b32 s97, s96, 15
    s_lshl3_add_u32 s98, s97, s3
    s_mul_i32 s99, s98, 49152
    s_lshl_b32 s96, s11, 7
    s_add_u32 s82, s99, s96
    s_lshr_b32 s96, s3, 1
    s_mul_i32 s97, s96, 2080
    s_and_b32 s98, s3, 1
    s_mul_i32 s99, s98, 1056
    s_add_u32 s96, s97, s99
    s_add_u32 s20, s96, 74880
    s_mov_b32 m0, s20
    s_nop 0
    buffer_load_dwordx4 v62, s[40:43], s82 offen lds
    s_add_u32 s82, s82, 2048
    s_add_u32 m0, s20, 8320
    s_nop 0
    buffer_load_dwordx4 v62, s[40:43], s82 offen lds
    s_add_u32 s82, s82, 2048
    s_add_u32 m0, s20, 16640
    s_nop 0
    buffer_load_dwordx4 v62, s[40:43], s82 offen lds
    buffer_load_dwordx4 v[96:99], v60, s[48:51], s17 offen nt
    s_add_u32 s17, s17, 12288
    buffer_load_dwordx4 v[100:103], v60, s[48:51], s17 offen nt
    s_add_u32 s17, s17, 12288
    s_waitcnt vmcnt(28)
    v_lshlrev_b32 v4, 16, v84
    v_and_b32 v5, s6, v84
    v_fmac_f32 v20, v4, v113
    v_fmac_f32 v21, v5, v113
    v_lshlrev_b32 v6, 16, v85
    v_and_b32 v7, s6, v85
    v_fmac_f32 v22, v6, v113
    v_fmac_f32 v23, v7, v113
    v_lshlrev_b32 v4, 16, v86
    v_and_b32 v5, s6, v86
    v_fmac_f32 v24, v4, v113
    v_fmac_f32 v25, v5, v113
    v_lshlrev_b32 v6, 16, v87
    v_and_b32 v7, s6, v87
    v_fmac_f32 v26, v6, v113
    v_fmac_f32 v27, v7, v113
    s_waitcnt vmcnt(22)
    s_barrier
    s_add_u32 s96, s85, 10
    s_and_b32 s97, s96, 15
    s_lshl3_add_u32 s98, s97, s3
    s_sub_u32 s99, s98, 4
    s_mul_i32 s96, s99, 49152
    s_lshl_b32 s97, s11, 7
    s_add_u32 s82, s96, s97
    s_sub_u32 s96, s3, 4
    s_lshr_b32 s97, s96, 1
    s_mul_i32 s98, s97, 2080
    s_sub_u32 s99, s3, 4
    s_and_b32 s96, s99, 1
    s_mul_i32 s97, s96, 1056
    s_add_u32 s99, s98, s97
    s_add_u32 s20, s99, 99840
    s_mov_b32 m0, s20
    s_nop 0
    buffer_load_dwordx4 v62, s[40:43], s82 offen lds
    s_add_u32 s82, s82, 2048
    s_add_u32 m0, s20, 8320
    s_nop 0
    buffer_load_dwordx4 v62, s[40:43], s82 offen lds
    s_add_u32 s82, s82, 2048
    s_add_u32 m0, s20, 16640
    s_nop 0
    buffer_load_dwordx4 v62, s[40:43], s82 offen lds
    s_add_u32 s96, s85, 10
    s_and_b32 s97, s96, 15
    s_lshl3_add_u32 s98, s97, s3
    s_mul_i32 s99, s98, 49152
    s_lshl_b32 s96, s11, 7
    s_add_u32 s82, s99, s96
    s_lshr_b32 s96, s3, 1
    s_mul_i32 s97, s96, 2080
    s_and_b32 s98, s3, 1
    s_mul_i32 s99, s98, 1056
    s_add_u32 s96, s97, s99
    s_add_u32 s20, s96, 99840
    s_mov_b32 m0, s20
    s_nop 0
    buffer_load_dwordx4 v62, s[40:43], s82 offen lds
    s_add_u32 s82, s82, 2048
    s_add_u32 m0, s20, 8320
    s_nop 0
    buffer_load_dwordx4 v62, s[40:43], s82 offen lds
    s_add_u32 s82, s82, 2048
    s_add_u32 m0, s20, 16640
    s_nop 0
    buffer_load_dwordx4 v62, s[40:43], s82 offen lds
    s_waitcnt vmcnt(21)
    v_lshlrev_b32 v4, 16, v88
    v_and_b32 v5, s6, v88
    v_fmac_f32 v20, v4, v114
    v_fmac_f32 v21, v5, v114
    v_lshlrev_b32 v6, 16, v89
    v_and_b32 v7, s6, v89
    v_fmac_f32 v22, v6, v114
    v_fmac_f32 v23, v7, v114
    v_lshlrev_b32 v4, 16, v90
    v_and_b32 v5, s6, v90
    v_fmac_f32 v24, v4, v114
    v_fmac_f32 v25, v5, v114
    v_lshlrev_b32 v6, 16, v91
    v_and_b32 v7, s6, v91
    v_fmac_f32 v26, v6, v114
    v_fmac_f32 v27, v7, v114
    s_barrier
    s_add_u32 s96, s85, 11
    s_and_b32 s97, s96, 15
    s_lshl3_add_u32 s98, s97, s3
    s_sub_u32 s99, s98, 4
    s_mul_i32 s96, s99, 49152
    s_lshl_b32 s97, s11, 7
    s_add_u32 s82, s96, s97
    s_sub_u32 s96, s3, 4
    s_lshr_b32 s97, s96, 1
    s_mul_i32 s98, s97, 2080
    s_sub_u32 s99, s3, 4
    s_and_b32 s96, s99, 1
    s_mul_i32 s97, s96, 1056
    s_add_u32 s99, s98, s97
    s_add_u32 s20, s99, 124800
    s_mov_b32 m0, s20
    s_nop 0
    buffer_load_dwordx4 v62, s[40:43], s82 offen lds
    s_add_u32 s82, s82, 2048
    s_add_u32 m0, s20, 8320
    s_nop 0
    buffer_load_dwordx4 v62, s[40:43], s82 offen lds
    s_add_u32 s82, s82, 2048
    s_add_u32 m0, s20, 16640
    s_nop 0
    buffer_load_dwordx4 v62, s[40:43], s82 offen lds
    s_add_u32 s96, s85, 11
    s_and_b32 s97, s96, 15
    s_lshl3_add_u32 s98, s97, s3
    s_mul_i32 s99, s98, 49152
    s_lshl_b32 s96, s11, 7
    s_add_u32 s82, s99, s96
    s_lshr_b32 s96, s3, 1
    s_mul_i32 s97, s96, 2080
    s_and_b32 s98, s3, 1
    s_mul_i32 s99, s98, 1056
    s_add_u32 s96, s97, s99
    s_add_u32 s20, s96, 124800
    s_mov_b32 m0, s20
    s_nop 0
    buffer_load_dwordx4 v62, s[40:43], s82 offen lds
    s_add_u32 s82, s82, 2048
    s_add_u32 m0, s20, 8320
    s_nop 0
    buffer_load_dwordx4 v62, s[40:43], s82 offen lds
    s_add_u32 s82, s82, 2048
    s_add_u32 m0, s20, 16640
    s_nop 0
    buffer_load_dwordx4 v62, s[40:43], s82 offen lds
    buffer_load_dwordx4 v[104:107], v60, s[48:51], s17 offen nt
    s_add_u32 s17, s17, 12288
    buffer_load_dwordx4 v[108:111], v60, s[48:51], s17 offen nt
    s_lshl2_add_u32 s96, s74, s75
    s_lshl_b32 s97, s96, 11
    s_and_b32 s98, s3, 1
    s_lshl_b32 s99, s98, 10
    s_add_u32 s96, s97, s99
    s_add_u32 s13, s96, 20971520
    s_lshl4_add_u32 s96, s21, s12
    s_lshl_b32 s97, s96, 11
    s_and_b32 s98, s3, 1
    s_lshl_b32 s99, s98, 10
    s_add_u32 s96, s97, s99
    s_add_u32 s14, s96, 12582912
    buffer_load_dwordx4 v[124:127], v2, s[32:35], s13 offen
    s_waitcnt vmcnt(29)
    v_lshlrev_b32 v4, 16, v92
    v_and_b32 v5, s6, v92
    v_fmac_f32 v20, v4, v115
    v_fmac_f32 v21, v5, v115
    v_lshlrev_b32 v6, 16, v93
    v_and_b32 v7, s6, v93
    v_fmac_f32 v22, v6, v115
    v_fmac_f32 v23, v7, v115
    v_lshlrev_b32 v4, 16, v94
    v_and_b32 v5, s6, v94
    v_fmac_f32 v24, v4, v115
    v_fmac_f32 v25, v5, v115
    v_lshlrev_b32 v6, 16, v95
    v_and_b32 v7, s6, v95
    v_fmac_f32 v26, v6, v115
    v_fmac_f32 v27, v7, v115
    s_waitcnt lgkmcnt(0)
    s_load_dword s24, s[32:33], s92 offset:2560 glc
    s_load_dword s25, s[32:33], s92 offset:2304 glc
    s_load_dword s26, s[32:33], s92 offset:3072 glc
    s_load_dword s27, s[32:33], s92 offset:2816 glc
    s_load_dword s28, s[32:33], s92 offset:3584 glc
    s_load_dword s29, s[32:33], s92 offset:3328 glc
    s_waitcnt vmcnt(23)
    s_barrier
    s_add_u32 s96, s85, 12
    s_and_b32 s97, s96, 15
    s_lshl3_add_u32 s98, s97, s3
    s_sub_u32 s99, s98, 4
    s_mul_i32 s96, s99, 49152
    s_lshl_b32 s97, s11, 7
    s_add_u32 s82, s96, s97
    s_sub_u32 s96, s3, 4
    s_lshr_b32 s97, s96, 1
    s_mul_i32 s98, s97, 2080
    s_sub_u32 s99, s3, 4
    s_and_b32 s96, s99, 1
    s_mul_i32 s97, s96, 1056
    s_add_u32 s20, s98, s97
    s_mov_b32 m0, s20
    s_nop 0
    buffer_load_dwordx4 v62, s[40:43], s82 offen lds
    s_add_u32 s82, s82, 2048
    s_add_u32 m0, s20, 8320
    s_nop 0
    buffer_load_dwordx4 v62, s[40:43], s82 offen lds
    s_add_u32 s82, s82, 2048
    s_add_u32 m0, s20, 16640
    s_nop 0
    buffer_load_dwordx4 v62, s[40:43], s82 offen lds
    s_add_u32 s96, s85, 12
    s_and_b32 s97, s96, 15
    s_lshl3_add_u32 s98, s97, s3
    s_mul_i32 s99, s98, 49152
    s_lshl_b32 s96, s11, 7
    s_add_u32 s82, s99, s96
    s_lshr_b32 s96, s3, 1
    s_mul_i32 s97, s96, 2080
    s_and_b32 s98, s3, 1
    s_mul_i32 s99, s98, 1056
    s_add_u32 s20, s97, s99
    s_mov_b32 m0, s20
    s_nop 0
    buffer_load_dwordx4 v62, s[40:43], s82 offen lds
    s_add_u32 s82, s82, 2048
    s_add_u32 m0, s20, 8320
    s_nop 0
    buffer_load_dwordx4 v62, s[40:43], s82 offen lds
    s_add_u32 s82, s82, 2048
    s_add_u32 m0, s20, 16640
    s_nop 0
    buffer_load_dwordx4 v62, s[40:43], s82 offen lds
    s_waitcnt vmcnt(22)
    v_lshlrev_b32 v4, 16, v96
    v_and_b32 v5, s6, v96
    v_fmac_f32 v20, v4, v116
    v_fmac_f32 v21, v5, v116
    v_lshlrev_b32 v6, 16, v97
    v_and_b32 v7, s6, v97
    v_fmac_f32 v22, v6, v116
    v_fmac_f32 v23, v7, v116
    v_lshlrev_b32 v4, 16, v98
    v_and_b32 v5, s6, v98
    v_fmac_f32 v24, v4, v116
    v_fmac_f32 v25, v5, v116
    v_lshlrev_b32 v6, 16, v99
    v_and_b32 v7, s6, v99
    v_fmac_f32 v26, v6, v116
    v_fmac_f32 v27, v7, v116
    s_waitcnt vmcnt(21)
    v_lshlrev_b32 v4, 16, v100
    v_and_b32 v5, s6, v100
    v_fmac_f32 v20, v4, v117
    v_fmac_f32 v21, v5, v117
    v_lshlrev_b32 v6, 16, v101
    v_and_b32 v7, s6, v101
    v_fmac_f32 v22, v6, v117
    v_fmac_f32 v23, v7, v117
    v_lshlrev_b32 v4, 16, v102
    v_and_b32 v5, s6, v102
    v_fmac_f32 v24, v4, v117
    v_fmac_f32 v25, v5, v117
    v_lshlrev_b32 v6, 16, v103
    v_and_b32 v7, s6, v103
    v_fmac_f32 v26, v6, v117
    v_fmac_f32 v27, v7, v117
    s_barrier
    s_add_u32 s96, s85, 13
    s_and_b32 s97, s96, 15
    s_lshl3_add_u32 s98, s97, s3
    s_sub_u32 s99, s98, 4
    s_mul_i32 s96, s99, 49152
    s_lshl_b32 s97, s11, 7
    s_add_u32 s82, s96, s97
    s_sub_u32 s96, s3, 4
    s_lshr_b32 s97, s96, 1
    s_mul_i32 s98, s97, 2080
    s_sub_u32 s99, s3, 4
    s_and_b32 s96, s99, 1
    s_mul_i32 s97, s96, 1056
    s_add_u32 s99, s98, s97
    s_add_u32 s20, s99, 24960
    s_mov_b32 m0, s20
    s_nop 0
    buffer_load_dwordx4 v62, s[40:43], s82 offen lds
    s_add_u32 s82, s82, 2048
    s_add_u32 m0, s20, 8320
    s_nop 0
    buffer_load_dwordx4 v62, s[40:43], s82 offen lds
    s_add_u32 s82, s82, 2048
    s_add_u32 m0, s20, 16640
    s_nop 0
    buffer_load_dwordx4 v62, s[40:43], s82 offen lds
    s_add_u32 s96, s85, 13
    s_and_b32 s97, s96, 15
    s_lshl3_add_u32 s98, s97, s3
    s_mul_i32 s99, s98, 49152
    s_lshl_b32 s96, s11, 7
    s_add_u32 s82, s99, s96
    s_lshr_b32 s96, s3, 1
    s_mul_i32 s97, s96, 2080
    s_and_b32 s98, s3, 1
    s_mul_i32 s99, s98, 1056
    s_add_u32 s96, s97, s99
    s_add_u32 s20, s96, 24960
    s_mov_b32 m0, s20
    s_nop 0
    buffer_load_dwordx4 v62, s[40:43], s82 offen lds
    s_add_u32 s82, s82, 2048
    s_add_u32 m0, s20, 8320
    s_nop 0
    buffer_load_dwordx4 v62, s[40:43], s82 offen lds
    s_add_u32 s82, s82, 2048
    s_add_u32 m0, s20, 16640
    s_nop 0
    buffer_load_dwordx4 v62, s[40:43], s82 offen lds
    s_waitcnt vmcnt(14)
    v_lshlrev_b32 v4, 16, v104
    v_and_b32 v5, s6, v104
    v_fmac_f32 v20, v4, v118
    v_fmac_f32 v21, v5, v118
    v_lshlrev_b32 v6, 16, v105
    v_and_b32 v7, s6, v105
    v_fmac_f32 v22, v6, v118
    v_fmac_f32 v23, v7, v118
    v_lshlrev_b32 v4, 16, v106
    v_and_b32 v5, s6, v106
    v_fmac_f32 v24, v4, v118
    v_fmac_f32 v25, v5, v118
    v_lshlrev_b32 v6, 16, v107
    v_and_b32 v7, s6, v107
    v_fmac_f32 v26, v6, v118
    v_fmac_f32 v27, v7, v118
    s_waitcnt vmcnt(13)
    v_lshlrev_b32 v4, 16, v108
    v_and_b32 v5, s6, v108
    v_fmac_f32 v20, v4, v119
    v_fmac_f32 v21, v5, v119
    v_lshlrev_b32 v6, 16, v109
    v_and_b32 v7, s6, v109
    v_fmac_f32 v22, v6, v119
    v_fmac_f32 v23, v7, v119
    v_lshlrev_b32 v4, 16, v110
    v_and_b32 v5, s6, v110
    v_fmac_f32 v24, v4, v119
    v_fmac_f32 v25, v5, v119
    v_lshlrev_b32 v6, 16, v111
    v_and_b32 v7, s6, v111
    v_fmac_f32 v26, v6, v119
    v_fmac_f32 v27, v7, v119
    v_permlane32_swap_b32 v20, v24
    v_permlane32_swap_b32 v21, v25
    v_permlane32_swap_b32 v22, v26
    v_permlane32_swap_b32 v23, v27
    v_add_f32 v20, v20, v24
    v_add_f32 v21, v21, v25
    v_add_f32 v22, v22, v26
    v_add_f32 v23, v23, v27
    s_nop 0
    v_permlane16_swap_b32 v20, v22
    v_permlane16_swap_b32 v21, v23
    v_add_f32 v20, v20, v22
    v_add_f32 v21, v21, v23
    s_nop 0
    v_add_f32_dpp v20, v20, v20 row_ror:8 row_mask:0xf bank_mask:0xf
    v_add_f32_dpp v21, v21, v21 row_ror:8 row_mask:0xf bank_mask:0xf
    s_nop 1
    v_mov_b32_dpp v20, v21 quad_perm:[0,1,2,3] row_mask:0xf bank_mask:0xc
    ds_write_b32 v65, v20 offset:1024
    s_waitcnt lgkmcnt(0)
    s_barrier
    s_add_u32 s96, s85, 14
    s_and_b32 s97, s96, 15
    s_lshl3_add_u32 s98, s97, s3
    s_sub_u32 s99, s98, 4
    s_mul_i32 s96, s99, 49152
    s_lshl_b32 s97, s11, 7
    s_add_u32 s82, s96, s97
    s_sub_u32 s96, s3, 4
    s_lshr_b32 s97, s96, 1
    s_mul_i32 s98, s97, 2080
    s_sub_u32 s99, s3, 4
    s_and_b32 s96, s99, 1
    s_mul_i32 s97, s96, 1056
    s_add_u32 s99, s98, s97
    s_add_u32 s20, s99, 49920
    s_mov_b32 m0, s20
    s_nop 0
    buffer_load_dwordx4 v62, s[40:43], s82 offen lds
    s_add_u32 s82, s82, 2048
    s_add_u32 m0, s20, 8320
    s_nop 0
    buffer_load_dwordx4 v62, s[40:43], s82 offen lds
    s_add_u32 s82, s82, 2048
    s_add_u32 m0, s20, 16640
    s_nop 0
    buffer_load_dwordx4 v62, s[40:43], s82 offen lds
    s_add_u32 s96, s85, 14
    s_and_b32 s97, s96, 15
    s_lshl3_add_u32 s98, s97, s3
    s_mul_i32 s99, s98, 49152
    s_lshl_b32 s96, s11, 7
    s_add_u32 s82, s99, s96
    s_lshr_b32 s96, s3, 1
    s_mul_i32 s97, s96, 2080
    s_and_b32 s98, s3, 1
    s_mul_i32 s99, s98, 1056
    s_add_u32 s96, s97, s99
    s_add_u32 s20, s96, 49920
    s_mov_b32 m0, s20
    s_nop 0
    buffer_load_dwordx4 v62, s[40:43], s82 offen lds
    s_add_u32 s82, s82, 2048
    s_add_u32 m0, s20, 8320
    s_nop 0
    buffer_load_dwordx4 v62, s[40:43], s82 offen lds
    s_add_u32 s82, s82, 2048
    s_add_u32 m0, s20, 16640
    s_nop 0
    buffer_load_dwordx4 v62, s[40:43], s82 offen lds
    s_cmp_lg_u32 s3, 4
    s_cbranch_scc1 L_M2F
    ds_read_b128 v[20:23], v64 offset:1024
    s_bfe_u32 s96, s9, 131074
    s_lshl_b32 s97, s8, 1
    s_lshl4_add_u32 s98, s96, s97
    s_lshr_b32 s99, s9, 4
    s_add_u32 s96, s98, s99
    s_and_b32 s97, s9, 3
    s_lshl2_add_u32 s98, s96, s97
    s_lshl_b32 s99, s98, 9
    s_add_u32 s13, s99, 131072
    s_waitcnt lgkmcnt(0)
    v_add_f32 v20, v20, v21
    v_add_f32 v22, v22, v23
    v_mov_b32 v21, s4
    v_add_f32 v20, v20, v22
    buffer_store_dwordx2 v[20:21], v63, s[32:35], s13 offen sc1
L_M2F:
    s_barrier
    s_add_u32 s96, s85, 15
    s_and_b32 s97, s96, 15
    s_lshl3_add_u32 s98, s97, s3
    s_sub_u32 s99, s98, 4
    s_mul_i32 s96, s99, 49152
    s_lshl_b32 s97, s11, 7
    s_add_u32 s82, s96, s97
    s_sub_u32 s96, s3, 4
    s_lshr_b32 s97, s96, 1
    s_mul_i32 s98, s97, 2080
    s_sub_u32 s99, s3, 4
    s_and_b32 s96, s99, 1
    s_mul_i32 s97, s96, 1056
    s_add_u32 s99, s98, s97
    s_add_u32 s20, s99, 74880
    s_mov_b32 m0, s20
    s_nop 0
    buffer_load_dwordx4 v62, s[40:43], s82 offen lds
    s_add_u32 s82, s82, 2048
    s_add_u32 m0, s20, 8320
    s_nop 0
    buffer_load_dwordx4 v62, s[40:43], s82 offen lds
    s_add_u32 s82, s82, 2048
    s_add_u32 m0, s20, 16640
    s_nop 0
    buffer_load_dwordx4 v62, s[40:43], s82 offen lds
    s_add_u32 s96, s85, 15
    s_and_b32 s97, s96, 15
    s_lshl3_add_u32 s98, s97, s3
    s_mul_i32 s99, s98, 49152
    s_lshl_b32 s96, s11, 7
    s_add_u32 s82, s99, s96
    s_lshr_b32 s96, s3, 1
    s_mul_i32 s97, s96, 2080
    s_and_b32 s98, s3, 1
    s_mul_i32 s99, s98, 1056
    s_add_u32 s96, s97, s99
    s_add_u32 s20, s96, 74880
    s_mov_b32 m0, s20
    s_nop 0
    buffer_load_dwordx4 v62, s[40:43], s82 offen lds
    s_add_u32 s82, s82, 2048
    s_add_u32 m0, s20, 8320
    s_nop 0
    buffer_load_dwordx4 v62, s[40:43], s82 offen lds
    s_add_u32 s82, s82, 2048
    s_add_u32 m0, s20, 16640
    s_nop 0
    buffer_load_dwordx4 v62, s[40:43], s82 offen lds
    s_mov_b32 s13, s80
    buffer_load_dwordx4 v[176:179], v72, s[52:55], s13 offen nt
    s_add_u32 s13, s80, 4294049792
    buffer_load_dwordx4 v[180:183], v72, s[52:55], s13 offen nt
    s_waitcnt vmcnt(20)
    s_barrier
    s_waitcnt vmcnt(14)
    s_waitcnt vmcnt(8)
    s_waitcnt vmcnt(2)
    s_barrier
    v_and_b32 v89, 31, v1
    v_lshlrev_b32 v89, 4, v89
    v_lshrrev_b32 v9, 5, v1
    v_lshl_add_u32 v89, v9, 9, v89
    s_and_b32 s96, s3, 3
    s_lshl4_add_u32 s97, s96, s12
    s_lshl_b32 s98, s97, 11
    s_add_u32 s18, s98, 131072
    s_lshl_b32 s13, s12, 7
    v_and_b32 v4, 31, v1
    v_lshl_add_u32 v4, v4, 2, s13
    global_load_dword v88, v4, s[78:79]
    buffer_load_dwordx4 v[80:83], v89, s[32:35], s18 offen sc1
    buffer_load_dwordx4 v[84:87], v89, s[32:35], s18 offen offset:1024 sc1
    s_barrier
    s_lshl4_add_u32 s96, s11, s10
    s_lshl_b32 s97, s96, 10
    s_and_b32 s98, s3, 3
    s_lshl_b32 s99, s98, 8
    s_add_u32 s96, s97, s99
    s_add_u32 s13, s96, 29360128
    s_lshl_b32 s96, s11, 7
    s_add_u32 s14, s96, 32768
    v_lshlrev_b32 v60, 7, v1
    s_mov_b64 exec, 3
    buffer_load_dword v60, v60, s[32:35], s13 offen
    buffer_load_dword v61, v3, s[32:35], s14 offen
    s_mov_b64 exec, -1
    s_add_u32 s96, s84, 1114112
    s_and_b32 s97, s96, 1048575
    s_lshl_b32 s98, s83, 16
    s_xor_b32 s99, s97, s98
    s_xor_b32 s96, s88, 1048576
    s_add_u32 s13, s99, s96
    s_add_u32 m0, s89, 102400
    s_nop 0
    buffer_load_dwordx4 v74, s[44:47], s13 offen lds
    s_add_u32 s96, s84, 1179648
    s_and_b32 s97, s96, 1048575
    s_lshl_b32 s98, s83, 16
    s_xor_b32 s99, s97, s98
    s_xor_b32 s96, s88, 1048576
    s_add_u32 s13, s99, s96
    s_add_u32 m0, s89, 106496
    s_nop 0
    buffer_load_dwordx4 v74, s[44:47], s13 offen lds
    s_add_u32 s96, s84, 1245184
    s_and_b32 s97, s96, 1048575
    s_lshl_b32 s98, s83, 16
    s_xor_b32 s99, s97, s98
    s_xor_b32 s96, s88, 1048576
    s_add_u32 s13, s99, s96
    s_add_u32 m0, s89, 110592
    s_nop 0
    buffer_load_dwordx4 v74, s[44:47], s13 offen lds
    s_add_u32 s96, s84, 1310720
    s_and_b32 s97, s96, 1048575
    s_lshl_b32 s98, s83, 16
    s_xor_b32 s99, s97, s98
    s_xor_b32 s96, s88, 1048576
    s_add_u32 s13, s99, s96
    s_add_u32 m0, s89, 114688
    s_nop 0
    buffer_load_dwordx4 v74, s[44:47], s13 offen lds
    s_add_u32 s96, s84, 1376256
    s_and_b32 s97, s96, 1048575
    s_lshl_b32 s98, s83, 16
    s_xor_b32 s99, s97, s98
    s_xor_b32 s96, s88, 1048576
    s_add_u32 s13, s99, s96
    s_add_u32 m0, s89, 118784
    s_nop 0
    buffer_load_dwordx4 v74, s[44:47], s13 offen lds
    s_add_u32 s96, s84, 1441792
    s_and_b32 s97, s96, 1048575
    s_lshl_b32 s98, s83, 16
    s_xor_b32 s99, s97, s98
    s_xor_b32 s96, s88, 1048576
    s_add_u32 s13, s99, s96
    s_add_u32 m0, s89, 122880
    s_nop 0
    buffer_load_dwordx4 v74, s[44:47], s13 offen lds
    s_add_u32 s96, s84, 1507328
    s_and_b32 s97, s96, 1048575
    s_lshl_b32 s98, s83, 16
    s_xor_b32 s99, s97, s98
    s_xor_b32 s96, s88, 1048576
    s_add_u32 s13, s99, s96
    s_add_u32 m0, s89, 126976
    s_nop 0
    buffer_load_dwordx4 v74, s[44:47], s13 offen lds
    s_add_u32 s96, s84, 1572864
    s_and_b32 s97, s96, 1048575
    s_lshl_b32 s98, s83, 16
    s_xor_b32 s99, s97, s98
    s_xor_b32 s96, s88, 1048576
    s_add_u32 s13, s99, s96
    s_add_u32 m0, s89, 131072
    s_nop 0
    buffer_load_dwordx4 v74, s[44:47], s13 offen lds
    s_add_u32 s13, s80, 57344
    buffer_load_dwordx4 v[184:187], v72, s[52:55], s13 offen nt
    s_add_u32 s13, s80, 4294107136
    buffer_load_dwordx4 v[188:191], v72, s[52:55], s13 offen nt
    s_add_u32 s13, s80, 114688
    buffer_load_dwordx4 v[192:195], v72, s[52:55], s13 offen nt
    s_add_u32 s13, s80, 4294164480
    buffer_load_dwordx4 v[196:199], v72, s[52:55], s13 offen nt
    s_add_u32 s13, s80, 172032
    buffer_load_dwordx4 v[200:203], v72, s[52:55], s13 offen nt
    s_add_u32 s13, s80, 4294221824
    buffer_load_dwordx4 v[204:207], v72, s[52:55], s13 offen nt
    s_mov_b32 s13, s80
    buffer_load_dwordx4 v[208:211], v72, s[56:59], s13 offen nt
    s_add_u32 s13, s80, 4294049792
    buffer_load_dwordx4 v[212:215], v72, s[56:59], s13 offen nt
    s_waitcnt vmcnt(18)
    v_bitop3_b32 v4, v81, v83, s4 bitop3:0x7e
    v_bitop3_b32 v4, v4, v85, s4 bitop3:0xf6
    v_bitop3_b32 v4, v4, v87, s4 bitop3:0xf6
    v_cmp_ne_u32 vcc, 0, v4
    s_cbranch_vccz TOK_14
POLL_15:
    buffer_load_dwordx4 v[80:83], v89, s[32:35], s18 offen sc1
    buffer_load_dwordx4 v[84:87], v89, s[32:35], s18 offen offset:1024 sc1
    s_waitcnt vmcnt(0)
    v_bitop3_b32 v4, v81, v83, s4 bitop3:0x7e
    v_bitop3_b32 v4, v4, v85, s4 bitop3:0xf6
    v_bitop3_b32 v4, v4, v87, s4 bitop3:0xf6
    v_cmp_ne_u32 vcc, 0, v4
    s_cbranch_vccz PDONE_16
    s_add_u32 s5, s5, 1
    s_cmp_lt_u32 s5, 300000
    s_cbranch_scc1 POLL_15
PDONE_16:
TOK_14:
    s_and_b32 s96, s3, 3
    s_lshl_b32 s97, s96, 7
    s_add_u32 s13, s97, 139264
    v_and_b32 v4, 31, v1
    v_lshl_add_u32 v4, v4, 2, s13
    s_and_b32 s14, s3, 3
    v_add_f32 v80, v80, v84
    v_add_f32 v81, v82, v86
    v_mov_b32 v82, v80
    v_mov_b32 v83, v81
    s_cmp_eq_u32 s14, 2
    s_cselect_b32 s15, 1.0, 0
    v_permlane32_swap_b32 v80, v82
    v_permlane32_swap_b32 v81, v83
    v_pk_add_f32 v[80:81], v[80:81], v[82:83]
    v_cvt_pk_bf16_f32 v80, 0, v80
    v_cvt_pk_bf16_f32 v81, 0, v81
    v_add_f32 v80, s15, v80
    v_add_f32 v81, s15, v81
    v_cvt_pk_bf16_f32 v82, v80, v81
    ds_write_b32 v4, v82
    s_cbranch_scc0 L_NOG
    v_lshlrev_b32 v80, 16, v82
    v_and_b32 v81, s6, v82
    v_lshlrev_b32 v84, 16, v88
    v_and_b32 v85, s6, v88
    v_pk_mul_f32 v[84:85], v[84:85], v[80:81]
    v_cvt_pk_bf16_f32 v86, v84, v85
    v_lshlrev_b32 v80, 16, v86
    v_and_b32 v81, s6, v86
    v_pk_add_f32 v[80:81], v[84:85], v[80:81] neg_lo:[0,1] neg_hi:[0,1]
    v_cvt_pk_bf16_f32 v87, v80, v81
    v_add_f32 v80, v84, v85
    ds_write2_b32 v4, v86, v87 offset0:64 offset1:96
    ds_write_b32 v4, v88 offset:512
    v_add_f32_dpp v80, v80, v80 quad_perm:[1,0,3,2] row_mask:0xf bank_mask:0xf
    s_nop 1
    v_add_f32_dpp v80, v80, v80 quad_perm:[2,3,0,1] row_mask:0xf bank_mask:0xf
    s_nop 1
    v_add_f32_dpp v80, v80, v80 row_half_mirror row_mask:0xf bank_mask:0xf
    s_nop 1
    v_add_f32_dpp v80, v80, v80 row_ror:8 row_mask:0xf bank_mask:0xf
    s_lshl4_add_u32 s96, s21, s12
    s_lshl3_add_u32 s13, s96, 65536
    v_mov_b32 v82, v80
    v_mov_b32 v81, s4
    s_nop 0
    v_permlane16_swap_b32 v80, v82
    v_add_f32 v80, v80, v82
    s_mov_b64 exec, 1
    buffer_store_dwordx2 v[80:81], v3, s[32:35], s13 offen sc1
    s_mov_b64 exec, -1
L_NOG:
    s_waitcnt lgkmcnt(0)
    s_barrier
    ds_read_b128 v[36:39], v76
    ds_read_b128 v[40:43], v76 offset:1024
    s_waitcnt lgkmcnt(0)
    v_mfma_f32_32x32x16_bf16 v[112:127], v[28:31], v[36:39], 0
    v_mfma_f32_32x32x16_bf16 v[112:127], v[32:35], v[40:43], v[112:127]
    s_add_u32 s13, s80, 57344
    buffer_load_dwordx4 v[216:219], v72, s[56:59], s13 offen nt
    s_add_u32 s13, s80, 4294107136
    buffer_load_dwordx4 v[220:223], v72, s[56:59], s13 offen nt
L_JOIN:
    s_nop 7
    v_cvt_pk_bf16_f32 v112, 0, v112
    v_cvt_pk_bf16_f32 v113, 0, v113
    v_cvt_pk_bf16_f32 v114, 0, v114
    v_cvt_pk_bf16_f32 v115, 0, v115
    v_cvt_pk_bf16_f32 v116, 0, v116
    v_cvt_pk_bf16_f32 v117, 0, v117
    v_cvt_pk_bf16_f32 v118, 0, v118
    v_cvt_pk_bf16_f32 v119, 0, v119
    v_cvt_pk_bf16_f32 v120, 0, v120
    v_cvt_pk_bf16_f32 v121, 0, v121
    v_cvt_pk_bf16_f32 v122, 0, v122
    v_cvt_pk_bf16_f32 v123, 0, v123
    v_cvt_pk_bf16_f32 v124, 0, v124
    v_cvt_pk_bf16_f32 v125, 0, v125
    v_cvt_pk_bf16_f32 v126, 0, v126
    v_cvt_pk_bf16_f32 v127, 0, v127
    v_max3_f32 v4, v112, v113, v114
    v_min3_f32 v5, v112, v113, v114
    v_max3_f32 v4, v4, v115, v116
    v_min3_f32 v5, v5, v115, v116
    v_max3_f32 v4, v4, v117, v118
    v_min3_f32 v5, v5, v117, v118
    v_max3_f32 v4, v4, v119, v120
    v_min3_f32 v5, v5, v119, v120
    v_max3_f32 v4, v4, v121, v122
    v_min3_f32 v5, v5, v121, v122
    v_max3_f32 v4, v4, v123, v124
    v_min3_f32 v5, v5, v123, v124
    v_max3_f32 v4, v4, v125, v126
    v_min3_f32 v5, v5, v125, v126
    v_max_f32 v6, v4, v127
    v_min_f32 v7, v5, v127
    v_max_f32 v4, v4, v127
    v_min_f32 v5, v5, v127
    s_nop 0
    v_permlane32_swap_b32 v4, v6
    v_permlane32_swap_b32 v5, v7
    v_max_f32 v4, v4, v6
    v_min_f32 v5, v5, v7
    v_pk_mul_f32 v[4:5], v[4:5], s[6:7] op_sel:[0,1]
    v_pk_fma_f32 v[128:129], v[112:113], s[6:7], v[4:5] op_sel:[0,1,0] op_sel_hi:[1,1,0] neg_lo:[0,0,1] neg_hi:[0,0,1]
    v_pk_fma_f32 v[112:113], v[112:113], s[6:7], v[4:5] op_sel:[0,1,1] neg_lo:[1,0,0] neg_hi:[1,0,0]
    v_pk_fma_f32 v[130:131], v[114:115], s[6:7], v[4:5] op_sel:[0,1,0] op_sel_hi:[1,1,0] neg_lo:[0,0,1] neg_hi:[0,0,1]
    v_pk_fma_f32 v[114:115], v[114:115], s[6:7], v[4:5] op_sel:[0,1,1] neg_lo:[1,0,0] neg_hi:[1,0,0]
    v_pk_fma_f32 v[132:133], v[116:117], s[6:7], v[4:5] op_sel:[0,1,0] op_sel_hi:[1,1,0] neg_lo:[0,0,1] neg_hi:[0,0,1]
    v_pk_fma_f32 v[116:117], v[116:117], s[6:7], v[4:5] op_sel:[0,1,1] neg_lo:[1,0,0] neg_hi:[1,0,0]
    v_pk_fma_f32 v[134:135], v[118:119], s[6:7], v[4:5] op_sel:[0,1,0] op_sel_hi:[1,1,0] neg_lo:[0,0,1] neg_hi:[0,0,1]
    v_pk_fma_f32 v[118:119], v[118:119], s[6:7], v[4:5] op_sel:[0,1,1] neg_lo:[1,0,0] neg_hi:[1,0,0]
    v_pk_fma_f32 v[136:137], v[120:121], s[6:7], v[4:5] op_sel:[0,1,0] op_sel_hi:[1,1,0] neg_lo:[0,0,1] neg_hi:[0,0,1]
    v_pk_fma_f32 v[120:121], v[120:121], s[6:7], v[4:5] op_sel:[0,1,1] neg_lo:[1,0,0] neg_hi:[1,0,0]
    v_pk_fma_f32 v[138:139], v[122:123], s[6:7], v[4:5] op_sel:[0,1,0] op_sel_hi:[1,1,0] neg_lo:[0,0,1] neg_hi:[0,0,1]
    v_pk_fma_f32 v[122:123], v[122:123], s[6:7], v[4:5] op_sel:[0,1,1] neg_lo:[1,0,0] neg_hi:[1,0,0]
    v_pk_fma_f32 v[140:141], v[124:125], s[6:7], v[4:5] op_sel:[0,1,0] op_sel_hi:[1,1,0] neg_lo:[0,0,1] neg_hi:[0,0,1]
    v_pk_fma_f32 v[124:125], v[124:125], s[6:7], v[4:5] op_sel:[0,1,1] neg_lo:[1,0,0] neg_hi:[1,0,0]
    v_pk_fma_f32 v[142:143], v[126:127], s[6:7], v[4:5] op_sel:[0,1,0] op_sel_hi:[1,1,0] neg_lo:[0,0,1] neg_hi:[0,0,1]
    v_pk_fma_f32 v[126:127], v[126:127], s[6:7], v[4:5] op_sel:[0,1,1] neg_lo:[1,0,0] neg_hi:[1,0,0]
    v_exp_f32 v128, v128
    v_exp_f32 v112, v112
    v_exp_f32 v129, v129
    v_exp_f32 v113, v113
    v_exp_f32 v130, v130
    v_exp_f32 v114, v114
    v_exp_f32 v131, v131
    v_exp_f32 v115, v115
    v_exp_f32 v132, v132
    v_exp_f32 v116, v116
    v_exp_f32 v133, v133
    v_exp_f32 v117, v117
    v_exp_f32 v134, v134
    v_exp_f32 v118, v118
    v_exp_f32 v135, v135
    v_exp_f32 v119, v119
    v_exp_f32 v136, v136
    v_exp_f32 v120, v120
    v_exp_f32 v137, v137
    v_exp_f32 v121, v121
    v_exp_f32 v138, v138
    v_exp_f32 v122, v122
    v_exp_f32 v139, v139
    v_exp_f32 v123, v123
    v_exp_f32 v140, v140
    v_exp_f32 v124, v124
    v_exp_f32 v141, v141
    v_exp_f32 v125, v125
    v_exp_f32 v142, v142
    v_exp_f32 v126, v126
    v_exp_f32 v143, v143
    v_exp_f32 v127, v127
    v_pk_add_f32 v[8:9], v[128:129], v[130:131]
    v_pk_add_f32 v[10:11], v[112:113], v[114:115]
    v_pk_add_f32 v[8:9], v[8:9], v[132:133]
    v_pk_add_f32 v[10:11], v[10:11], v[116:117]
    v_pk_add_f32 v[8:9], v[8:9], v[134:135]
    v_pk_add_f32 v[10:11], v[10:11], v[118:119]
    v_pk_add_f32 v[8:9], v[8:9], v[136:137]
    v_pk_add_f32 v[10:11], v[10:11], v[120:121]
    v_pk_add_f32 v[8:9], v[8:9], v[138:139]
    v_pk_add_f32 v[10:11], v[10:11], v[122:123]
    v_pk_add_f32 v[8:9], v[8:9], v[140:141]
    v_pk_add_f32 v[10:11], v[10:11], v[124:125]
    v_pk_add_f32 v[8:9], v[8:9], v[142:143]
    v_pk_add_f32 v[10:11], v[10:11], v[126:127]
    v_add_f32 v6, v8, v9
    v_add_f32 v7, v10, v11
    v_add_f32 v4, v8, v9
    v_add_f32 v5, v10, v11
    s_nop 0
    v_permlane32_swap_b32 v4, v6
    v_permlane32_swap_b32 v5, v7
    v_pk_add_f32 v[4:5], v[4:5], v[6:7]
    v_rcp_f32 v4, v4
    v_rcp_f32 v5, v5
    s_nop 0
    v_pk_mul_f32 v[128:129], v[128:129], v[4:5] op_sel_hi:[1,0]
    v_pk_mul_f32 v[112:113], v[112:113], v[4:5] op_sel:[0,1]
    v_pk_mul_f32 v[130:131], v[130:131], v[4:5] op_sel_hi:[1,0]
    v_pk_mul_f32 v[114:115], v[114:115], v[4:5] op_sel:[0,1]
    v_pk_mul_f32 v[132:133], v[132:133], v[4:5] op_sel_hi:[1,0]
    v_pk_mul_f32 v[116:117], v[116:117], v[4:5] op_sel:[0,1]
    v_pk_mul_f32 v[134:135], v[134:135], v[4:5] op_sel_hi:[1,0]
    v_pk_mul_f32 v[118:119], v[118:119], v[4:5] op_sel:[0,1]
    v_pk_mul_f32 v[136:137], v[136:137], v[4:5] op_sel_hi:[1,0]
    v_pk_mul_f32 v[120:121], v[120:121], v[4:5] op_sel:[0,1]
    v_pk_mul_f32 v[138:139], v[138:139], v[4:5] op_sel_hi:[1,0]
    v_pk_mul_f32 v[122:123], v[122:123], v[4:5] op_sel:[0,1]
    v_pk_mul_f32 v[140:141], v[140:141], v[4:5] op_sel_hi:[1,0]
    v_pk_mul_f32 v[124:125], v[124:125], v[4:5] op_sel:[0,1]
    v_pk_mul_f32 v[142:143], v[142:143], v[4:5] op_sel_hi:[1,0]
    v_pk_mul_f32 v[126:127], v[126:127], v[4:5] op_sel:[0,1]
    v_cvt_pk_bf16_f32 v80, v128, v129
    v_cvt_pk_bf16_f32 v88, v112, v113
    v_cvt_pk_bf16_f32 v81, v130, v131
    v_cvt_pk_bf16_f32 v89, v114, v115
    v_cvt_pk_bf16_f32 v82, v132, v133
    v_cvt_pk_bf16_f32 v90, v116, v117
    v_cvt_pk_bf16_f32 v83, v134, v135
    v_cvt_pk_bf16_f32 v91, v118, v119
    v_cvt_pk_bf16_f32 v84, v136, v137
    v_cvt_pk_bf16_f32 v92, v120, v121
    v_cvt_pk_bf16_f32 v85, v138, v139
    v_cvt_pk_bf16_f32 v93, v122, v123
    v_cvt_pk_bf16_f32 v86, v140, v141
    v_cvt_pk_bf16_f32 v94, v124, v125
    v_cvt_pk_bf16_f32 v87, v142, v143
    v_cvt_pk_bf16_f32 v95, v126, v127
    ds_write_b128 v75, v[80:83]
    ds_write_b128 v75, v[84:87] offset:4096
    ds_write_b128 v75, v[88:91] offset:8192
    ds_write_b128 v75, v[92:95] offset:12288
    s_lshl_b32 s13, s3, 12
    v_add_u32 v20, s13, v63
    s_lshl_b32 s96, s76, 13
    s_add_u32 s13, s96, 32768
    v_add_u32 v21, s13, v63
    v_mov_b32 v36, 0x3f803f80
    v_mov_b32 v37, 0x3f803f80
    v_mov_b32 v38, 0x3f803f80
    v_mov_b32 v39, 0x3f803f80
    s_lshl3_add_u32 s96, s11, s3
    s_lshl_b32 s97, s96, 5
    s_add_u32 s98, s97, s10
    s_lshl_b32 s99, s98, 10
    s_add_u32 s13, s99, 25165824
    s_add_u32 s15, s13, 16384
    s_lshl3_add_u32 s96, s11, s3
    s_lshl_b32 s97, s96, 10
    s_add_u32 s16, s97, 21495808
    s_lshl_b32 s96, s10, 6
    s_add_u32 s14, s96, s16
    s_waitcnt lgkmcnt(0)
    s_barrier
    s_lshl_b32 s96, s76, 6
    s_add_u32 s18, s96, 139264
    v_and_b32 v67, 7, v1
    v_lshl_add_u32 v67, v67, 2, s18
    v_lshrrev_b32 v9, 5, v1
    v_lshl_add_u32 v67, v9, 5, v67
    ds_read_b32 v64, v67
    ds_read_b32 v65, v67 offset:512
    ds_read_b32 v66, v67 offset:640
    ds_read_b32 v68, v67 offset:128
    ds_read_b32 v69, v67 offset:256
    ds_read_b32 v70, v67 offset:384
    ds_read_b32 v71, v67 offset:768
    ds_read_b64_tr_b16 v[128:129], v20
    ds_read_b64_tr_b16 v[130:131], v20 offset:512
    ds_read_b64_tr_b16 v[144:145], v21
    ds_read_b64_tr_b16 v[146:147], v21 offset:512
    ds_read_b64_tr_b16 v[148:149], v21 offset:4096
    ds_read_b64_tr_b16 v[150:151], v21 offset:4608
    ds_read_b64_tr_b16 v[132:133], v20 offset:1024
    ds_read_b64_tr_b16 v[134:135], v20 offset:1536
    ds_read_b64_tr_b16 v[152:153], v21 offset:1024
    ds_read_b64_tr_b16 v[154:155], v21 offset:1536
    ds_read_b64_tr_b16 v[156:157], v21 offset:5120
    ds_read_b64_tr_b16 v[158:159], v21 offset:5632
    ds_read_b64_tr_b16 v[136:137], v20 offset:2048
    ds_read_b64_tr_b16 v[138:139], v20 offset:2560
    ds_read_b64_tr_b16 v[160:161], v21 offset:2048
    ds_read_b64_tr_b16 v[162:163], v21 offset:2560
    ds_read_b64_tr_b16 v[164:165], v21 offset:6144
    ds_read_b64_tr_b16 v[166:167], v21 offset:6656
    s_waitcnt lgkmcnt(12)
    v_mfma_f32_16x16x32_bf16 v[52:55], v[128:131], v[144:147], 0
    v_mfma_f32_16x16x32_bf16 v[56:59], v[128:131], v[148:151], 0
    v_mfma_f32_16x16x32_bf16 v[40:43], v[128:131], v[36:39], 0
    ds_read_b64_tr_b16 v[140:141], v20 offset:3072
    ds_read_b64_tr_b16 v[142:143], v20 offset:3584
    ds_read_b64_tr_b16 v[168:169], v21 offset:3072
    ds_read_b64_tr_b16 v[170:171], v21 offset:3584
    ds_read_b64_tr_b16 v[172:173], v21 offset:7168
    ds_read_b64_tr_b16 v[174:175], v21 offset:7680
    s_waitcnt lgkmcnt(12)
    v_mfma_f32_16x16x32_bf16 v[52:55], v[132:135], v[152:155], v[52:55]
    v_mfma_f32_16x16x32_bf16 v[56:59], v[132:135], v[156:159], v[56:59]
    v_mfma_f32_16x16x32_bf16 v[40:43], v[132:135], v[36:39], v[40:43]
    v_and_b32 v75, 15, v1
    v_lshlrev_b32 v75, 15, v75
    s_and_b32 s96, s10, 1
    s_and_b32 s97, s2, 135
    s_lshl_b32 s98, s97, 12
    s_lshr_b32 s99, s10, 1
    s_lshl_b32 s97, s99, 6
    s_add_u32 s99, s98, s97
    s_lshl2_add_u32 s98, s96, s99
    s_add_u32 s97, s98, 1048576
    s_add_u32 s17, s97, 512
    s_waitcnt lgkmcnt(6)
    v_mfma_f32_16x16x32_bf16 v[52:55], v[136:139], v[160:163], v[52:55]
    v_mfma_f32_16x16x32_bf16 v[56:59], v[136:139], v[164:167], v[56:59]
    v_mfma_f32_16x16x32_bf16 v[40:43], v[136:139], v[36:39], v[40:43]
    s_waitcnt lgkmcnt(0)
    v_mfma_f32_16x16x32_bf16 v[52:55], v[140:143], v[168:171], v[52:55]
    v_mfma_f32_16x16x32_bf16 v[56:59], v[140:143], v[172:175], v[56:59]
    v_mfma_f32_16x16x32_bf16 v[40:43], v[140:143], v[36:39], v[40:43]
    s_cmp_lt_u32 s3, 4
    s_cbranch_scc1 L_NOQX
    ds_read_b128 v[44:47], v76 offset:2048
    ds_read_b128 v[48:51], v76 offset:3072
L_NOQX:
    s_nop 3
    buffer_store_dwordx4 v[52:55], v2, s[32:35], s13 offen sc1
    buffer_store_dwordx4 v[56:59], v2, s[32:35], s15 offen sc1
    s_mov_b32 exec_lo, 0x00010001
    s_mov_b32 exec_hi, 0x00010001
    buffer_store_dwordx4 v[40:43], v1, s[32:35], s14 offen sc1
    s_mov_b64 exec, -1
    s_waitcnt lgkmcnt(0)
    v_mfma_f32_32x32x16_bf16 v[112:127], v[28:31], v[44:47], 0
    v_mfma_f32_32x32x16_bf16 v[112:127], v[32:35], v[48:51], v[112:127]
    v_lshrrev_b32 v22, 3, v1
    v_lshlrev_b32 v22, 10, v22
    v_and_b32 v9, 7, v1
    v_lshl_add_u32 v22, v9, 4, v22
    v_and_b32 v76, 7, v1
    v_lshlrev_b32 v76, 4, v76
    v_lshrrev_b32 v9, 5, v1
    v_lshl_add_u32 v76, v9, 3, v76
    s_nop 3
    v_cvt_pk_bf16_f32 v112, 0, v112
    v_cvt_pk_bf16_f32 v113, 0, v113
    v_cvt_pk_bf16_f32 v114, 0, v114
    v_cvt_pk_bf16_f32 v115, 0, v115
    v_cvt_pk_bf16_f32 v116, 0, v116
    v_cvt_pk_bf16_f32 v117, 0, v117
    v_cvt_pk_bf16_f32 v118, 0, v118
    v_cvt_pk_bf16_f32 v119, 0, v119
    v_cvt_pk_bf16_f32 v120, 0, v120
    v_cvt_pk_bf16_f32 v121, 0, v121
    v_cvt_pk_bf16_f32 v122, 0, v122
    v_cvt_pk_bf16_f32 v123, 0, v123
    v_cvt_pk_bf16_f32 v124, 0, v124
    v_cvt_pk_bf16_f32 v125, 0, v125
    v_cvt_pk_bf16_f32 v126, 0, v126
    v_cvt_pk_bf16_f32 v127, 0, v127
    v_max3_f32 v52, v112, v113, v114
    v_min3_f32 v53, v112, v113, v114
    v_max3_f32 v52, v52, v115, v116
    v_min3_f32 v53, v53, v115, v116
    v_max3_f32 v52, v52, v117, v118
    v_min3_f32 v53, v53, v117, v118
    v_max3_f32 v52, v52, v119, v120
    v_min3_f32 v53, v53, v119, v120
    v_max3_f32 v52, v52, v121, v122
    v_min3_f32 v53, v53, v121, v122
    v_max3_f32 v52, v52, v123, v124
    v_min3_f32 v53, v53, v123, v124
    v_max3_f32 v52, v52, v125, v126
    v_min3_f32 v53, v53, v125, v126
    v_max_f32 v54, v52, v127
    v_min_f32 v55, v53, v127
    v_max_f32 v52, v52, v127
    v_min_f32 v53, v53, v127
    s_nop 0
    v_permlane32_swap_b32 v52, v54
    v_permlane32_swap_b32 v53, v55
    v_max_f32 v52, v52, v54
    v_min_f32 v53, v53, v55
    v_pk_mul_f32 v[52:53], v[52:53], s[6:7] op_sel:[0,1]
    v_pk_fma_f32 v[128:129], v[112:113], s[6:7], v[52:53] op_sel:[0,1,0] op_sel_hi:[1,1,0] neg_lo:[0,0,1] neg_hi:[0,0,1]
    v_pk_fma_f32 v[112:113], v[112:113], s[6:7], v[52:53] op_sel:[0,1,1] neg_lo:[1,0,0] neg_hi:[1,0,0]
    v_pk_fma_f32 v[130:131], v[114:115], s[6:7], v[52:53] op_sel:[0,1,0] op_sel_hi:[1,1,0] neg_lo:[0,0,1] neg_hi:[0,0,1]
    v_pk_fma_f32 v[114:115], v[114:115], s[6:7], v[52:53] op_sel:[0,1,1] neg_lo:[1,0,0] neg_hi:[1,0,0]
    v_pk_fma_f32 v[132:133], v[116:117], s[6:7], v[52:53] op_sel:[0,1,0] op_sel_hi:[1,1,0] neg_lo:[0,0,1] neg_hi:[0,0,1]
    v_pk_fma_f32 v[116:117], v[116:117], s[6:7], v[52:53] op_sel:[0,1,1] neg_lo:[1,0,0] neg_hi:[1,0,0]
    v_pk_fma_f32 v[134:135], v[118:119], s[6:7], v[52:53] op_sel:[0,1,0] op_sel_hi:[1,1,0] neg_lo:[0,0,1] neg_hi:[0,0,1]
    v_pk_fma_f32 v[118:119], v[118:119], s[6:7], v[52:53] op_sel:[0,1,1] neg_lo:[1,0,0] neg_hi:[1,0,0]
    v_pk_fma_f32 v[136:137], v[120:121], s[6:7], v[52:53] op_sel:[0,1,0] op_sel_hi:[1,1,0] neg_lo:[0,0,1] neg_hi:[0,0,1]
    v_pk_fma_f32 v[120:121], v[120:121], s[6:7], v[52:53] op_sel:[0,1,1] neg_lo:[1,0,0] neg_hi:[1,0,0]
    v_pk_fma_f32 v[138:139], v[122:123], s[6:7], v[52:53] op_sel:[0,1,0] op_sel_hi:[1,1,0] neg_lo:[0,0,1] neg_hi:[0,0,1]
    v_pk_fma_f32 v[122:123], v[122:123], s[6:7], v[52:53] op_sel:[0,1,1] neg_lo:[1,0,0] neg_hi:[1,0,0]
    v_pk_fma_f32 v[140:141], v[124:125], s[6:7], v[52:53] op_sel:[0,1,0] op_sel_hi:[1,1,0] neg_lo:[0,0,1] neg_hi:[0,0,1]
    v_pk_fma_f32 v[124:125], v[124:125], s[6:7], v[52:53] op_sel:[0,1,1] neg_lo:[1,0,0] neg_hi:[1,0,0]
    v_pk_fma_f32 v[142:143], v[126:127], s[6:7], v[52:53] op_sel:[0,1,0] op_sel_hi:[1,1,0] neg_lo:[0,0,1] neg_hi:[0,0,1]
    v_pk_fma_f32 v[126:127], v[126:127], s[6:7], v[52:53] op_sel:[0,1,1] neg_lo:[1,0,0] neg_hi:[1,0,0]
    v_exp_f32 v128, v128
    v_exp_f32 v112, v112
    v_exp_f32 v129, v129
    s_lshl_b32 s96, s11, 7
    s_add_u32 s18, s96, 32768
    s_lshl3_add_u32 s14, s10, s18
    v_and_b32 v23, 15, v1
    v_lshlrev_b32 v23, 3, v23
    s_waitcnt vmcnt(0)
    s_barrier
    s_cmp_lg_u32 s3, 0
    s_cbranch_scc1 L_PC
    v_mov_b32 v21, s4
    s_mov_b32 exec_hi, 0
    s_mov_b32 exec_lo, 65535
    buffer_store_dword v21, v75, s[32:35], s17 offen sc1
    s_mov_b64 exec, -1
L_PC:
    buffer_load_dword v67, v3, s[32:35], 0 offen offset:256 sc1
    s_lshl4_add_u32 s96, s11, s10
    s_lshl_b32 s97, s96, 14
    s_lshl_b32 s98, s3, 7
    s_add_u32 s99, s97, s98
    s_add_u32 s13, s99, 25165824
    s_lshl4_add_u32 s96, s11, s10
    s_lshl_b32 s97, s96, 10
    s_lshl_b32 s98, s3, 7
    s_add_u32 s99, s97, s98
    s_add_u32 s15, s99, 29360128
    s_add_u32 s17, s17, 3072
    s_load_dwordx2 s[24:25], s[32:33], s92 offset:512 glc
    s_add_u32 s96, s84, 262144
    s_and_b32 s97, s96, 1048575
    s_lshl_b32 s98, s83, 16
    s_xor_b32 s99, s97, s98
    s_add_u32 s19, s99, s88
    s_add_u32 m0, s89, 49152
    s_nop 0
    buffer_load_dwordx4 v74, s[44:47], s19 offen lds
    v_exp_f32 v113, v113
    v_exp_f32 v130, v130
    v_exp_f32 v114, v114
    v_exp_f32 v131, v131
    v_exp_f32 v115, v115
    v_exp_f32 v132, v132
    v_exp_f32 v116, v116
    v_exp_f32 v133, v133
    v_exp_f32 v117, v117
    v_exp_f32 v134, v134
    s_add_u32 s96, s84, 393216
    s_and_b32 s97, s96, 1048575
    s_lshl_b32 s98, s83, 16
    s_xor_b32 s99, s97, s98
    s_add_u32 s19, s99, s88
    s_add_u32 m0, s89, 57344
    s_nop 0
    buffer_load_dwordx4 v74, s[44:47], s19 offen lds
    v_exp_f32 v118, v118
    v_exp_f32 v135, v135
    v_exp_f32 v119, v119
    v_exp_f32 v136, v136
    v_exp_f32 v120, v120
    v_exp_f32 v137, v137
    v_exp_f32 v121, v121
    v_exp_f32 v138, v138
    v_exp_f32 v122, v122
    s_add_u32 s96, s84, 524288
    s_and_b32 s97, s96, 1048575
    s_lshl_b32 s98, s83, 16
    s_xor_b32 s99, s97, s98
    s_add_u32 s19, s99, s88
    s_add_u32 m0, s89, 65536
    s_nop 0
    buffer_load_dwordx4 v74, s[44:47], s19 offen lds
    v_exp_f32 v139, v139
    v_exp_f32 v123, v123
    v_exp_f32 v140, v140
    v_exp_f32 v124, v124
    v_exp_f32 v141, v141
    v_exp_f32 v125, v125
    v_exp_f32 v142, v142
    v_exp_f32 v126, v126
    v_exp_f32 v143, v143
    v_exp_f32 v127, v127
    s_add_u32 s96, s84, 655360
    s_and_b32 s97, s96, 1048575
    s_lshl_b32 s98, s83, 16
    s_xor_b32 s99, s97, s98
    s_add_u32 s19, s99, s88
    s_add_u32 m0, s89, 73728
    s_nop 0
    buffer_load_dwordx4 v74, s[44:47], s19 offen lds
    v_pk_add_f32 v[56:57], v[128:129], v[130:131]
    v_pk_add_f32 v[58:59], v[112:113], v[114:115]
    v_pk_add_f32 v[56:57], v[56:57], v[132:133]
    v_pk_add_f32 v[58:59], v[58:59], v[116:117]
    v_pk_add_f32 v[56:57], v[56:57], v[134:135]
    v_pk_add_f32 v[58:59], v[58:59], v[118:119]
    v_pk_add_f32 v[56:57], v[56:57], v[136:137]
    v_pk_add_f32 v[58:59], v[58:59], v[120:121]
    v_pk_add_f32 v[56:57], v[56:57], v[138:139]
    s_add_u32 s96, s84, 786432
    s_and_b32 s97, s96, 1048575
    s_lshl_b32 s98, s83, 16
    s_xor_b32 s99, s97, s98
    s_add_u32 s19, s99, s88
    s_add_u32 m0, s89, 81920
    s_nop 0
    buffer_load_dwordx4 v74, s[44:47], s19 offen lds
    v_pk_add_f32 v[58:59], v[58:59], v[122:123]
    v_pk_add_f32 v[56:57], v[56:57], v[140:141]
    v_pk_add_f32 v[58:59], v[58:59], v[124:125]
    v_pk_add_f32 v[56:57], v[56:57], v[142:143]
    v_pk_add_f32 v[58:59], v[58:59], v[126:127]
    v_add_f32 v54, v56, v57
    v_add_f32 v55, v58, v59
    v_add_f32 v52, v56, v57
    v_add_f32 v53, v58, v59
    s_nop 0
    v_permlane32_swap_b32 v52, v54
    s_add_u32 s96, s84, 917504
    s_and_b32 s97, s96, 1048575
    s_lshl_b32 s98, s83, 16
    s_xor_b32 s99, s97, s98
    s_add_u32 s19, s99, s88
    s_add_u32 m0, s89, 90112
    s_nop 0
    buffer_load_dwordx4 v74, s[44:47], s19 offen lds
    v_permlane32_swap_b32 v53, v55
    v_pk_add_f32 v[52:53], v[52:53], v[54:55]
    v_rcp_f32 v52, v52
    v_rcp_f32 v53, v53
    s_nop 0
    v_pk_mul_f32 v[128:129], v[128:129], v[52:53] op_sel_hi:[1,0]
    v_pk_mul_f32 v[112:113], v[112:113], v[52:53] op_sel:[0,1]
    v_pk_mul_f32 v[130:131], v[130:131], v[52:53] op_sel_hi:[1,0]
    v_pk_mul_f32 v[114:115], v[114:115], v[52:53] op_sel:[0,1]
    v_pk_mul_f32 v[132:133], v[132:133], v[52:53] op_sel_hi:[1,0]
    s_branch SCHK_18
SPOLL_17:
    s_load_dwordx2 s[24:25], s[32:33], s92 offset:512 glc
SCHK_18:
    s_add_u32 s5, s5, 1
    s_cmp_ge_u32 s5, 300000
    s_waitcnt lgkmcnt(0)
    s_cbranch_scc1 SDONE_19
    s_cmp_lg_u32 s24, s4
    s_cbranch_scc1 SPOLL_17
    s_cmp_lg_u32 s25, s4
    s_cbranch_scc1 SPOLL_17
SDONE_19:
    s_barrier
    s_add_u32 s18, s13, 8192
    buffer_load_dwordx4 v[144:147], v22, s[32:35], s13 offen sc1
    buffer_load_dwordx4 v[148:151], v22, s[32:35], s18 offen sc1
    buffer_load_dwordx4 v[160:163], v2, s[32:35], s16 offen sc1
    s_lshl_b32 s96, s3, 5
    s_add_u32 s14, s96, 8192
    v_and_b32 v6, 3, v1
    v_lshl_add_u32 v6, v6, 3, s14
    v_lshrrev_b32 v9, 5, v1
    v_lshl_add_u32 v6, v9, 2, v6
    s_lshl_b32 s14, s3, 10
    v_and_b32 v5, 15, v1
    v_lshl_add_u32 v5, v5, 4, s14
    v_lshrrev_b32 v9, 5, v1
    v_lshl_add_u32 v5, v9, 9, v5
    v_bfe_u32 v9, v1, 4, 1
    v_lshl_add_u32 v5, v9, 3, v5
    s_lshl_b32 s96, s76, 7
    s_add_u32 s14, s96, 8192
    v_lshrrev_b32 v7, 5, v1
    v_lshl_add_u32 v7, v7, 4, s14
    s_lshl_b32 s14, s76, 12
    v_add_u32 v20, s14, v2
    v_pk_mul_f32 v[116:117], v[116:117], v[52:53] op_sel:[0,1]
    v_pk_mul_f32 v[134:135], v[134:135], v[52:53] op_sel_hi:[1,0]
    v_pk_mul_f32 v[118:119], v[118:119], v[52:53] op_sel:[0,1]
    v_pk_mul_f32 v[136:137], v[136:137], v[52:53] op_sel_hi:[1,0]
    v_pk_mul_f32 v[120:121], v[120:121], v[52:53] op_sel:[0,1]
    v_pk_mul_f32 v[138:139], v[138:139], v[52:53] op_sel_hi:[1,0]
    v_pk_mul_f32 v[122:123], v[122:123], v[52:53] op_sel:[0,1]
    v_pk_mul_f32 v[140:141], v[140:141], v[52:53] op_sel_hi:[1,0]
    v_pk_mul_f32 v[124:125], v[124:125], v[52:53] op_sel:[0,1]
    v_pk_mul_f32 v[142:143], v[142:143], v[52:53] op_sel_hi:[1,0]
    v_pk_mul_f32 v[126:127], v[126:127], v[52:53] op_sel:[0,1]
    v_cvt_pk_bf16_f32 v80, v128, v129
    v_cvt_pk_bf16_f32 v88, v112, v113
    v_cvt_pk_bf16_f32 v81, v130, v131
    v_cvt_pk_bf16_f32 v89, v114, v115
    v_cvt_pk_bf16_f32 v82, v132, v133
    v_cvt_pk_bf16_f32 v90, v116, v117
    v_cvt_pk_bf16_f32 v83, v134, v135
    v_cvt_pk_bf16_f32 v91, v118, v119
    v_cvt_pk_bf16_f32 v84, v136, v137
    v_cvt_pk_bf16_f32 v92, v120, v121
    v_cvt_pk_bf16_f32 v85, v138, v139
    v_cvt_pk_bf16_f32 v93, v122, v123
    v_cvt_pk_bf16_f32 v86, v140, v141
    v_cvt_pk_bf16_f32 v94, v124, v125
    v_cvt_pk_bf16_f32 v87, v142, v143
    v_cvt_pk_bf16_f32 v95, v126, v127
    s_waitcnt vmcnt(1)
    v_cmp_eq_u32 vcc, s4, v67
    s_nop 0
    s_cmp_eq_u32 vcc_lo, 0
    s_cselect_b32 s93, 1, 0
    v_pk_add_f32 v[144:145], v[144:145], v[148:149]
    v_pk_add_f32 v[146:147], v[146:147], v[150:151]
    s_nop 1
    v_permlane32_swap_b32 v144, v146
    v_permlane32_swap_b32 v145, v147
    v_pk_add_f32 v[144:145], v[144:145], v[146:147]
    s_nop 1
    v_add_f32_dpp v144, v144, v144 row_ror:8 row_mask:0xf bank_mask:0xf
    v_add_f32_dpp v145, v145, v145 row_ror:8 row_mask:0xf bank_mask:0xf
    v_mov_b32 v146, v144
    v_mov_b32 v147, v145
    s_nop 0
    v_permlane16_swap_b32 v144, v146
    v_permlane16_swap_b32 v145, v147
    v_pk_add_f32 v[144:145], v[144:145], v[146:147]
    v_cvt_pk_bf16_f32 v144, v144, v145
    v_mov_b32 v145, s4
    s_mov_b32 exec_lo, 0xff
    s_mov_b32 exec_hi, 0xff
    s_cmp_lg_u32 s93, 0
    s_cbranch_scc1 LOC_20
    buffer_store_dwordx2 v[144:145], v76, s[32:35], s15 offen sc1
    s_branch LOCD_21
LOC_20:
    buffer_store_dwordx2 v[144:145], v76, s[32:35], s15 offen
LOCD_21:
    s_mov_b64 exec, -1
    v_mov_b32 v224, v144
    v_mov_b32 v225, v145
    v_add_u32 v226, s15, v76
    s_cbranch_scc1 L_PC2
    s_barrier
    s_cmp_lg_u32 s3, 0
    s_cbranch_scc1 L_PC2
    v_mov_b32 v21, s4
    s_mov_b32 exec_hi, 0
    s_mov_b32 exec_lo, 65535
    buffer_store_dword v21, v75, s[32:35], s17 offen sc1
    s_mov_b64 exec, -1
L_PC2:
    s_lshl3_add_u32 s96, s11, s3
    s_lshl_b32 s97, s96, 11
    s_add_u32 s13, s97, 29360128
    s_waitcnt vmcnt(0)
    v_permlane32_swap_b32 v160, v162
    v_permlane32_swap_b32 v161, v163
    v_pk_add_f32 v[160:161], v[160:161], v[162:163]
    s_nop 1
    v_add_f32_dpp v160, v160, v160 row_ror:4 row_mask:0xf bank_mask:0xf
    v_add_f32_dpp v161, v161, v161 row_ror:4 row_mask:0xf bank_mask:0xf
    s_nop 0
    v_add_f32_dpp v160, v160, v160 row_ror:8 row_mask:0xf bank_mask:0xf
    v_add_f32_dpp v161, v161, v161 row_ror:8 row_mask:0xf bank_mask:0xf
    v_mov_b32 v162, v160
    v_mov_b32 v163, v161
    s_nop 0
    v_permlane16_swap_b32 v160, v162
    v_permlane16_swap_b32 v161, v163
    v_pk_add_f32 v[160:161], v[160:161], v[162:163]
    v_cvt_pk_bf16_f32 v160, v160, v161
    ds_write_b32 v6, v160
    s_cmp_lg_u32 s93, 0
    s_cbranch_scc1 L_C2L
SPOLL_22:
    s_load_dwordx2 s[24:25], s[32:33], s92 offset:3584 glc
SCHK_23:
    s_add_u32 s5, s5, 1
    s_cmp_ge_u32 s5, 300000
    s_waitcnt lgkmcnt(0)
    s_cbranch_scc1 SDONE_24
    s_cmp_lg_u32 s24, s4
    s_cbranch_scc1 SPOLL_22
    s_cmp_lg_u32 s25, s4
    s_cbranch_scc1 SPOLL_22
SDONE_24:
L_C2L:
    buffer_load_dwordx4 v[152:155], v2, s[32:35], s13 offen sc1
    buffer_load_dwordx4 v[156:159], v2, s[32:35], s13 offen offset:1024 sc1
    s_waitcnt vmcnt(0)
    v_bitop3_b32 v4, v153, v155, s4 bitop3:0x7e
    v_bitop3_b32 v4, v4, v157, s4 bitop3:0xf6
    v_bitop3_b32 v4, v4, v159, s4 bitop3:0xf6
    v_cmp_ne_u32 vcc, 0, v4
    s_cbranch_vccz TOK_26
POLL_27:
    buffer_load_dwordx4 v[152:155], v2, s[32:35], s13 offen sc1
    buffer_load_dwordx4 v[156:159], v2, s[32:35], s13 offen offset:1024 sc1
    s_waitcnt vmcnt(0)
    v_bitop3_b32 v4, v153, v155, s4 bitop3:0x7e
    v_bitop3_b32 v4, v4, v157, s4 bitop3:0xf6
    v_bitop3_b32 v4, v4, v159, s4 bitop3:0xf6
    v_cmp_ne_u32 vcc, 0, v4
    s_cbranch_vccz PDONE_28
    s_add_u32 s5, s5, 1
    s_cmp_lt_u32 s5, 300000
    s_cbranch_scc1 POLL_27
PDONE_28:
TOK_26:
    ds_write2_b32 v5, v152, v154 offset0:0 offset1:1
    ds_write2_b32 v5, v156, v158 offset0:64 offset1:65
    s_waitcnt lgkmcnt(0)
    s_barrier
    ds_read_b128 v[160:163], v7
    ds_read_b128 v[164:167], v7 offset:32
    ds_read_b128 v[168:171], v7 offset:64
    ds_read_b128 v[172:175], v7 offset:96
    ds_read_b128 v[144:147], v20
    ds_read_b128 v[148:151], v20 offset:1024
    ds_read_b128 v[152:155], v20 offset:2048
    ds_read_b128 v[156:159], v20 offset:3072
    s_add_u32 s96, s84, 1048576
    s_and_b32 s97, s96, 1048575
    s_lshl_b32 s98, s83, 16
    s_xor_b32 s99, s97, s98
    s_xor_b32 s96, s88, 1048576
    s_add_u32 s19, s99, s96
    s_add_u32 m0, s89, 98304
    s_nop 0
    buffer_load_dwordx4 v74, s[44:47], s19 offen lds
    s_add_u32 s96, s84, 1703936
    s_and_b32 s97, s96, 1048575
    s_lshl_b32 s98, s83, 16
    s_xor_b32 s99, s97, s98
    s_xor_b32 s96, s88, 1048576
    s_add_u32 s19, s99, s96
    s_add_u32 m0, s89, 139264
    s_nop 0
    buffer_load_dwordx4 v74, s[44:47], s19 offen lds
    s_add_u32 s96, s84, 1835008
    s_and_b32 s97, s96, 1048575
    s_lshl_b32 s98, s83, 16
    s_xor_b32 s99, s97, s98
    s_xor_b32 s96, s88, 1048576
    s_add_u32 s19, s99, s96
    s_add_u32 m0, s89, 147456
    s_nop 0
    buffer_load_dwordx4 v74, s[44:47], s19 offen lds
    s_and_b32 s96, s3, 3
    s_lshl2_add_u32 s97, s10, s96
    s_lshl4_add_u32 s98, s97, s11
    s_lshl1_add_u32 s99, s98, s76
    s_lshl_b32 s96, s99, 11
    s_add_u32 s13, s96, 8388608
    v_and_b32 v8, 15, v1
    v_lshlrev_b32 v8, 4, v8
    v_bfe_u32 v9, v1, 4, 1
    v_lshl_add_u32 v8, v9, 10, v8
    v_lshrrev_b32 v9, 5, v1
    v_lshl_add_u32 v8, v9, 8, v8
    s_waitcnt lgkmcnt(7)
    v_mfma_f32_32x32x16_bf16 v[128:143], v[160:163], v[80:83], 0
    s_waitcnt lgkmcnt(6)
    v_mfma_f32_32x32x16_bf16 v[128:143], v[164:167], v[84:87], v[128:143]
    s_waitcnt lgkmcnt(5)
    v_mfma_f32_32x32x16_bf16 v[128:143], v[168:171], v[88:91], v[128:143]
    s_waitcnt lgkmcnt(4)
    v_mfma_f32_32x32x16_bf16 v[128:143], v[172:175], v[92:95], v[128:143]
    s_waitcnt lgkmcnt(3)
    v_mfma_f32_32x32x16_bf16 v[112:127], v[144:147], v[80:83], 0
    s_waitcnt lgkmcnt(2)
    v_mfma_f32_32x32x16_bf16 v[112:127], v[148:151], v[84:87], v[112:127]
    s_waitcnt lgkmcnt(1)
    v_mfma_f32_32x32x16_bf16 v[112:127], v[152:155], v[88:91], v[112:127]
    s_waitcnt lgkmcnt(0)
    v_mfma_f32_32x32x16_bf16 v[112:127], v[156:159], v[92:95], v[112:127]
    s_nop 3
    v_cvt_pk_bf16_f32 v128, 0, v128
    v_add_f32 v128, 0x358637bd, v128
    v_cvt_pk_bf16_f32 v128, 0, v128
    v_rcp_f32 v128, v128
    s_nop 3
    v_cvt_pk_bf16_f32 v112, 0, v112
    v_cvt_pk_bf16_f32 v113, 0, v113
    v_cvt_pk_bf16_f32 v114, 0, v114
    v_cvt_pk_bf16_f32 v115, 0, v115
    v_cvt_pk_bf16_f32 v116, 0, v116
    v_cvt_pk_bf16_f32 v117, 0, v117
    v_cvt_pk_bf16_f32 v118, 0, v118
    v_cvt_pk_bf16_f32 v119, 0, v119
    v_pk_mul_f32 v[112:113], v[112:113], v[128:129] op_sel_hi:[1,0]
    v_pk_mul_f32 v[114:115], v[114:115], v[128:129] op_sel_hi:[1,0]
    v_pk_mul_f32 v[116:117], v[116:117], v[128:129] op_sel_hi:[1,0]
    v_pk_mul_f32 v[118:119], v[118:119], v[128:129] op_sel_hi:[1,0]
    v_cvt_pk_bf16_f32 v44, v112, v113
    v_cvt_pk_bf16_f32 v45, v114, v115
    v_cvt_pk_bf16_f32 v46, v116, v117
    v_cvt_pk_bf16_f32 v47, v118, v119
    buffer_store_dwordx4 v[44:47], v8, s[32:35], s13 offen sc1
    v_cvt_pk_bf16_f32 v120, 0, v120
    v_cvt_pk_bf16_f32 v121, 0, v121
    v_cvt_pk_bf16_f32 v122, 0, v122
    v_cvt_pk_bf16_f32 v123, 0, v123
    v_cvt_pk_bf16_f32 v124, 0, v124
    v_cvt_pk_bf16_f32 v125, 0, v125
    v_cvt_pk_bf16_f32 v126, 0, v126
    v_cvt_pk_bf16_f32 v127, 0, v127
    v_pk_mul_f32 v[120:121], v[120:121], v[128:129] op_sel_hi:[1,0]
    v_pk_mul_f32 v[122:123], v[122:123], v[128:129] op_sel_hi:[1,0]
    v_pk_mul_f32 v[124:125], v[124:125], v[128:129] op_sel_hi:[1,0]
    v_pk_mul_f32 v[126:127], v[126:127], v[128:129] op_sel_hi:[1,0]
    v_cvt_pk_bf16_f32 v48, v120, v121
    v_cvt_pk_bf16_f32 v49, v122, v123
    v_cvt_pk_bf16_f32 v50, v124, v125
    v_cvt_pk_bf16_f32 v51, v126, v127
    buffer_store_dwordx4 v[48:51], v8, s[32:35], s13 offen offset:512 sc1
    s_mul_i32 s96, s76, 65600
    s_add_u32 s17, s96, 32768
    v_lshrrev_b32 v20, 5, v1
    v_lshlrev_b32 v20, 11, v20
    v_bfe_u32 v9, v1, 4, 1
    v_lshl_add_u32 v20, v9, 9, v20
    v_bfe_u32 v9, v1, 2, 2
    v_lshl_add_u32 v20, v9, 7, v20
    v_bfe_u32 v9, v1, 3, 1
    v_lshl_add_u32 v20, v9, 6, v20
    v_bfe_u32 v9, v1, 1, 1
    v_lshl_add_u32 v20, v9, 5, v20
    v_bfe_u32 v9, v1, 4, 1
    v_lshl_add_u32 v20, v9, 4, v20
    v_and_b32 v9, 1, v1
    v_lshl_add_u32 v20, v9, 3, v20
    v_xor_b32 v20, s17, v20
    v_xor_b32 v21, 16, v20
    v_xor_b32 v22, 64, v20
    v_xor_b32 v23, 80, v20
    v_and_b32 v5, 7, v1
    v_lshlrev_b32 v5, 15, v5
    v_bfe_u32 v9, v1, 3, 1
    v_lshl_add_u32 v5, v9, 12, v5
    s_bfe_u32 s96, s11, 65538
    s_lshr_b32 s97, s10, 2
    s_and_b32 s98, s10, 3
    s_lshl_b32 s99, s98, 6
    s_lshl1_add_u32 s98, s97, s99
    s_lshl_b32 s97, s98, 12
    s_lshr_b32 s99, s11, 3
    s_and_b32 s98, s11, 3
    s_lshl2_add_u32 s99, s99, s98
    s_lshl_b32 s98, s99, 6
    s_add_u32 s99, s97, s98
    s_lshl2_add_u32 s97, s96, s99
    s_add_u32 s98, s97, 1048576
    s_add_u32 s15, s98, 1024
    v_mov_b32 v52, 0x10000
    v_mov_b32 v53, s6
    v_lshlrev_b32 v28, 16, v12
    v_and_b32 v29, s6, v12
    v_lshlrev_b32 v30, 16, v13
    v_and_b32 v31, s6, v13
    v_lshlrev_b32 v32, 16, v14
    v_and_b32 v33, s6, v14
    v_lshlrev_b32 v34, 16, v15
    v_and_b32 v35, s6, v15
    v_lshlrev_b32 v36, 16, v16
    v_and_b32 v37, s6, v16
    v_lshlrev_b32 v38, 16, v17
    v_and_b32 v39, s6, v17
    v_lshlrev_b32 v40, 16, v18
    v_and_b32 v41, s6, v18
    v_lshlrev_b32 v42, 16, v19
    v_and_b32 v43, s6, v19
    v_mul_u32_u24_dpp v76, v64, v52 row_newbcast:0 row_mask:0xf bank_mask:0xf
    v_and_b32_dpp v77, v64, v53 row_newbcast:0 row_mask:0xf bank_mask:0xf
    v_mul_u32_u24_dpp v78, v64, v52 row_newbcast:1 row_mask:0xf bank_mask:0xf
    v_and_b32_dpp v79, v64, v53 row_newbcast:1 row_mask:0xf bank_mask:0xf
    v_mul_u32_u24_dpp v80, v64, v52 row_newbcast:2 row_mask:0xf bank_mask:0xf
    v_and_b32_dpp v81, v64, v53 row_newbcast:2 row_mask:0xf bank_mask:0xf
    v_mul_u32_u24_dpp v82, v64, v52 row_newbcast:3 row_mask:0xf bank_mask:0xf
    v_and_b32_dpp v83, v64, v53 row_newbcast:3 row_mask:0xf bank_mask:0xf
    v_mul_u32_u24_dpp v84, v64, v52 row_newbcast:4 row_mask:0xf bank_mask:0xf
    v_and_b32_dpp v85, v64, v53 row_newbcast:4 row_mask:0xf bank_mask:0xf
    v_mul_u32_u24_dpp v86, v64, v52 row_newbcast:5 row_mask:0xf bank_mask:0xf
    v_and_b32_dpp v87, v64, v53 row_newbcast:5 row_mask:0xf bank_mask:0xf
    v_mul_u32_u24_dpp v88, v64, v52 row_newbcast:6 row_mask:0xf bank_mask:0xf
    v_and_b32_dpp v89, v64, v53 row_newbcast:6 row_mask:0xf bank_mask:0xf
    v_mul_u32_u24_dpp v90, v64, v52 row_newbcast:7 row_mask:0xf bank_mask:0xf
    v_and_b32_dpp v91, v64, v53 row_newbcast:7 row_mask:0xf bank_mask:0xf
    s_lshl1_add_u32 s96, s94, s77
    s_lshl_b32 s97, s96, 15
    s_add_u32 s19, s97, 8388608
    v_and_b32 v25, 15, v1
    v_lshlrev_b32 v25, 3, v25
    s_waitcnt vmcnt(0)
    s_waitcnt lgkmcnt(0)
    s_barrier
    s_cmp_lg_u32 s3, 0
    s_cbranch_scc1 L_PD
    v_mov_b32 v6, s4
    s_mov_b32 exec_hi, 0
    s_mov_b32 exec_lo, 65535
    buffer_store_dword v6, v5, s[32:35], s15 offen sc1
    s_mov_b64 exec, -1
L_PD:
    s_add_u32 s96, s84, 1966080
    s_and_b32 s97, s96, 1048575
    s_lshl_b32 s98, s83, 16
    s_xor_b32 s99, s97, s98
    s_xor_b32 s96, s88, 1048576
    s_add_u32 s13, s99, s96
    s_add_u32 m0, s89, 155648
    s_nop 0
    buffer_load_dwordx4 v74, s[44:47], s13 offen lds
    s_and_b32 s96, s84, 1048575
    s_lshl_b32 s97, s83, 16
    s_xor_b32 s98, s96, s97
    s_add_u32 s13, s98, s88
    s_add_u32 m0, s89, 32768
    s_nop 0
    buffer_load_dwordx4 v74, s[44:47], s13 offen lds
    s_add_u32 s96, s84, 131072
    s_and_b32 s97, s96, 1048575
    s_lshl_b32 s98, s83, 16
    s_xor_b32 s99, s97, s98
    s_add_u32 s13, s99, s88
    s_add_u32 m0, s89, 40960
    s_nop 0
    buffer_load_dwordx4 v74, s[44:47], s13 offen lds
    s_load_dwordx2 s[24:25], s[32:33], s92 offset:1024 glc
    v_mov_b32_dpp v92, v65 row_newbcast:0 row_mask:0xf bank_mask:0xf
    v_mov_b32_dpp v93, v65 row_newbcast:1 row_mask:0xf bank_mask:0xf
    v_mov_b32_dpp v94, v65 row_newbcast:2 row_mask:0xf bank_mask:0xf
    v_mov_b32_dpp v95, v65 row_newbcast:3 row_mask:0xf bank_mask:0xf
    v_mov_b32_dpp v96, v65 row_newbcast:4 row_mask:0xf bank_mask:0xf
    v_mov_b32_dpp v97, v65 row_newbcast:5 row_mask:0xf bank_mask:0xf
    v_mov_b32_dpp v98, v65 row_newbcast:6 row_mask:0xf bank_mask:0xf
    v_mov_b32_dpp v99, v65 row_newbcast:7 row_mask:0xf bank_mask:0xf
    v_mov_b32_dpp v100, v66 row_newbcast:0 row_mask:0xf bank_mask:0xf
    v_mov_b32_dpp v101, v66 row_newbcast:1 row_mask:0xf bank_mask:0xf
    v_mov_b32_dpp v102, v66 row_newbcast:2 row_mask:0xf bank_mask:0xf
    v_mov_b32_dpp v103, v66 row_newbcast:3 row_mask:0xf bank_mask:0xf
    v_mov_b32_dpp v104, v66 row_newbcast:4 row_mask:0xf bank_mask:0xf
    v_mov_b32_dpp v105, v66 row_newbcast:5 row_mask:0xf bank_mask:0xf
    v_mov_b32_dpp v106, v66 row_newbcast:6 row_mask:0xf bank_mask:0xf
    v_mov_b32_dpp v107, v66 row_newbcast:7 row_mask:0xf bank_mask:0xf
    v_and_b32 v4, 3, v1
    v_cmp_eq_u32 vcc, 1, v4
    v_cmp_eq_u32 s[22:23], 0, v4
    v_mov_b32 v5, 0x3f803f80
    v_cndmask_b32 v92, v100, v92, vcc
    v_cndmask_b32 v93, v101, v93, vcc
    v_cndmask_b32 v94, v102, v94, vcc
    v_cndmask_b32 v95, v103, v95, vcc
    v_cndmask_b32 v96, v104, v96, vcc
    v_cndmask_b32 v97, v105, v97, vcc
    v_cndmask_b32 v98, v106, v98, vcc
    v_cndmask_b32 v99, v107, v99, vcc
    v_cndmask_b32 v92, v92, v5, s[22:23]
    v_cndmask_b32 v93, v93, v5, s[22:23]
    v_cndmask_b32 v94, v94, v5, s[22:23]
    v_cndmask_b32 v95, v95, v5, s[22:23]
    v_cndmask_b32 v96, v96, v5, s[22:23]
    v_cndmask_b32 v97, v97, v5, s[22:23]
    v_cndmask_b32 v98, v98, v5, s[22:23]
    v_cndmask_b32 v99, v99, v5, s[22:23]
    s_waitcnt vmcnt(0)
    s_branch SCHK_30
SPOLL_29:
    s_load_dwordx2 s[24:25], s[32:33], s92 offset:1024 glc
SCHK_30:
    s_add_u32 s5, s5, 1
    s_cmp_ge_u32 s5, 300000
    s_waitcnt lgkmcnt(0)
    s_cbranch_scc1 SDONE_31
    s_cmp_lg_u32 s24, s4
    s_cbranch_scc1 SPOLL_29
SDONE_31:
    s_barrier
    s_cmp_lt_u32 s3, 4
    s_cbranch_scc1 L_P2
    s_setprio 1
L_P2:
    s_lshl_b32 s96, s21, 7
    s_add_u32 s18, s96, 65536
    s_lshl_b32 s96, s83, 11
    s_add_u32 s20, s96, s19
    buffer_load_dwordx4 v[140:143], v2, s[32:35], s20 offen sc1
    buffer_load_dwordx4 v[144:147], v2, s[32:35], s20 offen offset:1024 sc1
    ds_read_b64_tr_b16 v[228:229], v22
    ds_read_b64_tr_b16 v[230:231], v22 offset:1024
    ds_read_b64_tr_b16 v[232:233], v23
    ds_read_b64_tr_b16 v[234:235], v23 offset:1024
    ds_read_b64_tr_b16 v[236:237], v20
    ds_read_b64_tr_b16 v[238:239], v20 offset:1024
    ds_read_b64_tr_b16 v[240:241], v21
    ds_read_b64_tr_b16 v[242:243], v21 offset:1024
    s_xor_b32 s96, s83, 1
    s_lshl_b32 s97, s96, 11
    s_add_u32 s20, s97, s19
    buffer_load_dwordx4 v[148:151], v2, s[32:35], s20 offen sc1
    buffer_load_dwordx4 v[152:155], v2, s[32:35], s20 offen offset:1024 sc1
    s_xor_b32 s96, s83, 2
    s_lshl_b32 s97, s96, 11
    s_add_u32 s20, s97, s19
    buffer_load_dwordx4 v[156:159], v2, s[32:35], s20 offen sc1
    buffer_load_dwordx4 v[160:163], v2, s[32:35], s20 offen offset:1024 sc1
    s_waitcnt lgkmcnt(6)
    s_waitcnt vmcnt(5)
    v_mfma_f32_16x16x32_bf16 v[124:127], v[228:231], v[140:143], 0
    ds_read_b64_tr_b16 v[244:245], v22 offset:4096
    s_waitcnt vmcnt(4)
    v_mfma_f32_16x16x32_bf16 v[128:131], v[228:231], v[144:147], 0
    ds_read_b64_tr_b16 v[246:247], v22 offset:5120
    s_xor_b32 s96, s83, 3
    s_lshl_b32 s97, s96, 11
    s_add_u32 s20, s97, s19
    buffer_load_dwordx4 v[164:167], v2, s[32:35], s20 offen sc1
    s_waitcnt lgkmcnt(6)
    v_mfma_f32_16x16x32_bf16 v[132:135], v[232:235], v[140:143], 0
    ds_read_b64_tr_b16 v[228:229], v23 offset:4096
    v_mfma_f32_16x16x32_bf16 v[136:139], v[232:235], v[144:147], 0
    ds_read_b64_tr_b16 v[230:231], v23 offset:5120
    buffer_load_dwordx4 v[168:171], v2, s[32:35], s20 offen offset:1024 sc1
    s_waitcnt lgkmcnt(6)
    v_mfma_f32_16x16x32_bf16 v[108:111], v[236:239], v[140:143], 0
    ds_read_b64_tr_b16 v[232:233], v20 offset:4096
    v_mfma_f32_16x16x32_bf16 v[112:115], v[236:239], v[144:147], 0
    ds_read_b64_tr_b16 v[234:235], v20 offset:5120
    s_waitcnt lgkmcnt(6)
    v_mfma_f32_16x16x32_bf16 v[116:119], v[240:243], v[140:143], 0
    ds_read_b64_tr_b16 v[236:237], v21 offset:4096
    v_mfma_f32_16x16x32_bf16 v[120:123], v[240:243], v[144:147], 0
    ds_read_b64_tr_b16 v[238:239], v21 offset:5120
    s_waitcnt lgkmcnt(6)
    s_waitcnt vmcnt(4)
    v_mfma_f32_16x16x32_bf16 v[124:127], v[244:247], v[148:151], v[124:127]
    ds_read_b64_tr_b16 v[240:241], v22 offset:8192
    v_mfma_f32_16x16x32_bf16 v[128:131], v[244:247], v[152:155], v[128:131]
    ds_read_b64_tr_b16 v[242:243], v22 offset:9216
    s_xor_b32 s96, s83, 4
    s_lshl_b32 s97, s96, 11
    s_add_u32 s20, s97, s19
    buffer_load_dwordx4 v[140:143], v2, s[32:35], s20 offen sc1
    s_waitcnt lgkmcnt(6)
    v_mfma_f32_16x16x32_bf16 v[132:135], v[228:231], v[148:151], v[132:135]
    ds_read_b64_tr_b16 v[244:245], v23 offset:8192
    v_mfma_f32_16x16x32_bf16 v[136:139], v[228:231], v[152:155], v[136:139]
    ds_read_b64_tr_b16 v[246:247], v23 offset:9216
    buffer_load_dwordx4 v[144:147], v2, s[32:35], s20 offen offset:1024 sc1
    s_waitcnt lgkmcnt(6)
    v_mfma_f32_16x16x32_bf16 v[108:111], v[232:235], v[148:151], v[108:111]
    ds_read_b64_tr_b16 v[228:229], v20 offset:8192
    v_mfma_f32_16x16x32_bf16 v[112:115], v[232:235], v[152:155], v[112:115]
    ds_read_b64_tr_b16 v[230:231], v20 offset:9216
    s_waitcnt lgkmcnt(6)
    v_mfma_f32_16x16x32_bf16 v[116:119], v[236:239], v[148:151], v[116:119]
    ds_read_b64_tr_b16 v[232:233], v21 offset:8192
    v_mfma_f32_16x16x32_bf16 v[120:123], v[236:239], v[152:155], v[120:123]
    ds_read_b64_tr_b16 v[234:235], v21 offset:9216
    s_waitcnt lgkmcnt(6)
    s_waitcnt vmcnt(4)
    v_mfma_f32_16x16x32_bf16 v[124:127], v[240:243], v[156:159], v[124:127]
    ds_read_b64_tr_b16 v[236:237], v22 offset:12288
    v_mfma_f32_16x16x32_bf16 v[128:131], v[240:243], v[160:163], v[128:131]
    ds_read_b64_tr_b16 v[238:239], v22 offset:13312
    s_xor_b32 s96, s83, 5
    s_lshl_b32 s97, s96, 11
    s_add_u32 s20, s97, s19
    buffer_load_dwordx4 v[148:151], v2, s[32:35], s20 offen sc1
    s_waitcnt lgkmcnt(6)
    v_mfma_f32_16x16x32_bf16 v[132:135], v[244:247], v[156:159], v[132:135]
    ds_read_b64_tr_b16 v[240:241], v23 offset:12288
    v_mfma_f32_16x16x32_bf16 v[136:139], v[244:247], v[160:163], v[136:139]
    ds_read_b64_tr_b16 v[242:243], v23 offset:13312
    buffer_load_dwordx4 v[152:155], v2, s[32:35], s20 offen offset:1024 sc1
    s_waitcnt lgkmcnt(6)
    v_mfma_f32_16x16x32_bf16 v[108:111], v[228:231], v[156:159], v[108:111]
    ds_read_b64_tr_b16 v[244:245], v20 offset:12288
    v_mfma_f32_16x16x32_bf16 v[112:115], v[228:231], v[160:163], v[112:115]
    ds_read_b64_tr_b16 v[246:247], v20 offset:13312
    s_waitcnt lgkmcnt(6)
    v_mfma_f32_16x16x32_bf16 v[116:119], v[232:235], v[156:159], v[116:119]
    ds_read_b64_tr_b16 v[228:229], v21 offset:12288
    v_mfma_f32_16x16x32_bf16 v[120:123], v[232:235], v[160:163], v[120:123]
    ds_read_b64_tr_b16 v[230:231], v21 offset:13312
    s_waitcnt lgkmcnt(6)
    s_waitcnt vmcnt(4)
    v_mfma_f32_16x16x32_bf16 v[124:127], v[236:239], v[164:167], v[124:127]
    ds_read_b64_tr_b16 v[232:233], v22 offset:16384
    v_mfma_f32_16x16x32_bf16 v[128:131], v[236:239], v[168:171], v[128:131]
    ds_read_b64_tr_b16 v[234:235], v22 offset:17408
    s_xor_b32 s96, s83, 6
    s_lshl_b32 s97, s96, 11
    s_add_u32 s20, s97, s19
    buffer_load_dwordx4 v[156:159], v2, s[32:35], s20 offen sc1
    s_waitcnt lgkmcnt(6)
    v_mfma_f32_16x16x32_bf16 v[132:135], v[240:243], v[164:167], v[132:135]
    ds_read_b64_tr_b16 v[236:237], v23 offset:16384
    v_mfma_f32_16x16x32_bf16 v[136:139], v[240:243], v[168:171], v[136:139]
    ds_read_b64_tr_b16 v[238:239], v23 offset:17408
    buffer_load_dwordx4 v[160:163], v2, s[32:35], s20 offen offset:1024 sc1
    s_waitcnt lgkmcnt(6)
    v_mfma_f32_16x16x32_bf16 v[108:111], v[244:247], v[164:167], v[108:111]
    ds_read_b64_tr_b16 v[240:241], v20 offset:16384
    v_mfma_f32_16x16x32_bf16 v[112:115], v[244:247], v[168:171], v[112:115]
    ds_read_b64_tr_b16 v[242:243], v20 offset:17408
    s_waitcnt lgkmcnt(6)
    v_mfma_f32_16x16x32_bf16 v[116:119], v[228:231], v[164:167], v[116:119]
    ds_read_b64_tr_b16 v[244:245], v21 offset:16384
    v_mfma_f32_16x16x32_bf16 v[120:123], v[228:231], v[168:171], v[120:123]
    ds_read_b64_tr_b16 v[246:247], v21 offset:17408
    s_waitcnt lgkmcnt(6)
    s_waitcnt vmcnt(4)
    v_mfma_f32_16x16x32_bf16 v[124:127], v[232:235], v[140:143], v[124:127]
    ds_read_b64_tr_b16 v[228:229], v22 offset:20480
    v_mfma_f32_16x16x32_bf16 v[128:131], v[232:235], v[144:147], v[128:131]
    ds_read_b64_tr_b16 v[230:231], v22 offset:21504
    s_xor_b32 s96, s83, 7
    s_lshl_b32 s97, s96, 11
    s_add_u32 s20, s97, s19
    buffer_load_dwordx4 v[164:167], v2, s[32:35], s20 offen sc1
    s_waitcnt lgkmcnt(6)
    v_mfma_f32_16x16x32_bf16 v[132:135], v[236:239], v[140:143], v[132:135]
    ds_read_b64_tr_b16 v[232:233], v23 offset:20480
    v_mfma_f32_16x16x32_bf16 v[136:139], v[236:239], v[144:147], v[136:139]
    ds_read_b64_tr_b16 v[234:235], v23 offset:21504
    buffer_load_dwordx4 v[168:171], v2, s[32:35], s20 offen offset:1024 sc1
    s_waitcnt lgkmcnt(6)
    v_mfma_f32_16x16x32_bf16 v[108:111], v[240:243], v[140:143], v[108:111]
    ds_read_b64_tr_b16 v[236:237], v20 offset:20480
    v_mfma_f32_16x16x32_bf16 v[112:115], v[240:243], v[144:147], v[112:115]
    ds_read_b64_tr_b16 v[238:239], v20 offset:21504
    s_setprio 0
    s_waitcnt lgkmcnt(6)
    v_mfma_f32_16x16x32_bf16 v[116:119], v[244:247], v[140:143], v[116:119]
    ds_read_b64_tr_b16 v[240:241], v21 offset:20480
    v_mfma_f32_16x16x32_bf16 v[120:123], v[244:247], v[144:147], v[120:123]
    ds_read_b64_tr_b16 v[242:243], v21 offset:21504
    s_waitcnt lgkmcnt(6)
    s_waitcnt vmcnt(4)
    v_mfma_f32_16x16x32_bf16 v[124:127], v[228:231], v[148:151], v[124:127]
    ds_read_b64_tr_b16 v[244:245], v22 offset:24576
    v_mfma_f32_16x16x32_bf16 v[128:131], v[228:231], v[152:155], v[128:131]
    ds_read_b64_tr_b16 v[246:247], v22 offset:25600
    s_cmp_eq_u32 s25, s4
    s_cbranch_scc1 L_D2
SPOLL_32:
    s_load_dwordx2 s[24:25], s[32:33], s92 offset:1024 glc
SCHK_33:
    s_add_u32 s5, s5, 1
    s_cmp_ge_u32 s5, 300000
    s_waitcnt lgkmcnt(0)
    s_cbranch_scc1 SDONE_34
    s_cmp_lg_u32 s25, s4
    s_cbranch_scc1 SPOLL_32
SDONE_34:
L_D2:
    s_barrier
    s_xor_b32 s96, s83, 8
    s_lshl_b32 s97, s96, 11
    s_add_u32 s20, s97, s19
    buffer_load_dwordx4 v[140:143], v2, s[32:35], s20 offen sc1
    s_waitcnt lgkmcnt(6)
    v_mfma_f32_16x16x32_bf16 v[132:135], v[232:235], v[148:151], v[132:135]
    ds_read_b64_tr_b16 v[228:229], v23 offset:24576
    v_mfma_f32_16x16x32_bf16 v[136:139], v[232:235], v[152:155], v[136:139]
    ds_read_b64_tr_b16 v[230:231], v23 offset:25600
    buffer_load_dwordx4 v[144:147], v2, s[32:35], s20 offen offset:1024 sc1
    s_waitcnt lgkmcnt(6)
    v_mfma_f32_16x16x32_bf16 v[108:111], v[236:239], v[148:151], v[108:111]
    ds_read_b64_tr_b16 v[232:233], v20 offset:24576
    v_mfma_f32_16x16x32_bf16 v[112:115], v[236:239], v[152:155], v[112:115]
    ds_read_b64_tr_b16 v[234:235], v20 offset:25600
    s_waitcnt lgkmcnt(6)
    v_mfma_f32_16x16x32_bf16 v[116:119], v[240:243], v[148:151], v[116:119]
    ds_read_b64_tr_b16 v[236:237], v21 offset:24576
    v_mfma_f32_16x16x32_bf16 v[120:123], v[240:243], v[152:155], v[120:123]
    ds_read_b64_tr_b16 v[238:239], v21 offset:25600
    s_waitcnt lgkmcnt(6)
    s_waitcnt vmcnt(4)
    v_mfma_f32_16x16x32_bf16 v[124:127], v[244:247], v[156:159], v[124:127]
    ds_read_b64_tr_b16 v[240:241], v22 offset:28672
    v_mfma_f32_16x16x32_bf16 v[128:131], v[244:247], v[160:163], v[128:131]
    ds_read_b64_tr_b16 v[242:243], v22 offset:29696
    s_xor_b32 s96, s83, 9
    s_lshl_b32 s97, s96, 11
    s_add_u32 s20, s97, s19
    buffer_load_dwordx4 v[148:151], v2, s[32:35], s20 offen sc1
    s_waitcnt lgkmcnt(6)
    v_mfma_f32_16x16x32_bf16 v[132:135], v[228:231], v[156:159], v[132:135]
    ds_read_b64_tr_b16 v[244:245], v23 offset:28672
    v_mfma_f32_16x16x32_bf16 v[136:139], v[228:231], v[160:163], v[136:139]
    ds_read_b64_tr_b16 v[246:247], v23 offset:29696
    buffer_load_dwordx4 v[152:155], v2, s[32:35], s20 offen offset:1024 sc1
    s_waitcnt lgkmcnt(6)
    v_mfma_f32_16x16x32_bf16 v[108:111], v[232:235], v[156:159], v[108:111]
    ds_read_b64_tr_b16 v[228:229], v20 offset:28672
    v_mfma_f32_16x16x32_bf16 v[112:115], v[232:235], v[160:163], v[112:115]
    ds_read_b64_tr_b16 v[230:231], v20 offset:29696
    s_waitcnt lgkmcnt(6)
    v_mfma_f32_16x16x32_bf16 v[116:119], v[236:239], v[156:159], v[116:119]
    ds_read_b64_tr_b16 v[232:233], v21 offset:28672
    v_mfma_f32_16x16x32_bf16 v[120:123], v[236:239], v[160:163], v[120:123]
    ds_read_b64_tr_b16 v[234:235], v21 offset:29696
    s_waitcnt lgkmcnt(6)
    s_waitcnt vmcnt(4)
    v_mfma_f32_16x16x32_bf16 v[124:127], v[240:243], v[164:167], v[124:127]
    ds_read_b64_tr_b16 v[236:237], v22 offset:32768
    v_mfma_f32_16x16x32_bf16 v[128:131], v[240:243], v[168:171], v[128:131]
    ds_read_b64_tr_b16 v[238:239], v22 offset:33792
    s_xor_b32 s96, s83, 10
    s_lshl_b32 s97, s96, 11
    s_add_u32 s20, s97, s19
    buffer_load_dwordx4 v[156:159], v2, s[32:35], s20 offen sc1
    s_waitcnt lgkmcnt(6)
    v_mfma_f32_16x16x32_bf16 v[132:135], v[244:247], v[164:167], v[132:135]
    ds_read_b64_tr_b16 v[240:241], v23 offset:32768
    v_mfma_f32_16x16x32_bf16 v[136:139], v[244:247], v[168:171], v[136:139]
    ds_read_b64_tr_b16 v[242:243], v23 offset:33792
    buffer_load_dwordx4 v[160:163], v2, s[32:35], s20 offen offset:1024 sc1
    s_waitcnt lgkmcnt(6)
    v_mfma_f32_16x16x32_bf16 v[108:111], v[228:231], v[164:167], v[108:111]
    ds_read_b64_tr_b16 v[244:245], v20 offset:32768
    v_mfma_f32_16x16x32_bf16 v[112:115], v[228:231], v[168:171], v[112:115]
    ds_read_b64_tr_b16 v[246:247], v20 offset:33792
    s_waitcnt lgkmcnt(6)
    v_mfma_f32_16x16x32_bf16 v[116:119], v[232:235], v[164:167], v[116:119]
    ds_read_b64_tr_b16 v[228:229], v21 offset:32768
    v_mfma_f32_16x16x32_bf16 v[120:123], v[232:235], v[168:171], v[120:123]
    ds_read_b64_tr_b16 v[230:231], v21 offset:33792
    s_waitcnt lgkmcnt(6)
    s_waitcnt vmcnt(4)
    v_mfma_f32_16x16x32_bf16 v[124:127], v[236:239], v[140:143], v[124:127]
    ds_read_b64_tr_b16 v[232:233], v22 offset:36864
    v_mfma_f32_16x16x32_bf16 v[128:131], v[236:239], v[144:147], v[128:131]
    ds_read_b64_tr_b16 v[234:235], v22 offset:37888
    s_xor_b32 s96, s83, 11
    s_lshl_b32 s97, s96, 11
    s_add_u32 s20, s97, s19
    buffer_load_dwordx4 v[164:167], v2, s[32:35], s20 offen sc1
    s_waitcnt lgkmcnt(6)
    v_mfma_f32_16x16x32_bf16 v[132:135], v[240:243], v[140:143], v[132:135]
    ds_read_b64_tr_b16 v[236:237], v23 offset:36864
    v_mfma_f32_16x16x32_bf16 v[136:139], v[240:243], v[144:147], v[136:139]
    ds_read_b64_tr_b16 v[238:239], v23 offset:37888
    buffer_load_dwordx4 v[168:171], v2, s[32:35], s20 offen offset:1024 sc1
    s_waitcnt lgkmcnt(6)
    v_mfma_f32_16x16x32_bf16 v[108:111], v[244:247], v[140:143], v[108:111]
    ds_read_b64_tr_b16 v[240:241], v20 offset:36864
    v_mfma_f32_16x16x32_bf16 v[112:115], v[244:247], v[144:147], v[112:115]
    ds_read_b64_tr_b16 v[242:243], v20 offset:37888
    s_waitcnt lgkmcnt(6)
    v_mfma_f32_16x16x32_bf16 v[116:119], v[228:231], v[140:143], v[116:119]
    ds_read_b64_tr_b16 v[244:245], v21 offset:36864
    v_mfma_f32_16x16x32_bf16 v[120:123], v[228:231], v[144:147], v[120:123]
    ds_read_b64_tr_b16 v[246:247], v21 offset:37888
    s_waitcnt lgkmcnt(6)
    s_waitcnt vmcnt(4)
    v_mfma_f32_16x16x32_bf16 v[124:127], v[232:235], v[148:151], v[124:127]
    ds_read_b64_tr_b16 v[228:229], v22 offset:40960
    v_mfma_f32_16x16x32_bf16 v[128:131], v[232:235], v[152:155], v[128:131]
    ds_read_b64_tr_b16 v[230:231], v22 offset:41984
    s_xor_b32 s96, s83, 12
    s_lshl_b32 s97, s96, 11
    s_add_u32 s20, s97, s19
    buffer_load_dwordx4 v[140:143], v2, s[32:35], s20 offen sc1
    s_waitcnt lgkmcnt(6)
    v_mfma_f32_16x16x32_bf16 v[132:135], v[236:239], v[148:151], v[132:135]
    ds_read_b64_tr_b16 v[232:233], v23 offset:40960
    v_mfma_f32_16x16x32_bf16 v[136:139], v[236:239], v[152:155], v[136:139]
    ds_read_b64_tr_b16 v[234:235], v23 offset:41984
    buffer_load_dwordx4 v[144:147], v2, s[32:35], s20 offen offset:1024 sc1
    s_waitcnt lgkmcnt(6)
    v_mfma_f32_16x16x32_bf16 v[108:111], v[240:243], v[148:151], v[108:111]
    ds_read_b64_tr_b16 v[236:237], v20 offset:40960
    v_mfma_f32_16x16x32_bf16 v[112:115], v[240:243], v[152:155], v[112:115]
    ds_read_b64_tr_b16 v[238:239], v20 offset:41984
    s_waitcnt lgkmcnt(6)
    v_mfma_f32_16x16x32_bf16 v[116:119], v[244:247], v[148:151], v[116:119]
    ds_read_b64_tr_b16 v[240:241], v21 offset:40960
    v_mfma_f32_16x16x32_bf16 v[120:123], v[244:247], v[152:155], v[120:123]
    ds_read_b64_tr_b16 v[242:243], v21 offset:41984
    s_waitcnt lgkmcnt(6)
    s_waitcnt vmcnt(4)
    v_mfma_f32_16x16x32_bf16 v[124:127], v[228:231], v[156:159], v[124:127]
    ds_read_b64_tr_b16 v[244:245], v22 offset:45056
    v_mfma_f32_16x16x32_bf16 v[128:131], v[228:231], v[160:163], v[128:131]
    ds_read_b64_tr_b16 v[246:247], v22 offset:46080
    s_xor_b32 s96, s83, 13
    s_lshl_b32 s97, s96, 11
    s_add_u32 s20, s97, s19
    buffer_load_dwordx4 v[148:151], v2, s[32:35], s20 offen sc1
    s_waitcnt lgkmcnt(6)
    v_mfma_f32_16x16x32_bf16 v[132:135], v[232:235], v[156:159], v[132:135]
    ds_read_b64_tr_b16 v[228:229], v23 offset:45056
    v_mfma_f32_16x16x32_bf16 v[136:139], v[232:235], v[160:163], v[136:139]
    ds_read_b64_tr_b16 v[230:231], v23 offset:46080
    buffer_load_dwordx4 v[152:155], v2, s[32:35], s20 offen offset:1024 sc1
    s_waitcnt lgkmcnt(6)
    v_mfma_f32_16x16x32_bf16 v[108:111], v[236:239], v[156:159], v[108:111]
    ds_read_b64_tr_b16 v[232:233], v20 offset:45056
    v_mfma_f32_16x16x32_bf16 v[112:115], v[236:239], v[160:163], v[112:115]
    ds_read_b64_tr_b16 v[234:235], v20 offset:46080
    s_waitcnt lgkmcnt(6)
    v_mfma_f32_16x16x32_bf16 v[116:119], v[240:243], v[156:159], v[116:119]
    ds_read_b64_tr_b16 v[236:237], v21 offset:45056
    v_mfma_f32_16x16x32_bf16 v[120:123], v[240:243], v[160:163], v[120:123]
    ds_read_b64_tr_b16 v[238:239], v21 offset:46080
    s_waitcnt lgkmcnt(6)
    s_waitcnt vmcnt(4)
    v_mfma_f32_16x16x32_bf16 v[124:127], v[244:247], v[164:167], v[124:127]
    ds_read_b64_tr_b16 v[240:241], v22 offset:49152
    v_mfma_f32_16x16x32_bf16 v[128:131], v[244:247], v[168:171], v[128:131]
    ds_read_b64_tr_b16 v[242:243], v22 offset:50176
    s_xor_b32 s96, s83, 14
    s_lshl_b32 s97, s96, 11
    s_add_u32 s20, s97, s19
    buffer_load_dwordx4 v[156:159], v2, s[32:35], s20 offen sc1
    s_waitcnt lgkmcnt(6)
    v_mfma_f32_16x16x32_bf16 v[132:135], v[228:231], v[164:167], v[132:135]
    ds_read_b64_tr_b16 v[244:245], v23 offset:49152
    v_mfma_f32_16x16x32_bf16 v[136:139], v[228:231], v[168:171], v[136:139]
    ds_read_b64_tr_b16 v[246:247], v23 offset:50176
    buffer_load_dwordx4 v[160:163], v2, s[32:35], s20 offen offset:1024 sc1
    s_waitcnt lgkmcnt(6)
    v_mfma_f32_16x16x32_bf16 v[108:111], v[232:235], v[164:167], v[108:111]
    ds_read_b64_tr_b16 v[228:229], v20 offset:49152
    v_mfma_f32_16x16x32_bf16 v[112:115], v[232:235], v[168:171], v[112:115]
    ds_read_b64_tr_b16 v[230:231], v20 offset:50176
    s_waitcnt lgkmcnt(6)
    v_mfma_f32_16x16x32_bf16 v[116:119], v[236:239], v[164:167], v[116:119]
    ds_read_b64_tr_b16 v[232:233], v21 offset:49152
    v_mfma_f32_16x16x32_bf16 v[120:123], v[236:239], v[168:171], v[120:123]
    ds_read_b64_tr_b16 v[234:235], v21 offset:50176
    s_waitcnt lgkmcnt(6)
    s_waitcnt vmcnt(4)
    v_mfma_f32_16x16x32_bf16 v[124:127], v[240:243], v[140:143], v[124:127]
    ds_read_b64_tr_b16 v[236:237], v22 offset:53248
    v_mfma_f32_16x16x32_bf16 v[128:131], v[240:243], v[144:147], v[128:131]
    ds_read_b64_tr_b16 v[238:239], v22 offset:54272
    s_xor_b32 s96, s83, 15
    s_lshl_b32 s97, s96, 11
    s_add_u32 s20, s97, s19
    buffer_load_dwordx4 v[164:167], v2, s[32:35], s20 offen sc1
    s_waitcnt lgkmcnt(6)
    v_mfma_f32_16x16x32_bf16 v[132:135], v[244:247], v[140:143], v[132:135]
    ds_read_b64_tr_b16 v[240:241], v23 offset:53248
    v_mfma_f32_16x16x32_bf16 v[136:139], v[244:247], v[144:147], v[136:139]
    ds_read_b64_tr_b16 v[242:243], v23 offset:54272
    buffer_load_dwordx4 v[168:171], v2, s[32:35], s20 offen offset:1024 sc1
    buffer_load_dwordx2 v[26:27], v25, s[32:35], s18 offen sc1
    s_waitcnt lgkmcnt(6)
    v_mfma_f32_16x16x32_bf16 v[108:111], v[228:231], v[140:143], v[108:111]
    ds_read_b64_tr_b16 v[244:245], v20 offset:53248
    v_mfma_f32_16x16x32_bf16 v[112:115], v[228:231], v[144:147], v[112:115]
    ds_read_b64_tr_b16 v[246:247], v20 offset:54272
    s_waitcnt lgkmcnt(6)
    v_mfma_f32_16x16x32_bf16 v[116:119], v[232:235], v[140:143], v[116:119]
    ds_read_b64_tr_b16 v[228:229], v21 offset:53248
    v_mfma_f32_16x16x32_bf16 v[120:123], v[232:235], v[144:147], v[120:123]
    ds_read_b64_tr_b16 v[230:231], v21 offset:54272
    s_waitcnt lgkmcnt(6)
    s_waitcnt vmcnt(5)
    v_mfma_f32_16x16x32_bf16 v[124:127], v[236:239], v[148:151], v[124:127]
    ds_read_b64_tr_b16 v[232:233], v22 offset:57344
    v_mfma_f32_16x16x32_bf16 v[128:131], v[236:239], v[152:155], v[128:131]
    ds_read_b64_tr_b16 v[234:235], v22 offset:58368
    s_waitcnt lgkmcnt(6)
    v_mfma_f32_16x16x32_bf16 v[132:135], v[240:243], v[148:151], v[132:135]
    ds_read_b64_tr_b16 v[236:237], v23 offset:57344
    v_mfma_f32_16x16x32_bf16 v[136:139], v[240:243], v[152:155], v[136:139]
    ds_read_b64_tr_b16 v[238:239], v23 offset:58368
    s_waitcnt lgkmcnt(6)
    v_mfma_f32_16x16x32_bf16 v[108:111], v[244:247], v[148:151], v[108:111]
    ds_read_b64_tr_b16 v[240:241], v20 offset:57344
    v_mfma_f32_16x16x32_bf16 v[112:115], v[244:247], v[152:155], v[112:115]
    ds_read_b64_tr_b16 v[242:243], v20 offset:58368
    s_waitcnt lgkmcnt(6)
    v_mfma_f32_16x16x32_bf16 v[116:119], v[228:231], v[148:151], v[116:119]
    ds_read_b64_tr_b16 v[244:245], v21 offset:57344
    v_mfma_f32_16x16x32_bf16 v[120:123], v[228:231], v[152:155], v[120:123]
    ds_read_b64_tr_b16 v[246:247], v21 offset:58368
    s_waitcnt lgkmcnt(6)
    s_waitcnt vmcnt(3)
    v_mfma_f32_16x16x32_bf16 v[124:127], v[232:235], v[156:159], v[124:127]
    ds_read_b64_tr_b16 v[228:229], v22 offset:61440
    v_mfma_f32_16x16x32_bf16 v[128:131], v[232:235], v[160:163], v[128:131]
    ds_read_b64_tr_b16 v[230:231], v22 offset:62464
    s_waitcnt lgkmcnt(6)
    v_mfma_f32_16x16x32_bf16 v[132:135], v[236:239], v[156:159], v[132:135]
    ds_read_b64_tr_b16 v[232:233], v23 offset:61440
    v_mfma_f32_16x16x32_bf16 v[136:139], v[236:239], v[160:163], v[136:139]
    ds_read_b64_tr_b16 v[234:235], v23 offset:62464
    s_waitcnt lgkmcnt(6)
    v_mfma_f32_16x16x32_bf16 v[108:111], v[240:243], v[156:159], v[108:111]
    ds_read_b64_tr_b16 v[236:237], v20 offset:61440
    v_mfma_f32_16x16x32_bf16 v[112:115], v[240:243], v[160:163], v[112:115]
    ds_read_b64_tr_b16 v[238:239], v20 offset:62464
    s_waitcnt lgkmcnt(6)
    v_mfma_f32_16x16x32_bf16 v[116:119], v[244:247], v[156:159], v[116:119]
    ds_read_b64_tr_b16 v[240:241], v21 offset:61440
    v_mfma_f32_16x16x32_bf16 v[120:123], v[244:247], v[160:163], v[120:123]
    ds_read_b64_tr_b16 v[242:243], v21 offset:62464
    s_waitcnt lgkmcnt(6)
    s_waitcnt vmcnt(1)
    v_mfma_f32_16x16x32_bf16 v[124:127], v[228:231], v[164:167], v[124:127]
    v_mfma_f32_16x16x32_bf16 v[128:131], v[228:231], v[168:171], v[128:131]
    s_waitcnt lgkmcnt(4)
    v_mfma_f32_16x16x32_bf16 v[132:135], v[232:235], v[164:167], v[132:135]
    v_mfma_f32_16x16x32_bf16 v[136:139], v[232:235], v[168:171], v[136:139]
    s_waitcnt lgkmcnt(2)
    v_mfma_f32_16x16x32_bf16 v[108:111], v[236:239], v[164:167], v[108:111]
    v_mfma_f32_16x16x32_bf16 v[112:115], v[236:239], v[168:171], v[112:115]
    s_waitcnt lgkmcnt(0)
    v_mfma_f32_16x16x32_bf16 v[116:119], v[240:243], v[164:167], v[116:119]
    v_mfma_f32_16x16x32_bf16 v[120:123], v[240:243], v[168:171], v[120:123]
    s_setprio 0
    s_lshl_b32 s13, s3, 12
    v_add_u32 v4, s13, v2
    ds_write_b128 v4, v[124:127]
    ds_write_b128 v4, v[128:131] offset:1024
    ds_write_b128 v4, v[132:135] offset:2048
    ds_write_b128 v4, v[136:139] offset:3072
    v_permlane16_swap_b32 v108, v112
    v_permlane16_swap_b32 v109, v113
    v_permlane16_swap_b32 v110, v114
    v_permlane16_swap_b32 v111, v115
    v_permlane16_swap_b32 v116, v120
    v_permlane16_swap_b32 v117, v121
    v_permlane16_swap_b32 v118, v122
    v_permlane16_swap_b32 v119, v123
    s_xor_b32 s96, s3, 4
    s_lshl_b32 s13, s96, 12
    v_and_b32 v5, 15, v1
    v_lshl_add_u32 v5, v5, 4, s13
    v_bfe_u32 v9, v1, 4, 1
    v_lshl_add_u32 v5, v9, 10, v5
    v_lshrrev_b32 v9, 5, v1
    v_lshl_add_u32 v5, v9, 9, v5
    s_lshl_b32 s96, s76, 11
    s_and_b32 s97, s3, 3
    s_lshl_b32 s98, s97, 9
    s_add_u32 s99, s96, s98
    s_add_u32 s13, s99, 131072
    v_and_b32 v6, 31, v1
    v_lshl_add_u32 v6, v6, 4, s13
    v_lshrrev_b32 v9, 5, v1
    v_lshl_add_u32 v6, v9, 3, v6
    s_lshl_b32 s96, s76, 6
    s_add_u32 s13, s96, 139008
    v_and_b32 v7, 7, v1
    v_lshl_add_u32 v7, v7, 2, s13
    v_lshrrev_b32 v9, 5, v1
    v_lshl_add_u32 v7, v9, 5, v7
    s_lshl_b32 s96, s21, 15
    s_lshl_b32 s97, s3, 8
    s_add_u32 s98, s96, s97
    s_add_u32 s19, s98, 12582912
    v_and_b32 v44, 15, v1
    v_lshlrev_b32 v44, 4, v44
    v_lshrrev_b32 v9, 4, v1
    v_lshl_add_u32 v44, v9, 11, v44
    v_mov_b32 v232, 0x3f803f80
    s_waitcnt lgkmcnt(0)
    s_barrier
    ds_read_b128 v[124:127], v5
    ds_read_b128 v[128:131], v5 offset:256
    ds_read_b128 v[132:135], v5 offset:2048
    ds_read_b128 v[136:139], v5 offset:2304
    s_add_u32 s14, s80, 114688
    s_lshl2_add_u32 m0, s89, 67584
    s_nop 0
    buffer_load_dwordx4 v72, s[56:59], s14 offen nt lds
    s_add_u32 s14, s80, 172032
    s_lshl2_add_u32 m0, s89, 68608
    s_nop 0
    buffer_load_dwordx4 v72, s[56:59], s14 offen nt lds
    s_mov_b32 s14, s81
    s_lshl2_add_u32 m0, s89, 98304
    s_nop 0
    buffer_load_dwordx4 v73, s[60:63], s14 offen nt lds
    s_waitcnt lgkmcnt(3)
    v_pk_add_f32 v[108:109], v[108:109], v[124:125]
    v_pk_add_f32 v[110:111], v[110:111], v[126:127]
    s_waitcnt lgkmcnt(2)
    v_pk_add_f32 v[112:113], v[112:113], v[128:129]
    v_pk_add_f32 v[114:115], v[114:115], v[130:131]
    v_cvt_pk_bf16_f32 v108, 0, v108
    v_cvt_pk_bf16_f32 v109, 0, v109
    v_cvt_pk_bf16_f32 v110, 0, v110
    v_cvt_pk_bf16_f32 v111, 0, v111
    v_cvt_pk_bf16_f32 v112, 0, v112
    v_cvt_pk_bf16_f32 v113, 0, v113
    v_cvt_pk_bf16_f32 v114, 0, v114
    v_cvt_pk_bf16_f32 v115, 0, v115
    v_pk_mul_f32 v[108:109], v[108:109], v[76:77]
    v_pk_mul_f32 v[110:111], v[110:111], v[78:79]
    v_pk_mul_f32 v[112:113], v[112:113], v[80:81]
    v_pk_mul_f32 v[114:115], v[114:115], v[82:83]
    v_cvt_pk_bf16_f32 v108, 0, v108
    v_cvt_pk_bf16_f32 v109, 0, v109
    v_cvt_pk_bf16_f32 v110, 0, v110
    v_cvt_pk_bf16_f32 v111, 0, v111
    v_cvt_pk_bf16_f32 v112, 0, v112
    v_cvt_pk_bf16_f32 v113, 0, v113
    v_cvt_pk_bf16_f32 v114, 0, v114
    v_cvt_pk_bf16_f32 v115, 0, v115
    v_pk_add_f32 v[108:109], v[108:109], v[28:29]
    v_pk_add_f32 v[110:111], v[110:111], v[30:31]
    v_pk_add_f32 v[112:113], v[112:113], v[32:33]
    v_pk_add_f32 v[114:115], v[114:115], v[34:35]
    v_cvt_pk_bf16_f32 v12, v108, v109
    v_cvt_pk_bf16_f32 v13, v110, v111
    v_cvt_pk_bf16_f32 v14, v112, v113
    v_cvt_pk_bf16_f32 v15, v114, v115
    s_waitcnt lgkmcnt(1)
    v_pk_add_f32 v[116:117], v[116:117], v[132:133]
    v_pk_add_f32 v[118:119], v[118:119], v[134:135]
    s_waitcnt lgkmcnt(0)
    v_pk_add_f32 v[120:121], v[120:121], v[136:137]
    v_pk_add_f32 v[122:123], v[122:123], v[138:139]
    v_cvt_pk_bf16_f32 v116, 0, v116
    v_cvt_pk_bf16_f32 v117, 0, v117
    v_cvt_pk_bf16_f32 v118, 0, v118
    v_cvt_pk_bf16_f32 v119, 0, v119
    v_cvt_pk_bf16_f32 v120, 0, v120
    v_cvt_pk_bf16_f32 v121, 0, v121
    v_cvt_pk_bf16_f32 v122, 0, v122
    v_cvt_pk_bf16_f32 v123, 0, v123
    v_pk_mul_f32 v[116:117], v[116:117], v[84:85]
    v_pk_mul_f32 v[118:119], v[118:119], v[86:87]
    v_pk_mul_f32 v[120:121], v[120:121], v[88:89]
    v_pk_mul_f32 v[122:123], v[122:123], v[90:91]
    v_cvt_pk_bf16_f32 v116, 0, v116
    v_cvt_pk_bf16_f32 v117, 0, v117
    v_cvt_pk_bf16_f32 v118, 0, v118
    v_cvt_pk_bf16_f32 v119, 0, v119
    v_cvt_pk_bf16_f32 v120, 0, v120
    v_cvt_pk_bf16_f32 v121, 0, v121
    v_cvt_pk_bf16_f32 v122, 0, v122
    v_cvt_pk_bf16_f32 v123, 0, v123
    v_pk_add_f32 v[116:117], v[116:117], v[36:37]
    v_pk_add_f32 v[118:119], v[118:119], v[38:39]
    v_pk_add_f32 v[120:121], v[120:121], v[40:41]
    v_pk_add_f32 v[122:123], v[122:123], v[42:43]
    v_cvt_pk_bf16_f32 v16, v116, v117
    v_cvt_pk_bf16_f32 v17, v118, v119
    v_cvt_pk_bf16_f32 v18, v120, v121
    v_cvt_pk_bf16_f32 v19, v122, v123
    v_mfma_f32_32x32x16_bf16 v[124:139], v[92:95], v[12:15], 0
    s_nop 0
    v_mfma_f32_32x32x16_bf16 v[124:139], v[96:99], v[16:19], v[124:139]
    v_dot2_f32_bf16 v228, v12, v12, 0
    v_dot2_f32_bf16 v229, v13, v13, 0
    v_dot2_f32_bf16 v228, v14, v14, v228
    v_dot2_f32_bf16 v229, v15, v15, v229
    v_dot2_f32_bf16 v228, v16, v16, v228
    v_dot2_f32_bf16 v229, v17, v17, v229
    v_dot2_f32_bf16 v228, v18, v18, v228
    v_dot2_f32_bf16 v229, v19, v19, v229
    s_nop 2
    v_add_f32 v230, v228, v229
    v_add_f32 v228, v228, v229
    s_nop 1
    v_permlane32_swap_b32 v228, v230
    s_mov_b32 exec_lo, 0
    v_add_f32 v124, v228, v230
    v_mov_b32 v125, v126
    s_mov_b32 exec_lo, -1
    ds_write_b64 v6, v[124:125]
    ds_write_b32 v7, v68
    ds_write_b32 v7, v69 offset:128
    ds_write_b32 v7, v70 offset:256
    ds_write_b32 v7, v71 offset:384
    v_add_u32 v4, 131072, v2
    v_and_b32 v5, 7, v1
    v_lshlrev_b32 v5, 15, v5
    v_bfe_u32 v9, v1, 3, 1
    v_lshl_add_u32 v5, v9, 12, v5
    s_lshl4_add_u32 s96, s21, s12
    s_lshl_b32 s97, s96, 11
    s_add_u32 s13, s97, 12582912
    s_and_b32 s96, s12, 1
    s_lshr_b32 s97, s21, 2
    s_and_b32 s98, s21, 3
    s_lshl_b32 s99, s98, 6
    s_lshl1_add_u32 s98, s97, s99
    s_lshl_b32 s97, s98, 12
    s_lshr_b32 s99, s12, 1
    s_lshl_b32 s98, s99, 6
    s_add_u32 s99, s97, s98
    s_lshl2_add_u32 s97, s96, s99
    s_add_u32 s98, s97, 1048576
    s_add_u32 s16, s98, 1536
    s_waitcnt lgkmcnt(0)
    s_barrier
    s_cmp_lg_u32 s3, 0
    s_cbranch_scc1 L_PE
    ds_read_b128 v[124:127], v4 offset:0
    ds_read_b128 v[128:131], v4 offset:2048
    ds_read_b128 v[132:135], v4 offset:1024
    ds_read_b128 v[136:139], v4 offset:3072
    s_waitcnt lgkmcnt(2)
    v_pk_add_f32 v[124:125], v[124:125], v[128:129]
    v_pk_add_f32 v[126:127], v[126:127], v[130:131]
    v_add_f32 v125, v125, v127
    v_mov_b32 v127, s4
    s_waitcnt lgkmcnt(0)
    v_pk_add_f32 v[132:133], v[132:133], v[136:137]
    v_pk_add_f32 v[134:135], v[134:135], v[138:139]
    v_add_f32 v133, v133, v135
    v_mov_b32 v135, s4
    buffer_store_dwordx4 v[124:127], v2, s[32:35], s13 offen sc1
    buffer_store_dwordx4 v[132:135], v2, s[32:35], s13 offen offset:1024 sc1
    s_mov_b64 exec, 0xffff
    buffer_store_dword v127, v5, s[32:35], s16 offen sc1
    s_mov_b64 exec, -1
L_PE:
    s_load_dwordx2 s[24:25], s[32:33], s92 offset:1536 glc
    s_and_b32 s96, s3, 3
    s_mul_i32 s97, s96, 4608
    s_lshl_b32 s98, s76, 6
    s_add_u32 s16, s97, s98
    v_and_b32 v23, 31, v1
    v_mul_u32_u24 v23, 144, v23
    v_lshrrev_b32 v9, 5, v1
    v_lshl_add_u32 v23, v9, 5, v23
    v_add_u32 v23, s16, v23
    ds_write_b128 v23, v[12:15]
    ds_write_b128 v23, v[16:19] offset:16
    v_add_u32 v23, 139776, v23
    s_lshl3_add_u32 s96, s21, s3
    s_lshl_b32 s97, s96, 5
    s_sub_u32 s15, 4094, s97
    v_and_b32 v22, 15, v1
    v_lshlrev_b32 v22, 1, v22
    v_sub_u32 v22, s15, v22
    s_lshl_b32 s96, s3, 7
    s_add_u32 s15, s96, 135168
    v_and_b32 v8, 15, v1
    v_lshl_add_u32 v8, v8, 3, s15
    s_and_b32 s96, s3, 3
    s_lshl_b32 s97, s96, 8
    s_add_u32 s15, s97, 135168
    v_and_b32 v10, 31, v1
    v_lshl_add_u32 v10, v10, 3, s15
    v_and_b32 v11, 7, v1
    v_lshlrev_b32 v11, 3, v11
    v_add_u32 v11, 136192, v11
    s_waitcnt vmcnt(3)
    v_cmp_ne_u32 vcc, s4, v27
    s_cbranch_vccz TOK_38
POLL_39:
    buffer_load_dwordx2 v[26:27], v25, s[32:35], s18 offen sc1
    s_waitcnt vmcnt(0)
    v_cmp_ne_u32 vcc, s4, v27
    s_cbranch_vccz PDONE_40
    s_add_u32 s5, s5, 1
    s_cmp_lt_u32 s5, 300000
    s_cbranch_scc1 POLL_39
PDONE_40:
TOK_38:
    v_add_f32_dpp v26, v26, v26 quad_perm:[1,0,3,2] row_mask:0xf bank_mask:0xf
    s_nop 1
    v_add_f32_dpp v26, v26, v26 quad_perm:[2,3,0,1] row_mask:0xf bank_mask:0xf
    s_nop 1
    v_add_f32_dpp v26, v26, v26 row_half_mirror row_mask:0xf bank_mask:0xf
    s_nop 1
    v_add_f32_dpp v26, v26, v26 row_ror:8 row_mask:0xf bank_mask:0xf
    s_cmp_lg_u32 s3, 1
    s_cbranch_scc1 L_NOCT
    v_and_b32 v5, 15, v1
    v_lshlrev_b32 v5, 3, v5
    v_add_u32 v5, 139008, v5
    ds_read_b64 v[150:151], v5
    ds_read_b64 v[154:155], v5 offset:128
    ds_read_b64 v[156:157], v5 offset:384
    s_waitcnt lgkmcnt(0)
    v_lshlrev_b32 v148, 16, v150
    v_and_b32 v149, s6, v150
    v_lshlrev_b32 v150, 16, v151
    v_and_b32 v151, s6, v151
    v_lshlrev_b32 v152, 16, v154
    v_and_b32 v153, s6, v154
    v_lshlrev_b32 v154, 16, v155
    v_and_b32 v155, s6, v155
L_NOCT:
    s_cmp_lt_u32 s3, 4
    s_cbranch_scc1 L_NOST
    s_sub_u32 s96, s3, 4
    s_lshl_b32 s97, s96, 12
    s_add_u32 s13, s97, 32768
    v_add_u32 v4, s13, v2
    v_add_u32 v7, 65536, v4
    ds_write_b128 v4, v[176:179] offset:16384
    ds_write_b128 v4, v[180:183]
    ds_write_b128 v4, v[184:187] offset:17408
    ds_write_b128 v4, v[188:191] offset:1024
    ds_write_b128 v4, v[192:195] offset:18432
    ds_write_b128 v4, v[196:199] offset:2048
    ds_write_b128 v4, v[200:203] offset:19456
    ds_write_b128 v4, v[204:207] offset:3072
    ds_write_b128 v4, v[208:211] offset:49152
    ds_write_b128 v4, v[212:215] offset:32768
    ds_write_b128 v4, v[216:219] offset:50176
    ds_write_b128 v4, v[220:223] offset:33792
L_NOST:
    s_branch SCHK_36
SPOLL_35:
    s_load_dwordx2 s[24:25], s[32:33], s92 offset:1536 glc
SCHK_36:
    s_add_u32 s5, s5, 1
    s_cmp_ge_u32 s5, 300000
    s_waitcnt lgkmcnt(0)
    s_cbranch_scc1 SDONE_37
    s_cmp_lg_u32 s24, s4
    s_cbranch_scc1 SPOLL_35
    s_cmp_lg_u32 s25, s4
    s_cbranch_scc1 SPOLL_35
SDONE_37:
    s_barrier
    s_mov_b32 s13, s19
    buffer_load_dwordx4 v[124:127], v44, s[32:35], s13 offen sc1
    s_add_u32 s13, s19, 8192
    buffer_load_dwordx4 v[128:131], v44, s[32:35], s13 offen sc1
    s_add_u32 s13, s19, 16384
    buffer_load_dwordx4 v[132:135], v44, s[32:35], s13 offen sc1
    s_add_u32 s13, s19, 24576
    buffer_load_dwordx4 v[136:139], v44, s[32:35], s13 offen sc1
    v_lshlrev_b32 v28, 16, v12
    v_and_b32 v29, s6, v12
    v_lshlrev_b32 v30, 16, v13
    v_and_b32 v31, s6, v13
    v_lshlrev_b32 v32, 16, v14
    v_and_b32 v33, s6, v14
    v_lshlrev_b32 v34, 16, v15
    v_and_b32 v35, s6, v15
    v_lshlrev_b32 v36, 16, v16
    v_and_b32 v37, s6, v16
    v_lshlrev_b32 v38, 16, v17
    v_and_b32 v39, s6, v17
    v_lshlrev_b32 v40, 16, v18
    v_and_b32 v41, s6, v18
    v_lshlrev_b32 v42, 16, v19
    v_and_b32 v43, s6, v19
    v_mul_u32_u24_dpp v92, v68, v52 row_newbcast:0 row_mask:0xf bank_mask:0xf
    v_and_b32_dpp v93, v68, v53 row_newbcast:0 row_mask:0xf bank_mask:0xf
    v_mul_u32_u24_dpp v94, v68, v52 row_newbcast:1 row_mask:0xf bank_mask:0xf
    v_and_b32_dpp v95, v68, v53 row_newbcast:1 row_mask:0xf bank_mask:0xf
    v_mul_u32_u24_dpp v96, v68, v52 row_newbcast:2 row_mask:0xf bank_mask:0xf
    v_and_b32_dpp v97, v68, v53 row_newbcast:2 row_mask:0xf bank_mask:0xf
    v_mul_u32_u24_dpp v98, v68, v52 row_newbcast:3 row_mask:0xf bank_mask:0xf
    v_and_b32_dpp v99, v68, v53 row_newbcast:3 row_mask:0xf bank_mask:0xf
    v_mul_u32_u24_dpp v100, v68, v52 row_newbcast:4 row_mask:0xf bank_mask:0xf
    v_and_b32_dpp v101, v68, v53 row_newbcast:4 row_mask:0xf bank_mask:0xf
    v_mul_u32_u24_dpp v102, v68, v52 row_newbcast:5 row_mask:0xf bank_mask:0xf
    v_and_b32_dpp v103, v68, v53 row_newbcast:5 row_mask:0xf bank_mask:0xf
    v_mul_u32_u24_dpp v104, v68, v52 row_newbcast:6 row_mask:0xf bank_mask:0xf
    v_and_b32_dpp v105, v68, v53 row_newbcast:6 row_mask:0xf bank_mask:0xf
    v_mul_u32_u24_dpp v106, v68, v52 row_newbcast:7 row_mask:0xf bank_mask:0xf
    v_and_b32_dpp v107, v68, v53 row_newbcast:7 row_mask:0xf bank_mask:0xf
    v_mul_u32_u24_dpp v108, v69, v52 row_newbcast:0 row_mask:0xf bank_mask:0xf
    v_and_b32_dpp v109, v69, v53 row_newbcast:0 row_mask:0xf bank_mask:0xf
    v_mul_u32_u24_dpp v110, v69, v52 row_newbcast:1 row_mask:0xf bank_mask:0xf
    v_and_b32_dpp v111, v69, v53 row_newbcast:1 row_mask:0xf bank_mask:0xf
    v_mul_u32_u24_dpp v112, v69, v52 row_newbcast:2 row_mask:0xf bank_mask:0xf
    v_and_b32_dpp v113, v69, v53 row_newbcast:2 row_mask:0xf bank_mask:0xf
    v_mul_u32_u24_dpp v114, v69, v52 row_newbcast:3 row_mask:0xf bank_mask:0xf
    v_and_b32_dpp v115, v69, v53 row_newbcast:3 row_mask:0xf bank_mask:0xf
    v_mul_u32_u24_dpp v116, v69, v52 row_newbcast:4 row_mask:0xf bank_mask:0xf
    v_and_b32_dpp v117, v69, v53 row_newbcast:4 row_mask:0xf bank_mask:0xf
    v_mul_u32_u24_dpp v118, v69, v52 row_newbcast:5 row_mask:0xf bank_mask:0xf
    v_and_b32_dpp v119, v69, v53 row_newbcast:5 row_mask:0xf bank_mask:0xf
    v_mul_u32_u24_dpp v120, v69, v52 row_newbcast:6 row_mask:0xf bank_mask:0xf
    v_and_b32_dpp v121, v69, v53 row_newbcast:6 row_mask:0xf bank_mask:0xf
    v_mul_u32_u24_dpp v122, v69, v52 row_newbcast:7 row_mask:0xf bank_mask:0xf
    v_and_b32_dpp v123, v69, v53 row_newbcast:7 row_mask:0xf bank_mask:0xf
    s_waitcnt vmcnt(0)
    v_bitop3_b32 v4, v127, v131, s4 bitop3:0x7e
    v_bitop3_b32 v4, v4, v135, s4 bitop3:0xf6
    v_bitop3_b32 v4, v4, v139, s4 bitop3:0xf6
    v_cmp_ne_u32 vcc, 0, v4
    s_cbranch_vccz TOK_42
POLL_43:
    s_mov_b32 s13, s19
    buffer_load_dwordx4 v[124:127], v44, s[32:35], s13 offen sc1
    s_add_u32 s13, s19, 8192
    buffer_load_dwordx4 v[128:131], v44, s[32:35], s13 offen sc1
    s_add_u32 s13, s19, 16384
    buffer_load_dwordx4 v[132:135], v44, s[32:35], s13 offen sc1
    s_add_u32 s13, s19, 24576
    buffer_load_dwordx4 v[136:139], v44, s[32:35], s13 offen sc1
    s_waitcnt vmcnt(0)
    v_bitop3_b32 v4, v127, v131, s4 bitop3:0x7e
    v_bitop3_b32 v4, v4, v135, s4 bitop3:0xf6
    v_bitop3_b32 v4, v4, v139, s4 bitop3:0xf6
    v_cmp_ne_u32 vcc, 0, v4
    s_cbranch_vccz PDONE_44
    s_add_u32 s5, s5, 1
    s_cmp_lt_u32 s5, 300000
    s_cbranch_scc1 POLL_43
PDONE_44:
TOK_42:
    s_lshl2_add_u32 s96, s74, s75
    s_lshl_b32 s97, s96, 11
    s_lshl_b32 s98, s3, 8
    s_add_u32 s99, s97, s98
    s_add_u32 s15, s99, 20971520
    v_lshlrev_b32 v44, 7, v1
    s_mov_b64 exec, 3
    buffer_load_dword v44, v44, s[32:35], s15 offen
    s_mov_b64 exec, -1
    s_add_u32 s15, s81, 4096
    s_lshl2_add_u32 m0, s89, 99328
    s_nop 0
    buffer_load_dwordx4 v73, s[60:63], s15 offen nt lds
    v_pk_add_f32 v[124:125], v[124:125], v[128:129]
    v_pk_add_f32 v[132:133], v[132:133], v[136:137]
    v_add_f32 v126, v126, v130
    v_add_f32 v134, v134, v138
    v_pk_add_f32 v[124:125], v[124:125], v[132:133]
    v_add_f32 v126, v126, v134
    v_mov_b32 v127, v125
    s_nop 0
    v_permlane32_swap_b32 v124, v126
    v_permlane32_swap_b32 v125, v127
    v_add_f32 v124, v124, v126
    v_add_f32 v125, v125, v127
    s_nop 1
    v_permlane16_swap_b32 v124, v125
    v_add_f32 v127, v124, v125
    v_add_f32 v124, v124, v125
    s_nop 1
    v_permlane16_swap_b32 v124, v127
    v_mul_f32 v126, 0x3a800000, v124
    v_mul_f32 v124, 0x3a800000, v124
    s_nop 1
    v_permlane32_swap_b32 v124, v126
    v_fma_f32 v21, -v124, v124, v126
    v_cvt_pk_bf16_f32 v20, 0, v124
    v_max_f32 v21, 0, v21
    v_cvt_pk_bf16_f32 v21, 0, v21
    v_add_f32 v21, 0x3727c5ac, v21
    v_cvt_pk_bf16_f32 v21, 0, v21
    v_sqrt_f32 v21, v21
    s_nop 0
    v_cvt_pk_bf16_f32 v21, 0, v21
    s_lshl3_add_u32 s13, s3, 136192
    v_rcp_f32 v21, v21
    v_fma_f32 v127, -v20, v26, v127
    v_mov_b32 v5, s13
    v_mul_f32 v127, v127, v21
    ds_write_b64 v8, v[20:21]
    s_movk_i32 s13, 0xfff
    v_ashrrev_i32 v124, 31, v127
    v_or_b32 v124, 0x80000000, v124
    v_xor_b32 v124, v124, v127
    v_bfi_b32 v48, s13, v22, v124
    s_nop 1
    v_min_u32_dpp v49, v48, v48 row_ror:8 row_mask:0xf bank_mask:0xf
    v_max_u32_dpp v48, v48, v48 row_ror:8 row_mask:0xf bank_mask:0xf
    s_nop 1
    v_min_u32_dpp v50, v48, v48 row_ror:4 row_mask:0xf bank_mask:0xf
    v_max_u32_dpp v49, v49, v49 row_ror:4 row_mask:0xf bank_mask:0xf
    v_max_u32_dpp v48, v48, v48 row_ror:4 row_mask:0xf bank_mask:0xf
    v_max_u32 v49, v49, v50
    s_nop 0
    v_min_u32_dpp v50, v48, v48 row_ror:2 row_mask:0xf bank_mask:0xf
    v_max_u32_dpp v49, v49, v49 row_ror:2 row_mask:0xf bank_mask:0xf
    v_max_u32_dpp v48, v48, v48 row_ror:2 row_mask:0xf bank_mask:0xf
    v_max_u32 v49, v49, v50
    s_nop 0
    v_min_u32_dpp v50, v48, v48 row_ror:1 row_mask:0xf bank_mask:0xf
    v_max_u32_dpp v49, v49, v49 row_ror:1 row_mask:0xf bank_mask:0xf
    v_max_u32_dpp v48, v48, v48 row_ror:1 row_mask:0xf bank_mask:0xf
    v_max_u32 v49, v49, v50
    ds_write_b64 v5, v[48:49]
    v_and_b32 v6, 3, v1
    v_lshlrev_b32 v6, 18, v6
    v_bfe_u32 v9, v1, 2, 2
    v_lshl_add_u32 v6, v9, 13, v6
    s_and_b32 s96, s21, 1
    s_and_b32 s97, s12, 7
    s_lshr_b32 s98, s12, 3
    s_lshl3_add_u32 s99, s97, s98
    s_lshl_b32 s97, s99, 12
    s_lshr_b32 s98, s21, 1
    s_lshl_b32 s99, s98, 6
    s_add_u32 s98, s97, s99
    s_lshl4_add_u32 s97, s96, s98
    s_add_u32 s99, s97, 1048576
    s_add_u32 s14, s99, 2560
    s_waitcnt lgkmcnt(0)
    s_barrier
    ds_read_b64 v[48:49], v11
    ds_read_b64 v[20:21], v10
    s_waitcnt lgkmcnt(1)
    v_min_u32_dpp v50, v48, v48 quad_perm:[1,0,3,2] row_mask:0xf bank_mask:0xf
    v_max_u32_dpp v49, v49, v49 quad_perm:[1,0,3,2] row_mask:0xf bank_mask:0xf
    v_max_u32_dpp v48, v48, v48 quad_perm:[1,0,3,2] row_mask:0xf bank_mask:0xf
    v_max_u32 v49, v49, v50
    s_nop 0
    v_min_u32_dpp v50, v48, v48 quad_perm:[2,3,0,1] row_mask:0xf bank_mask:0xf
    v_max_u32_dpp v49, v49, v49 quad_perm:[2,3,0,1] row_mask:0xf bank_mask:0xf
    v_max_u32_dpp v48, v48, v48 quad_perm:[2,3,0,1] row_mask:0xf bank_mask:0xf
    v_max_u32 v49, v49, v50
    s_nop 0
    v_min_u32_dpp v50, v48, v48 row_half_mirror row_mask:0xf bank_mask:0xf
    v_max_u32_dpp v49, v49, v49 row_half_mirror row_mask:0xf bank_mask:0xf
    v_max_u32_dpp v48, v48, v48 row_half_mirror row_mask:0xf bank_mask:0xf
    v_max_u32 v49, v49, v50
    v_or_b32 v50, 1, v49
    v_mov_b32 v49, s4
    v_mov_b32 v51, s4
    s_cmp_lg_u32 s3, 0
    s_cbranch_scc1 L_NOF
    s_mov_b64 exec, 0xffff
    buffer_store_dwordx4 v[48:51], v6, s[32:35], s14 offen sc1
    s_mov_b64 exec, -1
L_NOF:
    s_cmp_lg_u32 s3, 1
    s_cbranch_scc1 L_NOC
    v_and_b32 v4, 16, v1
    v_cmp_eq_u32 vcc, 0, v4
    s_nop 1
    v_cndmask_b32 v4, v50, v48, vcc
    v_not_b32 v4, v4
    v_bfe_u32 v4, v4, 1, 7
    v_lshlrev_b32 v6, 3, v4
    v_mul_u32_u24 v4, 144, v4
    v_add_u32 v6, 135168, v6
    v_and_b32 v5, 15, v1
    v_lshlrev_b32 v5, 3, v5
    v_add_u32 v4, v4, v5
    ds_read_b64 v[128:129], v6
    ds_read_b64 v[124:125], v4 offset:0
    v_and_b32 v6, 15, v1
    v_lshlrev_b32 v6, 4, v6
    v_bfe_u32 v9, v1, 4, 1
    v_lshl_add_u32 v6, v9, 14, v6
    v_lshrrev_b32 v9, 5, v1
    v_lshl_add_u32 v6, v9, 12, v6
    v_bfe_u32 v7, v1, 4, 1
    v_lshlrev_b32 v7, 14, v7
    s_lshl_b32 s96, s21, 15
    s_lshl_b32 s97, s12, 8
    s_add_u32 s98, s96, s97
    s_add_u32 s13, s98, 33554432
    s_lshl_b32 s96, s21, 15
    s_lshl3_add_u32 s97, s12, s96
    s_add_u32 s98, s97, 8192
    s_add_u32 s16, s98, 33554432
    v_mov_b32 v127, s4
    s_waitcnt lgkmcnt(0)
    v_lshlrev_b32 v132, 16, v124
    v_and_b32 v133, s6, v124
    v_lshlrev_b32 v134, 16, v125
    v_and_b32 v135, s6, v125
    v_pk_add_f32 v[132:133], v[132:133], v[128:129] op_sel_hi:[1,0] neg_lo:[0,1] neg_hi:[0,1]
    v_pk_add_f32 v[134:135], v[134:135], v[128:129] op_sel_hi:[1,0] neg_lo:[0,1] neg_hi:[0,1]
    v_cvt_pk_bf16_f32 v132, 0, v132
    v_cvt_pk_bf16_f32 v133, 0, v133
    v_cvt_pk_bf16_f32 v134, 0, v134
    v_cvt_pk_bf16_f32 v135, 0, v135
    v_pk_mul_f32 v[132:133], v[132:133], v[128:129] op_sel:[0,1]
    v_pk_mul_f32 v[134:135], v[134:135], v[128:129] op_sel:[0,1]
    v_cvt_pk_bf16_f32 v132, 0, v132
    v_cvt_pk_bf16_f32 v133, 0, v133
    v_cvt_pk_bf16_f32 v134, 0, v134
    v_cvt_pk_bf16_f32 v135, 0, v135
    v_pk_mul_f32 v[132:133], v[132:133], v[152:153]
    v_pk_mul_f32 v[134:135], v[134:135], v[154:155]
    v_cvt_pk_bf16_f32 v132, 0, v132
    v_cvt_pk_bf16_f32 v133, 0, v133
    v_cvt_pk_bf16_f32 v134, 0, v134
    v_cvt_pk_bf16_f32 v135, 0, v135
    v_pk_add_f32 v[132:133], v[132:133], v[148:149]
    v_pk_add_f32 v[134:135], v[134:135], v[150:151]
    v_mov_b32 v126, v125
    v_mov_b32 v125, s4
    s_mov_b32 exec_hi, 0
    v_cvt_pk_bf16_f32 v124, v132, v133
    v_cvt_pk_bf16_f32 v126, v134, v135
    s_mov_b32 exec_hi, -1
    v_dot2_f32_bf16 v128, v124, v156, 0
    v_mov_b32 v129, s4
    v_dot2_f32_bf16 v128, v126, v157, v128
    buffer_store_dwordx4 v[124:127], v6, s[32:35], s13 offen sc1
    s_nop 1
    v_add_f32_dpp v128, v128, v128 quad_perm:[1,0,3,2] row_mask:0xf bank_mask:0xf
    s_nop 1
    v_add_f32_dpp v128, v128, v128 quad_perm:[2,3,0,1] row_mask:0xf bank_mask:0xf
    s_nop 1
    v_add_f32_dpp v128, v128, v128 row_half_mirror row_mask:0xf bank_mask:0xf
    s_nop 1
    v_add_f32_dpp v128, v128, v128 row_ror:8 row_mask:0xf bank_mask:0xf
    s_mov_b64 exec, 0x10001
    buffer_store_dwordx2 v[128:129], v7, s[32:35], s16 offen sc1
    s_mov_b64 exec, -1
L_NOC:
    s_waitcnt lgkmcnt(0)
    s_mov_b32 exec_lo, 0xff
    s_mov_b32 exec_hi, 0xff
    buffer_store_dwordx2 v[224:225], v226, s[32:35], 0 offen sc1
    s_mov_b64 exec, -1
    s_add_u32 s13, s81, 8192
    s_lshl2_add_u32 m0, s89, 100352
    s_nop 0
    buffer_load_dwordx4 v73, s[60:63], s13 offen nt lds
    s_load_dwordx8 s[24:31], s[32:33], s92 offset:2560 glc
    v_pk_add_f32 v[76:77], v[28:29], v[20:21] op_sel_hi:[1,0] neg_lo:[0,1] neg_hi:[0,1]
    v_pk_add_f32 v[78:79], v[30:31], v[20:21] op_sel_hi:[1,0] neg_lo:[0,1] neg_hi:[0,1]
    v_pk_add_f32 v[80:81], v[32:33], v[20:21] op_sel_hi:[1,0] neg_lo:[0,1] neg_hi:[0,1]
    v_pk_add_f32 v[82:83], v[34:35], v[20:21] op_sel_hi:[1,0] neg_lo:[0,1] neg_hi:[0,1]
    v_pk_add_f32 v[84:85], v[36:37], v[20:21] op_sel_hi:[1,0] neg_lo:[0,1] neg_hi:[0,1]
    v_pk_add_f32 v[86:87], v[38:39], v[20:21] op_sel_hi:[1,0] neg_lo:[0,1] neg_hi:[0,1]
    v_pk_add_f32 v[88:89], v[40:41], v[20:21] op_sel_hi:[1,0] neg_lo:[0,1] neg_hi:[0,1]
    v_pk_add_f32 v[90:91], v[42:43], v[20:21] op_sel_hi:[1,0] neg_lo:[0,1] neg_hi:[0,1]
    v_cvt_pk_bf16_f32 v76, 0, v76
    v_cvt_pk_bf16_f32 v77, 0, v77
    v_cvt_pk_bf16_f32 v78, 0, v78
    v_cvt_pk_bf16_f32 v79, 0, v79
    v_cvt_pk_bf16_f32 v80, 0, v80
    v_cvt_pk_bf16_f32 v81, 0, v81
    v_cvt_pk_bf16_f32 v82, 0, v82
    v_cvt_pk_bf16_f32 v83, 0, v83
    v_cvt_pk_bf16_f32 v84, 0, v84
    v_cvt_pk_bf16_f32 v85, 0, v85
    v_cvt_pk_bf16_f32 v86, 0, v86
    v_cvt_pk_bf16_f32 v87, 0, v87
    v_cvt_pk_bf16_f32 v88, 0, v88
    v_cvt_pk_bf16_f32 v89, 0, v89
    v_cvt_pk_bf16_f32 v90, 0, v90
    v_cvt_pk_bf16_f32 v91, 0, v91
    v_pk_mul_f32 v[76:77], v[76:77], v[20:21] op_sel:[0,1]
    v_pk_mul_f32 v[78:79], v[78:79], v[20:21] op_sel:[0,1]
    v_pk_mul_f32 v[80:81], v[80:81], v[20:21] op_sel:[0,1]
    v_pk_mul_f32 v[82:83], v[82:83], v[20:21] op_sel:[0,1]
    v_pk_mul_f32 v[84:85], v[84:85], v[20:21] op_sel:[0,1]
    v_pk_mul_f32 v[86:87], v[86:87], v[20:21] op_sel:[0,1]
    v_pk_mul_f32 v[88:89], v[88:89], v[20:21] op_sel:[0,1]
    v_pk_mul_f32 v[90:91], v[90:91], v[20:21] op_sel:[0,1]
    v_cvt_pk_bf16_f32 v76, 0, v76
    v_cvt_pk_bf16_f32 v77, 0, v77
    v_cvt_pk_bf16_f32 v78, 0, v78
    v_cvt_pk_bf16_f32 v79, 0, v79
    v_cvt_pk_bf16_f32 v80, 0, v80
    v_cvt_pk_bf16_f32 v81, 0, v81
    v_cvt_pk_bf16_f32 v82, 0, v82
    v_cvt_pk_bf16_f32 v83, 0, v83
    v_cvt_pk_bf16_f32 v84, 0, v84
    v_cvt_pk_bf16_f32 v85, 0, v85
    v_cvt_pk_bf16_f32 v86, 0, v86
    v_cvt_pk_bf16_f32 v87, 0, v87
    v_cvt_pk_bf16_f32 v88, 0, v88
    v_cvt_pk_bf16_f32 v89, 0, v89
    v_cvt_pk_bf16_f32 v90, 0, v90
    v_cvt_pk_bf16_f32 v91, 0, v91
    v_pk_mul_f32 v[76:77], v[76:77], v[108:109]
    v_pk_mul_f32 v[78:79], v[78:79], v[110:111]
    v_pk_mul_f32 v[80:81], v[80:81], v[112:113]
    v_pk_mul_f32 v[82:83], v[82:83], v[114:115]
    v_pk_mul_f32 v[84:85], v[84:85], v[116:117]
    v_pk_mul_f32 v[86:87], v[86:87], v[118:119]
    v_pk_mul_f32 v[88:89], v[88:89], v[120:121]
    v_pk_mul_f32 v[90:91], v[90:91], v[122:123]
    v_cvt_pk_bf16_f32 v76, 0, v76
    v_cvt_pk_bf16_f32 v77, 0, v77
    v_cvt_pk_bf16_f32 v78, 0, v78
    v_cvt_pk_bf16_f32 v79, 0, v79
    v_cvt_pk_bf16_f32 v80, 0, v80
    v_cvt_pk_bf16_f32 v81, 0, v81
    v_cvt_pk_bf16_f32 v82, 0, v82
    v_cvt_pk_bf16_f32 v83, 0, v83
    v_cvt_pk_bf16_f32 v84, 0, v84
    v_cvt_pk_bf16_f32 v85, 0, v85
    v_cvt_pk_bf16_f32 v86, 0, v86
    v_cvt_pk_bf16_f32 v87, 0, v87
    v_cvt_pk_bf16_f32 v88, 0, v88
    v_cvt_pk_bf16_f32 v89, 0, v89
    v_cvt_pk_bf16_f32 v90, 0, v90
    v_cvt_pk_bf16_f32 v91, 0, v91
    v_pk_add_f32 v[76:77], v[76:77], v[92:93]
    v_pk_add_f32 v[78:79], v[78:79], v[94:95]
    v_pk_add_f32 v[80:81], v[80:81], v[96:97]
    v_pk_add_f32 v[82:83], v[82:83], v[98:99]
    v_pk_add_f32 v[84:85], v[84:85], v[100:101]
    v_pk_add_f32 v[86:87], v[86:87], v[102:103]
    v_pk_add_f32 v[88:89], v[88:89], v[104:105]
    v_pk_add_f32 v[90:91], v[90:91], v[106:107]
    v_cvt_pk_bf16_f32 v76, 0, v76
    v_cvt_pk_bf16_f32 v77, 0, v77
    v_cvt_pk_bf16_f32 v78, 0, v78
    v_cvt_pk_bf16_f32 v79, 0, v79
    v_cvt_pk_bf16_f32 v80, 0, v80
    v_cvt_pk_bf16_f32 v81, 0, v81
    v_cvt_pk_bf16_f32 v82, 0, v82
    v_cvt_pk_bf16_f32 v83, 0, v83
    v_cvt_pk_bf16_f32 v84, 0, v84
    v_cvt_pk_bf16_f32 v85, 0, v85
    v_cvt_pk_bf16_f32 v86, 0, v86
    v_cvt_pk_bf16_f32 v87, 0, v87
    v_cvt_pk_bf16_f32 v88, 0, v88
    v_cvt_pk_bf16_f32 v89, 0, v89
    v_cvt_pk_bf16_f32 v90, 0, v90
    v_cvt_pk_bf16_f32 v91, 0, v91
    s_lshr_b32 s96, s3, 2
    s_lshl_b32 s97, s96, 15
    s_and_b32 s98, s3, 3
    s_lshl_b32 s99, s98, 5
    s_add_u32 s96, s97, s99
    s_add_u32 s13, s96, 32768
    v_lshrrev_b32 v24, 4, v1
    v_lshlrev_b32 v24, 13, v24
    v_bfe_u32 v9, v1, 2, 2
    v_lshl_add_u32 v24, v9, 7, v24
    v_bfe_u32 v9, v1, 3, 2
    v_lshl_add_u32 v24, v9, 5, v24
    v_and_b32 v9, 3, v1
    v_lshl_add_u32 v24, v9, 3, v24
    v_xor_b32 v24, s13, v24
    s_lshl_b32 s13, s3, 6
    v_bfe_u32 v45, v1, 2, 1
    v_lshlrev_b32 v45, 9, v45
    v_bfe_u32 v9, v1, 3, 1
    v_lshl_add_u32 v45, v9, 12, v45
    v_lshrrev_b32 v9, 5, v1
    v_lshl_add_u32 v45, v9, 11, v45
    v_bfe_u32 v9, v1, 2, 2
    v_lshl_add_u32 v45, v9, 6, v45
    v_bfe_u32 v9, v1, 4, 1
    v_lshl_add_u32 v45, v9, 5, v45
    v_and_b32 v9, 3, v1
    v_lshl_add_u32 v45, v9, 3, v45
    v_xor_b32 v45, s13, v45
    v_add_u32 v45, 98304, v45
    v_and_b32 v46, 7, v1
    v_lshlrev_b32 v46, 4, v46
    v_lshrrev_b32 v9, 4, v1
    v_lshl_add_u32 v46, v9, 7, v46
    v_add_u32 v46, 136704, v46
    s_lshl4_add_u32 s13, s3, 136256
    v_mov_b32 v4, s13
    v_and_b32 v5, 7, v1
    v_lshlrev_b32 v5, 4, v5
    v_add_u32 v5, 136256, v5
    v_and_b32 v8, 8, v1
    v_cmp_eq_u32 s[22:23], 0, v8
    s_branch SCHK_46
SPOLL_45:
    s_load_dwordx8 s[24:31], s[32:33], s92 offset:2560 glc
SCHK_46:
    s_add_u32 s5, s5, 1
    s_cmp_ge_u32 s5, 300000
    s_waitcnt lgkmcnt(0)
    s_cbranch_scc1 SDONE_47
    s_cmp_lg_u32 s25, s4
    s_cbranch_scc1 SPOLL_45
    s_cmp_lg_u32 s27, s4
    s_cbranch_scc1 SPOLL_45
    s_cmp_lg_u32 s29, s4
    s_cbranch_scc1 SPOLL_45
    s_cmp_lg_u32 s31, s4
    s_cbranch_scc1 SPOLL_45
SDONE_47:
    s_min_u32 s25, s24, s28
    s_max_u32 s24, s24, s28
    s_max_u32 s27, s26, s30
    s_min_u32 s26, s26, s30
    s_max_u32 s28, s25, s27
    s_min_u32 s25, s25, s27
    v_mov_b32 v148, s24
    v_mov_b32 v151, s26
    v_mov_b32 v149, s28
    v_mov_b32 v150, s25
    ds_write_b128 v4, v[148:151]
    s_waitcnt lgkmcnt(0)
    s_barrier
    s_cmp_lt_u32 s3, 4
    s_cbranch_scc1 L_CSEL
    ds_read_b64_tr_b16 v[164:165], v24
    ds_read_b64_tr_b16 v[166:167], v24 offset:512
    ds_read_b64_tr_b16 v[168:169], v24 offset:1024
    ds_read_b64_tr_b16 v[170:171], v24 offset:1536
    ds_read_b64_tr_b16 v[172:173], v24 offset:2048
    ds_read_b64_tr_b16 v[174:175], v24 offset:2560
    ds_read_b64_tr_b16 v[176:177], v24 offset:3072
    ds_read_b64_tr_b16 v[178:179], v24 offset:3584
    ds_read_b64_tr_b16 v[180:181], v24 offset:4096
    ds_read_b64_tr_b16 v[182:183], v24 offset:4608
    ds_read_b64_tr_b16 v[184:185], v24 offset:5120
    ds_read_b64_tr_b16 v[186:187], v24 offset:5632
    ds_read_b64_tr_b16 v[188:189], v24 offset:6144
    ds_read_b64_tr_b16 v[190:191], v24 offset:6656
    ds_read_b64_tr_b16 v[192:193], v24 offset:7168
    ds_read_b64_tr_b16 v[194:195], v24 offset:7680
    v_mul_u32_u24_dpp v92, v70, v52 row_newbcast:0 row_mask:0xf bank_mask:0xf
    v_and_b32_dpp v93, v70, v53 row_newbcast:0 row_mask:0xf bank_mask:0xf
    v_mul_u32_u24_dpp v94, v70, v52 row_newbcast:1 row_mask:0xf bank_mask:0xf
    v_and_b32_dpp v95, v70, v53 row_newbcast:1 row_mask:0xf bank_mask:0xf
    v_mul_u32_u24_dpp v96, v70, v52 row_newbcast:2 row_mask:0xf bank_mask:0xf
    v_and_b32_dpp v97, v70, v53 row_newbcast:2 row_mask:0xf bank_mask:0xf
    v_mul_u32_u24_dpp v98, v70, v52 row_newbcast:3 row_mask:0xf bank_mask:0xf
    v_and_b32_dpp v99, v70, v53 row_newbcast:3 row_mask:0xf bank_mask:0xf
    v_mul_u32_u24_dpp v100, v70, v52 row_newbcast:4 row_mask:0xf bank_mask:0xf
    v_and_b32_dpp v101, v70, v53 row_newbcast:4 row_mask:0xf bank_mask:0xf
    v_mul_u32_u24_dpp v102, v70, v52 row_newbcast:5 row_mask:0xf bank_mask:0xf
    v_and_b32_dpp v103, v70, v53 row_newbcast:5 row_mask:0xf bank_mask:0xf
    v_mul_u32_u24_dpp v104, v70, v52 row_newbcast:6 row_mask:0xf bank_mask:0xf
    v_and_b32_dpp v105, v70, v53 row_newbcast:6 row_mask:0xf bank_mask:0xf
    v_mul_u32_u24_dpp v106, v70, v52 row_newbcast:7 row_mask:0xf bank_mask:0xf
    v_and_b32_dpp v107, v70, v53 row_newbcast:7 row_mask:0xf bank_mask:0xf
    v_pk_mul_f32 v[76:77], v[76:77], v[92:93]
    v_pk_mul_f32 v[78:79], v[78:79], v[94:95]
    v_pk_mul_f32 v[80:81], v[80:81], v[96:97]
    v_pk_mul_f32 v[82:83], v[82:83], v[98:99]
    v_pk_mul_f32 v[84:85], v[84:85], v[100:101]
    v_pk_mul_f32 v[86:87], v[86:87], v[102:103]
    v_pk_mul_f32 v[88:89], v[88:89], v[104:105]
    v_pk_mul_f32 v[90:91], v[90:91], v[106:107]
    v_cvt_pk_bf16_f32 v76, 0, v76
    v_cvt_pk_bf16_f32 v77, 0, v77
    v_cvt_pk_bf16_f32 v78, 0, v78
    v_cvt_pk_bf16_f32 v79, 0, v79
    v_cvt_pk_bf16_f32 v80, 0, v80
    v_cvt_pk_bf16_f32 v81, 0, v81
    v_cvt_pk_bf16_f32 v82, 0, v82
    v_cvt_pk_bf16_f32 v83, 0, v83
    v_cvt_pk_bf16_f32 v84, 0, v84
    v_cvt_pk_bf16_f32 v85, 0, v85
    v_cvt_pk_bf16_f32 v86, 0, v86
    v_cvt_pk_bf16_f32 v87, 0, v87
    v_cvt_pk_bf16_f32 v88, 0, v88
    v_cvt_pk_bf16_f32 v89, 0, v89
    v_cvt_pk_bf16_f32 v90, 0, v90
    v_cvt_pk_bf16_f32 v91, 0, v91
    v_pk_add_f32 v[76:77], v[76:77], v[28:29]
    v_pk_add_f32 v[78:79], v[78:79], v[30:31]
    v_pk_add_f32 v[80:81], v[80:81], v[32:33]
    v_pk_add_f32 v[82:83], v[82:83], v[34:35]
    v_pk_add_f32 v[84:85], v[84:85], v[36:37]
    v_pk_add_f32 v[86:87], v[86:87], v[38:39]
    v_pk_add_f32 v[88:89], v[88:89], v[40:41]
    v_pk_add_f32 v[90:91], v[90:91], v[42:43]
    v_cvt_pk_bf16_f32 v140, v76, v77
    v_cvt_pk_bf16_f32 v141, v78, v79
    v_cvt_pk_bf16_f32 v142, v80, v81
    v_cvt_pk_bf16_f32 v143, v82, v83
    v_cvt_pk_bf16_f32 v144, v84, v85
    v_cvt_pk_bf16_f32 v145, v86, v87
    v_cvt_pk_bf16_f32 v146, v88, v89
    v_cvt_pk_bf16_f32 v147, v90, v91
    ds_write_b128 v23, v[140:143]
    ds_write_b128 v23, v[144:147] offset:16
    s_mul_i32 s96, s3, 2304
    s_add_u32 s16, s96, 139776
    v_lshrrev_b32 v23, 3, v1
    v_mul_u32_u24 v23, 144, v23
    v_and_b32 v9, 7, v1
    v_lshl_add_u32 v23, v9, 4, v23
    v_add_u32 v23, s16, v23
    s_add_u32 s13, s81, 12288
    s_lshl2_add_u32 m0, s89, 101376
    s_nop 0
    buffer_load_dwordx4 v73, s[60:63], s13 offen nt lds
    s_branch L_CSELD
L_CSEL:
    ds_read_b128 v[148:151], v5
    s_lshl_b32 s96, s3, 9
    s_add_u32 s13, s96, 136704
    v_add_u32 v6, s13, v63
    s_lshl2_add_u32 s13, s3, 136384
    v_mov_b32 v7, s13
    s_waitcnt lgkmcnt(0)
    v_max_u32_dpp v152, v151, v148 quad_perm:[1,0,3,2] row_mask:0xf bank_mask:0xf
    v_max_u32_dpp v153, v150, v149 quad_perm:[1,0,3,2] row_mask:0xf bank_mask:0xf
    v_max_u32_dpp v154, v149, v150 quad_perm:[1,0,3,2] row_mask:0xf bank_mask:0xf
    v_max_u32_dpp v155, v148, v151 quad_perm:[1,0,3,2] row_mask:0xf bank_mask:0xf
    v_max_u32 v156, v152, v154
    v_max_u32 v157, v153, v155
    v_min_u32 v158, v152, v154
    v_min_u32 v159, v153, v155
    v_max_u32 v148, v156, v157
    v_min_u32 v149, v156, v157
    v_max_u32 v150, v158, v159
    v_min_u32 v151, v158, v159
    s_nop 1
    v_max_u32_dpp v152, v151, v148 quad_perm:[2,3,0,1] row_mask:0xf bank_mask:0xf
    v_max_u32_dpp v153, v150, v149 quad_perm:[2,3,0,1] row_mask:0xf bank_mask:0xf
    v_max_u32_dpp v154, v149, v150 quad_perm:[2,3,0,1] row_mask:0xf bank_mask:0xf
    v_max_u32_dpp v155, v148, v151 quad_perm:[2,3,0,1] row_mask:0xf bank_mask:0xf
    v_max_u32 v156, v152, v154
    v_max_u32 v157, v153, v155
    v_min_u32 v158, v152, v154
    v_min_u32 v159, v153, v155
    v_max_u32 v148, v156, v157
    v_min_u32 v149, v156, v157
    v_max_u32 v150, v158, v159
    v_min_u32 v151, v158, v159
    s_nop 1
    v_max_u32_dpp v152, v151, v148 row_half_mirror row_mask:0xf bank_mask:0xf
    v_max_u32_dpp v153, v150, v149 row_half_mirror row_mask:0xf bank_mask:0xf
    v_max_u32_dpp v154, v149, v150 row_half_mirror row_mask:0xf bank_mask:0xf
    v_max_u32_dpp v155, v148, v151 row_half_mirror row_mask:0xf bank_mask:0xf
    v_readfirstlane_b32 s24, v152
    v_readfirstlane_b32 s25, v153
    v_readfirstlane_b32 s26, v154
    v_readfirstlane_b32 s27, v155
    s_bitcmp1_b32 s3, 0
    s_cselect_b32 s24, s25, s24
    s_cselect_b32 s26, s27, s26
    s_bitcmp1_b32 s3, 1
    s_cselect_b32 s24, s26, s24
    s_and_b32 s15, s24, 4095
    s_lshr_b32 s96, s15, 8
    s_sub_u32 s97, 15, s96
    s_and_b32 s98, s15, 1
    s_lshl1_add_u32 s99, s97, s98
    s_lshl_b32 s96, s99, 14
    s_add_u32 s13, s96, 33554432
    s_lshl_b32 s96, s75, 10
    s_add_u32 s14, s96, s13
    s_add_u32 s13, s13, 8192
    v_and_b32 v10, 15, v1
    v_lshlrev_b32 v10, 3, v10
    buffer_load_dwordx2 v[152:153], v10, s[32:35], s13 offen sc1
    buffer_load_dwordx4 v[148:151], v2, s[32:35], s14 offen sc1
    s_add_u32 s16, s81, 12288
    s_lshl2_add_u32 m0, s89, 101376
    s_nop 0
    buffer_load_dwordx4 v73, s[60:63], s16 offen nt lds
    ds_read_b64_tr_b16 v[164:165], v24
    ds_read_b64_tr_b16 v[166:167], v24 offset:512
    ds_read_b64_tr_b16 v[168:169], v24 offset:1024
    ds_read_b64_tr_b16 v[170:171], v24 offset:1536
    ds_read_b64_tr_b16 v[172:173], v24 offset:2048
    ds_read_b64_tr_b16 v[174:175], v24 offset:2560
    ds_read_b64_tr_b16 v[176:177], v24 offset:3072
    ds_read_b64_tr_b16 v[178:179], v24 offset:3584
    ds_read_b64_tr_b16 v[180:181], v24 offset:4096
    ds_read_b64_tr_b16 v[182:183], v24 offset:4608
    ds_read_b64_tr_b16 v[184:185], v24 offset:5120
    ds_read_b64_tr_b16 v[186:187], v24 offset:5632
    ds_read_b64_tr_b16 v[188:189], v24 offset:6144
    ds_read_b64_tr_b16 v[190:191], v24 offset:6656
    ds_read_b64_tr_b16 v[192:193], v24 offset:7168
    ds_read_b64_tr_b16 v[194:195], v24 offset:7680
    v_mul_u32_u24_dpp v92, v70, v52 row_newbcast:0 row_mask:0xf bank_mask:0xf
    v_and_b32_dpp v93, v70, v53 row_newbcast:0 row_mask:0xf bank_mask:0xf
    v_mul_u32_u24_dpp v94, v70, v52 row_newbcast:1 row_mask:0xf bank_mask:0xf
    v_and_b32_dpp v95, v70, v53 row_newbcast:1 row_mask:0xf bank_mask:0xf
    v_mul_u32_u24_dpp v96, v70, v52 row_newbcast:2 row_mask:0xf bank_mask:0xf
    v_and_b32_dpp v97, v70, v53 row_newbcast:2 row_mask:0xf bank_mask:0xf
    v_mul_u32_u24_dpp v98, v70, v52 row_newbcast:3 row_mask:0xf bank_mask:0xf
    v_and_b32_dpp v99, v70, v53 row_newbcast:3 row_mask:0xf bank_mask:0xf
    v_mul_u32_u24_dpp v100, v70, v52 row_newbcast:4 row_mask:0xf bank_mask:0xf
    v_and_b32_dpp v101, v70, v53 row_newbcast:4 row_mask:0xf bank_mask:0xf
    v_mul_u32_u24_dpp v102, v70, v52 row_newbcast:5 row_mask:0xf bank_mask:0xf
    v_and_b32_dpp v103, v70, v53 row_newbcast:5 row_mask:0xf bank_mask:0xf
    v_mul_u32_u24_dpp v104, v70, v52 row_newbcast:6 row_mask:0xf bank_mask:0xf
    v_and_b32_dpp v105, v70, v53 row_newbcast:6 row_mask:0xf bank_mask:0xf
    v_mul_u32_u24_dpp v106, v70, v52 row_newbcast:7 row_mask:0xf bank_mask:0xf
    v_and_b32_dpp v107, v70, v53 row_newbcast:7 row_mask:0xf bank_mask:0xf
    v_pk_mul_f32 v[76:77], v[76:77], v[92:93]
    v_pk_mul_f32 v[78:79], v[78:79], v[94:95]
    v_pk_mul_f32 v[80:81], v[80:81], v[96:97]
    v_pk_mul_f32 v[82:83], v[82:83], v[98:99]
    v_pk_mul_f32 v[84:85], v[84:85], v[100:101]
    v_pk_mul_f32 v[86:87], v[86:87], v[102:103]
    v_pk_mul_f32 v[88:89], v[88:89], v[104:105]
    v_pk_mul_f32 v[90:91], v[90:91], v[106:107]
    v_cvt_pk_bf16_f32 v76, 0, v76
    v_cvt_pk_bf16_f32 v77, 0, v77
    v_cvt_pk_bf16_f32 v78, 0, v78
    v_cvt_pk_bf16_f32 v79, 0, v79
    v_cvt_pk_bf16_f32 v80, 0, v80
    v_cvt_pk_bf16_f32 v81, 0, v81
    v_cvt_pk_bf16_f32 v82, 0, v82
    v_cvt_pk_bf16_f32 v83, 0, v83
    v_cvt_pk_bf16_f32 v84, 0, v84
    v_cvt_pk_bf16_f32 v85, 0, v85
    v_cvt_pk_bf16_f32 v86, 0, v86
    v_cvt_pk_bf16_f32 v87, 0, v87
    v_cvt_pk_bf16_f32 v88, 0, v88
    v_cvt_pk_bf16_f32 v89, 0, v89
    v_cvt_pk_bf16_f32 v90, 0, v90
    v_cvt_pk_bf16_f32 v91, 0, v91
    v_pk_add_f32 v[76:77], v[76:77], v[28:29]
    v_pk_add_f32 v[78:79], v[78:79], v[30:31]
    v_pk_add_f32 v[80:81], v[80:81], v[32:33]
    v_pk_add_f32 v[82:83], v[82:83], v[34:35]
    v_pk_add_f32 v[84:85], v[84:85], v[36:37]
    v_pk_add_f32 v[86:87], v[86:87], v[38:39]
    v_pk_add_f32 v[88:89], v[88:89], v[40:41]
    v_pk_add_f32 v[90:91], v[90:91], v[42:43]
    v_cvt_pk_bf16_f32 v140, v76, v77
    v_cvt_pk_bf16_f32 v141, v78, v79
    v_cvt_pk_bf16_f32 v142, v80, v81
    v_cvt_pk_bf16_f32 v143, v82, v83
    v_cvt_pk_bf16_f32 v144, v84, v85
    v_cvt_pk_bf16_f32 v145, v86, v87
    v_cvt_pk_bf16_f32 v146, v88, v89
    v_cvt_pk_bf16_f32 v147, v90, v91
    ds_write_b128 v23, v[140:143]
    ds_write_b128 v23, v[144:147] offset:16
    s_mul_i32 s96, s3, 2304
    s_add_u32 s16, s96, 139776
    v_lshrrev_b32 v23, 3, v1
    v_mul_u32_u24 v23, 144, v23
    v_and_b32 v9, 7, v1
    v_lshl_add_u32 v23, v9, 4, v23
    v_add_u32 v23, s16, v23
    s_lshl2_add_u32 s15, s15, s3
    s_waitcnt vmcnt(1)
    v_bitop3_b32 v8, v149, v151, s4 bitop3:0x7e
    v_bitop3_b32 v8, v8, v153, s4 bitop3:0xf6
    v_cmp_ne_u32 vcc, 0, v8
    s_cbranch_vccz TOK_49
POLL_50:
    buffer_load_dwordx2 v[152:153], v10, s[32:35], s13 offen sc1
    buffer_load_dwordx4 v[148:151], v2, s[32:35], s14 offen sc1
    s_waitcnt vmcnt(0)
    v_bitop3_b32 v8, v149, v151, s4 bitop3:0x7e
    v_bitop3_b32 v8, v8, v153, s4 bitop3:0xf6
    v_cmp_ne_u32 vcc, 0, v8
    s_cbranch_vccz PDONE_51
    s_add_u32 s5, s5, 1
    s_cmp_lt_u32 s5, 300000
    s_cbranch_scc1 POLL_50
PDONE_51:
TOK_49:
    ds_write2_b32 v6, v148, v150 offset0:0 offset1:1
    v_add_f32_dpp v152, v152, v152 quad_perm:[1,0,3,2] row_mask:0xf bank_mask:0xf
    s_nop 1
    v_add_f32_dpp v152, v152, v152 quad_perm:[2,3,0,1] row_mask:0xf bank_mask:0xf
    s_nop 1
    v_add_f32_dpp v152, v152, v152 row_half_mirror row_mask:0xf bank_mask:0xf
    s_nop 1
    v_add_f32_dpp v152, v152, v152 row_ror:8 row_mask:0xf bank_mask:0xf
    v_cvt_pk_bf16_f32 v152, 0, v152
    v_ashrrev_i32 v153, 31, v152
    v_or_b32 v153, 0x80000000, v153
    v_xor_b32 v152, v152, v153
    v_and_b32 v152, s6, v152
    v_or_b32 v152, s15, v152
    ds_write_b32 v7, v152
L_CSELD:
    v_mov_b32 v4, 136384
    v_and_b32 v8, 15, v1
    v_lshlrev_b32 v8, 4, v8
    v_lshrrev_b32 v9, 5, v1
    v_lshl_add_u32 v8, v9, 3, v8
    s_lshl_b32 s96, s74, 13
    s_add_u32 s14, s96, 20971520
    s_lshl3_add_u32 s96, s75, s3
    s_lshl_b32 s97, s96, 8
    s_add_u32 s20, s97, s14
    s_waitcnt lgkmcnt(0)
    s_barrier
    ds_read_b128 v[148:151], v4
    s_waitcnt lgkmcnt(0)
    v_max_u32 v152, v148, v149
    v_max_u32 v153, v150, v151
    v_min_u32 v154, v148, v149
    v_min_u32 v155, v150, v151
    v_min_u32 v149, v152, v153
    v_max_u32 v148, v152, v153
    v_max3_u32 v149, v149, v154, v155
    v_cndmask_b32 v4, v149, v148, s[22:23]
    v_readfirstlane_b32 s68, v148
    v_and_b32 v4, 3, v4
    v_readfirstlane_b32 s69, v149
    v_lshl_add_u32 v4, v4, 9, v46
    ds_read_b128 v[152:155], v4
    ds_read_b128 v[140:143], v23
    ds_read_b128 v[144:147], v23 offset:1152
    s_bfe_u32 s70, s68, 720899
    s_bfe_u32 s71, s69, 720899
    s_sub_u32 s70, 2047, s70
    s_sub_u32 s71, 2047, s71
    s_waitcnt lgkmcnt(2)
    v_mfma_f32_16x16x32_bf16 v[212:215], v[152:155], v[164:167], 0
    v_mfma_f32_16x16x32_bf16 v[216:219], v[152:155], v[168:171], 0
    v_mfma_f32_16x16x32_bf16 v[220:223], v[152:155], v[172:175], 0
    v_mfma_f32_16x16x32_bf16 v[224:227], v[152:155], v[176:179], 0
    v_mfma_f32_16x16x32_bf16 v[228:231], v[152:155], v[180:183], 0
    v_mfma_f32_16x16x32_bf16 v[232:235], v[152:155], v[184:187], 0
    v_mfma_f32_16x16x32_bf16 v[236:239], v[152:155], v[188:191], 0
    v_mfma_f32_16x16x32_bf16 v[240:243], v[152:155], v[192:195], 0
    s_nop 1
    v_add_f32 v148, v212, v217
    s_nop 0
    v_add_f32 v149, v222, v227
    s_nop 0
    v_add_f32 v150, v228, v233
    s_nop 0
    v_add_f32 v151, v238, v243
    v_add_f32 v148, v148, v149
    v_add_f32 v150, v150, v151
    v_mov_b32 v149, s4
    s_nop 0
    v_permlane16_swap_b32 v150, v151
    s_cmp_ge_u32 s9, 28
    s_cbranch_scc1 L_NOHP
    v_add_f32 v148, v148, v151
    s_mov_b32 exec_lo, 0xffff
    s_mov_b32 exec_hi, 0xffff
    s_cmp_lg_u32 s93, 0
    s_cbranch_scc1 LOC_52
    buffer_store_dwordx2 v[148:149], v8, s[32:35], s20 offen sc1
    s_branch LOCD_53
LOC_52:
    buffer_store_dwordx2 v[148:149], v8, s[32:35], s20 offen
LOCD_53:
    s_mov_b64 exec, -1
L_NOHP:
    v_mov_b32 v56, v148
    v_mov_b32 v57, v149
    v_add_u32 v58, s20, v8
    s_waitcnt lgkmcnt(0)
    s_bitcmp1_b32 s21, 2
    s_cselect_b32 s17, s71, s70
    s_cselect_b32 s18, s69, s68
    s_cmp_lg_u32 s3, 7
    s_cbranch_scc1 L_NOFZ
    s_cmp_lg_u32 s2, 0
    s_cbranch_scc1 L_NONON
    v_mov_b32 v6, s4
    s_mov_b64 exec, 1
    buffer_store_dword v6, v3, s[32:35], 0 offen sc1
    s_mov_b64 exec, -1
L_NONON:
    s_lshr_b32 s96, s21, 3
    s_and_b32 s97, s21, 1
    s_lshl1_add_u32 s19, s96, s97
    s_lshr_b32 s96, s21, 2
    s_lshl_b32 s97, s96, 1
    s_lshl3_add_u32 s98, s12, s97
    s_and_b32 s99, s21, 1
    s_add_u32 s96, s98, s99
    s_mul_i32 s97, s96, 7168
    s_add_u32 s20, s97, 22020096
    s_lshl_b32 s96, s17, 11
    s_lshl_b32 s97, s12, 7
    s_add_u32 s98, s96, s97
    s_lshl_b32 s99, s19, 5
    s_add_u32 s82, s98, s99
    v_and_b32 v10, 7, v1
    v_lshlrev_b32 v10, 2, v10
    s_lshl_b32 s96, s19, 5
    s_add_u32 s13, s96, 139264
    v_add_u32 v5, s13, v10
    ds_read_b32 v74, v5
    s_lshr_b32 s96, s17, 7
    s_bfe_u32 s97, s18, 65538
    s_lshl1_add_u32 s98, s96, s97
    s_lshl_b32 s99, s98, 14
    s_lshl_b32 s96, s12, 8
    s_add_u32 s97, s99, s96
    s_lshl_b32 s98, s19, 6
    s_add_u32 s99, s97, s98
    s_add_u32 s68, s99, 33554432
    s_add_u32 s69, s68, 4096
    v_and_b32 v11, 7, v1
    v_lshlrev_b32 v11, 3, v11
    buffer_load_dwordx2 v[20:21], v11, s[32:35], s68 offen sc1
    buffer_load_dwordx2 v[72:73], v11, s[32:35], s69 offen sc1
    s_and_b32 s13, s18, s6
    s_ashr_i32 s15, s13, 31
    s_andn2_b32 s15, 0x7fff0000, s15
    s_or_b32 s15, s15, 0x80000000
    s_xor_b32 s13, s13, s15
    v_mov_b32 v75, s13
    v_mul_f32 v75, s7, v75
    v_exp_f32 v75, -v75
    s_nop 0
    v_add_f32 v75, 1.0, v75
    v_rcp_f32 v75, v75
    s_nop 0
    v_cvt_pk_bf16_f32 v75, 0, v75
L_NOFZ:
    s_cmp_lt_u32 s9, 28
    s_cbranch_scc1 L_HSEC
    s_branch L_GSEC
L_HSEC:
    s_cmp_lt_u32 s3, 4
    s_cbranch_scc1 L_HW
    s_branch L_NOH
L_HW:
    s_lshl_b32 s96, s3, 8
    s_add_u32 s13, s96, s14
    v_lshrrev_b32 v4, 4, v1
    v_lshlrev_b32 v4, 11, v4
    v_and_b32 v9, 15, v1
    v_lshl_add_u32 v4, v9, 4, v4
    s_lshl_b32 s96, s3, 5
    s_add_u32 s15, s96, 138752
    v_lshrrev_b32 v5, 5, v1
    v_lshl_add_u32 v5, v5, 7, s15
    v_bfe_u32 v9, v1, 2, 1
    v_lshl_add_u32 v5, v9, 4, v5
    v_bfe_u32 v9, v1, 1, 1
    v_lshl_add_u32 v5, v9, 3, v5
    v_bfe_u32 v9, v1, 3, 1
    v_lshl_add_u32 v5, v9, 2, v5
    v_and_b32 v9, 1, v1
    v_lshl_add_u32 v5, v9, 1, v5
    s_cmp_lg_u32 s93, 0
    s_cbranch_scc1 L_HLOC
SPOLL_54:
    s_load_dword s24, s[32:33], s13 offset:1276 glc
    s_load_dword s25, s[32:33], s13 offset:3324 glc
    s_load_dword s26, s[32:33], s13 offset:5372 glc
    s_load_dword s27, s[32:33], s13 offset:7420 glc
SCHK_55:
    s_add_u32 s5, s5, 1
    s_cmp_ge_u32 s5, 300000
    s_waitcnt lgkmcnt(0)
    s_cbranch_scc1 SDONE_56
    s_cmp_lg_u32 s24, s4
    s_cbranch_scc1 SPOLL_54
    s_cmp_lg_u32 s25, s4
    s_cbranch_scc1 SPOLL_54
    s_cmp_lg_u32 s26, s4
    s_cbranch_scc1 SPOLL_54
    s_cmp_lg_u32 s27, s4
    s_cbranch_scc1 SPOLL_54
SDONE_56:
L_HLOC:
    buffer_load_dwordx4 v[212:215], v4, s[32:35], s13 offen sc1
    buffer_load_dwordx4 v[216:219], v4, s[32:35], s13 offen offset:1024 sc1
    s_waitcnt vmcnt(0)
    v_bitop3_b32 v6, v213, v215, s4 bitop3:0x7e
    v_bitop3_b32 v6, v6, v217, s4 bitop3:0xf6
    v_bitop3_b32 v6, v6, v219, s4 bitop3:0xf6
    v_cmp_ne_u32 vcc, 0, v6
    s_cbranch_vccz TOK_58
POLL_59:
    buffer_load_dwordx4 v[212:215], v4, s[32:35], s13 offen sc1
    buffer_load_dwordx4 v[216:219], v4, s[32:35], s13 offen offset:1024 sc1
    s_waitcnt vmcnt(0)
    v_bitop3_b32 v6, v213, v215, s4 bitop3:0x7e
    v_bitop3_b32 v6, v6, v217, s4 bitop3:0xf6
    v_bitop3_b32 v6, v6, v219, s4 bitop3:0xf6
    v_cmp_ne_u32 vcc, 0, v6
    s_cbranch_vccz PDONE_60
    s_add_u32 s5, s5, 1
    s_cmp_lt_u32 s5, 300000
    s_cbranch_scc1 POLL_59
PDONE_60:
TOK_58:
    v_permlane32_swap_b32 v212, v214
    v_permlane32_swap_b32 v216, v218
    v_add_f32 v212, v212, v214
    v_add_f32 v216, v216, v218
    v_mov_b32 v214, v212
    v_mov_b32 v218, v216
    s_nop 0
    v_permlane16_swap_b32 v212, v214
    v_permlane16_swap_b32 v216, v218
    v_add_f32 v212, v212, v214
    v_add_f32 v216, v216, v218
    v_cvt_pk_bf16_f32 v212, 0, v212
    v_cvt_pk_bf16_f32 v216, 0, v216
    v_mul_f32 v6, s7, v212
    v_exp_f32 v6, -v6
    s_nop 0
    v_add_f32 v6, 1.0, v6
    v_rcp_f32 v6, v6
    s_nop 0
    v_mul_f32 v212, v212, v6
    v_cvt_pk_bf16_f32 v212, 0, v212
    v_mul_f32 v212, v212, v216
    v_cvt_pk_bf16_f32 v212, v212, v212
    ds_write_b16 v5, v212
L_NOH:
    v_bfe_u32 v4, v1, 2, 1
    v_lshlrev_b32 v4, 7, v4
    v_lshrrev_b32 v9, 5, v1
    v_lshl_add_u32 v4, v9, 4, v4
    v_add_u32 v4, 138752, v4
    v_lshrrev_b32 v5, 4, v1
    v_mul_u32_u24 v5, 7168, v5
    v_and_b32 v9, 15, v1
    v_lshl_add_u32 v5, v9, 3, v5
    v_and_b32 v6, 1, v1
    v_lshlrev_b32 v6, 18, v6
    v_bfe_u32 v9, v1, 1, 1
    v_lshl_add_u32 v6, v9, 13, v6
    s_lshl3_add_u32 s96, s75, s3
    s_mul_i32 s97, s96, 28672
    s_lshl_b32 s98, s74, 7
    s_add_u32 s99, s97, s98
    s_add_u32 s13, s99, 22020096
    s_lshr_b32 s96, s9, 2
    s_and_b32 s97, s75, 1
    s_lshr_b32 s98, s3, 1
    s_lshl2_add_u32 s99, s97, s98
    s_and_b32 s97, s3, 1
    s_lshl_b32 s98, s97, 2
    s_lshl3_add_u32 s97, s99, s98
    s_lshr_b32 s99, s75, 1
    s_add_u32 s98, s97, s99
    s_lshl_b32 s97, s98, 12
    s_lshl_b32 s99, s8, 6
    s_add_u32 s98, s97, s99
    s_lshl2_add_u32 s97, s96, s98
    s_add_u32 s99, s97, 1048576
    s_add_u32 s14, s99, 3072
    s_waitcnt vmcnt(0)
    s_waitcnt lgkmcnt(0)
    s_barrier
    ds_read_b128 v[212:215], v4
    ds_read_b64_tr_b16 v[196:197], v45
    ds_read_b64_tr_b16 v[198:199], v45 offset:1024
    ds_read_b128 v[216:219], v4 offset:32
    ds_read_b64_tr_b16 v[200:201], v45 offset:8192
    ds_read_b64_tr_b16 v[202:203], v45 offset:9216
    ds_read_b128 v[220:223], v4 offset:64
    ds_read_b64_tr_b16 v[204:205], v45 offset:16384
    ds_read_b64_tr_b16 v[206:207], v45 offset:17408
    ds_read_b128 v[224:227], v4 offset:96
    ds_read_b64_tr_b16 v[208:209], v45 offset:24576
    ds_read_b64_tr_b16 v[210:211], v45 offset:25600
    s_waitcnt lgkmcnt(9)
    v_mfma_f32_32x32x16_bf16 v[228:243], v[212:215], v[196:199], 0
    s_waitcnt lgkmcnt(6)
    v_mfma_f32_32x32x16_bf16 v[228:243], v[216:219], v[200:203], v[228:243]
    s_waitcnt lgkmcnt(3)
    v_mfma_f32_32x32x16_bf16 v[228:243], v[220:223], v[204:207], v[228:243]
    s_waitcnt lgkmcnt(0)
    v_mfma_f32_32x32x16_bf16 v[228:243], v[224:227], v[208:211], v[228:243]
    s_nop 11
    v_mov_b32 v229, s4
    buffer_store_dwordx2 v[228:229], v5, s[32:35], s13 offen sc1
    s_mov_b64 exec, 15
    buffer_store_dword v229, v6, s[32:35], s14 offen sc1
    s_mov_b64 exec, -1
    s_waitcnt lgkmcnt(0)
L_GSEC:
    s_lshl_b32 s96, s21, 7
    s_lshl4_add_u32 s13, s3, s96
    v_lshrrev_b32 v22, 3, v1
    v_lshl_add_u32 v22, v22, 0, s13
    s_lshl_b32 s96, s13, 11
    s_lshl_b32 s97, s12, 7
    s_add_u32 s15, s96, s97
    s_add_u32 s16, s15, 16384
    v_lshrrev_b32 v25, 3, v1
    v_lshlrev_b32 v25, 11, v25
    v_and_b32 v9, 7, v1
    v_lshl_add_u32 v25, v9, 4, v25
    v_cmp_ne_u32 vcc, s70, v22
    v_cmp_ne_u32 s[22:23], s71, v22
    s_nop 0
    s_and_b64 exec, vcc, s[22:23]
    buffer_store_dwordx4 v[140:143], v25, s[64:67], s15 offen sc1
    s_mov_b64 exec, -1
    v_add_u32 v22, 8, v22
    v_cmp_ne_u32 vcc, s70, v22
    v_cmp_ne_u32 s[22:23], s71, v22
    s_nop 0
    s_and_b64 exec, vcc, s[22:23]
    buffer_store_dwordx4 v[144:147], v25, s[64:67], s16 offen sc1
    s_mov_b64 exec, -1
    s_cmp_lt_u32 s9, 16
    s_cbranch_scc1 L_GF
    s_cmp_ge_u32 s9, 28
    s_cbranch_scc1 L_FIN
    s_waitcnt vmcnt(0)
    s_mov_b32 exec_lo, 0xffff
    s_mov_b32 exec_hi, 0xffff
    buffer_store_dwordx2 v[56:57], v58, s[32:35], 0 offen sc1
    s_mov_b64 exec, -1
    s_branch L_FIN
L_GF:
SPOLL_61:
    s_load_dwordx8 s[24:31], s[32:33], s92 offset:3072 glc
SCHK_62:
    s_add_u32 s5, s5, 1
    s_cmp_ge_u32 s5, 300000
    s_waitcnt lgkmcnt(0)
    s_cbranch_scc1 SDONE_63
    s_cmp_lg_u32 s24, s4
    s_cbranch_scc1 SPOLL_61
    s_cmp_lg_u32 s25, s4
    s_cbranch_scc1 SPOLL_61
    s_cmp_lg_u32 s26, s4
    s_cbranch_scc1 SPOLL_61
    s_cmp_lg_u32 s27, s4
    s_cbranch_scc1 SPOLL_61
    s_cmp_lg_u32 s28, s4
    s_cbranch_scc1 SPOLL_61
    s_cmp_lg_u32 s29, s4
    s_cbranch_scc1 SPOLL_61
    s_cmp_lg_u32 s30, s4
    s_cbranch_scc1 SPOLL_61
SDONE_63:
    s_barrier
    s_cmp_eq_u32 s3, 7
    s_cbranch_scc1 L_G7
    s_barrier
    s_mov_b32 exec_lo, 0xffff
    s_mov_b32 exec_hi, 0xffff
    buffer_store_dwordx2 v[56:57], v58, s[32:35], 0 offen sc1
    s_mov_b64 exec, -1
    s_branch L_FIN
L_G7:
    s_cmp_lg_u32 s3, 7
    s_cbranch_scc1 L_FIN
    s_add_u32 s13, s20, 4096
POLL_64:
    buffer_load_dwordx4 v[212:215], v2, s[32:35], s20 offen sc1
    buffer_load_dwordx4 v[216:219], v2, s[32:35], s20 offen offset:1024 sc1
    buffer_load_dwordx4 v[220:223], v2, s[32:35], s20 offen offset:2048 sc1
    buffer_load_dwordx4 v[224:227], v2, s[32:35], s20 offen offset:3072 sc1
    buffer_load_dwordx4 v[148:151], v2, s[32:35], s13 offen sc1
    buffer_load_dwordx4 v[152:155], v2, s[32:35], s13 offen offset:1024 sc1
    buffer_load_dwordx4 v[156:159], v2, s[32:35], s13 offen offset:2048 sc1
    s_waitcnt vmcnt(0)
    v_bitop3_b32 v4, v213, v215, s4 bitop3:0x7e
    v_bitop3_b32 v4, v4, v217, s4 bitop3:0xf6
    v_bitop3_b32 v4, v4, v219, s4 bitop3:0xf6
    v_bitop3_b32 v4, v4, v221, s4 bitop3:0xf6
    v_bitop3_b32 v4, v4, v223, s4 bitop3:0xf6
    v_bitop3_b32 v4, v4, v225, s4 bitop3:0xf6
    v_bitop3_b32 v4, v4, v227, s4 bitop3:0xf6
    v_bitop3_b32 v4, v4, v149, s4 bitop3:0xf6
    v_bitop3_b32 v4, v4, v151, s4 bitop3:0xf6
    v_bitop3_b32 v4, v4, v153, s4 bitop3:0xf6
    v_bitop3_b32 v4, v4, v155, s4 bitop3:0xf6
    v_bitop3_b32 v4, v4, v157, s4 bitop3:0xf6
    v_bitop3_b32 v4, v4, v159, s4 bitop3:0xf6
    v_cmp_ne_u32 vcc, 0, v4
    s_cbranch_vccz PDONE_65
    s_add_u32 s5, s5, 1
    s_cmp_lt_u32 s5, 300000
    s_cbranch_scc1 POLL_64
PDONE_65:
    v_bitop3_b32 v4, v21, v73, s4 bitop3:0x7e
    v_cmp_ne_u32 vcc, 0, v4
    s_cbranch_vccz TOK_66
POLL_67:
    buffer_load_dwordx2 v[20:21], v11, s[32:35], s68 offen sc1
    buffer_load_dwordx2 v[72:73], v11, s[32:35], s69 offen sc1
    s_waitcnt vmcnt(0)
    v_bitop3_b32 v4, v21, v73, s4 bitop3:0x7e
    v_cmp_ne_u32 vcc, 0, v4
    s_cbranch_vccz PDONE_68
    s_add_u32 s5, s5, 1
    s_cmp_lt_u32 s5, 300000
    s_cbranch_scc1 POLL_67
PDONE_68:
TOK_66:
    s_barrier
    v_add_f32 v212, v212, v216
    v_add_f32 v214, v214, v218
    v_add_f32 v220, v220, v224
    v_add_f32 v222, v222, v226
    v_add_f32 v148, v148, v152
    v_add_f32 v150, v150, v154
    v_add_f32 v212, v212, v220
    v_add_f32 v214, v214, v222
    v_add_f32 v148, v148, v156
    v_add_f32 v150, v150, v158
    v_add_f32 v212, v212, v148
    v_add_f32 v214, v214, v150
    v_mov_b32 v213, v214
    v_add_f32_dpp v212, v212, v212 row_ror:8 row_mask:0xf bank_mask:0xf
    s_nop 0
    v_add_f32_dpp v213, v213, v213 row_ror:8 row_mask:0xf bank_mask:0xf
    v_mov_b32 v214, v212
    v_mov_b32 v215, v213
    s_nop 0
    v_permlane16_swap_b32 v212, v214
    v_permlane16_swap_b32 v213, v215
    v_pk_add_f32 v[212:213], v[212:213], v[214:215]
    v_mov_b32 v214, v212
    v_mov_b32 v215, v213
    s_nop 0
    v_permlane32_swap_b32 v212, v214
    v_permlane32_swap_b32 v213, v215
    v_pk_add_f32 v[212:213], v[212:213], v[214:215]
    v_cvt_pk_bf16_f32 v212, 0, v212
    v_cvt_pk_bf16_f32 v213, 0, v213
    v_pk_mul_f32 v[212:213], v[212:213], v[74:75] op_sel:[0,1]
    v_lshlrev_b32 v4, 16, v20
    v_and_b32 v5, s6, v20
    v_cvt_pk_bf16_f32 v212, 0, v212
    v_cvt_pk_bf16_f32 v213, 0, v213
    v_pk_add_f32 v[212:213], v[212:213], v[4:5]
    v_lshlrev_b32 v4, 16, v74
    v_and_b32 v5, s6, v74
    v_cvt_pk_bf16_f32 v212, 0, v212
    v_cvt_pk_bf16_f32 v213, 0, v213
    v_pk_mul_f32 v[212:213], v[212:213], v[4:5]
    v_lshlrev_b32 v4, 16, v72
    v_and_b32 v5, s6, v72
    v_cvt_pk_bf16_f32 v212, 0, v212
    v_cvt_pk_bf16_f32 v213, 0, v213
    v_pk_add_f32 v[212:213], v[212:213], v[4:5]
    v_cvt_pk_bf16_f32 v212, v212, v213
    s_mov_b64 exec, 0xff
    buffer_store_dword v212, v10, s[64:67], s82 offen sc1
    s_mov_b64 exec, -1
    s_mov_b32 exec_lo, 0xffff
    s_mov_b32 exec_hi, 0xffff
    buffer_store_dwordx2 v[56:57], v58, s[32:35], 0 offen sc1
    s_mov_b64 exec, -1
L_FIN:
L_END:
    s_endpgm
.p2align 10
.fill 768, 4, 0xbf800000
.section .rodata,"a"
.p2align 6
.amdhsa_kernel adaLN_cond__linear_kernel_hedgehog__moe_arch_mod__prompt_kernel
  .amdhsa_next_free_vgpr 256
  .amdhsa_next_free_sgpr 102
  .amdhsa_accum_offset 256
  .amdhsa_group_segment_fixed_size 0
  .amdhsa_kernarg_size 112
  .amdhsa_user_sgpr_count 2
  .amdhsa_user_sgpr_kernarg_segment_ptr 1
  .amdhsa_system_sgpr_workgroup_id_x 1
  .amdhsa_float_denorm_mode_32 3
  .amdhsa_float_denorm_mode_16_64 3
.end_amdhsa_kernel
```

```asm
; @launch grid=(256,1,1) block=(512,1,1) lds=163840
.amdgcn_target "amdgcn-amd-amdhsa--gfx950"
.text
.globl adaLN_cond__linear_kernel_hedgehog__moe_arch_mod__prompt_kernel
.p2align 8
.type adaLN_cond__linear_kernel_hedgehog__moe_arch_mod__prompt_kernel,@function
adaLN_cond__linear_kernel_hedgehog__moe_arch_mod__prompt_kernel:
    s_load_dwordx16 s[68:83], s[0:1], 0
    s_load_dwordx8 s[84:91], s[0:1], 64
    s_load_dwordx2 s[32:33], s[0:1], 104
    s_load_dwordx2 s[30:31], s[0:1], 96
    s_cmp_ge_u32 s2, 256
    s_cbranch_scc1 L_END
    v_lshrrev_b32 v4, 6, v0
    v_and_b32 v1, 63, v0
    v_mov_b32 v3, 0
    v_readfirstlane_b32 s3, v4
    v_lshlrev_b32 v2, 4, v1
    s_and_b32 s8, s2, 7
    s_lshr_b32 s9, s2, 3
    s_lshl2_add_u32 s96, s8, s3
    s_lshl_b32 s15, s96, 6
    s_mul_i32 s96, s15, 6144
    s_xor_b32 s97, s9, 1
    s_lshl_b32 s98, s97, 7
    s_add_u32 s13, s96, s98
    v_lshrrev_b32 v60, 3, v1
    v_mul_u32_u24 v60, 49152, v60
    v_and_b32 v9, 7, v1
    v_lshl_add_u32 v60, v9, 4, v60
    v_lshrrev_b32 v61, 3, v1
    v_lshl_add_u32 v61, v61, 3, s15
    s_lshl_b32 s96, s8, 5
    s_add_u32 s97, s96, s9
    s_lshl2_add_u32 s98, s97, s3
    s_sub_u32 s99, s98, 4
    s_lshl_b32 s16, s99, 12
    s_mov_b32 s50, 12582912
    s_mov_b32 s51, 0x20000
    s_mov_b32 s38, 4194304
    s_mov_b32 s39, 0x20000
    s_mov_b32 s34, 268435456
    s_mov_b32 s35, 0x20000
    s_getreg_b32 s94, hwreg(HW_REG_XCC_ID, 0, 3)
    s_getpc_b64 s[22:23]
    s_mul_i32 s96, s9, 7
    s_add_u32 s97, s96, s3
    s_lshl_b32 s19, s97, 7
    v_lshrrev_b32 v10, 5, v1
    v_mul_u32_u24 v10, 28672, v10
    v_add_u32 v10, s19, v10
    v_min_u32 v10, 44032, v10
    s_cmp_ge_u32 s3, 4
    s_waitcnt lgkmcnt(0)
    s_mov_b64 s[48:49], s[88:89]
    s_mov_b64 s[36:37], s[68:69]
    s_load_dword s4, s[32:33], 0
    s_cbranch_scc1 L_FS
    global_load_dwordx2 v[96:97], v61, s[86:87]
    buffer_load_dwordx4 v[80:83], v60, s[48:51], s13 offen nt
    s_add_u32 s13, s13, 12288
    buffer_load_dwordx4 v[84:87], v60, s[48:51], s13 offen nt
    s_add_u32 s13, s13, 12288
    buffer_load_dwordx4 v[88:91], v60, s[48:51], s13 offen nt
    s_add_u32 s13, s13, 12288
    buffer_load_dwordx4 v[92:95], v60, s[48:51], s13 offen nt
    s_barrier
    s_barrier
    s_and_b32 s22, s22, 0xfffffc00
    global_load_dword v78, v10, s[22:23]
    s_mov_b32 s42, 6291456
    s_mov_b32 s43, 0x20000
    s_mov_b32 s46, 2097152
    s_mov_b32 s47, 0x20000
    s_mov_b32 s54, 7340032
    s_mov_b32 s55, 0x20000
    s_mov_b32 s58, 7340032
    s_mov_b32 s59, 0x20000
    s_mov_b32 s62, 7340032
    s_mov_b32 s63, 0x20000
    s_mov_b32 s66, 4194304
    s_mov_b32 s67, 0x20000
    s_mov_b64 s[40:41], s[70:71]
    s_mov_b64 s[44:45], s[74:75]
    s_mov_b64 s[52:53], s[80:81]
    s_mov_b64 s[56:57], s[82:83]
    s_mov_b64 s[60:61], s[84:85]
    s_mov_b64 s[64:65], s[90:91]
    s_mov_b32 s5, 0
    s_mov_b32 s6, 0xffff0000
    s_mov_b32 s7, 0x3fb8aa3b
    s_lshr_b32 s76, s3, 2
    v_bfe_u32 v6, v1, 4, 1
    v_lshlrev_b32 v6, 6, v6
    v_and_b32 v62, 7, v1
    v_lshlrev_b32 v62, 4, v62
    v_xor_b32 v62, v62, v6
    v_lshrrev_b32 v6, 3, v1
    v_mul_u32_u24 v6, 6144, v6
    v_add_u32 v62, v62, v6
    v_lshlrev_b32 v63, 3, v1
    v_add_u32 v64, 149760, v2
    s_and_b32 s96, s3, 3
    s_lshl2_add_u32 s13, s96, 149760
    v_lshrrev_b32 v65, 4, v1
    v_lshl_add_u32 v65, v65, 5, s13
    v_and_b32 v9, 7, v1
    v_lshl_add_u32 v65, v9, 7, v65
    v_bfe_u32 v9, v1, 3, 1
    v_lshl_add_u32 v65, v9, 4, v65
    s_and_b32 s96, s8, 6
    s_and_b32 s97, s8, 1
    s_lshr_b32 s98, s9, 4
    s_lshl1_add_u32 s99, s97, s98
    s_lshl_b32 s97, s99, 6
    s_add_u32 s98, s96, s97
    s_lshl3_add_u32 s99, s3, s98
    s_lshl_b32 s96, s99, 10
    s_and_b32 s97, s9, 15
    s_lshl_b32 s98, s97, 6
    s_add_u32 s99, s96, s98
    s_add_u32 s14, s99, 262144
    s_xor_b32 s96, s9, 1
    s_and_b32 s97, s96, 15
    s_lshl4_add_u32 s98, s3, s97
    s_lshr_b32 s99, s9, 4
    s_lshl1_add_u32 s96, s98, s99
    s_lshl3_add_u32 s97, s96, s8
    s_lshl_b32 s98, s97, 9
    s_add_u32 s13, s98, 524288
    s_lshr_b32 s96, s9, 4
    s_xor_b32 s97, s9, 1
    s_and_b32 s98, s97, 7
    s_lshl_b32 s99, s3, 1
    s_lshl3_add_u32 s97, s98, s99
    s_bfe_u32 s98, s9, 65539
    s_add_u32 s99, s97, s98
    s_lshl_b32 s97, s99, 9
    s_lshl_b32 s98, s8, 6
    s_add_u32 s99, s97, s98
    s_lshl2_add_u32 s97, s96, s99
    s_add_u32 s15, s97, 2097152
    v_and_b32 v10, 3, v1
    v_lshlrev_b32 v10, 15, v10
    s_waitcnt vmcnt(5)
    v_lshlrev_b32 v98, 16, v97
    v_and_b32 v99, s6, v97
    v_and_b32 v97, s6, v96
    v_lshlrev_b32 v96, 16, v96
    v_mul_f32 v4, s7, v96
    v_exp_f32 v4, -v4
    s_nop 0
    v_add_f32 v4, 1.0, v4
    v_rcp_f32 v4, v4
    s_nop 0
    v_mul_f32 v96, v96, v4
    v_cvt_pk_bf16_f32 v96, 0, v96
    v_mul_f32 v5, s7, v97
    v_exp_f32 v5, -v5
    s_nop 0
    v_add_f32 v5, 1.0, v5
    v_rcp_f32 v5, v5
    s_nop 0
    v_mul_f32 v97, v97, v5
    v_cvt_pk_bf16_f32 v97, 0, v97
    v_mul_f32 v4, s7, v98
    v_exp_f32 v4, -v4
    s_nop 0
    v_add_f32 v4, 1.0, v4
    v_rcp_f32 v4, v4
    s_nop 0
    v_mul_f32 v98, v98, v4
    v_cvt_pk_bf16_f32 v98, 0, v98
    v_mul_f32 v5, s7, v99
    v_exp_f32 v5, -v5
    s_nop 0
    v_add_f32 v5, 1.0, v5
    v_rcp_f32 v5, v5
    s_nop 0
    v_mul_f32 v99, v99, v5
    v_cvt_pk_bf16_f32 v99, 0, v99
    s_waitcnt vmcnt(4)
    v_lshlrev_b32 v4, 16, v80
    v_and_b32 v5, s6, v80
    v_pk_mul_f32 v[20:21], v[4:5], v[96:97] op_sel:[0,0] op_sel_hi:[1,0]
    v_lshlrev_b32 v6, 16, v81
    v_and_b32 v7, s6, v81
    v_pk_mul_f32 v[22:23], v[6:7], v[96:97] op_sel:[0,0] op_sel_hi:[1,0]
    v_lshlrev_b32 v4, 16, v82
    v_and_b32 v5, s6, v82
    v_pk_mul_f32 v[24:25], v[4:5], v[96:97] op_sel:[0,0] op_sel_hi:[1,0]
    v_lshlrev_b32 v6, 16, v83
    v_and_b32 v7, s6, v83
    v_pk_mul_f32 v[26:27], v[6:7], v[96:97] op_sel:[0,0] op_sel_hi:[1,0]
    s_waitcnt vmcnt(3)
    v_lshlrev_b32 v4, 16, v84
    v_and_b32 v5, s6, v84
    v_pk_fma_f32 v[20:21], v[4:5], v[96:97], v[20:21] op_sel:[0,1,0] op_sel_hi:[1,1,1]
    v_lshlrev_b32 v6, 16, v85
    v_and_b32 v7, s6, v85
    v_pk_fma_f32 v[22:23], v[6:7], v[96:97], v[22:23] op_sel:[0,1,0] op_sel_hi:[1,1,1]
    v_lshlrev_b32 v4, 16, v86
    v_and_b32 v5, s6, v86
    v_pk_fma_f32 v[24:25], v[4:5], v[96:97], v[24:25] op_sel:[0,1,0] op_sel_hi:[1,1,1]
    v_lshlrev_b32 v6, 16, v87
    v_and_b32 v7, s6, v87
    v_pk_fma_f32 v[26:27], v[6:7], v[96:97], v[26:27] op_sel:[0,1,0] op_sel_hi:[1,1,1]
    s_waitcnt vmcnt(2)
    v_lshlrev_b32 v4, 16, v88
    v_and_b32 v5, s6, v88
    v_pk_fma_f32 v[20:21], v[4:5], v[98:99], v[20:21] op_sel:[0,0,0] op_sel_hi:[1,0,1]
    v_lshlrev_b32 v6, 16, v89
    v_and_b32 v7, s6, v89
    v_pk_fma_f32 v[22:23], v[6:7], v[98:99], v[22:23] op_sel:[0,0,0] op_sel_hi:[1,0,1]
    v_lshlrev_b32 v4, 16, v90
    v_and_b32 v5, s6, v90
    v_pk_fma_f32 v[24:25], v[4:5], v[98:99], v[24:25] op_sel:[0,0,0] op_sel_hi:[1,0,1]
    v_lshlrev_b32 v6, 16, v91
    v_and_b32 v7, s6, v91
    v_pk_fma_f32 v[26:27], v[6:7], v[98:99], v[26:27] op_sel:[0,0,0] op_sel_hi:[1,0,1]
    s_waitcnt vmcnt(1)
    v_lshlrev_b32 v4, 16, v92
    v_and_b32 v5, s6, v92
    v_pk_fma_f32 v[20:21], v[4:5], v[98:99], v[20:21] op_sel:[0,1,0] op_sel_hi:[1,1,1]
    v_lshlrev_b32 v6, 16, v93
    v_and_b32 v7, s6, v93
    v_pk_fma_f32 v[22:23], v[6:7], v[98:99], v[22:23] op_sel:[0,1,0] op_sel_hi:[1,1,1]
    v_lshlrev_b32 v4, 16, v94
    v_and_b32 v5, s6, v94
    v_pk_fma_f32 v[24:25], v[4:5], v[98:99], v[24:25] op_sel:[0,1,0] op_sel_hi:[1,1,1]
    v_lshlrev_b32 v6, 16, v95
    v_and_b32 v7, s6, v95
    v_pk_fma_f32 v[26:27], v[6:7], v[98:99], v[26:27] op_sel:[0,1,0] op_sel_hi:[1,1,1]
    v_permlane32_swap_b32 v20, v24
    v_permlane32_swap_b32 v21, v25
    v_permlane32_swap_b32 v22, v26
    v_permlane32_swap_b32 v23, v27
    v_add_f32 v20, v20, v24
    v_add_f32 v21, v21, v25
    v_add_f32 v22, v22, v26
    v_add_f32 v23, v23, v27
    s_nop 0
    v_permlane16_swap_b32 v20, v22
    v_permlane16_swap_b32 v21, v23
    v_add_f32 v20, v20, v22
    v_add_f32 v21, v21, v23
    s_nop 0
    v_add_f32_dpp v20, v20, v20 row_ror:8 row_mask:0xf bank_mask:0xf
    v_add_f32_dpp v21, v21, v21 row_ror:8 row_mask:0xf bank_mask:0xf
    s_nop 1
    v_mov_b32_dpp v20, v21 quad_perm:[0,1,2,3] row_mask:0xf bank_mask:0xc
    ds_write_b32 v65, v20
    s_waitcnt lgkmcnt(0)
    s_barrier
    ds_read_b128 v[20:23], v64 offset:0
    s_mul_i32 s4, s4, 0x9e3779b1
    s_add_u32 s4, s4, 0x7f4a7c15
    s_waitcnt lgkmcnt(0)
    v_pk_add_f32 v[20:21], v[20:21], v[22:23]
    v_add_f32 v20, v20, v21
    v_mov_b32 v21, s4
    buffer_store_dwordx2 v[20:21], v63, s[32:35], s13 offen sc1
    s_mov_b64 exec, 15
    buffer_store_dword v21, v10, s[32:35], s15 offen sc1
    s_mov_b64 exec, -1
    s_branch L_FJ
L_FS:
    s_barrier
    buffer_load_dwordx4 v[80:83], v2, s[36:39], s16 offen
    buffer_load_dwordx4 v[84:87], v2, s[36:39], s16 offen offset:1024
    buffer_load_dwordx4 v[88:91], v2, s[36:39], s16 offen offset:2048
    buffer_load_dwordx4 v[92:95], v2, s[36:39], s16 offen offset:3072
    s_lshl2_add_u32 s96, s2, s3
    s_sub_u32 s97, s96, 4
    s_lshl_b32 s98, s97, 7
    s_add_u32 s17, s98, 2097152
    s_load_dword s24, s[32:33], s17 offset:0 glc
    s_load_dword s25, s[32:33], s17 offset:64 glc
    s_lshl_b32 s96, s2, 5
    s_add_u32 s97, s96, s3
    s_sub_u32 s98, s97, 4
    s_lshl_b32 s99, s98, 7
    s_add_u32 s17, s99, 1048576
    s_load_dword s24, s[32:33], s17 offset:0 glc
    s_load_dword s25, s[32:33], s17 offset:64 glc
    s_lshl_b32 s19, s94, 5
    v_mov_b32 v78, 1
    v_mov_b32 v79, s19
    s_barrier
    s_cmp_lg_u32 s3, 7
    s_cbranch_scc1 L_NOTK
    s_mov_b64 exec, 1
    global_atomic_add v78, v79, v78, s[30:31] sc0 sc1
    s_mov_b64 exec, -1
    s_branch L_TK0
L_NOTK:
    s_and_b32 s22, s22, 0xfffffc00
    global_load_dword v78, v10, s[22:23]
L_TK0:
    s_mov_b32 s42, 6291456
    s_mov_b32 s43, 0x20000
    s_mov_b32 s46, 2097152
    s_mov_b32 s47, 0x20000
    s_mov_b32 s54, 7340032
    s_mov_b32 s55, 0x20000
    s_mov_b32 s58, 7340032
    s_mov_b32 s59, 0x20000
    s_mov_b32 s62, 7340032
    s_mov_b32 s63, 0x20000
    s_mov_b32 s66, 4194304
    s_mov_b32 s67, 0x20000
    s_mov_b64 s[40:41], s[70:71]
    s_mov_b64 s[44:45], s[74:75]
    s_mov_b64 s[52:53], s[80:81]
    s_mov_b64 s[56:57], s[82:83]
    s_mov_b64 s[60:61], s[84:85]
    s_mov_b64 s[64:65], s[90:91]
    s_mov_b32 s5, 0
    s_mov_b32 s6, 0xffff0000
    s_mov_b32 s7, 0x3fb8aa3b
    s_lshr_b32 s76, s3, 2
    v_bfe_u32 v6, v1, 4, 1
    v_lshlrev_b32 v6, 6, v6
    v_and_b32 v62, 7, v1
    v_lshlrev_b32 v62, 4, v62
    v_xor_b32 v62, v62, v6
    v_lshrrev_b32 v6, 3, v1
    v_mul_u32_u24 v6, 6144, v6
    v_add_u32 v62, v62, v6
    v_lshlrev_b32 v63, 3, v1
    v_add_u32 v64, 149760, v2
    s_and_b32 s96, s3, 3
    s_lshl2_add_u32 s13, s96, 149760
    v_lshrrev_b32 v65, 4, v1
    v_lshl_add_u32 v65, v65, 5, s13
    v_and_b32 v9, 7, v1
    v_lshl_add_u32 v65, v9, 7, v65
    v_bfe_u32 v9, v1, 3, 1
    v_lshl_add_u32 v65, v9, 4, v65
    s_and_b32 s96, s8, 6
    s_and_b32 s97, s8, 1
    s_lshr_b32 s98, s9, 4
    s_lshl1_add_u32 s99, s97, s98
    s_lshl_b32 s97, s99, 6
    s_add_u32 s98, s96, s97
    s_lshl3_add_u32 s99, s3, s98
    s_lshl_b32 s96, s99, 10
    s_and_b32 s97, s9, 15
    s_lshl_b32 s98, s97, 6
    s_add_u32 s99, s96, s98
    s_add_u32 s14, s99, 262144
    s_sub_u32 s96, s3, 4
    s_lshl4_add_u32 s13, s96, 151808
    v_lshrrev_b32 v10, 5, v1
    v_lshl_add_u32 v10, v10, 3, s13
    s_barrier
    s_waitcnt vmcnt(1)
    s_waitcnt lgkmcnt(0)
    s_mul_i32 s4, s4, 0x9e3779b1
    s_add_u32 s4, s4, 0x7f4a7c15
    v_mov_b32 v104, 0x3f803f80
    v_dot2_f32_bf16 v100, v80, v104, 0
    v_dot2_f32_bf16 v102, v80, v80, 0
    v_dot2_f32_bf16 v101, v88, v104, 0
    v_dot2_f32_bf16 v103, v88, v88, 0
    v_dot2_f32_bf16 v100, v81, v104, v100
    v_dot2_f32_bf16 v102, v81, v81, v102
    v_dot2_f32_bf16 v101, v89, v104, v101
    v_dot2_f32_bf16 v103, v89, v89, v103
    v_dot2_f32_bf16 v100, v82, v104, v100
    v_dot2_f32_bf16 v102, v82, v82, v102
    v_dot2_f32_bf16 v101, v90, v104, v101
    v_dot2_f32_bf16 v103, v90, v90, v103
    v_dot2_f32_bf16 v100, v83, v104, v100
    v_dot2_f32_bf16 v102, v83, v83, v102
    v_dot2_f32_bf16 v101, v91, v104, v101
    v_dot2_f32_bf16 v103, v91, v91, v103
    v_dot2_f32_bf16 v100, v84, v104, v100
    v_dot2_f32_bf16 v102, v84, v84, v102
    v_dot2_f32_bf16 v101, v92, v104, v101
    v_dot2_f32_bf16 v103, v92, v92, v103
    v_dot2_f32_bf16 v100, v85, v104, v100
    v_dot2_f32_bf16 v102, v85, v85, v102
    v_dot2_f32_bf16 v101, v93, v104, v101
    v_dot2_f32_bf16 v103, v93, v93, v103
    v_dot2_f32_bf16 v100, v86, v104, v100
    v_dot2_f32_bf16 v102, v86, v86, v102
    v_dot2_f32_bf16 v101, v94, v104, v101
    v_dot2_f32_bf16 v103, v94, v94, v103
    v_dot2_f32_bf16 v100, v87, v104, v100
    v_dot2_f32_bf16 v102, v87, v87, v102
    v_dot2_f32_bf16 v101, v95, v104, v101
    v_dot2_f32_bf16 v103, v95, v95, v103
    s_nop 1
    v_permlane32_swap_b32 v100, v101
    v_permlane32_swap_b32 v102, v103
    v_add_f32 v100, v100, v101
    v_add_f32 v102, v102, v103
    s_nop 1
    v_permlane16_swap_b32 v100, v102
    v_add_f32 v100, v100, v102
    s_nop 1
    v_add_f32_dpp v100, v100, v100 quad_perm:[1,0,3,2] row_mask:0xf bank_mask:0xf
    s_nop 1
    v_add_f32_dpp v100, v100, v100 quad_perm:[2,3,0,1] row_mask:0xf bank_mask:0xf
    s_nop 1
    v_add_f32_dpp v100, v100, v100 row_half_mirror row_mask:0xf bank_mask:0xf
    s_nop 1
    v_add_f32_dpp v100, v100, v100 row_ror:8 row_mask:0xf bank_mask:0xf
    v_mul_f32 v102, 0x3a800000, v100
    v_mul_f32 v100, 0x3a800000, v100
    s_nop 1
    v_permlane16_swap_b32 v100, v102
    v_fma_f32 v117, -v100, v100, v102
    v_cvt_pk_bf16_f32 v116, 0, v100
    v_max_f32 v117, 0, v117
    v_cvt_pk_bf16_f32 v117, 0, v117
    v_add_f32 v117, 0x3727c5ac, v117
    v_cvt_pk_bf16_f32 v117, 0, v117
    v_sqrt_f32 v117, v117
    s_nop 0
    v_cvt_pk_bf16_f32 v117, 0, v117
    v_lshrrev_b32 v116, 16, v116
    v_or_b32 v116, v116, v117
    v_mov_b32 v117, s4
    ds_write_b64 v10, v[116:117]
L_FJ:
    v_and_b32 v5, 3, v1
    v_lshlrev_b32 v5, 4, v5
    v_add_u32 v5, 151808, v5
    v_and_b32 v4, 3, v1
    v_lshlrev_b32 v4, 4, v4
    v_bfe_u32 v9, v1, 2, 1
    v_lshl_add_u32 v4, v9, 10, v4
    v_and_b32 v10, 31, v1
    v_lshlrev_b32 v10, 11, v10
    v_lshrrev_b32 v9, 5, v1
    v_lshl_add_u32 v10, v9, 5, v10
    v_and_b32 v6, 1, v1
    v_lshlrev_b32 v6, 9, v6
    v_bfe_u32 v9, v1, 1, 1
    v_lshl_add_u32 v6, v9, 8, v6
    s_and_b32 s96, s9, 3
    s_and_b32 s97, s8, 6
    s_and_b32 s98, s8, 1
    s_lshr_b32 s99, s9, 4
    s_lshl1_add_u32 s98, s98, s99
    s_lshl_b32 s99, s98, 6
    s_add_u32 s98, s97, s99
    s_lshl3_add_u32 s97, s3, s98
    s_lshl_b32 s99, s97, 9
    s_bfe_u32 s98, s9, 131074
    s_lshl_b32 s97, s98, 6
    s_add_u32 s98, s99, s97
    s_lshl2_add_u32 s99, s96, s98
    s_add_u32 s97, s99, 16
    s_add_u32 s15, s97, 2097152
    s_waitcnt lgkmcnt(0)
    s_barrier
    ds_read_b128 v[116:119], v5
    s_waitcnt lgkmcnt(0)
    s_mov_b64 exec, 0xff
    buffer_store_dwordx4 v[116:119], v4, s[32:35], s14 offen sc1
    s_mov_b64 exec, 15
    buffer_store_dword v117, v6, s[32:35], s15 offen sc1
    s_mov_b64 exec, -1
    s_cmp_lg_u32 s3, 7
    s_cbranch_scc1 L_NOTK2
    s_mov_b32 s13, 0
    s_waitcnt vmcnt(2)
L_TK:
    v_readfirstlane_b32 s15, v78
    s_nop 0
    s_cmp_lt_u32 s15, 32
    s_cbranch_scc1 L_TKOK
    v_mov_b32 v78, s4
    s_mov_b64 exec, 1
    buffer_store_dword v78, v3, s[32:35], 0 offen offset:256 sc1
    s_mov_b64 exec, -1
    s_add_u32 s13, s13, 1
    s_cmp_lt_u32 s13, 8
    s_cbranch_scc0 L_TKNO
    s_add_u32 s94, s94, 1
    s_and_b32 s94, s94, 7
    s_lshl_b32 s19, s94, 5
    v_mov_b32 v78, 1
    v_mov_b32 v79, s19
    s_mov_b64 exec, 1
    global_atomic_add v78, v79, v78, s[30:31] sc0 sc1
    s_mov_b64 exec, -1
    s_waitcnt vmcnt(0)
    s_branch L_TK
L_TKNO:
    s_and_b32 s94, s2, 7
    s_lshr_b32 s15, s2, 3
L_TKOK:
    s_lshl3_add_u32 s15, s15, s94
    v_mov_b32 v78, s15
    ds_write_b32 v5, v78 offset:64
L_NOTK2:
    s_waitcnt lgkmcnt(0)
    s_barrier
    ds_read_b32 v120, v5 offset:64
    s_waitcnt lgkmcnt(0)
    v_readfirstlane_b32 s2, v120
    s_nop 0
    s_and_b32 s8, s2, 7
    s_lshr_b32 s9, s2, 3
    s_and_b32 s96, s8, 1
    s_and_b32 s97, s9, 7
    s_lshl3_add_u32 s12, s96, s97
    s_lshr_b32 s96, s8, 1
    s_lshr_b32 s97, s9, 3
    s_lshl2_add_u32 s21, s96, s97
    s_and_b32 s96, s3, 3
    s_lshl2_add_u32 s94, s21, s96
    s_lshl1_add_u32 s95, s12, s76
    s_lshl_b32 s96, s94, 16
    s_lshl_b32 s97, s95, 6
    s_add_u32 s18, s96, s97
    buffer_load_dwordx4 v[12:15], v10, s[36:39], s18 offen
    buffer_load_dwordx4 v[16:19], v10, s[36:39], s18 offen offset:16
    s_lshr_b32 s96, s8, 1
    s_lshl4_add_u32 s97, s96, s12
    s_lshl4_add_u32 s98, s97, s3
    s_lshl_b32 s99, s98, 9
    s_add_u32 s13, s99, 524288
    s_lshl3_add_u32 s96, s2, s3
    s_lshl_b32 s97, s96, 6
    s_add_u32 s15, s97, 2097152
    s_and_b32 s96, s3, 3
    s_lshl2_add_u32 s97, s2, s96
    s_lshl_b32 s98, s97, 8
    s_add_u32 s14, s98, 262144
    s_load_dwordx8 s[24:31], s[32:33], s15 offset:0 glc
    s_and_b32 s10, s9, 15
    s_lshr_b32 s96, s8, 2
    s_and_b32 s97, s8, 1
    s_lshl1_add_u32 s98, s96, s97
    s_and_b32 s99, s8, 2
    s_lshl2_add_u32 s96, s98, s99
    s_lshr_b32 s97, s9, 4
    s_add_u32 s11, s96, s97
    s_and_b32 s85, s9, 12
    s_lshl_b32 s96, s2, 6
    s_add_u32 s97, s96, s3
    s_lshl_b32 s98, s97, 6
    s_add_u32 s92, s98, 1048576
    s_lshr_b32 s96, s9, 4
    s_xor_b32 s77, s76, s96
    s_lshr_b32 s96, s9, 3
    s_xor_b32 s97, s96, s9
    s_and_b32 s98, s97, 1
    s_lshl2_add_u32 s83, s98, 8
    s_mul_i32 s96, s8, 7
    s_lshr_b32 s97, s9, 2
    s_add_u32 s74, s96, s97
    s_and_b32 s75, s9, 3
    v_and_b32 v8, 31, v1
    v_lshlrev_b32 v8, 3, v8
    v_and_b32 v4, 31, v1
    v_lshlrev_b32 v4, 4, v4
    v_lshrrev_b32 v9, 5, v1
    v_lshl_add_u32 v4, v9, 12, v4
    s_lshl2_add_u32 s16, s3, 152320
    v_lshl_add_u32 v5, v1, 6, s16
    s_lshl_b32 s96, s76, 10
    s_add_u32 s16, s96, 152320
    v_and_b32 v6, 15, v1
    v_lshl_add_u32 v6, v6, 5, s16
    v_lshrrev_b32 v9, 5, v1
    v_lshl_add_u32 v6, v9, 9, v6
    s_branch SCHK_2
SPOLL_1:
    s_load_dwordx8 s[24:31], s[32:33], s15 offset:0 glc
SCHK_2:
    s_add_u32 s5, s5, 1
    s_cmp_ge_u32 s5, 300000
    s_waitcnt lgkmcnt(0)
    s_cbranch_scc1 SDONE_3
    s_cmp_lg_u32 s24, s4
    s_cbranch_scc1 SPOLL_1
    s_cmp_lg_u32 s25, s4
    s_cbranch_scc1 SPOLL_1
    s_cmp_lg_u32 s28, s4
    s_cbranch_scc1 SPOLL_1
    s_cmp_lg_u32 s29, s4
    s_cbranch_scc1 SPOLL_1
    s_cmp_lg_u32 s30, s4
    s_cbranch_scc1 SPOLL_1
    s_cmp_lg_u32 s31, s4
    s_cbranch_scc1 SPOLL_1
SDONE_3:
    buffer_load_dwordx4 v[120:123], v4, s[32:35], s13 offen sc1
    buffer_load_dwordx2 v[116:117], v8, s[32:35], s14 offen sc1
    s_barrier
    s_lshl_b32 s96, s11, 12
    s_lshl_b32 s97, s3, 9
    s_add_u32 s16, s96, s97
    v_add_u32 v10, s16, v2
    s_lshl_b32 s96, s3, 9
    s_add_u32 m0, s96, 156416
    s_mov_b32 exec_hi, 0
    global_load_lds_dwordx4 v10, s[72:73]
    s_mov_b32 exec_hi, -1
    s_and_b32 s20, s9, 3
    s_add_u32 s96, s20, s85
    s_and_b32 s97, s96, 15
    s_lshl3_add_u32 s98, s97, s3
    s_mul_i32 s99, s98, 49152
    s_lshl_b32 s96, s11, 7
    s_add_u32 s82, s99, s96
    s_mul_i32 s96, s20, 24960
    s_lshr_b32 s97, s3, 1
    s_mul_i32 s98, s97, 2080
    s_add_u32 s99, s96, s98
    s_and_b32 s97, s3, 1
    s_mul_i32 s96, s97, 1056
    s_add_u32 s20, s99, s96
    s_mov_b32 m0, s20
    s_nop 0
    buffer_load_dwordx4 v62, s[40:43], s82 offen lds
    s_add_u32 s82, s82, 2048
    s_add_u32 m0, s20, 8320
    s_nop 0
    buffer_load_dwordx4 v62, s[40:43], s82 offen lds
    s_add_u32 s82, s82, 2048
    s_add_u32 m0, s20, 16640
    s_nop 0
    buffer_load_dwordx4 v62, s[40:43], s82 offen lds
    s_waitcnt vmcnt(5)
    v_bitop3_b32 v7, v121, v123, s4 bitop3:0x7e
    v_cmp_ne_u32 vcc, 0, v7
    s_cbranch_vccz TOK_5
POLL_6:
    buffer_load_dwordx4 v[120:123], v4, s[32:35], s13 offen sc1
    s_waitcnt vmcnt(0)
    v_bitop3_b32 v7, v121, v123, s4 bitop3:0x7e
    v_cmp_ne_u32 vcc, 0, v7
    s_cbranch_vccz PDONE_7
    s_add_u32 s5, s5, 1
    s_cmp_lt_u32 s5, 300000
    s_cbranch_scc1 POLL_6
PDONE_7:
TOK_5:
    ds_write2_b32 v5, v120, v122 offset0:0 offset1:8
    v_lshlrev_b32 v100, 16, v12
    v_and_b32 v101, s6, v12
    v_lshlrev_b32 v102, 16, v13
    v_and_b32 v103, s6, v13
    v_lshlrev_b32 v104, 16, v14
    v_and_b32 v105, s6, v14
    v_lshlrev_b32 v106, 16, v15
    v_and_b32 v107, s6, v15
    v_lshlrev_b32 v108, 16, v16
    v_and_b32 v109, s6, v16
    v_lshlrev_b32 v110, 16, v17
    v_and_b32 v111, s6, v17
    v_lshlrev_b32 v112, 16, v18
    v_and_b32 v113, s6, v18
    v_lshlrev_b32 v114, 16, v19
    v_and_b32 v115, s6, v19
    s_waitcnt lgkmcnt(0)
    s_barrier
    ds_read_b128 v[88:91], v6 offset:2048
    ds_read_b128 v[92:95], v6 offset:2064
    ds_read_b128 v[80:83], v6
    ds_read_b128 v[84:87], v6 offset:16
    s_waitcnt vmcnt(4)
    v_cmp_ne_u32 vcc, s4, v117
    s_cbranch_vccz TOK_8
POLL_9:
    buffer_load_dwordx2 v[116:117], v8, s[32:35], s14 offen sc1
    s_waitcnt vmcnt(0)
    v_cmp_ne_u32 vcc, s4, v117
    s_cbranch_vccz PDONE_10
    s_add_u32 s5, s5, 1
    s_cmp_lt_u32 s5, 300000
    s_cbranch_scc1 POLL_9
PDONE_10:
TOK_8:
    v_lshlrev_b32 v117, 16, v116
    v_and_b32 v116, s6, v116
    v_rcp_f32 v116, v116
    s_nop 0
    v_pk_add_f32 v[100:101], v[100:101], v[116:117] op_sel:[0,1] neg_lo:[0,1] neg_hi:[0,1]
    v_pk_add_f32 v[102:103], v[102:103], v[116:117] op_sel:[0,1] neg_lo:[0,1] neg_hi:[0,1]
    v_pk_add_f32 v[104:105], v[104:105], v[116:117] op_sel:[0,1] neg_lo:[0,1] neg_hi:[0,1]
    v_pk_add_f32 v[106:107], v[106:107], v[116:117] op_sel:[0,1] neg_lo:[0,1] neg_hi:[0,1]
    v_pk_add_f32 v[108:109], v[108:109], v[116:117] op_sel:[0,1] neg_lo:[0,1] neg_hi:[0,1]
    v_pk_add_f32 v[110:111], v[110:111], v[116:117] op_sel:[0,1] neg_lo:[0,1] neg_hi:[0,1]
    v_pk_add_f32 v[112:113], v[112:113], v[116:117] op_sel:[0,1] neg_lo:[0,1] neg_hi:[0,1]
    v_pk_add_f32 v[114:115], v[114:115], v[116:117] op_sel:[0,1] neg_lo:[0,1] neg_hi:[0,1]
    s_lshl4_add_u32 s96, s21, s12
    s_and_b32 s97, s3, 3
    s_lshl2_add_u32 s98, s96, s97
    s_lshl1_add_u32 s99, s98, s76
    s_lshl_b32 s96, s99, 11
    s_add_u32 s13, s96, 4194304
    v_and_b32 v8, 15, v1
    v_lshlrev_b32 v8, 4, v8
    v_bfe_u32 v9, v1, 4, 1
    v_lshl_add_u32 v8, v9, 10, v8
    v_lshrrev_b32 v9, 5, v1
    v_lshl_add_u32 v8, v9, 9, v8
    s_waitcnt lgkmcnt(2)
    v_pk_add_f32 v[88:89], v[88:89], v[90:91]
    v_pk_add_f32 v[92:93], v[92:93], v[94:95]
    v_pk_add_f32 v[88:89], v[88:89], v[92:93]
    v_add_f32 v88, v88, v89
    v_cvt_pk_bf16_f32 v88, 0, v88
    s_waitcnt lgkmcnt(0)
    v_pk_add_f32 v[80:81], v[80:81], v[82:83]
    v_pk_add_f32 v[84:85], v[84:85], v[86:87]
    v_pk_add_f32 v[80:81], v[80:81], v[84:85]
    v_add_f32 v80, v80, v81
    v_add_f32 v88, 1.0, v88
    v_cvt_pk_bf16_f32 v88, 0, v88
    v_cvt_pk_bf16_f32 v80, 0, v80
    s_lshl_b32 s96, s3, 8
    s_add_u32 s16, s96, 160512
    v_and_b32 v4, 15, v1
    v_lshl_add_u32 v4, v4, 2, s16
    v_lshrrev_b32 v9, 5, v1
    v_lshl_add_u32 v4, v9, 6, v4
    v_lshrrev_b32 v5, 5, v1
    v_lshl_add_u32 v5, v5, 6, s16
    ds_write2_b32 v4, v88, v80 offset0:0 offset1:32
    ds_read_b128 v[132:135], v5
    ds_read_b128 v[136:139], v5 offset:16
    ds_read_b128 v[140:143], v5 offset:32
    ds_read_b128 v[144:147], v5 offset:48
    ds_read_b128 v[148:151], v5 offset:128
    ds_read_b128 v[152:155], v5 offset:144
    ds_read_b128 v[156:159], v5 offset:160
    ds_read_b128 v[160:163], v5 offset:176
    v_cvt_pk_bf16_f32 v100, 0, v100
    v_cvt_pk_bf16_f32 v101, 0, v101
    v_cvt_pk_bf16_f32 v102, 0, v102
    v_cvt_pk_bf16_f32 v103, 0, v103
    v_cvt_pk_bf16_f32 v104, 0, v104
    v_cvt_pk_bf16_f32 v105, 0, v105
    v_cvt_pk_bf16_f32 v106, 0, v106
    v_cvt_pk_bf16_f32 v107, 0, v107
    v_pk_mul_f32 v[100:101], v[100:101], v[116:117] op_sel_hi:[1,0]
    v_pk_mul_f32 v[102:103], v[102:103], v[116:117] op_sel_hi:[1,0]
    v_pk_mul_f32 v[104:105], v[104:105], v[116:117] op_sel_hi:[1,0]
    v_pk_mul_f32 v[106:107], v[106:107], v[116:117] op_sel_hi:[1,0]
    v_cvt_pk_bf16_f32 v100, 0, v100
    v_cvt_pk_bf16_f32 v101, 0, v101
    v_cvt_pk_bf16_f32 v102, 0, v102
    v_cvt_pk_bf16_f32 v103, 0, v103
    v_cvt_pk_bf16_f32 v104, 0, v104
    v_cvt_pk_bf16_f32 v105, 0, v105
    v_cvt_pk_bf16_f32 v106, 0, v106
    v_cvt_pk_bf16_f32 v107, 0, v107
    v_cvt_pk_bf16_f32 v108, 0, v108
    v_cvt_pk_bf16_f32 v109, 0, v109
    v_cvt_pk_bf16_f32 v110, 0, v110
    v_cvt_pk_bf16_f32 v111, 0, v111
    v_cvt_pk_bf16_f32 v112, 0, v112
    v_cvt_pk_bf16_f32 v113, 0, v113
    v_cvt_pk_bf16_f32 v114, 0, v114
    v_cvt_pk_bf16_f32 v115, 0, v115
    v_pk_mul_f32 v[108:109], v[108:109], v[116:117] op_sel_hi:[1,0]
    v_pk_mul_f32 v[110:111], v[110:111], v[116:117] op_sel_hi:[1,0]
    v_pk_mul_f32 v[112:113], v[112:113], v[116:117] op_sel_hi:[1,0]
    v_pk_mul_f32 v[114:115], v[114:115], v[116:117] op_sel_hi:[1,0]
    v_cvt_pk_bf16_f32 v108, 0, v108
    v_cvt_pk_bf16_f32 v109, 0, v109
    v_cvt_pk_bf16_f32 v110, 0, v110
    v_cvt_pk_bf16_f32 v111, 0, v111
    v_cvt_pk_bf16_f32 v112, 0, v112
    v_cvt_pk_bf16_f32 v113, 0, v113
    v_cvt_pk_bf16_f32 v114, 0, v114
    v_cvt_pk_bf16_f32 v115, 0, v115
    s_waitcnt lgkmcnt(6)
    v_pk_mul_f32 v[100:101], v[100:101], v[132:133]
    v_pk_mul_f32 v[102:103], v[102:103], v[134:135]
    v_pk_mul_f32 v[104:105], v[104:105], v[136:137]
    v_pk_mul_f32 v[106:107], v[106:107], v[138:139]
    v_cvt_pk_bf16_f32 v100, 0, v100
    v_cvt_pk_bf16_f32 v101, 0, v101
    v_cvt_pk_bf16_f32 v102, 0, v102
    v_cvt_pk_bf16_f32 v103, 0, v103
    v_cvt_pk_bf16_f32 v104, 0, v104
    v_cvt_pk_bf16_f32 v105, 0, v105
    v_cvt_pk_bf16_f32 v106, 0, v106
    v_cvt_pk_bf16_f32 v107, 0, v107
    s_waitcnt lgkmcnt(2)
    v_pk_add_f32 v[100:101], v[100:101], v[148:149]
    v_pk_add_f32 v[102:103], v[102:103], v[150:151]
    v_pk_add_f32 v[104:105], v[104:105], v[152:153]
    v_pk_add_f32 v[106:107], v[106:107], v[154:155]
    v_cvt_pk_bf16_f32 v124, v100, v101
    v_cvt_pk_bf16_f32 v125, v102, v103
    v_cvt_pk_bf16_f32 v126, v104, v105
    v_cvt_pk_bf16_f32 v127, v106, v107
    buffer_store_dwordx4 v[124:127], v8, s[32:35], s13 offen sc1
    v_pk_mul_f32 v[108:109], v[108:109], v[140:141]
    v_pk_mul_f32 v[110:111], v[110:111], v[142:143]
    v_pk_mul_f32 v[112:113], v[112:113], v[144:145]
    v_pk_mul_f32 v[114:115], v[114:115], v[146:147]
    v_cvt_pk_bf16_f32 v108, 0, v108
    v_cvt_pk_bf16_f32 v109, 0, v109
    v_cvt_pk_bf16_f32 v110, 0, v110
    v_cvt_pk_bf16_f32 v111, 0, v111
    v_cvt_pk_bf16_f32 v112, 0, v112
    v_cvt_pk_bf16_f32 v113, 0, v113
    v_cvt_pk_bf16_f32 v114, 0, v114
    v_cvt_pk_bf16_f32 v115, 0, v115
    s_waitcnt lgkmcnt(0)
    v_pk_add_f32 v[108:109], v[108:109], v[156:157]
    v_pk_add_f32 v[110:111], v[110:111], v[158:159]
    v_pk_add_f32 v[112:113], v[112:113], v[160:161]
    v_pk_add_f32 v[114:115], v[114:115], v[162:163]
    v_cvt_pk_bf16_f32 v128, v108, v109
    v_cvt_pk_bf16_f32 v129, v110, v111
    v_cvt_pk_bf16_f32 v130, v112, v113
    v_cvt_pk_bf16_f32 v131, v114, v115
    buffer_store_dwordx4 v[128:131], v8, s[32:35], s13 offen offset:256 sc1
    v_lshrrev_b32 v66, 5, v1
    v_mul_u32_u24 v66, 2080, v66
    v_bfe_u32 v9, v1, 2, 2
    v_lshl_add_u32 v66, v9, 7, v66
    v_bfe_u32 v9, v1, 3, 1
    v_lshl_add_u32 v66, v9, 6, v66
    v_and_b32 v9, 3, v1
    v_lshl_add_u32 v66, v9, 3, v66
    v_bfe_u32 v67, v1, 4, 1
    v_mul_u32_u24 v67, 1056, v67
    v_bfe_u32 v68, v1, 3, 1
    v_lshlrev_b32 v68, 7, v68
    v_add_u32 v66, v66, v67
    v_sub_u32 v67, v66, v68
    v_add_u32 v67, 64, v67
    v_add_u32 v68, 49920, v66
    v_add_u32 v69, 49920, v67
    v_add_u32 v70, 99840, v66
    v_add_u32 v71, 99840, v67
    s_lshl_b32 s96, s76, 11
    s_add_u32 s14, s96, 156416
    v_bfe_u32 v4, v1, 2, 2
    v_lshl_add_u32 v4, v4, 6, s14
    v_bfe_u32 v9, v1, 4, 1
    v_lshl_add_u32 v4, v9, 5, v4
    v_and_b32 v9, 3, v1
    v_lshl_add_u32 v4, v9, 3, v4
    v_lshrrev_b32 v9, 5, v1
    v_lshl_add_u32 v4, v9, 9, v4
    v_and_b32 v5, 7, v1
    v_lshlrev_b32 v5, 12, v5
    v_bfe_u32 v9, v1, 3, 1
    v_lshl_add_u32 v5, v9, 19, v5
    s_and_b32 s96, s12, 1
    s_lshl_b32 s97, s21, 15
    s_lshr_b32 s98, s12, 1
    s_lshl_b32 s99, s98, 6
    s_add_u32 s98, s97, s99
    s_lshl2_add_u32 s97, s96, s98
    s_add_u32 s13, s97, 1048576
    v_bfe_u32 v6, v1, 4, 1
    v_lshlrev_b32 v6, 6, v6
    v_lshrrev_b32 v9, 5, v1
    v_lshl_add_u32 v6, v9, 4, v6
    v_and_b32 v74, 7, v1
    v_lshlrev_b32 v74, 4, v74
    v_xor_b32 v74, v74, v6
    v_lshrrev_b32 v6, 3, v1
    v_lshlrev_b32 v6, 11, v6
    v_add_u32 v74, v74, v6
    s_and_b32 s96, s3, 2
    s_lshl_b32 s14, s96, 5
    v_bfe_u32 v6, v1, 4, 1
    v_lshl_add_u32 v6, v6, 5, s14
    v_and_b32 v72, 7, v1
    v_lshlrev_b32 v72, 4, v72
    v_xor_b32 v72, v72, v6
    v_lshrrev_b32 v6, 3, v1
    v_mul_u32_u24 v6, 7168, v6
    v_add_u32 v72, v72, v6
    s_and_b32 s96, s3, 1
    s_lshl_b32 s14, s96, 7
    v_lshrrev_b32 v6, 5, v1
    v_lshl_add_u32 v6, v6, 6, s14
    v_and_b32 v73, 31, v1
    v_lshlrev_b32 v73, 4, v73
    v_lshrrev_b32 v9, 5, v1
    v_lshl_add_u32 v73, v9, 11, v73
    v_xor_b32 v73, v73, v6
    s_lshl3_add_u32 s96, s75, s3
    s_mul_i32 s97, s96, 229376
    s_lshl_b32 s98, s74, 7
    s_add_u32 s80, s97, s98
    s_lshl3_add_u32 s96, s74, s3
    s_lshl_b32 s97, s96, 14
    s_lshl_b32 s98, s75, 9
    s_add_u32 s81, s97, s98
    s_cmp_ge_u32 s9, 28
    s_cselect_b32 s54, 0, s54
    s_cselect_b32 s58, 0, s58
    s_cselect_b32 s62, 0, s62
    s_waitcnt vmcnt(0)
    s_barrier
    s_cmp_lg_u32 s3, 0
    s_cbranch_scc1 L_PB
    v_mov_b32 v6, s4
    s_mov_b32 exec_hi, 0
    s_mov_b32 exec_lo, 65535
    buffer_store_dword v6, v5, s[32:35], s13 offen sc1
    s_mov_b64 exec, -1
L_PB:
    s_and_b32 s20, s9, 3
    s_cmp_le_u32 s20, 0
    s_cselect_b32 s20, 1, 0
    s_add_u32 s96, s20, s85
    s_and_b32 s97, s96, 15
    s_lshl3_add_u32 s98, s97, s3
    s_mul_i32 s99, s98, 49152
    s_lshl_b32 s96, s11, 7
    s_add_u32 s82, s99, s96
    s_mul_i32 s96, s20, 24960
    s_lshr_b32 s97, s3, 1
    s_mul_i32 s98, s97, 2080
    s_add_u32 s99, s96, s98
    s_and_b32 s97, s3, 1
    s_mul_i32 s96, s97, 1056
    s_add_u32 s20, s99, s96
    s_mov_b32 m0, s20
    s_nop 0
    buffer_load_dwordx4 v62, s[40:43], s82 offen lds
    s_add_u32 s82, s82, 2048
    s_add_u32 m0, s20, 8320
    s_nop 0
    buffer_load_dwordx4 v62, s[40:43], s82 offen lds
    s_add_u32 s82, s82, 2048
    s_add_u32 m0, s20, 16640
    s_nop 0
    buffer_load_dwordx4 v62, s[40:43], s82 offen lds
    s_and_b32 s20, s9, 3
    s_cmp_le_u32 s20, 1
    s_cselect_b32 s20, 2, 1
    s_add_u32 s96, s20, s85
    s_and_b32 s97, s96, 15
    s_lshl3_add_u32 s98, s97, s3
    s_mul_i32 s99, s98, 49152
    s_lshl_b32 s96, s11, 7
    s_add_u32 s82, s99, s96
    s_mul_i32 s96, s20, 24960
    s_lshr_b32 s97, s3, 1
    s_mul_i32 s98, s97, 2080
    s_add_u32 s99, s96, s98
    s_and_b32 s97, s3, 1
    s_mul_i32 s96, s97, 1056
    s_add_u32 s20, s99, s96
    s_mov_b32 m0, s20
    s_nop 0
    buffer_load_dwordx4 v62, s[40:43], s82 offen lds
    s_add_u32 s82, s82, 2048
    s_add_u32 m0, s20, 8320
    s_nop 0
    buffer_load_dwordx4 v62, s[40:43], s82 offen lds
    s_add_u32 s82, s82, 2048
    s_add_u32 m0, s20, 16640
    s_nop 0
    buffer_load_dwordx4 v62, s[40:43], s82 offen lds
    ds_read_b64_tr_b16 v[28:29], v4
    ds_read_b64_tr_b16 v[30:31], v4 offset:256
    ds_read_b64_tr_b16 v[32:33], v4 offset:1024
    ds_read_b64_tr_b16 v[34:35], v4 offset:1280
    s_lshl_b32 s96, s10, 6
    s_add_u32 s97, s96, s3
    s_lshl_b32 s98, s97, 12
    s_add_u32 s15, s98, 4194304
    s_and_b32 s96, s3, 3
    s_lshl_b32 s97, s96, 12
    s_add_u32 s13, s97, 147456
    v_add_u32 v76, s13, v2
    v_and_b32 v77, 15, v1
    v_lshl_add_u32 v77, v77, 4, s13
    v_lshrrev_b32 v9, 5, v1
    v_lshl_add_u32 v77, v9, 9, v77
    v_bfe_u32 v9, v1, 4, 1
    v_lshl_add_u32 v77, v9, 3, v77
    s_and_b32 s96, s3, 3
    s_lshl_b32 s97, s96, 10
    s_add_u32 s13, s97, 32768
    v_and_b32 v78, 15, v1
    v_lshl_add_u32 v78, v78, 5, s13
    v_lshrrev_b32 v9, 4, v1
    v_lshl_add_u32 v78, v9, 3, v78
    s_and_b32 s96, s3, 3
    s_lshl_b32 s97, s96, 10
    s_lshl_b32 s98, s76, 14
    s_add_u32 s13, s97, s98
    v_and_b32 v75, 31, v1
    v_lshl_add_u32 v75, v75, 5, s13
    v_lshrrev_b32 v9, 5, v1
    v_lshl_add_u32 v75, v9, 4, v75
    s_lshl_b32 s84, s3, 14
    s_lshr_b32 s96, s9, 4
    s_lshl_b32 s97, s96, 20
    s_lshl_b32 s98, s12, 7
    s_add_u32 s88, s97, s98
    s_lshl_b32 s89, s3, 10
    s_load_dwordx2 s[24:25], s[32:33], s92 offset:0 glc
    s_and_b32 s20, s9, 3
    s_cmp_le_u32 s20, 2
    s_cselect_b32 s20, 3, 2
    s_add_u32 s96, s20, s85
    s_and_b32 s97, s96, 15
    s_lshl3_add_u32 s98, s97, s3
    s_mul_i32 s99, s98, 49152
    s_lshl_b32 s96, s11, 7
    s_add_u32 s82, s99, s96
    s_mul_i32 s96, s20, 24960
    s_lshr_b32 s97, s3, 1
    s_mul_i32 s98, s97, 2080
    s_add_u32 s99, s96, s98
    s_and_b32 s97, s3, 1
    s_mul_i32 s96, s97, 1056
    s_add_u32 s20, s99, s96
    s_mov_b32 m0, s20
    s_nop 0
    buffer_load_dwordx4 v62, s[40:43], s82 offen lds
    s_add_u32 s82, s82, 2048
    s_add_u32 m0, s20, 8320
    s_nop 0
    buffer_load_dwordx4 v62, s[40:43], s82 offen lds
    s_add_u32 s82, s82, 2048
    s_add_u32 m0, s20, 16640
    s_nop 0
    buffer_load_dwordx4 v62, s[40:43], s82 offen lds
    s_add_u32 s96, s85, 4
    s_and_b32 s97, s96, 15
    s_lshl3_add_u32 s98, s97, s3
    s_mul_i32 s99, s98, 49152
    s_lshl_b32 s96, s11, 7
    s_add_u32 s82, s99, s96
    s_lshr_b32 s96, s3, 1
    s_mul_i32 s97, s96, 2080
    s_and_b32 s98, s3, 1
    s_mul_i32 s99, s98, 1056
    s_add_u32 s96, s97, s99
    s_add_u32 s20, s96, 99840
    s_mov_b32 m0, s20
    s_nop 0
    buffer_load_dwordx4 v62, s[40:43], s82 offen lds
    s_add_u32 s82, s82, 2048
    s_add_u32 m0, s20, 8320
    s_nop 0
    buffer_load_dwordx4 v62, s[40:43], s82 offen lds
    s_add_u32 s82, s82, 2048
    s_add_u32 m0, s20, 16640
    s_nop 0
    buffer_load_dwordx4 v62, s[40:43], s82 offen lds
    s_branch SCHK_12
SPOLL_11:
    s_load_dwordx2 s[24:25], s[32:33], s92 offset:0 glc
SCHK_12:
    s_add_u32 s5, s5, 1
    s_cmp_ge_u32 s5, 300000
    s_waitcnt lgkmcnt(0)
    s_cbranch_scc1 SDONE_13
    s_cmp_lg_u32 s24, s4
    s_cbranch_scc1 SPOLL_11
    s_cmp_lg_u32 s25, s4
    s_cbranch_scc1 SPOLL_11
SDONE_13:
    s_waitcnt vmcnt(9)
    s_barrier
    s_cmp_ge_u32 s3, 4
    s_cbranch_scc1 L_HELP
    s_setprio 2
    s_and_b32 s96, s85, 15
    s_lshl_b32 s97, s96, 14
    s_add_u32 s16, s97, s15
    buffer_load_dwordx4 v[176:179], v2, s[32:35], s16 offen sc1
    buffer_load_dwordx4 v[180:183], v2, s[32:35], s16 offen offset:1024 sc1
    ds_read_b64_tr_b16 v[224:225], v67 offset:8320
    ds_read_b64_tr_b16 v[226:227], v67 offset:8832
    ds_read_b64_tr_b16 v[228:229], v67 offset:8352
    ds_read_b64_tr_b16 v[230:231], v67 offset:8864
    ds_read_b64_tr_b16 v[232:233], v66 offset:8320
    ds_read_b64_tr_b16 v[234:235], v66 offset:8832
    ds_read_b64_tr_b16 v[236:237], v66 offset:8352
    ds_read_b64_tr_b16 v[238:239], v66 offset:8864
    ds_read_b64_tr_b16 v[240:241], v66
    ds_read_b64_tr_b16 v[242:243], v66 offset:512
    ds_read_b64_tr_b16 v[244:245], v66 offset:32
    ds_read_b64_tr_b16 v[246:247], v66 offset:544
    buffer_load_dwordx4 v[184:187], v2, s[32:35], s16 offen offset:2048 sc1
    buffer_load_dwordx4 v[188:191], v2, s[32:35], s16 offen offset:3072 sc1
    s_waitcnt lgkmcnt(8)
    s_waitcnt vmcnt(3)
    v_mfma_f32_16x16x32_bf16 v[128:131], v[224:227], v[176:179], 0
    ds_read_b64_tr_b16 v[248:249], v67
    s_waitcnt vmcnt(2)
    v_mfma_f32_16x16x32_bf16 v[132:135], v[224:227], v[180:183], 0
    ds_read_b64_tr_b16 v[250:251], v67 offset:512
    s_add_u32 s96, s85, 1
    s_and_b32 s97, s96, 15
    s_lshl_b32 s98, s97, 14
    s_add_u32 s16, s98, s15
    buffer_load_dwordx4 v[192:195], v2, s[32:35], s16 offen sc1
    v_mfma_f32_16x16x32_bf16 v[136:139], v[228:231], v[176:179], 0
    ds_read_b64_tr_b16 v[224:225], v67 offset:32
    v_mfma_f32_16x16x32_bf16 v[140:143], v[228:231], v[180:183], 0
    ds_read_b64_tr_b16 v[226:227], v67 offset:544
    s_waitcnt lgkmcnt(8)
    v_mfma_f32_16x16x32_bf16 v[112:115], v[232:235], v[176:179], 0
    ds_read_b64_tr_b16 v[228:229], v66 offset:16640
    v_mfma_f32_16x16x32_bf16 v[116:119], v[232:235], v[180:183], 0
    ds_read_b64_tr_b16 v[230:231], v66 offset:17152
    v_mfma_f32_16x16x32_bf16 v[120:123], v[236:239], v[176:179], 0
    ds_read_b64_tr_b16 v[232:233], v66 offset:16672
    v_mfma_f32_16x16x32_bf16 v[124:127], v[236:239], v[180:183], 0
    ds_read_b64_tr_b16 v[234:235], v66 offset:17184
    buffer_load_dwordx4 v[196:199], v2, s[32:35], s16 offen offset:1024 sc1
    s_waitcnt lgkmcnt(8)
    v_mfma_f32_16x16x32_bf16 v[80:83], v[240:243], v[176:179], 0
    ds_read_b64_tr_b16 v[236:237], v67 offset:16640
    v_mfma_f32_16x16x32_bf16 v[84:87], v[240:243], v[180:183], 0
    ds_read_b64_tr_b16 v[238:239], v67 offset:17152
    v_mfma_f32_16x16x32_bf16 v[88:91], v[244:247], v[176:179], 0
    ds_read_b64_tr_b16 v[240:241], v67 offset:16672
    v_mfma_f32_16x16x32_bf16 v[92:95], v[244:247], v[180:183], 0
    ds_read_b64_tr_b16 v[242:243], v67 offset:17184
    s_waitcnt lgkmcnt(8)
    v_mfma_f32_16x16x32_bf16 v[96:99], v[248:251], v[176:179], 0
    ds_read_b64_tr_b16 v[244:245], v67 offset:12480
    v_mfma_f32_16x16x32_bf16 v[100:103], v[248:251], v[180:183], 0
    ds_read_b64_tr_b16 v[246:247], v67 offset:12992
    buffer_load_dwordx4 v[200:203], v2, s[32:35], s16 offen offset:2048 sc1
    v_mfma_f32_16x16x32_bf16 v[104:107], v[224:227], v[176:179], 0
    ds_read_b64_tr_b16 v[248:249], v67 offset:12512
    v_mfma_f32_16x16x32_bf16 v[108:111], v[224:227], v[180:183], 0
    ds_read_b64_tr_b16 v[250:251], v67 offset:13024
    s_waitcnt lgkmcnt(8)
    v_mfma_f32_16x16x32_bf16 v[144:147], v[228:231], v[176:179], 0
    ds_read_b64_tr_b16 v[224:225], v66 offset:12480
    v_mfma_f32_16x16x32_bf16 v[148:151], v[228:231], v[180:183], 0
    ds_read_b64_tr_b16 v[226:227], v66 offset:12992
    v_mfma_f32_16x16x32_bf16 v[152:155], v[232:235], v[176:179], 0
    ds_read_b64_tr_b16 v[228:229], v66 offset:12512
    v_mfma_f32_16x16x32_bf16 v[156:159], v[232:235], v[180:183], 0
    ds_read_b64_tr_b16 v[230:231], v66 offset:13024
    buffer_load_dwordx4 v[204:207], v2, s[32:35], s16 offen offset:3072 sc1
    s_waitcnt lgkmcnt(8)
    v_mfma_f32_16x16x32_bf16 v[160:163], v[236:239], v[176:179], 0
    ds_read_b64_tr_b16 v[232:233], v66 offset:4160
    v_mfma_f32_16x16x32_bf16 v[164:167], v[236:239], v[180:183], 0
    ds_read_b64_tr_b16 v[234:235], v66 offset:4672
    v_mfma_f32_16x16x32_bf16 v[168:171], v[240:243], v[176:179], 0
    ds_read_b64_tr_b16 v[236:237], v66 offset:4192
    v_mfma_f32_16x16x32_bf16 v[172:175], v[240:243], v[180:183], 0
    ds_read_b64_tr_b16 v[238:239], v66 offset:4704
    s_waitcnt lgkmcnt(8)
    s_waitcnt vmcnt(5)
    v_mfma_f32_16x16x32_bf16 v[128:131], v[244:247], v[184:187], v[128:131]
    ds_read_b64_tr_b16 v[240:241], v67 offset:4160
    s_waitcnt vmcnt(4)
    v_mfma_f32_16x16x32_bf16 v[132:135], v[244:247], v[188:191], v[132:135]
    ds_read_b64_tr_b16 v[242:243], v67 offset:4672
    s_add_u32 s96, s85, 2
    s_and_b32 s97, s96, 15
    s_lshl_b32 s98, s97, 14
    s_add_u32 s16, s98, s15
    buffer_load_dwordx4 v[208:211], v2, s[32:35], s16 offen sc1
    v_mfma_f32_16x16x32_bf16 v[136:139], v[248:251], v[184:187], v[136:139]
    ds_read_b64_tr_b16 v[244:245], v67 offset:4192
    v_mfma_f32_16x16x32_bf16 v[140:143], v[248:251], v[188:191], v[140:143]
    ds_read_b64_tr_b16 v[246:247], v67 offset:4704
    s_waitcnt lgkmcnt(8)
    v_mfma_f32_16x16x32_bf16 v[112:115], v[224:227], v[184:187], v[112:115]
    ds_read_b64_tr_b16 v[248:249], v66 offset:20800
    v_mfma_f32_16x16x32_bf16 v[116:119], v[224:227], v[188:191], v[116:119]
    ds_read_b64_tr_b16 v[250:251], v66 offset:21312
    v_mfma_f32_16x16x32_bf16 v[120:123], v[228:231], v[184:187], v[120:123]
    ds_read_b64_tr_b16 v[224:225], v66 offset:20832
    v_mfma_f32_16x16x32_bf16 v[124:127], v[228:231], v[188:191], v[124:127]
    ds_read_b64_tr_b16 v[226:227], v66 offset:21344
    buffer_load_dwordx4 v[212:215], v2, s[32:35], s16 offen offset:1024 sc1
    s_waitcnt lgkmcnt(8)
    v_mfma_f32_16x16x32_bf16 v[80:83], v[232:235], v[184:187], v[80:83]
    ds_read_b64_tr_b16 v[228:229], v67 offset:20800
    v_mfma_f32_16x16x32_bf16 v[84:87], v[232:235], v[188:191], v[84:87]
    ds_read_b64_tr_b16 v[230:231], v67 offset:21312
    v_mfma_f32_16x16x32_bf16 v[88:91], v[236:239], v[184:187], v[88:91]
    ds_read_b64_tr_b16 v[232:233], v67 offset:20832
    v_mfma_f32_16x16x32_bf16 v[92:95], v[236:239], v[188:191], v[92:95]
    ds_read_b64_tr_b16 v[234:235], v67 offset:21344
    s_waitcnt lgkmcnt(8)
    v_mfma_f32_16x16x32_bf16 v[96:99], v[240:243], v[184:187], v[96:99]
    s_barrier
    ds_read_b64_tr_b16 v[236:237], v67 offset:33280
    v_mfma_f32_16x16x32_bf16 v[100:103], v[240:243], v[188:191], v[100:103]
    ds_read_b64_tr_b16 v[238:239], v67 offset:33792
    buffer_load_dwordx4 v[216:219], v2, s[32:35], s16 offen offset:2048 sc1
    v_mfma_f32_16x16x32_bf16 v[104:107], v[244:247], v[184:187], v[104:107]
    ds_read_b64_tr_b16 v[240:241], v67 offset:33312
    v_mfma_f32_16x16x32_bf16 v[108:111], v[244:247], v[188:191], v[108:111]
    ds_read_b64_tr_b16 v[242:243], v67 offset:33824
    s_waitcnt lgkmcnt(8)
    v_mfma_f32_16x16x32_bf16 v[144:147], v[248:251], v[184:187], v[144:147]
    ds_read_b64_tr_b16 v[244:245], v66 offset:33280
    v_mfma_f32_16x16x32_bf16 v[148:151], v[248:251], v[188:191], v[148:151]
    ds_read_b64_tr_b16 v[246:247], v66 offset:33792
    v_mfma_f32_16x16x32_bf16 v[152:155], v[224:227], v[184:187], v[152:155]
    ds_read_b64_tr_b16 v[248:249], v66 offset:33312
    v_mfma_f32_16x16x32_bf16 v[156:159], v[224:227], v[188:191], v[156:159]
    ds_read_b64_tr_b16 v[250:251], v66 offset:33824
    buffer_load_dwordx4 v[220:223], v2, s[32:35], s16 offen offset:3072 sc1
    s_waitcnt lgkmcnt(8)
    v_mfma_f32_16x16x32_bf16 v[160:163], v[228:231], v[184:187], v[160:163]
    ds_read_b64_tr_b16 v[224:225], v66 offset:24960
    v_mfma_f32_16x16x32_bf16 v[164:167], v[228:231], v[188:191], v[164:167]
    ds_read_b64_tr_b16 v[226:227], v66 offset:25472
    v_mfma_f32_16x16x32_bf16 v[168:171], v[232:235], v[184:187], v[168:171]
    ds_read_b64_tr_b16 v[228:229], v66 offset:24992
    v_mfma_f32_16x16x32_bf16 v[172:175], v[232:235], v[188:191], v[172:175]
    ds_read_b64_tr_b16 v[230:231], v66 offset:25504
    s_waitcnt lgkmcnt(8)
    s_waitcnt vmcnt(6)
    v_mfma_f32_16x16x32_bf16 v[128:131], v[236:239], v[192:195], v[128:131]
    ds_read_b64_tr_b16 v[232:233], v67 offset:24960
    v_mfma_f32_16x16x32_bf16 v[132:135], v[236:239], v[196:199], v[132:135]
    ds_read_b64_tr_b16 v[234:235], v67 offset:25472
    s_add_u32 s96, s85, 3
    s_and_b32 s97, s96, 15
    s_lshl_b32 s98, s97, 14
    s_add_u32 s16, s98, s15
    buffer_load_dwordx4 v[176:179], v2, s[32:35], s16 offen sc1
    v_mfma_f32_16x16x32_bf16 v[136:139], v[240:243], v[192:195], v[136:139]
    ds_read_b64_tr_b16 v[236:237], v67 offset:24992
    v_mfma_f32_16x16x32_bf16 v[140:143], v[240:243], v[196:199], v[140:143]
    ds_read_b64_tr_b16 v[238:239], v67 offset:25504
    s_waitcnt lgkmcnt(8)
    v_mfma_f32_16x16x32_bf16 v[112:115], v[244:247], v[192:195], v[112:115]
    ds_read_b64_tr_b16 v[240:241], v66 offset:41600
    v_mfma_f32_16x16x32_bf16 v[116:119], v[244:247], v[196:199], v[116:119]
    ds_read_b64_tr_b16 v[242:243], v66 offset:42112
    v_mfma_f32_16x16x32_bf16 v[120:123], v[248:251], v[192:195], v[120:123]
    ds_read_b64_tr_b16 v[244:245], v66 offset:41632
    v_mfma_f32_16x16x32_bf16 v[124:127], v[248:251], v[196:199], v[124:127]
    ds_read_b64_tr_b16 v[246:247], v66 offset:42144
    buffer_load_dwordx4 v[180:183], v2, s[32:35], s16 offen offset:1024 sc1
    s_waitcnt lgkmcnt(8)
    v_mfma_f32_16x16x32_bf16 v[80:83], v[224:227], v[192:195], v[80:83]
    ds_read_b64_tr_b16 v[248:249], v67 offset:41600
    v_mfma_f32_16x16x32_bf16 v[84:87], v[224:227], v[196:199], v[84:87]
    ds_read_b64_tr_b16 v[250:251], v67 offset:42112
    v_mfma_f32_16x16x32_bf16 v[88:91], v[228:231], v[192:195], v[88:91]
    ds_read_b64_tr_b16 v[224:225], v67 offset:41632
    v_mfma_f32_16x16x32_bf16 v[92:95], v[228:231], v[196:199], v[92:95]
    ds_read_b64_tr_b16 v[226:227], v67 offset:42144
    s_waitcnt lgkmcnt(8)
    v_mfma_f32_16x16x32_bf16 v[96:99], v[232:235], v[192:195], v[96:99]
    ds_read_b64_tr_b16 v[228:229], v67 offset:37440
    v_mfma_f32_16x16x32_bf16 v[100:103], v[232:235], v[196:199], v[100:103]
    ds_read_b64_tr_b16 v[230:231], v67 offset:37952
    buffer_load_dwordx4 v[184:187], v2, s[32:35], s16 offen offset:2048 sc1
    v_mfma_f32_16x16x32_bf16 v[104:107], v[236:239], v[192:195], v[104:107]
    ds_read_b64_tr_b16 v[232:233], v67 offset:37472
    v_mfma_f32_16x16x32_bf16 v[108:111], v[236:239], v[196:199], v[108:111]
    ds_read_b64_tr_b16 v[234:235], v67 offset:37984
    s_waitcnt lgkmcnt(8)
    v_mfma_f32_16x16x32_bf16 v[144:147], v[240:243], v[192:195], v[144:147]
    ds_read_b64_tr_b16 v[236:237], v66 offset:37440
    v_mfma_f32_16x16x32_bf16 v[148:151], v[240:243], v[196:199], v[148:151]
    ds_read_b64_tr_b16 v[238:239], v66 offset:37952
    v_mfma_f32_16x16x32_bf16 v[152:155], v[244:247], v[192:195], v[152:155]
    ds_read_b64_tr_b16 v[240:241], v66 offset:37472
    v_mfma_f32_16x16x32_bf16 v[156:159], v[244:247], v[196:199], v[156:159]
    ds_read_b64_tr_b16 v[242:243], v66 offset:37984
    buffer_load_dwordx4 v[188:191], v2, s[32:35], s16 offen offset:3072 sc1
    s_waitcnt lgkmcnt(8)
    v_mfma_f32_16x16x32_bf16 v[160:163], v[248:251], v[192:195], v[160:163]
    ds_read_b64_tr_b16 v[244:245], v66 offset:29120
    v_mfma_f32_16x16x32_bf16 v[164:167], v[248:251], v[196:199], v[164:167]
    ds_read_b64_tr_b16 v[246:247], v66 offset:29632
    v_mfma_f32_16x16x32_bf16 v[168:171], v[224:227], v[192:195], v[168:171]
    ds_read_b64_tr_b16 v[248:249], v66 offset:29152
    v_mfma_f32_16x16x32_bf16 v[172:175], v[224:227], v[196:199], v[172:175]
    ds_read_b64_tr_b16 v[250:251], v66 offset:29664
    s_waitcnt lgkmcnt(8)
    s_waitcnt vmcnt(8)
    v_mfma_f32_16x16x32_bf16 v[128:131], v[228:231], v[200:203], v[128:131]
    ds_read_b64_tr_b16 v[224:225], v67 offset:29120
    v_mfma_f32_16x16x32_bf16 v[132:135], v[228:231], v[204:207], v[132:135]
    ds_read_b64_tr_b16 v[226:227], v67 offset:29632
    s_add_u32 s96, s85, 4
    s_and_b32 s97, s96, 15
    s_lshl_b32 s98, s97, 14
    s_add_u32 s16, s98, s15
    buffer_load_dwordx4 v[192:195], v2, s[32:35], s16 offen sc1
    v_mfma_f32_16x16x32_bf16 v[136:139], v[232:235], v[200:203], v[136:139]
    ds_read_b64_tr_b16 v[228:229], v67 offset:29152
    v_mfma_f32_16x16x32_bf16 v[140:143], v[232:235], v[204:207], v[140:143]
    ds_read_b64_tr_b16 v[230:231], v67 offset:29664
    s_waitcnt lgkmcnt(8)
    v_mfma_f32_16x16x32_bf16 v[112:115], v[236:239], v[200:203], v[112:115]
    ds_read_b64_tr_b16 v[232:233], v66 offset:45760
    v_mfma_f32_16x16x32_bf16 v[116:119], v[236:239], v[204:207], v[116:119]
    ds_read_b64_tr_b16 v[234:235], v66 offset:46272
    v_mfma_f32_16x16x32_bf16 v[120:123], v[240:243], v[200:203], v[120:123]
    ds_read_b64_tr_b16 v[236:237], v66 offset:45792
    v_mfma_f32_16x16x32_bf16 v[124:127], v[240:243], v[204:207], v[124:127]
    ds_read_b64_tr_b16 v[238:239], v66 offset:46304
    buffer_load_dwordx4 v[196:199], v2, s[32:35], s16 offen offset:1024 sc1
    s_waitcnt lgkmcnt(8)
    v_mfma_f32_16x16x32_bf16 v[80:83], v[244:247], v[200:203], v[80:83]
    ds_read_b64_tr_b16 v[240:241], v67 offset:45760
    v_mfma_f32_16x16x32_bf16 v[84:87], v[244:247], v[204:207], v[84:87]
    ds_read_b64_tr_b16 v[242:243], v67 offset:46272
    v_mfma_f32_16x16x32_bf16 v[88:91], v[248:251], v[200:203], v[88:91]
    ds_read_b64_tr_b16 v[244:245], v67 offset:45792
    v_mfma_f32_16x16x32_bf16 v[92:95], v[248:251], v[204:207], v[92:95]
    ds_read_b64_tr_b16 v[246:247], v67 offset:46304
    s_waitcnt lgkmcnt(8)
    v_mfma_f32_16x16x32_bf16 v[96:99], v[224:227], v[200:203], v[96:99]
    s_barrier
    ds_read_b64_tr_b16 v[248:249], v69 offset:8320
    v_mfma_f32_16x16x32_bf16 v[100:103], v[224:227], v[204:207], v[100:103]
    ds_read_b64_tr_b16 v[250:251], v69 offset:8832
    v_mfma_f32_16x16x32_bf16 v[104:107], v[228:231], v[200:203], v[104:107]
    ds_read_b64_tr_b16 v[224:225], v69 offset:8352
    v_mfma_f32_16x16x32_bf16 v[108:111], v[228:231], v[204:207], v[108:111]
    ds_read_b64_tr_b16 v[226:227], v69 offset:8864
    s_waitcnt lgkmcnt(8)
    v_mfma_f32_16x16x32_bf16 v[144:147], v[232:235], v[200:203], v[144:147]
    ds_read_b64_tr_b16 v[228:229], v68 offset:8320
    v_mfma_f32_16x16x32_bf16 v[148:151], v[232:235], v[204:207], v[148:151]
    ds_read_b64_tr_b16 v[230:231], v68 offset:8832
    v_mfma_f32_16x16x32_bf16 v[152:155], v[236:239], v[200:203], v[152:155]
    ds_read_b64_tr_b16 v[232:233], v68 offset:8352
    v_mfma_f32_16x16x32_bf16 v[156:159], v[236:239], v[204:207], v[156:159]
    ds_read_b64_tr_b16 v[234:235], v68 offset:8864
    s_waitcnt lgkmcnt(8)
    v_mfma_f32_16x16x32_bf16 v[160:163], v[240:243], v[200:203], v[160:163]
    ds_read_b64_tr_b16 v[236:237], v68
    v_mfma_f32_16x16x32_bf16 v[164:167], v[240:243], v[204:207], v[164:167]
    ds_read_b64_tr_b16 v[238:239], v68 offset:512
    v_mfma_f32_16x16x32_bf16 v[168:171], v[244:247], v[200:203], v[168:171]
    ds_read_b64_tr_b16 v[240:241], v68 offset:32
    v_mfma_f32_16x16x32_bf16 v[172:175], v[244:247], v[204:207], v[172:175]
    ds_read_b64_tr_b16 v[242:243], v68 offset:544
    s_waitcnt lgkmcnt(8)
    s_waitcnt vmcnt(8)
    v_mfma_f32_16x16x32_bf16 v[128:131], v[248:251], v[208:211], v[128:131]
    ds_read_b64_tr_b16 v[244:245], v69
    v_mfma_f32_16x16x32_bf16 v[132:135], v[248:251], v[212:215], v[132:135]
    ds_read_b64_tr_b16 v[246:247], v69 offset:512
    buffer_load_dwordx4 v[200:203], v2, s[32:35], s16 offen offset:2048 sc1
    v_mfma_f32_16x16x32_bf16 v[136:139], v[224:227], v[208:211], v[136:139]
    ds_read_b64_tr_b16 v[248:249], v69 offset:32
    v_mfma_f32_16x16x32_bf16 v[140:143], v[224:227], v[212:215], v[140:143]
    ds_read_b64_tr_b16 v[250:251], v69 offset:544
    s_waitcnt lgkmcnt(8)
    v_mfma_f32_16x16x32_bf16 v[112:115], v[228:231], v[208:211], v[112:115]
    ds_read_b64_tr_b16 v[224:225], v68 offset:16640
    v_mfma_f32_16x16x32_bf16 v[116:119], v[228:231], v[212:215], v[116:119]
    ds_read_b64_tr_b16 v[226:227], v68 offset:17152
    v_mfma_f32_16x16x32_bf16 v[120:123], v[232:235], v[208:211], v[120:123]
    ds_read_b64_tr_b16 v[228:229], v68 offset:16672
    v_mfma_f32_16x16x32_bf16 v[124:127], v[232:235], v[212:215], v[124:127]
    ds_read_b64_tr_b16 v[230:231], v68 offset:17184
    buffer_load_dwordx4 v[204:207], v2, s[32:35], s16 offen offset:3072 sc1
    s_waitcnt lgkmcnt(8)
    v_mfma_f32_16x16x32_bf16 v[80:83], v[236:239], v[208:211], v[80:83]
    ds_read_b64_tr_b16 v[232:233], v69 offset:16640
    v_mfma_f32_16x16x32_bf16 v[84:87], v[236:239], v[212:215], v[84:87]
    ds_read_b64_tr_b16 v[234:235], v69 offset:17152
    v_mfma_f32_16x16x32_bf16 v[88:91], v[240:243], v[208:211], v[88:91]
    ds_read_b64_tr_b16 v[236:237], v69 offset:16672
    v_mfma_f32_16x16x32_bf16 v[92:95], v[240:243], v[212:215], v[92:95]
    ds_read_b64_tr_b16 v[238:239], v69 offset:17184
    s_waitcnt lgkmcnt(8)
    v_mfma_f32_16x16x32_bf16 v[96:99], v[244:247], v[208:211], v[96:99]
    ds_read_b64_tr_b16 v[240:241], v69 offset:12480
    v_mfma_f32_16x16x32_bf16 v[100:103], v[244:247], v[212:215], v[100:103]
    ds_read_b64_tr_b16 v[242:243], v69 offset:12992
    v_mfma_f32_16x16x32_bf16 v[104:107], v[248:251], v[208:211], v[104:107]
    ds_read_b64_tr_b16 v[244:245], v69 offset:12512
    v_mfma_f32_16x16x32_bf16 v[108:111], v[248:251], v[212:215], v[108:111]
    ds_read_b64_tr_b16 v[246:247], v69 offset:13024
    s_waitcnt lgkmcnt(8)
    v_mfma_f32_16x16x32_bf16 v[144:147], v[224:227], v[208:211], v[144:147]
    ds_read_b64_tr_b16 v[248:249], v68 offset:12480
    v_mfma_f32_16x16x32_bf16 v[148:151], v[224:227], v[212:215], v[148:151]
    ds_read_b64_tr_b16 v[250:251], v68 offset:12992
    v_mfma_f32_16x16x32_bf16 v[152:155], v[228:231], v[208:211], v[152:155]
    ds_read_b64_tr_b16 v[224:225], v68 offset:12512
    v_mfma_f32_16x16x32_bf16 v[156:159], v[228:231], v[212:215], v[156:159]
    ds_read_b64_tr_b16 v[226:227], v68 offset:13024
    s_waitcnt lgkmcnt(8)
    v_mfma_f32_16x16x32_bf16 v[160:163], v[232:235], v[208:211], v[160:163]
    ds_read_b64_tr_b16 v[228:229], v68 offset:4160
    v_mfma_f32_16x16x32_bf16 v[164:167], v[232:235], v[212:215], v[164:167]
    ds_read_b64_tr_b16 v[230:231], v68 offset:4672
    v_mfma_f32_16x16x32_bf16 v[168:171], v[236:239], v[208:211], v[168:171]
    ds_read_b64_tr_b16 v[232:233], v68 offset:4192
    v_mfma_f32_16x16x32_bf16 v[172:175], v[236:239], v[212:215], v[172:175]
    ds_read_b64_tr_b16 v[234:235], v68 offset:4704
    s_waitcnt lgkmcnt(8)
    s_waitcnt vmcnt(8)
    v_mfma_f32_16x16x32_bf16 v[128:131], v[240:243], v[216:219], v[128:131]
    ds_read_b64_tr_b16 v[236:237], v69 offset:4160
    v_mfma_f32_16x16x32_bf16 v[132:135], v[240:243], v[220:223], v[132:135]
    ds_read_b64_tr_b16 v[238:239], v69 offset:4672
    s_add_u32 s96, s85, 5
    s_and_b32 s97, s96, 15
    s_lshl_b32 s98, s97, 14
    s_add_u32 s16, s98, s15
    buffer_load_dwordx4 v[208:211], v2, s[32:35], s16 offen sc1
    v_mfma_f32_16x16x32_bf16 v[136:139], v[244:247], v[216:219], v[136:139]
    ds_read_b64_tr_b16 v[240:241], v69 offset:4192
    v_mfma_f32_16x16x32_bf16 v[140:143], v[244:247], v[220:223], v[140:143]
    ds_read_b64_tr_b16 v[242:243], v69 offset:4704
    s_waitcnt lgkmcnt(8)
    v_mfma_f32_16x16x32_bf16 v[112:115], v[248:251], v[216:219], v[112:115]
    ds_read_b64_tr_b16 v[244:245], v68 offset:20800
    v_mfma_f32_16x16x32_bf16 v[116:119], v[248:251], v[220:223], v[116:119]
    ds_read_b64_tr_b16 v[246:247], v68 offset:21312
    v_mfma_f32_16x16x32_bf16 v[120:123], v[224:227], v[216:219], v[120:123]
    ds_read_b64_tr_b16 v[248:249], v68 offset:20832
    v_mfma_f32_16x16x32_bf16 v[124:127], v[224:227], v[220:223], v[124:127]
    ds_read_b64_tr_b16 v[250:251], v68 offset:21344
    buffer_load_dwordx4 v[212:215], v2, s[32:35], s16 offen offset:1024 sc1
    s_waitcnt lgkmcnt(8)
    v_mfma_f32_16x16x32_bf16 v[80:83], v[228:231], v[216:219], v[80:83]
    ds_read_b64_tr_b16 v[224:225], v69 offset:20800
    v_mfma_f32_16x16x32_bf16 v[84:87], v[228:231], v[220:223], v[84:87]
    ds_read_b64_tr_b16 v[226:227], v69 offset:21312
    v_mfma_f32_16x16x32_bf16 v[88:91], v[232:235], v[216:219], v[88:91]
    ds_read_b64_tr_b16 v[228:229], v69 offset:20832
    v_mfma_f32_16x16x32_bf16 v[92:95], v[232:235], v[220:223], v[92:95]
    ds_read_b64_tr_b16 v[230:231], v69 offset:21344
    s_waitcnt lgkmcnt(8)
    v_mfma_f32_16x16x32_bf16 v[96:99], v[236:239], v[216:219], v[96:99]
    s_barrier
    ds_read_b64_tr_b16 v[232:233], v69 offset:33280
    v_mfma_f32_16x16x32_bf16 v[100:103], v[236:239], v[220:223], v[100:103]
    ds_read_b64_tr_b16 v[234:235], v69 offset:33792
    v_mfma_f32_16x16x32_bf16 v[104:107], v[240:243], v[216:219], v[104:107]
    ds_read_b64_tr_b16 v[236:237], v69 offset:33312
    v_mfma_f32_16x16x32_bf16 v[108:111], v[240:243], v[220:223], v[108:111]
    ds_read_b64_tr_b16 v[238:239], v69 offset:33824
    s_waitcnt lgkmcnt(8)
    v_mfma_f32_16x16x32_bf16 v[144:147], v[244:247], v[216:219], v[144:147]
    ds_read_b64_tr_b16 v[240:241], v68 offset:33280
    v_mfma_f32_16x16x32_bf16 v[148:151], v[244:247], v[220:223], v[148:151]
    ds_read_b64_tr_b16 v[242:243], v68 offset:33792
    v_mfma_f32_16x16x32_bf16 v[152:155], v[248:251], v[216:219], v[152:155]
    ds_read_b64_tr_b16 v[244:245], v68 offset:33312
    v_mfma_f32_16x16x32_bf16 v[156:159], v[248:251], v[220:223], v[156:159]
    ds_read_b64_tr_b16 v[246:247], v68 offset:33824
    s_waitcnt lgkmcnt(8)
    v_mfma_f32_16x16x32_bf16 v[160:163], v[224:227], v[216:219], v[160:163]
    ds_read_b64_tr_b16 v[248:249], v68 offset:24960
    v_mfma_f32_16x16x32_bf16 v[164:167], v[224:227], v[220:223], v[164:167]
    ds_read_b64_tr_b16 v[250:251], v68 offset:25472
    v_mfma_f32_16x16x32_bf16 v[168:171], v[228:231], v[216:219], v[168:171]
    ds_read_b64_tr_b16 v[224:225], v68 offset:24992
    v_mfma_f32_16x16x32_bf16 v[172:175], v[228:231], v[220:223], v[172:175]
    ds_read_b64_tr_b16 v[226:227], v68 offset:25504
    s_waitcnt lgkmcnt(8)
    s_waitcnt vmcnt(8)
    v_mfma_f32_16x16x32_bf16 v[128:131], v[232:235], v[176:179], v[128:131]
    ds_read_b64_tr_b16 v[228:229], v69 offset:24960
    v_mfma_f32_16x16x32_bf16 v[132:135], v[232:235], v[180:183], v[132:135]
    ds_read_b64_tr_b16 v[230:231], v69 offset:25472
    buffer_load_dwordx4 v[216:219], v2, s[32:35], s16 offen offset:2048 sc1
    v_mfma_f32_16x16x32_bf16 v[136:139], v[236:239], v[176:179], v[136:139]
    ds_read_b64_tr_b16 v[232:233], v69 offset:24992
    v_mfma_f32_16x16x32_bf16 v[140:143], v[236:239], v[180:183], v[140:143]
    ds_read_b64_tr_b16 v[234:235], v69 offset:25504
    s_waitcnt lgkmcnt(8)
    v_mfma_f32_16x16x32_bf16 v[112:115], v[240:243], v[176:179], v[112:115]
    ds_read_b64_tr_b16 v[236:237], v68 offset:41600
    v_mfma_f32_16x16x32_bf16 v[116:119], v[240:243], v[180:183], v[116:119]
    ds_read_b64_tr_b16 v[238:239], v68 offset:42112
    v_mfma_f32_16x16x32_bf16 v[120:123], v[244:247], v[176:179], v[120:123]
    ds_read_b64_tr_b16 v[240:241], v68 offset:41632
    v_mfma_f32_16x16x32_bf16 v[124:127], v[244:247], v[180:183], v[124:127]
    ds_read_b64_tr_b16 v[242:243], v68 offset:42144
    buffer_load_dwordx4 v[220:223], v2, s[32:35], s16 offen offset:3072 sc1
    s_waitcnt lgkmcnt(8)
    v_mfma_f32_16x16x32_bf16 v[80:83], v[248:251], v[176:179], v[80:83]
    ds_read_b64_tr_b16 v[244:245], v69 offset:41600
    v_mfma_f32_16x16x32_bf16 v[84:87], v[248:251], v[180:183], v[84:87]
    ds_read_b64_tr_b16 v[246:247], v69 offset:42112
    v_mfma_f32_16x16x32_bf16 v[88:91], v[224:227], v[176:179], v[88:91]
    ds_read_b64_tr_b16 v[248:249], v69 offset:41632
    v_mfma_f32_16x16x32_bf16 v[92:95], v[224:227], v[180:183], v[92:95]
    ds_read_b64_tr_b16 v[250:251], v69 offset:42144
    s_waitcnt lgkmcnt(8)
    v_mfma_f32_16x16x32_bf16 v[96:99], v[228:231], v[176:179], v[96:99]
    ds_read_b64_tr_b16 v[224:225], v69 offset:37440
    v_mfma_f32_16x16x32_bf16 v[100:103], v[228:231], v[180:183], v[100:103]
    ds_read_b64_tr_b16 v[226:227], v69 offset:37952
    v_mfma_f32_16x16x32_bf16 v[104:107], v[232:235], v[176:179], v[104:107]
    ds_read_b64_tr_b16 v[228:229], v69 offset:37472
    v_mfma_f32_16x16x32_bf16 v[108:111], v[232:235], v[180:183], v[108:111]
    ds_read_b64_tr_b16 v[230:231], v69 offset:37984
    s_waitcnt lgkmcnt(8)
    v_mfma_f32_16x16x32_bf16 v[144:147], v[236:239], v[176:179], v[144:147]
    ds_read_b64_tr_b16 v[232:233], v68 offset:37440
    v_mfma_f32_16x16x32_bf16 v[148:151], v[236:239], v[180:183], v[148:151]
    ds_read_b64_tr_b16 v[234:235], v68 offset:37952
    v_mfma_f32_16x16x32_bf16 v[152:155], v[240:243], v[176:179], v[152:155]
    ds_read_b64_tr_b16 v[236:237], v68 offset:37472
    v_mfma_f32_16x16x32_bf16 v[156:159], v[240:243], v[180:183], v[156:159]
    ds_read_b64_tr_b16 v[238:239], v68 offset:37984
    s_waitcnt lgkmcnt(8)
    v_mfma_f32_16x16x32_bf16 v[160:163], v[244:247], v[176:179], v[160:163]
    ds_read_b64_tr_b16 v[240:241], v68 offset:29120
    v_mfma_f32_16x16x32_bf16 v[164:167], v[244:247], v[180:183], v[164:167]
    ds_read_b64_tr_b16 v[242:243], v68 offset:29632
    v_mfma_f32_16x16x32_bf16 v[168:171], v[248:251], v[176:179], v[168:171]
    ds_read_b64_tr_b16 v[244:245], v68 offset:29152
    v_mfma_f32_16x16x32_bf16 v[172:175], v[248:251], v[180:183], v[172:175]
    ds_read_b64_tr_b16 v[246:247], v68 offset:29664
    s_waitcnt lgkmcnt(8)
    s_waitcnt vmcnt(8)
    v_mfma_f32_16x16x32_bf16 v[128:131], v[224:227], v[184:187], v[128:131]
    ds_read_b64_tr_b16 v[248:249], v69 offset:29120
    v_mfma_f32_16x16x32_bf16 v[132:135], v[224:227], v[188:191], v[132:135]
    ds_read_b64_tr_b16 v[250:251], v69 offset:29632
    s_add_u32 s96, s85, 6
    s_and_b32 s97, s96, 15
    s_lshl_b32 s98, s97, 14
    s_add_u32 s16, s98, s15
    buffer_load_dwordx4 v[176:179], v2, s[32:35], s16 offen sc1
    v_mfma_f32_16x16x32_bf16 v[136:139], v[228:231], v[184:187], v[136:139]
    ds_read_b64_tr_b16 v[224:225], v69 offset:29152
    v_mfma_f32_16x16x32_bf16 v[140:143], v[228:231], v[188:191], v[140:143]
    ds_read_b64_tr_b16 v[226:227], v69 offset:29664
    s_waitcnt lgkmcnt(8)
    v_mfma_f32_16x16x32_bf16 v[112:115], v[232:235], v[184:187], v[112:115]
    ds_read_b64_tr_b16 v[228:229], v68 offset:45760
    v_mfma_f32_16x16x32_bf16 v[116:119], v[232:235], v[188:191], v[116:119]
    ds_read_b64_tr_b16 v[230:231], v68 offset:46272
    v_mfma_f32_16x16x32_bf16 v[120:123], v[236:239], v[184:187], v[120:123]
    ds_read_b64_tr_b16 v[232:233], v68 offset:45792
    v_mfma_f32_16x16x32_bf16 v[124:127], v[236:239], v[188:191], v[124:127]
    ds_read_b64_tr_b16 v[234:235], v68 offset:46304
    buffer_load_dwordx4 v[180:183], v2, s[32:35], s16 offen offset:1024 sc1
    s_waitcnt lgkmcnt(8)
    v_mfma_f32_16x16x32_bf16 v[80:83], v[240:243], v[184:187], v[80:83]
    ds_read_b64_tr_b16 v[236:237], v69 offset:45760
    v_mfma_f32_16x16x32_bf16 v[84:87], v[240:243], v[188:191], v[84:87]
    ds_read_b64_tr_b16 v[238:239], v69 offset:46272
    v_mfma_f32_16x16x32_bf16 v[88:91], v[244:247], v[184:187], v[88:91]
    ds_read_b64_tr_b16 v[240:241], v69 offset:45792
    v_mfma_f32_16x16x32_bf16 v[92:95], v[244:247], v[188:191], v[92:95]
    ds_read_b64_tr_b16 v[242:243], v69 offset:46304
    s_waitcnt lgkmcnt(8)
    v_mfma_f32_16x16x32_bf16 v[96:99], v[248:251], v[184:187], v[96:99]
    s_barrier
    ds_read_b64_tr_b16 v[244:245], v71 offset:8320
    v_mfma_f32_16x16x32_bf16 v[100:103], v[248:251], v[188:191], v[100:103]
    ds_read_b64_tr_b16 v[246:247], v71 offset:8832
    v_mfma_f32_16x16x32_bf16 v[104:107], v[224:227], v[184:187], v[104:107]
    ds_read_b64_tr_b16 v[248:249], v71 offset:8352
    v_mfma_f32_16x16x32_bf16 v[108:111], v[224:227], v[188:191], v[108:111]
    ds_read_b64_tr_b16 v[250:251], v71 offset:8864
    s_waitcnt lgkmcnt(8)
    v_mfma_f32_16x16x32_bf16 v[144:147], v[228:231], v[184:187], v[144:147]
    ds_read_b64_tr_b16 v[224:225], v70 offset:8320
    v_mfma_f32_16x16x32_bf16 v[148:151], v[228:231], v[188:191], v[148:151]
    ds_read_b64_tr_b16 v[226:227], v70 offset:8832
    v_mfma_f32_16x16x32_bf16 v[152:155], v[232:235], v[184:187], v[152:155]
    ds_read_b64_tr_b16 v[228:229], v70 offset:8352
    v_mfma_f32_16x16x32_bf16 v[156:159], v[232:235], v[188:191], v[156:159]
    ds_read_b64_tr_b16 v[230:231], v70 offset:8864
    s_waitcnt lgkmcnt(8)
    v_mfma_f32_16x16x32_bf16 v[160:163], v[236:239], v[184:187], v[160:163]
    ds_read_b64_tr_b16 v[232:233], v70
    v_mfma_f32_16x16x32_bf16 v[164:167], v[236:239], v[188:191], v[164:167]
    ds_read_b64_tr_b16 v[234:235], v70 offset:512
    v_mfma_f32_16x16x32_bf16 v[168:171], v[240:243], v[184:187], v[168:171]
    ds_read_b64_tr_b16 v[236:237], v70 offset:32
    v_mfma_f32_16x16x32_bf16 v[172:175], v[240:243], v[188:191], v[172:175]
    ds_read_b64_tr_b16 v[238:239], v70 offset:544
    s_waitcnt lgkmcnt(8)
    s_waitcnt vmcnt(8)
    v_mfma_f32_16x16x32_bf16 v[128:131], v[244:247], v[192:195], v[128:131]
    ds_read_b64_tr_b16 v[240:241], v71
    v_mfma_f32_16x16x32_bf16 v[132:135], v[244:247], v[196:199], v[132:135]
    ds_read_b64_tr_b16 v[242:243], v71 offset:512
    buffer_load_dwordx4 v[184:187], v2, s[32:35], s16 offen offset:2048 sc1
    v_mfma_f32_16x16x32_bf16 v[136:139], v[248:251], v[192:195], v[136:139]
    ds_read_b64_tr_b16 v[244:245], v71 offset:32
    v_mfma_f32_16x16x32_bf16 v[140:143], v[248:251], v[196:199], v[140:143]
    ds_read_b64_tr_b16 v[246:247], v71 offset:544
    s_waitcnt lgkmcnt(8)
    v_mfma_f32_16x16x32_bf16 v[112:115], v[224:227], v[192:195], v[112:115]
    ds_read_b64_tr_b16 v[248:249], v70 offset:16640
    v_mfma_f32_16x16x32_bf16 v[116:119], v[224:227], v[196:199], v[116:119]
    ds_read_b64_tr_b16 v[250:251], v70 offset:17152
    v_mfma_f32_16x16x32_bf16 v[120:123], v[228:231], v[192:195], v[120:123]
    ds_read_b64_tr_b16 v[224:225], v70 offset:16672
    v_mfma_f32_16x16x32_bf16 v[124:127], v[228:231], v[196:199], v[124:127]
    ds_read_b64_tr_b16 v[226:227], v70 offset:17184
    buffer_load_dwordx4 v[188:191], v2, s[32:35], s16 offen offset:3072 sc1
    s_waitcnt lgkmcnt(8)
    v_mfma_f32_16x16x32_bf16 v[80:83], v[232:235], v[192:195], v[80:83]
    ds_read_b64_tr_b16 v[228:229], v71 offset:16640
    v_mfma_f32_16x16x32_bf16 v[84:87], v[232:235], v[196:199], v[84:87]
    ds_read_b64_tr_b16 v[230:231], v71 offset:17152
    v_mfma_f32_16x16x32_bf16 v[88:91], v[236:239], v[192:195], v[88:91]
    ds_read_b64_tr_b16 v[232:233], v71 offset:16672
    v_mfma_f32_16x16x32_bf16 v[92:95], v[236:239], v[196:199], v[92:95]
    ds_read_b64_tr_b16 v[234:235], v71 offset:17184
    s_waitcnt lgkmcnt(8)
    v_mfma_f32_16x16x32_bf16 v[96:99], v[240:243], v[192:195], v[96:99]
    ds_read_b64_tr_b16 v[236:237], v71 offset:12480
    v_mfma_f32_16x16x32_bf16 v[100:103], v[240:243], v[196:199], v[100:103]
    ds_read_b64_tr_b16 v[238:239], v71 offset:12992
    v_mfma_f32_16x16x32_bf16 v[104:107], v[244:247], v[192:195], v[104:107]
    ds_read_b64_tr_b16 v[240:241], v71 offset:12512
    v_mfma_f32_16x16x32_bf16 v[108:111], v[244:247], v[196:199], v[108:111]
    ds_read_b64_tr_b16 v[242:243], v71 offset:13024
    s_waitcnt lgkmcnt(8)
    v_mfma_f32_16x16x32_bf16 v[144:147], v[248:251], v[192:195], v[144:147]
    ds_read_b64_tr_b16 v[244:245], v70 offset:12480
    v_mfma_f32_16x16x32_bf16 v[148:151], v[248:251], v[196:199], v[148:151]
    ds_read_b64_tr_b16 v[246:247], v70 offset:12992
    v_mfma_f32_16x16x32_bf16 v[152:155], v[224:227], v[192:195], v[152:155]
    ds_read_b64_tr_b16 v[248:249], v70 offset:12512
    v_mfma_f32_16x16x32_bf16 v[156:159], v[224:227], v[196:199], v[156:159]
    ds_read_b64_tr_b16 v[250:251], v70 offset:13024
    s_waitcnt lgkmcnt(8)
    v_mfma_f32_16x16x32_bf16 v[160:163], v[228:231], v[192:195], v[160:163]
    ds_read_b64_tr_b16 v[224:225], v70 offset:4160
    v_mfma_f32_16x16x32_bf16 v[164:167], v[228:231], v[196:199], v[164:167]
    ds_read_b64_tr_b16 v[226:227], v70 offset:4672
    v_mfma_f32_16x16x32_bf16 v[168:171], v[232:235], v[192:195], v[168:171]
    ds_read_b64_tr_b16 v[228:229], v70 offset:4192
    v_mfma_f32_16x16x32_bf16 v[172:175], v[232:235], v[196:199], v[172:175]
    ds_read_b64_tr_b16 v[230:231], v70 offset:4704
    s_waitcnt lgkmcnt(8)
    s_waitcnt vmcnt(8)
    v_mfma_f32_16x16x32_bf16 v[128:131], v[236:239], v[200:203], v[128:131]
    ds_read_b64_tr_b16 v[232:233], v71 offset:4160
    v_mfma_f32_16x16x32_bf16 v[132:135], v[236:239], v[204:207], v[132:135]
    ds_read_b64_tr_b16 v[234:235], v71 offset:4672
    s_add_u32 s96, s85, 7
    s_and_b32 s97, s96, 15
    s_lshl_b32 s98, s97, 14
    s_add_u32 s16, s98, s15
    buffer_load_dwordx4 v[192:195], v2, s[32:35], s16 offen sc1
    v_mfma_f32_16x16x32_bf16 v[136:139], v[240:243], v[200:203], v[136:139]
    ds_read_b64_tr_b16 v[236:237], v71 offset:4192
    v_mfma_f32_16x16x32_bf16 v[140:143], v[240:243], v[204:207], v[140:143]
    ds_read_b64_tr_b16 v[238:239], v71 offset:4704
    s_waitcnt lgkmcnt(8)
    v_mfma_f32_16x16x32_bf16 v[112:115], v[244:247], v[200:203], v[112:115]
    ds_read_b64_tr_b16 v[240:241], v70 offset:20800
    v_mfma_f32_16x16x32_bf16 v[116:119], v[244:247], v[204:207], v[116:119]
    ds_read_b64_tr_b16 v[242:243], v70 offset:21312
    v_mfma_f32_16x16x32_bf16 v[120:123], v[248:251], v[200:203], v[120:123]
    ds_read_b64_tr_b16 v[244:245], v70 offset:20832
    v_mfma_f32_16x16x32_bf16 v[124:127], v[248:251], v[204:207], v[124:127]
    ds_read_b64_tr_b16 v[246:247], v70 offset:21344
    buffer_load_dwordx4 v[196:199], v2, s[32:35], s16 offen offset:1024 sc1
    s_waitcnt lgkmcnt(8)
    v_mfma_f32_16x16x32_bf16 v[80:83], v[224:227], v[200:203], v[80:83]
    ds_read_b64_tr_b16 v[248:249], v71 offset:20800
    v_mfma_f32_16x16x32_bf16 v[84:87], v[224:227], v[204:207], v[84:87]
    ds_read_b64_tr_b16 v[250:251], v71 offset:21312
    v_mfma_f32_16x16x32_bf16 v[88:91], v[228:231], v[200:203], v[88:91]
    ds_read_b64_tr_b16 v[224:225], v71 offset:20832
    v_mfma_f32_16x16x32_bf16 v[92:95], v[228:231], v[204:207], v[92:95]
    ds_read_b64_tr_b16 v[226:227], v71 offset:21344
    s_waitcnt lgkmcnt(8)
    v_mfma_f32_16x16x32_bf16 v[96:99], v[232:235], v[200:203], v[96:99]
    s_barrier
    ds_read_b64_tr_b16 v[228:229], v71 offset:33280
    v_mfma_f32_16x16x32_bf16 v[100:103], v[232:235], v[204:207], v[100:103]
    ds_read_b64_tr_b16 v[230:231], v71 offset:33792
    v_mfma_f32_16x16x32_bf16 v[104:107], v[236:239], v[200:203], v[104:107]
    ds_read_b64_tr_b16 v[232:233], v71 offset:33312
    v_mfma_f32_16x16x32_bf16 v[108:111], v[236:239], v[204:207], v[108:111]
    ds_read_b64_tr_b16 v[234:235], v71 offset:33824
    s_waitcnt lgkmcnt(8)
    v_mfma_f32_16x16x32_bf16 v[144:147], v[240:243], v[200:203], v[144:147]
    ds_read_b64_tr_b16 v[236:237], v70 offset:33280
    v_mfma_f32_16x16x32_bf16 v[148:151], v[240:243], v[204:207], v[148:151]
    ds_read_b64_tr_b16 v[238:239], v70 offset:33792
    v_mfma_f32_16x16x32_bf16 v[152:155], v[244:247], v[200:203], v[152:155]
    ds_read_b64_tr_b16 v[240:241], v70 offset:33312
    v_mfma_f32_16x16x32_bf16 v[156:159], v[244:247], v[204:207], v[156:159]
    ds_read_b64_tr_b16 v[242:243], v70 offset:33824
    s_waitcnt lgkmcnt(8)
    v_mfma_f32_16x16x32_bf16 v[160:163], v[248:251], v[200:203], v[160:163]
    ds_read_b64_tr_b16 v[244:245], v70 offset:24960
    v_mfma_f32_16x16x32_bf16 v[164:167], v[248:251], v[204:207], v[164:167]
    ds_read_b64_tr_b16 v[246:247], v70 offset:25472
    v_mfma_f32_16x16x32_bf16 v[168:171], v[224:227], v[200:203], v[168:171]
    ds_read_b64_tr_b16 v[248:249], v70 offset:24992
    v_mfma_f32_16x16x32_bf16 v[172:175], v[224:227], v[204:207], v[172:175]
    ds_read_b64_tr_b16 v[250:251], v70 offset:25504
    s_waitcnt lgkmcnt(8)
    s_waitcnt vmcnt(8)
    v_mfma_f32_16x16x32_bf16 v[128:131], v[228:231], v[208:211], v[128:131]
    ds_read_b64_tr_b16 v[224:225], v71 offset:24960
    v_mfma_f32_16x16x32_bf16 v[132:135], v[228:231], v[212:215], v[132:135]
    ds_read_b64_tr_b16 v[226:227], v71 offset:25472
    buffer_load_dwordx4 v[200:203], v2, s[32:35], s16 offen offset:2048 sc1
    v_mfma_f32_16x16x32_bf16 v[136:139], v[232:235], v[208:211], v[136:139]
    ds_read_b64_tr_b16 v[228:229], v71 offset:24992
    v_mfma_f32_16x16x32_bf16 v[140:143], v[232:235], v[212:215], v[140:143]
    ds_read_b64_tr_b16 v[230:231], v71 offset:25504
    s_waitcnt lgkmcnt(8)
    v_mfma_f32_16x16x32_bf16 v[112:115], v[236:239], v[208:211], v[112:115]
    ds_read_b64_tr_b16 v[232:233], v70 offset:41600
    v_mfma_f32_16x16x32_bf16 v[116:119], v[236:239], v[212:215], v[116:119]
    ds_read_b64_tr_b16 v[234:235], v70 offset:42112
    v_mfma_f32_16x16x32_bf16 v[120:123], v[240:243], v[208:211], v[120:123]
    ds_read_b64_tr_b16 v[236:237], v70 offset:41632
    v_mfma_f32_16x16x32_bf16 v[124:127], v[240:243], v[212:215], v[124:127]
    ds_read_b64_tr_b16 v[238:239], v70 offset:42144
    buffer_load_dwordx4 v[204:207], v2, s[32:35], s16 offen offset:3072 sc1
    s_waitcnt lgkmcnt(8)
    v_mfma_f32_16x16x32_bf16 v[80:83], v[244:247], v[208:211], v[80:83]
    ds_read_b64_tr_b16 v[240:241], v71 offset:41600
    v_mfma_f32_16x16x32_bf16 v[84:87], v[244:247], v[212:215], v[84:87]
    ds_read_b64_tr_b16 v[242:243], v71 offset:42112
    v_mfma_f32_16x16x32_bf16 v[88:91], v[248:251], v[208:211], v[88:91]
    ds_read_b64_tr_b16 v[244:245], v71 offset:41632
    v_mfma_f32_16x16x32_bf16 v[92:95], v[248:251], v[212:215], v[92:95]
    ds_read_b64_tr_b16 v[246:247], v71 offset:42144
    s_waitcnt lgkmcnt(8)
    v_mfma_f32_16x16x32_bf16 v[96:99], v[224:227], v[208:211], v[96:99]
    ds_read_b64_tr_b16 v[248:249], v71 offset:37440
    v_mfma_f32_16x16x32_bf16 v[100:103], v[224:227], v[212:215], v[100:103]
    ds_read_b64_tr_b16 v[250:251], v71 offset:37952
    v_mfma_f32_16x16x32_bf16 v[104:107], v[228:231], v[208:211], v[104:107]
    ds_read_b64_tr_b16 v[224:225], v71 offset:37472
    v_mfma_f32_16x16x32_bf16 v[108:111], v[228:231], v[212:215], v[108:111]
    ds_read_b64_tr_b16 v[226:227], v71 offset:37984
    s_waitcnt lgkmcnt(8)
    v_mfma_f32_16x16x32_bf16 v[144:147], v[232:235], v[208:211], v[144:147]
    ds_read_b64_tr_b16 v[228:229], v70 offset:37440
    v_mfma_f32_16x16x32_bf16 v[148:151], v[232:235], v[212:215], v[148:151]
    ds_read_b64_tr_b16 v[230:231], v70 offset:37952
    v_mfma_f32_16x16x32_bf16 v[152:155], v[236:239], v[208:211], v[152:155]
    ds_read_b64_tr_b16 v[232:233], v70 offset:37472
    v_mfma_f32_16x16x32_bf16 v[156:159], v[236:239], v[212:215], v[156:159]
    ds_read_b64_tr_b16 v[234:235], v70 offset:37984
    s_waitcnt lgkmcnt(8)
    v_mfma_f32_16x16x32_bf16 v[160:163], v[240:243], v[208:211], v[160:163]
    ds_read_b64_tr_b16 v[236:237], v70 offset:29120
    v_mfma_f32_16x16x32_bf16 v[164:167], v[240:243], v[212:215], v[164:167]
    ds_read_b64_tr_b16 v[238:239], v70 offset:29632
    v_mfma_f32_16x16x32_bf16 v[168:171], v[244:247], v[208:211], v[168:171]
    ds_read_b64_tr_b16 v[240:241], v70 offset:29152
    v_mfma_f32_16x16x32_bf16 v[172:175], v[244:247], v[212:215], v[172:175]
    ds_read_b64_tr_b16 v[242:243], v70 offset:29664
    s_waitcnt lgkmcnt(8)
    s_waitcnt vmcnt(8)
    v_mfma_f32_16x16x32_bf16 v[128:131], v[248:251], v[216:219], v[128:131]
    ds_read_b64_tr_b16 v[244:245], v71 offset:29120
    v_mfma_f32_16x16x32_bf16 v[132:135], v[248:251], v[220:223], v[132:135]
    ds_read_b64_tr_b16 v[246:247], v71 offset:29632
    s_add_u32 s96, s85, 8
    s_and_b32 s97, s96, 15
    s_lshl_b32 s98, s97, 14
    s_add_u32 s16, s98, s15
    buffer_load_dwordx4 v[208:211], v2, s[32:35], s16 offen sc1
    v_mfma_f32_16x16x32_bf16 v[136:139], v[224:227], v[216:219], v[136:139]
    ds_read_b64_tr_b16 v[248:249], v71 offset:29152
    v_mfma_f32_16x16x32_bf16 v[140:143], v[224:227], v[220:223], v[140:143]
    ds_read_b64_tr_b16 v[250:251], v71 offset:29664
    s_waitcnt lgkmcnt(8)
    v_mfma_f32_16x16x32_bf16 v[112:115], v[228:231], v[216:219], v[112:115]
    ds_read_b64_tr_b16 v[224:225], v70 offset:45760
    v_mfma_f32_16x16x32_bf16 v[116:119], v[228:231], v[220:223], v[116:119]
    ds_read_b64_tr_b16 v[226:227], v70 offset:46272
    v_mfma_f32_16x16x32_bf16 v[120:123], v[232:235], v[216:219], v[120:123]
    ds_read_b64_tr_b16 v[228:229], v70 offset:45792
    v_mfma_f32_16x16x32_bf16 v[124:127], v[232:235], v[220:223], v[124:127]
    ds_read_b64_tr_b16 v[230:231], v70 offset:46304
    buffer_load_dwordx4 v[212:215], v2, s[32:35], s16 offen offset:1024 sc1
    s_waitcnt lgkmcnt(8)
    v_mfma_f32_16x16x32_bf16 v[80:83], v[236:239], v[216:219], v[80:83]
    ds_read_b64_tr_b16 v[232:233], v71 offset:45760
    v_mfma_f32_16x16x32_bf16 v[84:87], v[236:239], v[220:223], v[84:87]
    ds_read_b64_tr_b16 v[234:235], v71 offset:46272
    v_mfma_f32_16x16x32_bf16 v[88:91], v[240:243], v[216:219], v[88:91]
    ds_read_b64_tr_b16 v[236:237], v71 offset:45792
    v_mfma_f32_16x16x32_bf16 v[92:95], v[240:243], v[220:223], v[92:95]
    ds_read_b64_tr_b16 v[238:239], v71 offset:46304
    s_waitcnt lgkmcnt(8)
    v_mfma_f32_16x16x32_bf16 v[96:99], v[244:247], v[216:219], v[96:99]
    s_barrier
    ds_read_b64_tr_b16 v[240:241], v67 offset:8320
    v_mfma_f32_16x16x32_bf16 v[100:103], v[244:247], v[220:223], v[100:103]
    ds_read_b64_tr_b16 v[242:243], v67 offset:8832
    v_mfma_f32_16x16x32_bf16 v[104:107], v[248:251], v[216:219], v[104:107]
    ds_read_b64_tr_b16 v[244:245], v67 offset:8352
    v_mfma_f32_16x16x32_bf16 v[108:111], v[248:251], v[220:223], v[108:111]
    ds_read_b64_tr_b16 v[246:247], v67 offset:8864
    s_waitcnt lgkmcnt(8)
    v_mfma_f32_16x16x32_bf16 v[144:147], v[224:227], v[216:219], v[144:147]
    ds_read_b64_tr_b16 v[248:249], v66 offset:8320
    v_mfma_f32_16x16x32_bf16 v[148:151], v[224:227], v[220:223], v[148:151]
    ds_read_b64_tr_b16 v[250:251], v66 offset:8832
    v_mfma_f32_16x16x32_bf16 v[152:155], v[228:231], v[216:219], v[152:155]
    ds_read_b64_tr_b16 v[224:225], v66 offset:8352
    v_mfma_f32_16x16x32_bf16 v[156:159], v[228:231], v[220:223], v[156:159]
    ds_read_b64_tr_b16 v[226:227], v66 offset:8864
    s_waitcnt lgkmcnt(8)
    v_mfma_f32_16x16x32_bf16 v[160:163], v[232:235], v[216:219], v[160:163]
    ds_read_b64_tr_b16 v[228:229], v66
    v_mfma_f32_16x16x32_bf16 v[164:167], v[232:235], v[220:223], v[164:167]
    ds_read_b64_tr_b16 v[230:231], v66 offset:512
    v_mfma_f32_16x16x32_bf16 v[168:171], v[236:239], v[216:219], v[168:171]
    ds_read_b64_tr_b16 v[232:233], v66 offset:32
    v_mfma_f32_16x16x32_bf16 v[172:175], v[236:239], v[220:223], v[172:175]
    ds_read_b64_tr_b16 v[234:235], v66 offset:544
    s_waitcnt lgkmcnt(8)
    s_waitcnt vmcnt(8)
    v_mfma_f32_16x16x32_bf16 v[128:131], v[240:243], v[176:179], v[128:131]
    ds_read_b64_tr_b16 v[236:237], v67
    v_mfma_f32_16x16x32_bf16 v[132:135], v[240:243], v[180:183], v[132:135]
    ds_read_b64_tr_b16 v[238:239], v67 offset:512
    buffer_load_dwordx4 v[216:219], v2, s[32:35], s16 offen offset:2048 sc1
    v_mfma_f32_16x16x32_bf16 v[136:139], v[244:247], v[176:179], v[136:139]
    ds_read_b64_tr_b16 v[240:241], v67 offset:32
    v_mfma_f32_16x16x32_bf16 v[140:143], v[244:247], v[180:183], v[140:143]
    ds_read_b64_tr_b16 v[242:243], v67 offset:544
    s_waitcnt lgkmcnt(8)
    v_mfma_f32_16x16x32_bf16 v[112:115], v[248:251], v[176:179], v[112:115]
    ds_read_b64_tr_b16 v[244:245], v66 offset:16640
    v_mfma_f32_16x16x32_bf16 v[116:119], v[248:251], v[180:183], v[116:119]
    ds_read_b64_tr_b16 v[246:247], v66 offset:17152
    v_mfma_f32_16x16x32_bf16 v[120:123], v[224:227], v[176:179], v[120:123]
    ds_read_b64_tr_b16 v[248:249], v66 offset:16672
    v_mfma_f32_16x16x32_bf16 v[124:127], v[224:227], v[180:183], v[124:127]
    ds_read_b64_tr_b16 v[250:251], v66 offset:17184
    buffer_load_dwordx4 v[220:223], v2, s[32:35], s16 offen offset:3072 sc1
    s_waitcnt lgkmcnt(8)
    v_mfma_f32_16x16x32_bf16 v[80:83], v[228:231], v[176:179], v[80:83]
    ds_read_b64_tr_b16 v[224:225], v67 offset:16640
    v_mfma_f32_16x16x32_bf16 v[84:87], v[228:231], v[180:183], v[84:87]
    ds_read_b64_tr_b16 v[226:227], v67 offset:17152
    v_mfma_f32_16x16x32_bf16 v[88:91], v[232:235], v[176:179], v[88:91]
    ds_read_b64_tr_b16 v[228:229], v67 offset:16672
    v_mfma_f32_16x16x32_bf16 v[92:95], v[232:235], v[180:183], v[92:95]
    ds_read_b64_tr_b16 v[230:231], v67 offset:17184
    s_waitcnt lgkmcnt(8)
    v_mfma_f32_16x16x32_bf16 v[96:99], v[236:239], v[176:179], v[96:99]
    ds_read_b64_tr_b16 v[232:233], v67 offset:12480
    v_mfma_f32_16x16x32_bf16 v[100:103], v[236:239], v[180:183], v[100:103]
    ds_read_b64_tr_b16 v[234:235], v67 offset:12992
    v_mfma_f32_16x16x32_bf16 v[104:107], v[240:243], v[176:179], v[104:107]
    ds_read_b64_tr_b16 v[236:237], v67 offset:12512
    v_mfma_f32_16x16x32_bf16 v[108:111], v[240:243], v[180:183], v[108:111]
    ds_read_b64_tr_b16 v[238:239], v67 offset:13024
    s_waitcnt lgkmcnt(8)
    v_mfma_f32_16x16x32_bf16 v[144:147], v[244:247], v[176:179], v[144:147]
    ds_read_b64_tr_b16 v[240:241], v66 offset:12480
    v_mfma_f32_16x16x32_bf16 v[148:151], v[244:247], v[180:183], v[148:151]
    ds_read_b64_tr_b16 v[242:243], v66 offset:12992
    v_mfma_f32_16x16x32_bf16 v[152:155], v[248:251], v[176:179], v[152:155]
    ds_read_b64_tr_b16 v[244:245], v66 offset:12512
    v_mfma_f32_16x16x32_bf16 v[156:159], v[248:251], v[180:183], v[156:159]
    ds_read_b64_tr_b16 v[246:247], v66 offset:13024
    s_waitcnt lgkmcnt(8)
    v_mfma_f32_16x16x32_bf16 v[160:163], v[224:227], v[176:179], v[160:163]
    ds_read_b64_tr_b16 v[248:249], v66 offset:4160
    v_mfma_f32_16x16x32_bf16 v[164:167], v[224:227], v[180:183], v[164:167]
    ds_read_b64_tr_b16 v[250:251], v66 offset:4672
    v_mfma_f32_16x16x32_bf16 v[168:171], v[228:231], v[176:179], v[168:171]
    ds_read_b64_tr_b16 v[224:225], v66 offset:4192
    v_mfma_f32_16x16x32_bf16 v[172:175], v[228:231], v[180:183], v[172:175]
    ds_read_b64_tr_b16 v[226:227], v66 offset:4704
    s_waitcnt lgkmcnt(8)
    s_waitcnt vmcnt(8)
    v_mfma_f32_16x16x32_bf16 v[128:131], v[232:235], v[184:187], v[128:131]
    ds_read_b64_tr_b16 v[228:229], v67 offset:4160
    v_mfma_f32_16x16x32_bf16 v[132:135], v[232:235], v[188:191], v[132:135]
    ds_read_b64_tr_b16 v[230:231], v67 offset:4672
    s_add_u32 s96, s85, 9
    s_and_b32 s97, s96, 15
    s_lshl_b32 s98, s97, 14
    s_add_u32 s16, s98, s15
    buffer_load_dwordx4 v[176:179], v2, s[32:35], s16 offen sc1
    v_mfma_f32_16x16x32_bf16 v[136:139], v[236:239], v[184:187], v[136:139]
    ds_read_b64_tr_b16 v[232:233], v67 offset:4192
    v_mfma_f32_16x16x32_bf16 v[140:143], v[236:239], v[188:191], v[140:143]
    ds_read_b64_tr_b16 v[234:235], v67 offset:4704
    s_waitcnt lgkmcnt(8)
    v_mfma_f32_16x16x32_bf16 v[112:115], v[240:243], v[184:187], v[112:115]
    ds_read_b64_tr_b16 v[236:237], v66 offset:20800
    v_mfma_f32_16x16x32_bf16 v[116:119], v[240:243], v[188:191], v[116:119]
    ds_read_b64_tr_b16 v[238:239], v66 offset:21312
    v_mfma_f32_16x16x32_bf16 v[120:123], v[244:247], v[184:187], v[120:123]
    ds_read_b64_tr_b16 v[240:241], v66 offset:20832
    v_mfma_f32_16x16x32_bf16 v[124:127], v[244:247], v[188:191], v[124:127]
    ds_read_b64_tr_b16 v[242:243], v66 offset:21344
    buffer_load_dwordx4 v[180:183], v2, s[32:35], s16 offen offset:1024 sc1
    s_waitcnt lgkmcnt(8)
    v_mfma_f32_16x16x32_bf16 v[80:83], v[248:251], v[184:187], v[80:83]
    ds_read_b64_tr_b16 v[244:245], v67 offset:20800
    v_mfma_f32_16x16x32_bf16 v[84:87], v[248:251], v[188:191], v[84:87]
    ds_read_b64_tr_b16 v[246:247], v67 offset:21312
    v_mfma_f32_16x16x32_bf16 v[88:91], v[224:227], v[184:187], v[88:91]
    ds_read_b64_tr_b16 v[248:249], v67 offset:20832
    v_mfma_f32_16x16x32_bf16 v[92:95], v[224:227], v[188:191], v[92:95]
    ds_read_b64_tr_b16 v[250:251], v67 offset:21344
    s_waitcnt lgkmcnt(8)
    v_mfma_f32_16x16x32_bf16 v[96:99], v[228:231], v[184:187], v[96:99]
    s_barrier
    ds_read_b64_tr_b16 v[224:225], v67 offset:33280
    v_mfma_f32_16x16x32_bf16 v[100:103], v[228:231], v[188:191], v[100:103]
    ds_read_b64_tr_b16 v[226:227], v67 offset:33792
    v_mfma_f32_16x16x32_bf16 v[104:107], v[232:235], v[184:187], v[104:107]
    ds_read_b64_tr_b16 v[228:229], v67 offset:33312
    v_mfma_f32_16x16x32_bf16 v[108:111], v[232:235], v[188:191], v[108:111]
    ds_read_b64_tr_b16 v[230:231], v67 offset:33824
    s_waitcnt lgkmcnt(8)
    v_mfma_f32_16x16x32_bf16 v[144:147], v[236:239], v[184:187], v[144:147]
    ds_read_b64_tr_b16 v[232:233], v66 offset:33280
    v_mfma_f32_16x16x32_bf16 v[148:151], v[236:239], v[188:191], v[148:151]
    ds_read_b64_tr_b16 v[234:235], v66 offset:33792
    v_mfma_f32_16x16x32_bf16 v[152:155], v[240:243], v[184:187], v[152:155]
    ds_read_b64_tr_b16 v[236:237], v66 offset:33312
    v_mfma_f32_16x16x32_bf16 v[156:159], v[240:243], v[188:191], v[156:159]
    ds_read_b64_tr_b16 v[238:239], v66 offset:33824
    s_waitcnt lgkmcnt(8)
    v_mfma_f32_16x16x32_bf16 v[160:163], v[244:247], v[184:187], v[160:163]
    ds_read_b64_tr_b16 v[240:241], v66 offset:24960
    v_mfma_f32_16x16x32_bf16 v[164:167], v[244:247], v[188:191], v[164:167]
    ds_read_b64_tr_b16 v[242:243], v66 offset:25472
    v_mfma_f32_16x16x32_bf16 v[168:171], v[248:251], v[184:187], v[168:171]
    ds_read_b64_tr_b16 v[244:245], v66 offset:24992
    v_mfma_f32_16x16x32_bf16 v[172:175], v[248:251], v[188:191], v[172:175]
    ds_read_b64_tr_b16 v[246:247], v66 offset:25504
    s_waitcnt lgkmcnt(8)
    s_waitcnt vmcnt(8)
    v_mfma_f32_16x16x32_bf16 v[128:131], v[224:227], v[192:195], v[128:131]
    ds_read_b64_tr_b16 v[248:249], v67 offset:24960
    v_mfma_f32_16x16x32_bf16 v[132:135], v[224:227], v[196:199], v[132:135]
    ds_read_b64_tr_b16 v[250:251], v67 offset:25472
    buffer_load_dwordx4 v[184:187], v2, s[32:35], s16 offen offset:2048 sc1
    v_mfma_f32_16x16x32_bf16 v[136:139], v[228:231], v[192:195], v[136:139]
    ds_read_b64_tr_b16 v[224:225], v67 offset:24992
    v_mfma_f32_16x16x32_bf16 v[140:143], v[228:231], v[196:199], v[140:143]
    ds_read_b64_tr_b16 v[226:227], v67 offset:25504
    s_waitcnt lgkmcnt(8)
    v_mfma_f32_16x16x32_bf16 v[112:115], v[232:235], v[192:195], v[112:115]
    ds_read_b64_tr_b16 v[228:229], v66 offset:41600
    v_mfma_f32_16x16x32_bf16 v[116:119], v[232:235], v[196:199], v[116:119]
    ds_read_b64_tr_b16 v[230:231], v66 offset:42112
    v_mfma_f32_16x16x32_bf16 v[120:123], v[236:239], v[192:195], v[120:123]
    ds_read_b64_tr_b16 v[232:233], v66 offset:41632
    v_mfma_f32_16x16x32_bf16 v[124:127], v[236:239], v[196:199], v[124:127]
    ds_read_b64_tr_b16 v[234:235], v66 offset:42144
    buffer_load_dwordx4 v[188:191], v2, s[32:35], s16 offen offset:3072 sc1
    s_waitcnt lgkmcnt(8)
    v_mfma_f32_16x16x32_bf16 v[80:83], v[240:243], v[192:195], v[80:83]
    ds_read_b64_tr_b16 v[236:237], v67 offset:41600
    v_mfma_f32_16x16x32_bf16 v[84:87], v[240:243], v[196:199], v[84:87]
    ds_read_b64_tr_b16 v[238:239], v67 offset:42112
    v_mfma_f32_16x16x32_bf16 v[88:91], v[244:247], v[192:195], v[88:91]
    ds_read_b64_tr_b16 v[240:241], v67 offset:41632
    v_mfma_f32_16x16x32_bf16 v[92:95], v[244:247], v[196:199], v[92:95]
    ds_read_b64_tr_b16 v[242:243], v67 offset:42144
    s_waitcnt lgkmcnt(8)
    v_mfma_f32_16x16x32_bf16 v[96:99], v[248:251], v[192:195], v[96:99]
    ds_read_b64_tr_b16 v[244:245], v67 offset:37440
    v_mfma_f32_16x16x32_bf16 v[100:103], v[248:251], v[196:199], v[100:103]
    ds_read_b64_tr_b16 v[246:247], v67 offset:37952
    v_mfma_f32_16x16x32_bf16 v[104:107], v[224:227], v[192:195], v[104:107]
    ds_read_b64_tr_b16 v[248:249], v67 offset:37472
    v_mfma_f32_16x16x32_bf16 v[108:111], v[224:227], v[196:199], v[108:111]
    ds_read_b64_tr_b16 v[250:251], v67 offset:37984
    s_waitcnt lgkmcnt(8)
    v_mfma_f32_16x16x32_bf16 v[144:147], v[228:231], v[192:195], v[144:147]
    ds_read_b64_tr_b16 v[224:225], v66 offset:37440
    v_mfma_f32_16x16x32_bf16 v[148:151], v[228:231], v[196:199], v[148:151]
    ds_read_b64_tr_b16 v[226:227], v66 offset:37952
    v_mfma_f32_16x16x32_bf16 v[152:155], v[232:235], v[192:195], v[152:155]
    ds_read_b64_tr_b16 v[228:229], v66 offset:37472
    v_mfma_f32_16x16x32_bf16 v[156:159], v[232:235], v[196:199], v[156:159]
    ds_read_b64_tr_b16 v[230:231], v66 offset:37984
    s_waitcnt lgkmcnt(8)
    v_mfma_f32_16x16x32_bf16 v[160:163], v[236:239], v[192:195], v[160:163]
    ds_read_b64_tr_b16 v[232:233], v66 offset:29120
    v_mfma_f32_16x16x32_bf16 v[164:167], v[236:239], v[196:199], v[164:167]
    ds_read_b64_tr_b16 v[234:235], v66 offset:29632
    v_mfma_f32_16x16x32_bf16 v[168:171], v[240:243], v[192:195], v[168:171]
    ds_read_b64_tr_b16 v[236:237], v66 offset:29152
    v_mfma_f32_16x16x32_bf16 v[172:175], v[240:243], v[196:199], v[172:175]
    ds_read_b64_tr_b16 v[238:239], v66 offset:29664
    s_waitcnt lgkmcnt(8)
    s_waitcnt vmcnt(8)
    v_mfma_f32_16x16x32_bf16 v[128:131], v[244:247], v[200:203], v[128:131]
    ds_read_b64_tr_b16 v[240:241], v67 offset:29120
    v_mfma_f32_16x16x32_bf16 v[132:135], v[244:247], v[204:207], v[132:135]
    ds_read_b64_tr_b16 v[242:243], v67 offset:29632
    s_add_u32 s96, s85, 10
    s_and_b32 s97, s96, 15
    s_lshl_b32 s98, s97, 14
    s_add_u32 s16, s98, s15
    buffer_load_dwordx4 v[192:195], v2, s[32:35], s16 offen sc1
    v_mfma_f32_16x16x32_bf16 v[136:139], v[248:251], v[200:203], v[136:139]
    ds_read_b64_tr_b16 v[244:245], v67 offset:29152
    v_mfma_f32_16x16x32_bf16 v[140:143], v[248:251], v[204:207], v[140:143]
    ds_read_b64_tr_b16 v[246:247], v67 offset:29664
    s_waitcnt lgkmcnt(8)
    v_mfma_f32_16x16x32_bf16 v[112:115], v[224:227], v[200:203], v[112:115]
    ds_read_b64_tr_b16 v[248:249], v66 offset:45760
    v_mfma_f32_16x16x32_bf16 v[116:119], v[224:227], v[204:207], v[116:119]
    ds_read_b64_tr_b16 v[250:251], v66 offset:46272
    v_mfma_f32_16x16x32_bf16 v[120:123], v[228:231], v[200:203], v[120:123]
    ds_read_b64_tr_b16 v[224:225], v66 offset:45792
    v_mfma_f32_16x16x32_bf16 v[124:127], v[228:231], v[204:207], v[124:127]
    ds_read_b64_tr_b16 v[226:227], v66 offset:46304
    buffer_load_dwordx4 v[196:199], v2, s[32:35], s16 offen offset:1024 sc1
    s_waitcnt lgkmcnt(8)
    v_mfma_f32_16x16x32_bf16 v[80:83], v[232:235], v[200:203], v[80:83]
    ds_read_b64_tr_b16 v[228:229], v67 offset:45760
    v_mfma_f32_16x16x32_bf16 v[84:87], v[232:235], v[204:207], v[84:87]
    ds_read_b64_tr_b16 v[230:231], v67 offset:46272
    v_mfma_f32_16x16x32_bf16 v[88:91], v[236:239], v[200:203], v[88:91]
    ds_read_b64_tr_b16 v[232:233], v67 offset:45792
    v_mfma_f32_16x16x32_bf16 v[92:95], v[236:239], v[204:207], v[92:95]
    ds_read_b64_tr_b16 v[234:235], v67 offset:46304
    s_waitcnt lgkmcnt(8)
    v_mfma_f32_16x16x32_bf16 v[96:99], v[240:243], v[200:203], v[96:99]
    s_barrier
    ds_read_b64_tr_b16 v[236:237], v69 offset:8320
    v_mfma_f32_16x16x32_bf16 v[100:103], v[240:243], v[204:207], v[100:103]
    ds_read_b64_tr_b16 v[238:239], v69 offset:8832
    v_mfma_f32_16x16x32_bf16 v[104:107], v[244:247], v[200:203], v[104:107]
    ds_read_b64_tr_b16 v[240:241], v69 offset:8352
    v_mfma_f32_16x16x32_bf16 v[108:111], v[244:247], v[204:207], v[108:111]
    ds_read_b64_tr_b16 v[242:243], v69 offset:8864
    s_waitcnt lgkmcnt(8)
    v_mfma_f32_16x16x32_bf16 v[144:147], v[248:251], v[200:203], v[144:147]
    ds_read_b64_tr_b16 v[244:245], v68 offset:8320
    v_mfma_f32_16x16x32_bf16 v[148:151], v[248:251], v[204:207], v[148:151]
    ds_read_b64_tr_b16 v[246:247], v68 offset:8832
    v_mfma_f32_16x16x32_bf16 v[152:155], v[224:227], v[200:203], v[152:155]
    ds_read_b64_tr_b16 v[248:249], v68 offset:8352
    v_mfma_f32_16x16x32_bf16 v[156:159], v[224:227], v[204:207], v[156:159]
    ds_read_b64_tr_b16 v[250:251], v68 offset:8864
    s_waitcnt lgkmcnt(8)
    v_mfma_f32_16x16x32_bf16 v[160:163], v[228:231], v[200:203], v[160:163]
    ds_read_b64_tr_b16 v[224:225], v68
    v_mfma_f32_16x16x32_bf16 v[164:167], v[228:231], v[204:207], v[164:167]
    ds_read_b64_tr_b16 v[226:227], v68 offset:512
    v_mfma_f32_16x16x32_bf16 v[168:171], v[232:235], v[200:203], v[168:171]
    ds_read_b64_tr_b16 v[228:229], v68 offset:32
    v_mfma_f32_16x16x32_bf16 v[172:175], v[232:235], v[204:207], v[172:175]
    ds_read_b64_tr_b16 v[230:231], v68 offset:544
    s_waitcnt lgkmcnt(8)
    s_waitcnt vmcnt(8)
    v_mfma_f32_16x16x32_bf16 v[128:131], v[236:239], v[208:211], v[128:131]
    ds_read_b64_tr_b16 v[232:233], v69
    v_mfma_f32_16x16x32_bf16 v[132:135], v[236:239], v[212:215], v[132:135]
    ds_read_b64_tr_b16 v[234:235], v69 offset:512
    buffer_load_dwordx4 v[200:203], v2, s[32:35], s16 offen offset:2048 sc1
    v_mfma_f32_16x16x32_bf16 v[136:139], v[240:243], v[208:211], v[136:139]
    ds_read_b64_tr_b16 v[236:237], v69 offset:32
    v_mfma_f32_16x16x32_bf16 v[140:143], v[240:243], v[212:215], v[140:143]
    ds_read_b64_tr_b16 v[238:239], v69 offset:544
    s_waitcnt lgkmcnt(8)
    v_mfma_f32_16x16x32_bf16 v[112:115], v[244:247], v[208:211], v[112:115]
    ds_read_b64_tr_b16 v[240:241], v68 offset:16640
    v_mfma_f32_16x16x32_bf16 v[116:119], v[244:247], v[212:215], v[116:119]
    ds_read_b64_tr_b16 v[242:243], v68 offset:17152
    v_mfma_f32_16x16x32_bf16 v[120:123], v[248:251], v[208:211], v[120:123]
    ds_read_b64_tr_b16 v[244:245], v68 offset:16672
    v_mfma_f32_16x16x32_bf16 v[124:127], v[248:251], v[212:215], v[124:127]
    ds_read_b64_tr_b16 v[246:247], v68 offset:17184
    buffer_load_dwordx4 v[204:207], v2, s[32:35], s16 offen offset:3072 sc1
    s_waitcnt lgkmcnt(8)
    v_mfma_f32_16x16x32_bf16 v[80:83], v[224:227], v[208:211], v[80:83]
    ds_read_b64_tr_b16 v[248:249], v69 offset:16640
    v_mfma_f32_16x16x32_bf16 v[84:87], v[224:227], v[212:215], v[84:87]
    ds_read_b64_tr_b16 v[250:251], v69 offset:17152
    v_mfma_f32_16x16x32_bf16 v[88:91], v[228:231], v[208:211], v[88:91]
    ds_read_b64_tr_b16 v[224:225], v69 offset:16672
    v_mfma_f32_16x16x32_bf16 v[92:95], v[228:231], v[212:215], v[92:95]
    ds_read_b64_tr_b16 v[226:227], v69 offset:17184
    s_waitcnt lgkmcnt(8)
    v_mfma_f32_16x16x32_bf16 v[96:99], v[232:235], v[208:211], v[96:99]
    ds_read_b64_tr_b16 v[228:229], v69 offset:12480
    v_mfma_f32_16x16x32_bf16 v[100:103], v[232:235], v[212:215], v[100:103]
    ds_read_b64_tr_b16 v[230:231], v69 offset:12992
    v_mfma_f32_16x16x32_bf16 v[104:107], v[236:239], v[208:211], v[104:107]
    ds_read_b64_tr_b16 v[232:233], v69 offset:12512
    v_mfma_f32_16x16x32_bf16 v[108:111], v[236:239], v[212:215], v[108:111]
    ds_read_b64_tr_b16 v[234:235], v69 offset:13024
    s_waitcnt lgkmcnt(8)
    v_mfma_f32_16x16x32_bf16 v[144:147], v[240:243], v[208:211], v[144:147]
    ds_read_b64_tr_b16 v[236:237], v68 offset:12480
    v_mfma_f32_16x16x32_bf16 v[148:151], v[240:243], v[212:215], v[148:151]
    ds_read_b64_tr_b16 v[238:239], v68 offset:12992
    v_mfma_f32_16x16x32_bf16 v[152:155], v[244:247], v[208:211], v[152:155]
    ds_read_b64_tr_b16 v[240:241], v68 offset:12512
    v_mfma_f32_16x16x32_bf16 v[156:159], v[244:247], v[212:215], v[156:159]
    ds_read_b64_tr_b16 v[242:243], v68 offset:13024
    s_waitcnt lgkmcnt(8)
    v_mfma_f32_16x16x32_bf16 v[160:163], v[248:251], v[208:211], v[160:163]
    ds_read_b64_tr_b16 v[244:245], v68 offset:4160
    v_mfma_f32_16x16x32_bf16 v[164:167], v[248:251], v[212:215], v[164:167]
    ds_read_b64_tr_b16 v[246:247], v68 offset:4672
    v_mfma_f32_16x16x32_bf16 v[168:171], v[224:227], v[208:211], v[168:171]
    ds_read_b64_tr_b16 v[248:249], v68 offset:4192
    v_mfma_f32_16x16x32_bf16 v[172:175], v[224:227], v[212:215], v[172:175]
    ds_read_b64_tr_b16 v[250:251], v68 offset:4704
    s_waitcnt lgkmcnt(8)
    s_waitcnt vmcnt(8)
    v_mfma_f32_16x16x32_bf16 v[128:131], v[228:231], v[216:219], v[128:131]
    ds_read_b64_tr_b16 v[224:225], v69 offset:4160
    v_mfma_f32_16x16x32_bf16 v[132:135], v[228:231], v[220:223], v[132:135]
    ds_read_b64_tr_b16 v[226:227], v69 offset:4672
    s_add_u32 s96, s85, 11
    s_and_b32 s97, s96, 15
    s_lshl_b32 s98, s97, 14
    s_add_u32 s16, s98, s15
    buffer_load_dwordx4 v[208:211], v2, s[32:35], s16 offen sc1
    v_mfma_f32_16x16x32_bf16 v[136:139], v[232:235], v[216:219], v[136:139]
    ds_read_b64_tr_b16 v[228:229], v69 offset:4192
    v_mfma_f32_16x16x32_bf16 v[140:143], v[232:235], v[220:223], v[140:143]
    ds_read_b64_tr_b16 v[230:231], v69 offset:4704
    s_waitcnt lgkmcnt(8)
    v_mfma_f32_16x16x32_bf16 v[112:115], v[236:239], v[216:219], v[112:115]
    ds_read_b64_tr_b16 v[232:233], v68 offset:20800
    v_mfma_f32_16x16x32_bf16 v[116:119], v[236:239], v[220:223], v[116:119]
    ds_read_b64_tr_b16 v[234:235], v68 offset:21312
    v_mfma_f32_16x16x32_bf16 v[120:123], v[240:243], v[216:219], v[120:123]
    ds_read_b64_tr_b16 v[236:237], v68 offset:20832
    v_mfma_f32_16x16x32_bf16 v[124:127], v[240:243], v[220:223], v[124:127]
    ds_read_b64_tr_b16 v[238:239], v68 offset:21344
    buffer_load_dwordx4 v[212:215], v2, s[32:35], s16 offen offset:1024 sc1
    s_waitcnt lgkmcnt(8)
    v_mfma_f32_16x16x32_bf16 v[80:83], v[244:247], v[216:219], v[80:83]
    ds_read_b64_tr_b16 v[240:241], v69 offset:20800
    v_mfma_f32_16x16x32_bf16 v[84:87], v[244:247], v[220:223], v[84:87]
    ds_read_b64_tr_b16 v[242:243], v69 offset:21312
    v_mfma_f32_16x16x32_bf16 v[88:91], v[248:251], v[216:219], v[88:91]
    ds_read_b64_tr_b16 v[244:245], v69 offset:20832
    v_mfma_f32_16x16x32_bf16 v[92:95], v[248:251], v[220:223], v[92:95]
    ds_read_b64_tr_b16 v[246:247], v69 offset:21344
    s_waitcnt lgkmcnt(8)
    v_mfma_f32_16x16x32_bf16 v[96:99], v[224:227], v[216:219], v[96:99]
    s_barrier
    ds_read_b64_tr_b16 v[248:249], v69 offset:33280
    v_mfma_f32_16x16x32_bf16 v[100:103], v[224:227], v[220:223], v[100:103]
    ds_read_b64_tr_b16 v[250:251], v69 offset:33792
    v_mfma_f32_16x16x32_bf16 v[104:107], v[228:231], v[216:219], v[104:107]
    ds_read_b64_tr_b16 v[224:225], v69 offset:33312
    v_mfma_f32_16x16x32_bf16 v[108:111], v[228:231], v[220:223], v[108:111]
    ds_read_b64_tr_b16 v[226:227], v69 offset:33824
    s_waitcnt lgkmcnt(8)
    v_mfma_f32_16x16x32_bf16 v[144:147], v[232:235], v[216:219], v[144:147]
    ds_read_b64_tr_b16 v[228:229], v68 offset:33280
    v_mfma_f32_16x16x32_bf16 v[148:151], v[232:235], v[220:223], v[148:151]
    ds_read_b64_tr_b16 v[230:231], v68 offset:33792
    v_mfma_f32_16x16x32_bf16 v[152:155], v[236:239], v[216:219], v[152:155]
    ds_read_b64_tr_b16 v[232:233], v68 offset:33312
    v_mfma_f32_16x16x32_bf16 v[156:159], v[236:239], v[220:223], v[156:159]
    ds_read_b64_tr_b16 v[234:235], v68 offset:33824
    s_waitcnt lgkmcnt(8)
    v_mfma_f32_16x16x32_bf16 v[160:163], v[240:243], v[216:219], v[160:163]
    ds_read_b64_tr_b16 v[236:237], v68 offset:24960
    v_mfma_f32_16x16x32_bf16 v[164:167], v[240:243], v[220:223], v[164:167]
    ds_read_b64_tr_b16 v[238:239], v68 offset:25472
    v_mfma_f32_16x16x32_bf16 v[168:171], v[244:247], v[216:219], v[168:171]
    ds_read_b64_tr_b16 v[240:241], v68 offset:24992
    v_mfma_f32_16x16x32_bf16 v[172:175], v[244:247], v[220:223], v[172:175]
    ds_read_b64_tr_b16 v[242:243], v68 offset:25504
    s_waitcnt lgkmcnt(8)
    s_waitcnt vmcnt(8)
    v_mfma_f32_16x16x32_bf16 v[128:131], v[248:251], v[176:179], v[128:131]
    ds_read_b64_tr_b16 v[244:245], v69 offset:24960
    v_mfma_f32_16x16x32_bf16 v[132:135], v[248:251], v[180:183], v[132:135]
    ds_read_b64_tr_b16 v[246:247], v69 offset:25472
    buffer_load_dwordx4 v[216:219], v2, s[32:35], s16 offen offset:2048 sc1
    v_mfma_f32_16x16x32_bf16 v[136:139], v[224:227], v[176:179], v[136:139]
    ds_read_b64_tr_b16 v[248:249], v69 offset:24992
    v_mfma_f32_16x16x32_bf16 v[140:143], v[224:227], v[180:183], v[140:143]
    ds_read_b64_tr_b16 v[250:251], v69 offset:25504
    s_waitcnt lgkmcnt(8)
    v_mfma_f32_16x16x32_bf16 v[112:115], v[228:231], v[176:179], v[112:115]
    ds_read_b64_tr_b16 v[224:225], v68 offset:41600
    v_mfma_f32_16x16x32_bf16 v[116:119], v[228:231], v[180:183], v[116:119]
    ds_read_b64_tr_b16 v[226:227], v68 offset:42112
    v_mfma_f32_16x16x32_bf16 v[120:123], v[232:235], v[176:179], v[120:123]
    ds_read_b64_tr_b16 v[228:229], v68 offset:41632
    v_mfma_f32_16x16x32_bf16 v[124:127], v[232:235], v[180:183], v[124:127]
    ds_read_b64_tr_b16 v[230:231], v68 offset:42144
    buffer_load_dwordx4 v[220:223], v2, s[32:35], s16 offen offset:3072 sc1
    s_waitcnt lgkmcnt(8)
    v_mfma_f32_16x16x32_bf16 v[80:83], v[236:239], v[176:179], v[80:83]
    ds_read_b64_tr_b16 v[232:233], v69 offset:41600
    v_mfma_f32_16x16x32_bf16 v[84:87], v[236:239], v[180:183], v[84:87]
    ds_read_b64_tr_b16 v[234:235], v69 offset:42112
    v_mfma_f32_16x16x32_bf16 v[88:91], v[240:243], v[176:179], v[88:91]
    ds_read_b64_tr_b16 v[236:237], v69 offset:41632
    v_mfma_f32_16x16x32_bf16 v[92:95], v[240:243], v[180:183], v[92:95]
    ds_read_b64_tr_b16 v[238:239], v69 offset:42144
    s_waitcnt lgkmcnt(8)
    v_mfma_f32_16x16x32_bf16 v[96:99], v[244:247], v[176:179], v[96:99]
    ds_read_b64_tr_b16 v[240:241], v69 offset:37440
    v_mfma_f32_16x16x32_bf16 v[100:103], v[244:247], v[180:183], v[100:103]
    ds_read_b64_tr_b16 v[242:243], v69 offset:37952
    v_mfma_f32_16x16x32_bf16 v[104:107], v[248:251], v[176:179], v[104:107]
    ds_read_b64_tr_b16 v[244:245], v69 offset:37472
    v_mfma_f32_16x16x32_bf16 v[108:111], v[248:251], v[180:183], v[108:111]
    ds_read_b64_tr_b16 v[246:247], v69 offset:37984
    s_waitcnt lgkmcnt(8)
    v_mfma_f32_16x16x32_bf16 v[144:147], v[224:227], v[176:179], v[144:147]
    ds_read_b64_tr_b16 v[248:249], v68 offset:37440
    v_mfma_f32_16x16x32_bf16 v[148:151], v[224:227], v[180:183], v[148:151]
    ds_read_b64_tr_b16 v[250:251], v68 offset:37952
    v_mfma_f32_16x16x32_bf16 v[152:155], v[228:231], v[176:179], v[152:155]
    ds_read_b64_tr_b16 v[224:225], v68 offset:37472
    v_mfma_f32_16x16x32_bf16 v[156:159], v[228:231], v[180:183], v[156:159]
    ds_read_b64_tr_b16 v[226:227], v68 offset:37984
    s_waitcnt lgkmcnt(8)
    v_mfma_f32_16x16x32_bf16 v[160:163], v[232:235], v[176:179], v[160:163]
    ds_read_b64_tr_b16 v[228:229], v68 offset:29120
    v_mfma_f32_16x16x32_bf16 v[164:167], v[232:235], v[180:183], v[164:167]
    ds_read_b64_tr_b16 v[230:231], v68 offset:29632
    v_mfma_f32_16x16x32_bf16 v[168:171], v[236:239], v[176:179], v[168:171]
    ds_read_b64_tr_b16 v[232:233], v68 offset:29152
    v_mfma_f32_16x16x32_bf16 v[172:175], v[236:239], v[180:183], v[172:175]
    ds_read_b64_tr_b16 v[234:235], v68 offset:29664
    s_waitcnt lgkmcnt(8)
    s_waitcnt vmcnt(8)
    v_mfma_f32_16x16x32_bf16 v[128:131], v[240:243], v[184:187], v[128:131]
    ds_read_b64_tr_b16 v[236:237], v69 offset:29120
    v_mfma_f32_16x16x32_bf16 v[132:135], v[240:243], v[188:191], v[132:135]
    ds_read_b64_tr_b16 v[238:239], v69 offset:29632
    s_add_u32 s96, s85, 12
    s_and_b32 s97, s96, 15
    s_lshl_b32 s98, s97, 14
    s_add_u32 s16, s98, s15
    buffer_load_dwordx4 v[176:179], v2, s[32:35], s16 offen sc1
    v_mfma_f32_16x16x32_bf16 v[136:139], v[244:247], v[184:187], v[136:139]
    ds_read_b64_tr_b16 v[240:241], v69 offset:29152
    v_mfma_f32_16x16x32_bf16 v[140:143], v[244:247], v[188:191], v[140:143]
    ds_read_b64_tr_b16 v[242:243], v69 offset:29664
    s_waitcnt lgkmcnt(8)
    v_mfma_f32_16x16x32_bf16 v[112:115], v[248:251], v[184:187], v[112:115]
    ds_read_b64_tr_b16 v[244:245], v68 offset:45760
    v_mfma_f32_16x16x32_bf16 v[116:119], v[248:251], v[188:191], v[116:119]
    ds_read_b64_tr_b16 v[246:247], v68 offset:46272
    v_mfma_f32_16x16x32_bf16 v[120:123], v[224:227], v[184:187], v[120:123]
    ds_read_b64_tr_b16 v[248:249], v68 offset:45792
    v_mfma_f32_16x16x32_bf16 v[124:127], v[224:227], v[188:191], v[124:127]
    ds_read_b64_tr_b16 v[250:251], v68 offset:46304
    buffer_load_dwordx4 v[180:183], v2, s[32:35], s16 offen offset:1024 sc1
    s_waitcnt lgkmcnt(8)
    v_mfma_f32_16x16x32_bf16 v[80:83], v[228:231], v[184:187], v[80:83]
    ds_read_b64_tr_b16 v[224:225], v69 offset:45760
    v_mfma_f32_16x16x32_bf16 v[84:87], v[228:231], v[188:191], v[84:87]
    ds_read_b64_tr_b16 v[226:227], v69 offset:46272
    v_mfma_f32_16x16x32_bf16 v[88:91], v[232:235], v[184:187], v[88:91]
    ds_read_b64_tr_b16 v[228:229], v69 offset:45792
    v_mfma_f32_16x16x32_bf16 v[92:95], v[232:235], v[188:191], v[92:95]
    ds_read_b64_tr_b16 v[230:231], v69 offset:46304
    s_waitcnt lgkmcnt(8)
    v_mfma_f32_16x16x32_bf16 v[96:99], v[236:239], v[184:187], v[96:99]
    s_barrier
    ds_read_b64_tr_b16 v[232:233], v71 offset:8320
    v_mfma_f32_16x16x32_bf16 v[100:103], v[236:239], v[188:191], v[100:103]
    ds_read_b64_tr_b16 v[234:235], v71 offset:8832
    v_mfma_f32_16x16x32_bf16 v[104:107], v[240:243], v[184:187], v[104:107]
    ds_read_b64_tr_b16 v[236:237], v71 offset:8352
    v_mfma_f32_16x16x32_bf16 v[108:111], v[240:243], v[188:191], v[108:111]
    ds_read_b64_tr_b16 v[238:239], v71 offset:8864
    s_waitcnt lgkmcnt(8)
    v_mfma_f32_16x16x32_bf16 v[144:147], v[244:247], v[184:187], v[144:147]
    ds_read_b64_tr_b16 v[240:241], v70 offset:8320
    v_mfma_f32_16x16x32_bf16 v[148:151], v[244:247], v[188:191], v[148:151]
    ds_read_b64_tr_b16 v[242:243], v70 offset:8832
    v_mfma_f32_16x16x32_bf16 v[152:155], v[248:251], v[184:187], v[152:155]
    ds_read_b64_tr_b16 v[244:245], v70 offset:8352
    v_mfma_f32_16x16x32_bf16 v[156:159], v[248:251], v[188:191], v[156:159]
    ds_read_b64_tr_b16 v[246:247], v70 offset:8864
    s_waitcnt lgkmcnt(8)
    v_mfma_f32_16x16x32_bf16 v[160:163], v[224:227], v[184:187], v[160:163]
    ds_read_b64_tr_b16 v[248:249], v70
    v_mfma_f32_16x16x32_bf16 v[164:167], v[224:227], v[188:191], v[164:167]
    ds_read_b64_tr_b16 v[250:251], v70 offset:512
    v_mfma_f32_16x16x32_bf16 v[168:171], v[228:231], v[184:187], v[168:171]
    ds_read_b64_tr_b16 v[224:225], v70 offset:32
    v_mfma_f32_16x16x32_bf16 v[172:175], v[228:231], v[188:191], v[172:175]
    ds_read_b64_tr_b16 v[226:227], v70 offset:544
    s_waitcnt lgkmcnt(8)
    s_waitcnt vmcnt(8)
    v_mfma_f32_16x16x32_bf16 v[128:131], v[232:235], v[192:195], v[128:131]
    ds_read_b64_tr_b16 v[228:229], v71
    v_mfma_f32_16x16x32_bf16 v[132:135], v[232:235], v[196:199], v[132:135]
    ds_read_b64_tr_b16 v[230:231], v71 offset:512
    buffer_load_dwordx4 v[184:187], v2, s[32:35], s16 offen offset:2048 sc1
    v_mfma_f32_16x16x32_bf16 v[136:139], v[236:239], v[192:195], v[136:139]
    ds_read_b64_tr_b16 v[232:233], v71 offset:32
    v_mfma_f32_16x16x32_bf16 v[140:143], v[236:239], v[196:199], v[140:143]
    ds_read_b64_tr_b16 v[234:235], v71 offset:544
    s_waitcnt lgkmcnt(8)
    v_mfma_f32_16x16x32_bf16 v[112:115], v[240:243], v[192:195], v[112:115]
    ds_read_b64_tr_b16 v[236:237], v70 offset:16640
    v_mfma_f32_16x16x32_bf16 v[116:119], v[240:243], v[196:199], v[116:119]
    ds_read_b64_tr_b16 v[238:239], v70 offset:17152
    v_mfma_f32_16x16x32_bf16 v[120:123], v[244:247], v[192:195], v[120:123]
    ds_read_b64_tr_b16 v[240:241], v70 offset:16672
    v_mfma_f32_16x16x32_bf16 v[124:127], v[244:247], v[196:199], v[124:127]
    ds_read_b64_tr_b16 v[242:243], v70 offset:17184
    buffer_load_dwordx4 v[188:191], v2, s[32:35], s16 offen offset:3072 sc1
    s_waitcnt lgkmcnt(8)
    v_mfma_f32_16x16x32_bf16 v[80:83], v[248:251], v[192:195], v[80:83]
    ds_read_b64_tr_b16 v[244:245], v71 offset:16640
    v_mfma_f32_16x16x32_bf16 v[84:87], v[248:251], v[196:199], v[84:87]
    ds_read_b64_tr_b16 v[246:247], v71 offset:17152
    v_mfma_f32_16x16x32_bf16 v[88:91], v[224:227], v[192:195], v[88:91]
    ds_read_b64_tr_b16 v[248:249], v71 offset:16672
    v_mfma_f32_16x16x32_bf16 v[92:95], v[224:227], v[196:199], v[92:95]
    ds_read_b64_tr_b16 v[250:251], v71 offset:17184
    s_waitcnt lgkmcnt(8)
    v_mfma_f32_16x16x32_bf16 v[96:99], v[228:231], v[192:195], v[96:99]
    ds_read_b64_tr_b16 v[224:225], v71 offset:12480
    v_mfma_f32_16x16x32_bf16 v[100:103], v[228:231], v[196:199], v[100:103]
    ds_read_b64_tr_b16 v[226:227], v71 offset:12992
    v_mfma_f32_16x16x32_bf16 v[104:107], v[232:235], v[192:195], v[104:107]
    ds_read_b64_tr_b16 v[228:229], v71 offset:12512
    v_mfma_f32_16x16x32_bf16 v[108:111], v[232:235], v[196:199], v[108:111]
    ds_read_b64_tr_b16 v[230:231], v71 offset:13024
    s_waitcnt lgkmcnt(8)
    v_mfma_f32_16x16x32_bf16 v[144:147], v[236:239], v[192:195], v[144:147]
    ds_read_b64_tr_b16 v[232:233], v70 offset:12480
    v_mfma_f32_16x16x32_bf16 v[148:151], v[236:239], v[196:199], v[148:151]
    ds_read_b64_tr_b16 v[234:235], v70 offset:12992
    v_mfma_f32_16x16x32_bf16 v[152:155], v[240:243], v[192:195], v[152:155]
    ds_read_b64_tr_b16 v[236:237], v70 offset:12512
    v_mfma_f32_16x16x32_bf16 v[156:159], v[240:243], v[196:199], v[156:159]
    ds_read_b64_tr_b16 v[238:239], v70 offset:13024
    s_waitcnt lgkmcnt(8)
    v_mfma_f32_16x16x32_bf16 v[160:163], v[244:247], v[192:195], v[160:163]
    ds_read_b64_tr_b16 v[240:241], v70 offset:4160
    v_mfma_f32_16x16x32_bf16 v[164:167], v[244:247], v[196:199], v[164:167]
    ds_read_b64_tr_b16 v[242:243], v70 offset:4672
    v_mfma_f32_16x16x32_bf16 v[168:171], v[248:251], v[192:195], v[168:171]
    ds_read_b64_tr_b16 v[244:245], v70 offset:4192
    v_mfma_f32_16x16x32_bf16 v[172:175], v[248:251], v[196:199], v[172:175]
    ds_read_b64_tr_b16 v[246:247], v70 offset:4704
    s_waitcnt lgkmcnt(8)
    s_waitcnt vmcnt(8)
    v_mfma_f32_16x16x32_bf16 v[128:131], v[224:227], v[200:203], v[128:131]
    ds_read_b64_tr_b16 v[248:249], v71 offset:4160
    v_mfma_f32_16x16x32_bf16 v[132:135], v[224:227], v[204:207], v[132:135]
    ds_read_b64_tr_b16 v[250:251], v71 offset:4672
    s_add_u32 s96, s85, 13
    s_and_b32 s97, s96, 15
    s_lshl_b32 s98, s97, 14
    s_add_u32 s16, s98, s15
    buffer_load_dwordx4 v[192:195], v2, s[32:35], s16 offen sc1
    v_mfma_f32_16x16x32_bf16 v[136:139], v[228:231], v[200:203], v[136:139]
    ds_read_b64_tr_b16 v[224:225], v71 offset:4192
    v_mfma_f32_16x16x32_bf16 v[140:143], v[228:231], v[204:207], v[140:143]
    ds_read_b64_tr_b16 v[226:227], v71 offset:4704
    s_waitcnt lgkmcnt(8)
    v_mfma_f32_16x16x32_bf16 v[112:115], v[232:235], v[200:203], v[112:115]
    ds_read_b64_tr_b16 v[228:229], v70 offset:20800
    v_mfma_f32_16x16x32_bf16 v[116:119], v[232:235], v[204:207], v[116:119]
    ds_read_b64_tr_b16 v[230:231], v70 offset:21312
    v_mfma_f32_16x16x32_bf16 v[120:123], v[236:239], v[200:203], v[120:123]
    ds_read_b64_tr_b16 v[232:233], v70 offset:20832
    v_mfma_f32_16x16x32_bf16 v[124:127], v[236:239], v[204:207], v[124:127]
    ds_read_b64_tr_b16 v[234:235], v70 offset:21344
    buffer_load_dwordx4 v[196:199], v2, s[32:35], s16 offen offset:1024 sc1
    s_waitcnt lgkmcnt(8)
    v_mfma_f32_16x16x32_bf16 v[80:83], v[240:243], v[200:203], v[80:83]
    ds_read_b64_tr_b16 v[236:237], v71 offset:20800
    v_mfma_f32_16x16x32_bf16 v[84:87], v[240:243], v[204:207], v[84:87]
    ds_read_b64_tr_b16 v[238:239], v71 offset:21312
    v_mfma_f32_16x16x32_bf16 v[88:91], v[244:247], v[200:203], v[88:91]
    ds_read_b64_tr_b16 v[240:241], v71 offset:20832
    v_mfma_f32_16x16x32_bf16 v[92:95], v[244:247], v[204:207], v[92:95]
    ds_read_b64_tr_b16 v[242:243], v71 offset:21344
    s_waitcnt lgkmcnt(8)
    v_mfma_f32_16x16x32_bf16 v[96:99], v[248:251], v[200:203], v[96:99]
    s_barrier
    ds_read_b64_tr_b16 v[244:245], v71 offset:33280
    v_mfma_f32_16x16x32_bf16 v[100:103], v[248:251], v[204:207], v[100:103]
    ds_read_b64_tr_b16 v[246:247], v71 offset:33792
    v_mfma_f32_16x16x32_bf16 v[104:107], v[224:227], v[200:203], v[104:107]
    ds_read_b64_tr_b16 v[248:249], v71 offset:33312
    v_mfma_f32_16x16x32_bf16 v[108:111], v[224:227], v[204:207], v[108:111]
    ds_read_b64_tr_b16 v[250:251], v71 offset:33824
    s_waitcnt lgkmcnt(8)
    v_mfma_f32_16x16x32_bf16 v[144:147], v[228:231], v[200:203], v[144:147]
    ds_read_b64_tr_b16 v[224:225], v70 offset:33280
    v_mfma_f32_16x16x32_bf16 v[148:151], v[228:231], v[204:207], v[148:151]
    ds_read_b64_tr_b16 v[226:227], v70 offset:33792
    v_mfma_f32_16x16x32_bf16 v[152:155], v[232:235], v[200:203], v[152:155]
    ds_read_b64_tr_b16 v[228:229], v70 offset:33312
    v_mfma_f32_16x16x32_bf16 v[156:159], v[232:235], v[204:207], v[156:159]
    ds_read_b64_tr_b16 v[230:231], v70 offset:33824
    s_waitcnt lgkmcnt(8)
    v_mfma_f32_16x16x32_bf16 v[160:163], v[236:239], v[200:203], v[160:163]
    ds_read_b64_tr_b16 v[232:233], v70 offset:24960
    v_mfma_f32_16x16x32_bf16 v[164:167], v[236:239], v[204:207], v[164:167]
    ds_read_b64_tr_b16 v[234:235], v70 offset:25472
    v_mfma_f32_16x16x32_bf16 v[168:171], v[240:243], v[200:203], v[168:171]
    ds_read_b64_tr_b16 v[236:237], v70 offset:24992
    v_mfma_f32_16x16x32_bf16 v[172:175], v[240:243], v[204:207], v[172:175]
    ds_read_b64_tr_b16 v[238:239], v70 offset:25504
    s_waitcnt lgkmcnt(8)
    s_waitcnt vmcnt(8)
    v_mfma_f32_16x16x32_bf16 v[128:131], v[244:247], v[208:211], v[128:131]
    ds_read_b64_tr_b16 v[240:241], v71 offset:24960
    v_mfma_f32_16x16x32_bf16 v[132:135], v[244:247], v[212:215], v[132:135]
    ds_read_b64_tr_b16 v[242:243], v71 offset:25472
    buffer_load_dwordx4 v[200:203], v2, s[32:35], s16 offen offset:2048 sc1
    v_mfma_f32_16x16x32_bf16 v[136:139], v[248:251], v[208:211], v[136:139]
    ds_read_b64_tr_b16 v[244:245], v71 offset:24992
    v_mfma_f32_16x16x32_bf16 v[140:143], v[248:251], v[212:215], v[140:143]
    ds_read_b64_tr_b16 v[246:247], v71 offset:25504
    s_waitcnt lgkmcnt(8)
    v_mfma_f32_16x16x32_bf16 v[112:115], v[224:227], v[208:211], v[112:115]
    ds_read_b64_tr_b16 v[248:249], v70 offset:41600
    v_mfma_f32_16x16x32_bf16 v[116:119], v[224:227], v[212:215], v[116:119]
    ds_read_b64_tr_b16 v[250:251], v70 offset:42112
    v_mfma_f32_16x16x32_bf16 v[120:123], v[228:231], v[208:211], v[120:123]
    ds_read_b64_tr_b16 v[224:225], v70 offset:41632
    v_mfma_f32_16x16x32_bf16 v[124:127], v[228:231], v[212:215], v[124:127]
    ds_read_b64_tr_b16 v[226:227], v70 offset:42144
    buffer_load_dwordx4 v[204:207], v2, s[32:35], s16 offen offset:3072 sc1
    s_waitcnt lgkmcnt(8)
    v_mfma_f32_16x16x32_bf16 v[80:83], v[232:235], v[208:211], v[80:83]
    ds_read_b64_tr_b16 v[228:229], v71 offset:41600
    v_mfma_f32_16x16x32_bf16 v[84:87], v[232:235], v[212:215], v[84:87]
    ds_read_b64_tr_b16 v[230:231], v71 offset:42112
    v_mfma_f32_16x16x32_bf16 v[88:91], v[236:239], v[208:211], v[88:91]
    ds_read_b64_tr_b16 v[232:233], v71 offset:41632
    v_mfma_f32_16x16x32_bf16 v[92:95], v[236:239], v[212:215], v[92:95]
    ds_read_b64_tr_b16 v[234:235], v71 offset:42144
    s_waitcnt lgkmcnt(8)
    v_mfma_f32_16x16x32_bf16 v[96:99], v[240:243], v[208:211], v[96:99]
    ds_read_b64_tr_b16 v[236:237], v71 offset:37440
    v_mfma_f32_16x16x32_bf16 v[100:103], v[240:243], v[212:215], v[100:103]
    ds_read_b64_tr_b16 v[238:239], v71 offset:37952
    v_mfma_f32_16x16x32_bf16 v[104:107], v[244:247], v[208:211], v[104:107]
    ds_read_b64_tr_b16 v[240:241], v71 offset:37472
    v_mfma_f32_16x16x32_bf16 v[108:111], v[244:247], v[212:215], v[108:111]
    ds_read_b64_tr_b16 v[242:243], v71 offset:37984
    s_waitcnt lgkmcnt(8)
    v_mfma_f32_16x16x32_bf16 v[144:147], v[248:251], v[208:211], v[144:147]
    ds_read_b64_tr_b16 v[244:245], v70 offset:37440
    v_mfma_f32_16x16x32_bf16 v[148:151], v[248:251], v[212:215], v[148:151]
    ds_read_b64_tr_b16 v[246:247], v70 offset:37952
    v_mfma_f32_16x16x32_bf16 v[152:155], v[224:227], v[208:211], v[152:155]
    ds_read_b64_tr_b16 v[248:249], v70 offset:37472
    v_mfma_f32_16x16x32_bf16 v[156:159], v[224:227], v[212:215], v[156:159]
    ds_read_b64_tr_b16 v[250:251], v70 offset:37984
    s_waitcnt lgkmcnt(8)
    v_mfma_f32_16x16x32_bf16 v[160:163], v[228:231], v[208:211], v[160:163]
    ds_read_b64_tr_b16 v[224:225], v70 offset:29120
    v_mfma_f32_16x16x32_bf16 v[164:167], v[228:231], v[212:215], v[164:167]
    ds_read_b64_tr_b16 v[226:227], v70 offset:29632
    v_mfma_f32_16x16x32_bf16 v[168:171], v[232:235], v[208:211], v[168:171]
    ds_read_b64_tr_b16 v[228:229], v70 offset:29152
    v_mfma_f32_16x16x32_bf16 v[172:175], v[232:235], v[212:215], v[172:175]
    ds_read_b64_tr_b16 v[230:231], v70 offset:29664
    s_waitcnt lgkmcnt(8)
    s_waitcnt vmcnt(8)
    v_mfma_f32_16x16x32_bf16 v[128:131], v[236:239], v[216:219], v[128:131]
    ds_read_b64_tr_b16 v[232:233], v71 offset:29120
    v_mfma_f32_16x16x32_bf16 v[132:135], v[236:239], v[220:223], v[132:135]
    ds_read_b64_tr_b16 v[234:235], v71 offset:29632
    s_add_u32 s96, s85, 14
    s_and_b32 s97, s96, 15
    s_lshl_b32 s98, s97, 14
    s_add_u32 s16, s98, s15
    buffer_load_dwordx4 v[208:211], v2, s[32:35], s16 offen sc1
    v_mfma_f32_16x16x32_bf16 v[136:139], v[240:243], v[216:219], v[136:139]
    ds_read_b64_tr_b16 v[236:237], v71 offset:29152
    v_mfma_f32_16x16x32_bf16 v[140:143], v[240:243], v[220:223], v[140:143]
    ds_read_b64_tr_b16 v[238:239], v71 offset:29664
    s_waitcnt lgkmcnt(8)
    v_mfma_f32_16x16x32_bf16 v[112:115], v[244:247], v[216:219], v[112:115]
    ds_read_b64_tr_b16 v[240:241], v70 offset:45760
    v_mfma_f32_16x16x32_bf16 v[116:119], v[244:247], v[220:223], v[116:119]
    ds_read_b64_tr_b16 v[242:243], v70 offset:46272
    v_mfma_f32_16x16x32_bf16 v[120:123], v[248:251], v[216:219], v[120:123]
    ds_read_b64_tr_b16 v[244:245], v70 offset:45792
    v_mfma_f32_16x16x32_bf16 v[124:127], v[248:251], v[220:223], v[124:127]
    ds_read_b64_tr_b16 v[246:247], v70 offset:46304
    buffer_load_dwordx4 v[212:215], v2, s[32:35], s16 offen offset:1024 sc1
    s_waitcnt lgkmcnt(8)
    v_mfma_f32_16x16x32_bf16 v[80:83], v[224:227], v[216:219], v[80:83]
    ds_read_b64_tr_b16 v[248:249], v71 offset:45760
    v_mfma_f32_16x16x32_bf16 v[84:87], v[224:227], v[220:223], v[84:87]
    ds_read_b64_tr_b16 v[250:251], v71 offset:46272
    v_mfma_f32_16x16x32_bf16 v[88:91], v[228:231], v[216:219], v[88:91]
    ds_read_b64_tr_b16 v[224:225], v71 offset:45792
    v_mfma_f32_16x16x32_bf16 v[92:95], v[228:231], v[220:223], v[92:95]
    ds_read_b64_tr_b16 v[226:227], v71 offset:46304
    s_waitcnt lgkmcnt(8)
    v_mfma_f32_16x16x32_bf16 v[96:99], v[232:235], v[216:219], v[96:99]
    s_barrier
    ds_read_b64_tr_b16 v[228:229], v67 offset:8320
    v_mfma_f32_16x16x32_bf16 v[100:103], v[232:235], v[220:223], v[100:103]
    ds_read_b64_tr_b16 v[230:231], v67 offset:8832
    v_mfma_f32_16x16x32_bf16 v[104:107], v[236:239], v[216:219], v[104:107]
    ds_read_b64_tr_b16 v[232:233], v67 offset:8352
    v_mfma_f32_16x16x32_bf16 v[108:111], v[236:239], v[220:223], v[108:111]
    ds_read_b64_tr_b16 v[234:235], v67 offset:8864
    s_waitcnt lgkmcnt(8)
    v_mfma_f32_16x16x32_bf16 v[144:147], v[240:243], v[216:219], v[144:147]
    ds_read_b64_tr_b16 v[236:237], v66 offset:8320
    v_mfma_f32_16x16x32_bf16 v[148:151], v[240:243], v[220:223], v[148:151]
    ds_read_b64_tr_b16 v[238:239], v66 offset:8832
    v_mfma_f32_16x16x32_bf16 v[152:155], v[244:247], v[216:219], v[152:155]
    ds_read_b64_tr_b16 v[240:241], v66 offset:8352
    v_mfma_f32_16x16x32_bf16 v[156:159], v[244:247], v[220:223], v[156:159]
    ds_read_b64_tr_b16 v[242:243], v66 offset:8864
    s_waitcnt lgkmcnt(8)
    v_mfma_f32_16x16x32_bf16 v[160:163], v[248:251], v[216:219], v[160:163]
    ds_read_b64_tr_b16 v[244:245], v66
    v_mfma_f32_16x16x32_bf16 v[164:167], v[248:251], v[220:223], v[164:167]
    ds_read_b64_tr_b16 v[246:247], v66 offset:512
    v_mfma_f32_16x16x32_bf16 v[168:171], v[224:227], v[216:219], v[168:171]
    ds_read_b64_tr_b16 v[248:249], v66 offset:32
    v_mfma_f32_16x16x32_bf16 v[172:175], v[224:227], v[220:223], v[172:175]
    ds_read_b64_tr_b16 v[250:251], v66 offset:544
    s_waitcnt lgkmcnt(8)
    s_waitcnt vmcnt(8)
    v_mfma_f32_16x16x32_bf16 v[128:131], v[228:231], v[176:179], v[128:131]
    ds_read_b64_tr_b16 v[224:225], v67
    v_mfma_f32_16x16x32_bf16 v[132:135], v[228:231], v[180:183], v[132:135]
    ds_read_b64_tr_b16 v[226:227], v67 offset:512
    buffer_load_dwordx4 v[216:219], v2, s[32:35], s16 offen offset:2048 sc1
    v_mfma_f32_16x16x32_bf16 v[136:139], v[232:235], v[176:179], v[136:139]
    ds_read_b64_tr_b16 v[228:229], v67 offset:32
    v_mfma_f32_16x16x32_bf16 v[140:143], v[232:235], v[180:183], v[140:143]
    ds_read_b64_tr_b16 v[230:231], v67 offset:544
    s_waitcnt lgkmcnt(8)
    v_mfma_f32_16x16x32_bf16 v[112:115], v[236:239], v[176:179], v[112:115]
    ds_read_b64_tr_b16 v[232:233], v66 offset:16640
    v_mfma_f32_16x16x32_bf16 v[116:119], v[236:239], v[180:183], v[116:119]
    ds_read_b64_tr_b16 v[234:235], v66 offset:17152
    v_mfma_f32_16x16x32_bf16 v[120:123], v[240:243], v[176:179], v[120:123]
    ds_read_b64_tr_b16 v[236:237], v66 offset:16672
    v_mfma_f32_16x16x32_bf16 v[124:127], v[240:243], v[180:183], v[124:127]
    ds_read_b64_tr_b16 v[238:239], v66 offset:17184
    buffer_load_dwordx4 v[220:223], v2, s[32:35], s16 offen offset:3072 sc1
    s_waitcnt lgkmcnt(8)
    v_mfma_f32_16x16x32_bf16 v[80:83], v[244:247], v[176:179], v[80:83]
    ds_read_b64_tr_b16 v[240:241], v67 offset:16640
    v_mfma_f32_16x16x32_bf16 v[84:87], v[244:247], v[180:183], v[84:87]
    ds_read_b64_tr_b16 v[242:243], v67 offset:17152
    v_mfma_f32_16x16x32_bf16 v[88:91], v[248:251], v[176:179], v[88:91]
    ds_read_b64_tr_b16 v[244:245], v67 offset:16672
    v_mfma_f32_16x16x32_bf16 v[92:95], v[248:251], v[180:183], v[92:95]
    ds_read_b64_tr_b16 v[246:247], v67 offset:17184
    s_waitcnt lgkmcnt(8)
    v_mfma_f32_16x16x32_bf16 v[96:99], v[224:227], v[176:179], v[96:99]
    ds_read_b64_tr_b16 v[248:249], v67 offset:12480
    v_mfma_f32_16x16x32_bf16 v[100:103], v[224:227], v[180:183], v[100:103]
    ds_read_b64_tr_b16 v[250:251], v67 offset:12992
    v_mfma_f32_16x16x32_bf16 v[104:107], v[228:231], v[176:179], v[104:107]
    ds_read_b64_tr_b16 v[224:225], v67 offset:12512
    v_mfma_f32_16x16x32_bf16 v[108:111], v[228:231], v[180:183], v[108:111]
    ds_read_b64_tr_b16 v[226:227], v67 offset:13024
    s_waitcnt lgkmcnt(8)
    v_mfma_f32_16x16x32_bf16 v[144:147], v[232:235], v[176:179], v[144:147]
    ds_read_b64_tr_b16 v[228:229], v66 offset:12480
    v_mfma_f32_16x16x32_bf16 v[148:151], v[232:235], v[180:183], v[148:151]
    ds_read_b64_tr_b16 v[230:231], v66 offset:12992
    v_mfma_f32_16x16x32_bf16 v[152:155], v[236:239], v[176:179], v[152:155]
    ds_read_b64_tr_b16 v[232:233], v66 offset:12512
    v_mfma_f32_16x16x32_bf16 v[156:159], v[236:239], v[180:183], v[156:159]
    ds_read_b64_tr_b16 v[234:235], v66 offset:13024
    s_waitcnt lgkmcnt(8)
    v_mfma_f32_16x16x32_bf16 v[160:163], v[240:243], v[176:179], v[160:163]
    ds_read_b64_tr_b16 v[236:237], v66 offset:4160
    v_mfma_f32_16x16x32_bf16 v[164:167], v[240:243], v[180:183], v[164:167]
    ds_read_b64_tr_b16 v[238:239], v66 offset:4672
    v_mfma_f32_16x16x32_bf16 v[168:171], v[244:247], v[176:179], v[168:171]
    ds_read_b64_tr_b16 v[240:241], v66 offset:4192
    v_mfma_f32_16x16x32_bf16 v[172:175], v[244:247], v[180:183], v[172:175]
    ds_read_b64_tr_b16 v[242:243], v66 offset:4704
    s_waitcnt lgkmcnt(8)
    s_waitcnt vmcnt(8)
    v_mfma_f32_16x16x32_bf16 v[128:131], v[248:251], v[184:187], v[128:131]
    ds_read_b64_tr_b16 v[244:245], v67 offset:4160
    v_mfma_f32_16x16x32_bf16 v[132:135], v[248:251], v[188:191], v[132:135]
    ds_read_b64_tr_b16 v[246:247], v67 offset:4672
    s_add_u32 s96, s85, 15
    s_and_b32 s97, s96, 15
    s_lshl_b32 s98, s97, 14
    s_add_u32 s16, s98, s15
    buffer_load_dwordx4 v[176:179], v2, s[32:35], s16 offen sc1
    v_mfma_f32_16x16x32_bf16 v[136:139], v[224:227], v[184:187], v[136:139]
    ds_read_b64_tr_b16 v[248:249], v67 offset:4192
    v_mfma_f32_16x16x32_bf16 v[140:143], v[224:227], v[188:191], v[140:143]
    ds_read_b64_tr_b16 v[250:251], v67 offset:4704
    s_waitcnt lgkmcnt(8)
    v_mfma_f32_16x16x32_bf16 v[112:115], v[228:231], v[184:187], v[112:115]
    ds_read_b64_tr_b16 v[224:225], v66 offset:20800
    v_mfma_f32_16x16x32_bf16 v[116:119], v[228:231], v[188:191], v[116:119]
    ds_read_b64_tr_b16 v[226:227], v66 offset:21312
    v_mfma_f32_16x16x32_bf16 v[120:123], v[232:235], v[184:187], v[120:123]
    ds_read_b64_tr_b16 v[228:229], v66 offset:20832
    v_mfma_f32_16x16x32_bf16 v[124:127], v[232:235], v[188:191], v[124:127]
    ds_read_b64_tr_b16 v[230:231], v66 offset:21344
    buffer_load_dwordx4 v[180:183], v2, s[32:35], s16 offen offset:1024 sc1
    s_waitcnt lgkmcnt(8)
    v_mfma_f32_16x16x32_bf16 v[80:83], v[236:239], v[184:187], v[80:83]
    ds_read_b64_tr_b16 v[232:233], v67 offset:20800
    v_mfma_f32_16x16x32_bf16 v[84:87], v[236:239], v[188:191], v[84:87]
    ds_read_b64_tr_b16 v[234:235], v67 offset:21312
    v_mfma_f32_16x16x32_bf16 v[88:91], v[240:243], v[184:187], v[88:91]
    ds_read_b64_tr_b16 v[236:237], v67 offset:20832
    v_mfma_f32_16x16x32_bf16 v[92:95], v[240:243], v[188:191], v[92:95]
    ds_read_b64_tr_b16 v[238:239], v67 offset:21344
    s_waitcnt lgkmcnt(8)
    v_mfma_f32_16x16x32_bf16 v[96:99], v[244:247], v[184:187], v[96:99]
    s_barrier
    ds_read_b64_tr_b16 v[240:241], v67 offset:33280
    v_mfma_f32_16x16x32_bf16 v[100:103], v[244:247], v[188:191], v[100:103]
    ds_read_b64_tr_b16 v[242:243], v67 offset:33792
    v_mfma_f32_16x16x32_bf16 v[104:107], v[248:251], v[184:187], v[104:107]
    ds_read_b64_tr_b16 v[244:245], v67 offset:33312
    v_mfma_f32_16x16x32_bf16 v[108:111], v[248:251], v[188:191], v[108:111]
    ds_read_b64_tr_b16 v[246:247], v67 offset:33824
    s_waitcnt lgkmcnt(8)
    v_mfma_f32_16x16x32_bf16 v[144:147], v[224:227], v[184:187], v[144:147]
    ds_read_b64_tr_b16 v[248:249], v66 offset:33280
    v_mfma_f32_16x16x32_bf16 v[148:151], v[224:227], v[188:191], v[148:151]
    ds_read_b64_tr_b16 v[250:251], v66 offset:33792
    v_mfma_f32_16x16x32_bf16 v[152:155], v[228:231], v[184:187], v[152:155]
    ds_read_b64_tr_b16 v[224:225], v66 offset:33312
    v_mfma_f32_16x16x32_bf16 v[156:159], v[228:231], v[188:191], v[156:159]
    ds_read_b64_tr_b16 v[226:227], v66 offset:33824
    s_waitcnt lgkmcnt(8)
    v_mfma_f32_16x16x32_bf16 v[160:163], v[232:235], v[184:187], v[160:163]
    ds_read_b64_tr_b16 v[228:229], v66 offset:24960
    v_mfma_f32_16x16x32_bf16 v[164:167], v[232:235], v[188:191], v[164:167]
    ds_read_b64_tr_b16 v[230:231], v66 offset:25472
    v_mfma_f32_16x16x32_bf16 v[168:171], v[236:239], v[184:187], v[168:171]
    ds_read_b64_tr_b16 v[232:233], v66 offset:24992
    v_mfma_f32_16x16x32_bf16 v[172:175], v[236:239], v[188:191], v[172:175]
    ds_read_b64_tr_b16 v[234:235], v66 offset:25504
    s_waitcnt lgkmcnt(8)
    s_waitcnt vmcnt(8)
    v_mfma_f32_16x16x32_bf16 v[128:131], v[240:243], v[192:195], v[128:131]
    ds_read_b64_tr_b16 v[236:237], v67 offset:24960
    v_mfma_f32_16x16x32_bf16 v[132:135], v[240:243], v[196:199], v[132:135]
    ds_read_b64_tr_b16 v[238:239], v67 offset:25472
    buffer_load_dwordx4 v[184:187], v2, s[32:35], s16 offen offset:2048 sc1
    v_mfma_f32_16x16x32_bf16 v[136:139], v[244:247], v[192:195], v[136:139]
    ds_read_b64_tr_b16 v[240:241], v67 offset:24992
    v_mfma_f32_16x16x32_bf16 v[140:143], v[244:247], v[196:199], v[140:143]
    ds_read_b64_tr_b16 v[242:243], v67 offset:25504
    s_waitcnt lgkmcnt(8)
    v_mfma_f32_16x16x32_bf16 v[112:115], v[248:251], v[192:195], v[112:115]
    ds_read_b64_tr_b16 v[244:245], v66 offset:41600
    v_mfma_f32_16x16x32_bf16 v[116:119], v[248:251], v[196:199], v[116:119]
    ds_read_b64_tr_b16 v[246:247], v66 offset:42112
    v_mfma_f32_16x16x32_bf16 v[120:123], v[224:227], v[192:195], v[120:123]
    ds_read_b64_tr_b16 v[248:249], v66 offset:41632
    v_mfma_f32_16x16x32_bf16 v[124:127], v[224:227], v[196:199], v[124:127]
    ds_read_b64_tr_b16 v[250:251], v66 offset:42144
    buffer_load_dwordx4 v[188:191], v2, s[32:35], s16 offen offset:3072 sc1
    s_barrier
    s_waitcnt lgkmcnt(8)
    v_mfma_f32_16x16x32_bf16 v[80:83], v[228:231], v[192:195], v[80:83]
    ds_read_b64_tr_b16 v[224:225], v67 offset:41600
    v_mfma_f32_16x16x32_bf16 v[84:87], v[228:231], v[196:199], v[84:87]
    ds_read_b64_tr_b16 v[226:227], v67 offset:42112
    v_mfma_f32_16x16x32_bf16 v[88:91], v[232:235], v[192:195], v[88:91]
    ds_read_b64_tr_b16 v[228:229], v67 offset:41632
    v_mfma_f32_16x16x32_bf16 v[92:95], v[232:235], v[196:199], v[92:95]
    ds_read_b64_tr_b16 v[230:231], v67 offset:42144
    s_waitcnt lgkmcnt(8)
    v_mfma_f32_16x16x32_bf16 v[96:99], v[236:239], v[192:195], v[96:99]
    ds_read_b64_tr_b16 v[232:233], v67 offset:37440
    v_mfma_f32_16x16x32_bf16 v[100:103], v[236:239], v[196:199], v[100:103]
    ds_read_b64_tr_b16 v[234:235], v67 offset:37952
    v_mfma_f32_16x16x32_bf16 v[104:107], v[240:243], v[192:195], v[104:107]
    ds_read_b64_tr_b16 v[236:237], v67 offset:37472
    v_mfma_f32_16x16x32_bf16 v[108:111], v[240:243], v[196:199], v[108:111]
    ds_read_b64_tr_b16 v[238:239], v67 offset:37984
    s_waitcnt lgkmcnt(8)
    v_mfma_f32_16x16x32_bf16 v[144:147], v[244:247], v[192:195], v[144:147]
    ds_read_b64_tr_b16 v[240:241], v66 offset:37440
    v_mfma_f32_16x16x32_bf16 v[148:151], v[244:247], v[196:199], v[148:151]
    ds_read_b64_tr_b16 v[242:243], v66 offset:37952
    v_mfma_f32_16x16x32_bf16 v[152:155], v[248:251], v[192:195], v[152:155]
    ds_read_b64_tr_b16 v[244:245], v66 offset:37472
    v_mfma_f32_16x16x32_bf16 v[156:159], v[248:251], v[196:199], v[156:159]
    ds_read_b64_tr_b16 v[246:247], v66 offset:37984
    s_waitcnt lgkmcnt(8)
    v_mfma_f32_16x16x32_bf16 v[160:163], v[224:227], v[192:195], v[160:163]
    ds_read_b64_tr_b16 v[248:249], v66 offset:29120
    v_mfma_f32_16x16x32_bf16 v[164:167], v[224:227], v[196:199], v[164:167]
    ds_read_b64_tr_b16 v[250:251], v66 offset:29632
    v_mfma_f32_16x16x32_bf16 v[168:171], v[228:231], v[192:195], v[168:171]
    ds_read_b64_tr_b16 v[224:225], v66 offset:29152
    v_mfma_f32_16x16x32_bf16 v[172:175], v[228:231], v[196:199], v[172:175]
    ds_read_b64_tr_b16 v[226:227], v66 offset:29664
    s_waitcnt lgkmcnt(8)
    s_waitcnt vmcnt(8)
    v_mfma_f32_16x16x32_bf16 v[128:131], v[232:235], v[200:203], v[128:131]
    ds_read_b64_tr_b16 v[228:229], v67 offset:29120
    v_mfma_f32_16x16x32_bf16 v[132:135], v[232:235], v[204:207], v[132:135]
    ds_read_b64_tr_b16 v[230:231], v67 offset:29632
    v_mfma_f32_16x16x32_bf16 v[136:139], v[236:239], v[200:203], v[136:139]
    ds_read_b64_tr_b16 v[232:233], v67 offset:29152
    v_mfma_f32_16x16x32_bf16 v[140:143], v[236:239], v[204:207], v[140:143]
    ds_read_b64_tr_b16 v[234:235], v67 offset:29664
    s_waitcnt lgkmcnt(8)
    v_mfma_f32_16x16x32_bf16 v[112:115], v[240:243], v[200:203], v[112:115]
    ds_read_b64_tr_b16 v[236:237], v66 offset:45760
    v_mfma_f32_16x16x32_bf16 v[116:119], v[240:243], v[204:207], v[116:119]
    ds_read_b64_tr_b16 v[238:239], v66 offset:46272
    v_mfma_f32_16x16x32_bf16 v[120:123], v[244:247], v[200:203], v[120:123]
    ds_read_b64_tr_b16 v[240:241], v66 offset:45792
    v_mfma_f32_16x16x32_bf16 v[124:127], v[244:247], v[204:207], v[124:127]
    ds_read_b64_tr_b16 v[242:243], v66 offset:46304
    s_waitcnt lgkmcnt(8)
    v_mfma_f32_16x16x32_bf16 v[80:83], v[248:251], v[200:203], v[80:83]
    ds_read_b64_tr_b16 v[244:245], v67 offset:45760
    v_mfma_f32_16x16x32_bf16 v[84:87], v[248:251], v[204:207], v[84:87]
    ds_read_b64_tr_b16 v[246:247], v67 offset:46272
    v_mfma_f32_16x16x32_bf16 v[88:91], v[224:227], v[200:203], v[88:91]
    ds_read_b64_tr_b16 v[248:249], v67 offset:45792
    v_mfma_f32_16x16x32_bf16 v[92:95], v[224:227], v[204:207], v[92:95]
    ds_read_b64_tr_b16 v[250:251], v67 offset:46304
    s_waitcnt lgkmcnt(8)
    v_mfma_f32_16x16x32_bf16 v[96:99], v[228:231], v[200:203], v[96:99]
    ds_read_b64_tr_b16 v[224:225], v69 offset:8320
    v_mfma_f32_16x16x32_bf16 v[100:103], v[228:231], v[204:207], v[100:103]
    ds_read_b64_tr_b16 v[226:227], v69 offset:8832
    v_mfma_f32_16x16x32_bf16 v[104:107], v[232:235], v[200:203], v[104:107]
    ds_read_b64_tr_b16 v[228:229], v69 offset:8352
    v_mfma_f32_16x16x32_bf16 v[108:111], v[232:235], v[204:207], v[108:111]
    ds_read_b64_tr_b16 v[230:231], v69 offset:8864
    s_waitcnt lgkmcnt(8)
    v_mfma_f32_16x16x32_bf16 v[144:147], v[236:239], v[200:203], v[144:147]
    ds_read_b64_tr_b16 v[232:233], v68 offset:8320
    v_mfma_f32_16x16x32_bf16 v[148:151], v[236:239], v[204:207], v[148:151]
    ds_read_b64_tr_b16 v[234:235], v68 offset:8832
    v_mfma_f32_16x16x32_bf16 v[152:155], v[240:243], v[200:203], v[152:155]
    ds_read_b64_tr_b16 v[236:237], v68 offset:8352
    v_mfma_f32_16x16x32_bf16 v[156:159], v[240:243], v[204:207], v[156:159]
    ds_read_b64_tr_b16 v[238:239], v68 offset:8864
    s_waitcnt lgkmcnt(8)
    v_mfma_f32_16x16x32_bf16 v[160:163], v[244:247], v[200:203], v[160:163]
    ds_read_b64_tr_b16 v[240:241], v68
    v_mfma_f32_16x16x32_bf16 v[164:167], v[244:247], v[204:207], v[164:167]
    ds_read_b64_tr_b16 v[242:243], v68 offset:512
    v_mfma_f32_16x16x32_bf16 v[168:171], v[248:251], v[200:203], v[168:171]
    ds_read_b64_tr_b16 v[244:245], v68 offset:32
    v_mfma_f32_16x16x32_bf16 v[172:175], v[248:251], v[204:207], v[172:175]
    ds_read_b64_tr_b16 v[246:247], v68 offset:544
    s_waitcnt lgkmcnt(8)
    s_waitcnt vmcnt(6)
    v_mfma_f32_16x16x32_bf16 v[128:131], v[224:227], v[208:211], v[128:131]
    ds_read_b64_tr_b16 v[248:249], v69
    v_mfma_f32_16x16x32_bf16 v[132:135], v[224:227], v[212:215], v[132:135]
    ds_read_b64_tr_b16 v[250:251], v69 offset:512
    v_mfma_f32_16x16x32_bf16 v[136:139], v[228:231], v[208:211], v[136:139]
    ds_read_b64_tr_b16 v[224:225], v69 offset:32
    v_mfma_f32_16x16x32_bf16 v[140:143], v[228:231], v[212:215], v[140:143]
    ds_read_b64_tr_b16 v[226:227], v69 offset:544
    s_waitcnt lgkmcnt(8)
    v_mfma_f32_16x16x32_bf16 v[112:115], v[232:235], v[208:211], v[112:115]
    ds_read_b64_tr_b16 v[228:229], v68 offset:16640
    v_mfma_f32_16x16x32_bf16 v[116:119], v[232:235], v[212:215], v[116:119]
    ds_read_b64_tr_b16 v[230:231], v68 offset:17152
    v_mfma_f32_16x16x32_bf16 v[120:123], v[236:239], v[208:211], v[120:123]
    ds_read_b64_tr_b16 v[232:233], v68 offset:16672
    v_mfma_f32_16x16x32_bf16 v[124:127], v[236:239], v[212:215], v[124:127]
    ds_read_b64_tr_b16 v[234:235], v68 offset:17184
    s_waitcnt lgkmcnt(8)
    v_mfma_f32_16x16x32_bf16 v[80:83], v[240:243], v[208:211], v[80:83]
    ds_read_b64_tr_b16 v[236:237], v69 offset:16640
    v_mfma_f32_16x16x32_bf16 v[84:87], v[240:243], v[212:215], v[84:87]
    ds_read_b64_tr_b16 v[238:239], v69 offset:17152
    v_mfma_f32_16x16x32_bf16 v[88:91], v[244:247], v[208:211], v[88:91]
    ds_read_b64_tr_b16 v[240:241], v69 offset:16672
    v_mfma_f32_16x16x32_bf16 v[92:95], v[244:247], v[212:215], v[92:95]
    ds_read_b64_tr_b16 v[242:243], v69 offset:17184
    s_waitcnt lgkmcnt(8)
    v_mfma_f32_16x16x32_bf16 v[96:99], v[248:251], v[208:211], v[96:99]
    ds_read_b64_tr_b16 v[244:245], v69 offset:12480
    v_mfma_f32_16x16x32_bf16 v[100:103], v[248:251], v[212:215], v[100:103]
    ds_read_b64_tr_b16 v[246:247], v69 offset:12992
    v_mfma_f32_16x16x32_bf16 v[104:107], v[224:227], v[208:211], v[104:107]
    ds_read_b64_tr_b16 v[248:249], v69 offset:12512
    v_mfma_f32_16x16x32_bf16 v[108:111], v[224:227], v[212:215], v[108:111]
    ds_read_b64_tr_b16 v[250:251], v69 offset:13024
    s_waitcnt lgkmcnt(8)
    v_mfma_f32_16x16x32_bf16 v[144:147], v[228:231], v[208:211], v[144:147]
    ds_read_b64_tr_b16 v[224:225], v68 offset:12480
    v_mfma_f32_16x16x32_bf16 v[148:151], v[228:231], v[212:215], v[148:151]
    ds_read_b64_tr_b16 v[226:227], v68 offset:12992
    v_mfma_f32_16x16x32_bf16 v[152:155], v[232:235], v[208:211], v[152:155]
    ds_read_b64_tr_b16 v[228:229], v68 offset:12512
    v_mfma_f32_16x16x32_bf16 v[156:159], v[232:235], v[212:215], v[156:159]
    ds_read_b64_tr_b16 v[230:231], v68 offset:13024
    s_waitcnt lgkmcnt(8)
    v_mfma_f32_16x16x32_bf16 v[160:163], v[236:239], v[208:211], v[160:163]
    ds_read_b64_tr_b16 v[232:233], v68 offset:4160
    v_mfma_f32_16x16x32_bf16 v[164:167], v[236:239], v[212:215], v[164:167]
    ds_read_b64_tr_b16 v[234:235], v68 offset:4672
    v_mfma_f32_16x16x32_bf16 v[168:171], v[240:243], v[208:211], v[168:171]
    ds_read_b64_tr_b16 v[236:237], v68 offset:4192
    v_mfma_f32_16x16x32_bf16 v[172:175], v[240:243], v[212:215], v[172:175]
    ds_read_b64_tr_b16 v[238:239], v68 offset:4704
    s_waitcnt lgkmcnt(8)
    s_waitcnt vmcnt(4)
    v_mfma_f32_16x16x32_bf16 v[128:131], v[244:247], v[216:219], v[128:131]
    ds_read_b64_tr_b16 v[240:241], v69 offset:4160
    v_mfma_f32_16x16x32_bf16 v[132:135], v[244:247], v[220:223], v[132:135]
    ds_read_b64_tr_b16 v[242:243], v69 offset:4672
    v_mfma_f32_16x16x32_bf16 v[136:139], v[248:251], v[216:219], v[136:139]
    ds_read_b64_tr_b16 v[244:245], v69 offset:4192
    v_mfma_f32_16x16x32_bf16 v[140:143], v[248:251], v[220:223], v[140:143]
    ds_read_b64_tr_b16 v[246:247], v69 offset:4704
    s_waitcnt lgkmcnt(8)
    v_mfma_f32_16x16x32_bf16 v[112:115], v[224:227], v[216:219], v[112:115]
    ds_read_b64_tr_b16 v[248:249], v68 offset:20800
    v_mfma_f32_16x16x32_bf16 v[116:119], v[224:227], v[220:223], v[116:119]
    ds_read_b64_tr_b16 v[250:251], v68 offset:21312
    v_mfma_f32_16x16x32_bf16 v[120:123], v[228:231], v[216:219], v[120:123]
    ds_read_b64_tr_b16 v[224:225], v68 offset:20832
    v_mfma_f32_16x16x32_bf16 v[124:127], v[228:231], v[220:223], v[124:127]
    ds_read_b64_tr_b16 v[226:227], v68 offset:21344
    s_waitcnt lgkmcnt(8)
    v_mfma_f32_16x16x32_bf16 v[80:83], v[232:235], v[216:219], v[80:83]
    ds_read_b64_tr_b16 v[228:229], v69 offset:20800
    v_mfma_f32_16x16x32_bf16 v[84:87], v[232:235], v[220:223], v[84:87]
    ds_read_b64_tr_b16 v[230:231], v69 offset:21312
    v_mfma_f32_16x16x32_bf16 v[88:91], v[236:239], v[216:219], v[88:91]
    ds_read_b64_tr_b16 v[232:233], v69 offset:20832
    v_mfma_f32_16x16x32_bf16 v[92:95], v[236:239], v[220:223], v[92:95]
    ds_read_b64_tr_b16 v[234:235], v69 offset:21344
    s_waitcnt lgkmcnt(8)
    v_mfma_f32_16x16x32_bf16 v[96:99], v[240:243], v[216:219], v[96:99]
    ds_read_b64_tr_b16 v[236:237], v69 offset:33280
    v_mfma_f32_16x16x32_bf16 v[100:103], v[240:243], v[220:223], v[100:103]
    ds_read_b64_tr_b16 v[238:239], v69 offset:33792
    v_mfma_f32_16x16x32_bf16 v[104:107], v[244:247], v[216:219], v[104:107]
    ds_read_b64_tr_b16 v[240:241], v69 offset:33312
    v_mfma_f32_16x16x32_bf16 v[108:111], v[244:247], v[220:223], v[108:111]
    ds_read_b64_tr_b16 v[242:243], v69 offset:33824
    s_waitcnt lgkmcnt(8)
    v_mfma_f32_16x16x32_bf16 v[144:147], v[248:251], v[216:219], v[144:147]
    ds_read_b64_tr_b16 v[244:245], v68 offset:33280
    v_mfma_f32_16x16x32_bf16 v[148:151], v[248:251], v[220:223], v[148:151]
    ds_read_b64_tr_b16 v[246:247], v68 offset:33792
    v_mfma_f32_16x16x32_bf16 v[152:155], v[224:227], v[216:219], v[152:155]
    ds_read_b64_tr_b16 v[248:249], v68 offset:33312
    v_mfma_f32_16x16x32_bf16 v[156:159], v[224:227], v[220:223], v[156:159]
    ds_read_b64_tr_b16 v[250:251], v68 offset:33824
    s_waitcnt lgkmcnt(8)
    v_mfma_f32_16x16x32_bf16 v[160:163], v[228:231], v[216:219], v[160:163]
    ds_read_b64_tr_b16 v[224:225], v68 offset:24960
    v_mfma_f32_16x16x32_bf16 v[164:167], v[228:231], v[220:223], v[164:167]
    ds_read_b64_tr_b16 v[226:227], v68 offset:25472
    v_mfma_f32_16x16x32_bf16 v[168:171], v[232:235], v[216:219], v[168:171]
    ds_read_b64_tr_b16 v[228:229], v68 offset:24992
    v_mfma_f32_16x16x32_bf16 v[172:175], v[232:235], v[220:223], v[172:175]
    ds_read_b64_tr_b16 v[230:231], v68 offset:25504
    s_waitcnt lgkmcnt(8)
    s_waitcnt vmcnt(2)
    v_mfma_f32_16x16x32_bf16 v[128:131], v[236:239], v[176:179], v[128:131]
    ds_read_b64_tr_b16 v[232:233], v69 offset:24960
    v_mfma_f32_16x16x32_bf16 v[132:135], v[236:239], v[180:183], v[132:135]
    ds_read_b64_tr_b16 v[234:235], v69 offset:25472
    v_mfma_f32_16x16x32_bf16 v[136:139], v[240:243], v[176:179], v[136:139]
    ds_read_b64_tr_b16 v[236:237], v69 offset:24992
    v_mfma_f32_16x16x32_bf16 v[140:143], v[240:243], v[180:183], v[140:143]
    ds_read_b64_tr_b16 v[238:239], v69 offset:25504
    s_waitcnt lgkmcnt(8)
    v_mfma_f32_16x16x32_bf16 v[112:115], v[244:247], v[176:179], v[112:115]
    ds_read_b64_tr_b16 v[240:241], v68 offset:41600
    v_mfma_f32_16x16x32_bf16 v[116:119], v[244:247], v[180:183], v[116:119]
    ds_read_b64_tr_b16 v[242:243], v68 offset:42112
    v_mfma_f32_16x16x32_bf16 v[120:123], v[248:251], v[176:179], v[120:123]
    ds_read_b64_tr_b16 v[244:245], v68 offset:41632
    v_mfma_f32_16x16x32_bf16 v[124:127], v[248:251], v[180:183], v[124:127]
    ds_read_b64_tr_b16 v[246:247], v68 offset:42144
    s_waitcnt lgkmcnt(8)
    v_mfma_f32_16x16x32_bf16 v[80:83], v[224:227], v[176:179], v[80:83]
    ds_read_b64_tr_b16 v[248:249], v69 offset:41600
    v_mfma_f32_16x16x32_bf16 v[84:87], v[224:227], v[180:183], v[84:87]
    ds_read_b64_tr_b16 v[250:251], v69 offset:42112
    v_mfma_f32_16x16x32_bf16 v[88:91], v[228:231], v[176:179], v[88:91]
    ds_read_b64_tr_b16 v[224:225], v69 offset:41632
    v_mfma_f32_16x16x32_bf16 v[92:95], v[228:231], v[180:183], v[92:95]
    ds_read_b64_tr_b16 v[226:227], v69 offset:42144
    s_waitcnt lgkmcnt(8)
    v_mfma_f32_16x16x32_bf16 v[96:99], v[232:235], v[176:179], v[96:99]
    ds_read_b64_tr_b16 v[228:229], v69 offset:37440
    v_mfma_f32_16x16x32_bf16 v[100:103], v[232:235], v[180:183], v[100:103]
    ds_read_b64_tr_b16 v[230:231], v69 offset:37952
    v_mfma_f32_16x16x32_bf16 v[104:107], v[236:239], v[176:179], v[104:107]
    ds_read_b64_tr_b16 v[232:233], v69 offset:37472
    v_mfma_f32_16x16x32_bf16 v[108:111], v[236:239], v[180:183], v[108:111]
    ds_read_b64_tr_b16 v[234:235], v69 offset:37984
    s_waitcnt lgkmcnt(8)
    v_mfma_f32_16x16x32_bf16 v[144:147], v[240:243], v[176:179], v[144:147]
    ds_read_b64_tr_b16 v[236:237], v68 offset:37440
    v_mfma_f32_16x16x32_bf16 v[148:151], v[240:243], v[180:183], v[148:151]
    ds_read_b64_tr_b16 v[238:239], v68 offset:37952
    v_mfma_f32_16x16x32_bf16 v[152:155], v[244:247], v[176:179], v[152:155]
    ds_read_b64_tr_b16 v[240:241], v68 offset:37472
    v_mfma_f32_16x16x32_bf16 v[156:159], v[244:247], v[180:183], v[156:159]
    ds_read_b64_tr_b16 v[242:243], v68 offset:37984
    s_waitcnt lgkmcnt(8)
    v_mfma_f32_16x16x32_bf16 v[160:163], v[248:251], v[176:179], v[160:163]
    ds_read_b64_tr_b16 v[244:245], v68 offset:29120
    v_mfma_f32_16x16x32_bf16 v[164:167], v[248:251], v[180:183], v[164:167]
    ds_read_b64_tr_b16 v[246:247], v68 offset:29632
    v_mfma_f32_16x16x32_bf16 v[168:171], v[224:227], v[176:179], v[168:171]
    ds_read_b64_tr_b16 v[248:249], v68 offset:29152
    v_mfma_f32_16x16x32_bf16 v[172:175], v[224:227], v[180:183], v[172:175]
    ds_read_b64_tr_b16 v[250:251], v68 offset:29664
    s_waitcnt lgkmcnt(8)
    s_waitcnt vmcnt(0)
    v_mfma_f32_16x16x32_bf16 v[128:131], v[228:231], v[184:187], v[128:131]
    ds_read_b64_tr_b16 v[224:225], v69 offset:29120
    v_mfma_f32_16x16x32_bf16 v[132:135], v[228:231], v[188:191], v[132:135]
    ds_read_b64_tr_b16 v[226:227], v69 offset:29632
    v_mfma_f32_16x16x32_bf16 v[136:139], v[232:235], v[184:187], v[136:139]
    ds_read_b64_tr_b16 v[228:229], v69 offset:29152
    v_mfma_f32_16x16x32_bf16 v[140:143], v[232:235], v[188:191], v[140:143]
    ds_read_b64_tr_b16 v[230:231], v69 offset:29664
    s_waitcnt lgkmcnt(8)
    v_mfma_f32_16x16x32_bf16 v[112:115], v[236:239], v[184:187], v[112:115]
    ds_read_b64_tr_b16 v[232:233], v68 offset:45760
    v_mfma_f32_16x16x32_bf16 v[116:119], v[236:239], v[188:191], v[116:119]
    ds_read_b64_tr_b16 v[234:235], v68 offset:46272
    v_mfma_f32_16x16x32_bf16 v[120:123], v[240:243], v[184:187], v[120:123]
    ds_read_b64_tr_b16 v[236:237], v68 offset:45792
    v_mfma_f32_16x16x32_bf16 v[124:127], v[240:243], v[188:191], v[124:127]
    ds_read_b64_tr_b16 v[238:239], v68 offset:46304
    s_waitcnt lgkmcnt(8)
    v_mfma_f32_16x16x32_bf16 v[80:83], v[244:247], v[184:187], v[80:83]
    ds_read_b64_tr_b16 v[240:241], v69 offset:45760
    v_mfma_f32_16x16x32_bf16 v[84:87], v[244:247], v[188:191], v[84:87]
    ds_read_b64_tr_b16 v[242:243], v69 offset:46272
    v_mfma_f32_16x16x32_bf16 v[88:91], v[248:251], v[184:187], v[88:91]
    ds_read_b64_tr_b16 v[244:245], v69 offset:45792
    v_mfma_f32_16x16x32_bf16 v[92:95], v[248:251], v[188:191], v[92:95]
    ds_read_b64_tr_b16 v[246:247], v69 offset:46304
    s_waitcnt lgkmcnt(8)
    v_mfma_f32_16x16x32_bf16 v[96:99], v[224:227], v[184:187], v[96:99]
    v_mfma_f32_16x16x32_bf16 v[100:103], v[224:227], v[188:191], v[100:103]
    v_mfma_f32_16x16x32_bf16 v[104:107], v[228:231], v[184:187], v[104:107]
    v_mfma_f32_16x16x32_bf16 v[108:111], v[228:231], v[188:191], v[108:111]
    s_waitcnt lgkmcnt(4)
    v_mfma_f32_16x16x32_bf16 v[144:147], v[232:235], v[184:187], v[144:147]
    v_mfma_f32_16x16x32_bf16 v[148:151], v[232:235], v[188:191], v[148:151]
    v_mfma_f32_16x16x32_bf16 v[152:155], v[236:239], v[184:187], v[152:155]
    v_mfma_f32_16x16x32_bf16 v[156:159], v[236:239], v[188:191], v[156:159]
    s_waitcnt lgkmcnt(0)
    v_mfma_f32_16x16x32_bf16 v[160:163], v[240:243], v[184:187], v[160:163]
    v_mfma_f32_16x16x32_bf16 v[164:167], v[240:243], v[188:191], v[164:167]
    v_mfma_f32_16x16x32_bf16 v[168:171], v[244:247], v[184:187], v[168:171]
    v_mfma_f32_16x16x32_bf16 v[172:175], v[244:247], v[188:191], v[172:175]
    v_cvt_pk_bf16_f32 v52, v128, v129
    v_cvt_pk_bf16_f32 v53, v130, v131
    v_cvt_pk_bf16_f32 v54, v132, v133
    v_cvt_pk_bf16_f32 v55, v134, v135
    v_cvt_pk_bf16_f32 v56, v136, v137
    v_cvt_pk_bf16_f32 v57, v138, v139
    v_cvt_pk_bf16_f32 v58, v140, v141
    v_cvt_pk_bf16_f32 v59, v142, v143
    ds_write_b64 v77, v[52:53]
    ds_write_b64 v77, v[54:55] offset:256
    ds_write_b64 v77, v[56:57] offset:1024
    ds_write_b64 v77, v[58:59] offset:1280
    v_cvt_pk_bf16_f32 v36, v112, v113
    v_cvt_pk_bf16_f32 v37, v114, v115
    v_cvt_pk_bf16_f32 v38, v116, v117
    v_cvt_pk_bf16_f32 v39, v118, v119
    v_cvt_pk_bf16_f32 v40, v120, v121
    v_cvt_pk_bf16_f32 v41, v122, v123
    v_cvt_pk_bf16_f32 v42, v124, v125
    v_cvt_pk_bf16_f32 v43, v126, v127
    v_permlane16_swap_b32 v36, v38
    v_permlane16_swap_b32 v37, v39
    v_permlane16_swap_b32 v40, v42
    v_permlane16_swap_b32 v41, v43
    s_waitcnt lgkmcnt(0)
    s_barrier
    s_setprio 0
    v_mfma_f32_32x32x16_bf16 v[112:127], v[28:31], v[36:39], 0
    v_mfma_f32_32x32x16_bf16 v[112:127], v[32:35], v[40:43], v[112:127]
    v_cvt_pk_bf16_f32 v52, v144, v145
    v_cvt_pk_bf16_f32 v53, v146, v147
    v_cvt_pk_bf16_f32 v54, v148, v149
    v_cvt_pk_bf16_f32 v55, v150, v151
    v_cvt_pk_bf16_f32 v56, v152, v153
    v_cvt_pk_bf16_f32 v57, v154, v155
    v_cvt_pk_bf16_f32 v58, v156, v157
    v_cvt_pk_bf16_f32 v59, v158, v159
    ds_write_b64 v78, v[52:53]
    ds_write_b64 v78, v[54:55] offset:512
    ds_write_b64 v78, v[56:57] offset:4096
    ds_write_b64 v78, v[58:59] offset:4608
    v_cvt_pk_bf16_f32 v44, v160, v161
    v_cvt_pk_bf16_f32 v45, v162, v163
    v_cvt_pk_bf16_f32 v46, v164, v165
    v_cvt_pk_bf16_f32 v47, v166, v167
    v_cvt_pk_bf16_f32 v48, v168, v169
    v_cvt_pk_bf16_f32 v49, v170, v171
    v_cvt_pk_bf16_f32 v50, v172, v173
    v_cvt_pk_bf16_f32 v51, v174, v175
    ds_write_b64 v78, v[44:45] offset:8192
    ds_write_b64 v78, v[46:47] offset:8704
    ds_write_b64 v78, v[48:49] offset:12288
    ds_write_b64 v78, v[50:51] offset:12800
    v_cvt_pk_bf16_f32 v36, v96, v97
    v_cvt_pk_bf16_f32 v37, v98, v99
    v_cvt_pk_bf16_f32 v38, v100, v101
    v_cvt_pk_bf16_f32 v39, v102, v103
    v_cvt_pk_bf16_f32 v40, v104, v105
    v_cvt_pk_bf16_f32 v41, v106, v107
    v_cvt_pk_bf16_f32 v42, v108, v109
    v_cvt_pk_bf16_f32 v43, v110, v111
    ds_write_b64 v77, v[36:37] offset:2048
    ds_write_b64 v77, v[38:39] offset:2304
    ds_write_b64 v77, v[40:41] offset:3072
    ds_write_b64 v77, v[42:43] offset:3328
    v_cvt_pk_bf16_f32 v44, v80, v81
    v_cvt_pk_bf16_f32 v45, v82, v83
    v_cvt_pk_bf16_f32 v46, v84, v85
    v_cvt_pk_bf16_f32 v47, v86, v87
    v_cvt_pk_bf16_f32 v48, v88, v89
    v_cvt_pk_bf16_f32 v49, v90, v91
    v_cvt_pk_bf16_f32 v50, v92, v93
    v_cvt_pk_bf16_f32 v51, v94, v95
    v_permlane16_swap_b32 v44, v46
    v_permlane16_swap_b32 v45, v47
    v_permlane16_swap_b32 v48, v50
    v_permlane16_swap_b32 v49, v51
    s_branch L_JOIN
L_HELP:
    s_add_u32 s96, s85, 5
    s_and_b32 s97, s96, 15
    s_lshl3_add_u32 s98, s97, s3
    s_sub_u32 s99, s98, 4
    s_mul_i32 s96, s99, 49152
    s_lshl_b32 s97, s11, 7
    s_add_u32 s82, s96, s97
    s_sub_u32 s96, s3, 4
    s_lshr_b32 s97, s96, 1
    s_mul_i32 s98, s97, 2080
    s_sub_u32 s99, s3, 4
    s_and_b32 s96, s99, 1
    s_mul_i32 s97, s96, 1056
    s_add_u32 s99, s98, s97
    s_add_u32 s20, s99, 124800
    s_mov_b32 m0, s20
    s_nop 0
    buffer_load_dwordx4 v62, s[40:43], s82 offen lds
    s_add_u32 s82, s82, 2048
    s_add_u32 m0, s20, 8320
    s_nop 0
    buffer_load_dwordx4 v62, s[40:43], s82 offen lds
    s_add_u32 s82, s82, 2048
    s_add_u32 m0, s20, 16640
    s_nop 0
    buffer_load_dwordx4 v62, s[40:43], s82 offen lds
    s_add_u32 s96, s85, 5
    s_and_b32 s97, s96, 15
    s_lshl3_add_u32 s98, s97, s3
    s_mul_i32 s99, s98, 49152
    s_lshl_b32 s96, s11, 7
    s_add_u32 s82, s99, s96
    s_lshr_b32 s96, s3, 1
    s_mul_i32 s97, s96, 2080
    s_and_b32 s98, s3, 1
    s_mul_i32 s99, s98, 1056
    s_add_u32 s96, s97, s99
    s_add_u32 s20, s96, 124800
    s_mov_b32 m0, s20
    s_nop 0
    buffer_load_dwordx4 v62, s[40:43], s82 offen lds
    s_add_u32 s82, s82, 2048
    s_add_u32 m0, s20, 8320
    s_nop 0
    buffer_load_dwordx4 v62, s[40:43], s82 offen lds
    s_add_u32 s82, s82, 2048
    s_add_u32 m0, s20, 16640
    s_nop 0
    buffer_load_dwordx4 v62, s[40:43], s82 offen lds
    s_and_b32 s96, s9, 3
    s_lshl2_add_u32 s97, s96, s3
    s_sub_u32 s98, s97, 4
    s_lshl_b32 s13, s98, 7
    v_lshrrev_b32 v61, 3, v1
    v_lshl_add_u32 v61, v61, 4, s13
    v_lshrrev_b32 v60, 3, v1
    v_mul_u32_u24 v60, 98304, v60
    v_and_b32 v9, 7, v1
    v_lshl_add_u32 v60, v9, 4, v60
    s_mul_i32 s96, s13, 6144
    s_bfe_u32 s97, s9, 131074
    s_lshl_b32 s98, s8, 1
    s_lshl4_add_u32 s99, s97, s98
    s_lshr_b32 s97, s9, 4
    s_add_u32 s98, s99, s97
    s_lshl_b32 s99, s98, 7
    s_add_u32 s97, s96, s99
    s_add_u32 s17, s97, 4096
    global_load_dwordx4 v[120:123], v61, s[86:87]
    s_waitcnt vmcnt(13)
    s_barrier
    buffer_load_dwordx4 v[80:83], v60, s[48:51], s17 offen nt
    s_add_u32 s17, s17, 12288
    buffer_load_dwordx4 v[84:87], v60, s[48:51], s17 offen nt
    s_add_u32 s17, s17, 12288
    s_waitcnt lgkmcnt(0)
    s_load_dword s24, s[32:33], s92 offset:512 glc
    s_load_dword s25, s[32:33], s92 offset:256 glc
    s_load_dword s26, s[32:33], s92 offset:1024 glc
    s_load_dword s27, s[32:33], s92 offset:768 glc
    s_waitcnt vmcnt(12)
    s_barrier
    s_add_u32 s96, s85, 6
    s_and_b32 s97, s96, 15
    s_lshl3_add_u32 s98, s97, s3
    s_sub_u32 s99, s98, 4
    s_mul_i32 s96, s99, 49152
    s_lshl_b32 s97, s11, 7
    s_add_u32 s82, s96, s97
    s_sub_u32 s96, s3, 4
    s_lshr_b32 s97, s96, 1
    s_mul_i32 s98, s97, 2080
    s_sub_u32 s99, s3, 4
    s_and_b32 s96, s99, 1
    s_mul_i32 s97, s96, 1056
    s_add_u32 s20, s98, s97
    s_mov_b32 m0, s20
    s_nop 0
    buffer_load_dwordx4 v62, s[40:43], s82 offen lds
    s_add_u32 s82, s82, 2048
    s_add_u32 m0, s20, 8320
    s_nop 0
    buffer_load_dwordx4 v62, s[40:43], s82 offen lds
    s_add_u32 s82, s82, 2048
    s_add_u32 m0, s20, 16640
    s_nop 0
    buffer_load_dwordx4 v62, s[40:43], s82 offen lds
    s_add_u32 s96, s85, 6
    s_and_b32 s97, s96, 15
    s_lshl3_add_u32 s98, s97, s3
    s_mul_i32 s99, s98, 49152
    s_lshl_b32 s96, s11, 7
    s_add_u32 s82, s99, s96
    s_lshr_b32 s96, s3, 1
    s_mul_i32 s97, s96, 2080
    s_and_b32 s98, s3, 1
    s_mul_i32 s99, s98, 1056
    s_add_u32 s20, s97, s99
    s_mov_b32 m0, s20
    s_nop 0
    buffer_load_dwordx4 v62, s[40:43], s82 offen lds
    s_add_u32 s82, s82, 2048
    s_add_u32 m0, s20, 8320
    s_nop 0
    buffer_load_dwordx4 v62, s[40:43], s82 offen lds
    s_add_u32 s82, s82, 2048
    s_add_u32 m0, s20, 16640
    s_nop 0
    buffer_load_dwordx4 v62, s[40:43], s82 offen lds
    s_waitcnt vmcnt(8)
    v_lshlrev_b32 v112, 16, v120
    v_mul_f32 v4, s7, v112
    v_exp_f32 v4, -v4
    s_nop 0
    v_add_f32 v4, 1.0, v4
    v_rcp_f32 v4, v4
    s_nop 0
    v_mul_f32 v112, v112, v4
    v_cvt_pk_bf16_f32 v112, 0, v112
    v_and_b32 v113, s6, v120
    v_mul_f32 v5, s7, v113
    v_exp_f32 v5, -v5
    s_nop 0
    v_add_f32 v5, 1.0, v5
    v_rcp_f32 v5, v5
    s_nop 0
    v_mul_f32 v113, v113, v5
    v_cvt_pk_bf16_f32 v113, 0, v113
    v_lshlrev_b32 v114, 16, v121
    v_mul_f32 v4, s7, v114
    v_exp_f32 v4, -v4
    s_nop 0
    v_add_f32 v4, 1.0, v4
    v_rcp_f32 v4, v4
    s_nop 0
    v_mul_f32 v114, v114, v4
    v_cvt_pk_bf16_f32 v114, 0, v114
    v_and_b32 v115, s6, v121
    v_mul_f32 v5, s7, v115
    v_exp_f32 v5, -v5
    s_nop 0
    v_add_f32 v5, 1.0, v5
    v_rcp_f32 v5, v5
    s_nop 0
    v_mul_f32 v115, v115, v5
    v_cvt_pk_bf16_f32 v115, 0, v115
    s_barrier
    s_add_u32 s96, s85, 7
    s_and_b32 s97, s96, 15
    s_lshl3_add_u32 s98, s97, s3
    s_sub_u32 s99, s98, 4
    s_mul_i32 s96, s99, 49152
    s_lshl_b32 s97, s11, 7
    s_add_u32 s82, s96, s97
    s_sub_u32 s96, s3, 4
    s_lshr_b32 s97, s96, 1
    s_mul_i32 s98, s97, 2080
    s_sub_u32 s99, s3, 4
    s_and_b32 s96, s99, 1
    s_mul_i32 s97, s96, 1056
    s_add_u32 s99, s98, s97
    s_add_u32 s20, s99, 24960
    s_mov_b32 m0, s20
    s_nop 0
    buffer_load_dwordx4 v62, s[40:43], s82 offen lds
    s_add_u32 s82, s82, 2048
    s_add_u32 m0, s20, 8320
    s_nop 0
    buffer_load_dwordx4 v62, s[40:43], s82 offen lds
    s_add_u32 s82, s82, 2048
    s_add_u32 m0, s20, 16640
    s_nop 0
    buffer_load_dwordx4 v62, s[40:43], s82 offen lds
    s_add_u32 s96, s85, 7
    s_and_b32 s97, s96, 15
    s_lshl3_add_u32 s98, s97, s3
    s_mul_i32 s99, s98, 49152
    s_lshl_b32 s96, s11, 7
    s_add_u32 s82, s99, s96
    s_lshr_b32 s96, s3, 1
    s_mul_i32 s97, s96, 2080
    s_and_b32 s98, s3, 1
    s_mul_i32 s99, s98, 1056
    s_add_u32 s96, s97, s99
    s_add_u32 s20, s96, 24960
    s_mov_b32 m0, s20
    s_nop 0
    buffer_load_dwordx4 v62, s[40:43], s82 offen lds
    s_add_u32 s82, s82, 2048
    s_add_u32 m0, s20, 8320
    s_nop 0
    buffer_load_dwordx4 v62, s[40:43], s82 offen lds
    s_add_u32 s82, s82, 2048
    s_add_u32 m0, s20, 16640
    s_nop 0
    buffer_load_dwordx4 v62, s[40:43], s82 offen lds
    buffer_load_dwordx4 v[88:91], v60, s[48:51], s17 offen nt
    s_add_u32 s17, s17, 12288
    buffer_load_dwordx4 v[92:95], v60, s[48:51], s17 offen nt
    s_add_u32 s17, s17, 12288
    v_lshlrev_b32 v116, 16, v122
    v_mul_f32 v4, s7, v116
    v_exp_f32 v4, -v4
    s_nop 0
    v_add_f32 v4, 1.0, v4
    v_rcp_f32 v4, v4
    s_nop 0
    v_mul_f32 v116, v116, v4
    v_cvt_pk_bf16_f32 v116, 0, v116
    v_and_b32 v117, s6, v122
    v_mul_f32 v5, s7, v117
    v_exp_f32 v5, -v5
    s_nop 0
    v_add_f32 v5, 1.0, v5
    v_rcp_f32 v5, v5
    s_nop 0
    v_mul_f32 v117, v117, v5
    v_cvt_pk_bf16_f32 v117, 0, v117
    v_lshlrev_b32 v118, 16, v123
    v_mul_f32 v4, s7, v118
    v_exp_f32 v4, -v4
    s_nop 0
    v_add_f32 v4, 1.0, v4
    v_rcp_f32 v4, v4
    s_nop 0
    v_mul_f32 v118, v118, v4
    v_cvt_pk_bf16_f32 v118, 0, v118
    v_and_b32 v119, s6, v123
    v_mul_f32 v5, s7, v119
    v_exp_f32 v5, -v5
    s_nop 0
    v_add_f32 v5, 1.0, v5
    v_rcp_f32 v5, v5
    s_nop 0
    v_mul_f32 v119, v119, v5
    v_cvt_pk_bf16_f32 v119, 0, v119
    s_barrier
    s_add_u32 s96, s85, 8
    s_and_b32 s97, s96, 15
    s_lshl3_add_u32 s98, s97, s3
    s_sub_u32 s99, s98, 4
    s_mul_i32 s96, s99, 49152
    s_lshl_b32 s97, s11, 7
    s_add_u32 s82, s96, s97
    s_sub_u32 s96, s3, 4
    s_lshr_b32 s97, s96, 1
    s_mul_i32 s98, s97, 2080
    s_sub_u32 s99, s3, 4
    s_and_b32 s96, s99, 1
    s_mul_i32 s97, s96, 1056
    s_add_u32 s99, s98, s97
    s_add_u32 s20, s99, 49920
    s_mov_b32 m0, s20
    s_nop 0
    buffer_load_dwordx4 v62, s[40:43], s82 offen lds
    s_add_u32 s82, s82, 2048
    s_add_u32 m0, s20, 8320
    s_nop 0
    buffer_load_dwordx4 v62, s[40:43], s82 offen lds
    s_add_u32 s82, s82, 2048
    s_add_u32 m0, s20, 16640
    s_nop 0
    buffer_load_dwordx4 v62, s[40:43], s82 offen lds
    s_add_u32 s96, s85, 8
    s_and_b32 s97, s96, 15
    s_lshl3_add_u32 s98, s97, s3
    s_mul_i32 s99, s98, 49152
    s_lshl_b32 s96, s11, 7
    s_add_u32 s82, s99, s96
    s_lshr_b32 s96, s3, 1
    s_mul_i32 s97, s96, 2080
    s_and_b32 s98, s3, 1
    s_mul_i32 s99, s98, 1056
    s_add_u32 s96, s97, s99
    s_add_u32 s20, s96, 49920
    s_mov_b32 m0, s20
    s_nop 0
    buffer_load_dwordx4 v62, s[40:43], s82 offen lds
    s_add_u32 s82, s82, 2048
    s_add_u32 m0, s20, 8320
    s_nop 0
    buffer_load_dwordx4 v62, s[40:43], s82 offen lds
    s_add_u32 s82, s82, 2048
    s_add_u32 m0, s20, 16640
    s_nop 0
    buffer_load_dwordx4 v62, s[40:43], s82 offen lds
    s_waitcnt lgkmcnt(0)
    s_load_dword s24, s[32:33], s92 offset:1536 glc
    s_load_dword s25, s[32:33], s92 offset:1280 glc
    s_load_dword s26, s[32:33], s92 offset:2048 glc
    s_load_dword s27, s[32:33], s92 offset:1792 glc
    s_waitcnt vmcnt(21)
    v_lshlrev_b32 v4, 16, v80
    v_and_b32 v5, s6, v80
    v_mul_f32 v20, v4, v112
    v_mul_f32 v21, v5, v112
    v_lshlrev_b32 v6, 16, v81
    v_and_b32 v7, s6, v81
    v_mul_f32 v22, v6, v112
    v_mul_f32 v23, v7, v112
    v_lshlrev_b32 v4, 16, v82
    v_and_b32 v5, s6, v82
    v_mul_f32 v24, v4, v112
    v_mul_f32 v25, v5, v112
    v_lshlrev_b32 v6, 16, v83
    v_and_b32 v7, s6, v83
    v_mul_f32 v26, v6, v112
    v_mul_f32 v27, v7, v112
    s_barrier
    s_add_u32 s96, s85, 9
    s_and_b32 s97, s96, 15
    s_lshl3_add_u32 s98, s97, s3
    s_sub_u32 s99, s98, 4
    s_mul_i32 s96, s99, 49152
    s_lshl_b32 s97, s11, 7
    s_add_u32 s82, s96, s97
    s_sub_u32 s96, s3, 4
    s_lshr_b32 s97, s96, 1
    s_mul_i32 s98, s97, 2080
    s_sub_u32 s99, s3, 4
    s_and_b32 s96, s99, 1
    s_mul_i32 s97, s96, 1056
    s_add_u32 s99, s98, s97
    s_add_u32 s20, s99, 74880
    s_mov_b32 m0, s20
    s_nop 0
    buffer_load_dwordx4 v62, s[40:43], s82 offen lds
    s_add_u32 s82, s82, 2048
    s_add_u32 m0, s20, 8320
    s_nop 0
    buffer_load_dwordx4 v62, s[40:43], s82 offen lds
    s_add_u32 s82, s82, 2048
    s_add_u32 m0, s20, 16640
    s_nop 0
    buffer_load_dwordx4 v62, s[40:43], s82 offen lds
    s_add_u32 s96, s85, 9
    s_and_b32 s97, s96, 15
    s_lshl3_add_u32 s98, s97, s3
    s_mul_i32 s99, s98, 49152
    s_lshl_b32 s96, s11, 7
    s_add_u32 s82, s99, s96
    s_lshr_b32 s96, s3, 1
    s_mul_i32 s97, s96, 2080
    s_and_b32 s98, s3, 1
    s_mul_i32 s99, s98, 1056
    s_add_u32 s96, s97, s99
    s_add_u32 s20, s96, 74880
    s_mov_b32 m0, s20
    s_nop 0
    buffer_load_dwordx4 v62, s[40:43], s82 offen lds
    s_add_u32 s82, s82, 2048
    s_add_u32 m0, s20, 8320
    s_nop 0
    buffer_load_dwordx4 v62, s[40:43], s82 offen lds
    s_add_u32 s82, s82, 2048
    s_add_u32 m0, s20, 16640
    s_nop 0
    buffer_load_dwordx4 v62, s[40:43], s82 offen lds
    buffer_load_dwordx4 v[96:99], v60, s[48:51], s17 offen nt
    s_add_u32 s17, s17, 12288
    buffer_load_dwordx4 v[100:103], v60, s[48:51], s17 offen nt
    s_add_u32 s17, s17, 12288
    s_waitcnt vmcnt(28)
    v_lshlrev_b32 v4, 16, v84
    v_and_b32 v5, s6, v84
    v_fmac_f32 v20, v4, v113
    v_fmac_f32 v21, v5, v113
    v_lshlrev_b32 v6, 16, v85
    v_and_b32 v7, s6, v85
    v_fmac_f32 v22, v6, v113
    v_fmac_f32 v23, v7, v113
    v_lshlrev_b32 v4, 16, v86
    v_and_b32 v5, s6, v86
    v_fmac_f32 v24, v4, v113
    v_fmac_f32 v25, v5, v113
    v_lshlrev_b32 v6, 16, v87
    v_and_b32 v7, s6, v87
    v_fmac_f32 v26, v6, v113
    v_fmac_f32 v27, v7, v113
    s_waitcnt vmcnt(22)
    s_barrier
    s_add_u32 s96, s85, 10
    s_and_b32 s97, s96, 15
    s_lshl3_add_u32 s98, s97, s3
    s_sub_u32 s99, s98, 4
    s_mul_i32 s96, s99, 49152
    s_lshl_b32 s97, s11, 7
    s_add_u32 s82, s96, s97
    s_sub_u32 s96, s3, 4
    s_lshr_b32 s97, s96, 1
    s_mul_i32 s98, s97, 2080
    s_sub_u32 s99, s3, 4
    s_and_b32 s96, s99, 1
    s_mul_i32 s97, s96, 1056
    s_add_u32 s99, s98, s97
    s_add_u32 s20, s99, 99840
    s_mov_b32 m0, s20
    s_nop 0
    buffer_load_dwordx4 v62, s[40:43], s82 offen lds
    s_add_u32 s82, s82, 2048
    s_add_u32 m0, s20, 8320
    s_nop 0
    buffer_load_dwordx4 v62, s[40:43], s82 offen lds
    s_add_u32 s82, s82, 2048
    s_add_u32 m0, s20, 16640
    s_nop 0
    buffer_load_dwordx4 v62, s[40:43], s82 offen lds
    s_add_u32 s96, s85, 10
    s_and_b32 s97, s96, 15
    s_lshl3_add_u32 s98, s97, s3
    s_mul_i32 s99, s98, 49152
    s_lshl_b32 s96, s11, 7
    s_add_u32 s82, s99, s96
    s_lshr_b32 s96, s3, 1
    s_mul_i32 s97, s96, 2080
    s_and_b32 s98, s3, 1
    s_mul_i32 s99, s98, 1056
    s_add_u32 s96, s97, s99
    s_add_u32 s20, s96, 99840
    s_mov_b32 m0, s20
    s_nop 0
    buffer_load_dwordx4 v62, s[40:43], s82 offen lds
    s_add_u32 s82, s82, 2048
    s_add_u32 m0, s20, 8320
    s_nop 0
    buffer_load_dwordx4 v62, s[40:43], s82 offen lds
    s_add_u32 s82, s82, 2048
    s_add_u32 m0, s20, 16640
    s_nop 0
    buffer_load_dwordx4 v62, s[40:43], s82 offen lds
    s_waitcnt vmcnt(21)
    v_lshlrev_b32 v4, 16, v88
    v_and_b32 v5, s6, v88
    v_fmac_f32 v20, v4, v114
    v_fmac_f32 v21, v5, v114
    v_lshlrev_b32 v6, 16, v89
    v_and_b32 v7, s6, v89
    v_fmac_f32 v22, v6, v114
    v_fmac_f32 v23, v7, v114
    v_lshlrev_b32 v4, 16, v90
    v_and_b32 v5, s6, v90
    v_fmac_f32 v24, v4, v114
    v_fmac_f32 v25, v5, v114
    v_lshlrev_b32 v6, 16, v91
    v_and_b32 v7, s6, v91
    v_fmac_f32 v26, v6, v114
    v_fmac_f32 v27, v7, v114
    s_barrier
    s_add_u32 s96, s85, 11
    s_and_b32 s97, s96, 15
    s_lshl3_add_u32 s98, s97, s3
    s_sub_u32 s99, s98, 4
    s_mul_i32 s96, s99, 49152
    s_lshl_b32 s97, s11, 7
    s_add_u32 s82, s96, s97
    s_sub_u32 s96, s3, 4
    s_lshr_b32 s97, s96, 1
    s_mul_i32 s98, s97, 2080
    s_sub_u32 s99, s3, 4
    s_and_b32 s96, s99, 1
    s_mul_i32 s97, s96, 1056
    s_add_u32 s99, s98, s97
    s_add_u32 s20, s99, 124800
    s_mov_b32 m0, s20
    s_nop 0
    buffer_load_dwordx4 v62, s[40:43], s82 offen lds
    s_add_u32 s82, s82, 2048
    s_add_u32 m0, s20, 8320
    s_nop 0
    buffer_load_dwordx4 v62, s[40:43], s82 offen lds
    s_add_u32 s82, s82, 2048
    s_add_u32 m0, s20, 16640
    s_nop 0
    buffer_load_dwordx4 v62, s[40:43], s82 offen lds
    s_add_u32 s96, s85, 11
    s_and_b32 s97, s96, 15
    s_lshl3_add_u32 s98, s97, s3
    s_mul_i32 s99, s98, 49152
    s_lshl_b32 s96, s11, 7
    s_add_u32 s82, s99, s96
    s_lshr_b32 s96, s3, 1
    s_mul_i32 s97, s96, 2080
    s_and_b32 s98, s3, 1
    s_mul_i32 s99, s98, 1056
    s_add_u32 s96, s97, s99
    s_add_u32 s20, s96, 124800
    s_mov_b32 m0, s20
    s_nop 0
    buffer_load_dwordx4 v62, s[40:43], s82 offen lds
    s_add_u32 s82, s82, 2048
    s_add_u32 m0, s20, 8320
    s_nop 0
    buffer_load_dwordx4 v62, s[40:43], s82 offen lds
    s_add_u32 s82, s82, 2048
    s_add_u32 m0, s20, 16640
    s_nop 0
    buffer_load_dwordx4 v62, s[40:43], s82 offen lds
    buffer_load_dwordx4 v[104:107], v60, s[48:51], s17 offen nt
    s_add_u32 s17, s17, 12288
    buffer_load_dwordx4 v[108:111], v60, s[48:51], s17 offen nt
    s_lshl2_add_u32 s96, s74, s75
    s_lshl_b32 s97, s96, 11
    s_and_b32 s98, s3, 1
    s_lshl_b32 s99, s98, 10
    s_add_u32 s96, s97, s99
    s_add_u32 s13, s96, 20971520
    s_lshl4_add_u32 s96, s21, s12
    s_lshl_b32 s97, s96, 11
    s_and_b32 s98, s3, 1
    s_lshl_b32 s99, s98, 10
    s_add_u32 s96, s97, s99
    s_add_u32 s14, s96, 12582912
    buffer_load_dwordx4 v[124:127], v2, s[32:35], s13 offen
    s_waitcnt vmcnt(29)
    v_lshlrev_b32 v4, 16, v92
    v_and_b32 v5, s6, v92
    v_fmac_f32 v20, v4, v115
    v_fmac_f32 v21, v5, v115
    v_lshlrev_b32 v6, 16, v93
    v_and_b32 v7, s6, v93
    v_fmac_f32 v22, v6, v115
    v_fmac_f32 v23, v7, v115
    v_lshlrev_b32 v4, 16, v94
    v_and_b32 v5, s6, v94
    v_fmac_f32 v24, v4, v115
    v_fmac_f32 v25, v5, v115
    v_lshlrev_b32 v6, 16, v95
    v_and_b32 v7, s6, v95
    v_fmac_f32 v26, v6, v115
    v_fmac_f32 v27, v7, v115
    s_waitcnt lgkmcnt(0)
    s_load_dword s24, s[32:33], s92 offset:2560 glc
    s_load_dword s25, s[32:33], s92 offset:2304 glc
    s_load_dword s26, s[32:33], s92 offset:3072 glc
    s_load_dword s27, s[32:33], s92 offset:2816 glc
    s_load_dword s28, s[32:33], s92 offset:3584 glc
    s_load_dword s29, s[32:33], s92 offset:3328 glc
    s_waitcnt vmcnt(23)
    s_barrier
    s_add_u32 s96, s85, 12
    s_and_b32 s97, s96, 15
    s_lshl3_add_u32 s98, s97, s3
    s_sub_u32 s99, s98, 4
    s_mul_i32 s96, s99, 49152
    s_lshl_b32 s97, s11, 7
    s_add_u32 s82, s96, s97
    s_sub_u32 s96, s3, 4
    s_lshr_b32 s97, s96, 1
    s_mul_i32 s98, s97, 2080
    s_sub_u32 s99, s3, 4
    s_and_b32 s96, s99, 1
    s_mul_i32 s97, s96, 1056
    s_add_u32 s20, s98, s97
    s_mov_b32 m0, s20
    s_nop 0
    buffer_load_dwordx4 v62, s[40:43], s82 offen lds
    s_add_u32 s82, s82, 2048
    s_add_u32 m0, s20, 8320
    s_nop 0
    buffer_load_dwordx4 v62, s[40:43], s82 offen lds
    s_add_u32 s82, s82, 2048
    s_add_u32 m0, s20, 16640
    s_nop 0
    buffer_load_dwordx4 v62, s[40:43], s82 offen lds
    s_add_u32 s96, s85, 12
    s_and_b32 s97, s96, 15
    s_lshl3_add_u32 s98, s97, s3
    s_mul_i32 s99, s98, 49152
    s_lshl_b32 s96, s11, 7
    s_add_u32 s82, s99, s96
    s_lshr_b32 s96, s3, 1
    s_mul_i32 s97, s96, 2080
    s_and_b32 s98, s3, 1
    s_mul_i32 s99, s98, 1056
    s_add_u32 s20, s97, s99
    s_mov_b32 m0, s20
    s_nop 0
    buffer_load_dwordx4 v62, s[40:43], s82 offen lds
    s_add_u32 s82, s82, 2048
    s_add_u32 m0, s20, 8320
    s_nop 0
    buffer_load_dwordx4 v62, s[40:43], s82 offen lds
    s_add_u32 s82, s82, 2048
    s_add_u32 m0, s20, 16640
    s_nop 0
    buffer_load_dwordx4 v62, s[40:43], s82 offen lds
    s_waitcnt vmcnt(22)
    v_lshlrev_b32 v4, 16, v96
    v_and_b32 v5, s6, v96
    v_fmac_f32 v20, v4, v116
    v_fmac_f32 v21, v5, v116
    v_lshlrev_b32 v6, 16, v97
    v_and_b32 v7, s6, v97
    v_fmac_f32 v22, v6, v116
    v_fmac_f32 v23, v7, v116
    v_lshlrev_b32 v4, 16, v98
    v_and_b32 v5, s6, v98
    v_fmac_f32 v24, v4, v116
    v_fmac_f32 v25, v5, v116
    v_lshlrev_b32 v6, 16, v99
    v_and_b32 v7, s6, v99
    v_fmac_f32 v26, v6, v116
    v_fmac_f32 v27, v7, v116
    s_waitcnt vmcnt(21)
    v_lshlrev_b32 v4, 16, v100
    v_and_b32 v5, s6, v100
    v_fmac_f32 v20, v4, v117
    v_fmac_f32 v21, v5, v117
    v_lshlrev_b32 v6, 16, v101
    v_and_b32 v7, s6, v101
    v_fmac_f32 v22, v6, v117
    v_fmac_f32 v23, v7, v117
    v_lshlrev_b32 v4, 16, v102
    v_and_b32 v5, s6, v102
    v_fmac_f32 v24, v4, v117
    v_fmac_f32 v25, v5, v117
    v_lshlrev_b32 v6, 16, v103
    v_and_b32 v7, s6, v103
    v_fmac_f32 v26, v6, v117
    v_fmac_f32 v27, v7, v117
    s_barrier
    s_add_u32 s96, s85, 13
    s_and_b32 s97, s96, 15
    s_lshl3_add_u32 s98, s97, s3
    s_sub_u32 s99, s98, 4
    s_mul_i32 s96, s99, 49152
    s_lshl_b32 s97, s11, 7
    s_add_u32 s82, s96, s97
    s_sub_u32 s96, s3, 4
    s_lshr_b32 s97, s96, 1
    s_mul_i32 s98, s97, 2080
    s_sub_u32 s99, s3, 4
    s_and_b32 s96, s99, 1
    s_mul_i32 s97, s96, 1056
    s_add_u32 s99, s98, s97
    s_add_u32 s20, s99, 24960
    s_mov_b32 m0, s20
    s_nop 0
    buffer_load_dwordx4 v62, s[40:43], s82 offen lds
    s_add_u32 s82, s82, 2048
    s_add_u32 m0, s20, 8320
    s_nop 0
    buffer_load_dwordx4 v62, s[40:43], s82 offen lds
    s_add_u32 s82, s82, 2048
    s_add_u32 m0, s20, 16640
    s_nop 0
    buffer_load_dwordx4 v62, s[40:43], s82 offen lds
    s_add_u32 s96, s85, 13
    s_and_b32 s97, s96, 15
    s_lshl3_add_u32 s98, s97, s3
    s_mul_i32 s99, s98, 49152
    s_lshl_b32 s96, s11, 7
    s_add_u32 s82, s99, s96
    s_lshr_b32 s96, s3, 1
    s_mul_i32 s97, s96, 2080
    s_and_b32 s98, s3, 1
    s_mul_i32 s99, s98, 1056
    s_add_u32 s96, s97, s99
    s_add_u32 s20, s96, 24960
    s_mov_b32 m0, s20
    s_nop 0
    buffer_load_dwordx4 v62, s[40:43], s82 offen lds
    s_add_u32 s82, s82, 2048
    s_add_u32 m0, s20, 8320
    s_nop 0
    buffer_load_dwordx4 v62, s[40:43], s82 offen lds
    s_add_u32 s82, s82, 2048
    s_add_u32 m0, s20, 16640
    s_nop 0
    buffer_load_dwordx4 v62, s[40:43], s82 offen lds
    s_waitcnt vmcnt(14)
    v_lshlrev_b32 v4, 16, v104
    v_and_b32 v5, s6, v104
    v_fmac_f32 v20, v4, v118
    v_fmac_f32 v21, v5, v118
    v_lshlrev_b32 v6, 16, v105
    v_and_b32 v7, s6, v105
    v_fmac_f32 v22, v6, v118
    v_fmac_f32 v23, v7, v118
    v_lshlrev_b32 v4, 16, v106
    v_and_b32 v5, s6, v106
    v_fmac_f32 v24, v4, v118
    v_fmac_f32 v25, v5, v118
    v_lshlrev_b32 v6, 16, v107
    v_and_b32 v7, s6, v107
    v_fmac_f32 v26, v6, v118
    v_fmac_f32 v27, v7, v118
    s_waitcnt vmcnt(13)
    v_lshlrev_b32 v4, 16, v108
    v_and_b32 v5, s6, v108
    v_fmac_f32 v20, v4, v119
    v_fmac_f32 v21, v5, v119
    v_lshlrev_b32 v6, 16, v109
    v_and_b32 v7, s6, v109
    v_fmac_f32 v22, v6, v119
    v_fmac_f32 v23, v7, v119
    v_lshlrev_b32 v4, 16, v110
    v_and_b32 v5, s6, v110
    v_fmac_f32 v24, v4, v119
    v_fmac_f32 v25, v5, v119
    v_lshlrev_b32 v6, 16, v111
    v_and_b32 v7, s6, v111
    v_fmac_f32 v26, v6, v119
    v_fmac_f32 v27, v7, v119
    v_permlane32_swap_b32 v20, v24
    v_permlane32_swap_b32 v21, v25
    v_permlane32_swap_b32 v22, v26
    v_permlane32_swap_b32 v23, v27
    v_add_f32 v20, v20, v24
    v_add_f32 v21, v21, v25
    v_add_f32 v22, v22, v26
    v_add_f32 v23, v23, v27
    s_nop 0
    v_permlane16_swap_b32 v20, v22
    v_permlane16_swap_b32 v21, v23
    v_add_f32 v20, v20, v22
    v_add_f32 v21, v21, v23
    s_nop 0
    v_add_f32_dpp v20, v20, v20 row_ror:8 row_mask:0xf bank_mask:0xf
    v_add_f32_dpp v21, v21, v21 row_ror:8 row_mask:0xf bank_mask:0xf
    s_nop 1
    v_mov_b32_dpp v20, v21 quad_perm:[0,1,2,3] row_mask:0xf bank_mask:0xc
    ds_write_b32 v65, v20 offset:1024
    s_waitcnt lgkmcnt(0)
    s_barrier
    s_add_u32 s96, s85, 14
    s_and_b32 s97, s96, 15
    s_lshl3_add_u32 s98, s97, s3
    s_sub_u32 s99, s98, 4
    s_mul_i32 s96, s99, 49152
    s_lshl_b32 s97, s11, 7
    s_add_u32 s82, s96, s97
    s_sub_u32 s96, s3, 4
    s_lshr_b32 s97, s96, 1
    s_mul_i32 s98, s97, 2080
    s_sub_u32 s99, s3, 4
    s_and_b32 s96, s99, 1
    s_mul_i32 s97, s96, 1056
    s_add_u32 s99, s98, s97
    s_add_u32 s20, s99, 49920
    s_mov_b32 m0, s20
    s_nop 0
    buffer_load_dwordx4 v62, s[40:43], s82 offen lds
    s_add_u32 s82, s82, 2048
    s_add_u32 m0, s20, 8320
    s_nop 0
    buffer_load_dwordx4 v62, s[40:43], s82 offen lds
    s_add_u32 s82, s82, 2048
    s_add_u32 m0, s20, 16640
    s_nop 0
    buffer_load_dwordx4 v62, s[40:43], s82 offen lds
    s_add_u32 s96, s85, 14
    s_and_b32 s97, s96, 15
    s_lshl3_add_u32 s98, s97, s3
    s_mul_i32 s99, s98, 49152
    s_lshl_b32 s96, s11, 7
    s_add_u32 s82, s99, s96
    s_lshr_b32 s96, s3, 1
    s_mul_i32 s97, s96, 2080
    s_and_b32 s98, s3, 1
    s_mul_i32 s99, s98, 1056
    s_add_u32 s96, s97, s99
    s_add_u32 s20, s96, 49920
    s_mov_b32 m0, s20
    s_nop 0
    buffer_load_dwordx4 v62, s[40:43], s82 offen lds
    s_add_u32 s82, s82, 2048
    s_add_u32 m0, s20, 8320
    s_nop 0
    buffer_load_dwordx4 v62, s[40:43], s82 offen lds
    s_add_u32 s82, s82, 2048
    s_add_u32 m0, s20, 16640
    s_nop 0
    buffer_load_dwordx4 v62, s[40:43], s82 offen lds
    s_cmp_lg_u32 s3, 4
    s_cbranch_scc1 L_M2F
    ds_read_b128 v[20:23], v64 offset:1024
    s_bfe_u32 s96, s9, 131074
    s_lshl_b32 s97, s8, 1
    s_lshl4_add_u32 s98, s96, s97
    s_lshr_b32 s99, s9, 4
    s_add_u32 s96, s98, s99
    s_and_b32 s97, s9, 3
    s_lshl2_add_u32 s98, s96, s97
    s_lshl_b32 s99, s98, 9
    s_add_u32 s13, s99, 131072
    s_waitcnt lgkmcnt(0)
    v_add_f32 v20, v20, v21
    v_add_f32 v22, v22, v23
    v_mov_b32 v21, s4
    v_add_f32 v20, v20, v22
    buffer_store_dwordx2 v[20:21], v63, s[32:35], s13 offen sc1
L_M2F:
    s_barrier
    s_add_u32 s96, s85, 15
    s_and_b32 s97, s96, 15
    s_lshl3_add_u32 s98, s97, s3
    s_sub_u32 s99, s98, 4
    s_mul_i32 s96, s99, 49152
    s_lshl_b32 s97, s11, 7
    s_add_u32 s82, s96, s97
    s_sub_u32 s96, s3, 4
    s_lshr_b32 s97, s96, 1
    s_mul_i32 s98, s97, 2080
    s_sub_u32 s99, s3, 4
    s_and_b32 s96, s99, 1
    s_mul_i32 s97, s96, 1056
    s_add_u32 s99, s98, s97
    s_add_u32 s20, s99, 74880
    s_mov_b32 m0, s20
    s_nop 0
    buffer_load_dwordx4 v62, s[40:43], s82 offen lds
    s_add_u32 s82, s82, 2048
    s_add_u32 m0, s20, 8320
    s_nop 0
    buffer_load_dwordx4 v62, s[40:43], s82 offen lds
    s_add_u32 s82, s82, 2048
    s_add_u32 m0, s20, 16640
    s_nop 0
    buffer_load_dwordx4 v62, s[40:43], s82 offen lds
    s_add_u32 s96, s85, 15
    s_and_b32 s97, s96, 15
    s_lshl3_add_u32 s98, s97, s3
    s_mul_i32 s99, s98, 49152
    s_lshl_b32 s96, s11, 7
    s_add_u32 s82, s99, s96
    s_lshr_b32 s96, s3, 1
    s_mul_i32 s97, s96, 2080
    s_and_b32 s98, s3, 1
    s_mul_i32 s99, s98, 1056
    s_add_u32 s96, s97, s99
    s_add_u32 s20, s96, 74880
    s_mov_b32 m0, s20
    s_nop 0
    buffer_load_dwordx4 v62, s[40:43], s82 offen lds
    s_add_u32 s82, s82, 2048
    s_add_u32 m0, s20, 8320
    s_nop 0
    buffer_load_dwordx4 v62, s[40:43], s82 offen lds
    s_add_u32 s82, s82, 2048
    s_add_u32 m0, s20, 16640
    s_nop 0
    buffer_load_dwordx4 v62, s[40:43], s82 offen lds
    s_mov_b32 s13, s80
    buffer_load_dwordx4 v[176:179], v72, s[52:55], s13 offen nt
    s_add_u32 s13, s80, 4294049792
    buffer_load_dwordx4 v[180:183], v72, s[52:55], s13 offen nt
    s_waitcnt vmcnt(20)
    s_barrier
    s_waitcnt vmcnt(14)
    s_waitcnt vmcnt(8)
    s_waitcnt vmcnt(2)
    s_barrier
    v_and_b32 v89, 31, v1
    v_lshlrev_b32 v89, 4, v89
    v_lshrrev_b32 v9, 5, v1
    v_lshl_add_u32 v89, v9, 9, v89
    s_and_b32 s96, s3, 3
    s_lshl4_add_u32 s97, s96, s12
    s_lshl_b32 s98, s97, 11
    s_add_u32 s18, s98, 131072
    s_lshl_b32 s13, s12, 7
    v_and_b32 v4, 31, v1
    v_lshl_add_u32 v4, v4, 2, s13
    global_load_dword v88, v4, s[78:79]
    buffer_load_dwordx4 v[80:83], v89, s[32:35], s18 offen sc1
    buffer_load_dwordx4 v[84:87], v89, s[32:35], s18 offen offset:1024 sc1
    s_barrier
    s_lshl4_add_u32 s96, s11, s10
    s_lshl_b32 s97, s96, 10
    s_and_b32 s98, s3, 3
    s_lshl_b32 s99, s98, 8
    s_add_u32 s96, s97, s99
    s_add_u32 s13, s96, 29360128
    s_lshl_b32 s96, s11, 7
    s_add_u32 s14, s96, 32768
    v_lshlrev_b32 v60, 7, v1
    s_mov_b64 exec, 3
    buffer_load_dword v60, v60, s[32:35], s13 offen
    buffer_load_dword v61, v3, s[32:35], s14 offen
    s_mov_b64 exec, -1
    s_add_u32 s96, s84, 1114112
    s_and_b32 s97, s96, 1048575
    s_lshl_b32 s98, s83, 16
    s_xor_b32 s99, s97, s98
    s_xor_b32 s96, s88, 1048576
    s_add_u32 s13, s99, s96
    s_add_u32 m0, s89, 102400
    s_nop 0
    buffer_load_dwordx4 v74, s[44:47], s13 offen lds
    s_add_u32 s96, s84, 1179648
    s_and_b32 s97, s96, 1048575
    s_lshl_b32 s98, s83, 16
    s_xor_b32 s99, s97, s98
    s_xor_b32 s96, s88, 1048576
    s_add_u32 s13, s99, s96
    s_add_u32 m0, s89, 106496
    s_nop 0
    buffer_load_dwordx4 v74, s[44:47], s13 offen lds
    s_add_u32 s96, s84, 1245184
    s_and_b32 s97, s96, 1048575
    s_lshl_b32 s98, s83, 16
    s_xor_b32 s99, s97, s98
    s_xor_b32 s96, s88, 1048576
    s_add_u32 s13, s99, s96
    s_add_u32 m0, s89, 110592
    s_nop 0
    buffer_load_dwordx4 v74, s[44:47], s13 offen lds
    s_add_u32 s96, s84, 1310720
    s_and_b32 s97, s96, 1048575
    s_lshl_b32 s98, s83, 16
    s_xor_b32 s99, s97, s98
    s_xor_b32 s96, s88, 1048576
    s_add_u32 s13, s99, s96
    s_add_u32 m0, s89, 114688
    s_nop 0
    buffer_load_dwordx4 v74, s[44:47], s13 offen lds
    s_add_u32 s96, s84, 1376256
    s_and_b32 s97, s96, 1048575
    s_lshl_b32 s98, s83, 16
    s_xor_b32 s99, s97, s98
    s_xor_b32 s96, s88, 1048576
    s_add_u32 s13, s99, s96
    s_add_u32 m0, s89, 118784
    s_nop 0
    buffer_load_dwordx4 v74, s[44:47], s13 offen lds
    s_add_u32 s96, s84, 1441792
    s_and_b32 s97, s96, 1048575
    s_lshl_b32 s98, s83, 16
    s_xor_b32 s99, s97, s98
    s_xor_b32 s96, s88, 1048576
    s_add_u32 s13, s99, s96
    s_add_u32 m0, s89, 122880
    s_nop 0
    buffer_load_dwordx4 v74, s[44:47], s13 offen lds
    s_add_u32 s96, s84, 1507328
    s_and_b32 s97, s96, 1048575
    s_lshl_b32 s98, s83, 16
    s_xor_b32 s99, s97, s98
    s_xor_b32 s96, s88, 1048576
    s_add_u32 s13, s99, s96
    s_add_u32 m0, s89, 126976
    s_nop 0
    buffer_load_dwordx4 v74, s[44:47], s13 offen lds
    s_add_u32 s96, s84, 1572864
    s_and_b32 s97, s96, 1048575
    s_lshl_b32 s98, s83, 16
    s_xor_b32 s99, s97, s98
    s_xor_b32 s96, s88, 1048576
    s_add_u32 s13, s99, s96
    s_add_u32 m0, s89, 131072
    s_nop 0
    buffer_load_dwordx4 v74, s[44:47], s13 offen lds
    s_add_u32 s13, s80, 57344
    buffer_load_dwordx4 v[184:187], v72, s[52:55], s13 offen nt
    s_add_u32 s13, s80, 4294107136
    buffer_load_dwordx4 v[188:191], v72, s[52:55], s13 offen nt
    s_add_u32 s13, s80, 114688
    buffer_load_dwordx4 v[192:195], v72, s[52:55], s13 offen nt
    s_add_u32 s13, s80, 4294164480
    buffer_load_dwordx4 v[196:199], v72, s[52:55], s13 offen nt
    s_add_u32 s13, s80, 172032
    buffer_load_dwordx4 v[200:203], v72, s[52:55], s13 offen nt
    s_add_u32 s13, s80, 4294221824
    buffer_load_dwordx4 v[204:207], v72, s[52:55], s13 offen nt
    s_mov_b32 s13, s80
    buffer_load_dwordx4 v[208:211], v72, s[56:59], s13 offen nt
    s_add_u32 s13, s80, 4294049792
    buffer_load_dwordx4 v[212:215], v72, s[56:59], s13 offen nt
    s_waitcnt vmcnt(18)
    v_bitop3_b32 v4, v81, v83, s4 bitop3:0x7e
    v_bitop3_b32 v4, v4, v85, s4 bitop3:0xf6
    v_bitop3_b32 v4, v4, v87, s4 bitop3:0xf6
    v_cmp_ne_u32 vcc, 0, v4
    s_cbranch_vccz TOK_14
POLL_15:
    buffer_load_dwordx4 v[80:83], v89, s[32:35], s18 offen sc1
    buffer_load_dwordx4 v[84:87], v89, s[32:35], s18 offen offset:1024 sc1
    s_waitcnt vmcnt(0)
    v_bitop3_b32 v4, v81, v83, s4 bitop3:0x7e
    v_bitop3_b32 v4, v4, v85, s4 bitop3:0xf6
    v_bitop3_b32 v4, v4, v87, s4 bitop3:0xf6
    v_cmp_ne_u32 vcc, 0, v4
    s_cbranch_vccz PDONE_16
    s_add_u32 s5, s5, 1
    s_cmp_lt_u32 s5, 300000
    s_cbranch_scc1 POLL_15
PDONE_16:
TOK_14:
    s_and_b32 s96, s3, 3
    s_lshl_b32 s97, s96, 7
    s_add_u32 s13, s97, 139264
    v_and_b32 v4, 31, v1
    v_lshl_add_u32 v4, v4, 2, s13
    s_and_b32 s14, s3, 3
    v_add_f32 v80, v80, v84
    v_add_f32 v81, v82, v86
    v_mov_b32 v82, v80
    v_mov_b32 v83, v81
    s_cmp_eq_u32 s14, 2
    s_cselect_b32 s15, 1.0, 0
    v_permlane32_swap_b32 v80, v82
    v_permlane32_swap_b32 v81, v83
    v_pk_add_f32 v[80:81], v[80:81], v[82:83]
    v_cvt_pk_bf16_f32 v80, 0, v80
    v_cvt_pk_bf16_f32 v81, 0, v81
    v_add_f32 v80, s15, v80
    v_add_f32 v81, s15, v81
    v_cvt_pk_bf16_f32 v82, v80, v81
    ds_write_b32 v4, v82
    s_cbranch_scc0 L_NOG
    v_lshlrev_b32 v80, 16, v82
    v_and_b32 v81, s6, v82
    v_lshlrev_b32 v84, 16, v88
    v_and_b32 v85, s6, v88
    v_pk_mul_f32 v[84:85], v[84:85], v[80:81]
    v_cvt_pk_bf16_f32 v86, v84, v85
    v_lshlrev_b32 v80, 16, v86
    v_and_b32 v81, s6, v86
    v_pk_add_f32 v[80:81], v[84:85], v[80:81] neg_lo:[0,1] neg_hi:[0,1]
    v_cvt_pk_bf16_f32 v87, v80, v81
    v_add_f32 v80, v84, v85
    ds_write2_b32 v4, v86, v87 offset0:64 offset1:96
    ds_write_b32 v4, v88 offset:512
    v_add_f32_dpp v80, v80, v80 quad_perm:[1,0,3,2] row_mask:0xf bank_mask:0xf
    s_nop 1
    v_add_f32_dpp v80, v80, v80 quad_perm:[2,3,0,1] row_mask:0xf bank_mask:0xf
    s_nop 1
    v_add_f32_dpp v80, v80, v80 row_half_mirror row_mask:0xf bank_mask:0xf
    s_nop 1
    v_add_f32_dpp v80, v80, v80 row_ror:8 row_mask:0xf bank_mask:0xf
    s_lshl4_add_u32 s96, s21, s12
    s_lshl3_add_u32 s13, s96, 65536
    v_mov_b32 v82, v80
    v_mov_b32 v81, s4
    s_nop 0
    v_permlane16_swap_b32 v80, v82
    v_add_f32 v80, v80, v82
    s_mov_b64 exec, 1
    buffer_store_dwordx2 v[80:81], v3, s[32:35], s13 offen sc1
    s_mov_b64 exec, -1
L_NOG:
    s_waitcnt lgkmcnt(0)
    s_barrier
    ds_read_b128 v[36:39], v76
    ds_read_b128 v[40:43], v76 offset:1024
    s_waitcnt lgkmcnt(0)
    v_mfma_f32_32x32x16_bf16 v[112:127], v[28:31], v[36:39], 0
    v_mfma_f32_32x32x16_bf16 v[112:127], v[32:35], v[40:43], v[112:127]
    s_add_u32 s13, s80, 57344
    buffer_load_dwordx4 v[216:219], v72, s[56:59], s13 offen nt
    s_add_u32 s13, s80, 4294107136
    buffer_load_dwordx4 v[220:223], v72, s[56:59], s13 offen nt
L_JOIN:
    s_nop 7
    v_cvt_pk_bf16_f32 v112, 0, v112
    v_cvt_pk_bf16_f32 v113, 0, v113
    v_cvt_pk_bf16_f32 v114, 0, v114
    v_cvt_pk_bf16_f32 v115, 0, v115
    v_cvt_pk_bf16_f32 v116, 0, v116
    v_cvt_pk_bf16_f32 v117, 0, v117
    v_cvt_pk_bf16_f32 v118, 0, v118
    v_cvt_pk_bf16_f32 v119, 0, v119
    v_cvt_pk_bf16_f32 v120, 0, v120
    v_cvt_pk_bf16_f32 v121, 0, v121
    v_cvt_pk_bf16_f32 v122, 0, v122
    v_cvt_pk_bf16_f32 v123, 0, v123
    v_cvt_pk_bf16_f32 v124, 0, v124
    v_cvt_pk_bf16_f32 v125, 0, v125
    v_cvt_pk_bf16_f32 v126, 0, v126
    v_cvt_pk_bf16_f32 v127, 0, v127
    v_max3_f32 v4, v112, v113, v114
    v_min3_f32 v5, v112, v113, v114
    v_max3_f32 v4, v4, v115, v116
    v_min3_f32 v5, v5, v115, v116
    v_max3_f32 v4, v4, v117, v118
    v_min3_f32 v5, v5, v117, v118
    v_max3_f32 v4, v4, v119, v120
    v_min3_f32 v5, v5, v119, v120
    v_max3_f32 v4, v4, v121, v122
    v_min3_f32 v5, v5, v121, v122
    v_max3_f32 v4, v4, v123, v124
    v_min3_f32 v5, v5, v123, v124
    v_max3_f32 v4, v4, v125, v126
    v_min3_f32 v5, v5, v125, v126
    v_max_f32 v6, v4, v127
    v_min_f32 v7, v5, v127
    v_max_f32 v4, v4, v127
    v_min_f32 v5, v5, v127
    s_nop 0
    v_permlane32_swap_b32 v4, v6
    v_permlane32_swap_b32 v5, v7
    v_max_f32 v4, v4, v6
    v_min_f32 v5, v5, v7
    v_pk_mul_f32 v[4:5], v[4:5], s[6:7] op_sel:[0,1]
    v_pk_fma_f32 v[128:129], v[112:113], s[6:7], v[4:5] op_sel:[0,1,0] op_sel_hi:[1,1,0] neg_lo:[0,0,1] neg_hi:[0,0,1]
    v_pk_fma_f32 v[112:113], v[112:113], s[6:7], v[4:5] op_sel:[0,1,1] neg_lo:[1,0,0] neg_hi:[1,0,0]
    v_pk_fma_f32 v[130:131], v[114:115], s[6:7], v[4:5] op_sel:[0,1,0] op_sel_hi:[1,1,0] neg_lo:[0,0,1] neg_hi:[0,0,1]
    v_pk_fma_f32 v[114:115], v[114:115], s[6:7], v[4:5] op_sel:[0,1,1] neg_lo:[1,0,0] neg_hi:[1,0,0]
    v_pk_fma_f32 v[132:133], v[116:117], s[6:7], v[4:5] op_sel:[0,1,0] op_sel_hi:[1,1,0] neg_lo:[0,0,1] neg_hi:[0,0,1]
    v_pk_fma_f32 v[116:117], v[116:117], s[6:7], v[4:5] op_sel:[0,1,1] neg_lo:[1,0,0] neg_hi:[1,0,0]
    v_pk_fma_f32 v[134:135], v[118:119], s[6:7], v[4:5] op_sel:[0,1,0] op_sel_hi:[1,1,0] neg_lo:[0,0,1] neg_hi:[0,0,1]
    v_pk_fma_f32 v[118:119], v[118:119], s[6:7], v[4:5] op_sel:[0,1,1] neg_lo:[1,0,0] neg_hi:[1,0,0]
    v_pk_fma_f32 v[136:137], v[120:121], s[6:7], v[4:5] op_sel:[0,1,0] op_sel_hi:[1,1,0] neg_lo:[0,0,1] neg_hi:[0,0,1]
    v_pk_fma_f32 v[120:121], v[120:121], s[6:7], v[4:5] op_sel:[0,1,1] neg_lo:[1,0,0] neg_hi:[1,0,0]
    v_pk_fma_f32 v[138:139], v[122:123], s[6:7], v[4:5] op_sel:[0,1,0] op_sel_hi:[1,1,0] neg_lo:[0,0,1] neg_hi:[0,0,1]
    v_pk_fma_f32 v[122:123], v[122:123], s[6:7], v[4:5] op_sel:[0,1,1] neg_lo:[1,0,0] neg_hi:[1,0,0]
    v_pk_fma_f32 v[140:141], v[124:125], s[6:7], v[4:5] op_sel:[0,1,0] op_sel_hi:[1,1,0] neg_lo:[0,0,1] neg_hi:[0,0,1]
    v_pk_fma_f32 v[124:125], v[124:125], s[6:7], v[4:5] op_sel:[0,1,1] neg_lo:[1,0,0] neg_hi:[1,0,0]
    v_pk_fma_f32 v[142:143], v[126:127], s[6:7], v[4:5] op_sel:[0,1,0] op_sel_hi:[1,1,0] neg_lo:[0,0,1] neg_hi:[0,0,1]
    v_pk_fma_f32 v[126:127], v[126:127], s[6:7], v[4:5] op_sel:[0,1,1] neg_lo:[1,0,0] neg_hi:[1,0,0]
    v_exp_f32 v128, v128
    v_exp_f32 v112, v112
    v_exp_f32 v129, v129
    v_exp_f32 v113, v113
    v_exp_f32 v130, v130
    v_exp_f32 v114, v114
    v_exp_f32 v131, v131
    v_exp_f32 v115, v115
    v_exp_f32 v132, v132
    v_exp_f32 v116, v116
    v_exp_f32 v133, v133
    v_exp_f32 v117, v117
    v_exp_f32 v134, v134
    v_exp_f32 v118, v118
    v_exp_f32 v135, v135
    v_exp_f32 v119, v119
    v_exp_f32 v136, v136
    v_exp_f32 v120, v120
    v_exp_f32 v137, v137
    v_exp_f32 v121, v121
    v_exp_f32 v138, v138
    v_exp_f32 v122, v122
    v_exp_f32 v139, v139
    v_exp_f32 v123, v123
    v_exp_f32 v140, v140
    v_exp_f32 v124, v124
    v_exp_f32 v141, v141
    v_exp_f32 v125, v125
    v_exp_f32 v142, v142
    v_exp_f32 v126, v126
    v_exp_f32 v143, v143
    v_exp_f32 v127, v127
    v_pk_add_f32 v[8:9], v[128:129], v[130:131]
    v_pk_add_f32 v[10:11], v[112:113], v[114:115]
    v_pk_add_f32 v[8:9], v[8:9], v[132:133]
    v_pk_add_f32 v[10:11], v[10:11], v[116:117]
    v_pk_add_f32 v[8:9], v[8:9], v[134:135]
    v_pk_add_f32 v[10:11], v[10:11], v[118:119]
    v_pk_add_f32 v[8:9], v[8:9], v[136:137]
    v_pk_add_f32 v[10:11], v[10:11], v[120:121]
    v_pk_add_f32 v[8:9], v[8:9], v[138:139]
    v_pk_add_f32 v[10:11], v[10:11], v[122:123]
    v_pk_add_f32 v[8:9], v[8:9], v[140:141]
    v_pk_add_f32 v[10:11], v[10:11], v[124:125]
    v_pk_add_f32 v[8:9], v[8:9], v[142:143]
    v_pk_add_f32 v[10:11], v[10:11], v[126:127]
    v_add_f32 v6, v8, v9
    v_add_f32 v7, v10, v11
    v_add_f32 v4, v8, v9
    v_add_f32 v5, v10, v11
    s_nop 0
    v_permlane32_swap_b32 v4, v6
    v_permlane32_swap_b32 v5, v7
    v_pk_add_f32 v[4:5], v[4:5], v[6:7]
    v_rcp_f32 v4, v4
    v_rcp_f32 v5, v5
    s_nop 0
    v_pk_mul_f32 v[128:129], v[128:129], v[4:5] op_sel_hi:[1,0]
    v_pk_mul_f32 v[112:113], v[112:113], v[4:5] op_sel:[0,1]
    v_pk_mul_f32 v[130:131], v[130:131], v[4:5] op_sel_hi:[1,0]
    v_pk_mul_f32 v[114:115], v[114:115], v[4:5] op_sel:[0,1]
    v_pk_mul_f32 v[132:133], v[132:133], v[4:5] op_sel_hi:[1,0]
    v_pk_mul_f32 v[116:117], v[116:117], v[4:5] op_sel:[0,1]
    v_pk_mul_f32 v[134:135], v[134:135], v[4:5] op_sel_hi:[1,0]
    v_pk_mul_f32 v[118:119], v[118:119], v[4:5] op_sel:[0,1]
    v_pk_mul_f32 v[136:137], v[136:137], v[4:5] op_sel_hi:[1,0]
    v_pk_mul_f32 v[120:121], v[120:121], v[4:5] op_sel:[0,1]
    v_pk_mul_f32 v[138:139], v[138:139], v[4:5] op_sel_hi:[1,0]
    v_pk_mul_f32 v[122:123], v[122:123], v[4:5] op_sel:[0,1]
    v_pk_mul_f32 v[140:141], v[140:141], v[4:5] op_sel_hi:[1,0]
    v_pk_mul_f32 v[124:125], v[124:125], v[4:5] op_sel:[0,1]
    v_pk_mul_f32 v[142:143], v[142:143], v[4:5] op_sel_hi:[1,0]
    v_pk_mul_f32 v[126:127], v[126:127], v[4:5] op_sel:[0,1]
    v_cvt_pk_bf16_f32 v80, v128, v129
    v_cvt_pk_bf16_f32 v88, v112, v113
    v_cvt_pk_bf16_f32 v81, v130, v131
    v_cvt_pk_bf16_f32 v89, v114, v115
    v_cvt_pk_bf16_f32 v82, v132, v133
    v_cvt_pk_bf16_f32 v90, v116, v117
    v_cvt_pk_bf16_f32 v83, v134, v135
    v_cvt_pk_bf16_f32 v91, v118, v119
    v_cvt_pk_bf16_f32 v84, v136, v137
    v_cvt_pk_bf16_f32 v92, v120, v121
    v_cvt_pk_bf16_f32 v85, v138, v139
    v_cvt_pk_bf16_f32 v93, v122, v123
    v_cvt_pk_bf16_f32 v86, v140, v141
    v_cvt_pk_bf16_f32 v94, v124, v125
    v_cvt_pk_bf16_f32 v87, v142, v143
    v_cvt_pk_bf16_f32 v95, v126, v127
    ds_write_b128 v75, v[80:83]
    ds_write_b128 v75, v[84:87] offset:4096
    ds_write_b128 v75, v[88:91] offset:8192
    ds_write_b128 v75, v[92:95] offset:12288
    s_lshl_b32 s13, s3, 12
    v_add_u32 v20, s13, v63
    s_lshl_b32 s96, s76, 13
    s_add_u32 s13, s96, 32768
    v_add_u32 v21, s13, v63
    v_mov_b32 v36, 0x3f803f80
    v_mov_b32 v37, 0x3f803f80
    v_mov_b32 v38, 0x3f803f80
    v_mov_b32 v39, 0x3f803f80
    s_lshl3_add_u32 s96, s11, s3
    s_lshl_b32 s97, s96, 5
    s_add_u32 s98, s97, s10
    s_lshl_b32 s99, s98, 10
    s_add_u32 s13, s99, 25165824
    s_add_u32 s15, s13, 16384
    s_lshl3_add_u32 s96, s11, s3
    s_lshl_b32 s97, s96, 10
    s_add_u32 s16, s97, 21495808
    s_lshl_b32 s96, s10, 6
    s_add_u32 s14, s96, s16
    s_waitcnt lgkmcnt(0)
    s_barrier
    s_lshl_b32 s96, s76, 6
    s_add_u32 s18, s96, 139264
    v_and_b32 v67, 7, v1
    v_lshl_add_u32 v67, v67, 2, s18
    v_lshrrev_b32 v9, 5, v1
    v_lshl_add_u32 v67, v9, 5, v67
    ds_read_b32 v64, v67
    ds_read_b32 v65, v67 offset:512
    ds_read_b32 v66, v67 offset:640
    ds_read_b32 v68, v67 offset:128
    ds_read_b32 v69, v67 offset:256
    ds_read_b32 v70, v67 offset:384
    ds_read_b32 v71, v67 offset:768
    ds_read_b64_tr_b16 v[128:129], v20
    ds_read_b64_tr_b16 v[130:131], v20 offset:512
    ds_read_b64_tr_b16 v[144:145], v21
    ds_read_b64_tr_b16 v[146:147], v21 offset:512
    ds_read_b64_tr_b16 v[148:149], v21 offset:4096
    ds_read_b64_tr_b16 v[150:151], v21 offset:4608
    ds_read_b64_tr_b16 v[132:133], v20 offset:1024
    ds_read_b64_tr_b16 v[134:135], v20 offset:1536
    ds_read_b64_tr_b16 v[152:153], v21 offset:1024
    ds_read_b64_tr_b16 v[154:155], v21 offset:1536
    ds_read_b64_tr_b16 v[156:157], v21 offset:5120
    ds_read_b64_tr_b16 v[158:159], v21 offset:5632
    ds_read_b64_tr_b16 v[136:137], v20 offset:2048
    ds_read_b64_tr_b16 v[138:139], v20 offset:2560
    ds_read_b64_tr_b16 v[160:161], v21 offset:2048
    ds_read_b64_tr_b16 v[162:163], v21 offset:2560
    ds_read_b64_tr_b16 v[164:165], v21 offset:6144
    ds_read_b64_tr_b16 v[166:167], v21 offset:6656
    s_waitcnt lgkmcnt(12)
    v_mfma_f32_16x16x32_bf16 v[52:55], v[128:131], v[144:147], 0
    v_mfma_f32_16x16x32_bf16 v[56:59], v[128:131], v[148:151], 0
    v_mfma_f32_16x16x32_bf16 v[40:43], v[128:131], v[36:39], 0
    ds_read_b64_tr_b16 v[140:141], v20 offset:3072
    ds_read_b64_tr_b16 v[142:143], v20 offset:3584
    ds_read_b64_tr_b16 v[168:169], v21 offset:3072
    ds_read_b64_tr_b16 v[170:171], v21 offset:3584
    ds_read_b64_tr_b16 v[172:173], v21 offset:7168
    ds_read_b64_tr_b16 v[174:175], v21 offset:7680
    s_waitcnt lgkmcnt(12)
    v_mfma_f32_16x16x32_bf16 v[52:55], v[132:135], v[152:155], v[52:55]
    v_mfma_f32_16x16x32_bf16 v[56:59], v[132:135], v[156:159], v[56:59]
    v_mfma_f32_16x16x32_bf16 v[40:43], v[132:135], v[36:39], v[40:43]
    v_and_b32 v75, 15, v1
    v_lshlrev_b32 v75, 15, v75
    s_and_b32 s96, s10, 1
    s_and_b32 s97, s2, 135
    s_lshl_b32 s98, s97, 12
    s_lshr_b32 s99, s10, 1
    s_lshl_b32 s97, s99, 6
    s_add_u32 s99, s98, s97
    s_lshl2_add_u32 s98, s96, s99
    s_add_u32 s97, s98, 1048576
    s_add_u32 s17, s97, 512
    s_waitcnt lgkmcnt(6)
    v_mfma_f32_16x16x32_bf16 v[52:55], v[136:139], v[160:163], v[52:55]
    v_mfma_f32_16x16x32_bf16 v[56:59], v[136:139], v[164:167], v[56:59]
    v_mfma_f32_16x16x32_bf16 v[40:43], v[136:139], v[36:39], v[40:43]
    s_waitcnt lgkmcnt(0)
    v_mfma_f32_16x16x32_bf16 v[52:55], v[140:143], v[168:171], v[52:55]
    v_mfma_f32_16x16x32_bf16 v[56:59], v[140:143], v[172:175], v[56:59]
    v_mfma_f32_16x16x32_bf16 v[40:43], v[140:143], v[36:39], v[40:43]
    s_cmp_lt_u32 s3, 4
    s_cbranch_scc1 L_NOQX
    ds_read_b128 v[44:47], v76 offset:2048
    ds_read_b128 v[48:51], v76 offset:3072
L_NOQX:
    s_nop 3
    buffer_store_dwordx4 v[52:55], v2, s[32:35], s13 offen sc1
    buffer_store_dwordx4 v[56:59], v2, s[32:35], s15 offen sc1
    s_mov_b32 exec_lo, 0x00010001
    s_mov_b32 exec_hi, 0x00010001
    buffer_store_dwordx4 v[40:43], v1, s[32:35], s14 offen sc1
    s_mov_b64 exec, -1
    s_waitcnt lgkmcnt(0)
    v_mfma_f32_32x32x16_bf16 v[112:127], v[28:31], v[44:47], 0
    v_mfma_f32_32x32x16_bf16 v[112:127], v[32:35], v[48:51], v[112:127]
    v_lshrrev_b32 v22, 3, v1
    v_lshlrev_b32 v22, 10, v22
    v_and_b32 v9, 7, v1
    v_lshl_add_u32 v22, v9, 4, v22
    v_and_b32 v76, 7, v1
    v_lshlrev_b32 v76, 4, v76
    v_lshrrev_b32 v9, 5, v1
    v_lshl_add_u32 v76, v9, 3, v76
    s_nop 3
    v_cvt_pk_bf16_f32 v112, 0, v112
    v_cvt_pk_bf16_f32 v113, 0, v113
    v_cvt_pk_bf16_f32 v114, 0, v114
    v_cvt_pk_bf16_f32 v115, 0, v115
    v_cvt_pk_bf16_f32 v116, 0, v116
    v_cvt_pk_bf16_f32 v117, 0, v117
    v_cvt_pk_bf16_f32 v118, 0, v118
    v_cvt_pk_bf16_f32 v119, 0, v119
    v_cvt_pk_bf16_f32 v120, 0, v120
    v_cvt_pk_bf16_f32 v121, 0, v121
    v_cvt_pk_bf16_f32 v122, 0, v122
    v_cvt_pk_bf16_f32 v123, 0, v123
    v_cvt_pk_bf16_f32 v124, 0, v124
    v_cvt_pk_bf16_f32 v125, 0, v125
    v_cvt_pk_bf16_f32 v126, 0, v126
    v_cvt_pk_bf16_f32 v127, 0, v127
    v_max3_f32 v52, v112, v113, v114
    v_min3_f32 v53, v112, v113, v114
    v_max3_f32 v52, v52, v115, v116
    v_min3_f32 v53, v53, v115, v116
    v_max3_f32 v52, v52, v117, v118
    v_min3_f32 v53, v53, v117, v118
    v_max3_f32 v52, v52, v119, v120
    v_min3_f32 v53, v53, v119, v120
    v_max3_f32 v52, v52, v121, v122
    v_min3_f32 v53, v53, v121, v122
    v_max3_f32 v52, v52, v123, v124
    v_min3_f32 v53, v53, v123, v124
    v_max3_f32 v52, v52, v125, v126
    v_min3_f32 v53, v53, v125, v126
    v_max_f32 v54, v52, v127
    v_min_f32 v55, v53, v127
    v_max_f32 v52, v52, v127
    v_min_f32 v53, v53, v127
    s_nop 0
    v_permlane32_swap_b32 v52, v54
    v_permlane32_swap_b32 v53, v55
    v_max_f32 v52, v52, v54
    v_min_f32 v53, v53, v55
    v_pk_mul_f32 v[52:53], v[52:53], s[6:7] op_sel:[0,1]
    v_pk_fma_f32 v[128:129], v[112:113], s[6:7], v[52:53] op_sel:[0,1,0] op_sel_hi:[1,1,0] neg_lo:[0,0,1] neg_hi:[0,0,1]
    v_pk_fma_f32 v[112:113], v[112:113], s[6:7], v[52:53] op_sel:[0,1,1] neg_lo:[1,0,0] neg_hi:[1,0,0]
    v_pk_fma_f32 v[130:131], v[114:115], s[6:7], v[52:53] op_sel:[0,1,0] op_sel_hi:[1,1,0] neg_lo:[0,0,1] neg_hi:[0,0,1]
    v_pk_fma_f32 v[114:115], v[114:115], s[6:7], v[52:53] op_sel:[0,1,1] neg_lo:[1,0,0] neg_hi:[1,0,0]
    v_pk_fma_f32 v[132:133], v[116:117], s[6:7], v[52:53] op_sel:[0,1,0] op_sel_hi:[1,1,0] neg_lo:[0,0,1] neg_hi:[0,0,1]
    v_pk_fma_f32 v[116:117], v[116:117], s[6:7], v[52:53] op_sel:[0,1,1] neg_lo:[1,0,0] neg_hi:[1,0,0]
    v_pk_fma_f32 v[134:135], v[118:119], s[6:7], v[52:53] op_sel:[0,1,0] op_sel_hi:[1,1,0] neg_lo:[0,0,1] neg_hi:[0,0,1]
    v_pk_fma_f32 v[118:119], v[118:119], s[6:7], v[52:53] op_sel:[0,1,1] neg_lo:[1,0,0] neg_hi:[1,0,0]
    v_pk_fma_f32 v[136:137], v[120:121], s[6:7], v[52:53] op_sel:[0,1,0] op_sel_hi:[1,1,0] neg_lo:[0,0,1] neg_hi:[0,0,1]
    v_pk_fma_f32 v[120:121], v[120:121], s[6:7], v[52:53] op_sel:[0,1,1] neg_lo:[1,0,0] neg_hi:[1,0,0]
    v_pk_fma_f32 v[138:139], v[122:123], s[6:7], v[52:53] op_sel:[0,1,0] op_sel_hi:[1,1,0] neg_lo:[0,0,1] neg_hi:[0,0,1]
    v_pk_fma_f32 v[122:123], v[122:123], s[6:7], v[52:53] op_sel:[0,1,1] neg_lo:[1,0,0] neg_hi:[1,0,0]
    v_pk_fma_f32 v[140:141], v[124:125], s[6:7], v[52:53] op_sel:[0,1,0] op_sel_hi:[1,1,0] neg_lo:[0,0,1] neg_hi:[0,0,1]
    v_pk_fma_f32 v[124:125], v[124:125], s[6:7], v[52:53] op_sel:[0,1,1] neg_lo:[1,0,0] neg_hi:[1,0,0]
    v_pk_fma_f32 v[142:143], v[126:127], s[6:7], v[52:53] op_sel:[0,1,0] op_sel_hi:[1,1,0] neg_lo:[0,0,1] neg_hi:[0,0,1]
    v_pk_fma_f32 v[126:127], v[126:127], s[6:7], v[52:53] op_sel:[0,1,1] neg_lo:[1,0,0] neg_hi:[1,0,0]
    v_exp_f32 v128, v128
    v_exp_f32 v112, v112
    v_exp_f32 v129, v129
    s_lshl_b32 s96, s11, 7
    s_add_u32 s18, s96, 32768
    s_lshl3_add_u32 s14, s10, s18
    v_and_b32 v23, 15, v1
    v_lshlrev_b32 v23, 3, v23
    s_waitcnt vmcnt(0)
    s_barrier
    s_cmp_lg_u32 s3, 0
    s_cbranch_scc1 L_PC
    v_mov_b32 v21, s4
    s_mov_b32 exec_hi, 0
    s_mov_b32 exec_lo, 65535
    buffer_store_dword v21, v75, s[32:35], s17 offen sc1
    s_mov_b64 exec, -1
L_PC:
    buffer_load_dword v67, v3, s[32:35], 0 offen offset:256 sc1
    s_lshl4_add_u32 s96, s11, s10
    s_lshl_b32 s97, s96, 14
    s_lshl_b32 s98, s3, 7
    s_add_u32 s99, s97, s98
    s_add_u32 s13, s99, 25165824
    s_lshl4_add_u32 s96, s11, s10
    s_lshl_b32 s97, s96, 10
    s_lshl_b32 s98, s3, 7
    s_add_u32 s99, s97, s98
    s_add_u32 s15, s99, 29360128
    s_add_u32 s17, s17, 3072
    s_load_dwordx2 s[24:25], s[32:33], s92 offset:512 glc
    s_add_u32 s96, s84, 262144
    s_and_b32 s97, s96, 1048575
    s_lshl_b32 s98, s83, 16
    s_xor_b32 s99, s97, s98
    s_add_u32 s19, s99, s88
    s_add_u32 m0, s89, 49152
    s_nop 0
    buffer_load_dwordx4 v74, s[44:47], s19 offen lds
    v_exp_f32 v113, v113
    v_exp_f32 v130, v130
    v_exp_f32 v114, v114
    v_exp_f32 v131, v131
    v_exp_f32 v115, v115
    v_exp_f32 v132, v132
    v_exp_f32 v116, v116
    v_exp_f32 v133, v133
    v_exp_f32 v117, v117
    v_exp_f32 v134, v134
    s_add_u32 s96, s84, 393216
    s_and_b32 s97, s96, 1048575
    s_lshl_b32 s98, s83, 16
    s_xor_b32 s99, s97, s98
    s_add_u32 s19, s99, s88
    s_add_u32 m0, s89, 57344
    s_nop 0
    buffer_load_dwordx4 v74, s[44:47], s19 offen lds
    v_exp_f32 v118, v118
    v_exp_f32 v135, v135
    v_exp_f32 v119, v119
    v_exp_f32 v136, v136
    v_exp_f32 v120, v120
    v_exp_f32 v137, v137
    v_exp_f32 v121, v121
    v_exp_f32 v138, v138
    v_exp_f32 v122, v122
    s_add_u32 s96, s84, 524288
    s_and_b32 s97, s96, 1048575
    s_lshl_b32 s98, s83, 16
    s_xor_b32 s99, s97, s98
    s_add_u32 s19, s99, s88
    s_add_u32 m0, s89, 65536
    s_nop 0
    buffer_load_dwordx4 v74, s[44:47], s19 offen lds
    v_exp_f32 v139, v139
    v_exp_f32 v123, v123
    v_exp_f32 v140, v140
    v_exp_f32 v124, v124
    v_exp_f32 v141, v141
    v_exp_f32 v125, v125
    v_exp_f32 v142, v142
    v_exp_f32 v126, v126
    v_exp_f32 v143, v143
    v_exp_f32 v127, v127
    s_add_u32 s96, s84, 655360
    s_and_b32 s97, s96, 1048575
    s_lshl_b32 s98, s83, 16
    s_xor_b32 s99, s97, s98
    s_add_u32 s19, s99, s88
    s_add_u32 m0, s89, 73728
    s_nop 0
    buffer_load_dwordx4 v74, s[44:47], s19 offen lds
    v_pk_add_f32 v[56:57], v[128:129], v[130:131]
    v_pk_add_f32 v[58:59], v[112:113], v[114:115]
    v_pk_add_f32 v[56:57], v[56:57], v[132:133]
    v_pk_add_f32 v[58:59], v[58:59], v[116:117]
    v_pk_add_f32 v[56:57], v[56:57], v[134:135]
    v_pk_add_f32 v[58:59], v[58:59], v[118:119]
    v_pk_add_f32 v[56:57], v[56:57], v[136:137]
    v_pk_add_f32 v[58:59], v[58:59], v[120:121]
    v_pk_add_f32 v[56:57], v[56:57], v[138:139]
    s_add_u32 s96, s84, 786432
    s_and_b32 s97, s96, 1048575
    s_lshl_b32 s98, s83, 16
    s_xor_b32 s99, s97, s98
    s_add_u32 s19, s99, s88
    s_add_u32 m0, s89, 81920
    s_nop 0
    buffer_load_dwordx4 v74, s[44:47], s19 offen lds
    v_pk_add_f32 v[58:59], v[58:59], v[122:123]
    v_pk_add_f32 v[56:57], v[56:57], v[140:141]
    v_pk_add_f32 v[58:59], v[58:59], v[124:125]
    v_pk_add_f32 v[56:57], v[56:57], v[142:143]
    v_pk_add_f32 v[58:59], v[58:59], v[126:127]
    v_add_f32 v54, v56, v57
    v_add_f32 v55, v58, v59
    v_add_f32 v52, v56, v57
    v_add_f32 v53, v58, v59
    s_nop 0
    v_permlane32_swap_b32 v52, v54
    s_add_u32 s96, s84, 917504
    s_and_b32 s97, s96, 1048575
    s_lshl_b32 s98, s83, 16
    s_xor_b32 s99, s97, s98
    s_add_u32 s19, s99, s88
    s_add_u32 m0, s89, 90112
    s_nop 0
    buffer_load_dwordx4 v74, s[44:47], s19 offen lds
    v_permlane32_swap_b32 v53, v55
    v_pk_add_f32 v[52:53], v[52:53], v[54:55]
    v_rcp_f32 v52, v52
    v_rcp_f32 v53, v53
    s_nop 0
    v_pk_mul_f32 v[128:129], v[128:129], v[52:53] op_sel_hi:[1,0]
    v_pk_mul_f32 v[112:113], v[112:113], v[52:53] op_sel:[0,1]
    v_pk_mul_f32 v[130:131], v[130:131], v[52:53] op_sel_hi:[1,0]
    v_pk_mul_f32 v[114:115], v[114:115], v[52:53] op_sel:[0,1]
    v_pk_mul_f32 v[132:133], v[132:133], v[52:53] op_sel_hi:[1,0]
    s_branch SCHK_18
SPOLL_17:
    s_load_dwordx2 s[24:25], s[32:33], s92 offset:512 glc
SCHK_18:
    s_add_u32 s5, s5, 1
    s_cmp_ge_u32 s5, 300000
    s_waitcnt lgkmcnt(0)
    s_cbranch_scc1 SDONE_19
    s_cmp_lg_u32 s24, s4
    s_cbranch_scc1 SPOLL_17
    s_cmp_lg_u32 s25, s4
    s_cbranch_scc1 SPOLL_17
SDONE_19:
    s_barrier
    s_add_u32 s18, s13, 8192
    buffer_load_dwordx4 v[144:147], v22, s[32:35], s13 offen sc1
    buffer_load_dwordx4 v[148:151], v22, s[32:35], s18 offen sc1
    buffer_load_dwordx4 v[160:163], v2, s[32:35], s16 offen sc1
    s_lshl_b32 s96, s3, 5
    s_add_u32 s14, s96, 8192
    v_and_b32 v6, 3, v1
    v_lshl_add_u32 v6, v6, 3, s14
    v_lshrrev_b32 v9, 5, v1
    v_lshl_add_u32 v6, v9, 2, v6
    s_lshl_b32 s14, s3, 10
    v_and_b32 v5, 15, v1
    v_lshl_add_u32 v5, v5, 4, s14
    v_lshrrev_b32 v9, 5, v1
    v_lshl_add_u32 v5, v9, 9, v5
    v_bfe_u32 v9, v1, 4, 1
    v_lshl_add_u32 v5, v9, 3, v5
    s_lshl_b32 s96, s76, 7
    s_add_u32 s14, s96, 8192
    v_lshrrev_b32 v7, 5, v1
    v_lshl_add_u32 v7, v7, 4, s14
    s_lshl_b32 s14, s76, 12
    v_add_u32 v20, s14, v2
    v_pk_mul_f32 v[116:117], v[116:117], v[52:53] op_sel:[0,1]
    v_pk_mul_f32 v[134:135], v[134:135], v[52:53] op_sel_hi:[1,0]
    v_pk_mul_f32 v[118:119], v[118:119], v[52:53] op_sel:[0,1]
    v_pk_mul_f32 v[136:137], v[136:137], v[52:53] op_sel_hi:[1,0]
    v_pk_mul_f32 v[120:121], v[120:121], v[52:53] op_sel:[0,1]
    v_pk_mul_f32 v[138:139], v[138:139], v[52:53] op_sel_hi:[1,0]
    v_pk_mul_f32 v[122:123], v[122:123], v[52:53] op_sel:[0,1]
    v_pk_mul_f32 v[140:141], v[140:141], v[52:53] op_sel_hi:[1,0]
    v_pk_mul_f32 v[124:125], v[124:125], v[52:53] op_sel:[0,1]
    v_pk_mul_f32 v[142:143], v[142:143], v[52:53] op_sel_hi:[1,0]
    v_pk_mul_f32 v[126:127], v[126:127], v[52:53] op_sel:[0,1]
    v_cvt_pk_bf16_f32 v80, v128, v129
    v_cvt_pk_bf16_f32 v88, v112, v113
    v_cvt_pk_bf16_f32 v81, v130, v131
    v_cvt_pk_bf16_f32 v89, v114, v115
    v_cvt_pk_bf16_f32 v82, v132, v133
    v_cvt_pk_bf16_f32 v90, v116, v117
    v_cvt_pk_bf16_f32 v83, v134, v135
    v_cvt_pk_bf16_f32 v91, v118, v119
    v_cvt_pk_bf16_f32 v84, v136, v137
    v_cvt_pk_bf16_f32 v92, v120, v121
    v_cvt_pk_bf16_f32 v85, v138, v139
    v_cvt_pk_bf16_f32 v93, v122, v123
    v_cvt_pk_bf16_f32 v86, v140, v141
    v_cvt_pk_bf16_f32 v94, v124, v125
    v_cvt_pk_bf16_f32 v87, v142, v143
    v_cvt_pk_bf16_f32 v95, v126, v127
    s_waitcnt vmcnt(1)
    v_cmp_eq_u32 vcc, s4, v67
    s_nop 0
    s_cmp_eq_u32 vcc_lo, 0
    s_cselect_b32 s93, 1, 0
    v_pk_add_f32 v[144:145], v[144:145], v[148:149]
    v_pk_add_f32 v[146:147], v[146:147], v[150:151]
    s_nop 1
    v_permlane32_swap_b32 v144, v146
    v_permlane32_swap_b32 v145, v147
    v_pk_add_f32 v[144:145], v[144:145], v[146:147]
    s_nop 1
    v_add_f32_dpp v144, v144, v144 row_ror:8 row_mask:0xf bank_mask:0xf
    v_add_f32_dpp v145, v145, v145 row_ror:8 row_mask:0xf bank_mask:0xf
    v_mov_b32 v146, v144
    v_mov_b32 v147, v145
    s_nop 0
    v_permlane16_swap_b32 v144, v146
    v_permlane16_swap_b32 v145, v147
    v_pk_add_f32 v[144:145], v[144:145], v[146:147]
    v_cvt_pk_bf16_f32 v144, v144, v145
    v_mov_b32 v145, s4
    s_mov_b32 exec_lo, 0xff
    s_mov_b32 exec_hi, 0xff
    s_cmp_lg_u32 s93, 0
    s_cbranch_scc1 LOC_20
    buffer_store_dwordx2 v[144:145], v76, s[32:35], s15 offen sc1
    s_branch LOCD_21
LOC_20:
    buffer_store_dwordx2 v[144:145], v76, s[32:35], s15 offen
LOCD_21:
    s_mov_b64 exec, -1
    v_mov_b32 v224, v144
    v_mov_b32 v225, v145
    v_add_u32 v226, s15, v76
    s_cbranch_scc1 L_PC2
    s_barrier
    s_cmp_lg_u32 s3, 0
    s_cbranch_scc1 L_PC2
    v_mov_b32 v21, s4
    s_mov_b32 exec_hi, 0
    s_mov_b32 exec_lo, 65535
    buffer_store_dword v21, v75, s[32:35], s17 offen sc1
    s_mov_b64 exec, -1
L_PC2:
    s_lshl3_add_u32 s96, s11, s3
    s_lshl_b32 s97, s96, 11
    s_add_u32 s13, s97, 29360128
    s_waitcnt vmcnt(0)
    v_permlane32_swap_b32 v160, v162
    v_permlane32_swap_b32 v161, v163
    v_pk_add_f32 v[160:161], v[160:161], v[162:163]
    s_nop 1
    v_add_f32_dpp v160, v160, v160 row_ror:4 row_mask:0xf bank_mask:0xf
    v_add_f32_dpp v161, v161, v161 row_ror:4 row_mask:0xf bank_mask:0xf
    s_nop 0
    v_add_f32_dpp v160, v160, v160 row_ror:8 row_mask:0xf bank_mask:0xf
    v_add_f32_dpp v161, v161, v161 row_ror:8 row_mask:0xf bank_mask:0xf
    v_mov_b32 v162, v160
    v_mov_b32 v163, v161
    s_nop 0
    v_permlane16_swap_b32 v160, v162
    v_permlane16_swap_b32 v161, v163
    v_pk_add_f32 v[160:161], v[160:161], v[162:163]
    v_cvt_pk_bf16_f32 v160, v160, v161
    ds_write_b32 v6, v160
    s_cmp_lg_u32 s93, 0
    s_cbranch_scc1 L_C2L
SPOLL_22:
    s_load_dwordx2 s[24:25], s[32:33], s92 offset:3584 glc
SCHK_23:
    s_add_u32 s5, s5, 1
    s_cmp_ge_u32 s5, 300000
    s_waitcnt lgkmcnt(0)
    s_cbranch_scc1 SDONE_24
    s_cmp_lg_u32 s24, s4
    s_cbranch_scc1 SPOLL_22
    s_cmp_lg_u32 s25, s4
    s_cbranch_scc1 SPOLL_22
SDONE_24:
L_C2L:
    buffer_load_dwordx4 v[152:155], v2, s[32:35], s13 offen sc1
    buffer_load_dwordx4 v[156:159], v2, s[32:35], s13 offen offset:1024 sc1
    s_waitcnt vmcnt(0)
    v_bitop3_b32 v4, v153, v155, s4 bitop3:0x7e
    v_bitop3_b32 v4, v4, v157, s4 bitop3:0xf6
    v_bitop3_b32 v4, v4, v159, s4 bitop3:0xf6
    v_cmp_ne_u32 vcc, 0, v4
    s_cbranch_vccz TOK_26
POLL_27:
    buffer_load_dwordx4 v[152:155], v2, s[32:35], s13 offen sc1
    buffer_load_dwordx4 v[156:159], v2, s[32:35], s13 offen offset:1024 sc1
    s_waitcnt vmcnt(0)
    v_bitop3_b32 v4, v153, v155, s4 bitop3:0x7e
    v_bitop3_b32 v4, v4, v157, s4 bitop3:0xf6
    v_bitop3_b32 v4, v4, v159, s4 bitop3:0xf6
    v_cmp_ne_u32 vcc, 0, v4
    s_cbranch_vccz PDONE_28
    s_add_u32 s5, s5, 1
    s_cmp_lt_u32 s5, 300000
    s_cbranch_scc1 POLL_27
PDONE_28:
TOK_26:
    ds_write2_b32 v5, v152, v154 offset0:0 offset1:1
    ds_write2_b32 v5, v156, v158 offset0:64 offset1:65
    s_waitcnt lgkmcnt(0)
    s_barrier
    ds_read_b128 v[160:163], v7
    ds_read_b128 v[164:167], v7 offset:32
    ds_read_b128 v[168:171], v7 offset:64
    ds_read_b128 v[172:175], v7 offset:96
    ds_read_b128 v[144:147], v20
    ds_read_b128 v[148:151], v20 offset:1024
    ds_read_b128 v[152:155], v20 offset:2048
    ds_read_b128 v[156:159], v20 offset:3072
    s_add_u32 s96, s84, 1048576
    s_and_b32 s97, s96, 1048575
    s_lshl_b32 s98, s83, 16
    s_xor_b32 s99, s97, s98
    s_xor_b32 s96, s88, 1048576
    s_add_u32 s19, s99, s96
    s_add_u32 m0, s89, 98304
    s_nop 0
    buffer_load_dwordx4 v74, s[44:47], s19 offen lds
    s_add_u32 s96, s84, 1703936
    s_and_b32 s97, s96, 1048575
    s_lshl_b32 s98, s83, 16
    s_xor_b32 s99, s97, s98
    s_xor_b32 s96, s88, 1048576
    s_add_u32 s19, s99, s96
    s_add_u32 m0, s89, 139264
    s_nop 0
    buffer_load_dwordx4 v74, s[44:47], s19 offen lds
    s_add_u32 s96, s84, 1835008
    s_and_b32 s97, s96, 1048575
    s_lshl_b32 s98, s83, 16
    s_xor_b32 s99, s97, s98
    s_xor_b32 s96, s88, 1048576
    s_add_u32 s19, s99, s96
    s_add_u32 m0, s89, 147456
    s_nop 0
    buffer_load_dwordx4 v74, s[44:47], s19 offen lds
    s_and_b32 s96, s3, 3
    s_lshl2_add_u32 s97, s10, s96
    s_lshl4_add_u32 s98, s97, s11
    s_lshl1_add_u32 s99, s98, s76
    s_lshl_b32 s96, s99, 11
    s_add_u32 s13, s96, 8388608
    v_and_b32 v8, 15, v1
    v_lshlrev_b32 v8, 4, v8
    v_bfe_u32 v9, v1, 4, 1
    v_lshl_add_u32 v8, v9, 10, v8
    v_lshrrev_b32 v9, 5, v1
    v_lshl_add_u32 v8, v9, 8, v8
    s_waitcnt lgkmcnt(7)
    v_mfma_f32_32x32x16_bf16 v[128:143], v[160:163], v[80:83], 0
    s_waitcnt lgkmcnt(6)
    v_mfma_f32_32x32x16_bf16 v[128:143], v[164:167], v[84:87], v[128:143]
    s_waitcnt lgkmcnt(5)
    v_mfma_f32_32x32x16_bf16 v[128:143], v[168:171], v[88:91], v[128:143]
    s_waitcnt lgkmcnt(4)
    v_mfma_f32_32x32x16_bf16 v[128:143], v[172:175], v[92:95], v[128:143]
    s_waitcnt lgkmcnt(3)
    v_mfma_f32_32x32x16_bf16 v[112:127], v[144:147], v[80:83], 0
    s_waitcnt lgkmcnt(2)
    v_mfma_f32_32x32x16_bf16 v[112:127], v[148:151], v[84:87], v[112:127]
    s_waitcnt lgkmcnt(1)
    v_mfma_f32_32x32x16_bf16 v[112:127], v[152:155], v[88:91], v[112:127]
    s_waitcnt lgkmcnt(0)
    v_mfma_f32_32x32x16_bf16 v[112:127], v[156:159], v[92:95], v[112:127]
    s_nop 3
    v_cvt_pk_bf16_f32 v128, 0, v128
    v_add_f32 v128, 0x358637bd, v128
    v_cvt_pk_bf16_f32 v128, 0, v128
    v_rcp_f32 v128, v128
    s_nop 3
    v_cvt_pk_bf16_f32 v112, 0, v112
    v_cvt_pk_bf16_f32 v113, 0, v113
    v_cvt_pk_bf16_f32 v114, 0, v114
    v_cvt_pk_bf16_f32 v115, 0, v115
    v_cvt_pk_bf16_f32 v116, 0, v116
    v_cvt_pk_bf16_f32 v117, 0, v117
    v_cvt_pk_bf16_f32 v118, 0, v118
    v_cvt_pk_bf16_f32 v119, 0, v119
    v_pk_mul_f32 v[112:113], v[112:113], v[128:129] op_sel_hi:[1,0]
    v_pk_mul_f32 v[114:115], v[114:115], v[128:129] op_sel_hi:[1,0]
    v_pk_mul_f32 v[116:117], v[116:117], v[128:129] op_sel_hi:[1,0]
    v_pk_mul_f32 v[118:119], v[118:119], v[128:129] op_sel_hi:[1,0]
    v_cvt_pk_bf16_f32 v44, v112, v113
    v_cvt_pk_bf16_f32 v45, v114, v115
    v_cvt_pk_bf16_f32 v46, v116, v117
    v_cvt_pk_bf16_f32 v47, v118, v119
    buffer_store_dwordx4 v[44:47], v8, s[32:35], s13 offen sc1
    v_cvt_pk_bf16_f32 v120, 0, v120
    v_cvt_pk_bf16_f32 v121, 0, v121
    v_cvt_pk_bf16_f32 v122, 0, v122
    v_cvt_pk_bf16_f32 v123, 0, v123
    v_cvt_pk_bf16_f32 v124, 0, v124
    v_cvt_pk_bf16_f32 v125, 0, v125
    v_cvt_pk_bf16_f32 v126, 0, v126
    v_cvt_pk_bf16_f32 v127, 0, v127
    v_pk_mul_f32 v[120:121], v[120:121], v[128:129] op_sel_hi:[1,0]
    v_pk_mul_f32 v[122:123], v[122:123], v[128:129] op_sel_hi:[1,0]
    v_pk_mul_f32 v[124:125], v[124:125], v[128:129] op_sel_hi:[1,0]
    v_pk_mul_f32 v[126:127], v[126:127], v[128:129] op_sel_hi:[1,0]
    v_cvt_pk_bf16_f32 v48, v120, v121
    v_cvt_pk_bf16_f32 v49, v122, v123
    v_cvt_pk_bf16_f32 v50, v124, v125
    v_cvt_pk_bf16_f32 v51, v126, v127
    buffer_store_dwordx4 v[48:51], v8, s[32:35], s13 offen offset:512 sc1
    s_mul_i32 s96, s76, 65600
    s_add_u32 s17, s96, 32768
    v_lshrrev_b32 v20, 5, v1
    v_lshlrev_b32 v20, 11, v20
    v_bfe_u32 v9, v1, 4, 1
    v_lshl_add_u32 v20, v9, 9, v20
    v_bfe_u32 v9, v1, 2, 2
    v_lshl_add_u32 v20, v9, 7, v20
    v_bfe_u32 v9, v1, 3, 1
    v_lshl_add_u32 v20, v9, 6, v20
    v_bfe_u32 v9, v1, 1, 1
    v_lshl_add_u32 v20, v9, 5, v20
    v_bfe_u32 v9, v1, 4, 1
    v_lshl_add_u32 v20, v9, 4, v20
    v_and_b32 v9, 1, v1
    v_lshl_add_u32 v20, v9, 3, v20
    v_xor_b32 v20, s17, v20
    v_xor_b32 v21, 16, v20
    v_xor_b32 v22, 64, v20
    v_xor_b32 v23, 80, v20
    v_and_b32 v5, 7, v1
    v_lshlrev_b32 v5, 15, v5
    v_bfe_u32 v9, v1, 3, 1
    v_lshl_add_u32 v5, v9, 12, v5
    s_lshr_b32 s96, s11, 2
    s_xor_b32 s97, s96, 1
    s_and_b32 s98, s97, 1
    s_lshr_b32 s99, s10, 2
    s_and_b32 s96, s10, 3
    s_lshl_b32 s97, s96, 6
    s_lshl1_add_u32 s96, s99, s97
    s_lshl_b32 s99, s96, 12
    s_lshr_b32 s97, s11, 3
    s_and_b32 s96, s11, 3
    s_lshl2_add_u32 s97, s97, s96
    s_lshl_b32 s96, s97, 6
    s_add_u32 s97, s99, s96
    s_lshl2_add_u32 s99, s98, s97
    s_add_u32 s96, s99, 1048576
    s_add_u32 s15, s96, 1024
    v_mov_b32 v52, 0x10000
    v_mov_b32 v53, s6
    v_lshlrev_b32 v28, 16, v12
    v_and_b32 v29, s6, v12
    v_lshlrev_b32 v30, 16, v13
    v_and_b32 v31, s6, v13
    v_lshlrev_b32 v32, 16, v14
    v_and_b32 v33, s6, v14
    v_lshlrev_b32 v34, 16, v15
    v_and_b32 v35, s6, v15
    v_lshlrev_b32 v36, 16, v16
    v_and_b32 v37, s6, v16
    v_lshlrev_b32 v38, 16, v17
    v_and_b32 v39, s6, v17
    v_lshlrev_b32 v40, 16, v18
    v_and_b32 v41, s6, v18
    v_lshlrev_b32 v42, 16, v19
    v_and_b32 v43, s6, v19
    v_mul_u32_u24_dpp v76, v64, v52 row_newbcast:0 row_mask:0xf bank_mask:0xf
    v_and_b32_dpp v77, v64, v53 row_newbcast:0 row_mask:0xf bank_mask:0xf
    v_mul_u32_u24_dpp v78, v64, v52 row_newbcast:1 row_mask:0xf bank_mask:0xf
    v_and_b32_dpp v79, v64, v53 row_newbcast:1 row_mask:0xf bank_mask:0xf
    v_mul_u32_u24_dpp v80, v64, v52 row_newbcast:2 row_mask:0xf bank_mask:0xf
    v_and_b32_dpp v81, v64, v53 row_newbcast:2 row_mask:0xf bank_mask:0xf
    v_mul_u32_u24_dpp v82, v64, v52 row_newbcast:3 row_mask:0xf bank_mask:0xf
    v_and_b32_dpp v83, v64, v53 row_newbcast:3 row_mask:0xf bank_mask:0xf
    v_mul_u32_u24_dpp v84, v64, v52 row_newbcast:4 row_mask:0xf bank_mask:0xf
    v_and_b32_dpp v85, v64, v53 row_newbcast:4 row_mask:0xf bank_mask:0xf
    v_mul_u32_u24_dpp v86, v64, v52 row_newbcast:5 row_mask:0xf bank_mask:0xf
    v_and_b32_dpp v87, v64, v53 row_newbcast:5 row_mask:0xf bank_mask:0xf
    v_mul_u32_u24_dpp v88, v64, v52 row_newbcast:6 row_mask:0xf bank_mask:0xf
    v_and_b32_dpp v89, v64, v53 row_newbcast:6 row_mask:0xf bank_mask:0xf
    v_mul_u32_u24_dpp v90, v64, v52 row_newbcast:7 row_mask:0xf bank_mask:0xf
    v_and_b32_dpp v91, v64, v53 row_newbcast:7 row_mask:0xf bank_mask:0xf
    s_lshl1_add_u32 s96, s94, s77
    s_lshl_b32 s97, s96, 15
    s_add_u32 s19, s97, 8388608
    v_and_b32 v25, 15, v1
    v_lshlrev_b32 v25, 3, v25
    s_waitcnt vmcnt(0)
    s_waitcnt lgkmcnt(0)
    s_barrier
    s_cmp_lg_u32 s3, 0
    s_cbranch_scc1 L_PD
    v_mov_b32 v6, s4
    s_mov_b32 exec_hi, 0
    s_mov_b32 exec_lo, 65535
    buffer_store_dword v6, v5, s[32:35], s15 offen sc1
    s_mov_b64 exec, -1
L_PD:
    s_add_u32 s96, s84, 1966080
    s_and_b32 s97, s96, 1048575
    s_lshl_b32 s98, s83, 16
    s_xor_b32 s99, s97, s98
    s_xor_b32 s96, s88, 1048576
    s_add_u32 s13, s99, s96
    s_add_u32 m0, s89, 155648
    s_nop 0
    buffer_load_dwordx4 v74, s[44:47], s13 offen lds
    s_and_b32 s96, s84, 1048575
    s_lshl_b32 s97, s83, 16
    s_xor_b32 s98, s96, s97
    s_add_u32 s13, s98, s88
    s_add_u32 m0, s89, 32768
    s_nop 0
    buffer_load_dwordx4 v74, s[44:47], s13 offen lds
    s_add_u32 s96, s84, 131072
    s_and_b32 s97, s96, 1048575
    s_lshl_b32 s98, s83, 16
    s_xor_b32 s99, s97, s98
    s_add_u32 s13, s99, s88
    s_add_u32 m0, s89, 40960
    s_nop 0
    buffer_load_dwordx4 v74, s[44:47], s13 offen lds
    s_load_dwordx2 s[24:25], s[32:33], s92 offset:1024 glc
    v_mov_b32_dpp v92, v65 row_newbcast:0 row_mask:0xf bank_mask:0xf
    v_mov_b32_dpp v93, v65 row_newbcast:1 row_mask:0xf bank_mask:0xf
    v_mov_b32_dpp v94, v65 row_newbcast:2 row_mask:0xf bank_mask:0xf
    v_mov_b32_dpp v95, v65 row_newbcast:3 row_mask:0xf bank_mask:0xf
    v_mov_b32_dpp v96, v65 row_newbcast:4 row_mask:0xf bank_mask:0xf
    v_mov_b32_dpp v97, v65 row_newbcast:5 row_mask:0xf bank_mask:0xf
    v_mov_b32_dpp v98, v65 row_newbcast:6 row_mask:0xf bank_mask:0xf
    v_mov_b32_dpp v99, v65 row_newbcast:7 row_mask:0xf bank_mask:0xf
    v_mov_b32_dpp v100, v66 row_newbcast:0 row_mask:0xf bank_mask:0xf
    v_mov_b32_dpp v101, v66 row_newbcast:1 row_mask:0xf bank_mask:0xf
    v_mov_b32_dpp v102, v66 row_newbcast:2 row_mask:0xf bank_mask:0xf
    v_mov_b32_dpp v103, v66 row_newbcast:3 row_mask:0xf bank_mask:0xf
    v_mov_b32_dpp v104, v66 row_newbcast:4 row_mask:0xf bank_mask:0xf
    v_mov_b32_dpp v105, v66 row_newbcast:5 row_mask:0xf bank_mask:0xf
    v_mov_b32_dpp v106, v66 row_newbcast:6 row_mask:0xf bank_mask:0xf
    v_mov_b32_dpp v107, v66 row_newbcast:7 row_mask:0xf bank_mask:0xf
    v_and_b32 v4, 3, v1
    v_cmp_eq_u32 vcc, 1, v4
    v_cmp_eq_u32 s[22:23], 0, v4
    v_mov_b32 v5, 0x3f803f80
    v_cndmask_b32 v92, v100, v92, vcc
    v_cndmask_b32 v93, v101, v93, vcc
    v_cndmask_b32 v94, v102, v94, vcc
    v_cndmask_b32 v95, v103, v95, vcc
    v_cndmask_b32 v96, v104, v96, vcc
    v_cndmask_b32 v97, v105, v97, vcc
    v_cndmask_b32 v98, v106, v98, vcc
    v_cndmask_b32 v99, v107, v99, vcc
    v_cndmask_b32 v92, v92, v5, s[22:23]
    v_cndmask_b32 v93, v93, v5, s[22:23]
    v_cndmask_b32 v94, v94, v5, s[22:23]
    v_cndmask_b32 v95, v95, v5, s[22:23]
    v_cndmask_b32 v96, v96, v5, s[22:23]
    v_cndmask_b32 v97, v97, v5, s[22:23]
    v_cndmask_b32 v98, v98, v5, s[22:23]
    v_cndmask_b32 v99, v99, v5, s[22:23]
    s_waitcnt vmcnt(0)
    s_branch SCHK_30
SPOLL_29:
    s_load_dwordx2 s[24:25], s[32:33], s92 offset:1024 glc
SCHK_30:
    s_add_u32 s5, s5, 1
    s_cmp_ge_u32 s5, 300000
    s_waitcnt lgkmcnt(0)
    s_cbranch_scc1 SDONE_31
    s_cmp_lg_u32 s24, s4
    s_cbranch_scc1 SPOLL_29
SDONE_31:
    s_barrier
    s_cmp_lt_u32 s3, 4
    s_cbranch_scc1 L_P2
    s_setprio 1
L_P2:
    s_lshl_b32 s96, s21, 7
    s_add_u32 s18, s96, 65536
    s_lshl_b32 s96, s83, 11
    s_add_u32 s20, s96, s19
    buffer_load_dwordx4 v[140:143], v2, s[32:35], s20 offen sc1
    buffer_load_dwordx4 v[144:147], v2, s[32:35], s20 offen offset:1024 sc1
    ds_read_b64_tr_b16 v[228:229], v22
    ds_read_b64_tr_b16 v[230:231], v22 offset:1024
    ds_read_b64_tr_b16 v[232:233], v23
    ds_read_b64_tr_b16 v[234:235], v23 offset:1024
    ds_read_b64_tr_b16 v[236:237], v20
    ds_read_b64_tr_b16 v[238:239], v20 offset:1024
    ds_read_b64_tr_b16 v[240:241], v21
    ds_read_b64_tr_b16 v[242:243], v21 offset:1024
    s_xor_b32 s96, s83, 1
    s_lshl_b32 s97, s96, 11
    s_add_u32 s20, s97, s19
    buffer_load_dwordx4 v[148:151], v2, s[32:35], s20 offen sc1
    buffer_load_dwordx4 v[152:155], v2, s[32:35], s20 offen offset:1024 sc1
    s_xor_b32 s96, s83, 2
    s_lshl_b32 s97, s96, 11
    s_add_u32 s20, s97, s19
    buffer_load_dwordx4 v[156:159], v2, s[32:35], s20 offen sc1
    buffer_load_dwordx4 v[160:163], v2, s[32:35], s20 offen offset:1024 sc1
    s_waitcnt lgkmcnt(6)
    s_waitcnt vmcnt(5)
    v_mfma_f32_16x16x32_bf16 v[124:127], v[228:231], v[140:143], 0
    ds_read_b64_tr_b16 v[244:245], v22 offset:4096
    s_waitcnt vmcnt(4)
    v_mfma_f32_16x16x32_bf16 v[128:131], v[228:231], v[144:147], 0
    ds_read_b64_tr_b16 v[246:247], v22 offset:5120
    s_xor_b32 s96, s83, 3
    s_lshl_b32 s97, s96, 11
    s_add_u32 s20, s97, s19
    buffer_load_dwordx4 v[164:167], v2, s[32:35], s20 offen sc1
    s_waitcnt lgkmcnt(6)
    v_mfma_f32_16x16x32_bf16 v[132:135], v[232:235], v[140:143], 0
    ds_read_b64_tr_b16 v[228:229], v23 offset:4096
    v_mfma_f32_16x16x32_bf16 v[136:139], v[232:235], v[144:147], 0
    ds_read_b64_tr_b16 v[230:231], v23 offset:5120
    buffer_load_dwordx4 v[168:171], v2, s[32:35], s20 offen offset:1024 sc1
    s_waitcnt lgkmcnt(6)
    v_mfma_f32_16x16x32_bf16 v[108:111], v[236:239], v[140:143], 0
    ds_read_b64_tr_b16 v[232:233], v20 offset:4096
    v_mfma_f32_16x16x32_bf16 v[112:115], v[236:239], v[144:147], 0
    ds_read_b64_tr_b16 v[234:235], v20 offset:5120
    s_waitcnt lgkmcnt(6)
    v_mfma_f32_16x16x32_bf16 v[116:119], v[240:243], v[140:143], 0
    ds_read_b64_tr_b16 v[236:237], v21 offset:4096
    v_mfma_f32_16x16x32_bf16 v[120:123], v[240:243], v[144:147], 0
    ds_read_b64_tr_b16 v[238:239], v21 offset:5120
    s_waitcnt lgkmcnt(6)
    s_waitcnt vmcnt(4)
    v_mfma_f32_16x16x32_bf16 v[124:127], v[244:247], v[148:151], v[124:127]
    ds_read_b64_tr_b16 v[240:241], v22 offset:8192
    v_mfma_f32_16x16x32_bf16 v[128:131], v[244:247], v[152:155], v[128:131]
    ds_read_b64_tr_b16 v[242:243], v22 offset:9216
    s_xor_b32 s96, s83, 4
    s_lshl_b32 s97, s96, 11
    s_add_u32 s20, s97, s19
    buffer_load_dwordx4 v[140:143], v2, s[32:35], s20 offen sc1
    s_waitcnt lgkmcnt(6)
    v_mfma_f32_16x16x32_bf16 v[132:135], v[228:231], v[148:151], v[132:135]
    ds_read_b64_tr_b16 v[244:245], v23 offset:8192
    v_mfma_f32_16x16x32_bf16 v[136:139], v[228:231], v[152:155], v[136:139]
    ds_read_b64_tr_b16 v[246:247], v23 offset:9216
    buffer_load_dwordx4 v[144:147], v2, s[32:35], s20 offen offset:1024 sc1
    s_waitcnt lgkmcnt(6)
    v_mfma_f32_16x16x32_bf16 v[108:111], v[232:235], v[148:151], v[108:111]
    ds_read_b64_tr_b16 v[228:229], v20 offset:8192
    v_mfma_f32_16x16x32_bf16 v[112:115], v[232:235], v[152:155], v[112:115]
    ds_read_b64_tr_b16 v[230:231], v20 offset:9216
    s_waitcnt lgkmcnt(6)
    v_mfma_f32_16x16x32_bf16 v[116:119], v[236:239], v[148:151], v[116:119]
    ds_read_b64_tr_b16 v[232:233], v21 offset:8192
    v_mfma_f32_16x16x32_bf16 v[120:123], v[236:239], v[152:155], v[120:123]
    ds_read_b64_tr_b16 v[234:235], v21 offset:9216
    s_waitcnt lgkmcnt(6)
    s_waitcnt vmcnt(4)
    v_mfma_f32_16x16x32_bf16 v[124:127], v[240:243], v[156:159], v[124:127]
    ds_read_b64_tr_b16 v[236:237], v22 offset:12288
    v_mfma_f32_16x16x32_bf16 v[128:131], v[240:243], v[160:163], v[128:131]
    ds_read_b64_tr_b16 v[238:239], v22 offset:13312
    s_xor_b32 s96, s83, 5
    s_lshl_b32 s97, s96, 11
    s_add_u32 s20, s97, s19
    buffer_load_dwordx4 v[148:151], v2, s[32:35], s20 offen sc1
    s_waitcnt lgkmcnt(6)
    v_mfma_f32_16x16x32_bf16 v[132:135], v[244:247], v[156:159], v[132:135]
    ds_read_b64_tr_b16 v[240:241], v23 offset:12288
    v_mfma_f32_16x16x32_bf16 v[136:139], v[244:247], v[160:163], v[136:139]
    ds_read_b64_tr_b16 v[242:243], v23 offset:13312
    buffer_load_dwordx4 v[152:155], v2, s[32:35], s20 offen offset:1024 sc1
    s_waitcnt lgkmcnt(6)
    v_mfma_f32_16x16x32_bf16 v[108:111], v[228:231], v[156:159], v[108:111]
    ds_read_b64_tr_b16 v[244:245], v20 offset:12288
    v_mfma_f32_16x16x32_bf16 v[112:115], v[228:231], v[160:163], v[112:115]
    ds_read_b64_tr_b16 v[246:247], v20 offset:13312
    s_waitcnt lgkmcnt(6)
    v_mfma_f32_16x16x32_bf16 v[116:119], v[232:235], v[156:159], v[116:119]
    ds_read_b64_tr_b16 v[228:229], v21 offset:12288
    v_mfma_f32_16x16x32_bf16 v[120:123], v[232:235], v[160:163], v[120:123]
    ds_read_b64_tr_b16 v[230:231], v21 offset:13312
    s_waitcnt lgkmcnt(6)
    s_waitcnt vmcnt(4)
    v_mfma_f32_16x16x32_bf16 v[124:127], v[236:239], v[164:167], v[124:127]
    ds_read_b64_tr_b16 v[232:233], v22 offset:16384
    v_mfma_f32_16x16x32_bf16 v[128:131], v[236:239], v[168:171], v[128:131]
    ds_read_b64_tr_b16 v[234:235], v22 offset:17408
    s_xor_b32 s96, s83, 6
    s_lshl_b32 s97, s96, 11
    s_add_u32 s20, s97, s19
    buffer_load_dwordx4 v[156:159], v2, s[32:35], s20 offen sc1
    s_waitcnt lgkmcnt(6)
    v_mfma_f32_16x16x32_bf16 v[132:135], v[240:243], v[164:167], v[132:135]
    ds_read_b64_tr_b16 v[236:237], v23 offset:16384
    v_mfma_f32_16x16x32_bf16 v[136:139], v[240:243], v[168:171], v[136:139]
    ds_read_b64_tr_b16 v[238:239], v23 offset:17408
    buffer_load_dwordx4 v[160:163], v2, s[32:35], s20 offen offset:1024 sc1
    s_waitcnt lgkmcnt(6)
    v_mfma_f32_16x16x32_bf16 v[108:111], v[244:247], v[164:167], v[108:111]
    ds_read_b64_tr_b16 v[240:241], v20 offset:16384
    v_mfma_f32_16x16x32_bf16 v[112:115], v[244:247], v[168:171], v[112:115]
    ds_read_b64_tr_b16 v[242:243], v20 offset:17408
    s_waitcnt lgkmcnt(6)
    v_mfma_f32_16x16x32_bf16 v[116:119], v[228:231], v[164:167], v[116:119]
    ds_read_b64_tr_b16 v[244:245], v21 offset:16384
    v_mfma_f32_16x16x32_bf16 v[120:123], v[228:231], v[168:171], v[120:123]
    ds_read_b64_tr_b16 v[246:247], v21 offset:17408
    s_waitcnt lgkmcnt(6)
    s_waitcnt vmcnt(4)
    v_mfma_f32_16x16x32_bf16 v[124:127], v[232:235], v[140:143], v[124:127]
    ds_read_b64_tr_b16 v[228:229], v22 offset:20480
    v_mfma_f32_16x16x32_bf16 v[128:131], v[232:235], v[144:147], v[128:131]
    ds_read_b64_tr_b16 v[230:231], v22 offset:21504
    s_xor_b32 s96, s83, 7
    s_lshl_b32 s97, s96, 11
    s_add_u32 s20, s97, s19
    buffer_load_dwordx4 v[164:167], v2, s[32:35], s20 offen sc1
    s_waitcnt lgkmcnt(6)
    v_mfma_f32_16x16x32_bf16 v[132:135], v[236:239], v[140:143], v[132:135]
    ds_read_b64_tr_b16 v[232:233], v23 offset:20480
    v_mfma_f32_16x16x32_bf16 v[136:139], v[236:239], v[144:147], v[136:139]
    ds_read_b64_tr_b16 v[234:235], v23 offset:21504
    buffer_load_dwordx4 v[168:171], v2, s[32:35], s20 offen offset:1024 sc1
    s_waitcnt lgkmcnt(6)
    v_mfma_f32_16x16x32_bf16 v[108:111], v[240:243], v[140:143], v[108:111]
    ds_read_b64_tr_b16 v[236:237], v20 offset:20480
    v_mfma_f32_16x16x32_bf16 v[112:115], v[240:243], v[144:147], v[112:115]
    ds_read_b64_tr_b16 v[238:239], v20 offset:21504
    s_setprio 0
    s_waitcnt lgkmcnt(6)
    v_mfma_f32_16x16x32_bf16 v[116:119], v[244:247], v[140:143], v[116:119]
    ds_read_b64_tr_b16 v[240:241], v21 offset:20480
    v_mfma_f32_16x16x32_bf16 v[120:123], v[244:247], v[144:147], v[120:123]
    ds_read_b64_tr_b16 v[242:243], v21 offset:21504
    s_waitcnt lgkmcnt(6)
    s_waitcnt vmcnt(4)
    v_mfma_f32_16x16x32_bf16 v[124:127], v[228:231], v[148:151], v[124:127]
    ds_read_b64_tr_b16 v[244:245], v22 offset:24576
    v_mfma_f32_16x16x32_bf16 v[128:131], v[228:231], v[152:155], v[128:131]
    ds_read_b64_tr_b16 v[246:247], v22 offset:25600
    s_cmp_eq_u32 s25, s4
    s_cbranch_scc1 L_D2
SPOLL_32:
    s_load_dwordx2 s[24:25], s[32:33], s92 offset:1024 glc
SCHK_33:
    s_add_u32 s5, s5, 1
    s_cmp_ge_u32 s5, 300000
    s_waitcnt lgkmcnt(0)
    s_cbranch_scc1 SDONE_34
    s_cmp_lg_u32 s25, s4
    s_cbranch_scc1 SPOLL_32
SDONE_34:
L_D2:
    s_barrier
    s_xor_b32 s96, s83, 8
    s_lshl_b32 s97, s96, 11
    s_add_u32 s20, s97, s19
    buffer_load_dwordx4 v[140:143], v2, s[32:35], s20 offen sc1
    s_waitcnt lgkmcnt(6)
    v_mfma_f32_16x16x32_bf16 v[132:135], v[232:235], v[148:151], v[132:135]
    ds_read_b64_tr_b16 v[228:229], v23 offset:24576
    v_mfma_f32_16x16x32_bf16 v[136:139], v[232:235], v[152:155], v[136:139]
    ds_read_b64_tr_b16 v[230:231], v23 offset:25600
    buffer_load_dwordx4 v[144:147], v2, s[32:35], s20 offen offset:1024 sc1
    s_waitcnt lgkmcnt(6)
    v_mfma_f32_16x16x32_bf16 v[108:111], v[236:239], v[148:151], v[108:111]
    ds_read_b64_tr_b16 v[232:233], v20 offset:24576
    v_mfma_f32_16x16x32_bf16 v[112:115], v[236:239], v[152:155], v[112:115]
    ds_read_b64_tr_b16 v[234:235], v20 offset:25600
    s_waitcnt lgkmcnt(6)
    v_mfma_f32_16x16x32_bf16 v[116:119], v[240:243], v[148:151], v[116:119]
    ds_read_b64_tr_b16 v[236:237], v21 offset:24576
    v_mfma_f32_16x16x32_bf16 v[120:123], v[240:243], v[152:155], v[120:123]
    ds_read_b64_tr_b16 v[238:239], v21 offset:25600
    s_waitcnt lgkmcnt(6)
    s_waitcnt vmcnt(4)
    v_mfma_f32_16x16x32_bf16 v[124:127], v[244:247], v[156:159], v[124:127]
    ds_read_b64_tr_b16 v[240:241], v22 offset:28672
    v_mfma_f32_16x16x32_bf16 v[128:131], v[244:247], v[160:163], v[128:131]
    ds_read_b64_tr_b16 v[242:243], v22 offset:29696
    s_xor_b32 s96, s83, 9
    s_lshl_b32 s97, s96, 11
    s_add_u32 s20, s97, s19
    buffer_load_dwordx4 v[148:151], v2, s[32:35], s20 offen sc1
    s_waitcnt lgkmcnt(6)
    v_mfma_f32_16x16x32_bf16 v[132:135], v[228:231], v[156:159], v[132:135]
    ds_read_b64_tr_b16 v[244:245], v23 offset:28672
    v_mfma_f32_16x16x32_bf16 v[136:139], v[228:231], v[160:163], v[136:139]
    ds_read_b64_tr_b16 v[246:247], v23 offset:29696
    buffer_load_dwordx4 v[152:155], v2, s[32:35], s20 offen offset:1024 sc1
    s_waitcnt lgkmcnt(6)
    v_mfma_f32_16x16x32_bf16 v[108:111], v[232:235], v[156:159], v[108:111]
    ds_read_b64_tr_b16 v[228:229], v20 offset:28672
    v_mfma_f32_16x16x32_bf16 v[112:115], v[232:235], v[160:163], v[112:115]
    ds_read_b64_tr_b16 v[230:231], v20 offset:29696
    s_waitcnt lgkmcnt(6)
    v_mfma_f32_16x16x32_bf16 v[116:119], v[236:239], v[156:159], v[116:119]
    ds_read_b64_tr_b16 v[232:233], v21 offset:28672
    v_mfma_f32_16x16x32_bf16 v[120:123], v[236:239], v[160:163], v[120:123]
    ds_read_b64_tr_b16 v[234:235], v21 offset:29696
    s_waitcnt lgkmcnt(6)
    s_waitcnt vmcnt(4)
    v_mfma_f32_16x16x32_bf16 v[124:127], v[240:243], v[164:167], v[124:127]
    ds_read_b64_tr_b16 v[236:237], v22 offset:32768
    v_mfma_f32_16x16x32_bf16 v[128:131], v[240:243], v[168:171], v[128:131]
    ds_read_b64_tr_b16 v[238:239], v22 offset:33792
    s_xor_b32 s96, s83, 10
    s_lshl_b32 s97, s96, 11
    s_add_u32 s20, s97, s19
    buffer_load_dwordx4 v[156:159], v2, s[32:35], s20 offen sc1
    s_waitcnt lgkmcnt(6)
    v_mfma_f32_16x16x32_bf16 v[132:135], v[244:247], v[164:167], v[132:135]
    ds_read_b64_tr_b16 v[240:241], v23 offset:32768
    v_mfma_f32_16x16x32_bf16 v[136:139], v[244:247], v[168:171], v[136:139]
    ds_read_b64_tr_b16 v[242:243], v23 offset:33792
    buffer_load_dwordx4 v[160:163], v2, s[32:35], s20 offen offset:1024 sc1
    s_waitcnt lgkmcnt(6)
    v_mfma_f32_16x16x32_bf16 v[108:111], v[228:231], v[164:167], v[108:111]
    ds_read_b64_tr_b16 v[244:245], v20 offset:32768
    v_mfma_f32_16x16x32_bf16 v[112:115], v[228:231], v[168:171], v[112:115]
    ds_read_b64_tr_b16 v[246:247], v20 offset:33792
    s_waitcnt lgkmcnt(6)
    v_mfma_f32_16x16x32_bf16 v[116:119], v[232:235], v[164:167], v[116:119]
    ds_read_b64_tr_b16 v[228:229], v21 offset:32768
    v_mfma_f32_16x16x32_bf16 v[120:123], v[232:235], v[168:171], v[120:123]
    ds_read_b64_tr_b16 v[230:231], v21 offset:33792
    s_waitcnt lgkmcnt(6)
    s_waitcnt vmcnt(4)
    v_mfma_f32_16x16x32_bf16 v[124:127], v[236:239], v[140:143], v[124:127]
    ds_read_b64_tr_b16 v[232:233], v22 offset:36864
    v_mfma_f32_16x16x32_bf16 v[128:131], v[236:239], v[144:147], v[128:131]
    ds_read_b64_tr_b16 v[234:235], v22 offset:37888
    s_xor_b32 s96, s83, 11
    s_lshl_b32 s97, s96, 11
    s_add_u32 s20, s97, s19
    buffer_load_dwordx4 v[164:167], v2, s[32:35], s20 offen sc1
    s_waitcnt lgkmcnt(6)
    v_mfma_f32_16x16x32_bf16 v[132:135], v[240:243], v[140:143], v[132:135]
    ds_read_b64_tr_b16 v[236:237], v23 offset:36864
    v_mfma_f32_16x16x32_bf16 v[136:139], v[240:243], v[144:147], v[136:139]
    ds_read_b64_tr_b16 v[238:239], v23 offset:37888
    buffer_load_dwordx4 v[168:171], v2, s[32:35], s20 offen offset:1024 sc1
    s_waitcnt lgkmcnt(6)
    v_mfma_f32_16x16x32_bf16 v[108:111], v[244:247], v[140:143], v[108:111]
    ds_read_b64_tr_b16 v[240:241], v20 offset:36864
    v_mfma_f32_16x16x32_bf16 v[112:115], v[244:247], v[144:147], v[112:115]
    ds_read_b64_tr_b16 v[242:243], v20 offset:37888
    s_waitcnt lgkmcnt(6)
    v_mfma_f32_16x16x32_bf16 v[116:119], v[228:231], v[140:143], v[116:119]
    ds_read_b64_tr_b16 v[244:245], v21 offset:36864
    v_mfma_f32_16x16x32_bf16 v[120:123], v[228:231], v[144:147], v[120:123]
    ds_read_b64_tr_b16 v[246:247], v21 offset:37888
    s_waitcnt lgkmcnt(6)
    s_waitcnt vmcnt(4)
    v_mfma_f32_16x16x32_bf16 v[124:127], v[232:235], v[148:151], v[124:127]
    ds_read_b64_tr_b16 v[228:229], v22 offset:40960
    v_mfma_f32_16x16x32_bf16 v[128:131], v[232:235], v[152:155], v[128:131]
    ds_read_b64_tr_b16 v[230:231], v22 offset:41984
    s_xor_b32 s96, s83, 12
    s_lshl_b32 s97, s96, 11
    s_add_u32 s20, s97, s19
    buffer_load_dwordx4 v[140:143], v2, s[32:35], s20 offen sc1
    s_waitcnt lgkmcnt(6)
    v_mfma_f32_16x16x32_bf16 v[132:135], v[236:239], v[148:151], v[132:135]
    ds_read_b64_tr_b16 v[232:233], v23 offset:40960
    v_mfma_f32_16x16x32_bf16 v[136:139], v[236:239], v[152:155], v[136:139]
    ds_read_b64_tr_b16 v[234:235], v23 offset:41984
    buffer_load_dwordx4 v[144:147], v2, s[32:35], s20 offen offset:1024 sc1
    s_waitcnt lgkmcnt(6)
    v_mfma_f32_16x16x32_bf16 v[108:111], v[240:243], v[148:151], v[108:111]
    ds_read_b64_tr_b16 v[236:237], v20 offset:40960
    v_mfma_f32_16x16x32_bf16 v[112:115], v[240:243], v[152:155], v[112:115]
    ds_read_b64_tr_b16 v[238:239], v20 offset:41984
    s_waitcnt lgkmcnt(6)
    v_mfma_f32_16x16x32_bf16 v[116:119], v[244:247], v[148:151], v[116:119]
    ds_read_b64_tr_b16 v[240:241], v21 offset:40960
    v_mfma_f32_16x16x32_bf16 v[120:123], v[244:247], v[152:155], v[120:123]
    ds_read_b64_tr_b16 v[242:243], v21 offset:41984
    s_waitcnt lgkmcnt(6)
    s_waitcnt vmcnt(4)
    v_mfma_f32_16x16x32_bf16 v[124:127], v[228:231], v[156:159], v[124:127]
    ds_read_b64_tr_b16 v[244:245], v22 offset:45056
    v_mfma_f32_16x16x32_bf16 v[128:131], v[228:231], v[160:163], v[128:131]
    ds_read_b64_tr_b16 v[246:247], v22 offset:46080
    s_xor_b32 s96, s83, 13
    s_lshl_b32 s97, s96, 11
    s_add_u32 s20, s97, s19
    buffer_load_dwordx4 v[148:151], v2, s[32:35], s20 offen sc1
    s_waitcnt lgkmcnt(6)
    v_mfma_f32_16x16x32_bf16 v[132:135], v[232:235], v[156:159], v[132:135]
    ds_read_b64_tr_b16 v[228:229], v23 offset:45056
    v_mfma_f32_16x16x32_bf16 v[136:139], v[232:235], v[160:163], v[136:139]
    ds_read_b64_tr_b16 v[230:231], v23 offset:46080
    buffer_load_dwordx4 v[152:155], v2, s[32:35], s20 offen offset:1024 sc1
    s_waitcnt lgkmcnt(6)
    v_mfma_f32_16x16x32_bf16 v[108:111], v[236:239], v[156:159], v[108:111]
    ds_read_b64_tr_b16 v[232:233], v20 offset:45056
    v_mfma_f32_16x16x32_bf16 v[112:115], v[236:239], v[160:163], v[112:115]
    ds_read_b64_tr_b16 v[234:235], v20 offset:46080
    s_waitcnt lgkmcnt(6)
    v_mfma_f32_16x16x32_bf16 v[116:119], v[240:243], v[156:159], v[116:119]
    ds_read_b64_tr_b16 v[236:237], v21 offset:45056
    v_mfma_f32_16x16x32_bf16 v[120:123], v[240:243], v[160:163], v[120:123]
    ds_read_b64_tr_b16 v[238:239], v21 offset:46080
    s_waitcnt lgkmcnt(6)
    s_waitcnt vmcnt(4)
    v_mfma_f32_16x16x32_bf16 v[124:127], v[244:247], v[164:167], v[124:127]
    ds_read_b64_tr_b16 v[240:241], v22 offset:49152
    v_mfma_f32_16x16x32_bf16 v[128:131], v[244:247], v[168:171], v[128:131]
    ds_read_b64_tr_b16 v[242:243], v22 offset:50176
    s_xor_b32 s96, s83, 14
    s_lshl_b32 s97, s96, 11
    s_add_u32 s20, s97, s19
    buffer_load_dwordx4 v[156:159], v2, s[32:35], s20 offen sc1
    s_waitcnt lgkmcnt(6)
    v_mfma_f32_16x16x32_bf16 v[132:135], v[228:231], v[164:167], v[132:135]
    ds_read_b64_tr_b16 v[244:245], v23 offset:49152
    v_mfma_f32_16x16x32_bf16 v[136:139], v[228:231], v[168:171], v[136:139]
    ds_read_b64_tr_b16 v[246:247], v23 offset:50176
    buffer_load_dwordx4 v[160:163], v2, s[32:35], s20 offen offset:1024 sc1
    s_waitcnt lgkmcnt(6)
    v_mfma_f32_16x16x32_bf16 v[108:111], v[232:235], v[164:167], v[108:111]
    ds_read_b64_tr_b16 v[228:229], v20 offset:49152
    v_mfma_f32_16x16x32_bf16 v[112:115], v[232:235], v[168:171], v[112:115]
    ds_read_b64_tr_b16 v[230:231], v20 offset:50176
    s_waitcnt lgkmcnt(6)
    v_mfma_f32_16x16x32_bf16 v[116:119], v[236:239], v[164:167], v[116:119]
    ds_read_b64_tr_b16 v[232:233], v21 offset:49152
    v_mfma_f32_16x16x32_bf16 v[120:123], v[236:239], v[168:171], v[120:123]
    ds_read_b64_tr_b16 v[234:235], v21 offset:50176
    s_waitcnt lgkmcnt(6)
    s_waitcnt vmcnt(4)
    v_mfma_f32_16x16x32_bf16 v[124:127], v[240:243], v[140:143], v[124:127]
    ds_read_b64_tr_b16 v[236:237], v22 offset:53248
    v_mfma_f32_16x16x32_bf16 v[128:131], v[240:243], v[144:147], v[128:131]
    ds_read_b64_tr_b16 v[238:239], v22 offset:54272
    s_xor_b32 s96, s83, 15
    s_lshl_b32 s97, s96, 11
    s_add_u32 s20, s97, s19
    buffer_load_dwordx4 v[164:167], v2, s[32:35], s20 offen sc1
    s_waitcnt lgkmcnt(6)
    v_mfma_f32_16x16x32_bf16 v[132:135], v[244:247], v[140:143], v[132:135]
    ds_read_b64_tr_b16 v[240:241], v23 offset:53248
    v_mfma_f32_16x16x32_bf16 v[136:139], v[244:247], v[144:147], v[136:139]
    ds_read_b64_tr_b16 v[242:243], v23 offset:54272
    buffer_load_dwordx4 v[168:171], v2, s[32:35], s20 offen offset:1024 sc1
    buffer_load_dwordx2 v[26:27], v25, s[32:35], s18 offen sc1
    s_waitcnt lgkmcnt(6)
    v_mfma_f32_16x16x32_bf16 v[108:111], v[228:231], v[140:143], v[108:111]
    ds_read_b64_tr_b16 v[244:245], v20 offset:53248
    v_mfma_f32_16x16x32_bf16 v[112:115], v[228:231], v[144:147], v[112:115]
    ds_read_b64_tr_b16 v[246:247], v20 offset:54272
    s_waitcnt lgkmcnt(6)
    v_mfma_f32_16x16x32_bf16 v[116:119], v[232:235], v[140:143], v[116:119]
    ds_read_b64_tr_b16 v[228:229], v21 offset:53248
    v_mfma_f32_16x16x32_bf16 v[120:123], v[232:235], v[144:147], v[120:123]
    ds_read_b64_tr_b16 v[230:231], v21 offset:54272
    s_waitcnt lgkmcnt(6)
    s_waitcnt vmcnt(5)
    v_mfma_f32_16x16x32_bf16 v[124:127], v[236:239], v[148:151], v[124:127]
    ds_read_b64_tr_b16 v[232:233], v22 offset:57344
    v_mfma_f32_16x16x32_bf16 v[128:131], v[236:239], v[152:155], v[128:131]
    ds_read_b64_tr_b16 v[234:235], v22 offset:58368
    s_waitcnt lgkmcnt(6)
    v_mfma_f32_16x16x32_bf16 v[132:135], v[240:243], v[148:151], v[132:135]
    ds_read_b64_tr_b16 v[236:237], v23 offset:57344
    v_mfma_f32_16x16x32_bf16 v[136:139], v[240:243], v[152:155], v[136:139]
    ds_read_b64_tr_b16 v[238:239], v23 offset:58368
    s_waitcnt lgkmcnt(6)
    v_mfma_f32_16x16x32_bf16 v[108:111], v[244:247], v[148:151], v[108:111]
    ds_read_b64_tr_b16 v[240:241], v20 offset:57344
    v_mfma_f32_16x16x32_bf16 v[112:115], v[244:247], v[152:155], v[112:115]
    ds_read_b64_tr_b16 v[242:243], v20 offset:58368
    s_waitcnt lgkmcnt(6)
    v_mfma_f32_16x16x32_bf16 v[116:119], v[228:231], v[148:151], v[116:119]
    ds_read_b64_tr_b16 v[244:245], v21 offset:57344
    v_mfma_f32_16x16x32_bf16 v[120:123], v[228:231], v[152:155], v[120:123]
    ds_read_b64_tr_b16 v[246:247], v21 offset:58368
    s_waitcnt lgkmcnt(6)
    s_waitcnt vmcnt(3)
    v_mfma_f32_16x16x32_bf16 v[124:127], v[232:235], v[156:159], v[124:127]
    ds_read_b64_tr_b16 v[228:229], v22 offset:61440
    v_mfma_f32_16x16x32_bf16 v[128:131], v[232:235], v[160:163], v[128:131]
    ds_read_b64_tr_b16 v[230:231], v22 offset:62464
    s_waitcnt lgkmcnt(6)
    v_mfma_f32_16x16x32_bf16 v[132:135], v[236:239], v[156:159], v[132:135]
    ds_read_b64_tr_b16 v[232:233], v23 offset:61440
    v_mfma_f32_16x16x32_bf16 v[136:139], v[236:239], v[160:163], v[136:139]
    ds_read_b64_tr_b16 v[234:235], v23 offset:62464
    s_waitcnt lgkmcnt(6)
    v_mfma_f32_16x16x32_bf16 v[108:111], v[240:243], v[156:159], v[108:111]
    ds_read_b64_tr_b16 v[236:237], v20 offset:61440
    v_mfma_f32_16x16x32_bf16 v[112:115], v[240:243], v[160:163], v[112:115]
    ds_read_b64_tr_b16 v[238:239], v20 offset:62464
    s_waitcnt lgkmcnt(6)
    v_mfma_f32_16x16x32_bf16 v[116:119], v[244:247], v[156:159], v[116:119]
    ds_read_b64_tr_b16 v[240:241], v21 offset:61440
    v_mfma_f32_16x16x32_bf16 v[120:123], v[244:247], v[160:163], v[120:123]
    ds_read_b64_tr_b16 v[242:243], v21 offset:62464
    s_waitcnt lgkmcnt(6)
    s_waitcnt vmcnt(1)
    v_mfma_f32_16x16x32_bf16 v[124:127], v[228:231], v[164:167], v[124:127]
    v_mfma_f32_16x16x32_bf16 v[128:131], v[228:231], v[168:171], v[128:131]
    s_waitcnt lgkmcnt(4)
    v_mfma_f32_16x16x32_bf16 v[132:135], v[232:235], v[164:167], v[132:135]
    v_mfma_f32_16x16x32_bf16 v[136:139], v[232:235], v[168:171], v[136:139]
    s_waitcnt lgkmcnt(2)
    v_mfma_f32_16x16x32_bf16 v[108:111], v[236:239], v[164:167], v[108:111]
    v_mfma_f32_16x16x32_bf16 v[112:115], v[236:239], v[168:171], v[112:115]
    s_waitcnt lgkmcnt(0)
    v_mfma_f32_16x16x32_bf16 v[116:119], v[240:243], v[164:167], v[116:119]
    v_mfma_f32_16x16x32_bf16 v[120:123], v[240:243], v[168:171], v[120:123]
    s_setprio 0
    s_lshl_b32 s13, s3, 12
    v_add_u32 v4, s13, v2
    ds_write_b128 v4, v[124:127]
    ds_write_b128 v4, v[128:131] offset:1024
    ds_write_b128 v4, v[132:135] offset:2048
    ds_write_b128 v4, v[136:139] offset:3072
    v_permlane16_swap_b32 v108, v112
    v_permlane16_swap_b32 v109, v113
    v_permlane16_swap_b32 v110, v114
    v_permlane16_swap_b32 v111, v115
    v_permlane16_swap_b32 v116, v120
    v_permlane16_swap_b32 v117, v121
    v_permlane16_swap_b32 v118, v122
    v_permlane16_swap_b32 v119, v123
    s_xor_b32 s96, s3, 4
    s_lshl_b32 s13, s96, 12
    v_and_b32 v5, 15, v1
    v_lshl_add_u32 v5, v5, 4, s13
    v_bfe_u32 v9, v1, 4, 1
    v_lshl_add_u32 v5, v9, 10, v5
    v_lshrrev_b32 v9, 5, v1
    v_lshl_add_u32 v5, v9, 9, v5
    s_lshl_b32 s96, s76, 11
    s_and_b32 s97, s3, 3
    s_lshl_b32 s98, s97, 9
    s_add_u32 s99, s96, s98
    s_add_u32 s13, s99, 131072
    v_and_b32 v6, 31, v1
    v_lshl_add_u32 v6, v6, 4, s13
    v_lshrrev_b32 v9, 5, v1
    v_lshl_add_u32 v6, v9, 3, v6
    s_lshl_b32 s96, s76, 6
    s_add_u32 s13, s96, 139008
    v_and_b32 v7, 7, v1
    v_lshl_add_u32 v7, v7, 2, s13
    v_lshrrev_b32 v9, 5, v1
    v_lshl_add_u32 v7, v9, 5, v7
    s_lshl_b32 s96, s21, 15
    s_lshl_b32 s97, s3, 8
    s_add_u32 s98, s96, s97
    s_add_u32 s19, s98, 12582912
    v_and_b32 v44, 15, v1
    v_lshlrev_b32 v44, 4, v44
    v_lshrrev_b32 v9, 4, v1
    v_lshl_add_u32 v44, v9, 11, v44
    v_mov_b32 v232, 0x3f803f80
    s_waitcnt lgkmcnt(0)
    s_barrier
    ds_read_b128 v[124:127], v5
    ds_read_b128 v[128:131], v5 offset:256
    ds_read_b128 v[132:135], v5 offset:2048
    ds_read_b128 v[136:139], v5 offset:2304
    s_add_u32 s14, s80, 114688
    s_lshl2_add_u32 m0, s89, 67584
    s_nop 0
    buffer_load_dwordx4 v72, s[56:59], s14 offen nt lds
    s_add_u32 s14, s80, 172032
    s_lshl2_add_u32 m0, s89, 68608
    s_nop 0
    buffer_load_dwordx4 v72, s[56:59], s14 offen nt lds
    s_mov_b32 s14, s81
    s_lshl2_add_u32 m0, s89, 98304
    s_nop 0
    buffer_load_dwordx4 v73, s[60:63], s14 offen nt lds
    s_waitcnt lgkmcnt(3)
    v_pk_add_f32 v[108:109], v[108:109], v[124:125]
    v_pk_add_f32 v[110:111], v[110:111], v[126:127]
    s_waitcnt lgkmcnt(2)
    v_pk_add_f32 v[112:113], v[112:113], v[128:129]
    v_pk_add_f32 v[114:115], v[114:115], v[130:131]
    v_cvt_pk_bf16_f32 v108, 0, v108
    v_cvt_pk_bf16_f32 v109, 0, v109
    v_cvt_pk_bf16_f32 v110, 0, v110
    v_cvt_pk_bf16_f32 v111, 0, v111
    v_cvt_pk_bf16_f32 v112, 0, v112
    v_cvt_pk_bf16_f32 v113, 0, v113
    v_cvt_pk_bf16_f32 v114, 0, v114
    v_cvt_pk_bf16_f32 v115, 0, v115
    v_pk_mul_f32 v[108:109], v[108:109], v[76:77]
    v_pk_mul_f32 v[110:111], v[110:111], v[78:79]
    v_pk_mul_f32 v[112:113], v[112:113], v[80:81]
    v_pk_mul_f32 v[114:115], v[114:115], v[82:83]
    v_cvt_pk_bf16_f32 v108, 0, v108
    v_cvt_pk_bf16_f32 v109, 0, v109
    v_cvt_pk_bf16_f32 v110, 0, v110
    v_cvt_pk_bf16_f32 v111, 0, v111
    v_cvt_pk_bf16_f32 v112, 0, v112
    v_cvt_pk_bf16_f32 v113, 0, v113
    v_cvt_pk_bf16_f32 v114, 0, v114
    v_cvt_pk_bf16_f32 v115, 0, v115
    v_pk_add_f32 v[108:109], v[108:109], v[28:29]
    v_pk_add_f32 v[110:111], v[110:111], v[30:31]
    v_pk_add_f32 v[112:113], v[112:113], v[32:33]
    v_pk_add_f32 v[114:115], v[114:115], v[34:35]
    v_cvt_pk_bf16_f32 v12, v108, v109
    v_cvt_pk_bf16_f32 v13, v110, v111
    v_cvt_pk_bf16_f32 v14, v112, v113
    v_cvt_pk_bf16_f32 v15, v114, v115
    s_waitcnt lgkmcnt(1)
    v_pk_add_f32 v[116:117], v[116:117], v[132:133]
    v_pk_add_f32 v[118:119], v[118:119], v[134:135]
    s_waitcnt lgkmcnt(0)
    v_pk_add_f32 v[120:121], v[120:121], v[136:137]
    v_pk_add_f32 v[122:123], v[122:123], v[138:139]
    v_cvt_pk_bf16_f32 v116, 0, v116
    v_cvt_pk_bf16_f32 v117, 0, v117
    v_cvt_pk_bf16_f32 v118, 0, v118
    v_cvt_pk_bf16_f32 v119, 0, v119
    v_cvt_pk_bf16_f32 v120, 0, v120
    v_cvt_pk_bf16_f32 v121, 0, v121
    v_cvt_pk_bf16_f32 v122, 0, v122
    v_cvt_pk_bf16_f32 v123, 0, v123
    v_pk_mul_f32 v[116:117], v[116:117], v[84:85]
    v_pk_mul_f32 v[118:119], v[118:119], v[86:87]
    v_pk_mul_f32 v[120:121], v[120:121], v[88:89]
    v_pk_mul_f32 v[122:123], v[122:123], v[90:91]
    v_cvt_pk_bf16_f32 v116, 0, v116
    v_cvt_pk_bf16_f32 v117, 0, v117
    v_cvt_pk_bf16_f32 v118, 0, v118
    v_cvt_pk_bf16_f32 v119, 0, v119
    v_cvt_pk_bf16_f32 v120, 0, v120
    v_cvt_pk_bf16_f32 v121, 0, v121
    v_cvt_pk_bf16_f32 v122, 0, v122
    v_cvt_pk_bf16_f32 v123, 0, v123
    v_pk_add_f32 v[116:117], v[116:117], v[36:37]
    v_pk_add_f32 v[118:119], v[118:119], v[38:39]
    v_pk_add_f32 v[120:121], v[120:121], v[40:41]
    v_pk_add_f32 v[122:123], v[122:123], v[42:43]
    v_cvt_pk_bf16_f32 v16, v116, v117
    v_cvt_pk_bf16_f32 v17, v118, v119
    v_cvt_pk_bf16_f32 v18, v120, v121
    v_cvt_pk_bf16_f32 v19, v122, v123
    v_mfma_f32_32x32x16_bf16 v[124:139], v[92:95], v[12:15], 0
    s_nop 0
    v_mfma_f32_32x32x16_bf16 v[124:139], v[96:99], v[16:19], v[124:139]
    v_dot2_f32_bf16 v228, v12, v12, 0
    v_dot2_f32_bf16 v229, v13, v13, 0
    v_dot2_f32_bf16 v228, v14, v14, v228
    v_dot2_f32_bf16 v229, v15, v15, v229
    v_dot2_f32_bf16 v228, v16, v16, v228
    v_dot2_f32_bf16 v229, v17, v17, v229
    v_dot2_f32_bf16 v228, v18, v18, v228
    v_dot2_f32_bf16 v229, v19, v19, v229
    s_nop 2
    v_add_f32 v230, v228, v229
    v_add_f32 v228, v228, v229
    s_nop 1
    v_permlane32_swap_b32 v228, v230
    s_mov_b32 exec_lo, 0
    v_add_f32 v124, v228, v230
    v_mov_b32 v125, v126
    s_mov_b32 exec_lo, -1
    ds_write_b64 v6, v[124:125]
    ds_write_b32 v7, v68
    ds_write_b32 v7, v69 offset:128
    ds_write_b32 v7, v70 offset:256
    ds_write_b32 v7, v71 offset:384
    v_add_u32 v4, 131072, v2
    v_and_b32 v5, 7, v1
    v_lshlrev_b32 v5, 15, v5
    v_bfe_u32 v9, v1, 3, 1
    v_lshl_add_u32 v5, v9, 12, v5
    s_lshl4_add_u32 s96, s21, s12
    s_lshl_b32 s97, s96, 11
    s_add_u32 s13, s97, 12582912
    s_and_b32 s96, s12, 1
    s_lshr_b32 s97, s21, 2
    s_and_b32 s98, s21, 3
    s_lshl_b32 s99, s98, 6
    s_lshl1_add_u32 s98, s97, s99
    s_lshl_b32 s97, s98, 12
    s_lshr_b32 s99, s12, 1
    s_lshl_b32 s98, s99, 6
    s_add_u32 s99, s97, s98
    s_lshl2_add_u32 s97, s96, s99
    s_add_u32 s98, s97, 1048576
    s_add_u32 s16, s98, 1536
    s_waitcnt lgkmcnt(0)
    s_barrier
    s_cmp_lg_u32 s3, 0
    s_cbranch_scc1 L_PE
    ds_read_b128 v[124:127], v4 offset:0
    ds_read_b128 v[128:131], v4 offset:2048
    ds_read_b128 v[132:135], v4 offset:1024
    ds_read_b128 v[136:139], v4 offset:3072
    s_waitcnt lgkmcnt(2)
    v_pk_add_f32 v[124:125], v[124:125], v[128:129]
    v_pk_add_f32 v[126:127], v[126:127], v[130:131]
    v_add_f32 v125, v125, v127
    v_mov_b32 v127, s4
    s_waitcnt lgkmcnt(0)
    v_pk_add_f32 v[132:133], v[132:133], v[136:137]
    v_pk_add_f32 v[134:135], v[134:135], v[138:139]
    v_add_f32 v133, v133, v135
    v_mov_b32 v135, s4
    buffer_store_dwordx4 v[124:127], v2, s[32:35], s13 offen sc1
    buffer_store_dwordx4 v[132:135], v2, s[32:35], s13 offen offset:1024 sc1
    s_mov_b64 exec, 0xffff
    buffer_store_dword v127, v5, s[32:35], s16 offen sc1
    s_mov_b64 exec, -1
L_PE:
    s_load_dwordx2 s[24:25], s[32:33], s92 offset:1536 glc
    s_and_b32 s96, s3, 3
    s_mul_i32 s97, s96, 4608
    s_lshl_b32 s98, s76, 6
    s_add_u32 s16, s97, s98
    v_and_b32 v23, 31, v1
    v_mul_u32_u24 v23, 144, v23
    v_lshrrev_b32 v9, 5, v1
    v_lshl_add_u32 v23, v9, 5, v23
    v_add_u32 v23, s16, v23
    ds_write_b128 v23, v[12:15]
    ds_write_b128 v23, v[16:19] offset:16
    v_add_u32 v23, 139776, v23
    s_lshl3_add_u32 s96, s21, s3
    s_lshl_b32 s97, s96, 5
    s_sub_u32 s15, 4094, s97
    v_and_b32 v22, 15, v1
    v_lshlrev_b32 v22, 1, v22
    v_sub_u32 v22, s15, v22
    s_lshl_b32 s96, s3, 7
    s_add_u32 s15, s96, 135168
    v_and_b32 v8, 15, v1
    v_lshl_add_u32 v8, v8, 3, s15
    s_and_b32 s96, s3, 3
    s_lshl_b32 s97, s96, 8
    s_add_u32 s15, s97, 135168
    v_and_b32 v10, 31, v1
    v_lshl_add_u32 v10, v10, 3, s15
    v_and_b32 v11, 7, v1
    v_lshlrev_b32 v11, 3, v11
    v_add_u32 v11, 136192, v11
    s_waitcnt vmcnt(3)
    v_cmp_ne_u32 vcc, s4, v27
    s_cbranch_vccz TOK_38
POLL_39:
    buffer_load_dwordx2 v[26:27], v25, s[32:35], s18 offen sc1
    s_waitcnt vmcnt(0)
    v_cmp_ne_u32 vcc, s4, v27
    s_cbranch_vccz PDONE_40
    s_add_u32 s5, s5, 1
    s_cmp_lt_u32 s5, 300000
    s_cbranch_scc1 POLL_39
PDONE_40:
TOK_38:
    v_add_f32_dpp v26, v26, v26 quad_perm:[1,0,3,2] row_mask:0xf bank_mask:0xf
    s_nop 1
    v_add_f32_dpp v26, v26, v26 quad_perm:[2,3,0,1] row_mask:0xf bank_mask:0xf
    s_nop 1
    v_add_f32_dpp v26, v26, v26 row_half_mirror row_mask:0xf bank_mask:0xf
    s_nop 1
    v_add_f32_dpp v26, v26, v26 row_ror:8 row_mask:0xf bank_mask:0xf
    s_cmp_lg_u32 s3, 1
    s_cbranch_scc1 L_NOCT
    v_and_b32 v5, 15, v1
    v_lshlrev_b32 v5, 3, v5
    v_add_u32 v5, 139008, v5
    ds_read_b64 v[150:151], v5
    ds_read_b64 v[154:155], v5 offset:128
    ds_read_b64 v[156:157], v5 offset:384
    s_waitcnt lgkmcnt(0)
    v_lshlrev_b32 v148, 16, v150
    v_and_b32 v149, s6, v150
    v_lshlrev_b32 v150, 16, v151
    v_and_b32 v151, s6, v151
    v_lshlrev_b32 v152, 16, v154
    v_and_b32 v153, s6, v154
    v_lshlrev_b32 v154, 16, v155
    v_and_b32 v155, s6, v155
L_NOCT:
    s_cmp_lt_u32 s3, 4
    s_cbranch_scc1 L_NOST
    s_sub_u32 s96, s3, 4
    s_lshl_b32 s97, s96, 12
    s_add_u32 s13, s97, 32768
    v_add_u32 v4, s13, v2
    v_add_u32 v7, 65536, v4
    ds_write_b128 v4, v[176:179] offset:16384
    ds_write_b128 v4, v[180:183]
    ds_write_b128 v4, v[184:187] offset:17408
    ds_write_b128 v4, v[188:191] offset:1024
    ds_write_b128 v4, v[192:195] offset:18432
    ds_write_b128 v4, v[196:199] offset:2048
    ds_write_b128 v4, v[200:203] offset:19456
    ds_write_b128 v4, v[204:207] offset:3072
    ds_write_b128 v4, v[208:211] offset:49152
    ds_write_b128 v4, v[212:215] offset:32768
    ds_write_b128 v4, v[216:219] offset:50176
    ds_write_b128 v4, v[220:223] offset:33792
L_NOST:
    s_branch SCHK_36
SPOLL_35:
    s_load_dwordx2 s[24:25], s[32:33], s92 offset:1536 glc
SCHK_36:
    s_add_u32 s5, s5, 1
    s_cmp_ge_u32 s5, 300000
    s_waitcnt lgkmcnt(0)
    s_cbranch_scc1 SDONE_37
    s_cmp_lg_u32 s24, s4
    s_cbranch_scc1 SPOLL_35
    s_cmp_lg_u32 s25, s4
    s_cbranch_scc1 SPOLL_35
SDONE_37:
    s_barrier
    s_mov_b32 s13, s19
    buffer_load_dwordx4 v[124:127], v44, s[32:35], s13 offen sc1
    s_add_u32 s13, s19, 8192
    buffer_load_dwordx4 v[128:131], v44, s[32:35], s13 offen sc1
    s_add_u32 s13, s19, 16384
    buffer_load_dwordx4 v[132:135], v44, s[32:35], s13 offen sc1
    s_add_u32 s13, s19, 24576
    buffer_load_dwordx4 v[136:139], v44, s[32:35], s13 offen sc1
    v_lshlrev_b32 v28, 16, v12
    v_and_b32 v29, s6, v12
    v_lshlrev_b32 v30, 16, v13
    v_and_b32 v31, s6, v13
    v_lshlrev_b32 v32, 16, v14
    v_and_b32 v33, s6, v14
    v_lshlrev_b32 v34, 16, v15
    v_and_b32 v35, s6, v15
    v_lshlrev_b32 v36, 16, v16
    v_and_b32 v37, s6, v16
    v_lshlrev_b32 v38, 16, v17
    v_and_b32 v39, s6, v17
    v_lshlrev_b32 v40, 16, v18
    v_and_b32 v41, s6, v18
    v_lshlrev_b32 v42, 16, v19
    v_and_b32 v43, s6, v19
    v_mul_u32_u24_dpp v92, v68, v52 row_newbcast:0 row_mask:0xf bank_mask:0xf
    v_and_b32_dpp v93, v68, v53 row_newbcast:0 row_mask:0xf bank_mask:0xf
    v_mul_u32_u24_dpp v94, v68, v52 row_newbcast:1 row_mask:0xf bank_mask:0xf
    v_and_b32_dpp v95, v68, v53 row_newbcast:1 row_mask:0xf bank_mask:0xf
    v_mul_u32_u24_dpp v96, v68, v52 row_newbcast:2 row_mask:0xf bank_mask:0xf
    v_and_b32_dpp v97, v68, v53 row_newbcast:2 row_mask:0xf bank_mask:0xf
    v_mul_u32_u24_dpp v98, v68, v52 row_newbcast:3 row_mask:0xf bank_mask:0xf
    v_and_b32_dpp v99, v68, v53 row_newbcast:3 row_mask:0xf bank_mask:0xf
    v_mul_u32_u24_dpp v100, v68, v52 row_newbcast:4 row_mask:0xf bank_mask:0xf
    v_and_b32_dpp v101, v68, v53 row_newbcast:4 row_mask:0xf bank_mask:0xf
    v_mul_u32_u24_dpp v102, v68, v52 row_newbcast:5 row_mask:0xf bank_mask:0xf
    v_and_b32_dpp v103, v68, v53 row_newbcast:5 row_mask:0xf bank_mask:0xf
    v_mul_u32_u24_dpp v104, v68, v52 row_newbcast:6 row_mask:0xf bank_mask:0xf
    v_and_b32_dpp v105, v68, v53 row_newbcast:6 row_mask:0xf bank_mask:0xf
    v_mul_u32_u24_dpp v106, v68, v52 row_newbcast:7 row_mask:0xf bank_mask:0xf
    v_and_b32_dpp v107, v68, v53 row_newbcast:7 row_mask:0xf bank_mask:0xf
    v_mul_u32_u24_dpp v108, v69, v52 row_newbcast:0 row_mask:0xf bank_mask:0xf
    v_and_b32_dpp v109, v69, v53 row_newbcast:0 row_mask:0xf bank_mask:0xf
    v_mul_u32_u24_dpp v110, v69, v52 row_newbcast:1 row_mask:0xf bank_mask:0xf
    v_and_b32_dpp v111, v69, v53 row_newbcast:1 row_mask:0xf bank_mask:0xf
    v_mul_u32_u24_dpp v112, v69, v52 row_newbcast:2 row_mask:0xf bank_mask:0xf
    v_and_b32_dpp v113, v69, v53 row_newbcast:2 row_mask:0xf bank_mask:0xf
    v_mul_u32_u24_dpp v114, v69, v52 row_newbcast:3 row_mask:0xf bank_mask:0xf
    v_and_b32_dpp v115, v69, v53 row_newbcast:3 row_mask:0xf bank_mask:0xf
    v_mul_u32_u24_dpp v116, v69, v52 row_newbcast:4 row_mask:0xf bank_mask:0xf
    v_and_b32_dpp v117, v69, v53 row_newbcast:4 row_mask:0xf bank_mask:0xf
    v_mul_u32_u24_dpp v118, v69, v52 row_newbcast:5 row_mask:0xf bank_mask:0xf
    v_and_b32_dpp v119, v69, v53 row_newbcast:5 row_mask:0xf bank_mask:0xf
    v_mul_u32_u24_dpp v120, v69, v52 row_newbcast:6 row_mask:0xf bank_mask:0xf
    v_and_b32_dpp v121, v69, v53 row_newbcast:6 row_mask:0xf bank_mask:0xf
    v_mul_u32_u24_dpp v122, v69, v52 row_newbcast:7 row_mask:0xf bank_mask:0xf
    v_and_b32_dpp v123, v69, v53 row_newbcast:7 row_mask:0xf bank_mask:0xf
    s_waitcnt vmcnt(0)
    v_bitop3_b32 v4, v127, v131, s4 bitop3:0x7e
    v_bitop3_b32 v4, v4, v135, s4 bitop3:0xf6
    v_bitop3_b32 v4, v4, v139, s4 bitop3:0xf6
    v_cmp_ne_u32 vcc, 0, v4
    s_cbranch_vccz TOK_42
POLL_43:
    s_mov_b32 s13, s19
    buffer_load_dwordx4 v[124:127], v44, s[32:35], s13 offen sc1
    s_add_u32 s13, s19, 8192
    buffer_load_dwordx4 v[128:131], v44, s[32:35], s13 offen sc1
    s_add_u32 s13, s19, 16384
    buffer_load_dwordx4 v[132:135], v44, s[32:35], s13 offen sc1
    s_add_u32 s13, s19, 24576
    buffer_load_dwordx4 v[136:139], v44, s[32:35], s13 offen sc1
    s_waitcnt vmcnt(0)
    v_bitop3_b32 v4, v127, v131, s4 bitop3:0x7e
    v_bitop3_b32 v4, v4, v135, s4 bitop3:0xf6
    v_bitop3_b32 v4, v4, v139, s4 bitop3:0xf6
    v_cmp_ne_u32 vcc, 0, v4
    s_cbranch_vccz PDONE_44
    s_add_u32 s5, s5, 1
    s_cmp_lt_u32 s5, 300000
    s_cbranch_scc1 POLL_43
PDONE_44:
TOK_42:
    s_lshl2_add_u32 s96, s74, s75
    s_lshl_b32 s97, s96, 11
    s_lshl_b32 s98, s3, 8
    s_add_u32 s99, s97, s98
    s_add_u32 s15, s99, 20971520
    v_lshlrev_b32 v44, 7, v1
    s_mov_b64 exec, 3
    buffer_load_dword v44, v44, s[32:35], s15 offen
    s_mov_b64 exec, -1
    s_add_u32 s15, s81, 4096
    s_lshl2_add_u32 m0, s89, 99328
    s_nop 0
    buffer_load_dwordx4 v73, s[60:63], s15 offen nt lds
    v_pk_add_f32 v[124:125], v[124:125], v[128:129]
    v_pk_add_f32 v[132:133], v[132:133], v[136:137]
    v_add_f32 v126, v126, v130
    v_add_f32 v134, v134, v138
    v_pk_add_f32 v[124:125], v[124:125], v[132:133]
    v_add_f32 v126, v126, v134
    v_mov_b32 v127, v125
    s_nop 0
    v_permlane32_swap_b32 v124, v126
    v_permlane32_swap_b32 v125, v127
    v_add_f32 v124, v124, v126
    v_add_f32 v125, v125, v127
    s_nop 1
    v_permlane16_swap_b32 v124, v125
    v_add_f32 v127, v124, v125
    v_add_f32 v124, v124, v125
    s_nop 1
    v_permlane16_swap_b32 v124, v127
    v_mul_f32 v126, 0x3a800000, v124
    v_mul_f32 v124, 0x3a800000, v124
    s_nop 1
    v_permlane32_swap_b32 v124, v126
    v_fma_f32 v21, -v124, v124, v126
    v_cvt_pk_bf16_f32 v20, 0, v124
    v_max_f32 v21, 0, v21
    v_cvt_pk_bf16_f32 v21, 0, v21
    v_add_f32 v21, 0x3727c5ac, v21
    v_cvt_pk_bf16_f32 v21, 0, v21
    v_sqrt_f32 v21, v21
    s_nop 0
    v_cvt_pk_bf16_f32 v21, 0, v21
    s_lshl3_add_u32 s13, s3, 136192
    v_rcp_f32 v21, v21
    v_fma_f32 v127, -v20, v26, v127
    v_mov_b32 v5, s13
    v_mul_f32 v127, v127, v21
    ds_write_b64 v8, v[20:21]
    s_movk_i32 s13, 0xfff
    v_ashrrev_i32 v124, 31, v127
    v_or_b32 v124, 0x80000000, v124
    v_xor_b32 v124, v124, v127
    v_bfi_b32 v48, s13, v22, v124
    s_nop 1
    v_min_u32_dpp v49, v48, v48 row_ror:8 row_mask:0xf bank_mask:0xf
    v_max_u32_dpp v48, v48, v48 row_ror:8 row_mask:0xf bank_mask:0xf
    s_nop 1
    v_min_u32_dpp v50, v48, v48 row_ror:4 row_mask:0xf bank_mask:0xf
    v_max_u32_dpp v49, v49, v49 row_ror:4 row_mask:0xf bank_mask:0xf
    v_max_u32_dpp v48, v48, v48 row_ror:4 row_mask:0xf bank_mask:0xf
    v_max_u32 v49, v49, v50
    s_nop 0
    v_min_u32_dpp v50, v48, v48 row_ror:2 row_mask:0xf bank_mask:0xf
    v_max_u32_dpp v49, v49, v49 row_ror:2 row_mask:0xf bank_mask:0xf
    v_max_u32_dpp v48, v48, v48 row_ror:2 row_mask:0xf bank_mask:0xf
    v_max_u32 v49, v49, v50
    s_nop 0
    v_min_u32_dpp v50, v48, v48 row_ror:1 row_mask:0xf bank_mask:0xf
    v_max_u32_dpp v49, v49, v49 row_ror:1 row_mask:0xf bank_mask:0xf
    v_max_u32_dpp v48, v48, v48 row_ror:1 row_mask:0xf bank_mask:0xf
    v_max_u32 v49, v49, v50
    ds_write_b64 v5, v[48:49]
    v_and_b32 v6, 3, v1
    v_lshlrev_b32 v6, 18, v6
    v_bfe_u32 v9, v1, 2, 2
    v_lshl_add_u32 v6, v9, 13, v6
    s_and_b32 s96, s21, 1
    s_and_b32 s97, s12, 7
    s_lshr_b32 s98, s12, 3
    s_lshl3_add_u32 s99, s97, s98
    s_lshl_b32 s97, s99, 12
    s_lshr_b32 s98, s21, 1
    s_lshl_b32 s99, s98, 6
    s_add_u32 s98, s97, s99
    s_lshl4_add_u32 s97, s96, s98
    s_add_u32 s99, s97, 1048576
    s_add_u32 s14, s99, 2560
    s_waitcnt lgkmcnt(0)
    s_barrier
    ds_read_b64 v[48:49], v11
    ds_read_b64 v[20:21], v10
    s_waitcnt lgkmcnt(1)
    v_min_u32_dpp v50, v48, v48 quad_perm:[1,0,3,2] row_mask:0xf bank_mask:0xf
    v_max_u32_dpp v49, v49, v49 quad_perm:[1,0,3,2] row_mask:0xf bank_mask:0xf
    v_max_u32_dpp v48, v48, v48 quad_perm:[1,0,3,2] row_mask:0xf bank_mask:0xf
    v_max_u32 v49, v49, v50
    s_nop 0
    v_min_u32_dpp v50, v48, v48 quad_perm:[2,3,0,1] row_mask:0xf bank_mask:0xf
    v_max_u32_dpp v49, v49, v49 quad_perm:[2,3,0,1] row_mask:0xf bank_mask:0xf
    v_max_u32_dpp v48, v48, v48 quad_perm:[2,3,0,1] row_mask:0xf bank_mask:0xf
    v_max_u32 v49, v49, v50
    s_nop 0
    v_min_u32_dpp v50, v48, v48 row_half_mirror row_mask:0xf bank_mask:0xf
    v_max_u32_dpp v49, v49, v49 row_half_mirror row_mask:0xf bank_mask:0xf
    v_max_u32_dpp v48, v48, v48 row_half_mirror row_mask:0xf bank_mask:0xf
    v_max_u32 v49, v49, v50
    v_or_b32 v50, 1, v49
    v_mov_b32 v49, s4
    v_mov_b32 v51, s4
    s_cmp_lg_u32 s3, 0
    s_cbranch_scc1 L_NOF
    s_mov_b64 exec, 0xffff
    buffer_store_dwordx4 v[48:51], v6, s[32:35], s14 offen sc1
    s_mov_b64 exec, -1
L_NOF:
    s_cmp_lg_u32 s3, 1
    s_cbranch_scc1 L_NOC
    v_and_b32 v4, 16, v1
    v_cmp_eq_u32 vcc, 0, v4
    s_nop 1
    v_cndmask_b32 v4, v50, v48, vcc
    v_not_b32 v4, v4
    v_bfe_u32 v4, v4, 1, 7
    v_lshlrev_b32 v6, 3, v4
    v_mul_u32_u24 v4, 144, v4
    v_add_u32 v6, 135168, v6
    v_and_b32 v5, 15, v1
    v_lshlrev_b32 v5, 3, v5
    v_add_u32 v4, v4, v5
    ds_read_b64 v[128:129], v6
    ds_read_b64 v[124:125], v4 offset:0
    v_and_b32 v6, 15, v1
    v_lshlrev_b32 v6, 4, v6
    v_bfe_u32 v9, v1, 4, 1
    v_lshl_add_u32 v6, v9, 14, v6
    v_lshrrev_b32 v9, 5, v1
    v_lshl_add_u32 v6, v9, 12, v6
    v_bfe_u32 v7, v1, 4, 1
    v_lshlrev_b32 v7, 14, v7
    s_lshl_b32 s96, s21, 15
    s_lshl_b32 s97, s12, 8
    s_add_u32 s98, s96, s97
    s_add_u32 s13, s98, 33554432
    s_lshl_b32 s96, s21, 15
    s_lshl3_add_u32 s97, s12, s96
    s_add_u32 s98, s97, 8192
    s_add_u32 s16, s98, 33554432
    v_mov_b32 v127, s4
    s_waitcnt lgkmcnt(0)
    v_lshlrev_b32 v132, 16, v124
    v_and_b32 v133, s6, v124
    v_lshlrev_b32 v134, 16, v125
    v_and_b32 v135, s6, v125
    v_pk_add_f32 v[132:133], v[132:133], v[128:129] op_sel_hi:[1,0] neg_lo:[0,1] neg_hi:[0,1]
    v_pk_add_f32 v[134:135], v[134:135], v[128:129] op_sel_hi:[1,0] neg_lo:[0,1] neg_hi:[0,1]
    v_cvt_pk_bf16_f32 v132, 0, v132
    v_cvt_pk_bf16_f32 v133, 0, v133
    v_cvt_pk_bf16_f32 v134, 0, v134
    v_cvt_pk_bf16_f32 v135, 0, v135
    v_pk_mul_f32 v[132:133], v[132:133], v[128:129] op_sel:[0,1]
    v_pk_mul_f32 v[134:135], v[134:135], v[128:129] op_sel:[0,1]
    v_cvt_pk_bf16_f32 v132, 0, v132
    v_cvt_pk_bf16_f32 v133, 0, v133
    v_cvt_pk_bf16_f32 v134, 0, v134
    v_cvt_pk_bf16_f32 v135, 0, v135
    v_pk_mul_f32 v[132:133], v[132:133], v[152:153]
    v_pk_mul_f32 v[134:135], v[134:135], v[154:155]
    v_cvt_pk_bf16_f32 v132, 0, v132
    v_cvt_pk_bf16_f32 v133, 0, v133
    v_cvt_pk_bf16_f32 v134, 0, v134
    v_cvt_pk_bf16_f32 v135, 0, v135
    v_pk_add_f32 v[132:133], v[132:133], v[148:149]
    v_pk_add_f32 v[134:135], v[134:135], v[150:151]
    v_mov_b32 v126, v125
    v_mov_b32 v125, s4
    s_mov_b32 exec_hi, 0
    v_cvt_pk_bf16_f32 v124, v132, v133
    v_cvt_pk_bf16_f32 v126, v134, v135
    s_mov_b32 exec_hi, -1
    v_dot2_f32_bf16 v128, v124, v156, 0
    v_mov_b32 v129, s4
    v_dot2_f32_bf16 v128, v126, v157, v128
    buffer_store_dwordx4 v[124:127], v6, s[32:35], s13 offen sc1
    s_nop 1
    v_add_f32_dpp v128, v128, v128 quad_perm:[1,0,3,2] row_mask:0xf bank_mask:0xf
    s_nop 1
    v_add_f32_dpp v128, v128, v128 quad_perm:[2,3,0,1] row_mask:0xf bank_mask:0xf
    s_nop 1
    v_add_f32_dpp v128, v128, v128 row_half_mirror row_mask:0xf bank_mask:0xf
    s_nop 1
    v_add_f32_dpp v128, v128, v128 row_ror:8 row_mask:0xf bank_mask:0xf
    s_mov_b64 exec, 0x10001
    buffer_store_dwordx2 v[128:129], v7, s[32:35], s16 offen sc1
    s_mov_b64 exec, -1
L_NOC:
    s_waitcnt lgkmcnt(0)
    s_mov_b32 exec_lo, 0xff
    s_mov_b32 exec_hi, 0xff
    buffer_store_dwordx2 v[224:225], v226, s[32:35], 0 offen sc1
    s_mov_b64 exec, -1
    s_add_u32 s13, s81, 8192
    s_lshl2_add_u32 m0, s89, 100352
    s_nop 0
    buffer_load_dwordx4 v73, s[60:63], s13 offen nt lds
    s_load_dwordx8 s[24:31], s[32:33], s92 offset:2560 glc
    v_pk_add_f32 v[76:77], v[28:29], v[20:21] op_sel_hi:[1,0] neg_lo:[0,1] neg_hi:[0,1]
    v_pk_add_f32 v[78:79], v[30:31], v[20:21] op_sel_hi:[1,0] neg_lo:[0,1] neg_hi:[0,1]
    v_pk_add_f32 v[80:81], v[32:33], v[20:21] op_sel_hi:[1,0] neg_lo:[0,1] neg_hi:[0,1]
    v_pk_add_f32 v[82:83], v[34:35], v[20:21] op_sel_hi:[1,0] neg_lo:[0,1] neg_hi:[0,1]
    v_pk_add_f32 v[84:85], v[36:37], v[20:21] op_sel_hi:[1,0] neg_lo:[0,1] neg_hi:[0,1]
    v_pk_add_f32 v[86:87], v[38:39], v[20:21] op_sel_hi:[1,0] neg_lo:[0,1] neg_hi:[0,1]
    v_pk_add_f32 v[88:89], v[40:41], v[20:21] op_sel_hi:[1,0] neg_lo:[0,1] neg_hi:[0,1]
    v_pk_add_f32 v[90:91], v[42:43], v[20:21] op_sel_hi:[1,0] neg_lo:[0,1] neg_hi:[0,1]
    v_cvt_pk_bf16_f32 v76, 0, v76
    v_cvt_pk_bf16_f32 v77, 0, v77
    v_cvt_pk_bf16_f32 v78, 0, v78
    v_cvt_pk_bf16_f32 v79, 0, v79
    v_cvt_pk_bf16_f32 v80, 0, v80
    v_cvt_pk_bf16_f32 v81, 0, v81
    v_cvt_pk_bf16_f32 v82, 0, v82
    v_cvt_pk_bf16_f32 v83, 0, v83
    v_cvt_pk_bf16_f32 v84, 0, v84
    v_cvt_pk_bf16_f32 v85, 0, v85
    v_cvt_pk_bf16_f32 v86, 0, v86
    v_cvt_pk_bf16_f32 v87, 0, v87
    v_cvt_pk_bf16_f32 v88, 0, v88
    v_cvt_pk_bf16_f32 v89, 0, v89
    v_cvt_pk_bf16_f32 v90, 0, v90
    v_cvt_pk_bf16_f32 v91, 0, v91
    v_pk_mul_f32 v[76:77], v[76:77], v[20:21] op_sel:[0,1]
    v_pk_mul_f32 v[78:79], v[78:79], v[20:21] op_sel:[0,1]
    v_pk_mul_f32 v[80:81], v[80:81], v[20:21] op_sel:[0,1]
    v_pk_mul_f32 v[82:83], v[82:83], v[20:21] op_sel:[0,1]
    v_pk_mul_f32 v[84:85], v[84:85], v[20:21] op_sel:[0,1]
    v_pk_mul_f32 v[86:87], v[86:87], v[20:21] op_sel:[0,1]
    v_pk_mul_f32 v[88:89], v[88:89], v[20:21] op_sel:[0,1]
    v_pk_mul_f32 v[90:91], v[90:91], v[20:21] op_sel:[0,1]
    v_cvt_pk_bf16_f32 v76, 0, v76
    v_cvt_pk_bf16_f32 v77, 0, v77
    v_cvt_pk_bf16_f32 v78, 0, v78
    v_cvt_pk_bf16_f32 v79, 0, v79
    v_cvt_pk_bf16_f32 v80, 0, v80
    v_cvt_pk_bf16_f32 v81, 0, v81
    v_cvt_pk_bf16_f32 v82, 0, v82
    v_cvt_pk_bf16_f32 v83, 0, v83
    v_cvt_pk_bf16_f32 v84, 0, v84
    v_cvt_pk_bf16_f32 v85, 0, v85
    v_cvt_pk_bf16_f32 v86, 0, v86
    v_cvt_pk_bf16_f32 v87, 0, v87
    v_cvt_pk_bf16_f32 v88, 0, v88
    v_cvt_pk_bf16_f32 v89, 0, v89
    v_cvt_pk_bf16_f32 v90, 0, v90
    v_cvt_pk_bf16_f32 v91, 0, v91
    v_pk_mul_f32 v[76:77], v[76:77], v[108:109]
    v_pk_mul_f32 v[78:79], v[78:79], v[110:111]
    v_pk_mul_f32 v[80:81], v[80:81], v[112:113]
    v_pk_mul_f32 v[82:83], v[82:83], v[114:115]
    v_pk_mul_f32 v[84:85], v[84:85], v[116:117]
    v_pk_mul_f32 v[86:87], v[86:87], v[118:119]
    v_pk_mul_f32 v[88:89], v[88:89], v[120:121]
    v_pk_mul_f32 v[90:91], v[90:91], v[122:123]
    v_cvt_pk_bf16_f32 v76, 0, v76
    v_cvt_pk_bf16_f32 v77, 0, v77
    v_cvt_pk_bf16_f32 v78, 0, v78
    v_cvt_pk_bf16_f32 v79, 0, v79
    v_cvt_pk_bf16_f32 v80, 0, v80
    v_cvt_pk_bf16_f32 v81, 0, v81
    v_cvt_pk_bf16_f32 v82, 0, v82
    v_cvt_pk_bf16_f32 v83, 0, v83
    v_cvt_pk_bf16_f32 v84, 0, v84
    v_cvt_pk_bf16_f32 v85, 0, v85
    v_cvt_pk_bf16_f32 v86, 0, v86
    v_cvt_pk_bf16_f32 v87, 0, v87
    v_cvt_pk_bf16_f32 v88, 0, v88
    v_cvt_pk_bf16_f32 v89, 0, v89
    v_cvt_pk_bf16_f32 v90, 0, v90
    v_cvt_pk_bf16_f32 v91, 0, v91
    v_pk_add_f32 v[76:77], v[76:77], v[92:93]
    v_pk_add_f32 v[78:79], v[78:79], v[94:95]
    v_pk_add_f32 v[80:81], v[80:81], v[96:97]
    v_pk_add_f32 v[82:83], v[82:83], v[98:99]
    v_pk_add_f32 v[84:85], v[84:85], v[100:101]
    v_pk_add_f32 v[86:87], v[86:87], v[102:103]
    v_pk_add_f32 v[88:89], v[88:89], v[104:105]
    v_pk_add_f32 v[90:91], v[90:91], v[106:107]
    v_cvt_pk_bf16_f32 v76, 0, v76
    v_cvt_pk_bf16_f32 v77, 0, v77
    v_cvt_pk_bf16_f32 v78, 0, v78
    v_cvt_pk_bf16_f32 v79, 0, v79
    v_cvt_pk_bf16_f32 v80, 0, v80
    v_cvt_pk_bf16_f32 v81, 0, v81
    v_cvt_pk_bf16_f32 v82, 0, v82
    v_cvt_pk_bf16_f32 v83, 0, v83
    v_cvt_pk_bf16_f32 v84, 0, v84
    v_cvt_pk_bf16_f32 v85, 0, v85
    v_cvt_pk_bf16_f32 v86, 0, v86
    v_cvt_pk_bf16_f32 v87, 0, v87
    v_cvt_pk_bf16_f32 v88, 0, v88
    v_cvt_pk_bf16_f32 v89, 0, v89
    v_cvt_pk_bf16_f32 v90, 0, v90
    v_cvt_pk_bf16_f32 v91, 0, v91
    s_lshr_b32 s96, s3, 2
    s_lshl_b32 s97, s96, 15
    s_and_b32 s98, s3, 3
    s_lshl_b32 s99, s98, 5
    s_add_u32 s96, s97, s99
    s_add_u32 s13, s96, 32768
    v_lshrrev_b32 v24, 4, v1
    v_lshlrev_b32 v24, 13, v24
    v_bfe_u32 v9, v1, 2, 2
    v_lshl_add_u32 v24, v9, 7, v24
    v_bfe_u32 v9, v1, 3, 2
    v_lshl_add_u32 v24, v9, 5, v24
    v_and_b32 v9, 3, v1
    v_lshl_add_u32 v24, v9, 3, v24
    v_xor_b32 v24, s13, v24
    s_lshl_b32 s13, s3, 6
    v_bfe_u32 v45, v1, 2, 1
    v_lshlrev_b32 v45, 9, v45
    v_bfe_u32 v9, v1, 3, 1
    v_lshl_add_u32 v45, v9, 12, v45
    v_lshrrev_b32 v9, 5, v1
    v_lshl_add_u32 v45, v9, 11, v45
    v_bfe_u32 v9, v1, 2, 2
    v_lshl_add_u32 v45, v9, 6, v45
    v_bfe_u32 v9, v1, 4, 1
    v_lshl_add_u32 v45, v9, 5, v45
    v_and_b32 v9, 3, v1
    v_lshl_add_u32 v45, v9, 3, v45
    v_xor_b32 v45, s13, v45
    v_add_u32 v45, 98304, v45
    v_and_b32 v46, 7, v1
    v_lshlrev_b32 v46, 4, v46
    v_lshrrev_b32 v9, 4, v1
    v_lshl_add_u32 v46, v9, 7, v46
    v_add_u32 v46, 136704, v46
    s_lshl4_add_u32 s13, s3, 136256
    v_mov_b32 v4, s13
    v_and_b32 v5, 7, v1
    v_lshlrev_b32 v5, 4, v5
    v_add_u32 v5, 136256, v5
    v_and_b32 v8, 8, v1
    v_cmp_eq_u32 s[22:23], 0, v8
    s_branch SCHK_46
SPOLL_45:
    s_load_dwordx8 s[24:31], s[32:33], s92 offset:2560 glc
SCHK_46:
    s_add_u32 s5, s5, 1
    s_cmp_ge_u32 s5, 300000
    s_waitcnt lgkmcnt(0)
    s_cbranch_scc1 SDONE_47
    s_cmp_lg_u32 s25, s4
    s_cbranch_scc1 SPOLL_45
    s_cmp_lg_u32 s27, s4
    s_cbranch_scc1 SPOLL_45
    s_cmp_lg_u32 s29, s4
    s_cbranch_scc1 SPOLL_45
    s_cmp_lg_u32 s31, s4
    s_cbranch_scc1 SPOLL_45
SDONE_47:
    s_min_u32 s25, s24, s28
    s_max_u32 s24, s24, s28
    s_max_u32 s27, s26, s30
    s_min_u32 s26, s26, s30
    s_max_u32 s28, s25, s27
    s_min_u32 s25, s25, s27
    v_mov_b32 v148, s24
    v_mov_b32 v151, s26
    v_mov_b32 v149, s28
    v_mov_b32 v150, s25
    ds_write_b128 v4, v[148:151]
    s_waitcnt lgkmcnt(0)
    s_barrier
    s_cmp_lt_u32 s3, 4
    s_cbranch_scc1 L_CSEL
    ds_read_b64_tr_b16 v[164:165], v24
    ds_read_b64_tr_b16 v[166:167], v24 offset:512
    ds_read_b64_tr_b16 v[168:169], v24 offset:1024
    ds_read_b64_tr_b16 v[170:171], v24 offset:1536
    ds_read_b64_tr_b16 v[172:173], v24 offset:2048
    ds_read_b64_tr_b16 v[174:175], v24 offset:2560
    ds_read_b64_tr_b16 v[176:177], v24 offset:3072
    ds_read_b64_tr_b16 v[178:179], v24 offset:3584
    ds_read_b64_tr_b16 v[180:181], v24 offset:4096
    ds_read_b64_tr_b16 v[182:183], v24 offset:4608
    ds_read_b64_tr_b16 v[184:185], v24 offset:5120
    ds_read_b64_tr_b16 v[186:187], v24 offset:5632
    ds_read_b64_tr_b16 v[188:189], v24 offset:6144
    ds_read_b64_tr_b16 v[190:191], v24 offset:6656
    ds_read_b64_tr_b16 v[192:193], v24 offset:7168
    ds_read_b64_tr_b16 v[194:195], v24 offset:7680
    v_mul_u32_u24_dpp v92, v70, v52 row_newbcast:0 row_mask:0xf bank_mask:0xf
    v_and_b32_dpp v93, v70, v53 row_newbcast:0 row_mask:0xf bank_mask:0xf
    v_mul_u32_u24_dpp v94, v70, v52 row_newbcast:1 row_mask:0xf bank_mask:0xf
    v_and_b32_dpp v95, v70, v53 row_newbcast:1 row_mask:0xf bank_mask:0xf
    v_mul_u32_u24_dpp v96, v70, v52 row_newbcast:2 row_mask:0xf bank_mask:0xf
    v_and_b32_dpp v97, v70, v53 row_newbcast:2 row_mask:0xf bank_mask:0xf
    v_mul_u32_u24_dpp v98, v70, v52 row_newbcast:3 row_mask:0xf bank_mask:0xf
    v_and_b32_dpp v99, v70, v53 row_newbcast:3 row_mask:0xf bank_mask:0xf
    v_mul_u32_u24_dpp v100, v70, v52 row_newbcast:4 row_mask:0xf bank_mask:0xf
    v_and_b32_dpp v101, v70, v53 row_newbcast:4 row_mask:0xf bank_mask:0xf
    v_mul_u32_u24_dpp v102, v70, v52 row_newbcast:5 row_mask:0xf bank_mask:0xf
    v_and_b32_dpp v103, v70, v53 row_newbcast:5 row_mask:0xf bank_mask:0xf
    v_mul_u32_u24_dpp v104, v70, v52 row_newbcast:6 row_mask:0xf bank_mask:0xf
    v_and_b32_dpp v105, v70, v53 row_newbcast:6 row_mask:0xf bank_mask:0xf
    v_mul_u32_u24_dpp v106, v70, v52 row_newbcast:7 row_mask:0xf bank_mask:0xf
    v_and_b32_dpp v107, v70, v53 row_newbcast:7 row_mask:0xf bank_mask:0xf
    v_pk_mul_f32 v[76:77], v[76:77], v[92:93]
    v_pk_mul_f32 v[78:79], v[78:79], v[94:95]
    v_pk_mul_f32 v[80:81], v[80:81], v[96:97]
    v_pk_mul_f32 v[82:83], v[82:83], v[98:99]
    v_pk_mul_f32 v[84:85], v[84:85], v[100:101]
    v_pk_mul_f32 v[86:87], v[86:87], v[102:103]
    v_pk_mul_f32 v[88:89], v[88:89], v[104:105]
    v_pk_mul_f32 v[90:91], v[90:91], v[106:107]
    v_cvt_pk_bf16_f32 v76, 0, v76
    v_cvt_pk_bf16_f32 v77, 0, v77
    v_cvt_pk_bf16_f32 v78, 0, v78
    v_cvt_pk_bf16_f32 v79, 0, v79
    v_cvt_pk_bf16_f32 v80, 0, v80
    v_cvt_pk_bf16_f32 v81, 0, v81
    v_cvt_pk_bf16_f32 v82, 0, v82
    v_cvt_pk_bf16_f32 v83, 0, v83
    v_cvt_pk_bf16_f32 v84, 0, v84
    v_cvt_pk_bf16_f32 v85, 0, v85
    v_cvt_pk_bf16_f32 v86, 0, v86
    v_cvt_pk_bf16_f32 v87, 0, v87
    v_cvt_pk_bf16_f32 v88, 0, v88
    v_cvt_pk_bf16_f32 v89, 0, v89
    v_cvt_pk_bf16_f32 v90, 0, v90
    v_cvt_pk_bf16_f32 v91, 0, v91
    v_pk_add_f32 v[76:77], v[76:77], v[28:29]
    v_pk_add_f32 v[78:79], v[78:79], v[30:31]
    v_pk_add_f32 v[80:81], v[80:81], v[32:33]
    v_pk_add_f32 v[82:83], v[82:83], v[34:35]
    v_pk_add_f32 v[84:85], v[84:85], v[36:37]
    v_pk_add_f32 v[86:87], v[86:87], v[38:39]
    v_pk_add_f32 v[88:89], v[88:89], v[40:41]
    v_pk_add_f32 v[90:91], v[90:91], v[42:43]
    v_cvt_pk_bf16_f32 v140, v76, v77
    v_cvt_pk_bf16_f32 v141, v78, v79
    v_cvt_pk_bf16_f32 v142, v80, v81
    v_cvt_pk_bf16_f32 v143, v82, v83
    v_cvt_pk_bf16_f32 v144, v84, v85
    v_cvt_pk_bf16_f32 v145, v86, v87
    v_cvt_pk_bf16_f32 v146, v88, v89
    v_cvt_pk_bf16_f32 v147, v90, v91
    ds_write_b128 v23, v[140:143]
    ds_write_b128 v23, v[144:147] offset:16
    s_mul_i32 s96, s3, 2304
    s_add_u32 s16, s96, 139776
    v_lshrrev_b32 v23, 3, v1
    v_mul_u32_u24 v23, 144, v23
    v_and_b32 v9, 7, v1
    v_lshl_add_u32 v23, v9, 4, v23
    v_add_u32 v23, s16, v23
    s_add_u32 s13, s81, 12288
    s_lshl2_add_u32 m0, s89, 101376
    s_nop 0
    buffer_load_dwordx4 v73, s[60:63], s13 offen nt lds
    s_branch L_CSELD
L_CSEL:
    ds_read_b128 v[148:151], v5
    s_lshl_b32 s96, s3, 9
    s_add_u32 s13, s96, 136704
    v_add_u32 v6, s13, v63
    s_lshl2_add_u32 s13, s3, 136384
    v_mov_b32 v7, s13
    s_waitcnt lgkmcnt(0)
    v_max_u32_dpp v152, v151, v148 quad_perm:[1,0,3,2] row_mask:0xf bank_mask:0xf
    v_max_u32_dpp v153, v150, v149 quad_perm:[1,0,3,2] row_mask:0xf bank_mask:0xf
    v_max_u32_dpp v154, v149, v150 quad_perm:[1,0,3,2] row_mask:0xf bank_mask:0xf
    v_max_u32_dpp v155, v148, v151 quad_perm:[1,0,3,2] row_mask:0xf bank_mask:0xf
    v_max_u32 v156, v152, v154
    v_max_u32 v157, v153, v155
    v_min_u32 v158, v152, v154
    v_min_u32 v159, v153, v155
    v_max_u32 v148, v156, v157
    v_min_u32 v149, v156, v157
    v_max_u32 v150, v158, v159
    v_min_u32 v151, v158, v159
    s_nop 1
    v_max_u32_dpp v152, v151, v148 quad_perm:[2,3,0,1] row_mask:0xf bank_mask:0xf
    v_max_u32_dpp v153, v150, v149 quad_perm:[2,3,0,1] row_mask:0xf bank_mask:0xf
    v_max_u32_dpp v154, v149, v150 quad_perm:[2,3,0,1] row_mask:0xf bank_mask:0xf
    v_max_u32_dpp v155, v148, v151 quad_perm:[2,3,0,1] row_mask:0xf bank_mask:0xf
    v_max_u32 v156, v152, v154
    v_max_u32 v157, v153, v155
    v_min_u32 v158, v152, v154
    v_min_u32 v159, v153, v155
    v_max_u32 v148, v156, v157
    v_min_u32 v149, v156, v157
    v_max_u32 v150, v158, v159
    v_min_u32 v151, v158, v159
    s_nop 1
    v_max_u32_dpp v152, v151, v148 row_half_mirror row_mask:0xf bank_mask:0xf
    v_max_u32_dpp v153, v150, v149 row_half_mirror row_mask:0xf bank_mask:0xf
    v_max_u32_dpp v154, v149, v150 row_half_mirror row_mask:0xf bank_mask:0xf
    v_max_u32_dpp v155, v148, v151 row_half_mirror row_mask:0xf bank_mask:0xf
    v_readfirstlane_b32 s24, v152
    v_readfirstlane_b32 s25, v153
    v_readfirstlane_b32 s26, v154
    v_readfirstlane_b32 s27, v155
    s_bitcmp1_b32 s3, 0
    s_cselect_b32 s24, s25, s24
    s_cselect_b32 s26, s27, s26
    s_bitcmp1_b32 s3, 1
    s_cselect_b32 s24, s26, s24
    s_and_b32 s15, s24, 4095
    s_lshr_b32 s96, s15, 8
    s_sub_u32 s97, 15, s96
    s_and_b32 s98, s15, 1
    s_lshl1_add_u32 s99, s97, s98
    s_lshl_b32 s96, s99, 14
    s_add_u32 s13, s96, 33554432
    s_lshl_b32 s96, s75, 10
    s_add_u32 s14, s96, s13
    s_add_u32 s13, s13, 8192
    v_and_b32 v10, 15, v1
    v_lshlrev_b32 v10, 3, v10
    buffer_load_dwordx2 v[152:153], v10, s[32:35], s13 offen sc1
    buffer_load_dwordx4 v[148:151], v2, s[32:35], s14 offen sc1
    s_add_u32 s16, s81, 12288
    s_lshl2_add_u32 m0, s89, 101376
    s_nop 0
    buffer_load_dwordx4 v73, s[60:63], s16 offen nt lds
    ds_read_b64_tr_b16 v[164:165], v24
    ds_read_b64_tr_b16 v[166:167], v24 offset:512
    ds_read_b64_tr_b16 v[168:169], v24 offset:1024
    ds_read_b64_tr_b16 v[170:171], v24 offset:1536
    ds_read_b64_tr_b16 v[172:173], v24 offset:2048
    ds_read_b64_tr_b16 v[174:175], v24 offset:2560
    ds_read_b64_tr_b16 v[176:177], v24 offset:3072
    ds_read_b64_tr_b16 v[178:179], v24 offset:3584
    ds_read_b64_tr_b16 v[180:181], v24 offset:4096
    ds_read_b64_tr_b16 v[182:183], v24 offset:4608
    ds_read_b64_tr_b16 v[184:185], v24 offset:5120
    ds_read_b64_tr_b16 v[186:187], v24 offset:5632
    ds_read_b64_tr_b16 v[188:189], v24 offset:6144
    ds_read_b64_tr_b16 v[190:191], v24 offset:6656
    ds_read_b64_tr_b16 v[192:193], v24 offset:7168
    ds_read_b64_tr_b16 v[194:195], v24 offset:7680
    v_mul_u32_u24_dpp v92, v70, v52 row_newbcast:0 row_mask:0xf bank_mask:0xf
    v_and_b32_dpp v93, v70, v53 row_newbcast:0 row_mask:0xf bank_mask:0xf
    v_mul_u32_u24_dpp v94, v70, v52 row_newbcast:1 row_mask:0xf bank_mask:0xf
    v_and_b32_dpp v95, v70, v53 row_newbcast:1 row_mask:0xf bank_mask:0xf
    v_mul_u32_u24_dpp v96, v70, v52 row_newbcast:2 row_mask:0xf bank_mask:0xf
    v_and_b32_dpp v97, v70, v53 row_newbcast:2 row_mask:0xf bank_mask:0xf
    v_mul_u32_u24_dpp v98, v70, v52 row_newbcast:3 row_mask:0xf bank_mask:0xf
    v_and_b32_dpp v99, v70, v53 row_newbcast:3 row_mask:0xf bank_mask:0xf
    v_mul_u32_u24_dpp v100, v70, v52 row_newbcast:4 row_mask:0xf bank_mask:0xf
    v_and_b32_dpp v101, v70, v53 row_newbcast:4 row_mask:0xf bank_mask:0xf
    v_mul_u32_u24_dpp v102, v70, v52 row_newbcast:5 row_mask:0xf bank_mask:0xf
    v_and_b32_dpp v103, v70, v53 row_newbcast:5 row_mask:0xf bank_mask:0xf
    v_mul_u32_u24_dpp v104, v70, v52 row_newbcast:6 row_mask:0xf bank_mask:0xf
    v_and_b32_dpp v105, v70, v53 row_newbcast:6 row_mask:0xf bank_mask:0xf
    v_mul_u32_u24_dpp v106, v70, v52 row_newbcast:7 row_mask:0xf bank_mask:0xf
    v_and_b32_dpp v107, v70, v53 row_newbcast:7 row_mask:0xf bank_mask:0xf
    v_pk_mul_f32 v[76:77], v[76:77], v[92:93]
    v_pk_mul_f32 v[78:79], v[78:79], v[94:95]
    v_pk_mul_f32 v[80:81], v[80:81], v[96:97]
    v_pk_mul_f32 v[82:83], v[82:83], v[98:99]
    v_pk_mul_f32 v[84:85], v[84:85], v[100:101]
    v_pk_mul_f32 v[86:87], v[86:87], v[102:103]
    v_pk_mul_f32 v[88:89], v[88:89], v[104:105]
    v_pk_mul_f32 v[90:91], v[90:91], v[106:107]
    v_cvt_pk_bf16_f32 v76, 0, v76
    v_cvt_pk_bf16_f32 v77, 0, v77
    v_cvt_pk_bf16_f32 v78, 0, v78
    v_cvt_pk_bf16_f32 v79, 0, v79
    v_cvt_pk_bf16_f32 v80, 0, v80
    v_cvt_pk_bf16_f32 v81, 0, v81
    v_cvt_pk_bf16_f32 v82, 0, v82
    v_cvt_pk_bf16_f32 v83, 0, v83
    v_cvt_pk_bf16_f32 v84, 0, v84
    v_cvt_pk_bf16_f32 v85, 0, v85
    v_cvt_pk_bf16_f32 v86, 0, v86
    v_cvt_pk_bf16_f32 v87, 0, v87
    v_cvt_pk_bf16_f32 v88, 0, v88
    v_cvt_pk_bf16_f32 v89, 0, v89
    v_cvt_pk_bf16_f32 v90, 0, v90
    v_cvt_pk_bf16_f32 v91, 0, v91
    v_pk_add_f32 v[76:77], v[76:77], v[28:29]
    v_pk_add_f32 v[78:79], v[78:79], v[30:31]
    v_pk_add_f32 v[80:81], v[80:81], v[32:33]
    v_pk_add_f32 v[82:83], v[82:83], v[34:35]
    v_pk_add_f32 v[84:85], v[84:85], v[36:37]
    v_pk_add_f32 v[86:87], v[86:87], v[38:39]
    v_pk_add_f32 v[88:89], v[88:89], v[40:41]
    v_pk_add_f32 v[90:91], v[90:91], v[42:43]
    v_cvt_pk_bf16_f32 v140, v76, v77
    v_cvt_pk_bf16_f32 v141, v78, v79
    v_cvt_pk_bf16_f32 v142, v80, v81
    v_cvt_pk_bf16_f32 v143, v82, v83
    v_cvt_pk_bf16_f32 v144, v84, v85
    v_cvt_pk_bf16_f32 v145, v86, v87
    v_cvt_pk_bf16_f32 v146, v88, v89
    v_cvt_pk_bf16_f32 v147, v90, v91
    ds_write_b128 v23, v[140:143]
    ds_write_b128 v23, v[144:147] offset:16
    s_mul_i32 s96, s3, 2304
    s_add_u32 s16, s96, 139776
    v_lshrrev_b32 v23, 3, v1
    v_mul_u32_u24 v23, 144, v23
    v_and_b32 v9, 7, v1
    v_lshl_add_u32 v23, v9, 4, v23
    v_add_u32 v23, s16, v23
    s_lshl2_add_u32 s15, s15, s3
    s_waitcnt vmcnt(1)
    v_bitop3_b32 v8, v149, v151, s4 bitop3:0x7e
    v_bitop3_b32 v8, v8, v153, s4 bitop3:0xf6
    v_cmp_ne_u32 vcc, 0, v8
    s_cbranch_vccz TOK_49
POLL_50:
    buffer_load_dwordx2 v[152:153], v10, s[32:35], s13 offen sc1
    buffer_load_dwordx4 v[148:151], v2, s[32:35], s14 offen sc1
    s_waitcnt vmcnt(0)
    v_bitop3_b32 v8, v149, v151, s4 bitop3:0x7e
    v_bitop3_b32 v8, v8, v153, s4 bitop3:0xf6
    v_cmp_ne_u32 vcc, 0, v8
    s_cbranch_vccz PDONE_51
    s_add_u32 s5, s5, 1
    s_cmp_lt_u32 s5, 300000
    s_cbranch_scc1 POLL_50
PDONE_51:
TOK_49:
    ds_write2_b32 v6, v148, v150 offset0:0 offset1:1
    v_add_f32_dpp v152, v152, v152 quad_perm:[1,0,3,2] row_mask:0xf bank_mask:0xf
    s_nop 1
    v_add_f32_dpp v152, v152, v152 quad_perm:[2,3,0,1] row_mask:0xf bank_mask:0xf
    s_nop 1
    v_add_f32_dpp v152, v152, v152 row_half_mirror row_mask:0xf bank_mask:0xf
    s_nop 1
    v_add_f32_dpp v152, v152, v152 row_ror:8 row_mask:0xf bank_mask:0xf
    v_cvt_pk_bf16_f32 v152, 0, v152
    v_ashrrev_i32 v153, 31, v152
    v_or_b32 v153, 0x80000000, v153
    v_xor_b32 v152, v152, v153
    v_and_b32 v152, s6, v152
    v_or_b32 v152, s15, v152
    ds_write_b32 v7, v152
L_CSELD:
    v_mov_b32 v4, 136384
    v_and_b32 v8, 15, v1
    v_lshlrev_b32 v8, 4, v8
    v_lshrrev_b32 v9, 5, v1
    v_lshl_add_u32 v8, v9, 3, v8
    s_lshl_b32 s96, s74, 13
    s_add_u32 s14, s96, 20971520
    s_lshl3_add_u32 s96, s75, s3
    s_lshl_b32 s97, s96, 8
    s_add_u32 s20, s97, s14
    s_waitcnt lgkmcnt(0)
    s_barrier
    ds_read_b128 v[148:151], v4
    s_waitcnt lgkmcnt(0)
    v_max_u32 v152, v148, v149
    v_max_u32 v153, v150, v151
    v_min_u32 v154, v148, v149
    v_min_u32 v155, v150, v151
    v_min_u32 v149, v152, v153
    v_max_u32 v148, v152, v153
    v_max3_u32 v149, v149, v154, v155
    v_cndmask_b32 v4, v149, v148, s[22:23]
    v_readfirstlane_b32 s68, v148
    v_and_b32 v4, 3, v4
    v_readfirstlane_b32 s69, v149
    v_lshl_add_u32 v4, v4, 9, v46
    ds_read_b128 v[152:155], v4
    ds_read_b128 v[140:143], v23
    ds_read_b128 v[144:147], v23 offset:1152
    s_bfe_u32 s70, s68, 720899
    s_bfe_u32 s71, s69, 720899
    s_sub_u32 s70, 2047, s70
    s_sub_u32 s71, 2047, s71
    s_waitcnt lgkmcnt(2)
    v_mfma_f32_16x16x32_bf16 v[212:215], v[152:155], v[164:167], 0
    v_mfma_f32_16x16x32_bf16 v[216:219], v[152:155], v[168:171], 0
    v_mfma_f32_16x16x32_bf16 v[220:223], v[152:155], v[172:175], 0
    v_mfma_f32_16x16x32_bf16 v[224:227], v[152:155], v[176:179], 0
    v_mfma_f32_16x16x32_bf16 v[228:231], v[152:155], v[180:183], 0
    v_mfma_f32_16x16x32_bf16 v[232:235], v[152:155], v[184:187], 0
    v_mfma_f32_16x16x32_bf16 v[236:239], v[152:155], v[188:191], 0
    v_mfma_f32_16x16x32_bf16 v[240:243], v[152:155], v[192:195], 0
    s_nop 1
    v_add_f32 v148, v212, v217
    s_nop 0
    v_add_f32 v149, v222, v227
    s_nop 0
    v_add_f32 v150, v228, v233
    s_nop 0
    v_add_f32 v151, v238, v243
    v_add_f32 v148, v148, v149
    v_add_f32 v150, v150, v151
    v_mov_b32 v149, s4
    s_nop 0
    v_permlane16_swap_b32 v150, v151
    s_cmp_ge_u32 s9, 28
    s_cbranch_scc1 L_NOHP
    v_add_f32 v148, v148, v151
    s_mov_b32 exec_lo, 0xffff
    s_mov_b32 exec_hi, 0xffff
    s_cmp_lg_u32 s93, 0
    s_cbranch_scc1 LOC_52
    buffer_store_dwordx2 v[148:149], v8, s[32:35], s20 offen sc1
    s_branch LOCD_53
LOC_52:
    buffer_store_dwordx2 v[148:149], v8, s[32:35], s20 offen
LOCD_53:
    s_mov_b64 exec, -1
L_NOHP:
    v_mov_b32 v56, v148
    v_mov_b32 v57, v149
    v_add_u32 v58, s20, v8
    s_waitcnt lgkmcnt(0)
    s_bitcmp1_b32 s21, 2
    s_cselect_b32 s17, s71, s70
    s_cselect_b32 s18, s69, s68
    s_cmp_lg_u32 s3, 7
    s_cbranch_scc1 L_NOFZ
    s_cmp_lg_u32 s2, 0
    s_cbranch_scc1 L_NONON
    v_mov_b32 v6, s4
    s_mov_b64 exec, 1
    buffer_store_dword v6, v3, s[32:35], 0 offen sc1
    s_mov_b64 exec, -1
L_NONON:
    s_lshr_b32 s96, s21, 3
    s_and_b32 s97, s21, 1
    s_lshl1_add_u32 s19, s96, s97
    s_lshr_b32 s96, s21, 2
    s_lshl_b32 s97, s96, 1
    s_lshl3_add_u32 s98, s12, s97
    s_and_b32 s99, s21, 1
    s_add_u32 s96, s98, s99
    s_mul_i32 s97, s96, 7168
    s_add_u32 s20, s97, 22020096
    s_lshl_b32 s96, s17, 11
    s_lshl_b32 s97, s12, 7
    s_add_u32 s98, s96, s97
    s_lshl_b32 s99, s19, 5
    s_add_u32 s82, s98, s99
    v_and_b32 v10, 7, v1
    v_lshlrev_b32 v10, 2, v10
    s_lshl_b32 s96, s19, 5
    s_add_u32 s13, s96, 139264
    v_add_u32 v5, s13, v10
    ds_read_b32 v74, v5
    s_lshr_b32 s96, s17, 7
    s_bfe_u32 s97, s18, 65538
    s_lshl1_add_u32 s98, s96, s97
    s_lshl_b32 s99, s98, 14
    s_lshl_b32 s96, s12, 8
    s_add_u32 s97, s99, s96
    s_lshl_b32 s98, s19, 6
    s_add_u32 s99, s97, s98
    s_add_u32 s68, s99, 33554432
    s_add_u32 s69, s68, 4096
    v_and_b32 v11, 7, v1
    v_lshlrev_b32 v11, 3, v11
    buffer_load_dwordx2 v[20:21], v11, s[32:35], s68 offen sc1
    buffer_load_dwordx2 v[72:73], v11, s[32:35], s69 offen sc1
    s_and_b32 s13, s18, s6
    s_ashr_i32 s15, s13, 31
    s_andn2_b32 s15, 0x7fff0000, s15
    s_or_b32 s15, s15, 0x80000000
    s_xor_b32 s13, s13, s15
    v_mov_b32 v75, s13
    v_mul_f32 v75, s7, v75
    v_exp_f32 v75, -v75
    s_nop 0
    v_add_f32 v75, 1.0, v75
    v_rcp_f32 v75, v75
    s_nop 0
    v_cvt_pk_bf16_f32 v75, 0, v75
L_NOFZ:
    s_cmp_lt_u32 s9, 28
    s_cbranch_scc1 L_HSEC
    s_branch L_GSEC
L_HSEC:
    s_cmp_lt_u32 s3, 4
    s_cbranch_scc1 L_HW
    s_branch L_NOH
L_HW:
    s_lshl_b32 s96, s3, 8
    s_add_u32 s13, s96, s14
    v_lshrrev_b32 v4, 4, v1
    v_lshlrev_b32 v4, 11, v4
    v_and_b32 v9, 15, v1
    v_lshl_add_u32 v4, v9, 4, v4
    s_lshl_b32 s96, s3, 5
    s_add_u32 s15, s96, 138752
    v_lshrrev_b32 v5, 5, v1
    v_lshl_add_u32 v5, v5, 7, s15
    v_bfe_u32 v9, v1, 2, 1
    v_lshl_add_u32 v5, v9, 4, v5
    v_bfe_u32 v9, v1, 1, 1
    v_lshl_add_u32 v5, v9, 3, v5
    v_bfe_u32 v9, v1, 3, 1
    v_lshl_add_u32 v5, v9, 2, v5
    v_and_b32 v9, 1, v1
    v_lshl_add_u32 v5, v9, 1, v5
    s_cmp_lg_u32 s93, 0
    s_cbranch_scc1 L_HLOC
SPOLL_54:
    s_load_dword s24, s[32:33], s13 offset:1276 glc
    s_load_dword s25, s[32:33], s13 offset:3324 glc
    s_load_dword s26, s[32:33], s13 offset:5372 glc
    s_load_dword s27, s[32:33], s13 offset:7420 glc
SCHK_55:
    s_add_u32 s5, s5, 1
    s_cmp_ge_u32 s5, 300000
    s_waitcnt lgkmcnt(0)
    s_cbranch_scc1 SDONE_56
    s_cmp_lg_u32 s24, s4
    s_cbranch_scc1 SPOLL_54
    s_cmp_lg_u32 s25, s4
    s_cbranch_scc1 SPOLL_54
    s_cmp_lg_u32 s26, s4
    s_cbranch_scc1 SPOLL_54
    s_cmp_lg_u32 s27, s4
    s_cbranch_scc1 SPOLL_54
SDONE_56:
L_HLOC:
    buffer_load_dwordx4 v[212:215], v4, s[32:35], s13 offen sc1
    buffer_load_dwordx4 v[216:219], v4, s[32:35], s13 offen offset:1024 sc1
    s_waitcnt vmcnt(0)
    v_bitop3_b32 v6, v213, v215, s4 bitop3:0x7e
    v_bitop3_b32 v6, v6, v217, s4 bitop3:0xf6
    v_bitop3_b32 v6, v6, v219, s4 bitop3:0xf6
    v_cmp_ne_u32 vcc, 0, v6
    s_cbranch_vccz TOK_58
POLL_59:
    buffer_load_dwordx4 v[212:215], v4, s[32:35], s13 offen sc1
    buffer_load_dwordx4 v[216:219], v4, s[32:35], s13 offen offset:1024 sc1
    s_waitcnt vmcnt(0)
    v_bitop3_b32 v6, v213, v215, s4 bitop3:0x7e
    v_bitop3_b32 v6, v6, v217, s4 bitop3:0xf6
    v_bitop3_b32 v6, v6, v219, s4 bitop3:0xf6
    v_cmp_ne_u32 vcc, 0, v6
    s_cbranch_vccz PDONE_60
    s_add_u32 s5, s5, 1
    s_cmp_lt_u32 s5, 300000
    s_cbranch_scc1 POLL_59
PDONE_60:
TOK_58:
    v_permlane32_swap_b32 v212, v214
    v_permlane32_swap_b32 v216, v218
    v_add_f32 v212, v212, v214
    v_add_f32 v216, v216, v218
    v_mov_b32 v214, v212
    v_mov_b32 v218, v216
    s_nop 0
    v_permlane16_swap_b32 v212, v214
    v_permlane16_swap_b32 v216, v218
    v_add_f32 v212, v212, v214
    v_add_f32 v216, v216, v218
    v_cvt_pk_bf16_f32 v212, 0, v212
    v_cvt_pk_bf16_f32 v216, 0, v216
    v_mul_f32 v6, s7, v212
    v_exp_f32 v6, -v6
    s_nop 0
    v_add_f32 v6, 1.0, v6
    v_rcp_f32 v6, v6
    s_nop 0
    v_mul_f32 v212, v212, v6
    v_cvt_pk_bf16_f32 v212, 0, v212
    v_mul_f32 v212, v212, v216
    v_cvt_pk_bf16_f32 v212, v212, v212
    ds_write_b16 v5, v212
L_NOH:
    v_bfe_u32 v4, v1, 2, 1
    v_lshlrev_b32 v4, 7, v4
    v_lshrrev_b32 v9, 5, v1
    v_lshl_add_u32 v4, v9, 4, v4
    v_add_u32 v4, 138752, v4
    v_lshrrev_b32 v5, 4, v1
    v_mul_u32_u24 v5, 7168, v5
    v_and_b32 v9, 15, v1
    v_lshl_add_u32 v5, v9, 3, v5
    v_and_b32 v6, 1, v1
    v_lshlrev_b32 v6, 18, v6
    v_bfe_u32 v9, v1, 1, 1
    v_lshl_add_u32 v6, v9, 13, v6
    s_lshl3_add_u32 s96, s75, s3
    s_mul_i32 s97, s96, 28672
    s_lshl_b32 s98, s74, 7
    s_add_u32 s99, s97, s98
    s_add_u32 s13, s99, 22020096
    s_lshr_b32 s96, s9, 2
    s_and_b32 s97, s75, 1
    s_lshr_b32 s98, s3, 1
    s_lshl2_add_u32 s99, s97, s98
    s_and_b32 s97, s3, 1
    s_lshl_b32 s98, s97, 2
    s_lshl3_add_u32 s97, s99, s98
    s_lshr_b32 s99, s75, 1
    s_add_u32 s98, s97, s99
    s_lshl_b32 s97, s98, 12
    s_lshl_b32 s99, s8, 6
    s_add_u32 s98, s97, s99
    s_lshl2_add_u32 s97, s96, s98
    s_add_u32 s99, s97, 1048576
    s_add_u32 s14, s99, 3072
    s_waitcnt vmcnt(0)
    s_waitcnt lgkmcnt(0)
    s_barrier
    ds_read_b128 v[212:215], v4
    ds_read_b64_tr_b16 v[196:197], v45
    ds_read_b64_tr_b16 v[198:199], v45 offset:1024
    ds_read_b128 v[216:219], v4 offset:32
    ds_read_b64_tr_b16 v[200:201], v45 offset:8192
    ds_read_b64_tr_b16 v[202:203], v45 offset:9216
    ds_read_b128 v[220:223], v4 offset:64
    ds_read_b64_tr_b16 v[204:205], v45 offset:16384
    ds_read_b64_tr_b16 v[206:207], v45 offset:17408
    ds_read_b128 v[224:227], v4 offset:96
    ds_read_b64_tr_b16 v[208:209], v45 offset:24576
    ds_read_b64_tr_b16 v[210:211], v45 offset:25600
    s_waitcnt lgkmcnt(9)
    v_mfma_f32_32x32x16_bf16 v[228:243], v[212:215], v[196:199], 0
    s_waitcnt lgkmcnt(6)
    v_mfma_f32_32x32x16_bf16 v[228:243], v[216:219], v[200:203], v[228:243]
    s_waitcnt lgkmcnt(3)
    v_mfma_f32_32x32x16_bf16 v[228:243], v[220:223], v[204:207], v[228:243]
    s_waitcnt lgkmcnt(0)
    v_mfma_f32_32x32x16_bf16 v[228:243], v[224:227], v[208:211], v[228:243]
    s_nop 11
    v_mov_b32 v229, s4
    buffer_store_dwordx2 v[228:229], v5, s[32:35], s13 offen sc1
    s_mov_b64 exec, 15
    buffer_store_dword v229, v6, s[32:35], s14 offen sc1
    s_mov_b64 exec, -1
    s_waitcnt lgkmcnt(0)
L_GSEC:
    s_lshl_b32 s96, s21, 7
    s_lshl4_add_u32 s13, s3, s96
    v_lshrrev_b32 v22, 3, v1
    v_lshl_add_u32 v22, v22, 0, s13
    s_lshl_b32 s96, s13, 11
    s_lshl_b32 s97, s12, 7
    s_add_u32 s15, s96, s97
    s_add_u32 s16, s15, 16384
    v_lshrrev_b32 v25, 3, v1
    v_lshlrev_b32 v25, 11, v25
    v_and_b32 v9, 7, v1
    v_lshl_add_u32 v25, v9, 4, v25
    v_cmp_ne_u32 vcc, s70, v22
    v_cmp_ne_u32 s[22:23], s71, v22
    s_nop 0
    s_and_b64 exec, vcc, s[22:23]
    buffer_store_dwordx4 v[140:143], v25, s[64:67], s15 offen sc1
    s_mov_b64 exec, -1
    v_add_u32 v22, 8, v22
    v_cmp_ne_u32 vcc, s70, v22
    v_cmp_ne_u32 s[22:23], s71, v22
    s_nop 0
    s_and_b64 exec, vcc, s[22:23]
    buffer_store_dwordx4 v[144:147], v25, s[64:67], s16 offen sc1
    s_mov_b64 exec, -1
    s_cmp_lt_u32 s9, 16
    s_cbranch_scc1 L_GF
    s_cmp_ge_u32 s9, 28
    s_cbranch_scc1 L_FIN
    s_waitcnt vmcnt(0)
    s_mov_b32 exec_lo, 0xffff
    s_mov_b32 exec_hi, 0xffff
    buffer_store_dwordx2 v[56:57], v58, s[32:35], 0 offen sc1
    s_mov_b64 exec, -1
    s_branch L_FIN
L_GF:
SPOLL_61:
    s_load_dwordx8 s[24:31], s[32:33], s92 offset:3072 glc
SCHK_62:
    s_add_u32 s5, s5, 1
    s_cmp_ge_u32 s5, 300000
    s_waitcnt lgkmcnt(0)
    s_cbranch_scc1 SDONE_63
    s_cmp_lg_u32 s24, s4
    s_cbranch_scc1 SPOLL_61
    s_cmp_lg_u32 s25, s4
    s_cbranch_scc1 SPOLL_61
    s_cmp_lg_u32 s26, s4
    s_cbranch_scc1 SPOLL_61
    s_cmp_lg_u32 s27, s4
    s_cbranch_scc1 SPOLL_61
    s_cmp_lg_u32 s28, s4
    s_cbranch_scc1 SPOLL_61
    s_cmp_lg_u32 s29, s4
    s_cbranch_scc1 SPOLL_61
    s_cmp_lg_u32 s30, s4
    s_cbranch_scc1 SPOLL_61
SDONE_63:
    s_barrier
    s_cmp_eq_u32 s3, 7
    s_cbranch_scc1 L_G7
    s_barrier
    s_mov_b32 exec_lo, 0xffff
    s_mov_b32 exec_hi, 0xffff
    buffer_store_dwordx2 v[56:57], v58, s[32:35], 0 offen sc1
    s_mov_b64 exec, -1
    s_branch L_FIN
L_G7:
    s_cmp_lg_u32 s3, 7
    s_cbranch_scc1 L_FIN
    s_add_u32 s13, s20, 4096
POLL_64:
    buffer_load_dwordx4 v[212:215], v2, s[32:35], s20 offen sc1
    buffer_load_dwordx4 v[216:219], v2, s[32:35], s20 offen offset:1024 sc1
    buffer_load_dwordx4 v[220:223], v2, s[32:35], s20 offen offset:2048 sc1
    buffer_load_dwordx4 v[224:227], v2, s[32:35], s20 offen offset:3072 sc1
    buffer_load_dwordx4 v[148:151], v2, s[32:35], s13 offen sc1
    buffer_load_dwordx4 v[152:155], v2, s[32:35], s13 offen offset:1024 sc1
    buffer_load_dwordx4 v[156:159], v2, s[32:35], s13 offen offset:2048 sc1
    s_waitcnt vmcnt(0)
    v_bitop3_b32 v4, v213, v215, s4 bitop3:0x7e
    v_bitop3_b32 v4, v4, v217, s4 bitop3:0xf6
    v_bitop3_b32 v4, v4, v219, s4 bitop3:0xf6
    v_bitop3_b32 v4, v4, v221, s4 bitop3:0xf6
    v_bitop3_b32 v4, v4, v223, s4 bitop3:0xf6
    v_bitop3_b32 v4, v4, v225, s4 bitop3:0xf6
    v_bitop3_b32 v4, v4, v227, s4 bitop3:0xf6
    v_bitop3_b32 v4, v4, v149, s4 bitop3:0xf6
    v_bitop3_b32 v4, v4, v151, s4 bitop3:0xf6
    v_bitop3_b32 v4, v4, v153, s4 bitop3:0xf6
    v_bitop3_b32 v4, v4, v155, s4 bitop3:0xf6
    v_bitop3_b32 v4, v4, v157, s4 bitop3:0xf6
    v_bitop3_b32 v4, v4, v159, s4 bitop3:0xf6
    v_cmp_ne_u32 vcc, 0, v4
    s_cbranch_vccz PDONE_65
    s_add_u32 s5, s5, 1
    s_cmp_lt_u32 s5, 300000
    s_cbranch_scc1 POLL_64
PDONE_65:
    v_bitop3_b32 v4, v21, v73, s4 bitop3:0x7e
    v_cmp_ne_u32 vcc, 0, v4
    s_cbranch_vccz TOK_66
POLL_67:
    buffer_load_dwordx2 v[20:21], v11, s[32:35], s68 offen sc1
    buffer_load_dwordx2 v[72:73], v11, s[32:35], s69 offen sc1
    s_waitcnt vmcnt(0)
    v_bitop3_b32 v4, v21, v73, s4 bitop3:0x7e
    v_cmp_ne_u32 vcc, 0, v4
    s_cbranch_vccz PDONE_68
    s_add_u32 s5, s5, 1
    s_cmp_lt_u32 s5, 300000
    s_cbranch_scc1 POLL_67
PDONE_68:
TOK_66:
    s_barrier
    v_add_f32 v212, v212, v216
    v_add_f32 v214, v214, v218
    v_add_f32 v220, v220, v224
    v_add_f32 v222, v222, v226
    v_add_f32 v148, v148, v152
    v_add_f32 v150, v150, v154
    v_add_f32 v212, v212, v220
    v_add_f32 v214, v214, v222
    v_add_f32 v148, v148, v156
    v_add_f32 v150, v150, v158
    v_add_f32 v212, v212, v148
    v_add_f32 v214, v214, v150
    v_mov_b32 v213, v214
    v_add_f32_dpp v212, v212, v212 row_ror:8 row_mask:0xf bank_mask:0xf
    s_nop 0
    v_add_f32_dpp v213, v213, v213 row_ror:8 row_mask:0xf bank_mask:0xf
    v_mov_b32 v214, v212
    v_mov_b32 v215, v213
    s_nop 0
    v_permlane16_swap_b32 v212, v214
    v_permlane16_swap_b32 v213, v215
    v_pk_add_f32 v[212:213], v[212:213], v[214:215]
    v_mov_b32 v214, v212
    v_mov_b32 v215, v213
    s_nop 0
    v_permlane32_swap_b32 v212, v214
    v_permlane32_swap_b32 v213, v215
    v_pk_add_f32 v[212:213], v[212:213], v[214:215]
    v_cvt_pk_bf16_f32 v212, 0, v212
    v_cvt_pk_bf16_f32 v213, 0, v213
    v_pk_mul_f32 v[212:213], v[212:213], v[74:75] op_sel:[0,1]
    v_lshlrev_b32 v4, 16, v20
    v_and_b32 v5, s6, v20
    v_cvt_pk_bf16_f32 v212, 0, v212
    v_cvt_pk_bf16_f32 v213, 0, v213
    v_pk_add_f32 v[212:213], v[212:213], v[4:5]
    v_lshlrev_b32 v4, 16, v74
    v_and_b32 v5, s6, v74
    v_cvt_pk_bf16_f32 v212, 0, v212
    v_cvt_pk_bf16_f32 v213, 0, v213
    v_pk_mul_f32 v[212:213], v[212:213], v[4:5]
    v_lshlrev_b32 v4, 16, v72
    v_and_b32 v5, s6, v72
    v_cvt_pk_bf16_f32 v212, 0, v212
    v_cvt_pk_bf16_f32 v213, 0, v213
    v_pk_add_f32 v[212:213], v[212:213], v[4:5]
    v_cvt_pk_bf16_f32 v212, v212, v213
    s_mov_b64 exec, 0xff
    buffer_store_dword v212, v10, s[64:67], s82 offen sc1
    s_mov_b64 exec, -1
    s_mov_b32 exec_lo, 0xffff
    s_mov_b32 exec_hi, 0xffff
    buffer_store_dwordx2 v[56:57], v58, s[32:35], 0 offen sc1
    s_mov_b64 exec, -1
L_FIN:
L_END:
    s_endpgm
.p2align 10
.fill 768, 4, 0xbf800000
.section .rodata,"a"
.p2align 6
.amdhsa_kernel adaLN_cond__linear_kernel_hedgehog__moe_arch_mod__prompt_kernel
  .amdhsa_next_free_vgpr 256
  .amdhsa_next_free_sgpr 102
  .amdhsa_accum_offset 256
  .amdhsa_group_segment_fixed_size 0
  .amdhsa_kernarg_size 112
  .amdhsa_user_sgpr_count 2
  .amdhsa_user_sgpr_kernarg_segment_ptr 1
  .amdhsa_system_sgpr_workgroup_id_x 1
  .amdhsa_float_denorm_mode_32 3
  .amdhsa_float_denorm_mode_16_64 3
.end_amdhsa_kernel
```

```asm
; @launch grid=(256,1,1) block=(512,1,1) lds=163840
.amdgcn_target "amdgcn-amd-amdhsa--gfx950"
.text
.globl adaLN_cond__linear_kernel_hedgehog__moe_arch_mod__prompt_kernel
.p2align 8
.type adaLN_cond__linear_kernel_hedgehog__moe_arch_mod__prompt_kernel,@function
adaLN_cond__linear_kernel_hedgehog__moe_arch_mod__prompt_kernel:
    s_load_dwordx16 s[68:83], s[0:1], 0
    s_load_dwordx8 s[84:91], s[0:1], 64
    s_load_dwordx2 s[32:33], s[0:1], 104
    s_load_dwordx2 s[30:31], s[0:1], 96
    s_cmp_ge_u32 s2, 256
    s_cbranch_scc1 L_END
    v_lshrrev_b32 v4, 6, v0
    v_and_b32 v1, 63, v0
    v_mov_b32 v3, 0
    v_readfirstlane_b32 s3, v4
    v_lshlrev_b32 v2, 4, v1
    s_and_b32 s8, s2, 7
    s_lshr_b32 s9, s2, 3
    s_lshl2_add_u32 s96, s8, s3
    s_lshl_b32 s15, s96, 6
    s_mul_i32 s96, s15, 6144
    s_xor_b32 s97, s9, 1
    s_lshl_b32 s98, s97, 7
    s_add_u32 s13, s96, s98
    v_lshrrev_b32 v60, 3, v1
    v_mul_u32_u24 v60, 49152, v60
    v_and_b32 v9, 7, v1
    v_lshl_add_u32 v60, v9, 4, v60
    v_lshrrev_b32 v61, 3, v1
    v_lshl_add_u32 v61, v61, 3, s15
    s_lshl_b32 s96, s8, 5
    s_add_u32 s97, s96, s9
    s_lshl2_add_u32 s98, s97, s3
    s_sub_u32 s99, s98, 4
    s_lshl_b32 s16, s99, 12
    s_mov_b32 s50, 12582912
    s_mov_b32 s51, 0x20000
    s_mov_b32 s38, 4194304
    s_mov_b32 s39, 0x20000
    s_mov_b32 s34, 268435456
    s_mov_b32 s35, 0x20000
    s_getreg_b32 s94, hwreg(HW_REG_XCC_ID, 0, 3)
    s_getpc_b64 s[22:23]
    s_mul_i32 s96, s9, 7
    s_add_u32 s97, s96, s3
    s_lshl_b32 s19, s97, 7
    v_lshrrev_b32 v10, 5, v1
    v_mul_u32_u24 v10, 28672, v10
    v_add_u32 v10, s19, v10
    v_min_u32 v10, 44032, v10
    s_cmp_ge_u32 s3, 4
    s_waitcnt lgkmcnt(0)
    s_mov_b64 s[48:49], s[88:89]
    s_mov_b64 s[36:37], s[68:69]
    s_load_dword s4, s[32:33], 0
    s_cbranch_scc1 L_FS
    global_load_dwordx2 v[96:97], v61, s[86:87]
    buffer_load_dwordx4 v[80:83], v60, s[48:51], s13 offen nt
    s_add_u32 s13, s13, 12288
    buffer_load_dwordx4 v[84:87], v60, s[48:51], s13 offen nt
    s_add_u32 s13, s13, 12288
    buffer_load_dwordx4 v[88:91], v60, s[48:51], s13 offen nt
    s_add_u32 s13, s13, 12288
    buffer_load_dwordx4 v[92:95], v60, s[48:51], s13 offen nt
    s_barrier
    s_barrier
    s_and_b32 s22, s22, 0xfffffc00
    global_load_dword v78, v10, s[22:23]
    s_mov_b32 s42, 6291456
    s_mov_b32 s43, 0x20000
    s_mov_b32 s46, 2097152
    s_mov_b32 s47, 0x20000
    s_mov_b32 s54, 7340032
    s_mov_b32 s55, 0x20000
    s_mov_b32 s58, 7340032
    s_mov_b32 s59, 0x20000
    s_mov_b32 s62, 7340032
    s_mov_b32 s63, 0x20000
    s_mov_b32 s66, 4194304
    s_mov_b32 s67, 0x20000
    s_mov_b64 s[40:41], s[70:71]
    s_mov_b64 s[44:45], s[74:75]
    s_mov_b64 s[52:53], s[80:81]
    s_mov_b64 s[56:57], s[82:83]
    s_mov_b64 s[60:61], s[84:85]
    s_mov_b64 s[64:65], s[90:91]
    s_mov_b32 s5, 0
    s_mov_b32 s6, 0xffff0000
    s_mov_b32 s7, 0x3fb8aa3b
    s_lshr_b32 s76, s3, 2
    v_bfe_u32 v6, v1, 4, 1
    v_lshlrev_b32 v6, 6, v6
    v_and_b32 v62, 7, v1
    v_lshlrev_b32 v62, 4, v62
    v_xor_b32 v62, v62, v6
    v_lshrrev_b32 v6, 3, v1
    v_mul_u32_u24 v6, 6144, v6
    v_add_u32 v62, v62, v6
    v_lshlrev_b32 v63, 3, v1
    v_add_u32 v64, 149760, v2
    s_and_b32 s96, s3, 3
    s_lshl2_add_u32 s13, s96, 149760
    v_lshrrev_b32 v65, 4, v1
    v_lshl_add_u32 v65, v65, 5, s13
    v_and_b32 v9, 7, v1
    v_lshl_add_u32 v65, v9, 7, v65
    v_bfe_u32 v9, v1, 3, 1
    v_lshl_add_u32 v65, v9, 4, v65
    s_and_b32 s96, s8, 6
    s_and_b32 s97, s8, 1
    s_lshr_b32 s98, s9, 4
    s_lshl1_add_u32 s99, s97, s98
    s_lshl_b32 s97, s99, 6
    s_add_u32 s98, s96, s97
    s_lshl3_add_u32 s99, s3, s98
    s_lshl_b32 s96, s99, 10
    s_and_b32 s97, s9, 15
    s_lshl_b32 s98, s97, 6
    s_add_u32 s99, s96, s98
    s_add_u32 s14, s99, 262144
    s_xor_b32 s96, s9, 1
    s_and_b32 s97, s96, 15
    s_lshl4_add_u32 s98, s3, s97
    s_lshr_b32 s99, s9, 4
    s_lshl1_add_u32 s96, s98, s99
    s_lshl3_add_u32 s97, s96, s8
    s_lshl_b32 s98, s97, 9
    s_add_u32 s13, s98, 524288
    s_lshr_b32 s96, s9, 4
    s_xor_b32 s97, s9, 1
    s_and_b32 s98, s97, 7
    s_lshl_b32 s99, s3, 1
    s_lshl3_add_u32 s97, s98, s99
    s_bfe_u32 s98, s9, 65539
    s_add_u32 s99, s97, s98
    s_lshl_b32 s97, s99, 9
    s_lshl_b32 s98, s8, 6
    s_add_u32 s99, s97, s98
    s_lshl2_add_u32 s97, s96, s99
    s_add_u32 s15, s97, 2097152
    v_and_b32 v10, 3, v1
    v_lshlrev_b32 v10, 15, v10
    s_waitcnt vmcnt(5)
    v_lshlrev_b32 v98, 16, v97
    v_and_b32 v99, s6, v97
    v_and_b32 v97, s6, v96
    v_lshlrev_b32 v96, 16, v96
    v_mul_f32 v4, s7, v96
    v_exp_f32 v4, -v4
    s_nop 0
    v_add_f32 v4, 1.0, v4
    v_rcp_f32 v4, v4
    s_nop 0
    v_mul_f32 v96, v96, v4
    v_cvt_pk_bf16_f32 v96, 0, v96
    v_mul_f32 v5, s7, v97
    v_exp_f32 v5, -v5
    s_nop 0
    v_add_f32 v5, 1.0, v5
    v_rcp_f32 v5, v5
    s_nop 0
    v_mul_f32 v97, v97, v5
    v_cvt_pk_bf16_f32 v97, 0, v97
    v_mul_f32 v4, s7, v98
    v_exp_f32 v4, -v4
    s_nop 0
    v_add_f32 v4, 1.0, v4
    v_rcp_f32 v4, v4
    s_nop 0
    v_mul_f32 v98, v98, v4
    v_cvt_pk_bf16_f32 v98, 0, v98
    v_mul_f32 v5, s7, v99
    v_exp_f32 v5, -v5
    s_nop 0
    v_add_f32 v5, 1.0, v5
    v_rcp_f32 v5, v5
    s_nop 0
    v_mul_f32 v99, v99, v5
    v_cvt_pk_bf16_f32 v99, 0, v99
    s_waitcnt vmcnt(4)
    v_lshlrev_b32 v4, 16, v80
    v_and_b32 v5, s6, v80
    v_pk_mul_f32 v[20:21], v[4:5], v[96:97] op_sel:[0,0] op_sel_hi:[1,0]
    v_lshlrev_b32 v6, 16, v81
    v_and_b32 v7, s6, v81
    v_pk_mul_f32 v[22:23], v[6:7], v[96:97] op_sel:[0,0] op_sel_hi:[1,0]
    v_lshlrev_b32 v4, 16, v82
    v_and_b32 v5, s6, v82
    v_pk_mul_f32 v[24:25], v[4:5], v[96:97] op_sel:[0,0] op_sel_hi:[1,0]
    v_lshlrev_b32 v6, 16, v83
    v_and_b32 v7, s6, v83
    v_pk_mul_f32 v[26:27], v[6:7], v[96:97] op_sel:[0,0] op_sel_hi:[1,0]
    s_waitcnt vmcnt(3)
    v_lshlrev_b32 v4, 16, v84
    v_and_b32 v5, s6, v84
    v_pk_fma_f32 v[20:21], v[4:5], v[96:97], v[20:21] op_sel:[0,1,0] op_sel_hi:[1,1,1]
    v_lshlrev_b32 v6, 16, v85
    v_and_b32 v7, s6, v85
    v_pk_fma_f32 v[22:23], v[6:7], v[96:97], v[22:23] op_sel:[0,1,0] op_sel_hi:[1,1,1]
    v_lshlrev_b32 v4, 16, v86
    v_and_b32 v5, s6, v86
    v_pk_fma_f32 v[24:25], v[4:5], v[96:97], v[24:25] op_sel:[0,1,0] op_sel_hi:[1,1,1]
    v_lshlrev_b32 v6, 16, v87
    v_and_b32 v7, s6, v87
    v_pk_fma_f32 v[26:27], v[6:7], v[96:97], v[26:27] op_sel:[0,1,0] op_sel_hi:[1,1,1]
    s_waitcnt vmcnt(2)
    v_lshlrev_b32 v4, 16, v88
    v_and_b32 v5, s6, v88
    v_pk_fma_f32 v[20:21], v[4:5], v[98:99], v[20:21] op_sel:[0,0,0] op_sel_hi:[1,0,1]
    v_lshlrev_b32 v6, 16, v89
    v_and_b32 v7, s6, v89
    v_pk_fma_f32 v[22:23], v[6:7], v[98:99], v[22:23] op_sel:[0,0,0] op_sel_hi:[1,0,1]
    v_lshlrev_b32 v4, 16, v90
    v_and_b32 v5, s6, v90
    v_pk_fma_f32 v[24:25], v[4:5], v[98:99], v[24:25] op_sel:[0,0,0] op_sel_hi:[1,0,1]
    v_lshlrev_b32 v6, 16, v91
    v_and_b32 v7, s6, v91
    v_pk_fma_f32 v[26:27], v[6:7], v[98:99], v[26:27] op_sel:[0,0,0] op_sel_hi:[1,0,1]
    s_waitcnt vmcnt(1)
    v_lshlrev_b32 v4, 16, v92
    v_and_b32 v5, s6, v92
    v_pk_fma_f32 v[20:21], v[4:5], v[98:99], v[20:21] op_sel:[0,1,0] op_sel_hi:[1,1,1]
    v_lshlrev_b32 v6, 16, v93
    v_and_b32 v7, s6, v93
    v_pk_fma_f32 v[22:23], v[6:7], v[98:99], v[22:23] op_sel:[0,1,0] op_sel_hi:[1,1,1]
    v_lshlrev_b32 v4, 16, v94
    v_and_b32 v5, s6, v94
    v_pk_fma_f32 v[24:25], v[4:5], v[98:99], v[24:25] op_sel:[0,1,0] op_sel_hi:[1,1,1]
    v_lshlrev_b32 v6, 16, v95
    v_and_b32 v7, s6, v95
    v_pk_fma_f32 v[26:27], v[6:7], v[98:99], v[26:27] op_sel:[0,1,0] op_sel_hi:[1,1,1]
    v_permlane32_swap_b32 v20, v24
    v_permlane32_swap_b32 v21, v25
    v_permlane32_swap_b32 v22, v26
    v_permlane32_swap_b32 v23, v27
    v_add_f32 v20, v20, v24
    v_add_f32 v21, v21, v25
    v_add_f32 v22, v22, v26
    v_add_f32 v23, v23, v27
    s_nop 0
    v_permlane16_swap_b32 v20, v22
    v_permlane16_swap_b32 v21, v23
    v_add_f32 v20, v20, v22
    v_add_f32 v21, v21, v23
    s_nop 0
    v_add_f32_dpp v20, v20, v20 row_ror:8 row_mask:0xf bank_mask:0xf
    v_add_f32_dpp v21, v21, v21 row_ror:8 row_mask:0xf bank_mask:0xf
    s_nop 1
    v_mov_b32_dpp v20, v21 quad_perm:[0,1,2,3] row_mask:0xf bank_mask:0xc
    ds_write_b32 v65, v20
    s_waitcnt lgkmcnt(0)
    s_barrier
    ds_read_b128 v[20:23], v64 offset:0
    s_mul_i32 s4, s4, 0x9e3779b1
    s_add_u32 s4, s4, 0x7f4a7c15
    s_waitcnt lgkmcnt(0)
    v_pk_add_f32 v[20:21], v[20:21], v[22:23]
    v_add_f32 v20, v20, v21
    v_mov_b32 v21, s4
    buffer_store_dwordx2 v[20:21], v63, s[32:35], s13 offen sc1
    s_mov_b64 exec, 15
    buffer_store_dword v21, v10, s[32:35], s15 offen sc1
    s_mov_b64 exec, -1
    s_branch L_FJ
L_FS:
    s_barrier
    buffer_load_dwordx4 v[80:83], v2, s[36:39], s16 offen
    buffer_load_dwordx4 v[84:87], v2, s[36:39], s16 offen offset:1024
    buffer_load_dwordx4 v[88:91], v2, s[36:39], s16 offen offset:2048
    buffer_load_dwordx4 v[92:95], v2, s[36:39], s16 offen offset:3072
    s_lshl2_add_u32 s96, s2, s3
    s_sub_u32 s97, s96, 4
    s_lshl_b32 s98, s97, 7
    s_add_u32 s17, s98, 2097152
    s_load_dword s24, s[32:33], s17 offset:0 glc
    s_load_dword s25, s[32:33], s17 offset:64 glc
    s_lshl_b32 s96, s2, 5
    s_add_u32 s97, s96, s3
    s_sub_u32 s98, s97, 4
    s_lshl_b32 s99, s98, 7
    s_add_u32 s17, s99, 1048576
    s_load_dword s24, s[32:33], s17 offset:0 glc
    s_load_dword s25, s[32:33], s17 offset:64 glc
    s_lshl_b32 s19, s94, 5
    v_mov_b32 v78, 1
    v_mov_b32 v79, s19
    s_barrier
    s_cmp_lg_u32 s3, 7
    s_cbranch_scc1 L_NOTK
    s_mov_b64 exec, 1
    global_atomic_add v78, v79, v78, s[30:31] sc0 sc1
    s_mov_b64 exec, -1
    s_branch L_TK0
L_NOTK:
    s_and_b32 s22, s22, 0xfffffc00
    global_load_dword v78, v10, s[22:23]
L_TK0:
    s_mov_b32 s42, 6291456
    s_mov_b32 s43, 0x20000
    s_mov_b32 s46, 2097152
    s_mov_b32 s47, 0x20000
    s_mov_b32 s54, 7340032
    s_mov_b32 s55, 0x20000
    s_mov_b32 s58, 7340032
    s_mov_b32 s59, 0x20000
    s_mov_b32 s62, 7340032
    s_mov_b32 s63, 0x20000
    s_mov_b32 s66, 4194304
    s_mov_b32 s67, 0x20000
    s_mov_b64 s[40:41], s[70:71]
    s_mov_b64 s[44:45], s[74:75]
    s_mov_b64 s[52:53], s[80:81]
    s_mov_b64 s[56:57], s[82:83]
    s_mov_b64 s[60:61], s[84:85]
    s_mov_b64 s[64:65], s[90:91]
    s_mov_b32 s5, 0
    s_mov_b32 s6, 0xffff0000
    s_mov_b32 s7, 0x3fb8aa3b
    s_lshr_b32 s76, s3, 2
    v_bfe_u32 v6, v1, 4, 1
    v_lshlrev_b32 v6, 6, v6
    v_and_b32 v62, 7, v1
    v_lshlrev_b32 v62, 4, v62
    v_xor_b32 v62, v62, v6
    v_lshrrev_b32 v6, 3, v1
    v_mul_u32_u24 v6, 6144, v6
    v_add_u32 v62, v62, v6
    v_lshlrev_b32 v63, 3, v1
    v_add_u32 v64, 149760, v2
    s_and_b32 s96, s3, 3
    s_lshl2_add_u32 s13, s96, 149760
    v_lshrrev_b32 v65, 4, v1
    v_lshl_add_u32 v65, v65, 5, s13
    v_and_b32 v9, 7, v1
    v_lshl_add_u32 v65, v9, 7, v65
    v_bfe_u32 v9, v1, 3, 1
    v_lshl_add_u32 v65, v9, 4, v65
    s_and_b32 s96, s8, 6
    s_and_b32 s97, s8, 1
    s_lshr_b32 s98, s9, 4
    s_lshl1_add_u32 s99, s97, s98
    s_lshl_b32 s97, s99, 6
    s_add_u32 s98, s96, s97
    s_lshl3_add_u32 s99, s3, s98
    s_lshl_b32 s96, s99, 10
    s_and_b32 s97, s9, 15
    s_lshl_b32 s98, s97, 6
    s_add_u32 s99, s96, s98
    s_add_u32 s14, s99, 262144
    s_sub_u32 s96, s3, 4
    s_lshl4_add_u32 s13, s96, 151808
    v_lshrrev_b32 v10, 5, v1
    v_lshl_add_u32 v10, v10, 3, s13
    s_barrier
    s_waitcnt vmcnt(1)
    s_waitcnt lgkmcnt(0)
    s_mul_i32 s4, s4, 0x9e3779b1
    s_add_u32 s4, s4, 0x7f4a7c15
    v_mov_b32 v104, 0x3f803f80
    v_dot2_f32_bf16 v100, v80, v104, 0
    v_dot2_f32_bf16 v102, v80, v80, 0
    v_dot2_f32_bf16 v101, v88, v104, 0
    v_dot2_f32_bf16 v103, v88, v88, 0
    v_dot2_f32_bf16 v100, v81, v104, v100
    v_dot2_f32_bf16 v102, v81, v81, v102
    v_dot2_f32_bf16 v101, v89, v104, v101
    v_dot2_f32_bf16 v103, v89, v89, v103
    v_dot2_f32_bf16 v100, v82, v104, v100
    v_dot2_f32_bf16 v102, v82, v82, v102
    v_dot2_f32_bf16 v101, v90, v104, v101
    v_dot2_f32_bf16 v103, v90, v90, v103
    v_dot2_f32_bf16 v100, v83, v104, v100
    v_dot2_f32_bf16 v102, v83, v83, v102
    v_dot2_f32_bf16 v101, v91, v104, v101
    v_dot2_f32_bf16 v103, v91, v91, v103
    v_dot2_f32_bf16 v100, v84, v104, v100
    v_dot2_f32_bf16 v102, v84, v84, v102
    v_dot2_f32_bf16 v101, v92, v104, v101
    v_dot2_f32_bf16 v103, v92, v92, v103
    v_dot2_f32_bf16 v100, v85, v104, v100
    v_dot2_f32_bf16 v102, v85, v85, v102
    v_dot2_f32_bf16 v101, v93, v104, v101
    v_dot2_f32_bf16 v103, v93, v93, v103
    v_dot2_f32_bf16 v100, v86, v104, v100
    v_dot2_f32_bf16 v102, v86, v86, v102
    v_dot2_f32_bf16 v101, v94, v104, v101
    v_dot2_f32_bf16 v103, v94, v94, v103
    v_dot2_f32_bf16 v100, v87, v104, v100
    v_dot2_f32_bf16 v102, v87, v87, v102
    v_dot2_f32_bf16 v101, v95, v104, v101
    v_dot2_f32_bf16 v103, v95, v95, v103
    s_nop 1
    v_permlane32_swap_b32 v100, v101
    v_permlane32_swap_b32 v102, v103
    v_add_f32 v100, v100, v101
    v_add_f32 v102, v102, v103
    s_nop 1
    v_permlane16_swap_b32 v100, v102
    v_add_f32 v100, v100, v102
    s_nop 1
    v_add_f32_dpp v100, v100, v100 quad_perm:[1,0,3,2] row_mask:0xf bank_mask:0xf
    s_nop 1
    v_add_f32_dpp v100, v100, v100 quad_perm:[2,3,0,1] row_mask:0xf bank_mask:0xf
    s_nop 1
    v_add_f32_dpp v100, v100, v100 row_half_mirror row_mask:0xf bank_mask:0xf
    s_nop 1
    v_add_f32_dpp v100, v100, v100 row_ror:8 row_mask:0xf bank_mask:0xf
    v_mul_f32 v102, 0x3a800000, v100
    v_mul_f32 v100, 0x3a800000, v100
    s_nop 1
    v_permlane16_swap_b32 v100, v102
    v_fma_f32 v117, -v100, v100, v102
    v_cvt_pk_bf16_f32 v116, 0, v100
    v_max_f32 v117, 0, v117
    v_cvt_pk_bf16_f32 v117, 0, v117
    v_add_f32 v117, 0x3727c5ac, v117
    v_cvt_pk_bf16_f32 v117, 0, v117
    v_sqrt_f32 v117, v117
    s_nop 0
    v_cvt_pk_bf16_f32 v117, 0, v117
    v_lshrrev_b32 v116, 16, v116
    v_or_b32 v116, v116, v117
    v_mov_b32 v117, s4
    ds_write_b64 v10, v[116:117]
L_FJ:
    v_and_b32 v5, 3, v1
    v_lshlrev_b32 v5, 4, v5
    v_add_u32 v5, 151808, v5
    v_and_b32 v4, 3, v1
    v_lshlrev_b32 v4, 4, v4
    v_bfe_u32 v9, v1, 2, 1
    v_lshl_add_u32 v4, v9, 10, v4
    v_and_b32 v10, 31, v1
    v_lshlrev_b32 v10, 11, v10
    v_lshrrev_b32 v9, 5, v1
    v_lshl_add_u32 v10, v9, 5, v10
    v_and_b32 v6, 1, v1
    v_lshlrev_b32 v6, 9, v6
    v_bfe_u32 v9, v1, 1, 1
    v_lshl_add_u32 v6, v9, 8, v6
    s_and_b32 s96, s9, 3
    s_and_b32 s97, s8, 6
    s_and_b32 s98, s8, 1
    s_lshr_b32 s99, s9, 4
    s_lshl1_add_u32 s98, s98, s99
    s_lshl_b32 s99, s98, 6
    s_add_u32 s98, s97, s99
    s_lshl3_add_u32 s97, s3, s98
    s_lshl_b32 s99, s97, 9
    s_bfe_u32 s98, s9, 131074
    s_lshl_b32 s97, s98, 6
    s_add_u32 s98, s99, s97
    s_lshl2_add_u32 s99, s96, s98
    s_add_u32 s97, s99, 16
    s_add_u32 s15, s97, 2097152
    s_waitcnt lgkmcnt(0)
    s_barrier
    ds_read_b128 v[116:119], v5
    s_waitcnt lgkmcnt(0)
    s_mov_b64 exec, 0xff
    buffer_store_dwordx4 v[116:119], v4, s[32:35], s14 offen sc1
    s_mov_b64 exec, 15
    buffer_store_dword v117, v6, s[32:35], s15 offen sc1
    s_mov_b64 exec, -1
    s_cmp_lg_u32 s3, 7
    s_cbranch_scc1 L_NOTK2
    s_mov_b32 s13, 0
    s_waitcnt vmcnt(2)
L_TK:
    v_readfirstlane_b32 s15, v78
    s_nop 0
    s_cmp_lt_u32 s15, 32
    s_cbranch_scc1 L_TKOK
    v_mov_b32 v78, s4
    s_mov_b64 exec, 1
    buffer_store_dword v78, v3, s[32:35], 0 offen offset:256 sc1
    s_mov_b64 exec, -1
    s_add_u32 s13, s13, 1
    s_cmp_lt_u32 s13, 8
    s_cbranch_scc0 L_TKNO
    s_add_u32 s94, s94, 1
    s_and_b32 s94, s94, 7
    s_lshl_b32 s19, s94, 5
    v_mov_b32 v78, 1
    v_mov_b32 v79, s19
    s_mov_b64 exec, 1
    global_atomic_add v78, v79, v78, s[30:31] sc0 sc1
    s_mov_b64 exec, -1
    s_waitcnt vmcnt(0)
    s_branch L_TK
L_TKNO:
    s_and_b32 s94, s2, 7
    s_lshr_b32 s15, s2, 3
L_TKOK:
    s_lshl3_add_u32 s15, s15, s94
    v_mov_b32 v78, s15
    ds_write_b32 v5, v78 offset:64
L_NOTK2:
    s_waitcnt lgkmcnt(0)
    s_barrier
    ds_read_b32 v120, v5 offset:64
    s_waitcnt lgkmcnt(0)
    v_readfirstlane_b32 s2, v120
    s_nop 0
    s_and_b32 s8, s2, 7
    s_lshr_b32 s9, s2, 3
    s_and_b32 s96, s8, 1
    s_and_b32 s97, s9, 7
    s_lshl3_add_u32 s12, s96, s97
    s_lshr_b32 s96, s8, 1
    s_lshr_b32 s97, s9, 3
    s_lshl2_add_u32 s21, s96, s97
    s_and_b32 s96, s3, 3
    s_lshl2_add_u32 s94, s21, s96
    s_lshl1_add_u32 s95, s12, s76
    s_lshl_b32 s96, s94, 16
    s_lshl_b32 s97, s95, 6
    s_add_u32 s18, s96, s97
    buffer_load_dwordx4 v[12:15], v10, s[36:39], s18 offen
    buffer_load_dwordx4 v[16:19], v10, s[36:39], s18 offen offset:16
    s_lshr_b32 s96, s8, 1
    s_lshl4_add_u32 s97, s96, s12
    s_lshl4_add_u32 s98, s97, s3
    s_lshl_b32 s99, s98, 9
    s_add_u32 s13, s99, 524288
    s_lshl3_add_u32 s96, s2, s3
    s_lshl_b32 s97, s96, 6
    s_add_u32 s15, s97, 2097152
    s_and_b32 s96, s3, 3
    s_lshl2_add_u32 s97, s2, s96
    s_lshl_b32 s98, s97, 8
    s_add_u32 s14, s98, 262144
    s_load_dwordx8 s[24:31], s[32:33], s15 offset:0 glc
    s_and_b32 s10, s9, 15
    s_lshr_b32 s96, s8, 2
    s_and_b32 s97, s8, 1
    s_lshl1_add_u32 s98, s96, s97
    s_and_b32 s99, s8, 2
    s_lshl2_add_u32 s96, s98, s99
    s_lshr_b32 s97, s9, 4
    s_add_u32 s11, s96, s97
    s_and_b32 s85, s9, 12
    s_lshl_b32 s96, s2, 6
    s_add_u32 s97, s96, s3
    s_lshl_b32 s98, s97, 6
    s_add_u32 s92, s98, 1048576
    s_lshr_b32 s96, s9, 4
    s_xor_b32 s77, s76, s96
    s_lshr_b32 s96, s9, 3
    s_xor_b32 s97, s96, s9
    s_and_b32 s98, s97, 1
    s_lshl2_add_u32 s83, s98, 8
    s_mul_i32 s96, s8, 7
    s_lshr_b32 s97, s9, 2
    s_add_u32 s74, s96, s97
    s_and_b32 s75, s9, 3
    v_and_b32 v8, 31, v1
    v_lshlrev_b32 v8, 3, v8
    v_and_b32 v4, 31, v1
    v_lshlrev_b32 v4, 4, v4
    v_lshrrev_b32 v9, 5, v1
    v_lshl_add_u32 v4, v9, 12, v4
    s_lshl2_add_u32 s16, s3, 152320
    v_lshl_add_u32 v5, v1, 6, s16
    s_lshl_b32 s96, s76, 10
    s_add_u32 s16, s96, 152320
    v_and_b32 v6, 15, v1
    v_lshl_add_u32 v6, v6, 5, s16
    v_lshrrev_b32 v9, 5, v1
    v_lshl_add_u32 v6, v9, 9, v6
    s_branch SCHK_2
SPOLL_1:
    s_load_dwordx8 s[24:31], s[32:33], s15 offset:0 glc
SCHK_2:
    s_add_u32 s5, s5, 1
    s_cmp_ge_u32 s5, 300000
    s_waitcnt lgkmcnt(0)
    s_cbranch_scc1 SDONE_3
    s_cmp_lg_u32 s24, s4
    s_cbranch_scc1 SPOLL_1
    s_cmp_lg_u32 s25, s4
    s_cbranch_scc1 SPOLL_1
    s_cmp_lg_u32 s28, s4
    s_cbranch_scc1 SPOLL_1
    s_cmp_lg_u32 s29, s4
    s_cbranch_scc1 SPOLL_1
    s_cmp_lg_u32 s30, s4
    s_cbranch_scc1 SPOLL_1
    s_cmp_lg_u32 s31, s4
    s_cbranch_scc1 SPOLL_1
SDONE_3:
    buffer_load_dwordx4 v[120:123], v4, s[32:35], s13 offen sc1
    buffer_load_dwordx2 v[116:117], v8, s[32:35], s14 offen sc1
    s_barrier
    s_lshl_b32 s96, s11, 12
    s_lshl_b32 s97, s3, 9
    s_add_u32 s16, s96, s97
    v_add_u32 v10, s16, v2
    s_lshl_b32 s96, s3, 9
    s_add_u32 m0, s96, 156416
    s_mov_b32 exec_hi, 0
    global_load_lds_dwordx4 v10, s[72:73]
    s_mov_b32 exec_hi, -1
    s_and_b32 s20, s9, 3
    s_add_u32 s96, s20, s85
    s_and_b32 s97, s96, 15
    s_lshl3_add_u32 s98, s97, s3
    s_mul_i32 s99, s98, 49152
    s_lshl_b32 s96, s11, 7
    s_add_u32 s82, s99, s96
    s_mul_i32 s96, s20, 24960
    s_lshr_b32 s97, s3, 1
    s_mul_i32 s98, s97, 2080
    s_add_u32 s99, s96, s98
    s_and_b32 s97, s3, 1
    s_mul_i32 s96, s97, 1056
    s_add_u32 s20, s99, s96
    s_mov_b32 m0, s20
    s_nop 0
    buffer_load_dwordx4 v62, s[40:43], s82 offen lds
    s_add_u32 s82, s82, 2048
    s_add_u32 m0, s20, 8320
    s_nop 0
    buffer_load_dwordx4 v62, s[40:43], s82 offen lds
    s_add_u32 s82, s82, 2048
    s_add_u32 m0, s20, 16640
    s_nop 0
    buffer_load_dwordx4 v62, s[40:43], s82 offen lds
    s_waitcnt vmcnt(5)
    v_bitop3_b32 v7, v121, v123, s4 bitop3:0x7e
    v_cmp_ne_u32 vcc, 0, v7
    s_cbranch_vccz TOK_5
POLL_6:
    buffer_load_dwordx4 v[120:123], v4, s[32:35], s13 offen sc1
    s_waitcnt vmcnt(0)
    v_bitop3_b32 v7, v121, v123, s4 bitop3:0x7e
    v_cmp_ne_u32 vcc, 0, v7
    s_cbranch_vccz PDONE_7
    s_add_u32 s5, s5, 1
    s_cmp_lt_u32 s5, 300000
    s_cbranch_scc1 POLL_6
PDONE_7:
TOK_5:
    ds_write2_b32 v5, v120, v122 offset0:0 offset1:8
    v_lshlrev_b32 v100, 16, v12
    v_and_b32 v101, s6, v12
    v_lshlrev_b32 v102, 16, v13
    v_and_b32 v103, s6, v13
    v_lshlrev_b32 v104, 16, v14
    v_and_b32 v105, s6, v14
    v_lshlrev_b32 v106, 16, v15
    v_and_b32 v107, s6, v15
    v_lshlrev_b32 v108, 16, v16
    v_and_b32 v109, s6, v16
    v_lshlrev_b32 v110, 16, v17
    v_and_b32 v111, s6, v17
    v_lshlrev_b32 v112, 16, v18
    v_and_b32 v113, s6, v18
    v_lshlrev_b32 v114, 16, v19
    v_and_b32 v115, s6, v19
    s_waitcnt lgkmcnt(0)
    s_barrier
    ds_read_b128 v[88:91], v6 offset:2048
    ds_read_b128 v[92:95], v6 offset:2064
    ds_read_b128 v[80:83], v6
    ds_read_b128 v[84:87], v6 offset:16
    s_waitcnt vmcnt(4)
    v_cmp_ne_u32 vcc, s4, v117
    s_cbranch_vccz TOK_8
POLL_9:
    buffer_load_dwordx2 v[116:117], v8, s[32:35], s14 offen sc1
    s_waitcnt vmcnt(0)
    v_cmp_ne_u32 vcc, s4, v117
    s_cbranch_vccz PDONE_10
    s_add_u32 s5, s5, 1
    s_cmp_lt_u32 s5, 300000
    s_cbranch_scc1 POLL_9
PDONE_10:
TOK_8:
    v_lshlrev_b32 v117, 16, v116
    v_and_b32 v116, s6, v116
    v_rcp_f32 v116, v116
    s_nop 0
    v_pk_add_f32 v[100:101], v[100:101], v[116:117] op_sel:[0,1] neg_lo:[0,1] neg_hi:[0,1]
    v_pk_add_f32 v[102:103], v[102:103], v[116:117] op_sel:[0,1] neg_lo:[0,1] neg_hi:[0,1]
    v_pk_add_f32 v[104:105], v[104:105], v[116:117] op_sel:[0,1] neg_lo:[0,1] neg_hi:[0,1]
    v_pk_add_f32 v[106:107], v[106:107], v[116:117] op_sel:[0,1] neg_lo:[0,1] neg_hi:[0,1]
    v_pk_add_f32 v[108:109], v[108:109], v[116:117] op_sel:[0,1] neg_lo:[0,1] neg_hi:[0,1]
    v_pk_add_f32 v[110:111], v[110:111], v[116:117] op_sel:[0,1] neg_lo:[0,1] neg_hi:[0,1]
    v_pk_add_f32 v[112:113], v[112:113], v[116:117] op_sel:[0,1] neg_lo:[0,1] neg_hi:[0,1]
    v_pk_add_f32 v[114:115], v[114:115], v[116:117] op_sel:[0,1] neg_lo:[0,1] neg_hi:[0,1]
    s_lshl4_add_u32 s96, s21, s12
    s_and_b32 s97, s3, 3
    s_lshl2_add_u32 s98, s96, s97
    s_lshl1_add_u32 s99, s98, s76
    s_lshl_b32 s96, s99, 11
    s_add_u32 s13, s96, 4194304
    v_and_b32 v8, 15, v1
    v_lshlrev_b32 v8, 4, v8
    v_bfe_u32 v9, v1, 4, 1
    v_lshl_add_u32 v8, v9, 10, v8
    v_lshrrev_b32 v9, 5, v1
    v_lshl_add_u32 v8, v9, 9, v8
    s_waitcnt lgkmcnt(2)
    v_pk_add_f32 v[88:89], v[88:89], v[90:91]
    v_pk_add_f32 v[92:93], v[92:93], v[94:95]
    v_pk_add_f32 v[88:89], v[88:89], v[92:93]
    v_add_f32 v88, v88, v89
    v_cvt_pk_bf16_f32 v88, 0, v88
    s_waitcnt lgkmcnt(0)
    v_pk_add_f32 v[80:81], v[80:81], v[82:83]
    v_pk_add_f32 v[84:85], v[84:85], v[86:87]
    v_pk_add_f32 v[80:81], v[80:81], v[84:85]
    v_add_f32 v80, v80, v81
    v_add_f32 v88, 1.0, v88
    v_cvt_pk_bf16_f32 v88, 0, v88
    v_cvt_pk_bf16_f32 v80, 0, v80
    s_lshl_b32 s96, s3, 8
    s_add_u32 s16, s96, 160512
    v_and_b32 v4, 15, v1
    v_lshl_add_u32 v4, v4, 2, s16
    v_lshrrev_b32 v9, 5, v1
    v_lshl_add_u32 v4, v9, 6, v4
    v_lshrrev_b32 v5, 5, v1
    v_lshl_add_u32 v5, v5, 6, s16
    ds_write2_b32 v4, v88, v80 offset0:0 offset1:32
    ds_read_b128 v[132:135], v5
    ds_read_b128 v[136:139], v5 offset:16
    ds_read_b128 v[140:143], v5 offset:32
    ds_read_b128 v[144:147], v5 offset:48
    ds_read_b128 v[148:151], v5 offset:128
    ds_read_b128 v[152:155], v5 offset:144
    ds_read_b128 v[156:159], v5 offset:160
    ds_read_b128 v[160:163], v5 offset:176
    v_cvt_pk_bf16_f32 v100, 0, v100
    v_cvt_pk_bf16_f32 v101, 0, v101
    v_cvt_pk_bf16_f32 v102, 0, v102
    v_cvt_pk_bf16_f32 v103, 0, v103
    v_cvt_pk_bf16_f32 v104, 0, v104
    v_cvt_pk_bf16_f32 v105, 0, v105
    v_cvt_pk_bf16_f32 v106, 0, v106
    v_cvt_pk_bf16_f32 v107, 0, v107
    v_pk_mul_f32 v[100:101], v[100:101], v[116:117] op_sel_hi:[1,0]
    v_pk_mul_f32 v[102:103], v[102:103], v[116:117] op_sel_hi:[1,0]
    v_pk_mul_f32 v[104:105], v[104:105], v[116:117] op_sel_hi:[1,0]
    v_pk_mul_f32 v[106:107], v[106:107], v[116:117] op_sel_hi:[1,0]
    v_cvt_pk_bf16_f32 v100, 0, v100
    v_cvt_pk_bf16_f32 v101, 0, v101
    v_cvt_pk_bf16_f32 v102, 0, v102
    v_cvt_pk_bf16_f32 v103, 0, v103
    v_cvt_pk_bf16_f32 v104, 0, v104
    v_cvt_pk_bf16_f32 v105, 0, v105
    v_cvt_pk_bf16_f32 v106, 0, v106
    v_cvt_pk_bf16_f32 v107, 0, v107
    v_cvt_pk_bf16_f32 v108, 0, v108
    v_cvt_pk_bf16_f32 v109, 0, v109
    v_cvt_pk_bf16_f32 v110, 0, v110
    v_cvt_pk_bf16_f32 v111, 0, v111
    v_cvt_pk_bf16_f32 v112, 0, v112
    v_cvt_pk_bf16_f32 v113, 0, v113
    v_cvt_pk_bf16_f32 v114, 0, v114
    v_cvt_pk_bf16_f32 v115, 0, v115
    v_pk_mul_f32 v[108:109], v[108:109], v[116:117] op_sel_hi:[1,0]
    v_pk_mul_f32 v[110:111], v[110:111], v[116:117] op_sel_hi:[1,0]
    v_pk_mul_f32 v[112:113], v[112:113], v[116:117] op_sel_hi:[1,0]
    v_pk_mul_f32 v[114:115], v[114:115], v[116:117] op_sel_hi:[1,0]
    v_cvt_pk_bf16_f32 v108, 0, v108
    v_cvt_pk_bf16_f32 v109, 0, v109
    v_cvt_pk_bf16_f32 v110, 0, v110
    v_cvt_pk_bf16_f32 v111, 0, v111
    v_cvt_pk_bf16_f32 v112, 0, v112
    v_cvt_pk_bf16_f32 v113, 0, v113
    v_cvt_pk_bf16_f32 v114, 0, v114
    v_cvt_pk_bf16_f32 v115, 0, v115
    s_waitcnt lgkmcnt(6)
    v_pk_mul_f32 v[100:101], v[100:101], v[132:133]
    v_pk_mul_f32 v[102:103], v[102:103], v[134:135]
    v_pk_mul_f32 v[104:105], v[104:105], v[136:137]
    v_pk_mul_f32 v[106:107], v[106:107], v[138:139]
    v_cvt_pk_bf16_f32 v100, 0, v100
    v_cvt_pk_bf16_f32 v101, 0, v101
    v_cvt_pk_bf16_f32 v102, 0, v102
    v_cvt_pk_bf16_f32 v103, 0, v103
    v_cvt_pk_bf16_f32 v104, 0, v104
    v_cvt_pk_bf16_f32 v105, 0, v105
    v_cvt_pk_bf16_f32 v106, 0, v106
    v_cvt_pk_bf16_f32 v107, 0, v107
    s_waitcnt lgkmcnt(2)
    v_pk_add_f32 v[100:101], v[100:101], v[148:149]
    v_pk_add_f32 v[102:103], v[102:103], v[150:151]
    v_pk_add_f32 v[104:105], v[104:105], v[152:153]
    v_pk_add_f32 v[106:107], v[106:107], v[154:155]
    v_cvt_pk_bf16_f32 v124, v100, v101
    v_cvt_pk_bf16_f32 v125, v102, v103
    v_cvt_pk_bf16_f32 v126, v104, v105
    v_cvt_pk_bf16_f32 v127, v106, v107
    buffer_store_dwordx4 v[124:127], v8, s[32:35], s13 offen sc1
    v_pk_mul_f32 v[108:109], v[108:109], v[140:141]
    v_pk_mul_f32 v[110:111], v[110:111], v[142:143]
    v_pk_mul_f32 v[112:113], v[112:113], v[144:145]
    v_pk_mul_f32 v[114:115], v[114:115], v[146:147]
    v_cvt_pk_bf16_f32 v108, 0, v108
    v_cvt_pk_bf16_f32 v109, 0, v109
    v_cvt_pk_bf16_f32 v110, 0, v110
    v_cvt_pk_bf16_f32 v111, 0, v111
    v_cvt_pk_bf16_f32 v112, 0, v112
    v_cvt_pk_bf16_f32 v113, 0, v113
    v_cvt_pk_bf16_f32 v114, 0, v114
    v_cvt_pk_bf16_f32 v115, 0, v115
    s_waitcnt lgkmcnt(0)
    v_pk_add_f32 v[108:109], v[108:109], v[156:157]
    v_pk_add_f32 v[110:111], v[110:111], v[158:159]
    v_pk_add_f32 v[112:113], v[112:113], v[160:161]
    v_pk_add_f32 v[114:115], v[114:115], v[162:163]
    v_cvt_pk_bf16_f32 v128, v108, v109
    v_cvt_pk_bf16_f32 v129, v110, v111
    v_cvt_pk_bf16_f32 v130, v112, v113
    v_cvt_pk_bf16_f32 v131, v114, v115
    buffer_store_dwordx4 v[128:131], v8, s[32:35], s13 offen offset:256 sc1
    v_lshrrev_b32 v66, 5, v1
    v_mul_u32_u24 v66, 2080, v66
    v_bfe_u32 v9, v1, 2, 2
    v_lshl_add_u32 v66, v9, 7, v66
    v_bfe_u32 v9, v1, 3, 1
    v_lshl_add_u32 v66, v9, 6, v66
    v_and_b32 v9, 3, v1
    v_lshl_add_u32 v66, v9, 3, v66
    v_bfe_u32 v67, v1, 4, 1
    v_mul_u32_u24 v67, 1056, v67
    v_bfe_u32 v68, v1, 3, 1
    v_lshlrev_b32 v68, 7, v68
    v_add_u32 v66, v66, v67
    v_sub_u32 v67, v66, v68
    v_add_u32 v67, 64, v67
    v_add_u32 v68, 49920, v66
    v_add_u32 v69, 49920, v67
    v_add_u32 v70, 99840, v66
    v_add_u32 v71, 99840, v67
    s_lshl_b32 s96, s76, 11
    s_add_u32 s14, s96, 156416
    v_bfe_u32 v4, v1, 2, 2
    v_lshl_add_u32 v4, v4, 6, s14
    v_bfe_u32 v9, v1, 4, 1
    v_lshl_add_u32 v4, v9, 5, v4
    v_and_b32 v9, 3, v1
    v_lshl_add_u32 v4, v9, 3, v4
    v_lshrrev_b32 v9, 5, v1
    v_lshl_add_u32 v4, v9, 9, v4
    v_and_b32 v5, 7, v1
    v_lshlrev_b32 v5, 12, v5
    v_bfe_u32 v9, v1, 3, 1
    v_lshl_add_u32 v5, v9, 19, v5
    s_and_b32 s96, s12, 1
    s_lshl_b32 s97, s21, 15
    s_lshr_b32 s98, s12, 1
    s_lshl_b32 s99, s98, 6
    s_add_u32 s98, s97, s99
    s_lshl2_add_u32 s97, s96, s98
    s_add_u32 s13, s97, 1048576
    v_bfe_u32 v6, v1, 4, 1
    v_lshlrev_b32 v6, 6, v6
    v_lshrrev_b32 v9, 5, v1
    v_lshl_add_u32 v6, v9, 4, v6
    v_and_b32 v74, 7, v1
    v_lshlrev_b32 v74, 4, v74
    v_xor_b32 v74, v74, v6
    v_lshrrev_b32 v6, 3, v1
    v_lshlrev_b32 v6, 11, v6
    v_add_u32 v74, v74, v6
    s_and_b32 s96, s3, 2
    s_lshl_b32 s14, s96, 5
    v_bfe_u32 v6, v1, 4, 1
    v_lshl_add_u32 v6, v6, 5, s14
    v_and_b32 v72, 7, v1
    v_lshlrev_b32 v72, 4, v72
    v_xor_b32 v72, v72, v6
    v_lshrrev_b32 v6, 3, v1
    v_mul_u32_u24 v6, 7168, v6
    v_add_u32 v72, v72, v6
    s_and_b32 s96, s3, 1
    s_lshl_b32 s14, s96, 7
    v_lshrrev_b32 v6, 5, v1
    v_lshl_add_u32 v6, v6, 6, s14
    v_and_b32 v73, 31, v1
    v_lshlrev_b32 v73, 4, v73
    v_lshrrev_b32 v9, 5, v1
    v_lshl_add_u32 v73, v9, 11, v73
    v_xor_b32 v73, v73, v6
    s_lshl3_add_u32 s96, s75, s3
    s_mul_i32 s97, s96, 229376
    s_lshl_b32 s98, s74, 7
    s_add_u32 s80, s97, s98
    s_lshl3_add_u32 s96, s74, s3
    s_lshl_b32 s97, s96, 14
    s_lshl_b32 s98, s75, 9
    s_add_u32 s81, s97, s98
    s_cmp_ge_u32 s9, 28
    s_cselect_b32 s54, 0, s54
    s_cselect_b32 s58, 0, s58
    s_cselect_b32 s62, 0, s62
    s_waitcnt vmcnt(0)
    s_barrier
    s_cmp_lg_u32 s3, 0
    s_cbranch_scc1 L_PB
    v_mov_b32 v6, s4
    s_mov_b32 exec_hi, 0
    s_mov_b32 exec_lo, 65535
    buffer_store_dword v6, v5, s[32:35], s13 offen sc1
    s_mov_b64 exec, -1
L_PB:
    s_and_b32 s20, s9, 3
    s_cmp_le_u32 s20, 0
    s_cselect_b32 s20, 1, 0
    s_add_u32 s96, s20, s85
    s_and_b32 s97, s96, 15
    s_lshl3_add_u32 s98, s97, s3
    s_mul_i32 s99, s98, 49152
    s_lshl_b32 s96, s11, 7
    s_add_u32 s82, s99, s96
    s_mul_i32 s96, s20, 24960
    s_lshr_b32 s97, s3, 1
    s_mul_i32 s98, s97, 2080
    s_add_u32 s99, s96, s98
    s_and_b32 s97, s3, 1
    s_mul_i32 s96, s97, 1056
    s_add_u32 s20, s99, s96
    s_mov_b32 m0, s20
    s_nop 0
    buffer_load_dwordx4 v62, s[40:43], s82 offen lds
    s_add_u32 s82, s82, 2048
    s_add_u32 m0, s20, 8320
    s_nop 0
    buffer_load_dwordx4 v62, s[40:43], s82 offen lds
    s_add_u32 s82, s82, 2048
    s_add_u32 m0, s20, 16640
    s_nop 0
    buffer_load_dwordx4 v62, s[40:43], s82 offen lds
    s_and_b32 s20, s9, 3
    s_cmp_le_u32 s20, 1
    s_cselect_b32 s20, 2, 1
    s_add_u32 s96, s20, s85
    s_and_b32 s97, s96, 15
    s_lshl3_add_u32 s98, s97, s3
    s_mul_i32 s99, s98, 49152
    s_lshl_b32 s96, s11, 7
    s_add_u32 s82, s99, s96
    s_mul_i32 s96, s20, 24960
    s_lshr_b32 s97, s3, 1
    s_mul_i32 s98, s97, 2080
    s_add_u32 s99, s96, s98
    s_and_b32 s97, s3, 1
    s_mul_i32 s96, s97, 1056
    s_add_u32 s20, s99, s96
    s_mov_b32 m0, s20
    s_nop 0
    buffer_load_dwordx4 v62, s[40:43], s82 offen lds
    s_add_u32 s82, s82, 2048
    s_add_u32 m0, s20, 8320
    s_nop 0
    buffer_load_dwordx4 v62, s[40:43], s82 offen lds
    s_add_u32 s82, s82, 2048
    s_add_u32 m0, s20, 16640
    s_nop 0
    buffer_load_dwordx4 v62, s[40:43], s82 offen lds
    ds_read_b64_tr_b16 v[28:29], v4
    ds_read_b64_tr_b16 v[30:31], v4 offset:256
    ds_read_b64_tr_b16 v[32:33], v4 offset:1024
    ds_read_b64_tr_b16 v[34:35], v4 offset:1280
    s_lshl_b32 s96, s10, 6
    s_add_u32 s97, s96, s3
    s_lshl_b32 s98, s97, 12
    s_add_u32 s15, s98, 4194304
    s_and_b32 s96, s3, 3
    s_lshl_b32 s97, s96, 12
    s_add_u32 s13, s97, 147456
    v_add_u32 v76, s13, v2
    v_and_b32 v77, 15, v1
    v_lshl_add_u32 v77, v77, 4, s13
    v_lshrrev_b32 v9, 5, v1
    v_lshl_add_u32 v77, v9, 9, v77
    v_bfe_u32 v9, v1, 4, 1
    v_lshl_add_u32 v77, v9, 3, v77
    s_and_b32 s96, s3, 3
    s_lshl_b32 s97, s96, 10
    s_add_u32 s13, s97, 32768
    v_and_b32 v78, 15, v1
    v_lshl_add_u32 v78, v78, 5, s13
    v_lshrrev_b32 v9, 4, v1
    v_lshl_add_u32 v78, v9, 3, v78
    s_and_b32 s96, s3, 3
    s_lshl_b32 s97, s96, 10
    s_lshl_b32 s98, s76, 14
    s_add_u32 s13, s97, s98
    v_and_b32 v75, 31, v1
    v_lshl_add_u32 v75, v75, 5, s13
    v_lshrrev_b32 v9, 5, v1
    v_lshl_add_u32 v75, v9, 4, v75
    s_lshl_b32 s84, s3, 14
    s_lshr_b32 s96, s9, 4
    s_lshl_b32 s97, s96, 20
    s_lshl_b32 s98, s12, 7
    s_add_u32 s88, s97, s98
    s_lshl_b32 s89, s3, 10
    s_load_dwordx2 s[24:25], s[32:33], s92 offset:0 glc
    s_and_b32 s20, s9, 3
    s_cmp_le_u32 s20, 2
    s_cselect_b32 s20, 3, 2
    s_add_u32 s96, s20, s85
    s_and_b32 s97, s96, 15
    s_lshl3_add_u32 s98, s97, s3
    s_mul_i32 s99, s98, 49152
    s_lshl_b32 s96, s11, 7
    s_add_u32 s82, s99, s96
    s_mul_i32 s96, s20, 24960
    s_lshr_b32 s97, s3, 1
    s_mul_i32 s98, s97, 2080
    s_add_u32 s99, s96, s98
    s_and_b32 s97, s3, 1
    s_mul_i32 s96, s97, 1056
    s_add_u32 s20, s99, s96
    s_mov_b32 m0, s20
    s_nop 0
    buffer_load_dwordx4 v62, s[40:43], s82 offen lds
    s_add_u32 s82, s82, 2048
    s_add_u32 m0, s20, 8320
    s_nop 0
    buffer_load_dwordx4 v62, s[40:43], s82 offen lds
    s_add_u32 s82, s82, 2048
    s_add_u32 m0, s20, 16640
    s_nop 0
    buffer_load_dwordx4 v62, s[40:43], s82 offen lds
    s_add_u32 s96, s85, 4
    s_and_b32 s97, s96, 15
    s_lshl3_add_u32 s98, s97, s3
    s_mul_i32 s99, s98, 49152
    s_lshl_b32 s96, s11, 7
    s_add_u32 s82, s99, s96
    s_lshr_b32 s96, s3, 1
    s_mul_i32 s97, s96, 2080
    s_and_b32 s98, s3, 1
    s_mul_i32 s99, s98, 1056
    s_add_u32 s96, s97, s99
    s_add_u32 s20, s96, 99840
    s_mov_b32 m0, s20
    s_nop 0
    buffer_load_dwordx4 v62, s[40:43], s82 offen lds
    s_add_u32 s82, s82, 2048
    s_add_u32 m0, s20, 8320
    s_nop 0
    buffer_load_dwordx4 v62, s[40:43], s82 offen lds
    s_add_u32 s82, s82, 2048
    s_add_u32 m0, s20, 16640
    s_nop 0
    buffer_load_dwordx4 v62, s[40:43], s82 offen lds
    s_branch SCHK_12
SPOLL_11:
    s_load_dwordx2 s[24:25], s[32:33], s92 offset:0 glc
SCHK_12:
    s_add_u32 s5, s5, 1
    s_cmp_ge_u32 s5, 300000
    s_waitcnt lgkmcnt(0)
    s_cbranch_scc1 SDONE_13
    s_cmp_lg_u32 s24, s4
    s_cbranch_scc1 SPOLL_11
    s_cmp_lg_u32 s25, s4
    s_cbranch_scc1 SPOLL_11
SDONE_13:
    s_waitcnt vmcnt(9)
    s_barrier
    s_cmp_ge_u32 s3, 4
    s_cbranch_scc1 L_HELP
    s_setprio 2
    s_and_b32 s96, s85, 15
    s_lshl_b32 s97, s96, 14
    s_add_u32 s16, s97, s15
    buffer_load_dwordx4 v[176:179], v2, s[32:35], s16 offen sc1
    buffer_load_dwordx4 v[180:183], v2, s[32:35], s16 offen offset:1024 sc1
    ds_read_b64_tr_b16 v[224:225], v67 offset:8320
    ds_read_b64_tr_b16 v[226:227], v67 offset:8832
    ds_read_b64_tr_b16 v[228:229], v67 offset:8352
    ds_read_b64_tr_b16 v[230:231], v67 offset:8864
    ds_read_b64_tr_b16 v[232:233], v66 offset:8320
    ds_read_b64_tr_b16 v[234:235], v66 offset:8832
    ds_read_b64_tr_b16 v[236:237], v66 offset:8352
    ds_read_b64_tr_b16 v[238:239], v66 offset:8864
    ds_read_b64_tr_b16 v[240:241], v66
    ds_read_b64_tr_b16 v[242:243], v66 offset:512
    ds_read_b64_tr_b16 v[244:245], v66 offset:32
    ds_read_b64_tr_b16 v[246:247], v66 offset:544
    buffer_load_dwordx4 v[184:187], v2, s[32:35], s16 offen offset:2048 sc1
    buffer_load_dwordx4 v[188:191], v2, s[32:35], s16 offen offset:3072 sc1
    s_waitcnt lgkmcnt(8)
    s_waitcnt vmcnt(3)
    v_mfma_f32_16x16x32_bf16 v[128:131], v[224:227], v[176:179], 0
    ds_read_b64_tr_b16 v[248:249], v67
    s_waitcnt vmcnt(2)
    v_mfma_f32_16x16x32_bf16 v[132:135], v[224:227], v[180:183], 0
    ds_read_b64_tr_b16 v[250:251], v67 offset:512
    s_add_u32 s96, s85, 1
    s_and_b32 s97, s96, 15
    s_lshl_b32 s98, s97, 14
    s_add_u32 s16, s98, s15
    buffer_load_dwordx4 v[192:195], v2, s[32:35], s16 offen sc1
    v_mfma_f32_16x16x32_bf16 v[136:139], v[228:231], v[176:179], 0
    ds_read_b64_tr_b16 v[224:225], v67 offset:32
    v_mfma_f32_16x16x32_bf16 v[140:143], v[228:231], v[180:183], 0
    ds_read_b64_tr_b16 v[226:227], v67 offset:544
    s_waitcnt lgkmcnt(8)
    v_mfma_f32_16x16x32_bf16 v[112:115], v[232:235], v[176:179], 0
    ds_read_b64_tr_b16 v[228:229], v66 offset:16640
    v_mfma_f32_16x16x32_bf16 v[116:119], v[232:235], v[180:183], 0
    ds_read_b64_tr_b16 v[230:231], v66 offset:17152
    v_mfma_f32_16x16x32_bf16 v[120:123], v[236:239], v[176:179], 0
    ds_read_b64_tr_b16 v[232:233], v66 offset:16672
    v_mfma_f32_16x16x32_bf16 v[124:127], v[236:239], v[180:183], 0
    ds_read_b64_tr_b16 v[234:235], v66 offset:17184
    buffer_load_dwordx4 v[196:199], v2, s[32:35], s16 offen offset:1024 sc1
    s_waitcnt lgkmcnt(8)
    v_mfma_f32_16x16x32_bf16 v[80:83], v[240:243], v[176:179], 0
    ds_read_b64_tr_b16 v[236:237], v67 offset:16640
    v_mfma_f32_16x16x32_bf16 v[84:87], v[240:243], v[180:183], 0
    ds_read_b64_tr_b16 v[238:239], v67 offset:17152
    v_mfma_f32_16x16x32_bf16 v[88:91], v[244:247], v[176:179], 0
    ds_read_b64_tr_b16 v[240:241], v67 offset:16672
    v_mfma_f32_16x16x32_bf16 v[92:95], v[244:247], v[180:183], 0
    ds_read_b64_tr_b16 v[242:243], v67 offset:17184
    s_waitcnt lgkmcnt(8)
    v_mfma_f32_16x16x32_bf16 v[96:99], v[248:251], v[176:179], 0
    ds_read_b64_tr_b16 v[244:245], v67 offset:12480
    v_mfma_f32_16x16x32_bf16 v[100:103], v[248:251], v[180:183], 0
    ds_read_b64_tr_b16 v[246:247], v67 offset:12992
    buffer_load_dwordx4 v[200:203], v2, s[32:35], s16 offen offset:2048 sc1
    v_mfma_f32_16x16x32_bf16 v[104:107], v[224:227], v[176:179], 0
    ds_read_b64_tr_b16 v[248:249], v67 offset:12512
    v_mfma_f32_16x16x32_bf16 v[108:111], v[224:227], v[180:183], 0
    ds_read_b64_tr_b16 v[250:251], v67 offset:13024
    s_waitcnt lgkmcnt(8)
    v_mfma_f32_16x16x32_bf16 v[144:147], v[228:231], v[176:179], 0
    ds_read_b64_tr_b16 v[224:225], v66 offset:12480
    v_mfma_f32_16x16x32_bf16 v[148:151], v[228:231], v[180:183], 0
    ds_read_b64_tr_b16 v[226:227], v66 offset:12992
    v_mfma_f32_16x16x32_bf16 v[152:155], v[232:235], v[176:179], 0
    ds_read_b64_tr_b16 v[228:229], v66 offset:12512
    v_mfma_f32_16x16x32_bf16 v[156:159], v[232:235], v[180:183], 0
    ds_read_b64_tr_b16 v[230:231], v66 offset:13024
    buffer_load_dwordx4 v[204:207], v2, s[32:35], s16 offen offset:3072 sc1
    s_waitcnt lgkmcnt(8)
    v_mfma_f32_16x16x32_bf16 v[160:163], v[236:239], v[176:179], 0
    ds_read_b64_tr_b16 v[232:233], v66 offset:4160
    v_mfma_f32_16x16x32_bf16 v[164:167], v[236:239], v[180:183], 0
    ds_read_b64_tr_b16 v[234:235], v66 offset:4672
    v_mfma_f32_16x16x32_bf16 v[168:171], v[240:243], v[176:179], 0
    ds_read_b64_tr_b16 v[236:237], v66 offset:4192
    v_mfma_f32_16x16x32_bf16 v[172:175], v[240:243], v[180:183], 0
    ds_read_b64_tr_b16 v[238:239], v66 offset:4704
    s_waitcnt lgkmcnt(8)
    s_waitcnt vmcnt(5)
    v_mfma_f32_16x16x32_bf16 v[128:131], v[244:247], v[184:187], v[128:131]
    ds_read_b64_tr_b16 v[240:241], v67 offset:4160
    s_waitcnt vmcnt(4)
    v_mfma_f32_16x16x32_bf16 v[132:135], v[244:247], v[188:191], v[132:135]
    ds_read_b64_tr_b16 v[242:243], v67 offset:4672
    s_add_u32 s96, s85, 2
    s_and_b32 s97, s96, 15
    s_lshl_b32 s98, s97, 14
    s_add_u32 s16, s98, s15
    buffer_load_dwordx4 v[208:211], v2, s[32:35], s16 offen sc1
    v_mfma_f32_16x16x32_bf16 v[136:139], v[248:251], v[184:187], v[136:139]
    ds_read_b64_tr_b16 v[244:245], v67 offset:4192
    v_mfma_f32_16x16x32_bf16 v[140:143], v[248:251], v[188:191], v[140:143]
    ds_read_b64_tr_b16 v[246:247], v67 offset:4704
    s_waitcnt lgkmcnt(8)
    v_mfma_f32_16x16x32_bf16 v[112:115], v[224:227], v[184:187], v[112:115]
    ds_read_b64_tr_b16 v[248:249], v66 offset:20800
    v_mfma_f32_16x16x32_bf16 v[116:119], v[224:227], v[188:191], v[116:119]
    ds_read_b64_tr_b16 v[250:251], v66 offset:21312
    v_mfma_f32_16x16x32_bf16 v[120:123], v[228:231], v[184:187], v[120:123]
    ds_read_b64_tr_b16 v[224:225], v66 offset:20832
    v_mfma_f32_16x16x32_bf16 v[124:127], v[228:231], v[188:191], v[124:127]
    ds_read_b64_tr_b16 v[226:227], v66 offset:21344
    buffer_load_dwordx4 v[212:215], v2, s[32:35], s16 offen offset:1024 sc1
    s_waitcnt lgkmcnt(8)
    v_mfma_f32_16x16x32_bf16 v[80:83], v[232:235], v[184:187], v[80:83]
    ds_read_b64_tr_b16 v[228:229], v67 offset:20800
    v_mfma_f32_16x16x32_bf16 v[84:87], v[232:235], v[188:191], v[84:87]
    ds_read_b64_tr_b16 v[230:231], v67 offset:21312
    v_mfma_f32_16x16x32_bf16 v[88:91], v[236:239], v[184:187], v[88:91]
    ds_read_b64_tr_b16 v[232:233], v67 offset:20832
    v_mfma_f32_16x16x32_bf16 v[92:95], v[236:239], v[188:191], v[92:95]
    ds_read_b64_tr_b16 v[234:235], v67 offset:21344
    s_waitcnt lgkmcnt(8)
    v_mfma_f32_16x16x32_bf16 v[96:99], v[240:243], v[184:187], v[96:99]
    s_barrier
    ds_read_b64_tr_b16 v[236:237], v67 offset:33280
    v_mfma_f32_16x16x32_bf16 v[100:103], v[240:243], v[188:191], v[100:103]
    ds_read_b64_tr_b16 v[238:239], v67 offset:33792
    buffer_load_dwordx4 v[216:219], v2, s[32:35], s16 offen offset:2048 sc1
    v_mfma_f32_16x16x32_bf16 v[104:107], v[244:247], v[184:187], v[104:107]
    ds_read_b64_tr_b16 v[240:241], v67 offset:33312
    v_mfma_f32_16x16x32_bf16 v[108:111], v[244:247], v[188:191], v[108:111]
    ds_read_b64_tr_b16 v[242:243], v67 offset:33824
    s_waitcnt lgkmcnt(8)
    v_mfma_f32_16x16x32_bf16 v[144:147], v[248:251], v[184:187], v[144:147]
    ds_read_b64_tr_b16 v[244:245], v66 offset:33280
    v_mfma_f32_16x16x32_bf16 v[148:151], v[248:251], v[188:191], v[148:151]
    ds_read_b64_tr_b16 v[246:247], v66 offset:33792
    v_mfma_f32_16x16x32_bf16 v[152:155], v[224:227], v[184:187], v[152:155]
    ds_read_b64_tr_b16 v[248:249], v66 offset:33312
    v_mfma_f32_16x16x32_bf16 v[156:159], v[224:227], v[188:191], v[156:159]
    ds_read_b64_tr_b16 v[250:251], v66 offset:33824
    buffer_load_dwordx4 v[220:223], v2, s[32:35], s16 offen offset:3072 sc1
    s_waitcnt lgkmcnt(8)
    v_mfma_f32_16x16x32_bf16 v[160:163], v[228:231], v[184:187], v[160:163]
    ds_read_b64_tr_b16 v[224:225], v66 offset:24960
    v_mfma_f32_16x16x32_bf16 v[164:167], v[228:231], v[188:191], v[164:167]
    ds_read_b64_tr_b16 v[226:227], v66 offset:25472
    v_mfma_f32_16x16x32_bf16 v[168:171], v[232:235], v[184:187], v[168:171]
    ds_read_b64_tr_b16 v[228:229], v66 offset:24992
    v_mfma_f32_16x16x32_bf16 v[172:175], v[232:235], v[188:191], v[172:175]
    ds_read_b64_tr_b16 v[230:231], v66 offset:25504
    s_waitcnt lgkmcnt(8)
    s_waitcnt vmcnt(6)
    v_mfma_f32_16x16x32_bf16 v[128:131], v[236:239], v[192:195], v[128:131]
    ds_read_b64_tr_b16 v[232:233], v67 offset:24960
    v_mfma_f32_16x16x32_bf16 v[132:135], v[236:239], v[196:199], v[132:135]
    ds_read_b64_tr_b16 v[234:235], v67 offset:25472
    s_add_u32 s96, s85, 3
    s_and_b32 s97, s96, 15
    s_lshl_b32 s98, s97, 14
    s_add_u32 s16, s98, s15
    buffer_load_dwordx4 v[176:179], v2, s[32:35], s16 offen sc1
    v_mfma_f32_16x16x32_bf16 v[136:139], v[240:243], v[192:195], v[136:139]
    ds_read_b64_tr_b16 v[236:237], v67 offset:24992
    v_mfma_f32_16x16x32_bf16 v[140:143], v[240:243], v[196:199], v[140:143]
    ds_read_b64_tr_b16 v[238:239], v67 offset:25504
    s_waitcnt lgkmcnt(8)
    v_mfma_f32_16x16x32_bf16 v[112:115], v[244:247], v[192:195], v[112:115]
    ds_read_b64_tr_b16 v[240:241], v66 offset:41600
    v_mfma_f32_16x16x32_bf16 v[116:119], v[244:247], v[196:199], v[116:119]
    ds_read_b64_tr_b16 v[242:243], v66 offset:42112
    v_mfma_f32_16x16x32_bf16 v[120:123], v[248:251], v[192:195], v[120:123]
    ds_read_b64_tr_b16 v[244:245], v66 offset:41632
    v_mfma_f32_16x16x32_bf16 v[124:127], v[248:251], v[196:199], v[124:127]
    ds_read_b64_tr_b16 v[246:247], v66 offset:42144
    buffer_load_dwordx4 v[180:183], v2, s[32:35], s16 offen offset:1024 sc1
    s_waitcnt lgkmcnt(8)
    v_mfma_f32_16x16x32_bf16 v[80:83], v[224:227], v[192:195], v[80:83]
    ds_read_b64_tr_b16 v[248:249], v67 offset:41600
    v_mfma_f32_16x16x32_bf16 v[84:87], v[224:227], v[196:199], v[84:87]
    ds_read_b64_tr_b16 v[250:251], v67 offset:42112
    v_mfma_f32_16x16x32_bf16 v[88:91], v[228:231], v[192:195], v[88:91]
    ds_read_b64_tr_b16 v[224:225], v67 offset:41632
    v_mfma_f32_16x16x32_bf16 v[92:95], v[228:231], v[196:199], v[92:95]
    ds_read_b64_tr_b16 v[226:227], v67 offset:42144
    s_waitcnt lgkmcnt(8)
    v_mfma_f32_16x16x32_bf16 v[96:99], v[232:235], v[192:195], v[96:99]
    ds_read_b64_tr_b16 v[228:229], v67 offset:37440
    v_mfma_f32_16x16x32_bf16 v[100:103], v[232:235], v[196:199], v[100:103]
    ds_read_b64_tr_b16 v[230:231], v67 offset:37952
    buffer_load_dwordx4 v[184:187], v2, s[32:35], s16 offen offset:2048 sc1
    v_mfma_f32_16x16x32_bf16 v[104:107], v[236:239], v[192:195], v[104:107]
    ds_read_b64_tr_b16 v[232:233], v67 offset:37472
    v_mfma_f32_16x16x32_bf16 v[108:111], v[236:239], v[196:199], v[108:111]
    ds_read_b64_tr_b16 v[234:235], v67 offset:37984
    s_waitcnt lgkmcnt(8)
    v_mfma_f32_16x16x32_bf16 v[144:147], v[240:243], v[192:195], v[144:147]
    ds_read_b64_tr_b16 v[236:237], v66 offset:37440
    v_mfma_f32_16x16x32_bf16 v[148:151], v[240:243], v[196:199], v[148:151]
    ds_read_b64_tr_b16 v[238:239], v66 offset:37952
    v_mfma_f32_16x16x32_bf16 v[152:155], v[244:247], v[192:195], v[152:155]
    ds_read_b64_tr_b16 v[240:241], v66 offset:37472
    v_mfma_f32_16x16x32_bf16 v[156:159], v[244:247], v[196:199], v[156:159]
    ds_read_b64_tr_b16 v[242:243], v66 offset:37984
    buffer_load_dwordx4 v[188:191], v2, s[32:35], s16 offen offset:3072 sc1
    s_waitcnt lgkmcnt(8)
    v_mfma_f32_16x16x32_bf16 v[160:163], v[248:251], v[192:195], v[160:163]
    ds_read_b64_tr_b16 v[244:245], v66 offset:29120
    v_mfma_f32_16x16x32_bf16 v[164:167], v[248:251], v[196:199], v[164:167]
    ds_read_b64_tr_b16 v[246:247], v66 offset:29632
    v_mfma_f32_16x16x32_bf16 v[168:171], v[224:227], v[192:195], v[168:171]
    ds_read_b64_tr_b16 v[248:249], v66 offset:29152
    v_mfma_f32_16x16x32_bf16 v[172:175], v[224:227], v[196:199], v[172:175]
    ds_read_b64_tr_b16 v[250:251], v66 offset:29664
    s_waitcnt lgkmcnt(8)
    s_waitcnt vmcnt(8)
    v_mfma_f32_16x16x32_bf16 v[128:131], v[228:231], v[200:203], v[128:131]
    ds_read_b64_tr_b16 v[224:225], v67 offset:29120
    v_mfma_f32_16x16x32_bf16 v[132:135], v[228:231], v[204:207], v[132:135]
    ds_read_b64_tr_b16 v[226:227], v67 offset:29632
    s_add_u32 s96, s85, 4
    s_and_b32 s97, s96, 15
    s_lshl_b32 s98, s97, 14
    s_add_u32 s16, s98, s15
    buffer_load_dwordx4 v[192:195], v2, s[32:35], s16 offen sc1
    v_mfma_f32_16x16x32_bf16 v[136:139], v[232:235], v[200:203], v[136:139]
    ds_read_b64_tr_b16 v[228:229], v67 offset:29152
    v_mfma_f32_16x16x32_bf16 v[140:143], v[232:235], v[204:207], v[140:143]
    ds_read_b64_tr_b16 v[230:231], v67 offset:29664
    s_waitcnt lgkmcnt(8)
    v_mfma_f32_16x16x32_bf16 v[112:115], v[236:239], v[200:203], v[112:115]
    ds_read_b64_tr_b16 v[232:233], v66 offset:45760
    v_mfma_f32_16x16x32_bf16 v[116:119], v[236:239], v[204:207], v[116:119]
    ds_read_b64_tr_b16 v[234:235], v66 offset:46272
    v_mfma_f32_16x16x32_bf16 v[120:123], v[240:243], v[200:203], v[120:123]
    ds_read_b64_tr_b16 v[236:237], v66 offset:45792
    v_mfma_f32_16x16x32_bf16 v[124:127], v[240:243], v[204:207], v[124:127]
    ds_read_b64_tr_b16 v[238:239], v66 offset:46304
    buffer_load_dwordx4 v[196:199], v2, s[32:35], s16 offen offset:1024 sc1
    s_waitcnt lgkmcnt(8)
    v_mfma_f32_16x16x32_bf16 v[80:83], v[244:247], v[200:203], v[80:83]
    ds_read_b64_tr_b16 v[240:241], v67 offset:45760
    v_mfma_f32_16x16x32_bf16 v[84:87], v[244:247], v[204:207], v[84:87]
    ds_read_b64_tr_b16 v[242:243], v67 offset:46272
    v_mfma_f32_16x16x32_bf16 v[88:91], v[248:251], v[200:203], v[88:91]
    ds_read_b64_tr_b16 v[244:245], v67 offset:45792
    v_mfma_f32_16x16x32_bf16 v[92:95], v[248:251], v[204:207], v[92:95]
    ds_read_b64_tr_b16 v[246:247], v67 offset:46304
    s_waitcnt lgkmcnt(8)
    v_mfma_f32_16x16x32_bf16 v[96:99], v[224:227], v[200:203], v[96:99]
    s_barrier
    ds_read_b64_tr_b16 v[248:249], v69 offset:8320
    v_mfma_f32_16x16x32_bf16 v[100:103], v[224:227], v[204:207], v[100:103]
    ds_read_b64_tr_b16 v[250:251], v69 offset:8832
    v_mfma_f32_16x16x32_bf16 v[104:107], v[228:231], v[200:203], v[104:107]
    ds_read_b64_tr_b16 v[224:225], v69 offset:8352
    v_mfma_f32_16x16x32_bf16 v[108:111], v[228:231], v[204:207], v[108:111]
    ds_read_b64_tr_b16 v[226:227], v69 offset:8864
    s_waitcnt lgkmcnt(8)
    v_mfma_f32_16x16x32_bf16 v[144:147], v[232:235], v[200:203], v[144:147]
    ds_read_b64_tr_b16 v[228:229], v68 offset:8320
    v_mfma_f32_16x16x32_bf16 v[148:151], v[232:235], v[204:207], v[148:151]
    ds_read_b64_tr_b16 v[230:231], v68 offset:8832
    v_mfma_f32_16x16x32_bf16 v[152:155], v[236:239], v[200:203], v[152:155]
    ds_read_b64_tr_b16 v[232:233], v68 offset:8352
    v_mfma_f32_16x16x32_bf16 v[156:159], v[236:239], v[204:207], v[156:159]
    ds_read_b64_tr_b16 v[234:235], v68 offset:8864
    s_waitcnt lgkmcnt(8)
    v_mfma_f32_16x16x32_bf16 v[160:163], v[240:243], v[200:203], v[160:163]
    ds_read_b64_tr_b16 v[236:237], v68
    v_mfma_f32_16x16x32_bf16 v[164:167], v[240:243], v[204:207], v[164:167]
    ds_read_b64_tr_b16 v[238:239], v68 offset:512
    v_mfma_f32_16x16x32_bf16 v[168:171], v[244:247], v[200:203], v[168:171]
    ds_read_b64_tr_b16 v[240:241], v68 offset:32
    v_mfma_f32_16x16x32_bf16 v[172:175], v[244:247], v[204:207], v[172:175]
    ds_read_b64_tr_b16 v[242:243], v68 offset:544
    s_waitcnt lgkmcnt(8)
    s_waitcnt vmcnt(8)
    v_mfma_f32_16x16x32_bf16 v[128:131], v[248:251], v[208:211], v[128:131]
    ds_read_b64_tr_b16 v[244:245], v69
    v_mfma_f32_16x16x32_bf16 v[132:135], v[248:251], v[212:215], v[132:135]
    ds_read_b64_tr_b16 v[246:247], v69 offset:512
    buffer_load_dwordx4 v[200:203], v2, s[32:35], s16 offen offset:2048 sc1
    v_mfma_f32_16x16x32_bf16 v[136:139], v[224:227], v[208:211], v[136:139]
    ds_read_b64_tr_b16 v[248:249], v69 offset:32
    v_mfma_f32_16x16x32_bf16 v[140:143], v[224:227], v[212:215], v[140:143]
    ds_read_b64_tr_b16 v[250:251], v69 offset:544
    s_waitcnt lgkmcnt(8)
    v_mfma_f32_16x16x32_bf16 v[112:115], v[228:231], v[208:211], v[112:115]
    ds_read_b64_tr_b16 v[224:225], v68 offset:16640
    v_mfma_f32_16x16x32_bf16 v[116:119], v[228:231], v[212:215], v[116:119]
    ds_read_b64_tr_b16 v[226:227], v68 offset:17152
    v_mfma_f32_16x16x32_bf16 v[120:123], v[232:235], v[208:211], v[120:123]
    ds_read_b64_tr_b16 v[228:229], v68 offset:16672
    v_mfma_f32_16x16x32_bf16 v[124:127], v[232:235], v[212:215], v[124:127]
    ds_read_b64_tr_b16 v[230:231], v68 offset:17184
    buffer_load_dwordx4 v[204:207], v2, s[32:35], s16 offen offset:3072 sc1
    s_waitcnt lgkmcnt(8)
    v_mfma_f32_16x16x32_bf16 v[80:83], v[236:239], v[208:211], v[80:83]
    ds_read_b64_tr_b16 v[232:233], v69 offset:16640
    v_mfma_f32_16x16x32_bf16 v[84:87], v[236:239], v[212:215], v[84:87]
    ds_read_b64_tr_b16 v[234:235], v69 offset:17152
    v_mfma_f32_16x16x32_bf16 v[88:91], v[240:243], v[208:211], v[88:91]
    ds_read_b64_tr_b16 v[236:237], v69 offset:16672
    v_mfma_f32_16x16x32_bf16 v[92:95], v[240:243], v[212:215], v[92:95]
    ds_read_b64_tr_b16 v[238:239], v69 offset:17184
    s_waitcnt lgkmcnt(8)
    v_mfma_f32_16x16x32_bf16 v[96:99], v[244:247], v[208:211], v[96:99]
    ds_read_b64_tr_b16 v[240:241], v69 offset:12480
    v_mfma_f32_16x16x32_bf16 v[100:103], v[244:247], v[212:215], v[100:103]
    ds_read_b64_tr_b16 v[242:243], v69 offset:12992
    v_mfma_f32_16x16x32_bf16 v[104:107], v[248:251], v[208:211], v[104:107]
    ds_read_b64_tr_b16 v[244:245], v69 offset:12512
    v_mfma_f32_16x16x32_bf16 v[108:111], v[248:251], v[212:215], v[108:111]
    ds_read_b64_tr_b16 v[246:247], v69 offset:13024
    s_waitcnt lgkmcnt(8)
    v_mfma_f32_16x16x32_bf16 v[144:147], v[224:227], v[208:211], v[144:147]
    ds_read_b64_tr_b16 v[248:249], v68 offset:12480
    v_mfma_f32_16x16x32_bf16 v[148:151], v[224:227], v[212:215], v[148:151]
    ds_read_b64_tr_b16 v[250:251], v68 offset:12992
    v_mfma_f32_16x16x32_bf16 v[152:155], v[228:231], v[208:211], v[152:155]
    ds_read_b64_tr_b16 v[224:225], v68 offset:12512
    v_mfma_f32_16x16x32_bf16 v[156:159], v[228:231], v[212:215], v[156:159]
    ds_read_b64_tr_b16 v[226:227], v68 offset:13024
    s_waitcnt lgkmcnt(8)
    v_mfma_f32_16x16x32_bf16 v[160:163], v[232:235], v[208:211], v[160:163]
    ds_read_b64_tr_b16 v[228:229], v68 offset:4160
    v_mfma_f32_16x16x32_bf16 v[164:167], v[232:235], v[212:215], v[164:167]
    ds_read_b64_tr_b16 v[230:231], v68 offset:4672
    v_mfma_f32_16x16x32_bf16 v[168:171], v[236:239], v[208:211], v[168:171]
    ds_read_b64_tr_b16 v[232:233], v68 offset:4192
    v_mfma_f32_16x16x32_bf16 v[172:175], v[236:239], v[212:215], v[172:175]
    ds_read_b64_tr_b16 v[234:235], v68 offset:4704
    s_waitcnt lgkmcnt(8)
    s_waitcnt vmcnt(8)
    v_mfma_f32_16x16x32_bf16 v[128:131], v[240:243], v[216:219], v[128:131]
    ds_read_b64_tr_b16 v[236:237], v69 offset:4160
    v_mfma_f32_16x16x32_bf16 v[132:135], v[240:243], v[220:223], v[132:135]
    ds_read_b64_tr_b16 v[238:239], v69 offset:4672
    s_add_u32 s96, s85, 5
    s_and_b32 s97, s96, 15
    s_lshl_b32 s98, s97, 14
    s_add_u32 s16, s98, s15
    buffer_load_dwordx4 v[208:211], v2, s[32:35], s16 offen sc1
    v_mfma_f32_16x16x32_bf16 v[136:139], v[244:247], v[216:219], v[136:139]
    ds_read_b64_tr_b16 v[240:241], v69 offset:4192
    v_mfma_f32_16x16x32_bf16 v[140:143], v[244:247], v[220:223], v[140:143]
    ds_read_b64_tr_b16 v[242:243], v69 offset:4704
    s_waitcnt lgkmcnt(8)
    v_mfma_f32_16x16x32_bf16 v[112:115], v[248:251], v[216:219], v[112:115]
    ds_read_b64_tr_b16 v[244:245], v68 offset:20800
    v_mfma_f32_16x16x32_bf16 v[116:119], v[248:251], v[220:223], v[116:119]
    ds_read_b64_tr_b16 v[246:247], v68 offset:21312
    v_mfma_f32_16x16x32_bf16 v[120:123], v[224:227], v[216:219], v[120:123]
    ds_read_b64_tr_b16 v[248:249], v68 offset:20832
    v_mfma_f32_16x16x32_bf16 v[124:127], v[224:227], v[220:223], v[124:127]
    ds_read_b64_tr_b16 v[250:251], v68 offset:21344
    buffer_load_dwordx4 v[212:215], v2, s[32:35], s16 offen offset:1024 sc1
    s_waitcnt lgkmcnt(8)
    v_mfma_f32_16x16x32_bf16 v[80:83], v[228:231], v[216:219], v[80:83]
    ds_read_b64_tr_b16 v[224:225], v69 offset:20800
    v_mfma_f32_16x16x32_bf16 v[84:87], v[228:231], v[220:223], v[84:87]
    ds_read_b64_tr_b16 v[226:227], v69 offset:21312
    v_mfma_f32_16x16x32_bf16 v[88:91], v[232:235], v[216:219], v[88:91]
    ds_read_b64_tr_b16 v[228:229], v69 offset:20832
    v_mfma_f32_16x16x32_bf16 v[92:95], v[232:235], v[220:223], v[92:95]
    ds_read_b64_tr_b16 v[230:231], v69 offset:21344
    s_waitcnt lgkmcnt(8)
    v_mfma_f32_16x16x32_bf16 v[96:99], v[236:239], v[216:219], v[96:99]
    s_barrier
    ds_read_b64_tr_b16 v[232:233], v69 offset:33280
    v_mfma_f32_16x16x32_bf16 v[100:103], v[236:239], v[220:223], v[100:103]
    ds_read_b64_tr_b16 v[234:235], v69 offset:33792
    v_mfma_f32_16x16x32_bf16 v[104:107], v[240:243], v[216:219], v[104:107]
    ds_read_b64_tr_b16 v[236:237], v69 offset:33312
    v_mfma_f32_16x16x32_bf16 v[108:111], v[240:243], v[220:223], v[108:111]
    ds_read_b64_tr_b16 v[238:239], v69 offset:33824
    s_waitcnt lgkmcnt(8)
    v_mfma_f32_16x16x32_bf16 v[144:147], v[244:247], v[216:219], v[144:147]
    ds_read_b64_tr_b16 v[240:241], v68 offset:33280
    v_mfma_f32_16x16x32_bf16 v[148:151], v[244:247], v[220:223], v[148:151]
    ds_read_b64_tr_b16 v[242:243], v68 offset:33792
    v_mfma_f32_16x16x32_bf16 v[152:155], v[248:251], v[216:219], v[152:155]
    ds_read_b64_tr_b16 v[244:245], v68 offset:33312
    v_mfma_f32_16x16x32_bf16 v[156:159], v[248:251], v[220:223], v[156:159]
    ds_read_b64_tr_b16 v[246:247], v68 offset:33824
    s_waitcnt lgkmcnt(8)
    v_mfma_f32_16x16x32_bf16 v[160:163], v[224:227], v[216:219], v[160:163]
    ds_read_b64_tr_b16 v[248:249], v68 offset:24960
    v_mfma_f32_16x16x32_bf16 v[164:167], v[224:227], v[220:223], v[164:167]
    ds_read_b64_tr_b16 v[250:251], v68 offset:25472
    v_mfma_f32_16x16x32_bf16 v[168:171], v[228:231], v[216:219], v[168:171]
    ds_read_b64_tr_b16 v[224:225], v68 offset:24992
    v_mfma_f32_16x16x32_bf16 v[172:175], v[228:231], v[220:223], v[172:175]
    ds_read_b64_tr_b16 v[226:227], v68 offset:25504
    s_waitcnt lgkmcnt(8)
    s_waitcnt vmcnt(8)
    v_mfma_f32_16x16x32_bf16 v[128:131], v[232:235], v[176:179], v[128:131]
    ds_read_b64_tr_b16 v[228:229], v69 offset:24960
    v_mfma_f32_16x16x32_bf16 v[132:135], v[232:235], v[180:183], v[132:135]
    ds_read_b64_tr_b16 v[230:231], v69 offset:25472
    buffer_load_dwordx4 v[216:219], v2, s[32:35], s16 offen offset:2048 sc1
    v_mfma_f32_16x16x32_bf16 v[136:139], v[236:239], v[176:179], v[136:139]
    ds_read_b64_tr_b16 v[232:233], v69 offset:24992
    v_mfma_f32_16x16x32_bf16 v[140:143], v[236:239], v[180:183], v[140:143]
    ds_read_b64_tr_b16 v[234:235], v69 offset:25504
    s_waitcnt lgkmcnt(8)
    v_mfma_f32_16x16x32_bf16 v[112:115], v[240:243], v[176:179], v[112:115]
    ds_read_b64_tr_b16 v[236:237], v68 offset:41600
    v_mfma_f32_16x16x32_bf16 v[116:119], v[240:243], v[180:183], v[116:119]
    ds_read_b64_tr_b16 v[238:239], v68 offset:42112
    v_mfma_f32_16x16x32_bf16 v[120:123], v[244:247], v[176:179], v[120:123]
    ds_read_b64_tr_b16 v[240:241], v68 offset:41632
    v_mfma_f32_16x16x32_bf16 v[124:127], v[244:247], v[180:183], v[124:127]
    ds_read_b64_tr_b16 v[242:243], v68 offset:42144
    buffer_load_dwordx4 v[220:223], v2, s[32:35], s16 offen offset:3072 sc1
    s_waitcnt lgkmcnt(8)
    v_mfma_f32_16x16x32_bf16 v[80:83], v[248:251], v[176:179], v[80:83]
    ds_read_b64_tr_b16 v[244:245], v69 offset:41600
    v_mfma_f32_16x16x32_bf16 v[84:87], v[248:251], v[180:183], v[84:87]
    ds_read_b64_tr_b16 v[246:247], v69 offset:42112
    v_mfma_f32_16x16x32_bf16 v[88:91], v[224:227], v[176:179], v[88:91]
    ds_read_b64_tr_b16 v[248:249], v69 offset:41632
    v_mfma_f32_16x16x32_bf16 v[92:95], v[224:227], v[180:183], v[92:95]
    ds_read_b64_tr_b16 v[250:251], v69 offset:42144
    s_waitcnt lgkmcnt(8)
    v_mfma_f32_16x16x32_bf16 v[96:99], v[228:231], v[176:179], v[96:99]
    ds_read_b64_tr_b16 v[224:225], v69 offset:37440
    v_mfma_f32_16x16x32_bf16 v[100:103], v[228:231], v[180:183], v[100:103]
    ds_read_b64_tr_b16 v[226:227], v69 offset:37952
    v_mfma_f32_16x16x32_bf16 v[104:107], v[232:235], v[176:179], v[104:107]
    ds_read_b64_tr_b16 v[228:229], v69 offset:37472
    v_mfma_f32_16x16x32_bf16 v[108:111], v[232:235], v[180:183], v[108:111]
    ds_read_b64_tr_b16 v[230:231], v69 offset:37984
    s_waitcnt lgkmcnt(8)
    v_mfma_f32_16x16x32_bf16 v[144:147], v[236:239], v[176:179], v[144:147]
    ds_read_b64_tr_b16 v[232:233], v68 offset:37440
    v_mfma_f32_16x16x32_bf16 v[148:151], v[236:239], v[180:183], v[148:151]
    ds_read_b64_tr_b16 v[234:235], v68 offset:37952
    v_mfma_f32_16x16x32_bf16 v[152:155], v[240:243], v[176:179], v[152:155]
    ds_read_b64_tr_b16 v[236:237], v68 offset:37472
    v_mfma_f32_16x16x32_bf16 v[156:159], v[240:243], v[180:183], v[156:159]
    ds_read_b64_tr_b16 v[238:239], v68 offset:37984
    s_waitcnt lgkmcnt(8)
    v_mfma_f32_16x16x32_bf16 v[160:163], v[244:247], v[176:179], v[160:163]
    ds_read_b64_tr_b16 v[240:241], v68 offset:29120
    v_mfma_f32_16x16x32_bf16 v[164:167], v[244:247], v[180:183], v[164:167]
    ds_read_b64_tr_b16 v[242:243], v68 offset:29632
    v_mfma_f32_16x16x32_bf16 v[168:171], v[248:251], v[176:179], v[168:171]
    ds_read_b64_tr_b16 v[244:245], v68 offset:29152
    v_mfma_f32_16x16x32_bf16 v[172:175], v[248:251], v[180:183], v[172:175]
    ds_read_b64_tr_b16 v[246:247], v68 offset:29664
    s_waitcnt lgkmcnt(8)
    s_waitcnt vmcnt(8)
    v_mfma_f32_16x16x32_bf16 v[128:131], v[224:227], v[184:187], v[128:131]
    ds_read_b64_tr_b16 v[248:249], v69 offset:29120
    v_mfma_f32_16x16x32_bf16 v[132:135], v[224:227], v[188:191], v[132:135]
    ds_read_b64_tr_b16 v[250:251], v69 offset:29632
    s_add_u32 s96, s85, 6
    s_and_b32 s97, s96, 15
    s_lshl_b32 s98, s97, 14
    s_add_u32 s16, s98, s15
    buffer_load_dwordx4 v[176:179], v2, s[32:35], s16 offen sc1
    v_mfma_f32_16x16x32_bf16 v[136:139], v[228:231], v[184:187], v[136:139]
    ds_read_b64_tr_b16 v[224:225], v69 offset:29152
    v_mfma_f32_16x16x32_bf16 v[140:143], v[228:231], v[188:191], v[140:143]
    ds_read_b64_tr_b16 v[226:227], v69 offset:29664
    s_waitcnt lgkmcnt(8)
    v_mfma_f32_16x16x32_bf16 v[112:115], v[232:235], v[184:187], v[112:115]
    ds_read_b64_tr_b16 v[228:229], v68 offset:45760
    v_mfma_f32_16x16x32_bf16 v[116:119], v[232:235], v[188:191], v[116:119]
    ds_read_b64_tr_b16 v[230:231], v68 offset:46272
    v_mfma_f32_16x16x32_bf16 v[120:123], v[236:239], v[184:187], v[120:123]
    ds_read_b64_tr_b16 v[232:233], v68 offset:45792
    v_mfma_f32_16x16x32_bf16 v[124:127], v[236:239], v[188:191], v[124:127]
    ds_read_b64_tr_b16 v[234:235], v68 offset:46304
    buffer_load_dwordx4 v[180:183], v2, s[32:35], s16 offen offset:1024 sc1
    s_waitcnt lgkmcnt(8)
    v_mfma_f32_16x16x32_bf16 v[80:83], v[240:243], v[184:187], v[80:83]
    ds_read_b64_tr_b16 v[236:237], v69 offset:45760
    v_mfma_f32_16x16x32_bf16 v[84:87], v[240:243], v[188:191], v[84:87]
    ds_read_b64_tr_b16 v[238:239], v69 offset:46272
    v_mfma_f32_16x16x32_bf16 v[88:91], v[244:247], v[184:187], v[88:91]
    ds_read_b64_tr_b16 v[240:241], v69 offset:45792
    v_mfma_f32_16x16x32_bf16 v[92:95], v[244:247], v[188:191], v[92:95]
    ds_read_b64_tr_b16 v[242:243], v69 offset:46304
    s_waitcnt lgkmcnt(8)
    v_mfma_f32_16x16x32_bf16 v[96:99], v[248:251], v[184:187], v[96:99]
    s_barrier
    ds_read_b64_tr_b16 v[244:245], v71 offset:8320
    v_mfma_f32_16x16x32_bf16 v[100:103], v[248:251], v[188:191], v[100:103]
    ds_read_b64_tr_b16 v[246:247], v71 offset:8832
    v_mfma_f32_16x16x32_bf16 v[104:107], v[224:227], v[184:187], v[104:107]
    ds_read_b64_tr_b16 v[248:249], v71 offset:8352
    v_mfma_f32_16x16x32_bf16 v[108:111], v[224:227], v[188:191], v[108:111]
    ds_read_b64_tr_b16 v[250:251], v71 offset:8864
    s_waitcnt lgkmcnt(8)
    v_mfma_f32_16x16x32_bf16 v[144:147], v[228:231], v[184:187], v[144:147]
    ds_read_b64_tr_b16 v[224:225], v70 offset:8320
    v_mfma_f32_16x16x32_bf16 v[148:151], v[228:231], v[188:191], v[148:151]
    ds_read_b64_tr_b16 v[226:227], v70 offset:8832
    v_mfma_f32_16x16x32_bf16 v[152:155], v[232:235], v[184:187], v[152:155]
    ds_read_b64_tr_b16 v[228:229], v70 offset:8352
    v_mfma_f32_16x16x32_bf16 v[156:159], v[232:235], v[188:191], v[156:159]
    ds_read_b64_tr_b16 v[230:231], v70 offset:8864
    s_waitcnt lgkmcnt(8)
    v_mfma_f32_16x16x32_bf16 v[160:163], v[236:239], v[184:187], v[160:163]
    ds_read_b64_tr_b16 v[232:233], v70
    v_mfma_f32_16x16x32_bf16 v[164:167], v[236:239], v[188:191], v[164:167]
    ds_read_b64_tr_b16 v[234:235], v70 offset:512
    v_mfma_f32_16x16x32_bf16 v[168:171], v[240:243], v[184:187], v[168:171]
    ds_read_b64_tr_b16 v[236:237], v70 offset:32
    v_mfma_f32_16x16x32_bf16 v[172:175], v[240:243], v[188:191], v[172:175]
    ds_read_b64_tr_b16 v[238:239], v70 offset:544
    s_waitcnt lgkmcnt(8)
    s_waitcnt vmcnt(8)
    v_mfma_f32_16x16x32_bf16 v[128:131], v[244:247], v[192:195], v[128:131]
    ds_read_b64_tr_b16 v[240:241], v71
    v_mfma_f32_16x16x32_bf16 v[132:135], v[244:247], v[196:199], v[132:135]
    ds_read_b64_tr_b16 v[242:243], v71 offset:512
    buffer_load_dwordx4 v[184:187], v2, s[32:35], s16 offen offset:2048 sc1
    v_mfma_f32_16x16x32_bf16 v[136:139], v[248:251], v[192:195], v[136:139]
    ds_read_b64_tr_b16 v[244:245], v71 offset:32
    v_mfma_f32_16x16x32_bf16 v[140:143], v[248:251], v[196:199], v[140:143]
    ds_read_b64_tr_b16 v[246:247], v71 offset:544
    s_waitcnt lgkmcnt(8)
    v_mfma_f32_16x16x32_bf16 v[112:115], v[224:227], v[192:195], v[112:115]
    ds_read_b64_tr_b16 v[248:249], v70 offset:16640
    v_mfma_f32_16x16x32_bf16 v[116:119], v[224:227], v[196:199], v[116:119]
    ds_read_b64_tr_b16 v[250:251], v70 offset:17152
    v_mfma_f32_16x16x32_bf16 v[120:123], v[228:231], v[192:195], v[120:123]
    ds_read_b64_tr_b16 v[224:225], v70 offset:16672
    v_mfma_f32_16x16x32_bf16 v[124:127], v[228:231], v[196:199], v[124:127]
    ds_read_b64_tr_b16 v[226:227], v70 offset:17184
    buffer_load_dwordx4 v[188:191], v2, s[32:35], s16 offen offset:3072 sc1
    s_waitcnt lgkmcnt(8)
    v_mfma_f32_16x16x32_bf16 v[80:83], v[232:235], v[192:195], v[80:83]
    ds_read_b64_tr_b16 v[228:229], v71 offset:16640
    v_mfma_f32_16x16x32_bf16 v[84:87], v[232:235], v[196:199], v[84:87]
    ds_read_b64_tr_b16 v[230:231], v71 offset:17152
    v_mfma_f32_16x16x32_bf16 v[88:91], v[236:239], v[192:195], v[88:91]
    ds_read_b64_tr_b16 v[232:233], v71 offset:16672
    v_mfma_f32_16x16x32_bf16 v[92:95], v[236:239], v[196:199], v[92:95]
    ds_read_b64_tr_b16 v[234:235], v71 offset:17184
    s_waitcnt lgkmcnt(8)
    v_mfma_f32_16x16x32_bf16 v[96:99], v[240:243], v[192:195], v[96:99]
    ds_read_b64_tr_b16 v[236:237], v71 offset:12480
    v_mfma_f32_16x16x32_bf16 v[100:103], v[240:243], v[196:199], v[100:103]
    ds_read_b64_tr_b16 v[238:239], v71 offset:12992
    v_mfma_f32_16x16x32_bf16 v[104:107], v[244:247], v[192:195], v[104:107]
    ds_read_b64_tr_b16 v[240:241], v71 offset:12512
    v_mfma_f32_16x16x32_bf16 v[108:111], v[244:247], v[196:199], v[108:111]
    ds_read_b64_tr_b16 v[242:243], v71 offset:13024
    s_waitcnt lgkmcnt(8)
    v_mfma_f32_16x16x32_bf16 v[144:147], v[248:251], v[192:195], v[144:147]
    ds_read_b64_tr_b16 v[244:245], v70 offset:12480
    v_mfma_f32_16x16x32_bf16 v[148:151], v[248:251], v[196:199], v[148:151]
    ds_read_b64_tr_b16 v[246:247], v70 offset:12992
    v_mfma_f32_16x16x32_bf16 v[152:155], v[224:227], v[192:195], v[152:155]
    ds_read_b64_tr_b16 v[248:249], v70 offset:12512
    v_mfma_f32_16x16x32_bf16 v[156:159], v[224:227], v[196:199], v[156:159]
    ds_read_b64_tr_b16 v[250:251], v70 offset:13024
    s_waitcnt lgkmcnt(8)
    v_mfma_f32_16x16x32_bf16 v[160:163], v[228:231], v[192:195], v[160:163]
    ds_read_b64_tr_b16 v[224:225], v70 offset:4160
    v_mfma_f32_16x16x32_bf16 v[164:167], v[228:231], v[196:199], v[164:167]
    ds_read_b64_tr_b16 v[226:227], v70 offset:4672
    v_mfma_f32_16x16x32_bf16 v[168:171], v[232:235], v[192:195], v[168:171]
    ds_read_b64_tr_b16 v[228:229], v70 offset:4192
    v_mfma_f32_16x16x32_bf16 v[172:175], v[232:235], v[196:199], v[172:175]
    ds_read_b64_tr_b16 v[230:231], v70 offset:4704
    s_waitcnt lgkmcnt(8)
    s_waitcnt vmcnt(8)
    v_mfma_f32_16x16x32_bf16 v[128:131], v[236:239], v[200:203], v[128:131]
    ds_read_b64_tr_b16 v[232:233], v71 offset:4160
    v_mfma_f32_16x16x32_bf16 v[132:135], v[236:239], v[204:207], v[132:135]
    ds_read_b64_tr_b16 v[234:235], v71 offset:4672
    s_add_u32 s96, s85, 7
    s_and_b32 s97, s96, 15
    s_lshl_b32 s98, s97, 14
    s_add_u32 s16, s98, s15
    buffer_load_dwordx4 v[192:195], v2, s[32:35], s16 offen sc1
    v_mfma_f32_16x16x32_bf16 v[136:139], v[240:243], v[200:203], v[136:139]
    ds_read_b64_tr_b16 v[236:237], v71 offset:4192
    v_mfma_f32_16x16x32_bf16 v[140:143], v[240:243], v[204:207], v[140:143]
    ds_read_b64_tr_b16 v[238:239], v71 offset:4704
    s_waitcnt lgkmcnt(8)
    v_mfma_f32_16x16x32_bf16 v[112:115], v[244:247], v[200:203], v[112:115]
    ds_read_b64_tr_b16 v[240:241], v70 offset:20800
    v_mfma_f32_16x16x32_bf16 v[116:119], v[244:247], v[204:207], v[116:119]
    ds_read_b64_tr_b16 v[242:243], v70 offset:21312
    v_mfma_f32_16x16x32_bf16 v[120:123], v[248:251], v[200:203], v[120:123]
    ds_read_b64_tr_b16 v[244:245], v70 offset:20832
    v_mfma_f32_16x16x32_bf16 v[124:127], v[248:251], v[204:207], v[124:127]
    ds_read_b64_tr_b16 v[246:247], v70 offset:21344
    buffer_load_dwordx4 v[196:199], v2, s[32:35], s16 offen offset:1024 sc1
    s_waitcnt lgkmcnt(8)
    v_mfma_f32_16x16x32_bf16 v[80:83], v[224:227], v[200:203], v[80:83]
    ds_read_b64_tr_b16 v[248:249], v71 offset:20800
    v_mfma_f32_16x16x32_bf16 v[84:87], v[224:227], v[204:207], v[84:87]
    ds_read_b64_tr_b16 v[250:251], v71 offset:21312
    v_mfma_f32_16x16x32_bf16 v[88:91], v[228:231], v[200:203], v[88:91]
    ds_read_b64_tr_b16 v[224:225], v71 offset:20832
    v_mfma_f32_16x16x32_bf16 v[92:95], v[228:231], v[204:207], v[92:95]
    ds_read_b64_tr_b16 v[226:227], v71 offset:21344
    s_waitcnt lgkmcnt(8)
    v_mfma_f32_16x16x32_bf16 v[96:99], v[232:235], v[200:203], v[96:99]
    s_barrier
    ds_read_b64_tr_b16 v[228:229], v71 offset:33280
    v_mfma_f32_16x16x32_bf16 v[100:103], v[232:235], v[204:207], v[100:103]
    ds_read_b64_tr_b16 v[230:231], v71 offset:33792
    v_mfma_f32_16x16x32_bf16 v[104:107], v[236:239], v[200:203], v[104:107]
    ds_read_b64_tr_b16 v[232:233], v71 offset:33312
    v_mfma_f32_16x16x32_bf16 v[108:111], v[236:239], v[204:207], v[108:111]
    ds_read_b64_tr_b16 v[234:235], v71 offset:33824
    s_waitcnt lgkmcnt(8)
    v_mfma_f32_16x16x32_bf16 v[144:147], v[240:243], v[200:203], v[144:147]
    ds_read_b64_tr_b16 v[236:237], v70 offset:33280
    v_mfma_f32_16x16x32_bf16 v[148:151], v[240:243], v[204:207], v[148:151]
    ds_read_b64_tr_b16 v[238:239], v70 offset:33792
    v_mfma_f32_16x16x32_bf16 v[152:155], v[244:247], v[200:203], v[152:155]
    ds_read_b64_tr_b16 v[240:241], v70 offset:33312
    v_mfma_f32_16x16x32_bf16 v[156:159], v[244:247], v[204:207], v[156:159]
    ds_read_b64_tr_b16 v[242:243], v70 offset:33824
    s_waitcnt lgkmcnt(8)
    v_mfma_f32_16x16x32_bf16 v[160:163], v[248:251], v[200:203], v[160:163]
    ds_read_b64_tr_b16 v[244:245], v70 offset:24960
    v_mfma_f32_16x16x32_bf16 v[164:167], v[248:251], v[204:207], v[164:167]
    ds_read_b64_tr_b16 v[246:247], v70 offset:25472
    v_mfma_f32_16x16x32_bf16 v[168:171], v[224:227], v[200:203], v[168:171]
    ds_read_b64_tr_b16 v[248:249], v70 offset:24992
    v_mfma_f32_16x16x32_bf16 v[172:175], v[224:227], v[204:207], v[172:175]
    ds_read_b64_tr_b16 v[250:251], v70 offset:25504
    s_waitcnt lgkmcnt(8)
    s_waitcnt vmcnt(8)
    v_mfma_f32_16x16x32_bf16 v[128:131], v[228:231], v[208:211], v[128:131]
    ds_read_b64_tr_b16 v[224:225], v71 offset:24960
    v_mfma_f32_16x16x32_bf16 v[132:135], v[228:231], v[212:215], v[132:135]
    ds_read_b64_tr_b16 v[226:227], v71 offset:25472
    buffer_load_dwordx4 v[200:203], v2, s[32:35], s16 offen offset:2048 sc1
    v_mfma_f32_16x16x32_bf16 v[136:139], v[232:235], v[208:211], v[136:139]
    ds_read_b64_tr_b16 v[228:229], v71 offset:24992
    v_mfma_f32_16x16x32_bf16 v[140:143], v[232:235], v[212:215], v[140:143]
    ds_read_b64_tr_b16 v[230:231], v71 offset:25504
    s_waitcnt lgkmcnt(8)
    v_mfma_f32_16x16x32_bf16 v[112:115], v[236:239], v[208:211], v[112:115]
    ds_read_b64_tr_b16 v[232:233], v70 offset:41600
    v_mfma_f32_16x16x32_bf16 v[116:119], v[236:239], v[212:215], v[116:119]
    ds_read_b64_tr_b16 v[234:235], v70 offset:42112
    v_mfma_f32_16x16x32_bf16 v[120:123], v[240:243], v[208:211], v[120:123]
    ds_read_b64_tr_b16 v[236:237], v70 offset:41632
    v_mfma_f32_16x16x32_bf16 v[124:127], v[240:243], v[212:215], v[124:127]
    ds_read_b64_tr_b16 v[238:239], v70 offset:42144
    buffer_load_dwordx4 v[204:207], v2, s[32:35], s16 offen offset:3072 sc1
    s_waitcnt lgkmcnt(8)
    v_mfma_f32_16x16x32_bf16 v[80:83], v[244:247], v[208:211], v[80:83]
    ds_read_b64_tr_b16 v[240:241], v71 offset:41600
    v_mfma_f32_16x16x32_bf16 v[84:87], v[244:247], v[212:215], v[84:87]
    ds_read_b64_tr_b16 v[242:243], v71 offset:42112
    v_mfma_f32_16x16x32_bf16 v[88:91], v[248:251], v[208:211], v[88:91]
    ds_read_b64_tr_b16 v[244:245], v71 offset:41632
    v_mfma_f32_16x16x32_bf16 v[92:95], v[248:251], v[212:215], v[92:95]
    ds_read_b64_tr_b16 v[246:247], v71 offset:42144
    s_waitcnt lgkmcnt(8)
    v_mfma_f32_16x16x32_bf16 v[96:99], v[224:227], v[208:211], v[96:99]
    ds_read_b64_tr_b16 v[248:249], v71 offset:37440
    v_mfma_f32_16x16x32_bf16 v[100:103], v[224:227], v[212:215], v[100:103]
    ds_read_b64_tr_b16 v[250:251], v71 offset:37952
    v_mfma_f32_16x16x32_bf16 v[104:107], v[228:231], v[208:211], v[104:107]
    ds_read_b64_tr_b16 v[224:225], v71 offset:37472
    v_mfma_f32_16x16x32_bf16 v[108:111], v[228:231], v[212:215], v[108:111]
    ds_read_b64_tr_b16 v[226:227], v71 offset:37984
    s_waitcnt lgkmcnt(8)
    v_mfma_f32_16x16x32_bf16 v[144:147], v[232:235], v[208:211], v[144:147]
    ds_read_b64_tr_b16 v[228:229], v70 offset:37440
    v_mfma_f32_16x16x32_bf16 v[148:151], v[232:235], v[212:215], v[148:151]
    ds_read_b64_tr_b16 v[230:231], v70 offset:37952
    v_mfma_f32_16x16x32_bf16 v[152:155], v[236:239], v[208:211], v[152:155]
    ds_read_b64_tr_b16 v[232:233], v70 offset:37472
    v_mfma_f32_16x16x32_bf16 v[156:159], v[236:239], v[212:215], v[156:159]
    ds_read_b64_tr_b16 v[234:235], v70 offset:37984
    s_waitcnt lgkmcnt(8)
    v_mfma_f32_16x16x32_bf16 v[160:163], v[240:243], v[208:211], v[160:163]
    ds_read_b64_tr_b16 v[236:237], v70 offset:29120
    v_mfma_f32_16x16x32_bf16 v[164:167], v[240:243], v[212:215], v[164:167]
    ds_read_b64_tr_b16 v[238:239], v70 offset:29632
    v_mfma_f32_16x16x32_bf16 v[168:171], v[244:247], v[208:211], v[168:171]
    ds_read_b64_tr_b16 v[240:241], v70 offset:29152
    v_mfma_f32_16x16x32_bf16 v[172:175], v[244:247], v[212:215], v[172:175]
    ds_read_b64_tr_b16 v[242:243], v70 offset:29664
    s_waitcnt lgkmcnt(8)
    s_waitcnt vmcnt(8)
    v_mfma_f32_16x16x32_bf16 v[128:131], v[248:251], v[216:219], v[128:131]
    ds_read_b64_tr_b16 v[244:245], v71 offset:29120
    v_mfma_f32_16x16x32_bf16 v[132:135], v[248:251], v[220:223], v[132:135]
    ds_read_b64_tr_b16 v[246:247], v71 offset:29632
    s_add_u32 s96, s85, 8
    s_and_b32 s97, s96, 15
    s_lshl_b32 s98, s97, 14
    s_add_u32 s16, s98, s15
    buffer_load_dwordx4 v[208:211], v2, s[32:35], s16 offen sc1
    v_mfma_f32_16x16x32_bf16 v[136:139], v[224:227], v[216:219], v[136:139]
    ds_read_b64_tr_b16 v[248:249], v71 offset:29152
    v_mfma_f32_16x16x32_bf16 v[140:143], v[224:227], v[220:223], v[140:143]
    ds_read_b64_tr_b16 v[250:251], v71 offset:29664
    s_waitcnt lgkmcnt(8)
    v_mfma_f32_16x16x32_bf16 v[112:115], v[228:231], v[216:219], v[112:115]
    ds_read_b64_tr_b16 v[224:225], v70 offset:45760
    v_mfma_f32_16x16x32_bf16 v[116:119], v[228:231], v[220:223], v[116:119]
    ds_read_b64_tr_b16 v[226:227], v70 offset:46272
    v_mfma_f32_16x16x32_bf16 v[120:123], v[232:235], v[216:219], v[120:123]
    ds_read_b64_tr_b16 v[228:229], v70 offset:45792
    v_mfma_f32_16x16x32_bf16 v[124:127], v[232:235], v[220:223], v[124:127]
    ds_read_b64_tr_b16 v[230:231], v70 offset:46304
    buffer_load_dwordx4 v[212:215], v2, s[32:35], s16 offen offset:1024 sc1
    s_waitcnt lgkmcnt(8)
    v_mfma_f32_16x16x32_bf16 v[80:83], v[236:239], v[216:219], v[80:83]
    ds_read_b64_tr_b16 v[232:233], v71 offset:45760
    v_mfma_f32_16x16x32_bf16 v[84:87], v[236:239], v[220:223], v[84:87]
    ds_read_b64_tr_b16 v[234:235], v71 offset:46272
    v_mfma_f32_16x16x32_bf16 v[88:91], v[240:243], v[216:219], v[88:91]
    ds_read_b64_tr_b16 v[236:237], v71 offset:45792
    v_mfma_f32_16x16x32_bf16 v[92:95], v[240:243], v[220:223], v[92:95]
    ds_read_b64_tr_b16 v[238:239], v71 offset:46304
    s_waitcnt lgkmcnt(8)
    v_mfma_f32_16x16x32_bf16 v[96:99], v[244:247], v[216:219], v[96:99]
    s_barrier
    ds_read_b64_tr_b16 v[240:241], v67 offset:8320
    v_mfma_f32_16x16x32_bf16 v[100:103], v[244:247], v[220:223], v[100:103]
    ds_read_b64_tr_b16 v[242:243], v67 offset:8832
    v_mfma_f32_16x16x32_bf16 v[104:107], v[248:251], v[216:219], v[104:107]
    ds_read_b64_tr_b16 v[244:245], v67 offset:8352
    v_mfma_f32_16x16x32_bf16 v[108:111], v[248:251], v[220:223], v[108:111]
    ds_read_b64_tr_b16 v[246:247], v67 offset:8864
    s_waitcnt lgkmcnt(8)
    v_mfma_f32_16x16x32_bf16 v[144:147], v[224:227], v[216:219], v[144:147]
    ds_read_b64_tr_b16 v[248:249], v66 offset:8320
    v_mfma_f32_16x16x32_bf16 v[148:151], v[224:227], v[220:223], v[148:151]
    ds_read_b64_tr_b16 v[250:251], v66 offset:8832
    v_mfma_f32_16x16x32_bf16 v[152:155], v[228:231], v[216:219], v[152:155]
    ds_read_b64_tr_b16 v[224:225], v66 offset:8352
    v_mfma_f32_16x16x32_bf16 v[156:159], v[228:231], v[220:223], v[156:159]
    ds_read_b64_tr_b16 v[226:227], v66 offset:8864
    s_waitcnt lgkmcnt(8)
    v_mfma_f32_16x16x32_bf16 v[160:163], v[232:235], v[216:219], v[160:163]
    ds_read_b64_tr_b16 v[228:229], v66
    v_mfma_f32_16x16x32_bf16 v[164:167], v[232:235], v[220:223], v[164:167]
    ds_read_b64_tr_b16 v[230:231], v66 offset:512
    v_mfma_f32_16x16x32_bf16 v[168:171], v[236:239], v[216:219], v[168:171]
    ds_read_b64_tr_b16 v[232:233], v66 offset:32
    v_mfma_f32_16x16x32_bf16 v[172:175], v[236:239], v[220:223], v[172:175]
    ds_read_b64_tr_b16 v[234:235], v66 offset:544
    s_waitcnt lgkmcnt(8)
    s_waitcnt vmcnt(8)
    v_mfma_f32_16x16x32_bf16 v[128:131], v[240:243], v[176:179], v[128:131]
    ds_read_b64_tr_b16 v[236:237], v67
    v_mfma_f32_16x16x32_bf16 v[132:135], v[240:243], v[180:183], v[132:135]
    ds_read_b64_tr_b16 v[238:239], v67 offset:512
    buffer_load_dwordx4 v[216:219], v2, s[32:35], s16 offen offset:2048 sc1
    v_mfma_f32_16x16x32_bf16 v[136:139], v[244:247], v[176:179], v[136:139]
    ds_read_b64_tr_b16 v[240:241], v67 offset:32
    v_mfma_f32_16x16x32_bf16 v[140:143], v[244:247], v[180:183], v[140:143]
    ds_read_b64_tr_b16 v[242:243], v67 offset:544
    s_waitcnt lgkmcnt(8)
    v_mfma_f32_16x16x32_bf16 v[112:115], v[248:251], v[176:179], v[112:115]
    ds_read_b64_tr_b16 v[244:245], v66 offset:16640
    v_mfma_f32_16x16x32_bf16 v[116:119], v[248:251], v[180:183], v[116:119]
    ds_read_b64_tr_b16 v[246:247], v66 offset:17152
    v_mfma_f32_16x16x32_bf16 v[120:123], v[224:227], v[176:179], v[120:123]
    ds_read_b64_tr_b16 v[248:249], v66 offset:16672
    v_mfma_f32_16x16x32_bf16 v[124:127], v[224:227], v[180:183], v[124:127]
    ds_read_b64_tr_b16 v[250:251], v66 offset:17184
    buffer_load_dwordx4 v[220:223], v2, s[32:35], s16 offen offset:3072 sc1
    s_waitcnt lgkmcnt(8)
    v_mfma_f32_16x16x32_bf16 v[80:83], v[228:231], v[176:179], v[80:83]
    ds_read_b64_tr_b16 v[224:225], v67 offset:16640
    v_mfma_f32_16x16x32_bf16 v[84:87], v[228:231], v[180:183], v[84:87]
    ds_read_b64_tr_b16 v[226:227], v67 offset:17152
    v_mfma_f32_16x16x32_bf16 v[88:91], v[232:235], v[176:179], v[88:91]
    ds_read_b64_tr_b16 v[228:229], v67 offset:16672
    v_mfma_f32_16x16x32_bf16 v[92:95], v[232:235], v[180:183], v[92:95]
    ds_read_b64_tr_b16 v[230:231], v67 offset:17184
    s_waitcnt lgkmcnt(8)
    v_mfma_f32_16x16x32_bf16 v[96:99], v[236:239], v[176:179], v[96:99]
    ds_read_b64_tr_b16 v[232:233], v67 offset:12480
    v_mfma_f32_16x16x32_bf16 v[100:103], v[236:239], v[180:183], v[100:103]
    ds_read_b64_tr_b16 v[234:235], v67 offset:12992
    v_mfma_f32_16x16x32_bf16 v[104:107], v[240:243], v[176:179], v[104:107]
    ds_read_b64_tr_b16 v[236:237], v67 offset:12512
    v_mfma_f32_16x16x32_bf16 v[108:111], v[240:243], v[180:183], v[108:111]
    ds_read_b64_tr_b16 v[238:239], v67 offset:13024
    s_waitcnt lgkmcnt(8)
    v_mfma_f32_16x16x32_bf16 v[144:147], v[244:247], v[176:179], v[144:147]
    ds_read_b64_tr_b16 v[240:241], v66 offset:12480
    v_mfma_f32_16x16x32_bf16 v[148:151], v[244:247], v[180:183], v[148:151]
    ds_read_b64_tr_b16 v[242:243], v66 offset:12992
    v_mfma_f32_16x16x32_bf16 v[152:155], v[248:251], v[176:179], v[152:155]
    ds_read_b64_tr_b16 v[244:245], v66 offset:12512
    v_mfma_f32_16x16x32_bf16 v[156:159], v[248:251], v[180:183], v[156:159]
    ds_read_b64_tr_b16 v[246:247], v66 offset:13024
    s_waitcnt lgkmcnt(8)
    v_mfma_f32_16x16x32_bf16 v[160:163], v[224:227], v[176:179], v[160:163]
    ds_read_b64_tr_b16 v[248:249], v66 offset:4160
    v_mfma_f32_16x16x32_bf16 v[164:167], v[224:227], v[180:183], v[164:167]
    ds_read_b64_tr_b16 v[250:251], v66 offset:4672
    v_mfma_f32_16x16x32_bf16 v[168:171], v[228:231], v[176:179], v[168:171]
    ds_read_b64_tr_b16 v[224:225], v66 offset:4192
    v_mfma_f32_16x16x32_bf16 v[172:175], v[228:231], v[180:183], v[172:175]
    ds_read_b64_tr_b16 v[226:227], v66 offset:4704
    s_waitcnt lgkmcnt(8)
    s_waitcnt vmcnt(8)
    v_mfma_f32_16x16x32_bf16 v[128:131], v[232:235], v[184:187], v[128:131]
    ds_read_b64_tr_b16 v[228:229], v67 offset:4160
    v_mfma_f32_16x16x32_bf16 v[132:135], v[232:235], v[188:191], v[132:135]
    ds_read_b64_tr_b16 v[230:231], v67 offset:4672
    s_add_u32 s96, s85, 9
    s_and_b32 s97, s96, 15
    s_lshl_b32 s98, s97, 14
    s_add_u32 s16, s98, s15
    buffer_load_dwordx4 v[176:179], v2, s[32:35], s16 offen sc1
    v_mfma_f32_16x16x32_bf16 v[136:139], v[236:239], v[184:187], v[136:139]
    ds_read_b64_tr_b16 v[232:233], v67 offset:4192
    v_mfma_f32_16x16x32_bf16 v[140:143], v[236:239], v[188:191], v[140:143]
    ds_read_b64_tr_b16 v[234:235], v67 offset:4704
    s_waitcnt lgkmcnt(8)
    v_mfma_f32_16x16x32_bf16 v[112:115], v[240:243], v[184:187], v[112:115]
    ds_read_b64_tr_b16 v[236:237], v66 offset:20800
    v_mfma_f32_16x16x32_bf16 v[116:119], v[240:243], v[188:191], v[116:119]
    ds_read_b64_tr_b16 v[238:239], v66 offset:21312
    v_mfma_f32_16x16x32_bf16 v[120:123], v[244:247], v[184:187], v[120:123]
    ds_read_b64_tr_b16 v[240:241], v66 offset:20832
    v_mfma_f32_16x16x32_bf16 v[124:127], v[244:247], v[188:191], v[124:127]
    ds_read_b64_tr_b16 v[242:243], v66 offset:21344
    buffer_load_dwordx4 v[180:183], v2, s[32:35], s16 offen offset:1024 sc1
    s_waitcnt lgkmcnt(8)
    v_mfma_f32_16x16x32_bf16 v[80:83], v[248:251], v[184:187], v[80:83]
    ds_read_b64_tr_b16 v[244:245], v67 offset:20800
    v_mfma_f32_16x16x32_bf16 v[84:87], v[248:251], v[188:191], v[84:87]
    ds_read_b64_tr_b16 v[246:247], v67 offset:21312
    v_mfma_f32_16x16x32_bf16 v[88:91], v[224:227], v[184:187], v[88:91]
    ds_read_b64_tr_b16 v[248:249], v67 offset:20832
    v_mfma_f32_16x16x32_bf16 v[92:95], v[224:227], v[188:191], v[92:95]
    ds_read_b64_tr_b16 v[250:251], v67 offset:21344
    s_waitcnt lgkmcnt(8)
    v_mfma_f32_16x16x32_bf16 v[96:99], v[228:231], v[184:187], v[96:99]
    s_barrier
    ds_read_b64_tr_b16 v[224:225], v67 offset:33280
    v_mfma_f32_16x16x32_bf16 v[100:103], v[228:231], v[188:191], v[100:103]
    ds_read_b64_tr_b16 v[226:227], v67 offset:33792
    v_mfma_f32_16x16x32_bf16 v[104:107], v[232:235], v[184:187], v[104:107]
    ds_read_b64_tr_b16 v[228:229], v67 offset:33312
    v_mfma_f32_16x16x32_bf16 v[108:111], v[232:235], v[188:191], v[108:111]
    ds_read_b64_tr_b16 v[230:231], v67 offset:33824
    s_waitcnt lgkmcnt(8)
    v_mfma_f32_16x16x32_bf16 v[144:147], v[236:239], v[184:187], v[144:147]
    ds_read_b64_tr_b16 v[232:233], v66 offset:33280
    v_mfma_f32_16x16x32_bf16 v[148:151], v[236:239], v[188:191], v[148:151]
    ds_read_b64_tr_b16 v[234:235], v66 offset:33792
    v_mfma_f32_16x16x32_bf16 v[152:155], v[240:243], v[184:187], v[152:155]
    ds_read_b64_tr_b16 v[236:237], v66 offset:33312
    v_mfma_f32_16x16x32_bf16 v[156:159], v[240:243], v[188:191], v[156:159]
    ds_read_b64_tr_b16 v[238:239], v66 offset:33824
    s_waitcnt lgkmcnt(8)
    v_mfma_f32_16x16x32_bf16 v[160:163], v[244:247], v[184:187], v[160:163]
    ds_read_b64_tr_b16 v[240:241], v66 offset:24960
    v_mfma_f32_16x16x32_bf16 v[164:167], v[244:247], v[188:191], v[164:167]
    ds_read_b64_tr_b16 v[242:243], v66 offset:25472
    v_mfma_f32_16x16x32_bf16 v[168:171], v[248:251], v[184:187], v[168:171]
    ds_read_b64_tr_b16 v[244:245], v66 offset:24992
    v_mfma_f32_16x16x32_bf16 v[172:175], v[248:251], v[188:191], v[172:175]
    ds_read_b64_tr_b16 v[246:247], v66 offset:25504
    s_waitcnt lgkmcnt(8)
    s_waitcnt vmcnt(8)
    v_mfma_f32_16x16x32_bf16 v[128:131], v[224:227], v[192:195], v[128:131]
    ds_read_b64_tr_b16 v[248:249], v67 offset:24960
    v_mfma_f32_16x16x32_bf16 v[132:135], v[224:227], v[196:199], v[132:135]
    ds_read_b64_tr_b16 v[250:251], v67 offset:25472
    buffer_load_dwordx4 v[184:187], v2, s[32:35], s16 offen offset:2048 sc1
    v_mfma_f32_16x16x32_bf16 v[136:139], v[228:231], v[192:195], v[136:139]
    ds_read_b64_tr_b16 v[224:225], v67 offset:24992
    v_mfma_f32_16x16x32_bf16 v[140:143], v[228:231], v[196:199], v[140:143]
    ds_read_b64_tr_b16 v[226:227], v67 offset:25504
    s_waitcnt lgkmcnt(8)
    v_mfma_f32_16x16x32_bf16 v[112:115], v[232:235], v[192:195], v[112:115]
    ds_read_b64_tr_b16 v[228:229], v66 offset:41600
    v_mfma_f32_16x16x32_bf16 v[116:119], v[232:235], v[196:199], v[116:119]
    ds_read_b64_tr_b16 v[230:231], v66 offset:42112
    v_mfma_f32_16x16x32_bf16 v[120:123], v[236:239], v[192:195], v[120:123]
    ds_read_b64_tr_b16 v[232:233], v66 offset:41632
    v_mfma_f32_16x16x32_bf16 v[124:127], v[236:239], v[196:199], v[124:127]
    ds_read_b64_tr_b16 v[234:235], v66 offset:42144
    buffer_load_dwordx4 v[188:191], v2, s[32:35], s16 offen offset:3072 sc1
    s_waitcnt lgkmcnt(8)
    v_mfma_f32_16x16x32_bf16 v[80:83], v[240:243], v[192:195], v[80:83]
    ds_read_b64_tr_b16 v[236:237], v67 offset:41600
    v_mfma_f32_16x16x32_bf16 v[84:87], v[240:243], v[196:199], v[84:87]
    ds_read_b64_tr_b16 v[238:239], v67 offset:42112
    v_mfma_f32_16x16x32_bf16 v[88:91], v[244:247], v[192:195], v[88:91]
    ds_read_b64_tr_b16 v[240:241], v67 offset:41632
    v_mfma_f32_16x16x32_bf16 v[92:95], v[244:247], v[196:199], v[92:95]
    ds_read_b64_tr_b16 v[242:243], v67 offset:42144
    s_waitcnt lgkmcnt(8)
    v_mfma_f32_16x16x32_bf16 v[96:99], v[248:251], v[192:195], v[96:99]
    ds_read_b64_tr_b16 v[244:245], v67 offset:37440
    v_mfma_f32_16x16x32_bf16 v[100:103], v[248:251], v[196:199], v[100:103]
    ds_read_b64_tr_b16 v[246:247], v67 offset:37952
    v_mfma_f32_16x16x32_bf16 v[104:107], v[224:227], v[192:195], v[104:107]
    ds_read_b64_tr_b16 v[248:249], v67 offset:37472
    v_mfma_f32_16x16x32_bf16 v[108:111], v[224:227], v[196:199], v[108:111]
    ds_read_b64_tr_b16 v[250:251], v67 offset:37984
    s_waitcnt lgkmcnt(8)
    v_mfma_f32_16x16x32_bf16 v[144:147], v[228:231], v[192:195], v[144:147]
    ds_read_b64_tr_b16 v[224:225], v66 offset:37440
    v_mfma_f32_16x16x32_bf16 v[148:151], v[228:231], v[196:199], v[148:151]
    ds_read_b64_tr_b16 v[226:227], v66 offset:37952
    v_mfma_f32_16x16x32_bf16 v[152:155], v[232:235], v[192:195], v[152:155]
    ds_read_b64_tr_b16 v[228:229], v66 offset:37472
    v_mfma_f32_16x16x32_bf16 v[156:159], v[232:235], v[196:199], v[156:159]
    ds_read_b64_tr_b16 v[230:231], v66 offset:37984
    s_waitcnt lgkmcnt(8)
    v_mfma_f32_16x16x32_bf16 v[160:163], v[236:239], v[192:195], v[160:163]
    ds_read_b64_tr_b16 v[232:233], v66 offset:29120
    v_mfma_f32_16x16x32_bf16 v[164:167], v[236:239], v[196:199], v[164:167]
    ds_read_b64_tr_b16 v[234:235], v66 offset:29632
    v_mfma_f32_16x16x32_bf16 v[168:171], v[240:243], v[192:195], v[168:171]
    ds_read_b64_tr_b16 v[236:237], v66 offset:29152
    v_mfma_f32_16x16x32_bf16 v[172:175], v[240:243], v[196:199], v[172:175]
    ds_read_b64_tr_b16 v[238:239], v66 offset:29664
    s_waitcnt lgkmcnt(8)
    s_waitcnt vmcnt(8)
    v_mfma_f32_16x16x32_bf16 v[128:131], v[244:247], v[200:203], v[128:131]
    ds_read_b64_tr_b16 v[240:241], v67 offset:29120
    v_mfma_f32_16x16x32_bf16 v[132:135], v[244:247], v[204:207], v[132:135]
    ds_read_b64_tr_b16 v[242:243], v67 offset:29632
    s_add_u32 s96, s85, 10
    s_and_b32 s97, s96, 15
    s_lshl_b32 s98, s97, 14
    s_add_u32 s16, s98, s15
    buffer_load_dwordx4 v[192:195], v2, s[32:35], s16 offen sc1
    v_mfma_f32_16x16x32_bf16 v[136:139], v[248:251], v[200:203], v[136:139]
    ds_read_b64_tr_b16 v[244:245], v67 offset:29152
    v_mfma_f32_16x16x32_bf16 v[140:143], v[248:251], v[204:207], v[140:143]
    ds_read_b64_tr_b16 v[246:247], v67 offset:29664
    s_waitcnt lgkmcnt(8)
    v_mfma_f32_16x16x32_bf16 v[112:115], v[224:227], v[200:203], v[112:115]
    ds_read_b64_tr_b16 v[248:249], v66 offset:45760
    v_mfma_f32_16x16x32_bf16 v[116:119], v[224:227], v[204:207], v[116:119]
    ds_read_b64_tr_b16 v[250:251], v66 offset:46272
    v_mfma_f32_16x16x32_bf16 v[120:123], v[228:231], v[200:203], v[120:123]
    ds_read_b64_tr_b16 v[224:225], v66 offset:45792
    v_mfma_f32_16x16x32_bf16 v[124:127], v[228:231], v[204:207], v[124:127]
    ds_read_b64_tr_b16 v[226:227], v66 offset:46304
    buffer_load_dwordx4 v[196:199], v2, s[32:35], s16 offen offset:1024 sc1
    s_waitcnt lgkmcnt(8)
    v_mfma_f32_16x16x32_bf16 v[80:83], v[232:235], v[200:203], v[80:83]
    ds_read_b64_tr_b16 v[228:229], v67 offset:45760
    v_mfma_f32_16x16x32_bf16 v[84:87], v[232:235], v[204:207], v[84:87]
    ds_read_b64_tr_b16 v[230:231], v67 offset:46272
    v_mfma_f32_16x16x32_bf16 v[88:91], v[236:239], v[200:203], v[88:91]
    ds_read_b64_tr_b16 v[232:233], v67 offset:45792
    v_mfma_f32_16x16x32_bf16 v[92:95], v[236:239], v[204:207], v[92:95]
    ds_read_b64_tr_b16 v[234:235], v67 offset:46304
    s_waitcnt lgkmcnt(8)
    v_mfma_f32_16x16x32_bf16 v[96:99], v[240:243], v[200:203], v[96:99]
    s_barrier
    ds_read_b64_tr_b16 v[236:237], v69 offset:8320
    v_mfma_f32_16x16x32_bf16 v[100:103], v[240:243], v[204:207], v[100:103]
    ds_read_b64_tr_b16 v[238:239], v69 offset:8832
    v_mfma_f32_16x16x32_bf16 v[104:107], v[244:247], v[200:203], v[104:107]
    ds_read_b64_tr_b16 v[240:241], v69 offset:8352
    v_mfma_f32_16x16x32_bf16 v[108:111], v[244:247], v[204:207], v[108:111]
    ds_read_b64_tr_b16 v[242:243], v69 offset:8864
    s_waitcnt lgkmcnt(8)
    v_mfma_f32_16x16x32_bf16 v[144:147], v[248:251], v[200:203], v[144:147]
    ds_read_b64_tr_b16 v[244:245], v68 offset:8320
    v_mfma_f32_16x16x32_bf16 v[148:151], v[248:251], v[204:207], v[148:151]
    ds_read_b64_tr_b16 v[246:247], v68 offset:8832
    v_mfma_f32_16x16x32_bf16 v[152:155], v[224:227], v[200:203], v[152:155]
    ds_read_b64_tr_b16 v[248:249], v68 offset:8352
    v_mfma_f32_16x16x32_bf16 v[156:159], v[224:227], v[204:207], v[156:159]
    ds_read_b64_tr_b16 v[250:251], v68 offset:8864
    s_waitcnt lgkmcnt(8)
    v_mfma_f32_16x16x32_bf16 v[160:163], v[228:231], v[200:203], v[160:163]
    ds_read_b64_tr_b16 v[224:225], v68
    v_mfma_f32_16x16x32_bf16 v[164:167], v[228:231], v[204:207], v[164:167]
    ds_read_b64_tr_b16 v[226:227], v68 offset:512
    v_mfma_f32_16x16x32_bf16 v[168:171], v[232:235], v[200:203], v[168:171]
    ds_read_b64_tr_b16 v[228:229], v68 offset:32
    v_mfma_f32_16x16x32_bf16 v[172:175], v[232:235], v[204:207], v[172:175]
    ds_read_b64_tr_b16 v[230:231], v68 offset:544
    s_waitcnt lgkmcnt(8)
    s_waitcnt vmcnt(8)
    v_mfma_f32_16x16x32_bf16 v[128:131], v[236:239], v[208:211], v[128:131]
    ds_read_b64_tr_b16 v[232:233], v69
    v_mfma_f32_16x16x32_bf16 v[132:135], v[236:239], v[212:215], v[132:135]
    ds_read_b64_tr_b16 v[234:235], v69 offset:512
    buffer_load_dwordx4 v[200:203], v2, s[32:35], s16 offen offset:2048 sc1
    v_mfma_f32_16x16x32_bf16 v[136:139], v[240:243], v[208:211], v[136:139]
    ds_read_b64_tr_b16 v[236:237], v69 offset:32
    v_mfma_f32_16x16x32_bf16 v[140:143], v[240:243], v[212:215], v[140:143]
    ds_read_b64_tr_b16 v[238:239], v69 offset:544
    s_waitcnt lgkmcnt(8)
    v_mfma_f32_16x16x32_bf16 v[112:115], v[244:247], v[208:211], v[112:115]
    ds_read_b64_tr_b16 v[240:241], v68 offset:16640
    v_mfma_f32_16x16x32_bf16 v[116:119], v[244:247], v[212:215], v[116:119]
    ds_read_b64_tr_b16 v[242:243], v68 offset:17152
    v_mfma_f32_16x16x32_bf16 v[120:123], v[248:251], v[208:211], v[120:123]
    ds_read_b64_tr_b16 v[244:245], v68 offset:16672
    v_mfma_f32_16x16x32_bf16 v[124:127], v[248:251], v[212:215], v[124:127]
    ds_read_b64_tr_b16 v[246:247], v68 offset:17184
    buffer_load_dwordx4 v[204:207], v2, s[32:35], s16 offen offset:3072 sc1
    s_waitcnt lgkmcnt(8)
    v_mfma_f32_16x16x32_bf16 v[80:83], v[224:227], v[208:211], v[80:83]
    ds_read_b64_tr_b16 v[248:249], v69 offset:16640
    v_mfma_f32_16x16x32_bf16 v[84:87], v[224:227], v[212:215], v[84:87]
    ds_read_b64_tr_b16 v[250:251], v69 offset:17152
    v_mfma_f32_16x16x32_bf16 v[88:91], v[228:231], v[208:211], v[88:91]
    ds_read_b64_tr_b16 v[224:225], v69 offset:16672
    v_mfma_f32_16x16x32_bf16 v[92:95], v[228:231], v[212:215], v[92:95]
    ds_read_b64_tr_b16 v[226:227], v69 offset:17184
    s_waitcnt lgkmcnt(8)
    v_mfma_f32_16x16x32_bf16 v[96:99], v[232:235], v[208:211], v[96:99]
    ds_read_b64_tr_b16 v[228:229], v69 offset:12480
    v_mfma_f32_16x16x32_bf16 v[100:103], v[232:235], v[212:215], v[100:103]
    ds_read_b64_tr_b16 v[230:231], v69 offset:12992
    v_mfma_f32_16x16x32_bf16 v[104:107], v[236:239], v[208:211], v[104:107]
    ds_read_b64_tr_b16 v[232:233], v69 offset:12512
    v_mfma_f32_16x16x32_bf16 v[108:111], v[236:239], v[212:215], v[108:111]
    ds_read_b64_tr_b16 v[234:235], v69 offset:13024
    s_waitcnt lgkmcnt(8)
    v_mfma_f32_16x16x32_bf16 v[144:147], v[240:243], v[208:211], v[144:147]
    ds_read_b64_tr_b16 v[236:237], v68 offset:12480
    v_mfma_f32_16x16x32_bf16 v[148:151], v[240:243], v[212:215], v[148:151]
    ds_read_b64_tr_b16 v[238:239], v68 offset:12992
    v_mfma_f32_16x16x32_bf16 v[152:155], v[244:247], v[208:211], v[152:155]
    ds_read_b64_tr_b16 v[240:241], v68 offset:12512
    v_mfma_f32_16x16x32_bf16 v[156:159], v[244:247], v[212:215], v[156:159]
    ds_read_b64_tr_b16 v[242:243], v68 offset:13024
    s_waitcnt lgkmcnt(8)
    v_mfma_f32_16x16x32_bf16 v[160:163], v[248:251], v[208:211], v[160:163]
    ds_read_b64_tr_b16 v[244:245], v68 offset:4160
    v_mfma_f32_16x16x32_bf16 v[164:167], v[248:251], v[212:215], v[164:167]
    ds_read_b64_tr_b16 v[246:247], v68 offset:4672
    v_mfma_f32_16x16x32_bf16 v[168:171], v[224:227], v[208:211], v[168:171]
    ds_read_b64_tr_b16 v[248:249], v68 offset:4192
    v_mfma_f32_16x16x32_bf16 v[172:175], v[224:227], v[212:215], v[172:175]
    ds_read_b64_tr_b16 v[250:251], v68 offset:4704
    s_waitcnt lgkmcnt(8)
    s_waitcnt vmcnt(8)
    v_mfma_f32_16x16x32_bf16 v[128:131], v[228:231], v[216:219], v[128:131]
    ds_read_b64_tr_b16 v[224:225], v69 offset:4160
    v_mfma_f32_16x16x32_bf16 v[132:135], v[228:231], v[220:223], v[132:135]
    ds_read_b64_tr_b16 v[226:227], v69 offset:4672
    s_add_u32 s96, s85, 11
    s_and_b32 s97, s96, 15
    s_lshl_b32 s98, s97, 14
    s_add_u32 s16, s98, s15
    buffer_load_dwordx4 v[208:211], v2, s[32:35], s16 offen sc1
    v_mfma_f32_16x16x32_bf16 v[136:139], v[232:235], v[216:219], v[136:139]
    ds_read_b64_tr_b16 v[228:229], v69 offset:4192
    v_mfma_f32_16x16x32_bf16 v[140:143], v[232:235], v[220:223], v[140:143]
    ds_read_b64_tr_b16 v[230:231], v69 offset:4704
    s_waitcnt lgkmcnt(8)
    v_mfma_f32_16x16x32_bf16 v[112:115], v[236:239], v[216:219], v[112:115]
    ds_read_b64_tr_b16 v[232:233], v68 offset:20800
    v_mfma_f32_16x16x32_bf16 v[116:119], v[236:239], v[220:223], v[116:119]
    ds_read_b64_tr_b16 v[234:235], v68 offset:21312
    v_mfma_f32_16x16x32_bf16 v[120:123], v[240:243], v[216:219], v[120:123]
    ds_read_b64_tr_b16 v[236:237], v68 offset:20832
    v_mfma_f32_16x16x32_bf16 v[124:127], v[240:243], v[220:223], v[124:127]
    ds_read_b64_tr_b16 v[238:239], v68 offset:21344
    buffer_load_dwordx4 v[212:215], v2, s[32:35], s16 offen offset:1024 sc1
    s_waitcnt lgkmcnt(8)
    v_mfma_f32_16x16x32_bf16 v[80:83], v[244:247], v[216:219], v[80:83]
    ds_read_b64_tr_b16 v[240:241], v69 offset:20800
    v_mfma_f32_16x16x32_bf16 v[84:87], v[244:247], v[220:223], v[84:87]
    ds_read_b64_tr_b16 v[242:243], v69 offset:21312
    v_mfma_f32_16x16x32_bf16 v[88:91], v[248:251], v[216:219], v[88:91]
    ds_read_b64_tr_b16 v[244:245], v69 offset:20832
    v_mfma_f32_16x16x32_bf16 v[92:95], v[248:251], v[220:223], v[92:95]
    ds_read_b64_tr_b16 v[246:247], v69 offset:21344
    s_waitcnt lgkmcnt(8)
    v_mfma_f32_16x16x32_bf16 v[96:99], v[224:227], v[216:219], v[96:99]
    s_barrier
    ds_read_b64_tr_b16 v[248:249], v69 offset:33280
    v_mfma_f32_16x16x32_bf16 v[100:103], v[224:227], v[220:223], v[100:103]
    ds_read_b64_tr_b16 v[250:251], v69 offset:33792
    v_mfma_f32_16x16x32_bf16 v[104:107], v[228:231], v[216:219], v[104:107]
    ds_read_b64_tr_b16 v[224:225], v69 offset:33312
    v_mfma_f32_16x16x32_bf16 v[108:111], v[228:231], v[220:223], v[108:111]
    ds_read_b64_tr_b16 v[226:227], v69 offset:33824
    s_waitcnt lgkmcnt(8)
    v_mfma_f32_16x16x32_bf16 v[144:147], v[232:235], v[216:219], v[144:147]
    ds_read_b64_tr_b16 v[228:229], v68 offset:33280
    v_mfma_f32_16x16x32_bf16 v[148:151], v[232:235], v[220:223], v[148:151]
    ds_read_b64_tr_b16 v[230:231], v68 offset:33792
    v_mfma_f32_16x16x32_bf16 v[152:155], v[236:239], v[216:219], v[152:155]
    ds_read_b64_tr_b16 v[232:233], v68 offset:33312
    v_mfma_f32_16x16x32_bf16 v[156:159], v[236:239], v[220:223], v[156:159]
    ds_read_b64_tr_b16 v[234:235], v68 offset:33824
    s_waitcnt lgkmcnt(8)
    v_mfma_f32_16x16x32_bf16 v[160:163], v[240:243], v[216:219], v[160:163]
    ds_read_b64_tr_b16 v[236:237], v68 offset:24960
    v_mfma_f32_16x16x32_bf16 v[164:167], v[240:243], v[220:223], v[164:167]
    ds_read_b64_tr_b16 v[238:239], v68 offset:25472
    v_mfma_f32_16x16x32_bf16 v[168:171], v[244:247], v[216:219], v[168:171]
    ds_read_b64_tr_b16 v[240:241], v68 offset:24992
    v_mfma_f32_16x16x32_bf16 v[172:175], v[244:247], v[220:223], v[172:175]
    ds_read_b64_tr_b16 v[242:243], v68 offset:25504
    s_waitcnt lgkmcnt(8)
    s_waitcnt vmcnt(8)
    v_mfma_f32_16x16x32_bf16 v[128:131], v[248:251], v[176:179], v[128:131]
    ds_read_b64_tr_b16 v[244:245], v69 offset:24960
    v_mfma_f32_16x16x32_bf16 v[132:135], v[248:251], v[180:183], v[132:135]
    ds_read_b64_tr_b16 v[246:247], v69 offset:25472
    buffer_load_dwordx4 v[216:219], v2, s[32:35], s16 offen offset:2048 sc1
    v_mfma_f32_16x16x32_bf16 v[136:139], v[224:227], v[176:179], v[136:139]
    ds_read_b64_tr_b16 v[248:249], v69 offset:24992
    v_mfma_f32_16x16x32_bf16 v[140:143], v[224:227], v[180:183], v[140:143]
    ds_read_b64_tr_b16 v[250:251], v69 offset:25504
    s_waitcnt lgkmcnt(8)
    v_mfma_f32_16x16x32_bf16 v[112:115], v[228:231], v[176:179], v[112:115]
    ds_read_b64_tr_b16 v[224:225], v68 offset:41600
    v_mfma_f32_16x16x32_bf16 v[116:119], v[228:231], v[180:183], v[116:119]
    ds_read_b64_tr_b16 v[226:227], v68 offset:42112
    v_mfma_f32_16x16x32_bf16 v[120:123], v[232:235], v[176:179], v[120:123]
    ds_read_b64_tr_b16 v[228:229], v68 offset:41632
    v_mfma_f32_16x16x32_bf16 v[124:127], v[232:235], v[180:183], v[124:127]
    ds_read_b64_tr_b16 v[230:231], v68 offset:42144
    buffer_load_dwordx4 v[220:223], v2, s[32:35], s16 offen offset:3072 sc1
    s_waitcnt lgkmcnt(8)
    v_mfma_f32_16x16x32_bf16 v[80:83], v[236:239], v[176:179], v[80:83]
    ds_read_b64_tr_b16 v[232:233], v69 offset:41600
    v_mfma_f32_16x16x32_bf16 v[84:87], v[236:239], v[180:183], v[84:87]
    ds_read_b64_tr_b16 v[234:235], v69 offset:42112
    v_mfma_f32_16x16x32_bf16 v[88:91], v[240:243], v[176:179], v[88:91]
    ds_read_b64_tr_b16 v[236:237], v69 offset:41632
    v_mfma_f32_16x16x32_bf16 v[92:95], v[240:243], v[180:183], v[92:95]
    ds_read_b64_tr_b16 v[238:239], v69 offset:42144
    s_waitcnt lgkmcnt(8)
    v_mfma_f32_16x16x32_bf16 v[96:99], v[244:247], v[176:179], v[96:99]
    ds_read_b64_tr_b16 v[240:241], v69 offset:37440
    v_mfma_f32_16x16x32_bf16 v[100:103], v[244:247], v[180:183], v[100:103]
    ds_read_b64_tr_b16 v[242:243], v69 offset:37952
    v_mfma_f32_16x16x32_bf16 v[104:107], v[248:251], v[176:179], v[104:107]
    ds_read_b64_tr_b16 v[244:245], v69 offset:37472
    v_mfma_f32_16x16x32_bf16 v[108:111], v[248:251], v[180:183], v[108:111]
    ds_read_b64_tr_b16 v[246:247], v69 offset:37984
    s_waitcnt lgkmcnt(8)
    v_mfma_f32_16x16x32_bf16 v[144:147], v[224:227], v[176:179], v[144:147]
    ds_read_b64_tr_b16 v[248:249], v68 offset:37440
    v_mfma_f32_16x16x32_bf16 v[148:151], v[224:227], v[180:183], v[148:151]
    ds_read_b64_tr_b16 v[250:251], v68 offset:37952
    v_mfma_f32_16x16x32_bf16 v[152:155], v[228:231], v[176:179], v[152:155]
    ds_read_b64_tr_b16 v[224:225], v68 offset:37472
    v_mfma_f32_16x16x32_bf16 v[156:159], v[228:231], v[180:183], v[156:159]
    ds_read_b64_tr_b16 v[226:227], v68 offset:37984
    s_waitcnt lgkmcnt(8)
    v_mfma_f32_16x16x32_bf16 v[160:163], v[232:235], v[176:179], v[160:163]
    ds_read_b64_tr_b16 v[228:229], v68 offset:29120
    v_mfma_f32_16x16x32_bf16 v[164:167], v[232:235], v[180:183], v[164:167]
    ds_read_b64_tr_b16 v[230:231], v68 offset:29632
    v_mfma_f32_16x16x32_bf16 v[168:171], v[236:239], v[176:179], v[168:171]
    ds_read_b64_tr_b16 v[232:233], v68 offset:29152
    v_mfma_f32_16x16x32_bf16 v[172:175], v[236:239], v[180:183], v[172:175]
    ds_read_b64_tr_b16 v[234:235], v68 offset:29664
    s_waitcnt lgkmcnt(8)
    s_waitcnt vmcnt(8)
    v_mfma_f32_16x16x32_bf16 v[128:131], v[240:243], v[184:187], v[128:131]
    ds_read_b64_tr_b16 v[236:237], v69 offset:29120
    v_mfma_f32_16x16x32_bf16 v[132:135], v[240:243], v[188:191], v[132:135]
    ds_read_b64_tr_b16 v[238:239], v69 offset:29632
    s_add_u32 s96, s85, 12
    s_and_b32 s97, s96, 15
    s_lshl_b32 s98, s97, 14
    s_add_u32 s16, s98, s15
    buffer_load_dwordx4 v[176:179], v2, s[32:35], s16 offen sc1
    v_mfma_f32_16x16x32_bf16 v[136:139], v[244:247], v[184:187], v[136:139]
    ds_read_b64_tr_b16 v[240:241], v69 offset:29152
    v_mfma_f32_16x16x32_bf16 v[140:143], v[244:247], v[188:191], v[140:143]
    ds_read_b64_tr_b16 v[242:243], v69 offset:29664
    s_waitcnt lgkmcnt(8)
    v_mfma_f32_16x16x32_bf16 v[112:115], v[248:251], v[184:187], v[112:115]
    ds_read_b64_tr_b16 v[244:245], v68 offset:45760
    v_mfma_f32_16x16x32_bf16 v[116:119], v[248:251], v[188:191], v[116:119]
    ds_read_b64_tr_b16 v[246:247], v68 offset:46272
    v_mfma_f32_16x16x32_bf16 v[120:123], v[224:227], v[184:187], v[120:123]
    ds_read_b64_tr_b16 v[248:249], v68 offset:45792
    v_mfma_f32_16x16x32_bf16 v[124:127], v[224:227], v[188:191], v[124:127]
    ds_read_b64_tr_b16 v[250:251], v68 offset:46304
    buffer_load_dwordx4 v[180:183], v2, s[32:35], s16 offen offset:1024 sc1
    s_waitcnt lgkmcnt(8)
    v_mfma_f32_16x16x32_bf16 v[80:83], v[228:231], v[184:187], v[80:83]
    ds_read_b64_tr_b16 v[224:225], v69 offset:45760
    v_mfma_f32_16x16x32_bf16 v[84:87], v[228:231], v[188:191], v[84:87]
    ds_read_b64_tr_b16 v[226:227], v69 offset:46272
    v_mfma_f32_16x16x32_bf16 v[88:91], v[232:235], v[184:187], v[88:91]
    ds_read_b64_tr_b16 v[228:229], v69 offset:45792
    v_mfma_f32_16x16x32_bf16 v[92:95], v[232:235], v[188:191], v[92:95]
    ds_read_b64_tr_b16 v[230:231], v69 offset:46304
    s_waitcnt lgkmcnt(8)
    v_mfma_f32_16x16x32_bf16 v[96:99], v[236:239], v[184:187], v[96:99]
    s_barrier
    ds_read_b64_tr_b16 v[232:233], v71 offset:8320
    v_mfma_f32_16x16x32_bf16 v[100:103], v[236:239], v[188:191], v[100:103]
    ds_read_b64_tr_b16 v[234:235], v71 offset:8832
    v_mfma_f32_16x16x32_bf16 v[104:107], v[240:243], v[184:187], v[104:107]
    ds_read_b64_tr_b16 v[236:237], v71 offset:8352
    v_mfma_f32_16x16x32_bf16 v[108:111], v[240:243], v[188:191], v[108:111]
    ds_read_b64_tr_b16 v[238:239], v71 offset:8864
    s_waitcnt lgkmcnt(8)
    v_mfma_f32_16x16x32_bf16 v[144:147], v[244:247], v[184:187], v[144:147]
    ds_read_b64_tr_b16 v[240:241], v70 offset:8320
    v_mfma_f32_16x16x32_bf16 v[148:151], v[244:247], v[188:191], v[148:151]
    ds_read_b64_tr_b16 v[242:243], v70 offset:8832
    v_mfma_f32_16x16x32_bf16 v[152:155], v[248:251], v[184:187], v[152:155]
    ds_read_b64_tr_b16 v[244:245], v70 offset:8352
    v_mfma_f32_16x16x32_bf16 v[156:159], v[248:251], v[188:191], v[156:159]
    ds_read_b64_tr_b16 v[246:247], v70 offset:8864
    s_waitcnt lgkmcnt(8)
    v_mfma_f32_16x16x32_bf16 v[160:163], v[224:227], v[184:187], v[160:163]
    ds_read_b64_tr_b16 v[248:249], v70
    v_mfma_f32_16x16x32_bf16 v[164:167], v[224:227], v[188:191], v[164:167]
    ds_read_b64_tr_b16 v[250:251], v70 offset:512
    v_mfma_f32_16x16x32_bf16 v[168:171], v[228:231], v[184:187], v[168:171]
    ds_read_b64_tr_b16 v[224:225], v70 offset:32
    v_mfma_f32_16x16x32_bf16 v[172:175], v[228:231], v[188:191], v[172:175]
    ds_read_b64_tr_b16 v[226:227], v70 offset:544
    s_waitcnt lgkmcnt(8)
    s_waitcnt vmcnt(8)
    v_mfma_f32_16x16x32_bf16 v[128:131], v[232:235], v[192:195], v[128:131]
    ds_read_b64_tr_b16 v[228:229], v71
    v_mfma_f32_16x16x32_bf16 v[132:135], v[232:235], v[196:199], v[132:135]
    ds_read_b64_tr_b16 v[230:231], v71 offset:512
    buffer_load_dwordx4 v[184:187], v2, s[32:35], s16 offen offset:2048 sc1
    v_mfma_f32_16x16x32_bf16 v[136:139], v[236:239], v[192:195], v[136:139]
    ds_read_b64_tr_b16 v[232:233], v71 offset:32
    v_mfma_f32_16x16x32_bf16 v[140:143], v[236:239], v[196:199], v[140:143]
    ds_read_b64_tr_b16 v[234:235], v71 offset:544
    s_waitcnt lgkmcnt(8)
    v_mfma_f32_16x16x32_bf16 v[112:115], v[240:243], v[192:195], v[112:115]
    ds_read_b64_tr_b16 v[236:237], v70 offset:16640
    v_mfma_f32_16x16x32_bf16 v[116:119], v[240:243], v[196:199], v[116:119]
    ds_read_b64_tr_b16 v[238:239], v70 offset:17152
    v_mfma_f32_16x16x32_bf16 v[120:123], v[244:247], v[192:195], v[120:123]
    ds_read_b64_tr_b16 v[240:241], v70 offset:16672
    v_mfma_f32_16x16x32_bf16 v[124:127], v[244:247], v[196:199], v[124:127]
    ds_read_b64_tr_b16 v[242:243], v70 offset:17184
    buffer_load_dwordx4 v[188:191], v2, s[32:35], s16 offen offset:3072 sc1
    s_waitcnt lgkmcnt(8)
    v_mfma_f32_16x16x32_bf16 v[80:83], v[248:251], v[192:195], v[80:83]
    ds_read_b64_tr_b16 v[244:245], v71 offset:16640
    v_mfma_f32_16x16x32_bf16 v[84:87], v[248:251], v[196:199], v[84:87]
    ds_read_b64_tr_b16 v[246:247], v71 offset:17152
    v_mfma_f32_16x16x32_bf16 v[88:91], v[224:227], v[192:195], v[88:91]
    ds_read_b64_tr_b16 v[248:249], v71 offset:16672
    v_mfma_f32_16x16x32_bf16 v[92:95], v[224:227], v[196:199], v[92:95]
    ds_read_b64_tr_b16 v[250:251], v71 offset:17184
    s_waitcnt lgkmcnt(8)
    v_mfma_f32_16x16x32_bf16 v[96:99], v[228:231], v[192:195], v[96:99]
    ds_read_b64_tr_b16 v[224:225], v71 offset:12480
    v_mfma_f32_16x16x32_bf16 v[100:103], v[228:231], v[196:199], v[100:103]
    ds_read_b64_tr_b16 v[226:227], v71 offset:12992
    v_mfma_f32_16x16x32_bf16 v[104:107], v[232:235], v[192:195], v[104:107]
    ds_read_b64_tr_b16 v[228:229], v71 offset:12512
    v_mfma_f32_16x16x32_bf16 v[108:111], v[232:235], v[196:199], v[108:111]
    ds_read_b64_tr_b16 v[230:231], v71 offset:13024
    s_waitcnt lgkmcnt(8)
    v_mfma_f32_16x16x32_bf16 v[144:147], v[236:239], v[192:195], v[144:147]
    ds_read_b64_tr_b16 v[232:233], v70 offset:12480
    v_mfma_f32_16x16x32_bf16 v[148:151], v[236:239], v[196:199], v[148:151]
    ds_read_b64_tr_b16 v[234:235], v70 offset:12992
    v_mfma_f32_16x16x32_bf16 v[152:155], v[240:243], v[192:195], v[152:155]
    ds_read_b64_tr_b16 v[236:237], v70 offset:12512
    v_mfma_f32_16x16x32_bf16 v[156:159], v[240:243], v[196:199], v[156:159]
    ds_read_b64_tr_b16 v[238:239], v70 offset:13024
    s_waitcnt lgkmcnt(8)
    v_mfma_f32_16x16x32_bf16 v[160:163], v[244:247], v[192:195], v[160:163]
    ds_read_b64_tr_b16 v[240:241], v70 offset:4160
    v_mfma_f32_16x16x32_bf16 v[164:167], v[244:247], v[196:199], v[164:167]
    ds_read_b64_tr_b16 v[242:243], v70 offset:4672
    v_mfma_f32_16x16x32_bf16 v[168:171], v[248:251], v[192:195], v[168:171]
    ds_read_b64_tr_b16 v[244:245], v70 offset:4192
    v_mfma_f32_16x16x32_bf16 v[172:175], v[248:251], v[196:199], v[172:175]
    ds_read_b64_tr_b16 v[246:247], v70 offset:4704
    s_waitcnt lgkmcnt(8)
    s_waitcnt vmcnt(8)
    v_mfma_f32_16x16x32_bf16 v[128:131], v[224:227], v[200:203], v[128:131]
    ds_read_b64_tr_b16 v[248:249], v71 offset:4160
    v_mfma_f32_16x16x32_bf16 v[132:135], v[224:227], v[204:207], v[132:135]
    ds_read_b64_tr_b16 v[250:251], v71 offset:4672
    s_add_u32 s96, s85, 13
    s_and_b32 s97, s96, 15
    s_lshl_b32 s98, s97, 14
    s_add_u32 s16, s98, s15
    buffer_load_dwordx4 v[192:195], v2, s[32:35], s16 offen sc1
    v_mfma_f32_16x16x32_bf16 v[136:139], v[228:231], v[200:203], v[136:139]
    ds_read_b64_tr_b16 v[224:225], v71 offset:4192
    v_mfma_f32_16x16x32_bf16 v[140:143], v[228:231], v[204:207], v[140:143]
    ds_read_b64_tr_b16 v[226:227], v71 offset:4704
    s_waitcnt lgkmcnt(8)
    v_mfma_f32_16x16x32_bf16 v[112:115], v[232:235], v[200:203], v[112:115]
    ds_read_b64_tr_b16 v[228:229], v70 offset:20800
    v_mfma_f32_16x16x32_bf16 v[116:119], v[232:235], v[204:207], v[116:119]
    ds_read_b64_tr_b16 v[230:231], v70 offset:21312
    v_mfma_f32_16x16x32_bf16 v[120:123], v[236:239], v[200:203], v[120:123]
    ds_read_b64_tr_b16 v[232:233], v70 offset:20832
    v_mfma_f32_16x16x32_bf16 v[124:127], v[236:239], v[204:207], v[124:127]
    ds_read_b64_tr_b16 v[234:235], v70 offset:21344
    buffer_load_dwordx4 v[196:199], v2, s[32:35], s16 offen offset:1024 sc1
    s_waitcnt lgkmcnt(8)
    v_mfma_f32_16x16x32_bf16 v[80:83], v[240:243], v[200:203], v[80:83]
    ds_read_b64_tr_b16 v[236:237], v71 offset:20800
    v_mfma_f32_16x16x32_bf16 v[84:87], v[240:243], v[204:207], v[84:87]
    ds_read_b64_tr_b16 v[238:239], v71 offset:21312
    v_mfma_f32_16x16x32_bf16 v[88:91], v[244:247], v[200:203], v[88:91]
    ds_read_b64_tr_b16 v[240:241], v71 offset:20832
    v_mfma_f32_16x16x32_bf16 v[92:95], v[244:247], v[204:207], v[92:95]
    ds_read_b64_tr_b16 v[242:243], v71 offset:21344
    s_waitcnt lgkmcnt(8)
    v_mfma_f32_16x16x32_bf16 v[96:99], v[248:251], v[200:203], v[96:99]
    s_barrier
    ds_read_b64_tr_b16 v[244:245], v71 offset:33280
    v_mfma_f32_16x16x32_bf16 v[100:103], v[248:251], v[204:207], v[100:103]
    ds_read_b64_tr_b16 v[246:247], v71 offset:33792
    v_mfma_f32_16x16x32_bf16 v[104:107], v[224:227], v[200:203], v[104:107]
    ds_read_b64_tr_b16 v[248:249], v71 offset:33312
    v_mfma_f32_16x16x32_bf16 v[108:111], v[224:227], v[204:207], v[108:111]
    ds_read_b64_tr_b16 v[250:251], v71 offset:33824
    s_waitcnt lgkmcnt(8)
    v_mfma_f32_16x16x32_bf16 v[144:147], v[228:231], v[200:203], v[144:147]
    ds_read_b64_tr_b16 v[224:225], v70 offset:33280
    v_mfma_f32_16x16x32_bf16 v[148:151], v[228:231], v[204:207], v[148:151]
    ds_read_b64_tr_b16 v[226:227], v70 offset:33792
    v_mfma_f32_16x16x32_bf16 v[152:155], v[232:235], v[200:203], v[152:155]
    ds_read_b64_tr_b16 v[228:229], v70 offset:33312
    v_mfma_f32_16x16x32_bf16 v[156:159], v[232:235], v[204:207], v[156:159]
    ds_read_b64_tr_b16 v[230:231], v70 offset:33824
    s_waitcnt lgkmcnt(8)
    v_mfma_f32_16x16x32_bf16 v[160:163], v[236:239], v[200:203], v[160:163]
    ds_read_b64_tr_b16 v[232:233], v70 offset:24960
    v_mfma_f32_16x16x32_bf16 v[164:167], v[236:239], v[204:207], v[164:167]
    ds_read_b64_tr_b16 v[234:235], v70 offset:25472
    v_mfma_f32_16x16x32_bf16 v[168:171], v[240:243], v[200:203], v[168:171]
    ds_read_b64_tr_b16 v[236:237], v70 offset:24992
    v_mfma_f32_16x16x32_bf16 v[172:175], v[240:243], v[204:207], v[172:175]
    ds_read_b64_tr_b16 v[238:239], v70 offset:25504
    s_waitcnt lgkmcnt(8)
    s_waitcnt vmcnt(8)
    v_mfma_f32_16x16x32_bf16 v[128:131], v[244:247], v[208:211], v[128:131]
    ds_read_b64_tr_b16 v[240:241], v71 offset:24960
    v_mfma_f32_16x16x32_bf16 v[132:135], v[244:247], v[212:215], v[132:135]
    ds_read_b64_tr_b16 v[242:243], v71 offset:25472
    buffer_load_dwordx4 v[200:203], v2, s[32:35], s16 offen offset:2048 sc1
    v_mfma_f32_16x16x32_bf16 v[136:139], v[248:251], v[208:211], v[136:139]
    ds_read_b64_tr_b16 v[244:245], v71 offset:24992
    v_mfma_f32_16x16x32_bf16 v[140:143], v[248:251], v[212:215], v[140:143]
    ds_read_b64_tr_b16 v[246:247], v71 offset:25504
    s_waitcnt lgkmcnt(8)
    v_mfma_f32_16x16x32_bf16 v[112:115], v[224:227], v[208:211], v[112:115]
    ds_read_b64_tr_b16 v[248:249], v70 offset:41600
    v_mfma_f32_16x16x32_bf16 v[116:119], v[224:227], v[212:215], v[116:119]
    ds_read_b64_tr_b16 v[250:251], v70 offset:42112
    v_mfma_f32_16x16x32_bf16 v[120:123], v[228:231], v[208:211], v[120:123]
    ds_read_b64_tr_b16 v[224:225], v70 offset:41632
    v_mfma_f32_16x16x32_bf16 v[124:127], v[228:231], v[212:215], v[124:127]
    ds_read_b64_tr_b16 v[226:227], v70 offset:42144
    buffer_load_dwordx4 v[204:207], v2, s[32:35], s16 offen offset:3072 sc1
    s_waitcnt lgkmcnt(8)
    v_mfma_f32_16x16x32_bf16 v[80:83], v[232:235], v[208:211], v[80:83]
    ds_read_b64_tr_b16 v[228:229], v71 offset:41600
    v_mfma_f32_16x16x32_bf16 v[84:87], v[232:235], v[212:215], v[84:87]
    ds_read_b64_tr_b16 v[230:231], v71 offset:42112
    v_mfma_f32_16x16x32_bf16 v[88:91], v[236:239], v[208:211], v[88:91]
    ds_read_b64_tr_b16 v[232:233], v71 offset:41632
    v_mfma_f32_16x16x32_bf16 v[92:95], v[236:239], v[212:215], v[92:95]
    ds_read_b64_tr_b16 v[234:235], v71 offset:42144
    s_waitcnt lgkmcnt(8)
    v_mfma_f32_16x16x32_bf16 v[96:99], v[240:243], v[208:211], v[96:99]
    ds_read_b64_tr_b16 v[236:237], v71 offset:37440
    v_mfma_f32_16x16x32_bf16 v[100:103], v[240:243], v[212:215], v[100:103]
    ds_read_b64_tr_b16 v[238:239], v71 offset:37952
    v_mfma_f32_16x16x32_bf16 v[104:107], v[244:247], v[208:211], v[104:107]
    ds_read_b64_tr_b16 v[240:241], v71 offset:37472
    v_mfma_f32_16x16x32_bf16 v[108:111], v[244:247], v[212:215], v[108:111]
    ds_read_b64_tr_b16 v[242:243], v71 offset:37984
    s_waitcnt lgkmcnt(8)
    v_mfma_f32_16x16x32_bf16 v[144:147], v[248:251], v[208:211], v[144:147]
    ds_read_b64_tr_b16 v[244:245], v70 offset:37440
    v_mfma_f32_16x16x32_bf16 v[148:151], v[248:251], v[212:215], v[148:151]
    ds_read_b64_tr_b16 v[246:247], v70 offset:37952
    v_mfma_f32_16x16x32_bf16 v[152:155], v[224:227], v[208:211], v[152:155]
    ds_read_b64_tr_b16 v[248:249], v70 offset:37472
    v_mfma_f32_16x16x32_bf16 v[156:159], v[224:227], v[212:215], v[156:159]
    ds_read_b64_tr_b16 v[250:251], v70 offset:37984
    s_waitcnt lgkmcnt(8)
    v_mfma_f32_16x16x32_bf16 v[160:163], v[228:231], v[208:211], v[160:163]
    ds_read_b64_tr_b16 v[224:225], v70 offset:29120
    v_mfma_f32_16x16x32_bf16 v[164:167], v[228:231], v[212:215], v[164:167]
    ds_read_b64_tr_b16 v[226:227], v70 offset:29632
    v_mfma_f32_16x16x32_bf16 v[168:171], v[232:235], v[208:211], v[168:171]
    ds_read_b64_tr_b16 v[228:229], v70 offset:29152
    v_mfma_f32_16x16x32_bf16 v[172:175], v[232:235], v[212:215], v[172:175]
    ds_read_b64_tr_b16 v[230:231], v70 offset:29664
    s_waitcnt lgkmcnt(8)
    s_waitcnt vmcnt(8)
    v_mfma_f32_16x16x32_bf16 v[128:131], v[236:239], v[216:219], v[128:131]
    ds_read_b64_tr_b16 v[232:233], v71 offset:29120
    v_mfma_f32_16x16x32_bf16 v[132:135], v[236:239], v[220:223], v[132:135]
    ds_read_b64_tr_b16 v[234:235], v71 offset:29632
    s_add_u32 s96, s85, 14
    s_and_b32 s97, s96, 15
    s_lshl_b32 s98, s97, 14
    s_add_u32 s16, s98, s15
    buffer_load_dwordx4 v[208:211], v2, s[32:35], s16 offen sc1
    v_mfma_f32_16x16x32_bf16 v[136:139], v[240:243], v[216:219], v[136:139]
    ds_read_b64_tr_b16 v[236:237], v71 offset:29152
    v_mfma_f32_16x16x32_bf16 v[140:143], v[240:243], v[220:223], v[140:143]
    ds_read_b64_tr_b16 v[238:239], v71 offset:29664
    s_waitcnt lgkmcnt(8)
    v_mfma_f32_16x16x32_bf16 v[112:115], v[244:247], v[216:219], v[112:115]
    ds_read_b64_tr_b16 v[240:241], v70 offset:45760
    v_mfma_f32_16x16x32_bf16 v[116:119], v[244:247], v[220:223], v[116:119]
    ds_read_b64_tr_b16 v[242:243], v70 offset:46272
    v_mfma_f32_16x16x32_bf16 v[120:123], v[248:251], v[216:219], v[120:123]
    ds_read_b64_tr_b16 v[244:245], v70 offset:45792
    v_mfma_f32_16x16x32_bf16 v[124:127], v[248:251], v[220:223], v[124:127]
    ds_read_b64_tr_b16 v[246:247], v70 offset:46304
    buffer_load_dwordx4 v[212:215], v2, s[32:35], s16 offen offset:1024 sc1
    s_waitcnt lgkmcnt(8)
    v_mfma_f32_16x16x32_bf16 v[80:83], v[224:227], v[216:219], v[80:83]
    ds_read_b64_tr_b16 v[248:249], v71 offset:45760
    v_mfma_f32_16x16x32_bf16 v[84:87], v[224:227], v[220:223], v[84:87]
    ds_read_b64_tr_b16 v[250:251], v71 offset:46272
    v_mfma_f32_16x16x32_bf16 v[88:91], v[228:231], v[216:219], v[88:91]
    ds_read_b64_tr_b16 v[224:225], v71 offset:45792
    v_mfma_f32_16x16x32_bf16 v[92:95], v[228:231], v[220:223], v[92:95]
    ds_read_b64_tr_b16 v[226:227], v71 offset:46304
    s_waitcnt lgkmcnt(8)
    v_mfma_f32_16x16x32_bf16 v[96:99], v[232:235], v[216:219], v[96:99]
    s_barrier
    ds_read_b64_tr_b16 v[228:229], v67 offset:8320
    v_mfma_f32_16x16x32_bf16 v[100:103], v[232:235], v[220:223], v[100:103]
    ds_read_b64_tr_b16 v[230:231], v67 offset:8832
    v_mfma_f32_16x16x32_bf16 v[104:107], v[236:239], v[216:219], v[104:107]
    ds_read_b64_tr_b16 v[232:233], v67 offset:8352
    v_mfma_f32_16x16x32_bf16 v[108:111], v[236:239], v[220:223], v[108:111]
    ds_read_b64_tr_b16 v[234:235], v67 offset:8864
    s_waitcnt lgkmcnt(8)
    v_mfma_f32_16x16x32_bf16 v[144:147], v[240:243], v[216:219], v[144:147]
    ds_read_b64_tr_b16 v[236:237], v66 offset:8320
    v_mfma_f32_16x16x32_bf16 v[148:151], v[240:243], v[220:223], v[148:151]
    ds_read_b64_tr_b16 v[238:239], v66 offset:8832
    v_mfma_f32_16x16x32_bf16 v[152:155], v[244:247], v[216:219], v[152:155]
    ds_read_b64_tr_b16 v[240:241], v66 offset:8352
    v_mfma_f32_16x16x32_bf16 v[156:159], v[244:247], v[220:223], v[156:159]
    ds_read_b64_tr_b16 v[242:243], v66 offset:8864
    s_waitcnt lgkmcnt(8)
    v_mfma_f32_16x16x32_bf16 v[160:163], v[248:251], v[216:219], v[160:163]
    ds_read_b64_tr_b16 v[244:245], v66
    v_mfma_f32_16x16x32_bf16 v[164:167], v[248:251], v[220:223], v[164:167]
    ds_read_b64_tr_b16 v[246:247], v66 offset:512
    v_mfma_f32_16x16x32_bf16 v[168:171], v[224:227], v[216:219], v[168:171]
    ds_read_b64_tr_b16 v[248:249], v66 offset:32
    v_mfma_f32_16x16x32_bf16 v[172:175], v[224:227], v[220:223], v[172:175]
    ds_read_b64_tr_b16 v[250:251], v66 offset:544
    s_waitcnt lgkmcnt(8)
    s_waitcnt vmcnt(8)
    v_mfma_f32_16x16x32_bf16 v[128:131], v[228:231], v[176:179], v[128:131]
    ds_read_b64_tr_b16 v[224:225], v67
    v_mfma_f32_16x16x32_bf16 v[132:135], v[228:231], v[180:183], v[132:135]
    ds_read_b64_tr_b16 v[226:227], v67 offset:512
    buffer_load_dwordx4 v[216:219], v2, s[32:35], s16 offen offset:2048 sc1
    v_mfma_f32_16x16x32_bf16 v[136:139], v[232:235], v[176:179], v[136:139]
    ds_read_b64_tr_b16 v[228:229], v67 offset:32
    v_mfma_f32_16x16x32_bf16 v[140:143], v[232:235], v[180:183], v[140:143]
    ds_read_b64_tr_b16 v[230:231], v67 offset:544
    s_waitcnt lgkmcnt(8)
    v_mfma_f32_16x16x32_bf16 v[112:115], v[236:239], v[176:179], v[112:115]
    ds_read_b64_tr_b16 v[232:233], v66 offset:16640
    v_mfma_f32_16x16x32_bf16 v[116:119], v[236:239], v[180:183], v[116:119]
    ds_read_b64_tr_b16 v[234:235], v66 offset:17152
    v_mfma_f32_16x16x32_bf16 v[120:123], v[240:243], v[176:179], v[120:123]
    ds_read_b64_tr_b16 v[236:237], v66 offset:16672
    v_mfma_f32_16x16x32_bf16 v[124:127], v[240:243], v[180:183], v[124:127]
    ds_read_b64_tr_b16 v[238:239], v66 offset:17184
    buffer_load_dwordx4 v[220:223], v2, s[32:35], s16 offen offset:3072 sc1
    s_waitcnt lgkmcnt(8)
    v_mfma_f32_16x16x32_bf16 v[80:83], v[244:247], v[176:179], v[80:83]
    ds_read_b64_tr_b16 v[240:241], v67 offset:16640
    v_mfma_f32_16x16x32_bf16 v[84:87], v[244:247], v[180:183], v[84:87]
    ds_read_b64_tr_b16 v[242:243], v67 offset:17152
    v_mfma_f32_16x16x32_bf16 v[88:91], v[248:251], v[176:179], v[88:91]
    ds_read_b64_tr_b16 v[244:245], v67 offset:16672
    v_mfma_f32_16x16x32_bf16 v[92:95], v[248:251], v[180:183], v[92:95]
    ds_read_b64_tr_b16 v[246:247], v67 offset:17184
    s_waitcnt lgkmcnt(8)
    v_mfma_f32_16x16x32_bf16 v[96:99], v[224:227], v[176:179], v[96:99]
    ds_read_b64_tr_b16 v[248:249], v67 offset:12480
    v_mfma_f32_16x16x32_bf16 v[100:103], v[224:227], v[180:183], v[100:103]
    ds_read_b64_tr_b16 v[250:251], v67 offset:12992
    v_mfma_f32_16x16x32_bf16 v[104:107], v[228:231], v[176:179], v[104:107]
    ds_read_b64_tr_b16 v[224:225], v67 offset:12512
    v_mfma_f32_16x16x32_bf16 v[108:111], v[228:231], v[180:183], v[108:111]
    ds_read_b64_tr_b16 v[226:227], v67 offset:13024
    s_waitcnt lgkmcnt(8)
    v_mfma_f32_16x16x32_bf16 v[144:147], v[232:235], v[176:179], v[144:147]
    ds_read_b64_tr_b16 v[228:229], v66 offset:12480
    v_mfma_f32_16x16x32_bf16 v[148:151], v[232:235], v[180:183], v[148:151]
    ds_read_b64_tr_b16 v[230:231], v66 offset:12992
    v_mfma_f32_16x16x32_bf16 v[152:155], v[236:239], v[176:179], v[152:155]
    ds_read_b64_tr_b16 v[232:233], v66 offset:12512
    v_mfma_f32_16x16x32_bf16 v[156:159], v[236:239], v[180:183], v[156:159]
    ds_read_b64_tr_b16 v[234:235], v66 offset:13024
    s_waitcnt lgkmcnt(8)
    v_mfma_f32_16x16x32_bf16 v[160:163], v[240:243], v[176:179], v[160:163]
    ds_read_b64_tr_b16 v[236:237], v66 offset:4160
    v_mfma_f32_16x16x32_bf16 v[164:167], v[240:243], v[180:183], v[164:167]
    ds_read_b64_tr_b16 v[238:239], v66 offset:4672
    v_mfma_f32_16x16x32_bf16 v[168:171], v[244:247], v[176:179], v[168:171]
    ds_read_b64_tr_b16 v[240:241], v66 offset:4192
    v_mfma_f32_16x16x32_bf16 v[172:175], v[244:247], v[180:183], v[172:175]
    ds_read_b64_tr_b16 v[242:243], v66 offset:4704
    s_waitcnt lgkmcnt(8)
    s_waitcnt vmcnt(8)
    v_mfma_f32_16x16x32_bf16 v[128:131], v[248:251], v[184:187], v[128:131]
    ds_read_b64_tr_b16 v[244:245], v67 offset:4160
    v_mfma_f32_16x16x32_bf16 v[132:135], v[248:251], v[188:191], v[132:135]
    ds_read_b64_tr_b16 v[246:247], v67 offset:4672
    s_add_u32 s96, s85, 15
    s_and_b32 s97, s96, 15
    s_lshl_b32 s98, s97, 14
    s_add_u32 s16, s98, s15
    buffer_load_dwordx4 v[176:179], v2, s[32:35], s16 offen sc1
    v_mfma_f32_16x16x32_bf16 v[136:139], v[224:227], v[184:187], v[136:139]
    ds_read_b64_tr_b16 v[248:249], v67 offset:4192
    v_mfma_f32_16x16x32_bf16 v[140:143], v[224:227], v[188:191], v[140:143]
    ds_read_b64_tr_b16 v[250:251], v67 offset:4704
    s_waitcnt lgkmcnt(8)
    v_mfma_f32_16x16x32_bf16 v[112:115], v[228:231], v[184:187], v[112:115]
    ds_read_b64_tr_b16 v[224:225], v66 offset:20800
    v_mfma_f32_16x16x32_bf16 v[116:119], v[228:231], v[188:191], v[116:119]
    ds_read_b64_tr_b16 v[226:227], v66 offset:21312
    v_mfma_f32_16x16x32_bf16 v[120:123], v[232:235], v[184:187], v[120:123]
    ds_read_b64_tr_b16 v[228:229], v66 offset:20832
    v_mfma_f32_16x16x32_bf16 v[124:127], v[232:235], v[188:191], v[124:127]
    ds_read_b64_tr_b16 v[230:231], v66 offset:21344
    buffer_load_dwordx4 v[180:183], v2, s[32:35], s16 offen offset:1024 sc1
    s_waitcnt lgkmcnt(8)
    v_mfma_f32_16x16x32_bf16 v[80:83], v[236:239], v[184:187], v[80:83]
    ds_read_b64_tr_b16 v[232:233], v67 offset:20800
    v_mfma_f32_16x16x32_bf16 v[84:87], v[236:239], v[188:191], v[84:87]
    ds_read_b64_tr_b16 v[234:235], v67 offset:21312
    v_mfma_f32_16x16x32_bf16 v[88:91], v[240:243], v[184:187], v[88:91]
    ds_read_b64_tr_b16 v[236:237], v67 offset:20832
    v_mfma_f32_16x16x32_bf16 v[92:95], v[240:243], v[188:191], v[92:95]
    ds_read_b64_tr_b16 v[238:239], v67 offset:21344
    s_waitcnt lgkmcnt(8)
    v_mfma_f32_16x16x32_bf16 v[96:99], v[244:247], v[184:187], v[96:99]
    s_barrier
    ds_read_b64_tr_b16 v[240:241], v67 offset:33280
    v_mfma_f32_16x16x32_bf16 v[100:103], v[244:247], v[188:191], v[100:103]
    ds_read_b64_tr_b16 v[242:243], v67 offset:33792
    v_mfma_f32_16x16x32_bf16 v[104:107], v[248:251], v[184:187], v[104:107]
    ds_read_b64_tr_b16 v[244:245], v67 offset:33312
    v_mfma_f32_16x16x32_bf16 v[108:111], v[248:251], v[188:191], v[108:111]
    ds_read_b64_tr_b16 v[246:247], v67 offset:33824
    s_waitcnt lgkmcnt(8)
    v_mfma_f32_16x16x32_bf16 v[144:147], v[224:227], v[184:187], v[144:147]
    ds_read_b64_tr_b16 v[248:249], v66 offset:33280
    v_mfma_f32_16x16x32_bf16 v[148:151], v[224:227], v[188:191], v[148:151]
    ds_read_b64_tr_b16 v[250:251], v66 offset:33792
    v_mfma_f32_16x16x32_bf16 v[152:155], v[228:231], v[184:187], v[152:155]
    ds_read_b64_tr_b16 v[224:225], v66 offset:33312
    v_mfma_f32_16x16x32_bf16 v[156:159], v[228:231], v[188:191], v[156:159]
    ds_read_b64_tr_b16 v[226:227], v66 offset:33824
    s_waitcnt lgkmcnt(8)
    v_mfma_f32_16x16x32_bf16 v[160:163], v[232:235], v[184:187], v[160:163]
    ds_read_b64_tr_b16 v[228:229], v66 offset:24960
    v_mfma_f32_16x16x32_bf16 v[164:167], v[232:235], v[188:191], v[164:167]
    ds_read_b64_tr_b16 v[230:231], v66 offset:25472
    v_mfma_f32_16x16x32_bf16 v[168:171], v[236:239], v[184:187], v[168:171]
    ds_read_b64_tr_b16 v[232:233], v66 offset:24992
    v_mfma_f32_16x16x32_bf16 v[172:175], v[236:239], v[188:191], v[172:175]
    ds_read_b64_tr_b16 v[234:235], v66 offset:25504
    s_waitcnt lgkmcnt(8)
    s_waitcnt vmcnt(8)
    v_mfma_f32_16x16x32_bf16 v[128:131], v[240:243], v[192:195], v[128:131]
    ds_read_b64_tr_b16 v[236:237], v67 offset:24960
    v_mfma_f32_16x16x32_bf16 v[132:135], v[240:243], v[196:199], v[132:135]
    ds_read_b64_tr_b16 v[238:239], v67 offset:25472
    buffer_load_dwordx4 v[184:187], v2, s[32:35], s16 offen offset:2048 sc1
    v_mfma_f32_16x16x32_bf16 v[136:139], v[244:247], v[192:195], v[136:139]
    ds_read_b64_tr_b16 v[240:241], v67 offset:24992
    v_mfma_f32_16x16x32_bf16 v[140:143], v[244:247], v[196:199], v[140:143]
    ds_read_b64_tr_b16 v[242:243], v67 offset:25504
    s_waitcnt lgkmcnt(8)
    v_mfma_f32_16x16x32_bf16 v[112:115], v[248:251], v[192:195], v[112:115]
    ds_read_b64_tr_b16 v[244:245], v66 offset:41600
    v_mfma_f32_16x16x32_bf16 v[116:119], v[248:251], v[196:199], v[116:119]
    ds_read_b64_tr_b16 v[246:247], v66 offset:42112
    v_mfma_f32_16x16x32_bf16 v[120:123], v[224:227], v[192:195], v[120:123]
    ds_read_b64_tr_b16 v[248:249], v66 offset:41632
    v_mfma_f32_16x16x32_bf16 v[124:127], v[224:227], v[196:199], v[124:127]
    ds_read_b64_tr_b16 v[250:251], v66 offset:42144
    buffer_load_dwordx4 v[188:191], v2, s[32:35], s16 offen offset:3072 sc1
    s_barrier
    s_waitcnt lgkmcnt(8)
    v_mfma_f32_16x16x32_bf16 v[80:83], v[228:231], v[192:195], v[80:83]
    ds_read_b64_tr_b16 v[224:225], v67 offset:41600
    v_mfma_f32_16x16x32_bf16 v[84:87], v[228:231], v[196:199], v[84:87]
    ds_read_b64_tr_b16 v[226:227], v67 offset:42112
    v_mfma_f32_16x16x32_bf16 v[88:91], v[232:235], v[192:195], v[88:91]
    ds_read_b64_tr_b16 v[228:229], v67 offset:41632
    v_mfma_f32_16x16x32_bf16 v[92:95], v[232:235], v[196:199], v[92:95]
    ds_read_b64_tr_b16 v[230:231], v67 offset:42144
    s_waitcnt lgkmcnt(8)
    v_mfma_f32_16x16x32_bf16 v[96:99], v[236:239], v[192:195], v[96:99]
    ds_read_b64_tr_b16 v[232:233], v67 offset:37440
    v_mfma_f32_16x16x32_bf16 v[100:103], v[236:239], v[196:199], v[100:103]
    ds_read_b64_tr_b16 v[234:235], v67 offset:37952
    v_mfma_f32_16x16x32_bf16 v[104:107], v[240:243], v[192:195], v[104:107]
    ds_read_b64_tr_b16 v[236:237], v67 offset:37472
    v_mfma_f32_16x16x32_bf16 v[108:111], v[240:243], v[196:199], v[108:111]
    ds_read_b64_tr_b16 v[238:239], v67 offset:37984
    s_waitcnt lgkmcnt(8)
    v_mfma_f32_16x16x32_bf16 v[144:147], v[244:247], v[192:195], v[144:147]
    ds_read_b64_tr_b16 v[240:241], v66 offset:37440
    v_mfma_f32_16x16x32_bf16 v[148:151], v[244:247], v[196:199], v[148:151]
    ds_read_b64_tr_b16 v[242:243], v66 offset:37952
    v_mfma_f32_16x16x32_bf16 v[152:155], v[248:251], v[192:195], v[152:155]
    ds_read_b64_tr_b16 v[244:245], v66 offset:37472
    v_mfma_f32_16x16x32_bf16 v[156:159], v[248:251], v[196:199], v[156:159]
    ds_read_b64_tr_b16 v[246:247], v66 offset:37984
    s_waitcnt lgkmcnt(8)
    v_mfma_f32_16x16x32_bf16 v[160:163], v[224:227], v[192:195], v[160:163]
    ds_read_b64_tr_b16 v[248:249], v66 offset:29120
    v_mfma_f32_16x16x32_bf16 v[164:167], v[224:227], v[196:199], v[164:167]
    ds_read_b64_tr_b16 v[250:251], v66 offset:29632
    v_mfma_f32_16x16x32_bf16 v[168:171], v[228:231], v[192:195], v[168:171]
    ds_read_b64_tr_b16 v[224:225], v66 offset:29152
    v_mfma_f32_16x16x32_bf16 v[172:175], v[228:231], v[196:199], v[172:175]
    ds_read_b64_tr_b16 v[226:227], v66 offset:29664
    s_waitcnt lgkmcnt(8)
    s_waitcnt vmcnt(8)
    v_mfma_f32_16x16x32_bf16 v[128:131], v[232:235], v[200:203], v[128:131]
    ds_read_b64_tr_b16 v[228:229], v67 offset:29120
    v_mfma_f32_16x16x32_bf16 v[132:135], v[232:235], v[204:207], v[132:135]
    ds_read_b64_tr_b16 v[230:231], v67 offset:29632
    v_mfma_f32_16x16x32_bf16 v[136:139], v[236:239], v[200:203], v[136:139]
    ds_read_b64_tr_b16 v[232:233], v67 offset:29152
    v_mfma_f32_16x16x32_bf16 v[140:143], v[236:239], v[204:207], v[140:143]
    ds_read_b64_tr_b16 v[234:235], v67 offset:29664
    s_waitcnt lgkmcnt(8)
    v_mfma_f32_16x16x32_bf16 v[112:115], v[240:243], v[200:203], v[112:115]
    ds_read_b64_tr_b16 v[236:237], v66 offset:45760
    v_mfma_f32_16x16x32_bf16 v[116:119], v[240:243], v[204:207], v[116:119]
    ds_read_b64_tr_b16 v[238:239], v66 offset:46272
    v_mfma_f32_16x16x32_bf16 v[120:123], v[244:247], v[200:203], v[120:123]
    ds_read_b64_tr_b16 v[240:241], v66 offset:45792
    v_mfma_f32_16x16x32_bf16 v[124:127], v[244:247], v[204:207], v[124:127]
    ds_read_b64_tr_b16 v[242:243], v66 offset:46304
    s_waitcnt lgkmcnt(8)
    v_mfma_f32_16x16x32_bf16 v[80:83], v[248:251], v[200:203], v[80:83]
    ds_read_b64_tr_b16 v[244:245], v67 offset:45760
    v_mfma_f32_16x16x32_bf16 v[84:87], v[248:251], v[204:207], v[84:87]
    ds_read_b64_tr_b16 v[246:247], v67 offset:46272
    v_mfma_f32_16x16x32_bf16 v[88:91], v[224:227], v[200:203], v[88:91]
    ds_read_b64_tr_b16 v[248:249], v67 offset:45792
    v_mfma_f32_16x16x32_bf16 v[92:95], v[224:227], v[204:207], v[92:95]
    ds_read_b64_tr_b16 v[250:251], v67 offset:46304
    s_waitcnt lgkmcnt(8)
    v_mfma_f32_16x16x32_bf16 v[96:99], v[228:231], v[200:203], v[96:99]
    s_barrier
    ds_read_b64_tr_b16 v[224:225], v69 offset:8320
    v_mfma_f32_16x16x32_bf16 v[100:103], v[228:231], v[204:207], v[100:103]
    ds_read_b64_tr_b16 v[226:227], v69 offset:8832
    v_mfma_f32_16x16x32_bf16 v[104:107], v[232:235], v[200:203], v[104:107]
    ds_read_b64_tr_b16 v[228:229], v69 offset:8352
    v_mfma_f32_16x16x32_bf16 v[108:111], v[232:235], v[204:207], v[108:111]
    ds_read_b64_tr_b16 v[230:231], v69 offset:8864
    s_waitcnt lgkmcnt(8)
    v_mfma_f32_16x16x32_bf16 v[144:147], v[236:239], v[200:203], v[144:147]
    ds_read_b64_tr_b16 v[232:233], v68 offset:8320
    v_mfma_f32_16x16x32_bf16 v[148:151], v[236:239], v[204:207], v[148:151]
    ds_read_b64_tr_b16 v[234:235], v68 offset:8832
    v_mfma_f32_16x16x32_bf16 v[152:155], v[240:243], v[200:203], v[152:155]
    ds_read_b64_tr_b16 v[236:237], v68 offset:8352
    v_mfma_f32_16x16x32_bf16 v[156:159], v[240:243], v[204:207], v[156:159]
    ds_read_b64_tr_b16 v[238:239], v68 offset:8864
    s_waitcnt lgkmcnt(8)
    v_mfma_f32_16x16x32_bf16 v[160:163], v[244:247], v[200:203], v[160:163]
    ds_read_b64_tr_b16 v[240:241], v68
    v_mfma_f32_16x16x32_bf16 v[164:167], v[244:247], v[204:207], v[164:167]
    ds_read_b64_tr_b16 v[242:243], v68 offset:512
    v_mfma_f32_16x16x32_bf16 v[168:171], v[248:251], v[200:203], v[168:171]
    ds_read_b64_tr_b16 v[244:245], v68 offset:32
    v_mfma_f32_16x16x32_bf16 v[172:175], v[248:251], v[204:207], v[172:175]
    ds_read_b64_tr_b16 v[246:247], v68 offset:544
    s_waitcnt lgkmcnt(8)
    s_waitcnt vmcnt(6)
    v_mfma_f32_16x16x32_bf16 v[128:131], v[224:227], v[208:211], v[128:131]
    ds_read_b64_tr_b16 v[248:249], v69
    v_mfma_f32_16x16x32_bf16 v[132:135], v[224:227], v[212:215], v[132:135]
    ds_read_b64_tr_b16 v[250:251], v69 offset:512
    v_mfma_f32_16x16x32_bf16 v[136:139], v[228:231], v[208:211], v[136:139]
    ds_read_b64_tr_b16 v[224:225], v69 offset:32
    v_mfma_f32_16x16x32_bf16 v[140:143], v[228:231], v[212:215], v[140:143]
    ds_read_b64_tr_b16 v[226:227], v69 offset:544
    s_waitcnt lgkmcnt(8)
    v_mfma_f32_16x16x32_bf16 v[112:115], v[232:235], v[208:211], v[112:115]
    ds_read_b64_tr_b16 v[228:229], v68 offset:16640
    v_mfma_f32_16x16x32_bf16 v[116:119], v[232:235], v[212:215], v[116:119]
    ds_read_b64_tr_b16 v[230:231], v68 offset:17152
    v_mfma_f32_16x16x32_bf16 v[120:123], v[236:239], v[208:211], v[120:123]
    ds_read_b64_tr_b16 v[232:233], v68 offset:16672
    v_mfma_f32_16x16x32_bf16 v[124:127], v[236:239], v[212:215], v[124:127]
    ds_read_b64_tr_b16 v[234:235], v68 offset:17184
    s_waitcnt lgkmcnt(8)
    v_mfma_f32_16x16x32_bf16 v[80:83], v[240:243], v[208:211], v[80:83]
    ds_read_b64_tr_b16 v[236:237], v69 offset:16640
    v_mfma_f32_16x16x32_bf16 v[84:87], v[240:243], v[212:215], v[84:87]
    ds_read_b64_tr_b16 v[238:239], v69 offset:17152
    v_mfma_f32_16x16x32_bf16 v[88:91], v[244:247], v[208:211], v[88:91]
    ds_read_b64_tr_b16 v[240:241], v69 offset:16672
    v_mfma_f32_16x16x32_bf16 v[92:95], v[244:247], v[212:215], v[92:95]
    ds_read_b64_tr_b16 v[242:243], v69 offset:17184
    s_waitcnt lgkmcnt(8)
    v_mfma_f32_16x16x32_bf16 v[96:99], v[248:251], v[208:211], v[96:99]
    ds_read_b64_tr_b16 v[244:245], v69 offset:12480
    v_mfma_f32_16x16x32_bf16 v[100:103], v[248:251], v[212:215], v[100:103]
    ds_read_b64_tr_b16 v[246:247], v69 offset:12992
    v_mfma_f32_16x16x32_bf16 v[104:107], v[224:227], v[208:211], v[104:107]
    ds_read_b64_tr_b16 v[248:249], v69 offset:12512
    v_mfma_f32_16x16x32_bf16 v[108:111], v[224:227], v[212:215], v[108:111]
    ds_read_b64_tr_b16 v[250:251], v69 offset:13024
    s_waitcnt lgkmcnt(8)
    v_mfma_f32_16x16x32_bf16 v[144:147], v[228:231], v[208:211], v[144:147]
    ds_read_b64_tr_b16 v[224:225], v68 offset:12480
    v_mfma_f32_16x16x32_bf16 v[148:151], v[228:231], v[212:215], v[148:151]
    ds_read_b64_tr_b16 v[226:227], v68 offset:12992
    v_mfma_f32_16x16x32_bf16 v[152:155], v[232:235], v[208:211], v[152:155]
    ds_read_b64_tr_b16 v[228:229], v68 offset:12512
    v_mfma_f32_16x16x32_bf16 v[156:159], v[232:235], v[212:215], v[156:159]
    ds_read_b64_tr_b16 v[230:231], v68 offset:13024
    s_waitcnt lgkmcnt(8)
    v_mfma_f32_16x16x32_bf16 v[160:163], v[236:239], v[208:211], v[160:163]
    ds_read_b64_tr_b16 v[232:233], v68 offset:4160
    v_mfma_f32_16x16x32_bf16 v[164:167], v[236:239], v[212:215], v[164:167]
    ds_read_b64_tr_b16 v[234:235], v68 offset:4672
    v_mfma_f32_16x16x32_bf16 v[168:171], v[240:243], v[208:211], v[168:171]
    ds_read_b64_tr_b16 v[236:237], v68 offset:4192
    v_mfma_f32_16x16x32_bf16 v[172:175], v[240:243], v[212:215], v[172:175]
    ds_read_b64_tr_b16 v[238:239], v68 offset:4704
    s_waitcnt lgkmcnt(8)
    s_waitcnt vmcnt(4)
    v_mfma_f32_16x16x32_bf16 v[128:131], v[244:247], v[216:219], v[128:131]
    ds_read_b64_tr_b16 v[240:241], v69 offset:4160
    v_mfma_f32_16x16x32_bf16 v[132:135], v[244:247], v[220:223], v[132:135]
    ds_read_b64_tr_b16 v[242:243], v69 offset:4672
    v_mfma_f32_16x16x32_bf16 v[136:139], v[248:251], v[216:219], v[136:139]
    ds_read_b64_tr_b16 v[244:245], v69 offset:4192
    v_mfma_f32_16x16x32_bf16 v[140:143], v[248:251], v[220:223], v[140:143]
    ds_read_b64_tr_b16 v[246:247], v69 offset:4704
    s_waitcnt lgkmcnt(8)
    v_mfma_f32_16x16x32_bf16 v[112:115], v[224:227], v[216:219], v[112:115]
    ds_read_b64_tr_b16 v[248:249], v68 offset:20800
    v_mfma_f32_16x16x32_bf16 v[116:119], v[224:227], v[220:223], v[116:119]
    ds_read_b64_tr_b16 v[250:251], v68 offset:21312
    v_mfma_f32_16x16x32_bf16 v[120:123], v[228:231], v[216:219], v[120:123]
    ds_read_b64_tr_b16 v[224:225], v68 offset:20832
    v_mfma_f32_16x16x32_bf16 v[124:127], v[228:231], v[220:223], v[124:127]
    ds_read_b64_tr_b16 v[226:227], v68 offset:21344
    s_waitcnt lgkmcnt(8)
    v_mfma_f32_16x16x32_bf16 v[80:83], v[232:235], v[216:219], v[80:83]
    ds_read_b64_tr_b16 v[228:229], v69 offset:20800
    v_mfma_f32_16x16x32_bf16 v[84:87], v[232:235], v[220:223], v[84:87]
    ds_read_b64_tr_b16 v[230:231], v69 offset:21312
    v_mfma_f32_16x16x32_bf16 v[88:91], v[236:239], v[216:219], v[88:91]
    ds_read_b64_tr_b16 v[232:233], v69 offset:20832
    v_mfma_f32_16x16x32_bf16 v[92:95], v[236:239], v[220:223], v[92:95]
    ds_read_b64_tr_b16 v[234:235], v69 offset:21344
    s_waitcnt lgkmcnt(8)
    v_mfma_f32_16x16x32_bf16 v[96:99], v[240:243], v[216:219], v[96:99]
    ds_read_b64_tr_b16 v[236:237], v69 offset:33280
    v_mfma_f32_16x16x32_bf16 v[100:103], v[240:243], v[220:223], v[100:103]
    ds_read_b64_tr_b16 v[238:239], v69 offset:33792
    v_mfma_f32_16x16x32_bf16 v[104:107], v[244:247], v[216:219], v[104:107]
    ds_read_b64_tr_b16 v[240:241], v69 offset:33312
    v_mfma_f32_16x16x32_bf16 v[108:111], v[244:247], v[220:223], v[108:111]
    ds_read_b64_tr_b16 v[242:243], v69 offset:33824
    s_waitcnt lgkmcnt(8)
    v_mfma_f32_16x16x32_bf16 v[144:147], v[248:251], v[216:219], v[144:147]
    ds_read_b64_tr_b16 v[244:245], v68 offset:33280
    v_mfma_f32_16x16x32_bf16 v[148:151], v[248:251], v[220:223], v[148:151]
    ds_read_b64_tr_b16 v[246:247], v68 offset:33792
    v_mfma_f32_16x16x32_bf16 v[152:155], v[224:227], v[216:219], v[152:155]
    ds_read_b64_tr_b16 v[248:249], v68 offset:33312
    v_mfma_f32_16x16x32_bf16 v[156:159], v[224:227], v[220:223], v[156:159]
    ds_read_b64_tr_b16 v[250:251], v68 offset:33824
    s_waitcnt lgkmcnt(8)
    v_mfma_f32_16x16x32_bf16 v[160:163], v[228:231], v[216:219], v[160:163]
    ds_read_b64_tr_b16 v[224:225], v68 offset:24960
    v_mfma_f32_16x16x32_bf16 v[164:167], v[228:231], v[220:223], v[164:167]
    ds_read_b64_tr_b16 v[226:227], v68 offset:25472
    v_mfma_f32_16x16x32_bf16 v[168:171], v[232:235], v[216:219], v[168:171]
    ds_read_b64_tr_b16 v[228:229], v68 offset:24992
    v_mfma_f32_16x16x32_bf16 v[172:175], v[232:235], v[220:223], v[172:175]
    ds_read_b64_tr_b16 v[230:231], v68 offset:25504
    s_waitcnt lgkmcnt(8)
    s_waitcnt vmcnt(2)
    v_mfma_f32_16x16x32_bf16 v[128:131], v[236:239], v[176:179], v[128:131]
    ds_read_b64_tr_b16 v[232:233], v69 offset:24960
    v_mfma_f32_16x16x32_bf16 v[132:135], v[236:239], v[180:183], v[132:135]
    ds_read_b64_tr_b16 v[234:235], v69 offset:25472
    v_mfma_f32_16x16x32_bf16 v[136:139], v[240:243], v[176:179], v[136:139]
    ds_read_b64_tr_b16 v[236:237], v69 offset:24992
    v_mfma_f32_16x16x32_bf16 v[140:143], v[240:243], v[180:183], v[140:143]
    ds_read_b64_tr_b16 v[238:239], v69 offset:25504
    s_waitcnt lgkmcnt(8)
    v_mfma_f32_16x16x32_bf16 v[112:115], v[244:247], v[176:179], v[112:115]
    ds_read_b64_tr_b16 v[240:241], v68 offset:41600
    v_mfma_f32_16x16x32_bf16 v[116:119], v[244:247], v[180:183], v[116:119]
    ds_read_b64_tr_b16 v[242:243], v68 offset:42112
    v_mfma_f32_16x16x32_bf16 v[120:123], v[248:251], v[176:179], v[120:123]
    ds_read_b64_tr_b16 v[244:245], v68 offset:41632
    v_mfma_f32_16x16x32_bf16 v[124:127], v[248:251], v[180:183], v[124:127]
    ds_read_b64_tr_b16 v[246:247], v68 offset:42144
    s_waitcnt lgkmcnt(8)
    v_mfma_f32_16x16x32_bf16 v[80:83], v[224:227], v[176:179], v[80:83]
    ds_read_b64_tr_b16 v[248:249], v69 offset:41600
    v_mfma_f32_16x16x32_bf16 v[84:87], v[224:227], v[180:183], v[84:87]
    ds_read_b64_tr_b16 v[250:251], v69 offset:42112
    v_mfma_f32_16x16x32_bf16 v[88:91], v[228:231], v[176:179], v[88:91]
    ds_read_b64_tr_b16 v[224:225], v69 offset:41632
    v_mfma_f32_16x16x32_bf16 v[92:95], v[228:231], v[180:183], v[92:95]
    ds_read_b64_tr_b16 v[226:227], v69 offset:42144
    s_waitcnt lgkmcnt(8)
    v_mfma_f32_16x16x32_bf16 v[96:99], v[232:235], v[176:179], v[96:99]
    ds_read_b64_tr_b16 v[228:229], v69 offset:37440
    v_mfma_f32_16x16x32_bf16 v[100:103], v[232:235], v[180:183], v[100:103]
    ds_read_b64_tr_b16 v[230:231], v69 offset:37952
    v_mfma_f32_16x16x32_bf16 v[104:107], v[236:239], v[176:179], v[104:107]
    ds_read_b64_tr_b16 v[232:233], v69 offset:37472
    v_mfma_f32_16x16x32_bf16 v[108:111], v[236:239], v[180:183], v[108:111]
    ds_read_b64_tr_b16 v[234:235], v69 offset:37984
    s_waitcnt lgkmcnt(8)
    v_mfma_f32_16x16x32_bf16 v[144:147], v[240:243], v[176:179], v[144:147]
    ds_read_b64_tr_b16 v[236:237], v68 offset:37440
    v_mfma_f32_16x16x32_bf16 v[148:151], v[240:243], v[180:183], v[148:151]
    ds_read_b64_tr_b16 v[238:239], v68 offset:37952
    v_mfma_f32_16x16x32_bf16 v[152:155], v[244:247], v[176:179], v[152:155]
    ds_read_b64_tr_b16 v[240:241], v68 offset:37472
    v_mfma_f32_16x16x32_bf16 v[156:159], v[244:247], v[180:183], v[156:159]
    ds_read_b64_tr_b16 v[242:243], v68 offset:37984
    s_waitcnt lgkmcnt(8)
    v_mfma_f32_16x16x32_bf16 v[160:163], v[248:251], v[176:179], v[160:163]
    ds_read_b64_tr_b16 v[244:245], v68 offset:29120
    v_mfma_f32_16x16x32_bf16 v[164:167], v[248:251], v[180:183], v[164:167]
    ds_read_b64_tr_b16 v[246:247], v68 offset:29632
    v_mfma_f32_16x16x32_bf16 v[168:171], v[224:227], v[176:179], v[168:171]
    ds_read_b64_tr_b16 v[248:249], v68 offset:29152
    v_mfma_f32_16x16x32_bf16 v[172:175], v[224:227], v[180:183], v[172:175]
    ds_read_b64_tr_b16 v[250:251], v68 offset:29664
    s_waitcnt lgkmcnt(8)
    s_waitcnt vmcnt(0)
    v_mfma_f32_16x16x32_bf16 v[128:131], v[228:231], v[184:187], v[128:131]
    ds_read_b64_tr_b16 v[224:225], v69 offset:29120
    v_mfma_f32_16x16x32_bf16 v[132:135], v[228:231], v[188:191], v[132:135]
    ds_read_b64_tr_b16 v[226:227], v69 offset:29632
    v_mfma_f32_16x16x32_bf16 v[136:139], v[232:235], v[184:187], v[136:139]
    ds_read_b64_tr_b16 v[228:229], v69 offset:29152
    v_mfma_f32_16x16x32_bf16 v[140:143], v[232:235], v[188:191], v[140:143]
    ds_read_b64_tr_b16 v[230:231], v69 offset:29664
    s_waitcnt lgkmcnt(8)
    v_mfma_f32_16x16x32_bf16 v[112:115], v[236:239], v[184:187], v[112:115]
    ds_read_b64_tr_b16 v[232:233], v68 offset:45760
    v_mfma_f32_16x16x32_bf16 v[116:119], v[236:239], v[188:191], v[116:119]
    ds_read_b64_tr_b16 v[234:235], v68 offset:46272
    v_mfma_f32_16x16x32_bf16 v[120:123], v[240:243], v[184:187], v[120:123]
    ds_read_b64_tr_b16 v[236:237], v68 offset:45792
    v_mfma_f32_16x16x32_bf16 v[124:127], v[240:243], v[188:191], v[124:127]
    ds_read_b64_tr_b16 v[238:239], v68 offset:46304
    s_waitcnt lgkmcnt(8)
    v_mfma_f32_16x16x32_bf16 v[80:83], v[244:247], v[184:187], v[80:83]
    ds_read_b64_tr_b16 v[240:241], v69 offset:45760
    v_mfma_f32_16x16x32_bf16 v[84:87], v[244:247], v[188:191], v[84:87]
    ds_read_b64_tr_b16 v[242:243], v69 offset:46272
    v_mfma_f32_16x16x32_bf16 v[88:91], v[248:251], v[184:187], v[88:91]
    ds_read_b64_tr_b16 v[244:245], v69 offset:45792
    v_mfma_f32_16x16x32_bf16 v[92:95], v[248:251], v[188:191], v[92:95]
    ds_read_b64_tr_b16 v[246:247], v69 offset:46304
    s_waitcnt lgkmcnt(8)
    v_mfma_f32_16x16x32_bf16 v[96:99], v[224:227], v[184:187], v[96:99]
    v_mfma_f32_16x16x32_bf16 v[100:103], v[224:227], v[188:191], v[100:103]
    v_mfma_f32_16x16x32_bf16 v[104:107], v[228:231], v[184:187], v[104:107]
    v_mfma_f32_16x16x32_bf16 v[108:111], v[228:231], v[188:191], v[108:111]
    s_waitcnt lgkmcnt(4)
    v_mfma_f32_16x16x32_bf16 v[144:147], v[232:235], v[184:187], v[144:147]
    v_mfma_f32_16x16x32_bf16 v[148:151], v[232:235], v[188:191], v[148:151]
    v_mfma_f32_16x16x32_bf16 v[152:155], v[236:239], v[184:187], v[152:155]
    v_mfma_f32_16x16x32_bf16 v[156:159], v[236:239], v[188:191], v[156:159]
    s_waitcnt lgkmcnt(0)
    v_mfma_f32_16x16x32_bf16 v[160:163], v[240:243], v[184:187], v[160:163]
    v_mfma_f32_16x16x32_bf16 v[164:167], v[240:243], v[188:191], v[164:167]
    v_mfma_f32_16x16x32_bf16 v[168:171], v[244:247], v[184:187], v[168:171]
    v_mfma_f32_16x16x32_bf16 v[172:175], v[244:247], v[188:191], v[172:175]
    v_cvt_pk_bf16_f32 v52, v128, v129
    v_cvt_pk_bf16_f32 v53, v130, v131
    v_cvt_pk_bf16_f32 v54, v132, v133
    v_cvt_pk_bf16_f32 v55, v134, v135
    v_cvt_pk_bf16_f32 v56, v136, v137
    v_cvt_pk_bf16_f32 v57, v138, v139
    v_cvt_pk_bf16_f32 v58, v140, v141
    v_cvt_pk_bf16_f32 v59, v142, v143
    ds_write_b64 v77, v[52:53]
    ds_write_b64 v77, v[54:55] offset:256
    ds_write_b64 v77, v[56:57] offset:1024
    ds_write_b64 v77, v[58:59] offset:1280
    v_cvt_pk_bf16_f32 v36, v112, v113
    v_cvt_pk_bf16_f32 v37, v114, v115
    v_cvt_pk_bf16_f32 v38, v116, v117
    v_cvt_pk_bf16_f32 v39, v118, v119
    v_cvt_pk_bf16_f32 v40, v120, v121
    v_cvt_pk_bf16_f32 v41, v122, v123
    v_cvt_pk_bf16_f32 v42, v124, v125
    v_cvt_pk_bf16_f32 v43, v126, v127
    v_permlane16_swap_b32 v36, v38
    v_permlane16_swap_b32 v37, v39
    v_permlane16_swap_b32 v40, v42
    v_permlane16_swap_b32 v41, v43
    s_waitcnt lgkmcnt(0)
    s_barrier
    s_setprio 0
    v_mfma_f32_32x32x16_bf16 v[112:127], v[28:31], v[36:39], 0
    v_mfma_f32_32x32x16_bf16 v[112:127], v[32:35], v[40:43], v[112:127]
    v_cvt_pk_bf16_f32 v52, v144, v145
    v_cvt_pk_bf16_f32 v53, v146, v147
    v_cvt_pk_bf16_f32 v54, v148, v149
    v_cvt_pk_bf16_f32 v55, v150, v151
    v_cvt_pk_bf16_f32 v56, v152, v153
    v_cvt_pk_bf16_f32 v57, v154, v155
    v_cvt_pk_bf16_f32 v58, v156, v157
    v_cvt_pk_bf16_f32 v59, v158, v159
    ds_write_b64 v78, v[52:53]
    ds_write_b64 v78, v[54:55] offset:512
    ds_write_b64 v78, v[56:57] offset:4096
    ds_write_b64 v78, v[58:59] offset:4608
    v_cvt_pk_bf16_f32 v44, v160, v161
    v_cvt_pk_bf16_f32 v45, v162, v163
    v_cvt_pk_bf16_f32 v46, v164, v165
    v_cvt_pk_bf16_f32 v47, v166, v167
    v_cvt_pk_bf16_f32 v48, v168, v169
    v_cvt_pk_bf16_f32 v49, v170, v171
    v_cvt_pk_bf16_f32 v50, v172, v173
    v_cvt_pk_bf16_f32 v51, v174, v175
    ds_write_b64 v78, v[44:45] offset:8192
    ds_write_b64 v78, v[46:47] offset:8704
    ds_write_b64 v78, v[48:49] offset:12288
    ds_write_b64 v78, v[50:51] offset:12800
    v_cvt_pk_bf16_f32 v36, v96, v97
    v_cvt_pk_bf16_f32 v37, v98, v99
    v_cvt_pk_bf16_f32 v38, v100, v101
    v_cvt_pk_bf16_f32 v39, v102, v103
    v_cvt_pk_bf16_f32 v40, v104, v105
    v_cvt_pk_bf16_f32 v41, v106, v107
    v_cvt_pk_bf16_f32 v42, v108, v109
    v_cvt_pk_bf16_f32 v43, v110, v111
    ds_write_b64 v77, v[36:37] offset:2048
    ds_write_b64 v77, v[38:39] offset:2304
    ds_write_b64 v77, v[40:41] offset:3072
    ds_write_b64 v77, v[42:43] offset:3328
    v_cvt_pk_bf16_f32 v44, v80, v81
    v_cvt_pk_bf16_f32 v45, v82, v83
    v_cvt_pk_bf16_f32 v46, v84, v85
    v_cvt_pk_bf16_f32 v47, v86, v87
    v_cvt_pk_bf16_f32 v48, v88, v89
    v_cvt_pk_bf16_f32 v49, v90, v91
    v_cvt_pk_bf16_f32 v50, v92, v93
    v_cvt_pk_bf16_f32 v51, v94, v95
    v_permlane16_swap_b32 v44, v46
    v_permlane16_swap_b32 v45, v47
    v_permlane16_swap_b32 v48, v50
    v_permlane16_swap_b32 v49, v51
    s_branch L_JOIN
L_HELP:
    s_add_u32 s96, s85, 5
    s_and_b32 s97, s96, 15
    s_lshl3_add_u32 s98, s97, s3
    s_sub_u32 s99, s98, 4
    s_mul_i32 s96, s99, 49152
    s_lshl_b32 s97, s11, 7
    s_add_u32 s82, s96, s97
    s_sub_u32 s96, s3, 4
    s_lshr_b32 s97, s96, 1
    s_mul_i32 s98, s97, 2080
    s_sub_u32 s99, s3, 4
    s_and_b32 s96, s99, 1
    s_mul_i32 s97, s96, 1056
    s_add_u32 s99, s98, s97
    s_add_u32 s20, s99, 124800
    s_mov_b32 m0, s20
    s_nop 0
    buffer_load_dwordx4 v62, s[40:43], s82 offen lds
    s_add_u32 s82, s82, 2048
    s_add_u32 m0, s20, 8320
    s_nop 0
    buffer_load_dwordx4 v62, s[40:43], s82 offen lds
    s_add_u32 s82, s82, 2048
    s_add_u32 m0, s20, 16640
    s_nop 0
    buffer_load_dwordx4 v62, s[40:43], s82 offen lds
    s_add_u32 s96, s85, 5
    s_and_b32 s97, s96, 15
    s_lshl3_add_u32 s98, s97, s3
    s_mul_i32 s99, s98, 49152
    s_lshl_b32 s96, s11, 7
    s_add_u32 s82, s99, s96
    s_lshr_b32 s96, s3, 1
    s_mul_i32 s97, s96, 2080
    s_and_b32 s98, s3, 1
    s_mul_i32 s99, s98, 1056
    s_add_u32 s96, s97, s99
    s_add_u32 s20, s96, 124800
    s_mov_b32 m0, s20
    s_nop 0
    buffer_load_dwordx4 v62, s[40:43], s82 offen lds
    s_add_u32 s82, s82, 2048
    s_add_u32 m0, s20, 8320
    s_nop 0
    buffer_load_dwordx4 v62, s[40:43], s82 offen lds
    s_add_u32 s82, s82, 2048
    s_add_u32 m0, s20, 16640
    s_nop 0
    buffer_load_dwordx4 v62, s[40:43], s82 offen lds
    s_and_b32 s96, s9, 3
    s_lshl2_add_u32 s97, s96, s3
    s_sub_u32 s98, s97, 4
    s_lshl_b32 s13, s98, 7
    v_lshrrev_b32 v61, 3, v1
    v_lshl_add_u32 v61, v61, 4, s13
    v_lshrrev_b32 v60, 3, v1
    v_mul_u32_u24 v60, 98304, v60
    v_and_b32 v9, 7, v1
    v_lshl_add_u32 v60, v9, 4, v60
    s_mul_i32 s96, s13, 6144
    s_bfe_u32 s97, s9, 131074
    s_lshl_b32 s98, s8, 1
    s_lshl4_add_u32 s99, s97, s98
    s_lshr_b32 s97, s9, 4
    s_add_u32 s98, s99, s97
    s_lshl_b32 s99, s98, 7
    s_add_u32 s97, s96, s99
    s_add_u32 s17, s97, 4096
    global_load_dwordx4 v[120:123], v61, s[86:87]
    s_waitcnt vmcnt(13)
    s_barrier
    buffer_load_dwordx4 v[80:83], v60, s[48:51], s17 offen nt
    s_add_u32 s17, s17, 12288
    buffer_load_dwordx4 v[84:87], v60, s[48:51], s17 offen nt
    s_add_u32 s17, s17, 12288
    s_waitcnt lgkmcnt(0)
    s_load_dword s24, s[32:33], s92 offset:512 glc
    s_load_dword s25, s[32:33], s92 offset:256 glc
    s_load_dword s26, s[32:33], s92 offset:1024 glc
    s_load_dword s27, s[32:33], s92 offset:768 glc
    s_waitcnt vmcnt(12)
    s_barrier
    s_add_u32 s96, s85, 6
    s_and_b32 s97, s96, 15
    s_lshl3_add_u32 s98, s97, s3
    s_sub_u32 s99, s98, 4
    s_mul_i32 s96, s99, 49152
    s_lshl_b32 s97, s11, 7
    s_add_u32 s82, s96, s97
    s_sub_u32 s96, s3, 4
    s_lshr_b32 s97, s96, 1
    s_mul_i32 s98, s97, 2080
    s_sub_u32 s99, s3, 4
    s_and_b32 s96, s99, 1
    s_mul_i32 s97, s96, 1056
    s_add_u32 s20, s98, s97
    s_mov_b32 m0, s20
    s_nop 0
    buffer_load_dwordx4 v62, s[40:43], s82 offen lds
    s_add_u32 s82, s82, 2048
    s_add_u32 m0, s20, 8320
    s_nop 0
    buffer_load_dwordx4 v62, s[40:43], s82 offen lds
    s_add_u32 s82, s82, 2048
    s_add_u32 m0, s20, 16640
    s_nop 0
    buffer_load_dwordx4 v62, s[40:43], s82 offen lds
    s_add_u32 s96, s85, 6
    s_and_b32 s97, s96, 15
    s_lshl3_add_u32 s98, s97, s3
    s_mul_i32 s99, s98, 49152
    s_lshl_b32 s96, s11, 7
    s_add_u32 s82, s99, s96
    s_lshr_b32 s96, s3, 1
    s_mul_i32 s97, s96, 2080
    s_and_b32 s98, s3, 1
    s_mul_i32 s99, s98, 1056
    s_add_u32 s20, s97, s99
    s_mov_b32 m0, s20
    s_nop 0
    buffer_load_dwordx4 v62, s[40:43], s82 offen lds
    s_add_u32 s82, s82, 2048
    s_add_u32 m0, s20, 8320
    s_nop 0
    buffer_load_dwordx4 v62, s[40:43], s82 offen lds
    s_add_u32 s82, s82, 2048
    s_add_u32 m0, s20, 16640
    s_nop 0
    buffer_load_dwordx4 v62, s[40:43], s82 offen lds
    s_waitcnt vmcnt(8)
    v_lshlrev_b32 v112, 16, v120
    v_mul_f32 v4, s7, v112
    v_exp_f32 v4, -v4
    s_nop 0
    v_add_f32 v4, 1.0, v4
    v_rcp_f32 v4, v4
    s_nop 0
    v_mul_f32 v112, v112, v4
    v_cvt_pk_bf16_f32 v112, 0, v112
    v_and_b32 v113, s6, v120
    v_mul_f32 v5, s7, v113
    v_exp_f32 v5, -v5
    s_nop 0
    v_add_f32 v5, 1.0, v5
    v_rcp_f32 v5, v5
    s_nop 0
    v_mul_f32 v113, v113, v5
    v_cvt_pk_bf16_f32 v113, 0, v113
    v_lshlrev_b32 v114, 16, v121
    v_mul_f32 v4, s7, v114
    v_exp_f32 v4, -v4
    s_nop 0
    v_add_f32 v4, 1.0, v4
    v_rcp_f32 v4, v4
    s_nop 0
    v_mul_f32 v114, v114, v4
    v_cvt_pk_bf16_f32 v114, 0, v114
    v_and_b32 v115, s6, v121
    v_mul_f32 v5, s7, v115
    v_exp_f32 v5, -v5
    s_nop 0
    v_add_f32 v5, 1.0, v5
    v_rcp_f32 v5, v5
    s_nop 0
    v_mul_f32 v115, v115, v5
    v_cvt_pk_bf16_f32 v115, 0, v115
    s_barrier
    s_add_u32 s96, s85, 7
    s_and_b32 s97, s96, 15
    s_lshl3_add_u32 s98, s97, s3
    s_sub_u32 s99, s98, 4
    s_mul_i32 s96, s99, 49152
    s_lshl_b32 s97, s11, 7
    s_add_u32 s82, s96, s97
    s_sub_u32 s96, s3, 4
    s_lshr_b32 s97, s96, 1
    s_mul_i32 s98, s97, 2080
    s_sub_u32 s99, s3, 4
    s_and_b32 s96, s99, 1
    s_mul_i32 s97, s96, 1056
    s_add_u32 s99, s98, s97
    s_add_u32 s20, s99, 24960
    s_mov_b32 m0, s20
    s_nop 0
    buffer_load_dwordx4 v62, s[40:43], s82 offen lds
    s_add_u32 s82, s82, 2048
    s_add_u32 m0, s20, 8320
    s_nop 0
    buffer_load_dwordx4 v62, s[40:43], s82 offen lds
    s_add_u32 s82, s82, 2048
    s_add_u32 m0, s20, 16640
    s_nop 0
    buffer_load_dwordx4 v62, s[40:43], s82 offen lds
    buffer_load_dwordx4 v[88:91], v60, s[48:51], s17 offen nt
    s_add_u32 s17, s17, 12288
    buffer_load_dwordx4 v[92:95], v60, s[48:51], s17 offen nt
    s_add_u32 s17, s17, 12288
    v_lshlrev_b32 v116, 16, v122
    v_mul_f32 v4, s7, v116
    v_exp_f32 v4, -v4
    s_nop 0
    v_add_f32 v4, 1.0, v4
    v_rcp_f32 v4, v4
    s_nop 0
    v_mul_f32 v116, v116, v4
    v_cvt_pk_bf16_f32 v116, 0, v116
    v_and_b32 v117, s6, v122
    v_mul_f32 v5, s7, v117
    v_exp_f32 v5, -v5
    s_nop 0
    v_add_f32 v5, 1.0, v5
    v_rcp_f32 v5, v5
    s_nop 0
    v_mul_f32 v117, v117, v5
    v_cvt_pk_bf16_f32 v117, 0, v117
    v_lshlrev_b32 v118, 16, v123
    v_mul_f32 v4, s7, v118
    v_exp_f32 v4, -v4
    s_nop 0
    v_add_f32 v4, 1.0, v4
    v_rcp_f32 v4, v4
    s_nop 0
    v_mul_f32 v118, v118, v4
    v_cvt_pk_bf16_f32 v118, 0, v118
    v_and_b32 v119, s6, v123
    v_mul_f32 v5, s7, v119
    v_exp_f32 v5, -v5
    s_nop 0
    v_add_f32 v5, 1.0, v5
    v_rcp_f32 v5, v5
    s_nop 0
    v_mul_f32 v119, v119, v5
    v_cvt_pk_bf16_f32 v119, 0, v119
    s_barrier
    s_add_u32 s96, s85, 7
    s_and_b32 s97, s96, 15
    s_lshl3_add_u32 s98, s97, s3
    s_mul_i32 s99, s98, 49152
    s_lshl_b32 s96, s11, 7
    s_add_u32 s82, s99, s96
    s_lshr_b32 s96, s3, 1
    s_mul_i32 s97, s96, 2080
    s_and_b32 s98, s3, 1
    s_mul_i32 s99, s98, 1056
    s_add_u32 s96, s97, s99
    s_add_u32 s20, s96, 24960
    s_mov_b32 m0, s20
    s_nop 0
    buffer_load_dwordx4 v62, s[40:43], s82 offen lds
    s_add_u32 s82, s82, 2048
    s_add_u32 m0, s20, 8320
    s_nop 0
    buffer_load_dwordx4 v62, s[40:43], s82 offen lds
    s_add_u32 s82, s82, 2048
    s_add_u32 m0, s20, 16640
    s_nop 0
    buffer_load_dwordx4 v62, s[40:43], s82 offen lds
    s_add_u32 s96, s85, 8
    s_and_b32 s97, s96, 15
    s_lshl3_add_u32 s98, s97, s3
    s_sub_u32 s99, s98, 4
    s_mul_i32 s96, s99, 49152
    s_lshl_b32 s97, s11, 7
    s_add_u32 s82, s96, s97
    s_sub_u32 s96, s3, 4
    s_lshr_b32 s97, s96, 1
    s_mul_i32 s98, s97, 2080
    s_sub_u32 s99, s3, 4
    s_and_b32 s96, s99, 1
    s_mul_i32 s97, s96, 1056
    s_add_u32 s99, s98, s97
    s_add_u32 s20, s99, 49920
    s_mov_b32 m0, s20
    s_nop 0
    buffer_load_dwordx4 v62, s[40:43], s82 offen lds
    s_add_u32 s82, s82, 2048
    s_add_u32 m0, s20, 8320
    s_nop 0
    buffer_load_dwordx4 v62, s[40:43], s82 offen lds
    s_add_u32 s82, s82, 2048
    s_add_u32 m0, s20, 16640
    s_nop 0
    buffer_load_dwordx4 v62, s[40:43], s82 offen lds
    s_waitcnt lgkmcnt(0)
    s_load_dword s24, s[32:33], s92 offset:1536 glc
    s_load_dword s25, s[32:33], s92 offset:1280 glc
    s_load_dword s26, s[32:33], s92 offset:2048 glc
    s_load_dword s27, s[32:33], s92 offset:1792 glc
    s_waitcnt vmcnt(18)
    v_lshlrev_b32 v4, 16, v80
    v_and_b32 v5, s6, v80
    v_mul_f32 v20, v4, v112
    v_mul_f32 v21, v5, v112
    v_lshlrev_b32 v6, 16, v81
    v_and_b32 v7, s6, v81
    v_mul_f32 v22, v6, v112
    v_mul_f32 v23, v7, v112
    v_lshlrev_b32 v4, 16, v82
    v_and_b32 v5, s6, v82
    v_mul_f32 v24, v4, v112
    v_mul_f32 v25, v5, v112
    v_lshlrev_b32 v6, 16, v83
    v_and_b32 v7, s6, v83
    v_mul_f32 v26, v6, v112
    v_mul_f32 v27, v7, v112
    s_barrier
    s_add_u32 s96, s85, 8
    s_and_b32 s97, s96, 15
    s_lshl3_add_u32 s98, s97, s3
    s_mul_i32 s99, s98, 49152
    s_lshl_b32 s96, s11, 7
    s_add_u32 s82, s99, s96
    s_lshr_b32 s96, s3, 1
    s_mul_i32 s97, s96, 2080
    s_and_b32 s98, s3, 1
    s_mul_i32 s99, s98, 1056
    s_add_u32 s96, s97, s99
    s_add_u32 s20, s96, 49920
    s_mov_b32 m0, s20
    s_nop 0
    buffer_load_dwordx4 v62, s[40:43], s82 offen lds
    s_add_u32 s82, s82, 2048
    s_add_u32 m0, s20, 8320
    s_nop 0
    buffer_load_dwordx4 v62, s[40:43], s82 offen lds
    s_add_u32 s82, s82, 2048
    s_add_u32 m0, s20, 16640
    s_nop 0
    buffer_load_dwordx4 v62, s[40:43], s82 offen lds
    buffer_load_dwordx4 v[96:99], v60, s[48:51], s17 offen nt
    s_add_u32 s17, s17, 12288
    buffer_load_dwordx4 v[100:103], v60, s[48:51], s17 offen nt
    s_add_u32 s17, s17, 12288
    s_waitcnt vmcnt(22)
    v_lshlrev_b32 v4, 16, v84
    v_and_b32 v5, s6, v84
    v_fmac_f32 v20, v4, v113
    v_fmac_f32 v21, v5, v113
    v_lshlrev_b32 v6, 16, v85
    v_and_b32 v7, s6, v85
    v_fmac_f32 v22, v6, v113
    v_fmac_f32 v23, v7, v113
    v_lshlrev_b32 v4, 16, v86
    v_and_b32 v5, s6, v86
    v_fmac_f32 v24, v4, v113
    v_fmac_f32 v25, v5, v113
    v_lshlrev_b32 v6, 16, v87
    v_and_b32 v7, s6, v87
    v_fmac_f32 v26, v6, v113
    v_fmac_f32 v27, v7, v113
    s_waitcnt vmcnt(16)
    s_barrier
    s_add_u32 s96, s85, 9
    s_and_b32 s97, s96, 15
    s_lshl3_add_u32 s98, s97, s3
    s_sub_u32 s99, s98, 4
    s_mul_i32 s96, s99, 49152
    s_lshl_b32 s97, s11, 7
    s_add_u32 s82, s96, s97
    s_sub_u32 s96, s3, 4
    s_lshr_b32 s97, s96, 1
    s_mul_i32 s98, s97, 2080
    s_sub_u32 s99, s3, 4
    s_and_b32 s96, s99, 1
    s_mul_i32 s97, s96, 1056
    s_add_u32 s99, s98, s97
    s_add_u32 s20, s99, 74880
    s_mov_b32 m0, s20
    s_nop 0
    buffer_load_dwordx4 v62, s[40:43], s82 offen lds
    s_add_u32 s82, s82, 2048
    s_add_u32 m0, s20, 8320
    s_nop 0
    buffer_load_dwordx4 v62, s[40:43], s82 offen lds
    s_add_u32 s82, s82, 2048
    s_add_u32 m0, s20, 16640
    s_nop 0
    buffer_load_dwordx4 v62, s[40:43], s82 offen lds
    s_add_u32 s96, s85, 9
    s_and_b32 s97, s96, 15
    s_lshl3_add_u32 s98, s97, s3
    s_mul_i32 s99, s98, 49152
    s_lshl_b32 s96, s11, 7
    s_add_u32 s82, s99, s96
    s_lshr_b32 s96, s3, 1
    s_mul_i32 s97, s96, 2080
    s_and_b32 s98, s3, 1
    s_mul_i32 s99, s98, 1056
    s_add_u32 s96, s97, s99
    s_add_u32 s20, s96, 74880
    s_mov_b32 m0, s20
    s_nop 0
    buffer_load_dwordx4 v62, s[40:43], s82 offen lds
    s_add_u32 s82, s82, 2048
    s_add_u32 m0, s20, 8320
    s_nop 0
    buffer_load_dwordx4 v62, s[40:43], s82 offen lds
    s_add_u32 s82, s82, 2048
    s_add_u32 m0, s20, 16640
    s_nop 0
    buffer_load_dwordx4 v62, s[40:43], s82 offen lds
    s_waitcnt vmcnt(18)
    v_lshlrev_b32 v4, 16, v88
    v_and_b32 v5, s6, v88
    v_fmac_f32 v20, v4, v114
    v_fmac_f32 v21, v5, v114
    v_lshlrev_b32 v6, 16, v89
    v_and_b32 v7, s6, v89
    v_fmac_f32 v22, v6, v114
    v_fmac_f32 v23, v7, v114
    v_lshlrev_b32 v4, 16, v90
    v_and_b32 v5, s6, v90
    v_fmac_f32 v24, v4, v114
    v_fmac_f32 v25, v5, v114
    v_lshlrev_b32 v6, 16, v91
    v_and_b32 v7, s6, v91
    v_fmac_f32 v26, v6, v114
    v_fmac_f32 v27, v7, v114
    s_waitcnt vmcnt(14)
    s_barrier
    s_add_u32 s96, s85, 10
    s_and_b32 s97, s96, 15
    s_lshl3_add_u32 s98, s97, s3
    s_sub_u32 s99, s98, 4
    s_mul_i32 s96, s99, 49152
    s_lshl_b32 s97, s11, 7
    s_add_u32 s82, s96, s97
    s_sub_u32 s96, s3, 4
    s_lshr_b32 s97, s96, 1
    s_mul_i32 s98, s97, 2080
    s_sub_u32 s99, s3, 4
    s_and_b32 s96, s99, 1
    s_mul_i32 s97, s96, 1056
    s_add_u32 s99, s98, s97
    s_add_u32 s20, s99, 99840
    s_mov_b32 m0, s20
    s_nop 0
    buffer_load_dwordx4 v62, s[40:43], s82 offen lds
    s_add_u32 s82, s82, 2048
    s_add_u32 m0, s20, 8320
    s_nop 0
    buffer_load_dwordx4 v62, s[40:43], s82 offen lds
    s_add_u32 s82, s82, 2048
    s_add_u32 m0, s20, 16640
    s_nop 0
    buffer_load_dwordx4 v62, s[40:43], s82 offen lds
    buffer_load_dwordx4 v[104:107], v60, s[48:51], s17 offen nt
    s_add_u32 s17, s17, 12288
    buffer_load_dwordx4 v[108:111], v60, s[48:51], s17 offen nt
    s_lshl2_add_u32 s96, s74, s75
    s_lshl_b32 s97, s96, 11
    s_and_b32 s98, s3, 1
    s_lshl_b32 s99, s98, 10
    s_add_u32 s96, s97, s99
    s_add_u32 s13, s96, 20971520
    s_lshl4_add_u32 s96, s21, s12
    s_lshl_b32 s97, s96, 11
    s_and_b32 s98, s3, 1
    s_lshl_b32 s99, s98, 10
    s_add_u32 s96, s97, s99
    s_add_u32 s14, s96, 12582912
    buffer_load_dwordx4 v[124:127], v2, s[32:35], s13 offen
    v_lshlrev_b32 v4, 16, v92
    v_and_b32 v5, s6, v92
    v_fmac_f32 v20, v4, v115
    v_fmac_f32 v21, v5, v115
    v_lshlrev_b32 v6, 16, v93
    v_and_b32 v7, s6, v93
    v_fmac_f32 v22, v6, v115
    v_fmac_f32 v23, v7, v115
    v_lshlrev_b32 v4, 16, v94
    v_and_b32 v5, s6, v94
    v_fmac_f32 v24, v4, v115
    v_fmac_f32 v25, v5, v115
    v_lshlrev_b32 v6, 16, v95
    v_and_b32 v7, s6, v95
    v_fmac_f32 v26, v6, v115
    v_fmac_f32 v27, v7, v115
    s_waitcnt lgkmcnt(0)
    s_load_dword s24, s[32:33], s92 offset:2560 glc
    s_load_dword s25, s[32:33], s92 offset:2304 glc
    s_load_dword s26, s[32:33], s92 offset:3072 glc
    s_load_dword s27, s[32:33], s92 offset:2816 glc
    s_load_dword s28, s[32:33], s92 offset:3584 glc
    s_load_dword s29, s[32:33], s92 offset:3328 glc
    s_waitcnt vmcnt(14)
    s_barrier
    s_add_u32 s96, s85, 10
    s_and_b32 s97, s96, 15
    s_lshl3_add_u32 s98, s97, s3
    s_mul_i32 s99, s98, 49152
    s_lshl_b32 s96, s11, 7
    s_add_u32 s82, s99, s96
    s_lshr_b32 s96, s3, 1
    s_mul_i32 s97, s96, 2080
    s_and_b32 s98, s3, 1
    s_mul_i32 s99, s98, 1056
    s_add_u32 s96, s97, s99
    s_add_u32 s20, s96, 99840
    s_mov_b32 m0, s20
    s_nop 0
    buffer_load_dwordx4 v62, s[40:43], s82 offen lds
    s_add_u32 s82, s82, 2048
    s_add_u32 m0, s20, 8320
    s_nop 0
    buffer_load_dwordx4 v62, s[40:43], s82 offen lds
    s_add_u32 s82, s82, 2048
    s_add_u32 m0, s20, 16640
    s_nop 0
    buffer_load_dwordx4 v62, s[40:43], s82 offen lds
    s_add_u32 s96, s85, 11
    s_and_b32 s97, s96, 15
    s_lshl3_add_u32 s98, s97, s3
    s_sub_u32 s99, s98, 4
    s_mul_i32 s96, s99, 49152
    s_lshl_b32 s97, s11, 7
    s_add_u32 s82, s96, s97
    s_sub_u32 s96, s3, 4
    s_lshr_b32 s97, s96, 1
    s_mul_i32 s98, s97, 2080
    s_sub_u32 s99, s3, 4
    s_and_b32 s96, s99, 1
    s_mul_i32 s97, s96, 1056
    s_add_u32 s99, s98, s97
    s_add_u32 s20, s99, 124800
    s_mov_b32 m0, s20
    s_nop 0
    buffer_load_dwordx4 v62, s[40:43], s82 offen lds
    s_add_u32 s82, s82, 2048
    s_add_u32 m0, s20, 8320
    s_nop 0
    buffer_load_dwordx4 v62, s[40:43], s82 offen lds
    s_add_u32 s82, s82, 2048
    s_add_u32 m0, s20, 16640
    s_nop 0
    buffer_load_dwordx4 v62, s[40:43], s82 offen lds
    s_waitcnt vmcnt(19)
    v_lshlrev_b32 v4, 16, v96
    v_and_b32 v5, s6, v96
    v_fmac_f32 v20, v4, v116
    v_fmac_f32 v21, v5, v116
    v_lshlrev_b32 v6, 16, v97
    v_and_b32 v7, s6, v97
    v_fmac_f32 v22, v6, v116
    v_fmac_f32 v23, v7, v116
    v_lshlrev_b32 v4, 16, v98
    v_and_b32 v5, s6, v98
    v_fmac_f32 v24, v4, v116
    v_fmac_f32 v25, v5, v116
    v_lshlrev_b32 v6, 16, v99
    v_and_b32 v7, s6, v99
    v_fmac_f32 v26, v6, v116
    v_fmac_f32 v27, v7, v116
    s_waitcnt vmcnt(18)
    v_lshlrev_b32 v4, 16, v100
    v_and_b32 v5, s6, v100
    v_fmac_f32 v20, v4, v117
    v_fmac_f32 v21, v5, v117
    v_lshlrev_b32 v6, 16, v101
    v_and_b32 v7, s6, v101
    v_fmac_f32 v22, v6, v117
    v_fmac_f32 v23, v7, v117
    v_lshlrev_b32 v4, 16, v102
    v_and_b32 v5, s6, v102
    v_fmac_f32 v24, v4, v117
    v_fmac_f32 v25, v5, v117
    v_lshlrev_b32 v6, 16, v103
    v_and_b32 v7, s6, v103
    v_fmac_f32 v26, v6, v117
    v_fmac_f32 v27, v7, v117
    s_waitcnt vmcnt(12)
    s_barrier
    s_add_u32 s96, s85, 11
    s_and_b32 s97, s96, 15
    s_lshl3_add_u32 s98, s97, s3
    s_mul_i32 s99, s98, 49152
    s_lshl_b32 s96, s11, 7
    s_add_u32 s82, s99, s96
    s_lshr_b32 s96, s3, 1
    s_mul_i32 s97, s96, 2080
    s_and_b32 s98, s3, 1
    s_mul_i32 s99, s98, 1056
    s_add_u32 s96, s97, s99
    s_add_u32 s20, s96, 124800
    s_mov_b32 m0, s20
    s_nop 0
    buffer_load_dwordx4 v62, s[40:43], s82 offen lds
    s_add_u32 s82, s82, 2048
    s_add_u32 m0, s20, 8320
    s_nop 0
    buffer_load_dwordx4 v62, s[40:43], s82 offen lds
    s_add_u32 s82, s82, 2048
    s_add_u32 m0, s20, 16640
    s_nop 0
    buffer_load_dwordx4 v62, s[40:43], s82 offen lds
    s_add_u32 s96, s85, 12
    s_and_b32 s97, s96, 15
    s_lshl3_add_u32 s98, s97, s3
    s_sub_u32 s99, s98, 4
    s_mul_i32 s96, s99, 49152
    s_lshl_b32 s97, s11, 7
    s_add_u32 s82, s96, s97
    s_sub_u32 s96, s3, 4
    s_lshr_b32 s97, s96, 1
    s_mul_i32 s98, s97, 2080
    s_sub_u32 s99, s3, 4
    s_and_b32 s96, s99, 1
    s_mul_i32 s97, s96, 1056
    s_add_u32 s20, s98, s97
    s_mov_b32 m0, s20
    s_nop 0
    buffer_load_dwordx4 v62, s[40:43], s82 offen lds
    s_add_u32 s82, s82, 2048
    s_add_u32 m0, s20, 8320
    s_nop 0
    buffer_load_dwordx4 v62, s[40:43], s82 offen lds
    s_add_u32 s82, s82, 2048
    s_add_u32 m0, s20, 16640
    s_nop 0
    buffer_load_dwordx4 v62, s[40:43], s82 offen lds
    s_waitcnt vmcnt(14)
    v_lshlrev_b32 v4, 16, v104
    v_and_b32 v5, s6, v104
    v_fmac_f32 v20, v4, v118
    v_fmac_f32 v21, v5, v118
    v_lshlrev_b32 v6, 16, v105
    v_and_b32 v7, s6, v105
    v_fmac_f32 v22, v6, v118
    v_fmac_f32 v23, v7, v118
    v_lshlrev_b32 v4, 16, v106
    v_and_b32 v5, s6, v106
    v_fmac_f32 v24, v4, v118
    v_fmac_f32 v25, v5, v118
    v_lshlrev_b32 v6, 16, v107
    v_and_b32 v7, s6, v107
    v_fmac_f32 v26, v6, v118
    v_fmac_f32 v27, v7, v118
    s_waitcnt vmcnt(13)
    v_lshlrev_b32 v4, 16, v108
    v_and_b32 v5, s6, v108
    v_fmac_f32 v20, v4, v119
    v_fmac_f32 v21, v5, v119
    v_lshlrev_b32 v6, 16, v109
    v_and_b32 v7, s6, v109
    v_fmac_f32 v22, v6, v119
    v_fmac_f32 v23, v7, v119
    v_lshlrev_b32 v4, 16, v110
    v_and_b32 v5, s6, v110
    v_fmac_f32 v24, v4, v119
    v_fmac_f32 v25, v5, v119
    v_lshlrev_b32 v6, 16, v111
    v_and_b32 v7, s6, v111
    v_fmac_f32 v26, v6, v119
    v_fmac_f32 v27, v7, v119
    v_permlane32_swap_b32 v20, v24
    v_permlane32_swap_b32 v21, v25
    v_permlane32_swap_b32 v22, v26
    v_permlane32_swap_b32 v23, v27
    v_add_f32 v20, v20, v24
    v_add_f32 v21, v21, v25
    v_add_f32 v22, v22, v26
    v_add_f32 v23, v23, v27
    s_nop 0
    v_permlane16_swap_b32 v20, v22
    v_permlane16_swap_b32 v21, v23
    v_add_f32 v20, v20, v22
    v_add_f32 v21, v21, v23
    s_nop 0
    v_add_f32_dpp v20, v20, v20 row_ror:8 row_mask:0xf bank_mask:0xf
    v_add_f32_dpp v21, v21, v21 row_ror:8 row_mask:0xf bank_mask:0xf
    s_nop 1
    v_mov_b32_dpp v20, v21 quad_perm:[0,1,2,3] row_mask:0xf bank_mask:0xc
    ds_write_b32 v65, v20 offset:1024
    s_waitcnt lgkmcnt(0)
    s_waitcnt vmcnt(9)
    s_barrier
    s_add_u32 s96, s85, 12
    s_and_b32 s97, s96, 15
    s_lshl3_add_u32 s98, s97, s3
    s_mul_i32 s99, s98, 49152
    s_lshl_b32 s96, s11, 7
    s_add_u32 s82, s99, s96
    s_lshr_b32 s96, s3, 1
    s_mul_i32 s97, s96, 2080
    s_and_b32 s98, s3, 1
    s_mul_i32 s99, s98, 1056
    s_add_u32 s20, s97, s99
    s_mov_b32 m0, s20
    s_nop 0
    buffer_load_dwordx4 v62, s[40:43], s82 offen lds
    s_add_u32 s82, s82, 2048
    s_add_u32 m0, s20, 8320
    s_nop 0
    buffer_load_dwordx4 v62, s[40:43], s82 offen lds
    s_add_u32 s82, s82, 2048
    s_add_u32 m0, s20, 16640
    s_nop 0
    buffer_load_dwordx4 v62, s[40:43], s82 offen lds
    s_add_u32 s96, s85, 13
    s_and_b32 s97, s96, 15
    s_lshl3_add_u32 s98, s97, s3
    s_sub_u32 s99, s98, 4
    s_mul_i32 s96, s99, 49152
    s_lshl_b32 s97, s11, 7
    s_add_u32 s82, s96, s97
    s_sub_u32 s96, s3, 4
    s_lshr_b32 s97, s96, 1
    s_mul_i32 s98, s97, 2080
    s_sub_u32 s99, s3, 4
    s_and_b32 s96, s99, 1
    s_mul_i32 s97, s96, 1056
    s_add_u32 s99, s98, s97
    s_add_u32 s20, s99, 24960
    s_mov_b32 m0, s20
    s_nop 0
    buffer_load_dwordx4 v62, s[40:43], s82 offen lds
    s_add_u32 s82, s82, 2048
    s_add_u32 m0, s20, 8320
    s_nop 0
    buffer_load_dwordx4 v62, s[40:43], s82 offen lds
    s_add_u32 s82, s82, 2048
    s_add_u32 m0, s20, 16640
    s_nop 0
    buffer_load_dwordx4 v62, s[40:43], s82 offen lds
    s_cmp_lg_u32 s3, 4
    s_cbranch_scc1 L_M2F
    ds_read_b128 v[20:23], v64 offset:1024
    s_bfe_u32 s96, s9, 131074
    s_lshl_b32 s97, s8, 1
    s_lshl4_add_u32 s98, s96, s97
    s_lshr_b32 s99, s9, 4
    s_add_u32 s96, s98, s99
    s_and_b32 s97, s9, 3
    s_lshl2_add_u32 s98, s96, s97
    s_lshl_b32 s99, s98, 9
    s_add_u32 s13, s99, 131072
    s_waitcnt lgkmcnt(0)
    v_add_f32 v20, v20, v21
    v_add_f32 v22, v22, v23
    v_mov_b32 v21, s4
    v_add_f32 v20, v20, v22
    buffer_store_dwordx2 v[20:21], v63, s[32:35], s13 offen sc1
L_M2F:
    s_waitcnt vmcnt(9)
    s_barrier
    s_add_u32 s96, s85, 13
    s_and_b32 s97, s96, 15
    s_lshl3_add_u32 s98, s97, s3
    s_mul_i32 s99, s98, 49152
    s_lshl_b32 s96, s11, 7
    s_add_u32 s82, s99, s96
    s_lshr_b32 s96, s3, 1
    s_mul_i32 s97, s96, 2080
    s_and_b32 s98, s3, 1
    s_mul_i32 s99, s98, 1056
    s_add_u32 s96, s97, s99
    s_add_u32 s20, s96, 24960
    s_mov_b32 m0, s20
    s_nop 0
    buffer_load_dwordx4 v62, s[40:43], s82 offen lds
    s_add_u32 s82, s82, 2048
    s_add_u32 m0, s20, 8320
    s_nop 0
    buffer_load_dwordx4 v62, s[40:43], s82 offen lds
    s_add_u32 s82, s82, 2048
    s_add_u32 m0, s20, 16640
    s_nop 0
    buffer_load_dwordx4 v62, s[40:43], s82 offen lds
    s_add_u32 s96, s85, 14
    s_and_b32 s97, s96, 15
    s_lshl3_add_u32 s98, s97, s3
    s_sub_u32 s99, s98, 4
    s_mul_i32 s96, s99, 49152
    s_lshl_b32 s97, s11, 7
    s_add_u32 s82, s96, s97
    s_sub_u32 s96, s3, 4
    s_lshr_b32 s97, s96, 1
    s_mul_i32 s98, s97, 2080
    s_sub_u32 s99, s3, 4
    s_and_b32 s96, s99, 1
    s_mul_i32 s97, s96, 1056
    s_add_u32 s99, s98, s97
    s_add_u32 s20, s99, 49920
    s_mov_b32 m0, s20
    s_nop 0
    buffer_load_dwordx4 v62, s[40:43], s82 offen lds
    s_add_u32 s82, s82, 2048
    s_add_u32 m0, s20, 8320
    s_nop 0
    buffer_load_dwordx4 v62, s[40:43], s82 offen lds
    s_add_u32 s82, s82, 2048
    s_add_u32 m0, s20, 16640
    s_nop 0
    buffer_load_dwordx4 v62, s[40:43], s82 offen lds
    s_waitcnt vmcnt(9)
    s_barrier
    s_add_u32 s96, s85, 14
    s_and_b32 s97, s96, 15
    s_lshl3_add_u32 s98, s97, s3
    s_mul_i32 s99, s98, 49152
    s_lshl_b32 s96, s11, 7
    s_add_u32 s82, s99, s96
    s_lshr_b32 s96, s3, 1
    s_mul_i32 s97, s96, 2080
    s_and_b32 s98, s3, 1
    s_mul_i32 s99, s98, 1056
    s_add_u32 s96, s97, s99
    s_add_u32 s20, s96, 49920
    s_mov_b32 m0, s20
    s_nop 0
    buffer_load_dwordx4 v62, s[40:43], s82 offen lds
    s_add_u32 s82, s82, 2048
    s_add_u32 m0, s20, 8320
    s_nop 0
    buffer_load_dwordx4 v62, s[40:43], s82 offen lds
    s_add_u32 s82, s82, 2048
    s_add_u32 m0, s20, 16640
    s_nop 0
    buffer_load_dwordx4 v62, s[40:43], s82 offen lds
    s_add_u32 s96, s85, 15
    s_and_b32 s97, s96, 15
    s_lshl3_add_u32 s98, s97, s3
    s_sub_u32 s99, s98, 4
    s_mul_i32 s96, s99, 49152
    s_lshl_b32 s97, s11, 7
    s_add_u32 s82, s96, s97
    s_sub_u32 s96, s3, 4
    s_lshr_b32 s97, s96, 1
    s_mul_i32 s98, s97, 2080
    s_sub_u32 s99, s3, 4
    s_and_b32 s96, s99, 1
    s_mul_i32 s97, s96, 1056
    s_add_u32 s99, s98, s97
    s_add_u32 s20, s99, 74880
    s_mov_b32 m0, s20
    s_nop 0
    buffer_load_dwordx4 v62, s[40:43], s82 offen lds
    s_add_u32 s82, s82, 2048
    s_add_u32 m0, s20, 8320
    s_nop 0
    buffer_load_dwordx4 v62, s[40:43], s82 offen lds
    s_add_u32 s82, s82, 2048
    s_add_u32 m0, s20, 16640
    s_nop 0
    buffer_load_dwordx4 v62, s[40:43], s82 offen lds
    s_waitcnt vmcnt(9)
    s_barrier
    s_add_u32 s96, s85, 15
    s_and_b32 s97, s96, 15
    s_lshl3_add_u32 s98, s97, s3
    s_mul_i32 s99, s98, 49152
    s_lshl_b32 s96, s11, 7
    s_add_u32 s82, s99, s96
    s_lshr_b32 s96, s3, 1
    s_mul_i32 s97, s96, 2080
    s_and_b32 s98, s3, 1
    s_mul_i32 s99, s98, 1056
    s_add_u32 s96, s97, s99
    s_add_u32 s20, s96, 74880
    s_mov_b32 m0, s20
    s_nop 0
    buffer_load_dwordx4 v62, s[40:43], s82 offen lds
    s_add_u32 s82, s82, 2048
    s_add_u32 m0, s20, 8320
    s_nop 0
    buffer_load_dwordx4 v62, s[40:43], s82 offen lds
    s_add_u32 s82, s82, 2048
    s_add_u32 m0, s20, 16640
    s_nop 0
    buffer_load_dwordx4 v62, s[40:43], s82 offen lds
    v_and_b32 v89, 31, v1
    v_lshlrev_b32 v89, 4, v89
    v_lshrrev_b32 v9, 5, v1
    v_lshl_add_u32 v89, v9, 9, v89
    s_and_b32 s96, s3, 3
    s_lshl4_add_u32 s97, s96, s12
    s_lshl_b32 s98, s97, 11
    s_add_u32 s18, s98, 131072
    s_lshl_b32 s13, s12, 7
    v_and_b32 v4, 31, v1
    v_lshl_add_u32 v4, v4, 2, s13
    global_load_dword v88, v4, s[78:79]
    buffer_load_dwordx4 v[80:83], v89, s[32:35], s18 offen sc1
    buffer_load_dwordx4 v[84:87], v89, s[32:35], s18 offen offset:1024 sc1
    s_barrier
    s_waitcnt vmcnt(9)
    s_waitcnt vmcnt(3)
    s_barrier
    s_lshl4_add_u32 s96, s11, s10
    s_lshl_b32 s97, s96, 10
    s_and_b32 s98, s3, 3
    s_lshl_b32 s99, s98, 8
    s_add_u32 s96, s97, s99
    s_add_u32 s13, s96, 29360128
    s_lshl_b32 s96, s11, 7
    s_add_u32 s14, s96, 32768
    v_lshlrev_b32 v60, 7, v1
    s_mov_b64 exec, 3
    buffer_load_dword v60, v60, s[32:35], s13 offen
    buffer_load_dword v61, v3, s[32:35], s14 offen
    s_mov_b64 exec, -1
    s_add_u32 s96, s84, 1114112
    s_and_b32 s97, s96, 1048575
    s_lshl_b32 s98, s83, 16
    s_xor_b32 s99, s97, s98
    s_xor_b32 s96, s88, 1048576
    s_add_u32 s13, s99, s96
    s_add_u32 m0, s89, 102400
    s_nop 0
    buffer_load_dwordx4 v74, s[44:47], s13 offen lds
    s_add_u32 s96, s84, 1179648
    s_and_b32 s97, s96, 1048575
    s_lshl_b32 s98, s83, 16
    s_xor_b32 s99, s97, s98
    s_xor_b32 s96, s88, 1048576
    s_add_u32 s13, s99, s96
    s_add_u32 m0, s89, 106496
    s_nop 0
    buffer_load_dwordx4 v74, s[44:47], s13 offen lds
    s_add_u32 s96, s84, 1245184
    s_and_b32 s97, s96, 1048575
    s_lshl_b32 s98, s83, 16
    s_xor_b32 s99, s97, s98
    s_xor_b32 s96, s88, 1048576
    s_add_u32 s13, s99, s96
    s_add_u32 m0, s89, 110592
    s_nop 0
    buffer_load_dwordx4 v74, s[44:47], s13 offen lds
    s_add_u32 s96, s84, 1310720
    s_and_b32 s97, s96, 1048575
    s_lshl_b32 s98, s83, 16
    s_xor_b32 s99, s97, s98
    s_xor_b32 s96, s88, 1048576
    s_add_u32 s13, s99, s96
    s_add_u32 m0, s89, 114688
    s_nop 0
    buffer_load_dwordx4 v74, s[44:47], s13 offen lds
    s_add_u32 s96, s84, 1376256
    s_and_b32 s97, s96, 1048575
    s_lshl_b32 s98, s83, 16
    s_xor_b32 s99, s97, s98
    s_xor_b32 s96, s88, 1048576
    s_add_u32 s13, s99, s96
    s_add_u32 m0, s89, 118784
    s_nop 0
    buffer_load_dwordx4 v74, s[44:47], s13 offen lds
    s_add_u32 s96, s84, 1441792
    s_and_b32 s97, s96, 1048575
    s_lshl_b32 s98, s83, 16
    s_xor_b32 s99, s97, s98
    s_xor_b32 s96, s88, 1048576
    s_add_u32 s13, s99, s96
    s_add_u32 m0, s89, 122880
    s_nop 0
    buffer_load_dwordx4 v74, s[44:47], s13 offen lds
    s_add_u32 s96, s84, 1507328
    s_and_b32 s97, s96, 1048575
    s_lshl_b32 s98, s83, 16
    s_xor_b32 s99, s97, s98
    s_xor_b32 s96, s88, 1048576
    s_add_u32 s13, s99, s96
    s_add_u32 m0, s89, 126976
    s_nop 0
    buffer_load_dwordx4 v74, s[44:47], s13 offen lds
    s_add_u32 s96, s84, 1572864
    s_and_b32 s97, s96, 1048575
    s_lshl_b32 s98, s83, 16
    s_xor_b32 s99, s97, s98
    s_xor_b32 s96, s88, 1048576
    s_add_u32 s13, s99, s96
    s_add_u32 m0, s89, 131072
    s_nop 0
    buffer_load_dwordx4 v74, s[44:47], s13 offen lds
    s_mov_b32 s13, s80
    buffer_load_dwordx4 v[176:179], v72, s[52:55], s13 offen nt
    s_add_u32 s13, s80, 4294049792
    buffer_load_dwordx4 v[180:183], v72, s[52:55], s13 offen nt
    s_add_u32 s13, s80, 57344
    buffer_load_dwordx4 v[184:187], v72, s[52:55], s13 offen nt
    s_add_u32 s13, s80, 4294107136
    buffer_load_dwordx4 v[188:191], v72, s[52:55], s13 offen nt
    s_add_u32 s13, s80, 114688
    buffer_load_dwordx4 v[192:195], v72, s[52:55], s13 offen nt
    s_add_u32 s13, s80, 4294164480
    buffer_load_dwordx4 v[196:199], v72, s[52:55], s13 offen nt
    s_add_u32 s13, s80, 172032
    buffer_load_dwordx4 v[200:203], v72, s[52:55], s13 offen nt
    s_add_u32 s13, s80, 4294221824
    buffer_load_dwordx4 v[204:207], v72, s[52:55], s13 offen nt
    s_waitcnt vmcnt(18)
    v_bitop3_b32 v4, v81, v83, s4 bitop3:0x7e
    v_bitop3_b32 v4, v4, v85, s4 bitop3:0xf6
    v_bitop3_b32 v4, v4, v87, s4 bitop3:0xf6
    v_cmp_ne_u32 vcc, 0, v4
    s_cbranch_vccz TOK_14
POLL_15:
    buffer_load_dwordx4 v[80:83], v89, s[32:35], s18 offen sc1
    buffer_load_dwordx4 v[84:87], v89, s[32:35], s18 offen offset:1024 sc1
    s_waitcnt vmcnt(0)
    v_bitop3_b32 v4, v81, v83, s4 bitop3:0x7e
    v_bitop3_b32 v4, v4, v85, s4 bitop3:0xf6
    v_bitop3_b32 v4, v4, v87, s4 bitop3:0xf6
    v_cmp_ne_u32 vcc, 0, v4
    s_cbranch_vccz PDONE_16
    s_add_u32 s5, s5, 1
    s_cmp_lt_u32 s5, 300000
    s_cbranch_scc1 POLL_15
PDONE_16:
TOK_14:
    s_and_b32 s96, s3, 3
    s_lshl_b32 s97, s96, 7
    s_add_u32 s13, s97, 139264
    v_and_b32 v4, 31, v1
    v_lshl_add_u32 v4, v4, 2, s13
    s_and_b32 s14, s3, 3
    v_add_f32 v80, v80, v84
    v_add_f32 v81, v82, v86
    v_mov_b32 v82, v80
    v_mov_b32 v83, v81
    s_cmp_eq_u32 s14, 2
    s_cselect_b32 s15, 1.0, 0
    v_permlane32_swap_b32 v80, v82
    v_permlane32_swap_b32 v81, v83
    v_pk_add_f32 v[80:81], v[80:81], v[82:83]
    v_cvt_pk_bf16_f32 v80, 0, v80
    v_cvt_pk_bf16_f32 v81, 0, v81
    v_add_f32 v80, s15, v80
    v_add_f32 v81, s15, v81
    v_cvt_pk_bf16_f32 v82, v80, v81
    ds_write_b32 v4, v82
    s_cbranch_scc0 L_NOG
    v_lshlrev_b32 v80, 16, v82
    v_and_b32 v81, s6, v82
    v_lshlrev_b32 v84, 16, v88
    v_and_b32 v85, s6, v88
    v_pk_mul_f32 v[84:85], v[84:85], v[80:81]
    v_cvt_pk_bf16_f32 v86, v84, v85
    v_lshlrev_b32 v80, 16, v86
    v_and_b32 v81, s6, v86
    v_pk_add_f32 v[80:81], v[84:85], v[80:81] neg_lo:[0,1] neg_hi:[0,1]
    v_cvt_pk_bf16_f32 v87, v80, v81
    v_add_f32 v80, v84, v85
    ds_write2_b32 v4, v86, v87 offset0:64 offset1:96
    ds_write_b32 v4, v88 offset:512
    v_add_f32_dpp v80, v80, v80 quad_perm:[1,0,3,2] row_mask:0xf bank_mask:0xf
    s_nop 1
    v_add_f32_dpp v80, v80, v80 quad_perm:[2,3,0,1] row_mask:0xf bank_mask:0xf
    s_nop 1
    v_add_f32_dpp v80, v80, v80 row_half_mirror row_mask:0xf bank_mask:0xf
    s_nop 1
    v_add_f32_dpp v80, v80, v80 row_ror:8 row_mask:0xf bank_mask:0xf
    s_lshl4_add_u32 s96, s21, s12
    s_lshl3_add_u32 s13, s96, 65536
    v_mov_b32 v82, v80
    v_mov_b32 v81, s4
    s_nop 0
    v_permlane16_swap_b32 v80, v82
    v_add_f32 v80, v80, v82
    s_mov_b64 exec, 1
    buffer_store_dwordx2 v[80:81], v3, s[32:35], s13 offen sc1
    s_mov_b64 exec, -1
L_NOG:
    s_waitcnt lgkmcnt(0)
    s_barrier
    ds_read_b128 v[36:39], v76
    ds_read_b128 v[40:43], v76 offset:1024
    s_waitcnt lgkmcnt(0)
    v_mfma_f32_32x32x16_bf16 v[112:127], v[28:31], v[36:39], 0
    v_mfma_f32_32x32x16_bf16 v[112:127], v[32:35], v[40:43], v[112:127]
    s_mov_b32 s13, s80
    buffer_load_dwordx4 v[208:211], v72, s[56:59], s13 offen nt
    s_add_u32 s13, s80, 4294049792
    buffer_load_dwordx4 v[212:215], v72, s[56:59], s13 offen nt
    s_add_u32 s13, s80, 57344
    buffer_load_dwordx4 v[216:219], v72, s[56:59], s13 offen nt
    s_add_u32 s13, s80, 4294107136
    buffer_load_dwordx4 v[220:223], v72, s[56:59], s13 offen nt
L_JOIN:
    s_nop 3
    v_cvt_pk_bf16_f32 v112, 0, v112
    v_cvt_pk_bf16_f32 v113, 0, v113
    v_cvt_pk_bf16_f32 v114, 0, v114
    v_cvt_pk_bf16_f32 v115, 0, v115
    v_cvt_pk_bf16_f32 v116, 0, v116
    v_cvt_pk_bf16_f32 v117, 0, v117
    v_cvt_pk_bf16_f32 v118, 0, v118
    v_cvt_pk_bf16_f32 v119, 0, v119
    v_cvt_pk_bf16_f32 v120, 0, v120
    v_cvt_pk_bf16_f32 v121, 0, v121
    v_cvt_pk_bf16_f32 v122, 0, v122
    v_cvt_pk_bf16_f32 v123, 0, v123
    v_cvt_pk_bf16_f32 v124, 0, v124
    v_cvt_pk_bf16_f32 v125, 0, v125
    v_cvt_pk_bf16_f32 v126, 0, v126
    v_cvt_pk_bf16_f32 v127, 0, v127
    v_max3_f32 v4, v112, v113, v114
    v_min3_f32 v5, v112, v113, v114
    v_max3_f32 v4, v4, v115, v116
    v_min3_f32 v5, v5, v115, v116
    v_max3_f32 v4, v4, v117, v118
    v_min3_f32 v5, v5, v117, v118
    v_max3_f32 v4, v4, v119, v120
    v_min3_f32 v5, v5, v119, v120
    v_max3_f32 v4, v4, v121, v122
    v_min3_f32 v5, v5, v121, v122
    v_max3_f32 v4, v4, v123, v124
    v_min3_f32 v5, v5, v123, v124
    v_max3_f32 v4, v4, v125, v126
    v_min3_f32 v5, v5, v125, v126
    v_max_f32 v6, v4, v127
    v_min_f32 v7, v5, v127
    v_max_f32 v4, v4, v127
    v_min_f32 v5, v5, v127
    s_nop 0
    v_permlane32_swap_b32 v4, v6
    v_permlane32_swap_b32 v5, v7
    v_max_f32 v4, v4, v6
    v_min_f32 v5, v5, v7
    v_pk_mul_f32 v[4:5], v[4:5], s[6:7] op_sel:[0,1]
    v_pk_fma_f32 v[128:129], v[112:113], s[6:7], v[4:5] op_sel:[0,1,0] op_sel_hi:[1,1,0] neg_lo:[0,0,1] neg_hi:[0,0,1]
    v_pk_fma_f32 v[112:113], v[112:113], s[6:7], v[4:5] op_sel:[0,1,1] neg_lo:[1,0,0] neg_hi:[1,0,0]
    v_pk_fma_f32 v[130:131], v[114:115], s[6:7], v[4:5] op_sel:[0,1,0] op_sel_hi:[1,1,0] neg_lo:[0,0,1] neg_hi:[0,0,1]
    v_pk_fma_f32 v[114:115], v[114:115], s[6:7], v[4:5] op_sel:[0,1,1] neg_lo:[1,0,0] neg_hi:[1,0,0]
    v_pk_fma_f32 v[132:133], v[116:117], s[6:7], v[4:5] op_sel:[0,1,0] op_sel_hi:[1,1,0] neg_lo:[0,0,1] neg_hi:[0,0,1]
    v_pk_fma_f32 v[116:117], v[116:117], s[6:7], v[4:5] op_sel:[0,1,1] neg_lo:[1,0,0] neg_hi:[1,0,0]
    v_pk_fma_f32 v[134:135], v[118:119], s[6:7], v[4:5] op_sel:[0,1,0] op_sel_hi:[1,1,0] neg_lo:[0,0,1] neg_hi:[0,0,1]
    v_pk_fma_f32 v[118:119], v[118:119], s[6:7], v[4:5] op_sel:[0,1,1] neg_lo:[1,0,0] neg_hi:[1,0,0]
    v_pk_fma_f32 v[136:137], v[120:121], s[6:7], v[4:5] op_sel:[0,1,0] op_sel_hi:[1,1,0] neg_lo:[0,0,1] neg_hi:[0,0,1]
    v_pk_fma_f32 v[120:121], v[120:121], s[6:7], v[4:5] op_sel:[0,1,1] neg_lo:[1,0,0] neg_hi:[1,0,0]
    v_pk_fma_f32 v[138:139], v[122:123], s[6:7], v[4:5] op_sel:[0,1,0] op_sel_hi:[1,1,0] neg_lo:[0,0,1] neg_hi:[0,0,1]
    v_pk_fma_f32 v[122:123], v[122:123], s[6:7], v[4:5] op_sel:[0,1,1] neg_lo:[1,0,0] neg_hi:[1,0,0]
    v_pk_fma_f32 v[140:141], v[124:125], s[6:7], v[4:5] op_sel:[0,1,0] op_sel_hi:[1,1,0] neg_lo:[0,0,1] neg_hi:[0,0,1]
    v_pk_fma_f32 v[124:125], v[124:125], s[6:7], v[4:5] op_sel:[0,1,1] neg_lo:[1,0,0] neg_hi:[1,0,0]
    v_pk_fma_f32 v[142:143], v[126:127], s[6:7], v[4:5] op_sel:[0,1,0] op_sel_hi:[1,1,0] neg_lo:[0,0,1] neg_hi:[0,0,1]
    v_pk_fma_f32 v[126:127], v[126:127], s[6:7], v[4:5] op_sel:[0,1,1] neg_lo:[1,0,0] neg_hi:[1,0,0]
    v_exp_f32 v128, v128
    v_exp_f32 v112, v112
    v_exp_f32 v129, v129
    v_exp_f32 v113, v113
    v_exp_f32 v130, v130
    v_exp_f32 v114, v114
    v_exp_f32 v131, v131
    v_exp_f32 v115, v115
    v_exp_f32 v132, v132
    v_exp_f32 v116, v116
    v_exp_f32 v133, v133
    v_exp_f32 v117, v117
    v_exp_f32 v134, v134
    v_exp_f32 v118, v118
    v_exp_f32 v135, v135
    v_exp_f32 v119, v119
    v_exp_f32 v136, v136
    v_exp_f32 v120, v120
    v_exp_f32 v137, v137
    v_exp_f32 v121, v121
    v_exp_f32 v138, v138
    v_exp_f32 v122, v122
    v_exp_f32 v139, v139
    v_exp_f32 v123, v123
    v_exp_f32 v140, v140
    v_exp_f32 v124, v124
    v_exp_f32 v141, v141
    v_exp_f32 v125, v125
    v_exp_f32 v142, v142
    v_exp_f32 v126, v126
    v_exp_f32 v143, v143
    v_exp_f32 v127, v127
    v_pk_add_f32 v[8:9], v[128:129], v[130:131]
    v_pk_add_f32 v[10:11], v[112:113], v[114:115]
    v_pk_add_f32 v[8:9], v[8:9], v[132:133]
    v_pk_add_f32 v[10:11], v[10:11], v[116:117]
    v_pk_add_f32 v[8:9], v[8:9], v[134:135]
    v_pk_add_f32 v[10:11], v[10:11], v[118:119]
    v_pk_add_f32 v[8:9], v[8:9], v[136:137]
    v_pk_add_f32 v[10:11], v[10:11], v[120:121]
    v_pk_add_f32 v[8:9], v[8:9], v[138:139]
    v_pk_add_f32 v[10:11], v[10:11], v[122:123]
    v_pk_add_f32 v[8:9], v[8:9], v[140:141]
    v_pk_add_f32 v[10:11], v[10:11], v[124:125]
    v_pk_add_f32 v[8:9], v[8:9], v[142:143]
    v_pk_add_f32 v[10:11], v[10:11], v[126:127]
    v_add_f32 v6, v8, v9
    v_add_f32 v7, v10, v11
    v_add_f32 v4, v8, v9
    v_add_f32 v5, v10, v11
    s_nop 0
    v_permlane32_swap_b32 v4, v6
    v_permlane32_swap_b32 v5, v7
    v_pk_add_f32 v[4:5], v[4:5], v[6:7]
    v_rcp_f32 v4, v4
    v_rcp_f32 v5, v5
    s_nop 0
    v_pk_mul_f32 v[128:129], v[128:129], v[4:5] op_sel_hi:[1,0]
    v_pk_mul_f32 v[112:113], v[112:113], v[4:5] op_sel:[0,1]
    v_pk_mul_f32 v[130:131], v[130:131], v[4:5] op_sel_hi:[1,0]
    v_pk_mul_f32 v[114:115], v[114:115], v[4:5] op_sel:[0,1]
    v_pk_mul_f32 v[132:133], v[132:133], v[4:5] op_sel_hi:[1,0]
    v_pk_mul_f32 v[116:117], v[116:117], v[4:5] op_sel:[0,1]
    v_pk_mul_f32 v[134:135], v[134:135], v[4:5] op_sel_hi:[1,0]
    v_pk_mul_f32 v[118:119], v[118:119], v[4:5] op_sel:[0,1]
    v_pk_mul_f32 v[136:137], v[136:137], v[4:5] op_sel_hi:[1,0]
    v_pk_mul_f32 v[120:121], v[120:121], v[4:5] op_sel:[0,1]
    v_pk_mul_f32 v[138:139], v[138:139], v[4:5] op_sel_hi:[1,0]
    v_pk_mul_f32 v[122:123], v[122:123], v[4:5] op_sel:[0,1]
    v_pk_mul_f32 v[140:141], v[140:141], v[4:5] op_sel_hi:[1,0]
    v_pk_mul_f32 v[124:125], v[124:125], v[4:5] op_sel:[0,1]
    v_pk_mul_f32 v[142:143], v[142:143], v[4:5] op_sel_hi:[1,0]
    v_pk_mul_f32 v[126:127], v[126:127], v[4:5] op_sel:[0,1]
    v_cvt_pk_bf16_f32 v80, v128, v129
    v_cvt_pk_bf16_f32 v88, v112, v113
    v_cvt_pk_bf16_f32 v81, v130, v131
    v_cvt_pk_bf16_f32 v89, v114, v115
    v_cvt_pk_bf16_f32 v82, v132, v133
    v_cvt_pk_bf16_f32 v90, v116, v117
    v_cvt_pk_bf16_f32 v83, v134, v135
    v_cvt_pk_bf16_f32 v91, v118, v119
    v_cvt_pk_bf16_f32 v84, v136, v137
    v_cvt_pk_bf16_f32 v92, v120, v121
    v_cvt_pk_bf16_f32 v85, v138, v139
    v_cvt_pk_bf16_f32 v93, v122, v123
    v_cvt_pk_bf16_f32 v86, v140, v141
    v_cvt_pk_bf16_f32 v94, v124, v125
    v_cvt_pk_bf16_f32 v87, v142, v143
    v_cvt_pk_bf16_f32 v95, v126, v127
    ds_write_b128 v75, v[80:83]
    ds_write_b128 v75, v[84:87] offset:4096
    ds_write_b128 v75, v[88:91] offset:8192
    ds_write_b128 v75, v[92:95] offset:12288
    s_lshl_b32 s13, s3, 12
    v_add_u32 v20, s13, v63
    s_lshl_b32 s96, s76, 13
    s_add_u32 s13, s96, 32768
    v_add_u32 v21, s13, v63
    v_mov_b32 v36, 0x3f803f80
    v_mov_b32 v37, 0x3f803f80
    v_mov_b32 v38, 0x3f803f80
    v_mov_b32 v39, 0x3f803f80
    s_lshl3_add_u32 s96, s11, s3
    s_lshl_b32 s97, s96, 5
    s_add_u32 s98, s97, s10
    s_lshl_b32 s99, s98, 10
    s_add_u32 s13, s99, 25165824
    s_add_u32 s15, s13, 16384
    s_lshl3_add_u32 s96, s11, s3
    s_lshl_b32 s97, s96, 10
    s_add_u32 s16, s97, 21495808
    s_lshl_b32 s96, s10, 6
    s_add_u32 s14, s96, s16
    s_waitcnt lgkmcnt(0)
    s_barrier
    s_lshl_b32 s96, s76, 6
    s_add_u32 s18, s96, 139264
    v_and_b32 v67, 7, v1
    v_lshl_add_u32 v67, v67, 2, s18
    v_lshrrev_b32 v9, 5, v1
    v_lshl_add_u32 v67, v9, 5, v67
    ds_read_b32 v64, v67
    ds_read_b32 v65, v67 offset:512
    ds_read_b32 v66, v67 offset:640
    ds_read_b32 v68, v67 offset:128
    ds_read_b32 v69, v67 offset:256
    ds_read_b32 v70, v67 offset:384
    ds_read_b32 v71, v67 offset:768
    ds_read_b64_tr_b16 v[128:129], v20
    ds_read_b64_tr_b16 v[130:131], v20 offset:512
    ds_read_b64_tr_b16 v[144:145], v21
    ds_read_b64_tr_b16 v[146:147], v21 offset:512
    ds_read_b64_tr_b16 v[148:149], v21 offset:4096
    ds_read_b64_tr_b16 v[150:151], v21 offset:4608
    ds_read_b64_tr_b16 v[132:133], v20 offset:1024
    ds_read_b64_tr_b16 v[134:135], v20 offset:1536
    ds_read_b64_tr_b16 v[152:153], v21 offset:1024
    ds_read_b64_tr_b16 v[154:155], v21 offset:1536
    ds_read_b64_tr_b16 v[156:157], v21 offset:5120
    ds_read_b64_tr_b16 v[158:159], v21 offset:5632
    ds_read_b64_tr_b16 v[136:137], v20 offset:2048
    ds_read_b64_tr_b16 v[138:139], v20 offset:2560
    ds_read_b64_tr_b16 v[160:161], v21 offset:2048
    ds_read_b64_tr_b16 v[162:163], v21 offset:2560
    ds_read_b64_tr_b16 v[164:165], v21 offset:6144
    ds_read_b64_tr_b16 v[166:167], v21 offset:6656
    s_waitcnt lgkmcnt(12)
    v_mfma_f32_16x16x32_bf16 v[52:55], v[128:131], v[144:147], 0
    v_mfma_f32_16x16x32_bf16 v[56:59], v[128:131], v[148:151], 0
    v_mfma_f32_16x16x32_bf16 v[40:43], v[128:131], v[36:39], 0
    ds_read_b64_tr_b16 v[140:141], v20 offset:3072
    ds_read_b64_tr_b16 v[142:143], v20 offset:3584
    ds_read_b64_tr_b16 v[168:169], v21 offset:3072
    ds_read_b64_tr_b16 v[170:171], v21 offset:3584
    ds_read_b64_tr_b16 v[172:173], v21 offset:7168
    ds_read_b64_tr_b16 v[174:175], v21 offset:7680
    s_waitcnt lgkmcnt(12)
    v_mfma_f32_16x16x32_bf16 v[52:55], v[132:135], v[152:155], v[52:55]
    v_mfma_f32_16x16x32_bf16 v[56:59], v[132:135], v[156:159], v[56:59]
    v_mfma_f32_16x16x32_bf16 v[40:43], v[132:135], v[36:39], v[40:43]
    v_and_b32 v75, 15, v1
    v_lshlrev_b32 v75, 15, v75
    s_and_b32 s96, s10, 1
    s_and_b32 s97, s2, 135
    s_lshl_b32 s98, s97, 12
    s_lshr_b32 s99, s10, 1
    s_lshl_b32 s97, s99, 6
    s_add_u32 s99, s98, s97
    s_lshl2_add_u32 s98, s96, s99
    s_add_u32 s97, s98, 1048576
    s_add_u32 s17, s97, 512
    s_waitcnt lgkmcnt(6)
    v_mfma_f32_16x16x32_bf16 v[52:55], v[136:139], v[160:163], v[52:55]
    v_mfma_f32_16x16x32_bf16 v[56:59], v[136:139], v[164:167], v[56:59]
    v_mfma_f32_16x16x32_bf16 v[40:43], v[136:139], v[36:39], v[40:43]
    s_waitcnt lgkmcnt(0)
    v_mfma_f32_16x16x32_bf16 v[52:55], v[140:143], v[168:171], v[52:55]
    v_mfma_f32_16x16x32_bf16 v[56:59], v[140:143], v[172:175], v[56:59]
    v_mfma_f32_16x16x32_bf16 v[40:43], v[140:143], v[36:39], v[40:43]
    s_cmp_lt_u32 s3, 4
    s_cbranch_scc1 L_NOQX
    ds_read_b128 v[44:47], v76 offset:2048
    ds_read_b128 v[48:51], v76 offset:3072
L_NOQX:
    s_nop 3
    buffer_store_dwordx4 v[52:55], v2, s[32:35], s13 offen sc1
    buffer_store_dwordx4 v[56:59], v2, s[32:35], s15 offen sc1
    s_mov_b32 exec_lo, 0x00010001
    s_mov_b32 exec_hi, 0x00010001
    buffer_store_dwordx4 v[40:43], v1, s[32:35], s14 offen sc1
    s_mov_b64 exec, -1
    s_waitcnt lgkmcnt(0)
    v_mfma_f32_32x32x16_bf16 v[112:127], v[28:31], v[44:47], 0
    v_mfma_f32_32x32x16_bf16 v[112:127], v[32:35], v[48:51], v[112:127]
    v_lshrrev_b32 v22, 3, v1
    v_lshlrev_b32 v22, 10, v22
    v_and_b32 v9, 7, v1
    v_lshl_add_u32 v22, v9, 4, v22
    v_and_b32 v76, 7, v1
    v_lshlrev_b32 v76, 4, v76
    v_lshrrev_b32 v9, 5, v1
    v_lshl_add_u32 v76, v9, 3, v76
    s_nop 3
    v_cvt_pk_bf16_f32 v112, 0, v112
    v_cvt_pk_bf16_f32 v113, 0, v113
    v_cvt_pk_bf16_f32 v114, 0, v114
    v_cvt_pk_bf16_f32 v115, 0, v115
    v_cvt_pk_bf16_f32 v116, 0, v116
    v_cvt_pk_bf16_f32 v117, 0, v117
    v_cvt_pk_bf16_f32 v118, 0, v118
    v_cvt_pk_bf16_f32 v119, 0, v119
    v_cvt_pk_bf16_f32 v120, 0, v120
    v_cvt_pk_bf16_f32 v121, 0, v121
    v_cvt_pk_bf16_f32 v122, 0, v122
    v_cvt_pk_bf16_f32 v123, 0, v123
    v_cvt_pk_bf16_f32 v124, 0, v124
    v_cvt_pk_bf16_f32 v125, 0, v125
    v_cvt_pk_bf16_f32 v126, 0, v126
    v_cvt_pk_bf16_f32 v127, 0, v127
    v_max3_f32 v52, v112, v113, v114
    v_min3_f32 v53, v112, v113, v114
    v_max3_f32 v52, v52, v115, v116
    v_min3_f32 v53, v53, v115, v116
    v_max3_f32 v52, v52, v117, v118
    v_min3_f32 v53, v53, v117, v118
    v_max3_f32 v52, v52, v119, v120
    v_min3_f32 v53, v53, v119, v120
    v_max3_f32 v52, v52, v121, v122
    v_min3_f32 v53, v53, v121, v122
    v_max3_f32 v52, v52, v123, v124
    v_min3_f32 v53, v53, v123, v124
    v_max3_f32 v52, v52, v125, v126
    v_min3_f32 v53, v53, v125, v126
    v_max_f32 v54, v52, v127
    v_min_f32 v55, v53, v127
    v_max_f32 v52, v52, v127
    v_min_f32 v53, v53, v127
    s_nop 0
    v_permlane32_swap_b32 v52, v54
    v_permlane32_swap_b32 v53, v55
    v_max_f32 v52, v52, v54
    v_min_f32 v53, v53, v55
    v_pk_mul_f32 v[52:53], v[52:53], s[6:7] op_sel:[0,1]
    v_pk_fma_f32 v[128:129], v[112:113], s[6:7], v[52:53] op_sel:[0,1,0] op_sel_hi:[1,1,0] neg_lo:[0,0,1] neg_hi:[0,0,1]
    v_pk_fma_f32 v[112:113], v[112:113], s[6:7], v[52:53] op_sel:[0,1,1] neg_lo:[1,0,0] neg_hi:[1,0,0]
    v_pk_fma_f32 v[130:131], v[114:115], s[6:7], v[52:53] op_sel:[0,1,0] op_sel_hi:[1,1,0] neg_lo:[0,0,1] neg_hi:[0,0,1]
    v_pk_fma_f32 v[114:115], v[114:115], s[6:7], v[52:53] op_sel:[0,1,1] neg_lo:[1,0,0] neg_hi:[1,0,0]
    v_pk_fma_f32 v[132:133], v[116:117], s[6:7], v[52:53] op_sel:[0,1,0] op_sel_hi:[1,1,0] neg_lo:[0,0,1] neg_hi:[0,0,1]
    v_pk_fma_f32 v[116:117], v[116:117], s[6:7], v[52:53] op_sel:[0,1,1] neg_lo:[1,0,0] neg_hi:[1,0,0]
    v_pk_fma_f32 v[134:135], v[118:119], s[6:7], v[52:53] op_sel:[0,1,0] op_sel_hi:[1,1,0] neg_lo:[0,0,1] neg_hi:[0,0,1]
    v_pk_fma_f32 v[118:119], v[118:119], s[6:7], v[52:53] op_sel:[0,1,1] neg_lo:[1,0,0] neg_hi:[1,0,0]
    v_pk_fma_f32 v[136:137], v[120:121], s[6:7], v[52:53] op_sel:[0,1,0] op_sel_hi:[1,1,0] neg_lo:[0,0,1] neg_hi:[0,0,1]
    v_pk_fma_f32 v[120:121], v[120:121], s[6:7], v[52:53] op_sel:[0,1,1] neg_lo:[1,0,0] neg_hi:[1,0,0]
    v_pk_fma_f32 v[138:139], v[122:123], s[6:7], v[52:53] op_sel:[0,1,0] op_sel_hi:[1,1,0] neg_lo:[0,0,1] neg_hi:[0,0,1]
    v_pk_fma_f32 v[122:123], v[122:123], s[6:7], v[52:53] op_sel:[0,1,1] neg_lo:[1,0,0] neg_hi:[1,0,0]
    v_pk_fma_f32 v[140:141], v[124:125], s[6:7], v[52:53] op_sel:[0,1,0] op_sel_hi:[1,1,0] neg_lo:[0,0,1] neg_hi:[0,0,1]
    v_pk_fma_f32 v[124:125], v[124:125], s[6:7], v[52:53] op_sel:[0,1,1] neg_lo:[1,0,0] neg_hi:[1,0,0]
    v_pk_fma_f32 v[142:143], v[126:127], s[6:7], v[52:53] op_sel:[0,1,0] op_sel_hi:[1,1,0] neg_lo:[0,0,1] neg_hi:[0,0,1]
    v_pk_fma_f32 v[126:127], v[126:127], s[6:7], v[52:53] op_sel:[0,1,1] neg_lo:[1,0,0] neg_hi:[1,0,0]
    v_exp_f32 v128, v128
    v_exp_f32 v112, v112
    v_exp_f32 v129, v129
    s_lshl_b32 s96, s11, 7
    s_add_u32 s18, s96, 32768
    s_lshl3_add_u32 s14, s10, s18
    v_and_b32 v23, 15, v1
    v_lshlrev_b32 v23, 3, v23
    s_waitcnt vmcnt(0)
    s_barrier
    s_cmp_lg_u32 s3, 0
    s_cbranch_scc1 L_PC
    v_mov_b32 v21, s4
    s_mov_b32 exec_hi, 0
    s_mov_b32 exec_lo, 65535
    buffer_store_dword v21, v75, s[32:35], s17 offen sc1
    s_mov_b64 exec, -1
L_PC:
    buffer_load_dword v67, v3, s[32:35], 0 offen offset:256 sc1
    s_lshl4_add_u32 s96, s11, s10
    s_lshl_b32 s97, s96, 14
    s_lshl_b32 s98, s3, 7
    s_add_u32 s99, s97, s98
    s_add_u32 s13, s99, 25165824
    s_lshl4_add_u32 s96, s11, s10
    s_lshl_b32 s97, s96, 10
    s_lshl_b32 s98, s3, 7
    s_add_u32 s99, s97, s98
    s_add_u32 s15, s99, 29360128
    s_add_u32 s17, s17, 3072
    s_load_dwordx2 s[24:25], s[32:33], s92 offset:512 glc
    s_add_u32 s96, s84, 262144
    s_and_b32 s97, s96, 1048575
    s_lshl_b32 s98, s83, 16
    s_xor_b32 s99, s97, s98
    s_add_u32 s19, s99, s88
    s_add_u32 m0, s89, 49152
    s_nop 0
    buffer_load_dwordx4 v74, s[44:47], s19 offen lds
    v_exp_f32 v113, v113
    v_exp_f32 v130, v130
    v_exp_f32 v114, v114
    v_exp_f32 v131, v131
    v_exp_f32 v115, v115
    v_exp_f32 v132, v132
    v_exp_f32 v116, v116
    v_exp_f32 v133, v133
    v_exp_f32 v117, v117
    v_exp_f32 v134, v134
    s_add_u32 s96, s84, 393216
    s_and_b32 s97, s96, 1048575
    s_lshl_b32 s98, s83, 16
    s_xor_b32 s99, s97, s98
    s_add_u32 s19, s99, s88
    s_add_u32 m0, s89, 57344
    s_nop 0
    buffer_load_dwordx4 v74, s[44:47], s19 offen lds
    v_exp_f32 v118, v118
    v_exp_f32 v135, v135
    v_exp_f32 v119, v119
    v_exp_f32 v136, v136
    v_exp_f32 v120, v120
    v_exp_f32 v137, v137
    v_exp_f32 v121, v121
    v_exp_f32 v138, v138
    v_exp_f32 v122, v122
    s_add_u32 s96, s84, 524288
    s_and_b32 s97, s96, 1048575
    s_lshl_b32 s98, s83, 16
    s_xor_b32 s99, s97, s98
    s_add_u32 s19, s99, s88
    s_add_u32 m0, s89, 65536
    s_nop 0
    buffer_load_dwordx4 v74, s[44:47], s19 offen lds
    v_exp_f32 v139, v139
    v_exp_f32 v123, v123
    v_exp_f32 v140, v140
    v_exp_f32 v124, v124
    v_exp_f32 v141, v141
    v_exp_f32 v125, v125
    v_exp_f32 v142, v142
    v_exp_f32 v126, v126
    v_exp_f32 v143, v143
    v_exp_f32 v127, v127
    s_add_u32 s96, s84, 655360
    s_and_b32 s97, s96, 1048575
    s_lshl_b32 s98, s83, 16
    s_xor_b32 s99, s97, s98
    s_add_u32 s19, s99, s88
    s_add_u32 m0, s89, 73728
    s_nop 0
    buffer_load_dwordx4 v74, s[44:47], s19 offen lds
    v_pk_add_f32 v[56:57], v[128:129], v[130:131]
    v_pk_add_f32 v[58:59], v[112:113], v[114:115]
    v_pk_add_f32 v[56:57], v[56:57], v[132:133]
    v_pk_add_f32 v[58:59], v[58:59], v[116:117]
    v_pk_add_f32 v[56:57], v[56:57], v[134:135]
    v_pk_add_f32 v[58:59], v[58:59], v[118:119]
    v_pk_add_f32 v[56:57], v[56:57], v[136:137]
    v_pk_add_f32 v[58:59], v[58:59], v[120:121]
    v_pk_add_f32 v[56:57], v[56:57], v[138:139]
    s_add_u32 s96, s84, 786432
    s_and_b32 s97, s96, 1048575
    s_lshl_b32 s98, s83, 16
    s_xor_b32 s99, s97, s98
    s_add_u32 s19, s99, s88
    s_add_u32 m0, s89, 81920
    s_nop 0
    buffer_load_dwordx4 v74, s[44:47], s19 offen lds
    v_pk_add_f32 v[58:59], v[58:59], v[122:123]
    v_pk_add_f32 v[56:57], v[56:57], v[140:141]
    v_pk_add_f32 v[58:59], v[58:59], v[124:125]
    v_pk_add_f32 v[56:57], v[56:57], v[142:143]
    v_pk_add_f32 v[58:59], v[58:59], v[126:127]
    v_add_f32 v54, v56, v57
    v_add_f32 v55, v58, v59
    v_add_f32 v52, v56, v57
    v_add_f32 v53, v58, v59
    s_nop 0
    v_permlane32_swap_b32 v52, v54
    s_add_u32 s96, s84, 917504
    s_and_b32 s97, s96, 1048575
    s_lshl_b32 s98, s83, 16
    s_xor_b32 s99, s97, s98
    s_add_u32 s19, s99, s88
    s_add_u32 m0, s89, 90112
    s_nop 0
    buffer_load_dwordx4 v74, s[44:47], s19 offen lds
    v_permlane32_swap_b32 v53, v55
    v_pk_add_f32 v[52:53], v[52:53], v[54:55]
    v_rcp_f32 v52, v52
    v_rcp_f32 v53, v53
    s_nop 0
    v_pk_mul_f32 v[128:129], v[128:129], v[52:53] op_sel_hi:[1,0]
    v_pk_mul_f32 v[112:113], v[112:113], v[52:53] op_sel:[0,1]
    v_pk_mul_f32 v[130:131], v[130:131], v[52:53] op_sel_hi:[1,0]
    v_pk_mul_f32 v[114:115], v[114:115], v[52:53] op_sel:[0,1]
    v_pk_mul_f32 v[132:133], v[132:133], v[52:53] op_sel_hi:[1,0]
    s_branch SCHK_18
SPOLL_17:
    s_load_dwordx2 s[24:25], s[32:33], s92 offset:512 glc
SCHK_18:
    s_add_u32 s5, s5, 1
    s_cmp_ge_u32 s5, 300000
    s_waitcnt lgkmcnt(0)
    s_cbranch_scc1 SDONE_19
    s_cmp_lg_u32 s24, s4
    s_cbranch_scc1 SPOLL_17
    s_cmp_lg_u32 s25, s4
    s_cbranch_scc1 SPOLL_17
SDONE_19:
    s_barrier
    s_add_u32 s18, s13, 8192
    buffer_load_dwordx4 v[144:147], v22, s[32:35], s13 offen sc1
    buffer_load_dwordx4 v[148:151], v22, s[32:35], s18 offen sc1
    buffer_load_dwordx4 v[160:163], v2, s[32:35], s16 offen sc1
    s_lshl_b32 s96, s3, 5
    s_add_u32 s14, s96, 8192
    v_and_b32 v6, 3, v1
    v_lshl_add_u32 v6, v6, 3, s14
    v_lshrrev_b32 v9, 5, v1
    v_lshl_add_u32 v6, v9, 2, v6
    s_lshl_b32 s14, s3, 10
    v_and_b32 v5, 15, v1
    v_lshl_add_u32 v5, v5, 4, s14
    v_lshrrev_b32 v9, 5, v1
    v_lshl_add_u32 v5, v9, 9, v5
    v_bfe_u32 v9, v1, 4, 1
    v_lshl_add_u32 v5, v9, 3, v5
    s_lshl_b32 s96, s76, 7
    s_add_u32 s14, s96, 8192
    v_lshrrev_b32 v7, 5, v1
    v_lshl_add_u32 v7, v7, 4, s14
    s_lshl_b32 s14, s76, 12
    v_add_u32 v20, s14, v2
    v_pk_mul_f32 v[116:117], v[116:117], v[52:53] op_sel:[0,1]
    v_pk_mul_f32 v[134:135], v[134:135], v[52:53] op_sel_hi:[1,0]
    v_pk_mul_f32 v[118:119], v[118:119], v[52:53] op_sel:[0,1]
    v_pk_mul_f32 v[136:137], v[136:137], v[52:53] op_sel_hi:[1,0]
    v_pk_mul_f32 v[120:121], v[120:121], v[52:53] op_sel:[0,1]
    v_pk_mul_f32 v[138:139], v[138:139], v[52:53] op_sel_hi:[1,0]
    v_pk_mul_f32 v[122:123], v[122:123], v[52:53] op_sel:[0,1]
    v_pk_mul_f32 v[140:141], v[140:141], v[52:53] op_sel_hi:[1,0]
    v_pk_mul_f32 v[124:125], v[124:125], v[52:53] op_sel:[0,1]
    v_pk_mul_f32 v[142:143], v[142:143], v[52:53] op_sel_hi:[1,0]
    v_pk_mul_f32 v[126:127], v[126:127], v[52:53] op_sel:[0,1]
    v_cvt_pk_bf16_f32 v80, v128, v129
    v_cvt_pk_bf16_f32 v88, v112, v113
    v_cvt_pk_bf16_f32 v81, v130, v131
    v_cvt_pk_bf16_f32 v89, v114, v115
    v_cvt_pk_bf16_f32 v82, v132, v133
    v_cvt_pk_bf16_f32 v90, v116, v117
    v_cvt_pk_bf16_f32 v83, v134, v135
    v_cvt_pk_bf16_f32 v91, v118, v119
    v_cvt_pk_bf16_f32 v84, v136, v137
    v_cvt_pk_bf16_f32 v92, v120, v121
    v_cvt_pk_bf16_f32 v85, v138, v139
    v_cvt_pk_bf16_f32 v93, v122, v123
    v_cvt_pk_bf16_f32 v86, v140, v141
    v_cvt_pk_bf16_f32 v94, v124, v125
    v_cvt_pk_bf16_f32 v87, v142, v143
    v_cvt_pk_bf16_f32 v95, v126, v127
    s_waitcnt vmcnt(1)
    v_cmp_eq_u32 vcc, s4, v67
    s_nop 0
    s_cmp_eq_u32 vcc_lo, 0
    s_cselect_b32 s93, 1, 0
    v_pk_add_f32 v[144:145], v[144:145], v[148:149]
    v_pk_add_f32 v[146:147], v[146:147], v[150:151]
    s_nop 1
    v_permlane32_swap_b32 v144, v146
    v_permlane32_swap_b32 v145, v147
    v_pk_add_f32 v[144:145], v[144:145], v[146:147]
    s_nop 1
    v_add_f32_dpp v144, v144, v144 row_ror:8 row_mask:0xf bank_mask:0xf
    v_add_f32_dpp v145, v145, v145 row_ror:8 row_mask:0xf bank_mask:0xf
    v_mov_b32 v146, v144
    v_mov_b32 v147, v145
    s_nop 0
    v_permlane16_swap_b32 v144, v146
    v_permlane16_swap_b32 v145, v147
    v_pk_add_f32 v[144:145], v[144:145], v[146:147]
    v_cvt_pk_bf16_f32 v144, v144, v145
    v_mov_b32 v145, s4
    s_mov_b32 exec_lo, 0xff
    s_mov_b32 exec_hi, 0xff
    s_cmp_lg_u32 s93, 0
    s_cbranch_scc1 LOC_20
    buffer_store_dwordx2 v[144:145], v76, s[32:35], s15 offen sc1
    s_branch LOCD_21
LOC_20:
    buffer_store_dwordx2 v[144:145], v76, s[32:35], s15 offen
LOCD_21:
    s_mov_b64 exec, -1
    v_mov_b32 v224, v144
    v_mov_b32 v225, v145
    v_add_u32 v226, s15, v76
    s_cbranch_scc1 L_PC2
    s_barrier
    s_cmp_lg_u32 s3, 0
    s_cbranch_scc1 L_PC2
    v_mov_b32 v21, s4
    s_mov_b32 exec_hi, 0
    s_mov_b32 exec_lo, 65535
    buffer_store_dword v21, v75, s[32:35], s17 offen sc1
    s_mov_b64 exec, -1
L_PC2:
    s_lshl3_add_u32 s96, s11, s3
    s_lshl_b32 s97, s96, 11
    s_add_u32 s13, s97, 29360128
    s_waitcnt vmcnt(0)
    v_permlane32_swap_b32 v160, v162
    v_permlane32_swap_b32 v161, v163
    v_pk_add_f32 v[160:161], v[160:161], v[162:163]
    s_nop 1
    v_add_f32_dpp v160, v160, v160 row_ror:4 row_mask:0xf bank_mask:0xf
    v_add_f32_dpp v161, v161, v161 row_ror:4 row_mask:0xf bank_mask:0xf
    s_nop 0
    v_add_f32_dpp v160, v160, v160 row_ror:8 row_mask:0xf bank_mask:0xf
    v_add_f32_dpp v161, v161, v161 row_ror:8 row_mask:0xf bank_mask:0xf
    v_mov_b32 v162, v160
    v_mov_b32 v163, v161
    s_nop 0
    v_permlane16_swap_b32 v160, v162
    v_permlane16_swap_b32 v161, v163
    v_pk_add_f32 v[160:161], v[160:161], v[162:163]
    v_cvt_pk_bf16_f32 v160, v160, v161
    ds_write_b32 v6, v160
    s_cmp_lg_u32 s93, 0
    s_cbranch_scc1 L_C2L
SPOLL_22:
    s_load_dwordx2 s[24:25], s[32:33], s92 offset:3584 glc
SCHK_23:
    s_add_u32 s5, s5, 1
    s_cmp_ge_u32 s5, 300000
    s_waitcnt lgkmcnt(0)
    s_cbranch_scc1 SDONE_24
    s_cmp_lg_u32 s24, s4
    s_cbranch_scc1 SPOLL_22
    s_cmp_lg_u32 s25, s4
    s_cbranch_scc1 SPOLL_22
SDONE_24:
L_C2L:
    buffer_load_dwordx4 v[152:155], v2, s[32:35], s13 offen sc1
    buffer_load_dwordx4 v[156:159], v2, s[32:35], s13 offen offset:1024 sc1
    s_waitcnt vmcnt(0)
    v_bitop3_b32 v4, v153, v155, s4 bitop3:0x7e
    v_bitop3_b32 v4, v4, v157, s4 bitop3:0xf6
    v_bitop3_b32 v4, v4, v159, s4 bitop3:0xf6
    v_cmp_ne_u32 vcc, 0, v4
    s_cbranch_vccz TOK_26
POLL_27:
    buffer_load_dwordx4 v[152:155], v2, s[32:35], s13 offen sc1
    buffer_load_dwordx4 v[156:159], v2, s[32:35], s13 offen offset:1024 sc1
    s_waitcnt vmcnt(0)
    v_bitop3_b32 v4, v153, v155, s4 bitop3:0x7e
    v_bitop3_b32 v4, v4, v157, s4 bitop3:0xf6
    v_bitop3_b32 v4, v4, v159, s4 bitop3:0xf6
    v_cmp_ne_u32 vcc, 0, v4
    s_cbranch_vccz PDONE_28
    s_add_u32 s5, s5, 1
    s_cmp_lt_u32 s5, 300000
    s_cbranch_scc1 POLL_27
PDONE_28:
TOK_26:
    ds_write2_b32 v5, v152, v154 offset0:0 offset1:1
    ds_write2_b32 v5, v156, v158 offset0:64 offset1:65
    s_waitcnt lgkmcnt(0)
    s_barrier
    ds_read_b128 v[160:163], v7
    ds_read_b128 v[164:167], v7 offset:32
    ds_read_b128 v[168:171], v7 offset:64
    ds_read_b128 v[172:175], v7 offset:96
    ds_read_b128 v[144:147], v20
    ds_read_b128 v[148:151], v20 offset:1024
    ds_read_b128 v[152:155], v20 offset:2048
    ds_read_b128 v[156:159], v20 offset:3072
    s_add_u32 s96, s84, 1048576
    s_and_b32 s97, s96, 1048575
    s_lshl_b32 s98, s83, 16
    s_xor_b32 s99, s97, s98
    s_xor_b32 s96, s88, 1048576
    s_add_u32 s19, s99, s96
    s_add_u32 m0, s89, 98304
    s_nop 0
    buffer_load_dwordx4 v74, s[44:47], s19 offen lds
    s_add_u32 s96, s84, 1703936
    s_and_b32 s97, s96, 1048575
    s_lshl_b32 s98, s83, 16
    s_xor_b32 s99, s97, s98
    s_xor_b32 s96, s88, 1048576
    s_add_u32 s19, s99, s96
    s_add_u32 m0, s89, 139264
    s_nop 0
    buffer_load_dwordx4 v74, s[44:47], s19 offen lds
    s_add_u32 s96, s84, 1835008
    s_and_b32 s97, s96, 1048575
    s_lshl_b32 s98, s83, 16
    s_xor_b32 s99, s97, s98
    s_xor_b32 s96, s88, 1048576
    s_add_u32 s19, s99, s96
    s_add_u32 m0, s89, 147456
    s_nop 0
    buffer_load_dwordx4 v74, s[44:47], s19 offen lds
    s_and_b32 s96, s3, 3
    s_lshl2_add_u32 s97, s10, s96
    s_lshl4_add_u32 s98, s97, s11
    s_lshl1_add_u32 s99, s98, s76
    s_lshl_b32 s96, s99, 11
    s_add_u32 s13, s96, 8388608
    v_and_b32 v8, 15, v1
    v_lshlrev_b32 v8, 4, v8
    v_bfe_u32 v9, v1, 4, 1
    v_lshl_add_u32 v8, v9, 10, v8
    v_lshrrev_b32 v9, 5, v1
    v_lshl_add_u32 v8, v9, 8, v8
    s_waitcnt lgkmcnt(7)
    v_mfma_f32_32x32x16_bf16 v[128:143], v[160:163], v[80:83], 0
    s_waitcnt lgkmcnt(6)
    v_mfma_f32_32x32x16_bf16 v[128:143], v[164:167], v[84:87], v[128:143]
    s_waitcnt lgkmcnt(5)
    v_mfma_f32_32x32x16_bf16 v[128:143], v[168:171], v[88:91], v[128:143]
    s_waitcnt lgkmcnt(4)
    v_mfma_f32_32x32x16_bf16 v[128:143], v[172:175], v[92:95], v[128:143]
    s_waitcnt lgkmcnt(3)
    v_mfma_f32_32x32x16_bf16 v[112:127], v[144:147], v[80:83], 0
    s_waitcnt lgkmcnt(2)
    v_mfma_f32_32x32x16_bf16 v[112:127], v[148:151], v[84:87], v[112:127]
    s_waitcnt lgkmcnt(1)
    v_mfma_f32_32x32x16_bf16 v[112:127], v[152:155], v[88:91], v[112:127]
    s_waitcnt lgkmcnt(0)
    v_mfma_f32_32x32x16_bf16 v[112:127], v[156:159], v[92:95], v[112:127]
    s_nop 3
    v_cvt_pk_bf16_f32 v128, 0, v128
    v_add_f32 v128, 0x358637bd, v128
    v_cvt_pk_bf16_f32 v128, 0, v128
    v_rcp_f32 v128, v128
    s_nop 3
    v_cvt_pk_bf16_f32 v112, 0, v112
    v_cvt_pk_bf16_f32 v113, 0, v113
    v_cvt_pk_bf16_f32 v114, 0, v114
    v_cvt_pk_bf16_f32 v115, 0, v115
    v_cvt_pk_bf16_f32 v116, 0, v116
    v_cvt_pk_bf16_f32 v117, 0, v117
    v_cvt_pk_bf16_f32 v118, 0, v118
    v_cvt_pk_bf16_f32 v119, 0, v119
    v_pk_mul_f32 v[112:113], v[112:113], v[128:129] op_sel_hi:[1,0]
    v_pk_mul_f32 v[114:115], v[114:115], v[128:129] op_sel_hi:[1,0]
    v_pk_mul_f32 v[116:117], v[116:117], v[128:129] op_sel_hi:[1,0]
    v_pk_mul_f32 v[118:119], v[118:119], v[128:129] op_sel_hi:[1,0]
    v_cvt_pk_bf16_f32 v44, v112, v113
    v_cvt_pk_bf16_f32 v45, v114, v115
    v_cvt_pk_bf16_f32 v46, v116, v117
    v_cvt_pk_bf16_f32 v47, v118, v119
    buffer_store_dwordx4 v[44:47], v8, s[32:35], s13 offen sc1
    v_cvt_pk_bf16_f32 v120, 0, v120
    v_cvt_pk_bf16_f32 v121, 0, v121
    v_cvt_pk_bf16_f32 v122, 0, v122
    v_cvt_pk_bf16_f32 v123, 0, v123
    v_cvt_pk_bf16_f32 v124, 0, v124
    v_cvt_pk_bf16_f32 v125, 0, v125
    v_cvt_pk_bf16_f32 v126, 0, v126
    v_cvt_pk_bf16_f32 v127, 0, v127
    v_pk_mul_f32 v[120:121], v[120:121], v[128:129] op_sel_hi:[1,0]
    v_pk_mul_f32 v[122:123], v[122:123], v[128:129] op_sel_hi:[1,0]
    v_pk_mul_f32 v[124:125], v[124:125], v[128:129] op_sel_hi:[1,0]
    v_pk_mul_f32 v[126:127], v[126:127], v[128:129] op_sel_hi:[1,0]
    v_cvt_pk_bf16_f32 v48, v120, v121
    v_cvt_pk_bf16_f32 v49, v122, v123
    v_cvt_pk_bf16_f32 v50, v124, v125
    v_cvt_pk_bf16_f32 v51, v126, v127
    buffer_store_dwordx4 v[48:51], v8, s[32:35], s13 offen offset:512 sc1
    s_mul_i32 s96, s76, 65600
    s_add_u32 s17, s96, 32768
    v_lshrrev_b32 v20, 5, v1
    v_lshlrev_b32 v20, 11, v20
    v_bfe_u32 v9, v1, 4, 1
    v_lshl_add_u32 v20, v9, 9, v20
    v_bfe_u32 v9, v1, 2, 2
    v_lshl_add_u32 v20, v9, 7, v20
    v_bfe_u32 v9, v1, 3, 1
    v_lshl_add_u32 v20, v9, 6, v20
    v_bfe_u32 v9, v1, 1, 1
    v_lshl_add_u32 v20, v9, 5, v20
    v_bfe_u32 v9, v1, 4, 1
    v_lshl_add_u32 v20, v9, 4, v20
    v_and_b32 v9, 1, v1
    v_lshl_add_u32 v20, v9, 3, v20
    v_xor_b32 v20, s17, v20
    v_xor_b32 v21, 16, v20
    v_xor_b32 v22, 64, v20
    v_xor_b32 v23, 80, v20
    v_and_b32 v5, 7, v1
    v_lshlrev_b32 v5, 15, v5
    v_bfe_u32 v9, v1, 3, 1
    v_lshl_add_u32 v5, v9, 12, v5
    s_lshr_b32 s96, s11, 2
    s_xor_b32 s97, s96, 1
    s_and_b32 s98, s97, 1
    s_lshr_b32 s99, s10, 2
    s_and_b32 s96, s10, 3
    s_lshl_b32 s97, s96, 6
    s_lshl1_add_u32 s96, s99, s97
    s_lshl_b32 s99, s96, 12
    s_lshr_b32 s97, s11, 3
    s_and_b32 s96, s11, 3
    s_lshl2_add_u32 s97, s97, s96
    s_lshl_b32 s96, s97, 6
    s_add_u32 s97, s99, s96
    s_lshl2_add_u32 s99, s98, s97
    s_add_u32 s96, s99, 1048576
    s_add_u32 s15, s96, 1024
    v_mov_b32 v52, 0x10000
    v_mov_b32 v53, s6
    v_lshlrev_b32 v28, 16, v12
    v_and_b32 v29, s6, v12
    v_lshlrev_b32 v30, 16, v13
    v_and_b32 v31, s6, v13
    v_lshlrev_b32 v32, 16, v14
    v_and_b32 v33, s6, v14
    v_lshlrev_b32 v34, 16, v15
    v_and_b32 v35, s6, v15
    v_lshlrev_b32 v36, 16, v16
    v_and_b32 v37, s6, v16
    v_lshlrev_b32 v38, 16, v17
    v_and_b32 v39, s6, v17
    v_lshlrev_b32 v40, 16, v18
    v_and_b32 v41, s6, v18
    v_lshlrev_b32 v42, 16, v19
    v_and_b32 v43, s6, v19
    v_mul_u32_u24_dpp v76, v64, v52 row_newbcast:0 row_mask:0xf bank_mask:0xf
    v_and_b32_dpp v77, v64, v53 row_newbcast:0 row_mask:0xf bank_mask:0xf
    v_mul_u32_u24_dpp v78, v64, v52 row_newbcast:1 row_mask:0xf bank_mask:0xf
    v_and_b32_dpp v79, v64, v53 row_newbcast:1 row_mask:0xf bank_mask:0xf
    v_mul_u32_u24_dpp v80, v64, v52 row_newbcast:2 row_mask:0xf bank_mask:0xf
    v_and_b32_dpp v81, v64, v53 row_newbcast:2 row_mask:0xf bank_mask:0xf
    v_mul_u32_u24_dpp v82, v64, v52 row_newbcast:3 row_mask:0xf bank_mask:0xf
    v_and_b32_dpp v83, v64, v53 row_newbcast:3 row_mask:0xf bank_mask:0xf
    v_mul_u32_u24_dpp v84, v64, v52 row_newbcast:4 row_mask:0xf bank_mask:0xf
    v_and_b32_dpp v85, v64, v53 row_newbcast:4 row_mask:0xf bank_mask:0xf
    v_mul_u32_u24_dpp v86, v64, v52 row_newbcast:5 row_mask:0xf bank_mask:0xf
    v_and_b32_dpp v87, v64, v53 row_newbcast:5 row_mask:0xf bank_mask:0xf
    v_mul_u32_u24_dpp v88, v64, v52 row_newbcast:6 row_mask:0xf bank_mask:0xf
    v_and_b32_dpp v89, v64, v53 row_newbcast:6 row_mask:0xf bank_mask:0xf
    v_mul_u32_u24_dpp v90, v64, v52 row_newbcast:7 row_mask:0xf bank_mask:0xf
    v_and_b32_dpp v91, v64, v53 row_newbcast:7 row_mask:0xf bank_mask:0xf
    s_lshl1_add_u32 s96, s94, s77
    s_lshl_b32 s97, s96, 15
    s_add_u32 s19, s97, 8388608
    v_and_b32 v25, 15, v1
    v_lshlrev_b32 v25, 3, v25
    s_waitcnt vmcnt(0)
    s_waitcnt lgkmcnt(0)
    s_barrier
    s_cmp_lg_u32 s3, 0
    s_cbranch_scc1 L_PD
    v_mov_b32 v6, s4
    s_mov_b32 exec_hi, 0
    s_mov_b32 exec_lo, 65535
    buffer_store_dword v6, v5, s[32:35], s15 offen sc1
    s_mov_b64 exec, -1
L_PD:
    s_add_u32 s96, s84, 1966080
    s_and_b32 s97, s96, 1048575
    s_lshl_b32 s98, s83, 16
    s_xor_b32 s99, s97, s98
    s_xor_b32 s96, s88, 1048576
    s_add_u32 s13, s99, s96
    s_add_u32 m0, s89, 155648
    s_nop 0
    buffer_load_dwordx4 v74, s[44:47], s13 offen lds
    s_and_b32 s96, s84, 1048575
    s_lshl_b32 s97, s83, 16
    s_xor_b32 s98, s96, s97
    s_add_u32 s13, s98, s88
    s_add_u32 m0, s89, 32768
    s_nop 0
    buffer_load_dwordx4 v74, s[44:47], s13 offen lds
    s_add_u32 s96, s84, 131072
    s_and_b32 s97, s96, 1048575
    s_lshl_b32 s98, s83, 16
    s_xor_b32 s99, s97, s98
    s_add_u32 s13, s99, s88
    s_add_u32 m0, s89, 40960
    s_nop 0
    buffer_load_dwordx4 v74, s[44:47], s13 offen lds
    s_load_dwordx2 s[24:25], s[32:33], s92 offset:1024 glc
    v_mov_b32_dpp v92, v65 row_newbcast:0 row_mask:0xf bank_mask:0xf
    v_mov_b32_dpp v93, v65 row_newbcast:1 row_mask:0xf bank_mask:0xf
    v_mov_b32_dpp v94, v65 row_newbcast:2 row_mask:0xf bank_mask:0xf
    v_mov_b32_dpp v95, v65 row_newbcast:3 row_mask:0xf bank_mask:0xf
    v_mov_b32_dpp v96, v65 row_newbcast:4 row_mask:0xf bank_mask:0xf
    v_mov_b32_dpp v97, v65 row_newbcast:5 row_mask:0xf bank_mask:0xf
    v_mov_b32_dpp v98, v65 row_newbcast:6 row_mask:0xf bank_mask:0xf
    v_mov_b32_dpp v99, v65 row_newbcast:7 row_mask:0xf bank_mask:0xf
    v_mov_b32_dpp v100, v66 row_newbcast:0 row_mask:0xf bank_mask:0xf
    v_mov_b32_dpp v101, v66 row_newbcast:1 row_mask:0xf bank_mask:0xf
    v_mov_b32_dpp v102, v66 row_newbcast:2 row_mask:0xf bank_mask:0xf
    v_mov_b32_dpp v103, v66 row_newbcast:3 row_mask:0xf bank_mask:0xf
    v_mov_b32_dpp v104, v66 row_newbcast:4 row_mask:0xf bank_mask:0xf
    v_mov_b32_dpp v105, v66 row_newbcast:5 row_mask:0xf bank_mask:0xf
    v_mov_b32_dpp v106, v66 row_newbcast:6 row_mask:0xf bank_mask:0xf
    v_mov_b32_dpp v107, v66 row_newbcast:7 row_mask:0xf bank_mask:0xf
    v_and_b32 v4, 3, v1
    v_cmp_eq_u32 vcc, 1, v4
    v_cmp_eq_u32 s[22:23], 0, v4
    v_mov_b32 v5, 0x3f803f80
    v_cndmask_b32 v92, v100, v92, vcc
    v_cndmask_b32 v93, v101, v93, vcc
    v_cndmask_b32 v94, v102, v94, vcc
    v_cndmask_b32 v95, v103, v95, vcc
    v_cndmask_b32 v96, v104, v96, vcc
    v_cndmask_b32 v97, v105, v97, vcc
    v_cndmask_b32 v98, v106, v98, vcc
    v_cndmask_b32 v99, v107, v99, vcc
    v_cndmask_b32 v92, v92, v5, s[22:23]
    v_cndmask_b32 v93, v93, v5, s[22:23]
    v_cndmask_b32 v94, v94, v5, s[22:23]
    v_cndmask_b32 v95, v95, v5, s[22:23]
    v_cndmask_b32 v96, v96, v5, s[22:23]
    v_cndmask_b32 v97, v97, v5, s[22:23]
    v_cndmask_b32 v98, v98, v5, s[22:23]
    v_cndmask_b32 v99, v99, v5, s[22:23]
    s_waitcnt vmcnt(0)
    s_branch SCHK_30
SPOLL_29:
    s_load_dwordx2 s[24:25], s[32:33], s92 offset:1024 glc
SCHK_30:
    s_add_u32 s5, s5, 1
    s_cmp_ge_u32 s5, 300000
    s_waitcnt lgkmcnt(0)
    s_cbranch_scc1 SDONE_31
    s_cmp_lg_u32 s24, s4
    s_cbranch_scc1 SPOLL_29
SDONE_31:
    s_barrier
    s_cmp_lt_u32 s3, 4
    s_cbranch_scc1 L_P2
    s_setprio 1
L_P2:
    s_lshl_b32 s96, s21, 7
    s_add_u32 s18, s96, 65536
    s_lshl_b32 s96, s83, 11
    s_add_u32 s20, s96, s19
    buffer_load_dwordx4 v[140:143], v2, s[32:35], s20 offen sc1
    buffer_load_dwordx4 v[144:147], v2, s[32:35], s20 offen offset:1024 sc1
    ds_read_b64_tr_b16 v[228:229], v22
    ds_read_b64_tr_b16 v[230:231], v22 offset:1024
    ds_read_b64_tr_b16 v[232:233], v23
    ds_read_b64_tr_b16 v[234:235], v23 offset:1024
    ds_read_b64_tr_b16 v[236:237], v20
    ds_read_b64_tr_b16 v[238:239], v20 offset:1024
    ds_read_b64_tr_b16 v[240:241], v21
    ds_read_b64_tr_b16 v[242:243], v21 offset:1024
    s_xor_b32 s96, s83, 1
    s_lshl_b32 s97, s96, 11
    s_add_u32 s20, s97, s19
    buffer_load_dwordx4 v[148:151], v2, s[32:35], s20 offen sc1
    buffer_load_dwordx4 v[152:155], v2, s[32:35], s20 offen offset:1024 sc1
    s_xor_b32 s96, s83, 2
    s_lshl_b32 s97, s96, 11
    s_add_u32 s20, s97, s19
    buffer_load_dwordx4 v[156:159], v2, s[32:35], s20 offen sc1
    buffer_load_dwordx4 v[160:163], v2, s[32:35], s20 offen offset:1024 sc1
    s_waitcnt lgkmcnt(6)
    s_waitcnt vmcnt(5)
    v_mfma_f32_16x16x32_bf16 v[124:127], v[228:231], v[140:143], 0
    ds_read_b64_tr_b16 v[244:245], v22 offset:4096
    s_waitcnt vmcnt(4)
    v_mfma_f32_16x16x32_bf16 v[128:131], v[228:231], v[144:147], 0
    ds_read_b64_tr_b16 v[246:247], v22 offset:5120
    s_xor_b32 s96, s83, 3
    s_lshl_b32 s97, s96, 11
    s_add_u32 s20, s97, s19
    buffer_load_dwordx4 v[164:167], v2, s[32:35], s20 offen sc1
    s_waitcnt lgkmcnt(6)
    v_mfma_f32_16x16x32_bf16 v[132:135], v[232:235], v[140:143], 0
    ds_read_b64_tr_b16 v[228:229], v23 offset:4096
    v_mfma_f32_16x16x32_bf16 v[136:139], v[232:235], v[144:147], 0
    ds_read_b64_tr_b16 v[230:231], v23 offset:5120
    buffer_load_dwordx4 v[168:171], v2, s[32:35], s20 offen offset:1024 sc1
    s_waitcnt lgkmcnt(6)
    v_mfma_f32_16x16x32_bf16 v[108:111], v[236:239], v[140:143], 0
    ds_read_b64_tr_b16 v[232:233], v20 offset:4096
    v_mfma_f32_16x16x32_bf16 v[112:115], v[236:239], v[144:147], 0
    ds_read_b64_tr_b16 v[234:235], v20 offset:5120
    s_waitcnt lgkmcnt(6)
    v_mfma_f32_16x16x32_bf16 v[116:119], v[240:243], v[140:143], 0
    ds_read_b64_tr_b16 v[236:237], v21 offset:4096
    v_mfma_f32_16x16x32_bf16 v[120:123], v[240:243], v[144:147], 0
    ds_read_b64_tr_b16 v[238:239], v21 offset:5120
    s_waitcnt lgkmcnt(6)
    s_waitcnt vmcnt(4)
    v_mfma_f32_16x16x32_bf16 v[124:127], v[244:247], v[148:151], v[124:127]
    ds_read_b64_tr_b16 v[240:241], v22 offset:8192
    v_mfma_f32_16x16x32_bf16 v[128:131], v[244:247], v[152:155], v[128:131]
    ds_read_b64_tr_b16 v[242:243], v22 offset:9216
    s_xor_b32 s96, s83, 4
    s_lshl_b32 s97, s96, 11
    s_add_u32 s20, s97, s19
    buffer_load_dwordx4 v[140:143], v2, s[32:35], s20 offen sc1
    s_waitcnt lgkmcnt(6)
    v_mfma_f32_16x16x32_bf16 v[132:135], v[228:231], v[148:151], v[132:135]
    ds_read_b64_tr_b16 v[244:245], v23 offset:8192
    v_mfma_f32_16x16x32_bf16 v[136:139], v[228:231], v[152:155], v[136:139]
    ds_read_b64_tr_b16 v[246:247], v23 offset:9216
    buffer_load_dwordx4 v[144:147], v2, s[32:35], s20 offen offset:1024 sc1
    s_waitcnt lgkmcnt(6)
    v_mfma_f32_16x16x32_bf16 v[108:111], v[232:235], v[148:151], v[108:111]
    ds_read_b64_tr_b16 v[228:229], v20 offset:8192
    v_mfma_f32_16x16x32_bf16 v[112:115], v[232:235], v[152:155], v[112:115]
    ds_read_b64_tr_b16 v[230:231], v20 offset:9216
    s_waitcnt lgkmcnt(6)
    v_mfma_f32_16x16x32_bf16 v[116:119], v[236:239], v[148:151], v[116:119]
    ds_read_b64_tr_b16 v[232:233], v21 offset:8192
    v_mfma_f32_16x16x32_bf16 v[120:123], v[236:239], v[152:155], v[120:123]
    ds_read_b64_tr_b16 v[234:235], v21 offset:9216
    s_waitcnt lgkmcnt(6)
    s_waitcnt vmcnt(4)
    v_mfma_f32_16x16x32_bf16 v[124:127], v[240:243], v[156:159], v[124:127]
    ds_read_b64_tr_b16 v[236:237], v22 offset:12288
    v_mfma_f32_16x16x32_bf16 v[128:131], v[240:243], v[160:163], v[128:131]
    ds_read_b64_tr_b16 v[238:239], v22 offset:13312
    s_xor_b32 s96, s83, 5
    s_lshl_b32 s97, s96, 11
    s_add_u32 s20, s97, s19
    buffer_load_dwordx4 v[148:151], v2, s[32:35], s20 offen sc1
    s_waitcnt lgkmcnt(6)
    v_mfma_f32_16x16x32_bf16 v[132:135], v[244:247], v[156:159], v[132:135]
    ds_read_b64_tr_b16 v[240:241], v23 offset:12288
    v_mfma_f32_16x16x32_bf16 v[136:139], v[244:247], v[160:163], v[136:139]
    ds_read_b64_tr_b16 v[242:243], v23 offset:13312
    buffer_load_dwordx4 v[152:155], v2, s[32:35], s20 offen offset:1024 sc1
    s_waitcnt lgkmcnt(6)
    v_mfma_f32_16x16x32_bf16 v[108:111], v[228:231], v[156:159], v[108:111]
    ds_read_b64_tr_b16 v[244:245], v20 offset:12288
    v_mfma_f32_16x16x32_bf16 v[112:115], v[228:231], v[160:163], v[112:115]
    ds_read_b64_tr_b16 v[246:247], v20 offset:13312
    s_waitcnt lgkmcnt(6)
    v_mfma_f32_16x16x32_bf16 v[116:119], v[232:235], v[156:159], v[116:119]
    ds_read_b64_tr_b16 v[228:229], v21 offset:12288
    v_mfma_f32_16x16x32_bf16 v[120:123], v[232:235], v[160:163], v[120:123]
    ds_read_b64_tr_b16 v[230:231], v21 offset:13312
    s_waitcnt lgkmcnt(6)
    s_waitcnt vmcnt(4)
    v_mfma_f32_16x16x32_bf16 v[124:127], v[236:239], v[164:167], v[124:127]
    ds_read_b64_tr_b16 v[232:233], v22 offset:16384
    v_mfma_f32_16x16x32_bf16 v[128:131], v[236:239], v[168:171], v[128:131]
    ds_read_b64_tr_b16 v[234:235], v22 offset:17408
    s_xor_b32 s96, s83, 6
    s_lshl_b32 s97, s96, 11
    s_add_u32 s20, s97, s19
    buffer_load_dwordx4 v[156:159], v2, s[32:35], s20 offen sc1
    s_waitcnt lgkmcnt(6)
    v_mfma_f32_16x16x32_bf16 v[132:135], v[240:243], v[164:167], v[132:135]
    ds_read_b64_tr_b16 v[236:237], v23 offset:16384
    v_mfma_f32_16x16x32_bf16 v[136:139], v[240:243], v[168:171], v[136:139]
    ds_read_b64_tr_b16 v[238:239], v23 offset:17408
    buffer_load_dwordx4 v[160:163], v2, s[32:35], s20 offen offset:1024 sc1
    s_waitcnt lgkmcnt(6)
    v_mfma_f32_16x16x32_bf16 v[108:111], v[244:247], v[164:167], v[108:111]
    ds_read_b64_tr_b16 v[240:241], v20 offset:16384
    v_mfma_f32_16x16x32_bf16 v[112:115], v[244:247], v[168:171], v[112:115]
    ds_read_b64_tr_b16 v[242:243], v20 offset:17408
    s_waitcnt lgkmcnt(6)
    v_mfma_f32_16x16x32_bf16 v[116:119], v[228:231], v[164:167], v[116:119]
    ds_read_b64_tr_b16 v[244:245], v21 offset:16384
    v_mfma_f32_16x16x32_bf16 v[120:123], v[228:231], v[168:171], v[120:123]
    ds_read_b64_tr_b16 v[246:247], v21 offset:17408
    s_waitcnt lgkmcnt(6)
    s_waitcnt vmcnt(4)
    v_mfma_f32_16x16x32_bf16 v[124:127], v[232:235], v[140:143], v[124:127]
    ds_read_b64_tr_b16 v[228:229], v22 offset:20480
    v_mfma_f32_16x16x32_bf16 v[128:131], v[232:235], v[144:147], v[128:131]
    ds_read_b64_tr_b16 v[230:231], v22 offset:21504
    s_xor_b32 s96, s83, 7
    s_lshl_b32 s97, s96, 11
    s_add_u32 s20, s97, s19
    buffer_load_dwordx4 v[164:167], v2, s[32:35], s20 offen sc1
    s_waitcnt lgkmcnt(6)
    v_mfma_f32_16x16x32_bf16 v[132:135], v[236:239], v[140:143], v[132:135]
    ds_read_b64_tr_b16 v[232:233], v23 offset:20480
    v_mfma_f32_16x16x32_bf16 v[136:139], v[236:239], v[144:147], v[136:139]
    ds_read_b64_tr_b16 v[234:235], v23 offset:21504
    buffer_load_dwordx4 v[168:171], v2, s[32:35], s20 offen offset:1024 sc1
    s_waitcnt lgkmcnt(6)
    v_mfma_f32_16x16x32_bf16 v[108:111], v[240:243], v[140:143], v[108:111]
    ds_read_b64_tr_b16 v[236:237], v20 offset:20480
    v_mfma_f32_16x16x32_bf16 v[112:115], v[240:243], v[144:147], v[112:115]
    ds_read_b64_tr_b16 v[238:239], v20 offset:21504
    s_setprio 0
    s_waitcnt lgkmcnt(6)
    v_mfma_f32_16x16x32_bf16 v[116:119], v[244:247], v[140:143], v[116:119]
    ds_read_b64_tr_b16 v[240:241], v21 offset:20480
    v_mfma_f32_16x16x32_bf16 v[120:123], v[244:247], v[144:147], v[120:123]
    ds_read_b64_tr_b16 v[242:243], v21 offset:21504
    s_waitcnt lgkmcnt(6)
    s_waitcnt vmcnt(4)
    v_mfma_f32_16x16x32_bf16 v[124:127], v[228:231], v[148:151], v[124:127]
    ds_read_b64_tr_b16 v[244:245], v22 offset:24576
    v_mfma_f32_16x16x32_bf16 v[128:131], v[228:231], v[152:155], v[128:131]
    ds_read_b64_tr_b16 v[246:247], v22 offset:25600
    s_cmp_eq_u32 s25, s4
    s_cbranch_scc1 L_D2
SPOLL_32:
    s_load_dwordx2 s[24:25], s[32:33], s92 offset:1024 glc
SCHK_33:
    s_add_u32 s5, s5, 1
    s_cmp_ge_u32 s5, 300000
    s_waitcnt lgkmcnt(0)
    s_cbranch_scc1 SDONE_34
    s_cmp_lg_u32 s25, s4
    s_cbranch_scc1 SPOLL_32
SDONE_34:
L_D2:
    s_barrier
    s_xor_b32 s96, s83, 8
    s_lshl_b32 s97, s96, 11
    s_add_u32 s20, s97, s19
    buffer_load_dwordx4 v[140:143], v2, s[32:35], s20 offen sc1
    s_waitcnt lgkmcnt(6)
    v_mfma_f32_16x16x32_bf16 v[132:135], v[232:235], v[148:151], v[132:135]
    ds_read_b64_tr_b16 v[228:229], v23 offset:24576
    v_mfma_f32_16x16x32_bf16 v[136:139], v[232:235], v[152:155], v[136:139]
    ds_read_b64_tr_b16 v[230:231], v23 offset:25600
    buffer_load_dwordx4 v[144:147], v2, s[32:35], s20 offen offset:1024 sc1
    s_waitcnt lgkmcnt(6)
    v_mfma_f32_16x16x32_bf16 v[108:111], v[236:239], v[148:151], v[108:111]
    ds_read_b64_tr_b16 v[232:233], v20 offset:24576
    v_mfma_f32_16x16x32_bf16 v[112:115], v[236:239], v[152:155], v[112:115]
    ds_read_b64_tr_b16 v[234:235], v20 offset:25600
    s_waitcnt lgkmcnt(6)
    v_mfma_f32_16x16x32_bf16 v[116:119], v[240:243], v[148:151], v[116:119]
    ds_read_b64_tr_b16 v[236:237], v21 offset:24576
    v_mfma_f32_16x16x32_bf16 v[120:123], v[240:243], v[152:155], v[120:123]
    ds_read_b64_tr_b16 v[238:239], v21 offset:25600
    s_waitcnt lgkmcnt(6)
    s_waitcnt vmcnt(4)
    v_mfma_f32_16x16x32_bf16 v[124:127], v[244:247], v[156:159], v[124:127]
    ds_read_b64_tr_b16 v[240:241], v22 offset:28672
    v_mfma_f32_16x16x32_bf16 v[128:131], v[244:247], v[160:163], v[128:131]
    ds_read_b64_tr_b16 v[242:243], v22 offset:29696
    s_xor_b32 s96, s83, 9
    s_lshl_b32 s97, s96, 11
    s_add_u32 s20, s97, s19
    buffer_load_dwordx4 v[148:151], v2, s[32:35], s20 offen sc1
    s_waitcnt lgkmcnt(6)
    v_mfma_f32_16x16x32_bf16 v[132:135], v[228:231], v[156:159], v[132:135]
    ds_read_b64_tr_b16 v[244:245], v23 offset:28672
    v_mfma_f32_16x16x32_bf16 v[136:139], v[228:231], v[160:163], v[136:139]
    ds_read_b64_tr_b16 v[246:247], v23 offset:29696
    buffer_load_dwordx4 v[152:155], v2, s[32:35], s20 offen offset:1024 sc1
    s_waitcnt lgkmcnt(6)
    v_mfma_f32_16x16x32_bf16 v[108:111], v[232:235], v[156:159], v[108:111]
    ds_read_b64_tr_b16 v[228:229], v20 offset:28672
    v_mfma_f32_16x16x32_bf16 v[112:115], v[232:235], v[160:163], v[112:115]
    ds_read_b64_tr_b16 v[230:231], v20 offset:29696
    s_waitcnt lgkmcnt(6)
    v_mfma_f32_16x16x32_bf16 v[116:119], v[236:239], v[156:159], v[116:119]
    ds_read_b64_tr_b16 v[232:233], v21 offset:28672
    v_mfma_f32_16x16x32_bf16 v[120:123], v[236:239], v[160:163], v[120:123]
    ds_read_b64_tr_b16 v[234:235], v21 offset:29696
    s_waitcnt lgkmcnt(6)
    s_waitcnt vmcnt(4)
    v_mfma_f32_16x16x32_bf16 v[124:127], v[240:243], v[164:167], v[124:127]
    ds_read_b64_tr_b16 v[236:237], v22 offset:32768
    v_mfma_f32_16x16x32_bf16 v[128:131], v[240:243], v[168:171], v[128:131]
    ds_read_b64_tr_b16 v[238:239], v22 offset:33792
    s_xor_b32 s96, s83, 10
    s_lshl_b32 s97, s96, 11
    s_add_u32 s20, s97, s19
    buffer_load_dwordx4 v[156:159], v2, s[32:35], s20 offen sc1
    s_waitcnt lgkmcnt(6)
    v_mfma_f32_16x16x32_bf16 v[132:135], v[244:247], v[164:167], v[132:135]
    ds_read_b64_tr_b16 v[240:241], v23 offset:32768
    v_mfma_f32_16x16x32_bf16 v[136:139], v[244:247], v[168:171], v[136:139]
    ds_read_b64_tr_b16 v[242:243], v23 offset:33792
    buffer_load_dwordx4 v[160:163], v2, s[32:35], s20 offen offset:1024 sc1
    s_waitcnt lgkmcnt(6)
    v_mfma_f32_16x16x32_bf16 v[108:111], v[228:231], v[164:167], v[108:111]
    ds_read_b64_tr_b16 v[244:245], v20 offset:32768
    v_mfma_f32_16x16x32_bf16 v[112:115], v[228:231], v[168:171], v[112:115]
    ds_read_b64_tr_b16 v[246:247], v20 offset:33792
    s_waitcnt lgkmcnt(6)
    v_mfma_f32_16x16x32_bf16 v[116:119], v[232:235], v[164:167], v[116:119]
    ds_read_b64_tr_b16 v[228:229], v21 offset:32768
    v_mfma_f32_16x16x32_bf16 v[120:123], v[232:235], v[168:171], v[120:123]
    ds_read_b64_tr_b16 v[230:231], v21 offset:33792
    s_waitcnt lgkmcnt(6)
    s_waitcnt vmcnt(4)
    v_mfma_f32_16x16x32_bf16 v[124:127], v[236:239], v[140:143], v[124:127]
    ds_read_b64_tr_b16 v[232:233], v22 offset:36864
    v_mfma_f32_16x16x32_bf16 v[128:131], v[236:239], v[144:147], v[128:131]
    ds_read_b64_tr_b16 v[234:235], v22 offset:37888
    s_xor_b32 s96, s83, 11
    s_lshl_b32 s97, s96, 11
    s_add_u32 s20, s97, s19
    buffer_load_dwordx4 v[164:167], v2, s[32:35], s20 offen sc1
    s_waitcnt lgkmcnt(6)
    v_mfma_f32_16x16x32_bf16 v[132:135], v[240:243], v[140:143], v[132:135]
    ds_read_b64_tr_b16 v[236:237], v23 offset:36864
    v_mfma_f32_16x16x32_bf16 v[136:139], v[240:243], v[144:147], v[136:139]
    ds_read_b64_tr_b16 v[238:239], v23 offset:37888
    buffer_load_dwordx4 v[168:171], v2, s[32:35], s20 offen offset:1024 sc1
    s_waitcnt lgkmcnt(6)
    v_mfma_f32_16x16x32_bf16 v[108:111], v[244:247], v[140:143], v[108:111]
    ds_read_b64_tr_b16 v[240:241], v20 offset:36864
    v_mfma_f32_16x16x32_bf16 v[112:115], v[244:247], v[144:147], v[112:115]
    ds_read_b64_tr_b16 v[242:243], v20 offset:37888
    s_waitcnt lgkmcnt(6)
    v_mfma_f32_16x16x32_bf16 v[116:119], v[228:231], v[140:143], v[116:119]
    ds_read_b64_tr_b16 v[244:245], v21 offset:36864
    v_mfma_f32_16x16x32_bf16 v[120:123], v[228:231], v[144:147], v[120:123]
    ds_read_b64_tr_b16 v[246:247], v21 offset:37888
    s_waitcnt lgkmcnt(6)
    s_waitcnt vmcnt(4)
    v_mfma_f32_16x16x32_bf16 v[124:127], v[232:235], v[148:151], v[124:127]
    ds_read_b64_tr_b16 v[228:229], v22 offset:40960
    v_mfma_f32_16x16x32_bf16 v[128:131], v[232:235], v[152:155], v[128:131]
    ds_read_b64_tr_b16 v[230:231], v22 offset:41984
    s_xor_b32 s96, s83, 12
    s_lshl_b32 s97, s96, 11
    s_add_u32 s20, s97, s19
    buffer_load_dwordx4 v[140:143], v2, s[32:35], s20 offen sc1
    s_waitcnt lgkmcnt(6)
    v_mfma_f32_16x16x32_bf16 v[132:135], v[236:239], v[148:151], v[132:135]
    ds_read_b64_tr_b16 v[232:233], v23 offset:40960
    v_mfma_f32_16x16x32_bf16 v[136:139], v[236:239], v[152:155], v[136:139]
    ds_read_b64_tr_b16 v[234:235], v23 offset:41984
    buffer_load_dwordx4 v[144:147], v2, s[32:35], s20 offen offset:1024 sc1
    s_waitcnt lgkmcnt(6)
    v_mfma_f32_16x16x32_bf16 v[108:111], v[240:243], v[148:151], v[108:111]
    ds_read_b64_tr_b16 v[236:237], v20 offset:40960
    v_mfma_f32_16x16x32_bf16 v[112:115], v[240:243], v[152:155], v[112:115]
    ds_read_b64_tr_b16 v[238:239], v20 offset:41984
    s_waitcnt lgkmcnt(6)
    v_mfma_f32_16x16x32_bf16 v[116:119], v[244:247], v[148:151], v[116:119]
    ds_read_b64_tr_b16 v[240:241], v21 offset:40960
    v_mfma_f32_16x16x32_bf16 v[120:123], v[244:247], v[152:155], v[120:123]
    ds_read_b64_tr_b16 v[242:243], v21 offset:41984
    s_waitcnt lgkmcnt(6)
    s_waitcnt vmcnt(4)
    v_mfma_f32_16x16x32_bf16 v[124:127], v[228:231], v[156:159], v[124:127]
    ds_read_b64_tr_b16 v[244:245], v22 offset:45056
    v_mfma_f32_16x16x32_bf16 v[128:131], v[228:231], v[160:163], v[128:131]
    ds_read_b64_tr_b16 v[246:247], v22 offset:46080
    s_xor_b32 s96, s83, 13
    s_lshl_b32 s97, s96, 11
    s_add_u32 s20, s97, s19
    buffer_load_dwordx4 v[148:151], v2, s[32:35], s20 offen sc1
    s_waitcnt lgkmcnt(6)
    v_mfma_f32_16x16x32_bf16 v[132:135], v[232:235], v[156:159], v[132:135]
    ds_read_b64_tr_b16 v[228:229], v23 offset:45056
    v_mfma_f32_16x16x32_bf16 v[136:139], v[232:235], v[160:163], v[136:139]
    ds_read_b64_tr_b16 v[230:231], v23 offset:46080
    buffer_load_dwordx4 v[152:155], v2, s[32:35], s20 offen offset:1024 sc1
    s_waitcnt lgkmcnt(6)
    v_mfma_f32_16x16x32_bf16 v[108:111], v[236:239], v[156:159], v[108:111]
    ds_read_b64_tr_b16 v[232:233], v20 offset:45056
    v_mfma_f32_16x16x32_bf16 v[112:115], v[236:239], v[160:163], v[112:115]
    ds_read_b64_tr_b16 v[234:235], v20 offset:46080
    s_waitcnt lgkmcnt(6)
    v_mfma_f32_16x16x32_bf16 v[116:119], v[240:243], v[156:159], v[116:119]
    ds_read_b64_tr_b16 v[236:237], v21 offset:45056
    v_mfma_f32_16x16x32_bf16 v[120:123], v[240:243], v[160:163], v[120:123]
    ds_read_b64_tr_b16 v[238:239], v21 offset:46080
    s_waitcnt lgkmcnt(6)
    s_waitcnt vmcnt(4)
    v_mfma_f32_16x16x32_bf16 v[124:127], v[244:247], v[164:167], v[124:127]
    ds_read_b64_tr_b16 v[240:241], v22 offset:49152
    v_mfma_f32_16x16x32_bf16 v[128:131], v[244:247], v[168:171], v[128:131]
    ds_read_b64_tr_b16 v[242:243], v22 offset:50176
    s_xor_b32 s96, s83, 14
    s_lshl_b32 s97, s96, 11
    s_add_u32 s20, s97, s19
    buffer_load_dwordx4 v[156:159], v2, s[32:35], s20 offen sc1
    s_waitcnt lgkmcnt(6)
    v_mfma_f32_16x16x32_bf16 v[132:135], v[228:231], v[164:167], v[132:135]
    ds_read_b64_tr_b16 v[244:245], v23 offset:49152
    v_mfma_f32_16x16x32_bf16 v[136:139], v[228:231], v[168:171], v[136:139]
    ds_read_b64_tr_b16 v[246:247], v23 offset:50176
    buffer_load_dwordx4 v[160:163], v2, s[32:35], s20 offen offset:1024 sc1
    s_waitcnt lgkmcnt(6)
    v_mfma_f32_16x16x32_bf16 v[108:111], v[232:235], v[164:167], v[108:111]
    ds_read_b64_tr_b16 v[228:229], v20 offset:49152
    v_mfma_f32_16x16x32_bf16 v[112:115], v[232:235], v[168:171], v[112:115]
    ds_read_b64_tr_b16 v[230:231], v20 offset:50176
    s_waitcnt lgkmcnt(6)
    v_mfma_f32_16x16x32_bf16 v[116:119], v[236:239], v[164:167], v[116:119]
    ds_read_b64_tr_b16 v[232:233], v21 offset:49152
    v_mfma_f32_16x16x32_bf16 v[120:123], v[236:239], v[168:171], v[120:123]
    ds_read_b64_tr_b16 v[234:235], v21 offset:50176
    s_waitcnt lgkmcnt(6)
    s_waitcnt vmcnt(4)
    v_mfma_f32_16x16x32_bf16 v[124:127], v[240:243], v[140:143], v[124:127]
    ds_read_b64_tr_b16 v[236:237], v22 offset:53248
    v_mfma_f32_16x16x32_bf16 v[128:131], v[240:243], v[144:147], v[128:131]
    ds_read_b64_tr_b16 v[238:239], v22 offset:54272
    s_xor_b32 s96, s83, 15
    s_lshl_b32 s97, s96, 11
    s_add_u32 s20, s97, s19
    buffer_load_dwordx4 v[164:167], v2, s[32:35], s20 offen sc1
    s_waitcnt lgkmcnt(6)
    v_mfma_f32_16x16x32_bf16 v[132:135], v[244:247], v[140:143], v[132:135]
    ds_read_b64_tr_b16 v[240:241], v23 offset:53248
    v_mfma_f32_16x16x32_bf16 v[136:139], v[244:247], v[144:147], v[136:139]
    ds_read_b64_tr_b16 v[242:243], v23 offset:54272
    buffer_load_dwordx4 v[168:171], v2, s[32:35], s20 offen offset:1024 sc1
    buffer_load_dwordx2 v[26:27], v25, s[32:35], s18 offen sc1
    s_waitcnt lgkmcnt(6)
    v_mfma_f32_16x16x32_bf16 v[108:111], v[228:231], v[140:143], v[108:111]
    ds_read_b64_tr_b16 v[244:245], v20 offset:53248
    v_mfma_f32_16x16x32_bf16 v[112:115], v[228:231], v[144:147], v[112:115]
    ds_read_b64_tr_b16 v[246:247], v20 offset:54272
    s_waitcnt lgkmcnt(6)
    v_mfma_f32_16x16x32_bf16 v[116:119], v[232:235], v[140:143], v[116:119]
    ds_read_b64_tr_b16 v[228:229], v21 offset:53248
    v_mfma_f32_16x16x32_bf16 v[120:123], v[232:235], v[144:147], v[120:123]
    ds_read_b64_tr_b16 v[230:231], v21 offset:54272
    s_waitcnt lgkmcnt(6)
    s_waitcnt vmcnt(5)
    v_mfma_f32_16x16x32_bf16 v[124:127], v[236:239], v[148:151], v[124:127]
    ds_read_b64_tr_b16 v[232:233], v22 offset:57344
    v_mfma_f32_16x16x32_bf16 v[128:131], v[236:239], v[152:155], v[128:131]
    ds_read_b64_tr_b16 v[234:235], v22 offset:58368
    s_waitcnt lgkmcnt(6)
    v_mfma_f32_16x16x32_bf16 v[132:135], v[240:243], v[148:151], v[132:135]
    ds_read_b64_tr_b16 v[236:237], v23 offset:57344
    v_mfma_f32_16x16x32_bf16 v[136:139], v[240:243], v[152:155], v[136:139]
    ds_read_b64_tr_b16 v[238:239], v23 offset:58368
    s_waitcnt lgkmcnt(6)
    v_mfma_f32_16x16x32_bf16 v[108:111], v[244:247], v[148:151], v[108:111]
    ds_read_b64_tr_b16 v[240:241], v20 offset:57344
    v_mfma_f32_16x16x32_bf16 v[112:115], v[244:247], v[152:155], v[112:115]
    ds_read_b64_tr_b16 v[242:243], v20 offset:58368
    s_waitcnt lgkmcnt(6)
    v_mfma_f32_16x16x32_bf16 v[116:119], v[228:231], v[148:151], v[116:119]
    ds_read_b64_tr_b16 v[244:245], v21 offset:57344
    v_mfma_f32_16x16x32_bf16 v[120:123], v[228:231], v[152:155], v[120:123]
    ds_read_b64_tr_b16 v[246:247], v21 offset:58368
    s_waitcnt lgkmcnt(6)
    s_waitcnt vmcnt(3)
    v_mfma_f32_16x16x32_bf16 v[124:127], v[232:235], v[156:159], v[124:127]
    ds_read_b64_tr_b16 v[228:229], v22 offset:61440
    v_mfma_f32_16x16x32_bf16 v[128:131], v[232:235], v[160:163], v[128:131]
    ds_read_b64_tr_b16 v[230:231], v22 offset:62464
    s_waitcnt lgkmcnt(6)
    v_mfma_f32_16x16x32_bf16 v[132:135], v[236:239], v[156:159], v[132:135]
    ds_read_b64_tr_b16 v[232:233], v23 offset:61440
    v_mfma_f32_16x16x32_bf16 v[136:139], v[236:239], v[160:163], v[136:139]
    ds_read_b64_tr_b16 v[234:235], v23 offset:62464
    s_waitcnt lgkmcnt(6)
    v_mfma_f32_16x16x32_bf16 v[108:111], v[240:243], v[156:159], v[108:111]
    ds_read_b64_tr_b16 v[236:237], v20 offset:61440
    v_mfma_f32_16x16x32_bf16 v[112:115], v[240:243], v[160:163], v[112:115]
    ds_read_b64_tr_b16 v[238:239], v20 offset:62464
    s_waitcnt lgkmcnt(6)
    v_mfma_f32_16x16x32_bf16 v[116:119], v[244:247], v[156:159], v[116:119]
    ds_read_b64_tr_b16 v[240:241], v21 offset:61440
    v_mfma_f32_16x16x32_bf16 v[120:123], v[244:247], v[160:163], v[120:123]
    ds_read_b64_tr_b16 v[242:243], v21 offset:62464
    s_waitcnt lgkmcnt(6)
    s_waitcnt vmcnt(1)
    v_mfma_f32_16x16x32_bf16 v[124:127], v[228:231], v[164:167], v[124:127]
    v_mfma_f32_16x16x32_bf16 v[128:131], v[228:231], v[168:171], v[128:131]
    s_waitcnt lgkmcnt(4)
    v_mfma_f32_16x16x32_bf16 v[132:135], v[232:235], v[164:167], v[132:135]
    v_mfma_f32_16x16x32_bf16 v[136:139], v[232:235], v[168:171], v[136:139]
    s_waitcnt lgkmcnt(2)
    v_mfma_f32_16x16x32_bf16 v[108:111], v[236:239], v[164:167], v[108:111]
    v_mfma_f32_16x16x32_bf16 v[112:115], v[236:239], v[168:171], v[112:115]
    s_waitcnt lgkmcnt(0)
    v_mfma_f32_16x16x32_bf16 v[116:119], v[240:243], v[164:167], v[116:119]
    v_mfma_f32_16x16x32_bf16 v[120:123], v[240:243], v[168:171], v[120:123]
    s_setprio 0
    s_lshl_b32 s13, s3, 12
    v_add_u32 v4, s13, v2
    ds_write_b128 v4, v[124:127]
    ds_write_b128 v4, v[128:131] offset:1024
    ds_write_b128 v4, v[132:135] offset:2048
    ds_write_b128 v4, v[136:139] offset:3072
    v_permlane16_swap_b32 v108, v112
    v_permlane16_swap_b32 v109, v113
    v_permlane16_swap_b32 v110, v114
    v_permlane16_swap_b32 v111, v115
    v_permlane16_swap_b32 v116, v120
    v_permlane16_swap_b32 v117, v121
    v_permlane16_swap_b32 v118, v122
    v_permlane16_swap_b32 v119, v123
    s_xor_b32 s96, s3, 4
    s_lshl_b32 s13, s96, 12
    v_and_b32 v5, 15, v1
    v_lshl_add_u32 v5, v5, 4, s13
    v_bfe_u32 v9, v1, 4, 1
    v_lshl_add_u32 v5, v9, 10, v5
    v_lshrrev_b32 v9, 5, v1
    v_lshl_add_u32 v5, v9, 9, v5
    s_lshl_b32 s96, s76, 11
    s_and_b32 s97, s3, 3
    s_lshl_b32 s98, s97, 9
    s_add_u32 s99, s96, s98
    s_add_u32 s13, s99, 131072
    v_and_b32 v6, 31, v1
    v_lshl_add_u32 v6, v6, 4, s13
    v_lshrrev_b32 v9, 5, v1
    v_lshl_add_u32 v6, v9, 3, v6
    s_lshl_b32 s96, s76, 6
    s_add_u32 s13, s96, 139008
    v_and_b32 v7, 7, v1
    v_lshl_add_u32 v7, v7, 2, s13
    v_lshrrev_b32 v9, 5, v1
    v_lshl_add_u32 v7, v9, 5, v7
    s_lshl_b32 s96, s21, 15
    s_lshl_b32 s97, s3, 8
    s_add_u32 s98, s96, s97
    s_add_u32 s19, s98, 12582912
    v_and_b32 v44, 15, v1
    v_lshlrev_b32 v44, 4, v44
    v_lshrrev_b32 v9, 4, v1
    v_lshl_add_u32 v44, v9, 11, v44
    v_mov_b32 v232, 0x3f803f80
    s_waitcnt lgkmcnt(0)
    s_barrier
    ds_read_b128 v[124:127], v5
    ds_read_b128 v[128:131], v5 offset:256
    ds_read_b128 v[132:135], v5 offset:2048
    ds_read_b128 v[136:139], v5 offset:2304
    s_add_u32 s14, s80, 114688
    s_lshl2_add_u32 m0, s89, 67584
    s_nop 0
    buffer_load_dwordx4 v72, s[56:59], s14 offen nt lds
    s_add_u32 s14, s80, 172032
    s_lshl2_add_u32 m0, s89, 68608
    s_nop 0
    buffer_load_dwordx4 v72, s[56:59], s14 offen nt lds
    s_mov_b32 s14, s81
    s_lshl2_add_u32 m0, s89, 98304
    s_nop 0
    buffer_load_dwordx4 v73, s[60:63], s14 offen nt lds
    s_waitcnt lgkmcnt(3)
    v_pk_add_f32 v[108:109], v[108:109], v[124:125]
    v_pk_add_f32 v[110:111], v[110:111], v[126:127]
    s_waitcnt lgkmcnt(2)
    v_pk_add_f32 v[112:113], v[112:113], v[128:129]
    v_pk_add_f32 v[114:115], v[114:115], v[130:131]
    v_cvt_pk_bf16_f32 v108, 0, v108
    v_cvt_pk_bf16_f32 v109, 0, v109
    v_cvt_pk_bf16_f32 v110, 0, v110
    v_cvt_pk_bf16_f32 v111, 0, v111
    v_cvt_pk_bf16_f32 v112, 0, v112
    v_cvt_pk_bf16_f32 v113, 0, v113
    v_cvt_pk_bf16_f32 v114, 0, v114
    v_cvt_pk_bf16_f32 v115, 0, v115
    v_pk_mul_f32 v[108:109], v[108:109], v[76:77]
    v_pk_mul_f32 v[110:111], v[110:111], v[78:79]
    v_pk_mul_f32 v[112:113], v[112:113], v[80:81]
    v_pk_mul_f32 v[114:115], v[114:115], v[82:83]
    v_cvt_pk_bf16_f32 v108, 0, v108
    v_cvt_pk_bf16_f32 v109, 0, v109
    v_cvt_pk_bf16_f32 v110, 0, v110
    v_cvt_pk_bf16_f32 v111, 0, v111
    v_cvt_pk_bf16_f32 v112, 0, v112
    v_cvt_pk_bf16_f32 v113, 0, v113
    v_cvt_pk_bf16_f32 v114, 0, v114
    v_cvt_pk_bf16_f32 v115, 0, v115
    v_pk_add_f32 v[108:109], v[108:109], v[28:29]
    v_pk_add_f32 v[110:111], v[110:111], v[30:31]
    v_pk_add_f32 v[112:113], v[112:113], v[32:33]
    v_pk_add_f32 v[114:115], v[114:115], v[34:35]
    v_cvt_pk_bf16_f32 v12, v108, v109
    v_cvt_pk_bf16_f32 v13, v110, v111
    v_cvt_pk_bf16_f32 v14, v112, v113
    v_cvt_pk_bf16_f32 v15, v114, v115
    s_waitcnt lgkmcnt(1)
    v_pk_add_f32 v[116:117], v[116:117], v[132:133]
    v_pk_add_f32 v[118:119], v[118:119], v[134:135]
    s_waitcnt lgkmcnt(0)
    v_pk_add_f32 v[120:121], v[120:121], v[136:137]
    v_pk_add_f32 v[122:123], v[122:123], v[138:139]
    v_cvt_pk_bf16_f32 v116, 0, v116
    v_cvt_pk_bf16_f32 v117, 0, v117
    v_cvt_pk_bf16_f32 v118, 0, v118
    v_cvt_pk_bf16_f32 v119, 0, v119
    v_cvt_pk_bf16_f32 v120, 0, v120
    v_cvt_pk_bf16_f32 v121, 0, v121
    v_cvt_pk_bf16_f32 v122, 0, v122
    v_cvt_pk_bf16_f32 v123, 0, v123
    v_pk_mul_f32 v[116:117], v[116:117], v[84:85]
    v_pk_mul_f32 v[118:119], v[118:119], v[86:87]
    v_pk_mul_f32 v[120:121], v[120:121], v[88:89]
    v_pk_mul_f32 v[122:123], v[122:123], v[90:91]
    v_cvt_pk_bf16_f32 v116, 0, v116
    v_cvt_pk_bf16_f32 v117, 0, v117
    v_cvt_pk_bf16_f32 v118, 0, v118
    v_cvt_pk_bf16_f32 v119, 0, v119
    v_cvt_pk_bf16_f32 v120, 0, v120
    v_cvt_pk_bf16_f32 v121, 0, v121
    v_cvt_pk_bf16_f32 v122, 0, v122
    v_cvt_pk_bf16_f32 v123, 0, v123
    v_pk_add_f32 v[116:117], v[116:117], v[36:37]
    v_pk_add_f32 v[118:119], v[118:119], v[38:39]
    v_pk_add_f32 v[120:121], v[120:121], v[40:41]
    v_pk_add_f32 v[122:123], v[122:123], v[42:43]
    v_cvt_pk_bf16_f32 v16, v116, v117
    v_cvt_pk_bf16_f32 v17, v118, v119
    v_cvt_pk_bf16_f32 v18, v120, v121
    v_cvt_pk_bf16_f32 v19, v122, v123
    v_mfma_f32_32x32x16_bf16 v[124:139], v[92:95], v[12:15], 0
    s_nop 0
    v_mfma_f32_32x32x16_bf16 v[124:139], v[96:99], v[16:19], v[124:139]
    v_dot2_f32_bf16 v228, v12, v12, 0
    v_dot2_f32_bf16 v229, v13, v13, 0
    v_dot2_f32_bf16 v228, v14, v14, v228
    v_dot2_f32_bf16 v229, v15, v15, v229
    v_dot2_f32_bf16 v228, v16, v16, v228
    v_dot2_f32_bf16 v229, v17, v17, v229
    v_dot2_f32_bf16 v228, v18, v18, v228
    v_dot2_f32_bf16 v229, v19, v19, v229
    s_nop 2
    v_add_f32 v230, v228, v229
    v_add_f32 v228, v228, v229
    s_nop 1
    v_permlane32_swap_b32 v228, v230
    s_mov_b32 exec_lo, 0
    v_add_f32 v124, v228, v230
    v_mov_b32 v125, v126
    s_mov_b32 exec_lo, -1
    ds_write_b64 v6, v[124:125]
    ds_write_b32 v7, v68
    ds_write_b32 v7, v69 offset:128
    ds_write_b32 v7, v70 offset:256
    ds_write_b32 v7, v71 offset:384
    v_add_u32 v4, 131072, v2
    v_and_b32 v5, 7, v1
    v_lshlrev_b32 v5, 15, v5
    v_bfe_u32 v9, v1, 3, 1
    v_lshl_add_u32 v5, v9, 12, v5
    s_lshl4_add_u32 s96, s21, s12
    s_lshl_b32 s97, s96, 11
    s_add_u32 s13, s97, 12582912
    s_and_b32 s96, s12, 1
    s_lshr_b32 s97, s21, 2
    s_and_b32 s98, s21, 3
    s_lshl_b32 s99, s98, 6
    s_lshl1_add_u32 s98, s97, s99
    s_lshl_b32 s97, s98, 12
    s_lshr_b32 s99, s12, 1
    s_lshl_b32 s98, s99, 6
    s_add_u32 s99, s97, s98
    s_lshl2_add_u32 s97, s96, s99
    s_add_u32 s98, s97, 1048576
    s_add_u32 s16, s98, 1536
    s_waitcnt lgkmcnt(0)
    s_barrier
    s_cmp_lg_u32 s3, 0
    s_cbranch_scc1 L_PE
    ds_read_b128 v[124:127], v4 offset:0
    ds_read_b128 v[128:131], v4 offset:2048
    ds_read_b128 v[132:135], v4 offset:1024
    ds_read_b128 v[136:139], v4 offset:3072
    s_waitcnt lgkmcnt(2)
    v_pk_add_f32 v[124:125], v[124:125], v[128:129]
    v_pk_add_f32 v[126:127], v[126:127], v[130:131]
    v_add_f32 v125, v125, v127
    v_mov_b32 v127, s4
    s_waitcnt lgkmcnt(0)
    v_pk_add_f32 v[132:133], v[132:133], v[136:137]
    v_pk_add_f32 v[134:135], v[134:135], v[138:139]
    v_add_f32 v133, v133, v135
    v_mov_b32 v135, s4
    buffer_store_dwordx4 v[124:127], v2, s[32:35], s13 offen sc1
    buffer_store_dwordx4 v[132:135], v2, s[32:35], s13 offen offset:1024 sc1
    s_mov_b64 exec, 0xffff
    buffer_store_dword v127, v5, s[32:35], s16 offen sc1
    s_mov_b64 exec, -1
L_PE:
    s_load_dwordx2 s[24:25], s[32:33], s92 offset:1536 glc
    s_and_b32 s96, s3, 3
    s_mul_i32 s97, s96, 4608
    s_lshl_b32 s98, s76, 6
    s_add_u32 s16, s97, s98
    v_and_b32 v23, 31, v1
    v_mul_u32_u24 v23, 144, v23
    v_lshrrev_b32 v9, 5, v1
    v_lshl_add_u32 v23, v9, 5, v23
    v_add_u32 v23, s16, v23
    ds_write_b128 v23, v[12:15]
    ds_write_b128 v23, v[16:19] offset:16
    v_add_u32 v23, 139776, v23
    s_lshl3_add_u32 s96, s21, s3
    s_lshl_b32 s97, s96, 5
    s_sub_u32 s15, 4094, s97
    v_and_b32 v22, 15, v1
    v_lshlrev_b32 v22, 1, v22
    v_sub_u32 v22, s15, v22
    s_lshl_b32 s96, s3, 7
    s_add_u32 s15, s96, 135168
    v_and_b32 v8, 15, v1
    v_lshl_add_u32 v8, v8, 3, s15
    s_and_b32 s96, s3, 3
    s_lshl_b32 s97, s96, 8
    s_add_u32 s15, s97, 135168
    v_and_b32 v10, 31, v1
    v_lshl_add_u32 v10, v10, 3, s15
    v_and_b32 v11, 7, v1
    v_lshlrev_b32 v11, 3, v11
    v_add_u32 v11, 136192, v11
    s_waitcnt vmcnt(3)
    v_cmp_ne_u32 vcc, s4, v27
    s_cbranch_vccz TOK_38
POLL_39:
    buffer_load_dwordx2 v[26:27], v25, s[32:35], s18 offen sc1
    s_waitcnt vmcnt(0)
    v_cmp_ne_u32 vcc, s4, v27
    s_cbranch_vccz PDONE_40
    s_add_u32 s5, s5, 1
    s_cmp_lt_u32 s5, 300000
    s_cbranch_scc1 POLL_39
PDONE_40:
TOK_38:
    v_add_f32_dpp v26, v26, v26 quad_perm:[1,0,3,2] row_mask:0xf bank_mask:0xf
    s_nop 1
    v_add_f32_dpp v26, v26, v26 quad_perm:[2,3,0,1] row_mask:0xf bank_mask:0xf
    s_nop 1
    v_add_f32_dpp v26, v26, v26 row_half_mirror row_mask:0xf bank_mask:0xf
    s_nop 1
    v_add_f32_dpp v26, v26, v26 row_ror:8 row_mask:0xf bank_mask:0xf
    s_cmp_lg_u32 s3, 1
    s_cbranch_scc1 L_NOCT
    v_and_b32 v5, 15, v1
    v_lshlrev_b32 v5, 3, v5
    v_add_u32 v5, 139008, v5
    ds_read_b64 v[150:151], v5
    ds_read_b64 v[154:155], v5 offset:128
    ds_read_b64 v[156:157], v5 offset:384
    s_waitcnt lgkmcnt(0)
    v_lshlrev_b32 v148, 16, v150
    v_and_b32 v149, s6, v150
    v_lshlrev_b32 v150, 16, v151
    v_and_b32 v151, s6, v151
    v_lshlrev_b32 v152, 16, v154
    v_and_b32 v153, s6, v154
    v_lshlrev_b32 v154, 16, v155
    v_and_b32 v155, s6, v155
L_NOCT:
    s_cmp_lt_u32 s3, 4
    s_cbranch_scc1 L_NOST
    s_sub_u32 s96, s3, 4
    s_lshl_b32 s97, s96, 12
    s_add_u32 s13, s97, 32768
    v_add_u32 v4, s13, v2
    v_add_u32 v7, 65536, v4
    ds_write_b128 v4, v[176:179] offset:16384
    ds_write_b128 v4, v[180:183]
    ds_write_b128 v4, v[184:187] offset:17408
    ds_write_b128 v4, v[188:191] offset:1024
    ds_write_b128 v4, v[192:195] offset:18432
    ds_write_b128 v4, v[196:199] offset:2048
    ds_write_b128 v4, v[200:203] offset:19456
    ds_write_b128 v4, v[204:207] offset:3072
    ds_write_b128 v4, v[208:211] offset:49152
    ds_write_b128 v4, v[212:215] offset:32768
    ds_write_b128 v4, v[216:219] offset:50176
    ds_write_b128 v4, v[220:223] offset:33792
L_NOST:
    s_branch SCHK_36
SPOLL_35:
    s_load_dwordx2 s[24:25], s[32:33], s92 offset:1536 glc
SCHK_36:
    s_add_u32 s5, s5, 1
    s_cmp_ge_u32 s5, 300000
    s_waitcnt lgkmcnt(0)
    s_cbranch_scc1 SDONE_37
    s_cmp_lg_u32 s24, s4
    s_cbranch_scc1 SPOLL_35
    s_cmp_lg_u32 s25, s4
    s_cbranch_scc1 SPOLL_35
SDONE_37:
    s_barrier
    s_mov_b32 s13, s19
    buffer_load_dwordx4 v[124:127], v44, s[32:35], s13 offen sc1
    s_add_u32 s13, s19, 8192
    buffer_load_dwordx4 v[128:131], v44, s[32:35], s13 offen sc1
    s_add_u32 s13, s19, 16384
    buffer_load_dwordx4 v[132:135], v44, s[32:35], s13 offen sc1
    s_add_u32 s13, s19, 24576
    buffer_load_dwordx4 v[136:139], v44, s[32:35], s13 offen sc1
    v_lshlrev_b32 v28, 16, v12
    v_and_b32 v29, s6, v12
    v_lshlrev_b32 v30, 16, v13
    v_and_b32 v31, s6, v13
    v_lshlrev_b32 v32, 16, v14
    v_and_b32 v33, s6, v14
    v_lshlrev_b32 v34, 16, v15
    v_and_b32 v35, s6, v15
    v_lshlrev_b32 v36, 16, v16
    v_and_b32 v37, s6, v16
    v_lshlrev_b32 v38, 16, v17
    v_and_b32 v39, s6, v17
    v_lshlrev_b32 v40, 16, v18
    v_and_b32 v41, s6, v18
    v_lshlrev_b32 v42, 16, v19
    v_and_b32 v43, s6, v19
    v_mul_u32_u24_dpp v92, v68, v52 row_newbcast:0 row_mask:0xf bank_mask:0xf
    v_and_b32_dpp v93, v68, v53 row_newbcast:0 row_mask:0xf bank_mask:0xf
    v_mul_u32_u24_dpp v94, v68, v52 row_newbcast:1 row_mask:0xf bank_mask:0xf
    v_and_b32_dpp v95, v68, v53 row_newbcast:1 row_mask:0xf bank_mask:0xf
    v_mul_u32_u24_dpp v96, v68, v52 row_newbcast:2 row_mask:0xf bank_mask:0xf
    v_and_b32_dpp v97, v68, v53 row_newbcast:2 row_mask:0xf bank_mask:0xf
    v_mul_u32_u24_dpp v98, v68, v52 row_newbcast:3 row_mask:0xf bank_mask:0xf
    v_and_b32_dpp v99, v68, v53 row_newbcast:3 row_mask:0xf bank_mask:0xf
    v_mul_u32_u24_dpp v100, v68, v52 row_newbcast:4 row_mask:0xf bank_mask:0xf
    v_and_b32_dpp v101, v68, v53 row_newbcast:4 row_mask:0xf bank_mask:0xf
    v_mul_u32_u24_dpp v102, v68, v52 row_newbcast:5 row_mask:0xf bank_mask:0xf
    v_and_b32_dpp v103, v68, v53 row_newbcast:5 row_mask:0xf bank_mask:0xf
    v_mul_u32_u24_dpp v104, v68, v52 row_newbcast:6 row_mask:0xf bank_mask:0xf
    v_and_b32_dpp v105, v68, v53 row_newbcast:6 row_mask:0xf bank_mask:0xf
    v_mul_u32_u24_dpp v106, v68, v52 row_newbcast:7 row_mask:0xf bank_mask:0xf
    v_and_b32_dpp v107, v68, v53 row_newbcast:7 row_mask:0xf bank_mask:0xf
    v_mul_u32_u24_dpp v108, v69, v52 row_newbcast:0 row_mask:0xf bank_mask:0xf
    v_and_b32_dpp v109, v69, v53 row_newbcast:0 row_mask:0xf bank_mask:0xf
    v_mul_u32_u24_dpp v110, v69, v52 row_newbcast:1 row_mask:0xf bank_mask:0xf
    v_and_b32_dpp v111, v69, v53 row_newbcast:1 row_mask:0xf bank_mask:0xf
    v_mul_u32_u24_dpp v112, v69, v52 row_newbcast:2 row_mask:0xf bank_mask:0xf
    v_and_b32_dpp v113, v69, v53 row_newbcast:2 row_mask:0xf bank_mask:0xf
    v_mul_u32_u24_dpp v114, v69, v52 row_newbcast:3 row_mask:0xf bank_mask:0xf
    v_and_b32_dpp v115, v69, v53 row_newbcast:3 row_mask:0xf bank_mask:0xf
    v_mul_u32_u24_dpp v116, v69, v52 row_newbcast:4 row_mask:0xf bank_mask:0xf
    v_and_b32_dpp v117, v69, v53 row_newbcast:4 row_mask:0xf bank_mask:0xf
    v_mul_u32_u24_dpp v118, v69, v52 row_newbcast:5 row_mask:0xf bank_mask:0xf
    v_and_b32_dpp v119, v69, v53 row_newbcast:5 row_mask:0xf bank_mask:0xf
    v_mul_u32_u24_dpp v120, v69, v52 row_newbcast:6 row_mask:0xf bank_mask:0xf
    v_and_b32_dpp v121, v69, v53 row_newbcast:6 row_mask:0xf bank_mask:0xf
    v_mul_u32_u24_dpp v122, v69, v52 row_newbcast:7 row_mask:0xf bank_mask:0xf
    v_and_b32_dpp v123, v69, v53 row_newbcast:7 row_mask:0xf bank_mask:0xf
    s_waitcnt vmcnt(0)
    v_bitop3_b32 v4, v127, v131, s4 bitop3:0x7e
    v_bitop3_b32 v4, v4, v135, s4 bitop3:0xf6
    v_bitop3_b32 v4, v4, v139, s4 bitop3:0xf6
    v_cmp_ne_u32 vcc, 0, v4
    s_cbranch_vccz TOK_42
POLL_43:
    s_mov_b32 s13, s19
    buffer_load_dwordx4 v[124:127], v44, s[32:35], s13 offen sc1
    s_add_u32 s13, s19, 8192
    buffer_load_dwordx4 v[128:131], v44, s[32:35], s13 offen sc1
    s_add_u32 s13, s19, 16384
    buffer_load_dwordx4 v[132:135], v44, s[32:35], s13 offen sc1
    s_add_u32 s13, s19, 24576
    buffer_load_dwordx4 v[136:139], v44, s[32:35], s13 offen sc1
    s_waitcnt vmcnt(0)
    v_bitop3_b32 v4, v127, v131, s4 bitop3:0x7e
    v_bitop3_b32 v4, v4, v135, s4 bitop3:0xf6
    v_bitop3_b32 v4, v4, v139, s4 bitop3:0xf6
    v_cmp_ne_u32 vcc, 0, v4
    s_cbranch_vccz PDONE_44
    s_add_u32 s5, s5, 1
    s_cmp_lt_u32 s5, 300000
    s_cbranch_scc1 POLL_43
PDONE_44:
TOK_42:
    s_lshl2_add_u32 s96, s74, s75
    s_lshl_b32 s97, s96, 11
    s_lshl_b32 s98, s3, 8
    s_add_u32 s99, s97, s98
    s_add_u32 s15, s99, 20971520
    v_lshlrev_b32 v44, 7, v1
    s_mov_b64 exec, 3
    buffer_load_dword v44, v44, s[32:35], s15 offen
    s_mov_b64 exec, -1
    s_add_u32 s15, s81, 4096
    s_lshl2_add_u32 m0, s89, 99328
    s_nop 0
    buffer_load_dwordx4 v73, s[60:63], s15 offen nt lds
    v_pk_add_f32 v[124:125], v[124:125], v[128:129]
    v_pk_add_f32 v[132:133], v[132:133], v[136:137]
    v_add_f32 v126, v126, v130
    v_add_f32 v134, v134, v138
    v_pk_add_f32 v[124:125], v[124:125], v[132:133]
    v_add_f32 v126, v126, v134
    v_mov_b32 v127, v125
    s_nop 0
    v_permlane32_swap_b32 v124, v126
    v_permlane32_swap_b32 v125, v127
    v_add_f32 v124, v124, v126
    v_add_f32 v125, v125, v127
    s_nop 1
    v_permlane16_swap_b32 v124, v125
    v_add_f32 v127, v124, v125
    v_add_f32 v124, v124, v125
    s_nop 1
    v_permlane16_swap_b32 v124, v127
    v_mul_f32 v126, 0x3a800000, v124
    v_mul_f32 v124, 0x3a800000, v124
    s_nop 1
    v_permlane32_swap_b32 v124, v126
    v_fma_f32 v21, -v124, v124, v126
    v_cvt_pk_bf16_f32 v20, 0, v124
    v_max_f32 v21, 0, v21
    v_cvt_pk_bf16_f32 v21, 0, v21
    v_add_f32 v21, 0x3727c5ac, v21
    v_cvt_pk_bf16_f32 v21, 0, v21
    v_sqrt_f32 v21, v21
    s_nop 0
    v_cvt_pk_bf16_f32 v21, 0, v21
    s_lshl3_add_u32 s13, s3, 136192
    v_rcp_f32 v21, v21
    v_fma_f32 v127, -v20, v26, v127
    v_mov_b32 v5, s13
    v_mul_f32 v127, v127, v21
    ds_write_b64 v8, v[20:21]
    s_movk_i32 s13, 0xfff
    v_ashrrev_i32 v124, 31, v127
    v_or_b32 v124, 0x80000000, v124
    v_xor_b32 v124, v124, v127
    v_bfi_b32 v48, s13, v22, v124
    s_nop 1
    v_min_u32_dpp v49, v48, v48 row_ror:8 row_mask:0xf bank_mask:0xf
    v_max_u32_dpp v48, v48, v48 row_ror:8 row_mask:0xf bank_mask:0xf
    s_nop 1
    v_min_u32_dpp v50, v48, v48 row_ror:4 row_mask:0xf bank_mask:0xf
    v_max_u32_dpp v49, v49, v49 row_ror:4 row_mask:0xf bank_mask:0xf
    v_max_u32_dpp v48, v48, v48 row_ror:4 row_mask:0xf bank_mask:0xf
    v_max_u32 v49, v49, v50
    s_nop 0
    v_min_u32_dpp v50, v48, v48 row_ror:2 row_mask:0xf bank_mask:0xf
    v_max_u32_dpp v49, v49, v49 row_ror:2 row_mask:0xf bank_mask:0xf
    v_max_u32_dpp v48, v48, v48 row_ror:2 row_mask:0xf bank_mask:0xf
    v_max_u32 v49, v49, v50
    s_nop 0
    v_min_u32_dpp v50, v48, v48 row_ror:1 row_mask:0xf bank_mask:0xf
    v_max_u32_dpp v49, v49, v49 row_ror:1 row_mask:0xf bank_mask:0xf
    v_max_u32_dpp v48, v48, v48 row_ror:1 row_mask:0xf bank_mask:0xf
    v_max_u32 v49, v49, v50
    ds_write_b64 v5, v[48:49]
    v_and_b32 v6, 3, v1
    v_lshlrev_b32 v6, 18, v6
    v_bfe_u32 v9, v1, 2, 2
    v_lshl_add_u32 v6, v9, 13, v6
    s_and_b32 s96, s21, 1
    s_and_b32 s97, s12, 7
    s_lshr_b32 s98, s12, 3
    s_lshl3_add_u32 s99, s97, s98
    s_lshl_b32 s97, s99, 12
    s_lshr_b32 s98, s21, 1
    s_lshl_b32 s99, s98, 6
    s_add_u32 s98, s97, s99
    s_lshl4_add_u32 s97, s96, s98
    s_add_u32 s99, s97, 1048576
    s_add_u32 s14, s99, 2560
    s_waitcnt lgkmcnt(0)
    s_barrier
    ds_read_b64 v[48:49], v11
    ds_read_b64 v[20:21], v10
    s_waitcnt lgkmcnt(1)
    v_min_u32_dpp v50, v48, v48 quad_perm:[1,0,3,2] row_mask:0xf bank_mask:0xf
    v_max_u32_dpp v49, v49, v49 quad_perm:[1,0,3,2] row_mask:0xf bank_mask:0xf
    v_max_u32_dpp v48, v48, v48 quad_perm:[1,0,3,2] row_mask:0xf bank_mask:0xf
    v_max_u32 v49, v49, v50
    s_nop 0
    v_min_u32_dpp v50, v48, v48 quad_perm:[2,3,0,1] row_mask:0xf bank_mask:0xf
    v_max_u32_dpp v49, v49, v49 quad_perm:[2,3,0,1] row_mask:0xf bank_mask:0xf
    v_max_u32_dpp v48, v48, v48 quad_perm:[2,3,0,1] row_mask:0xf bank_mask:0xf
    v_max_u32 v49, v49, v50
    s_nop 0
    v_min_u32_dpp v50, v48, v48 row_half_mirror row_mask:0xf bank_mask:0xf
    v_max_u32_dpp v49, v49, v49 row_half_mirror row_mask:0xf bank_mask:0xf
    v_max_u32_dpp v48, v48, v48 row_half_mirror row_mask:0xf bank_mask:0xf
    v_max_u32 v49, v49, v50
    v_or_b32 v50, 1, v49
    v_mov_b32 v49, s4
    v_mov_b32 v51, s4
    s_cmp_lg_u32 s3, 0
    s_cbranch_scc1 L_NOF
    s_mov_b64 exec, 0xffff
    buffer_store_dwordx4 v[48:51], v6, s[32:35], s14 offen sc1
    s_mov_b64 exec, -1
L_NOF:
    s_cmp_lg_u32 s3, 1
    s_cbranch_scc1 L_NOC
    v_and_b32 v4, 16, v1
    v_cmp_eq_u32 vcc, 0, v4
    s_nop 1
    v_cndmask_b32 v4, v50, v48, vcc
    v_not_b32 v4, v4
    v_bfe_u32 v4, v4, 1, 7
    v_lshlrev_b32 v6, 3, v4
    v_mul_u32_u24 v4, 144, v4
    v_add_u32 v6, 135168, v6
    v_and_b32 v5, 15, v1
    v_lshlrev_b32 v5, 3, v5
    v_add_u32 v4, v4, v5
    ds_read_b64 v[128:129], v6
    ds_read_b64 v[124:125], v4 offset:0
    v_and_b32 v6, 15, v1
    v_lshlrev_b32 v6, 4, v6
    v_bfe_u32 v9, v1, 4, 1
    v_lshl_add_u32 v6, v9, 14, v6
    v_lshrrev_b32 v9, 5, v1
    v_lshl_add_u32 v6, v9, 12, v6
    v_bfe_u32 v7, v1, 4, 1
    v_lshlrev_b32 v7, 14, v7
    s_lshl_b32 s96, s21, 15
    s_lshl_b32 s97, s12, 8
    s_add_u32 s98, s96, s97
    s_add_u32 s13, s98, 33554432
    s_lshl_b32 s96, s21, 15
    s_lshl3_add_u32 s97, s12, s96
    s_add_u32 s98, s97, 8192
    s_add_u32 s16, s98, 33554432
    v_mov_b32 v127, s4
    s_waitcnt lgkmcnt(0)
    v_lshlrev_b32 v132, 16, v124
    v_and_b32 v133, s6, v124
    v_lshlrev_b32 v134, 16, v125
    v_and_b32 v135, s6, v125
    v_pk_add_f32 v[132:133], v[132:133], v[128:129] op_sel_hi:[1,0] neg_lo:[0,1] neg_hi:[0,1]
    v_pk_add_f32 v[134:135], v[134:135], v[128:129] op_sel_hi:[1,0] neg_lo:[0,1] neg_hi:[0,1]
    v_cvt_pk_bf16_f32 v132, 0, v132
    v_cvt_pk_bf16_f32 v133, 0, v133
    v_cvt_pk_bf16_f32 v134, 0, v134
    v_cvt_pk_bf16_f32 v135, 0, v135
    v_pk_mul_f32 v[132:133], v[132:133], v[128:129] op_sel:[0,1]
    v_pk_mul_f32 v[134:135], v[134:135], v[128:129] op_sel:[0,1]
    v_cvt_pk_bf16_f32 v132, 0, v132
    v_cvt_pk_bf16_f32 v133, 0, v133
    v_cvt_pk_bf16_f32 v134, 0, v134
    v_cvt_pk_bf16_f32 v135, 0, v135
    v_pk_mul_f32 v[132:133], v[132:133], v[152:153]
    v_pk_mul_f32 v[134:135], v[134:135], v[154:155]
    v_cvt_pk_bf16_f32 v132, 0, v132
    v_cvt_pk_bf16_f32 v133, 0, v133
    v_cvt_pk_bf16_f32 v134, 0, v134
    v_cvt_pk_bf16_f32 v135, 0, v135
    v_pk_add_f32 v[132:133], v[132:133], v[148:149]
    v_pk_add_f32 v[134:135], v[134:135], v[150:151]
    v_mov_b32 v126, v125
    v_mov_b32 v125, s4
    s_mov_b32 exec_hi, 0
    v_cvt_pk_bf16_f32 v124, v132, v133
    v_cvt_pk_bf16_f32 v126, v134, v135
    s_mov_b32 exec_hi, -1
    v_dot2_f32_bf16 v128, v124, v156, 0
    v_mov_b32 v129, s4
    v_dot2_f32_bf16 v128, v126, v157, v128
    buffer_store_dwordx4 v[124:127], v6, s[32:35], s13 offen sc1
    s_nop 1
    v_add_f32_dpp v128, v128, v128 quad_perm:[1,0,3,2] row_mask:0xf bank_mask:0xf
    s_nop 1
    v_add_f32_dpp v128, v128, v128 quad_perm:[2,3,0,1] row_mask:0xf bank_mask:0xf
    s_nop 1
    v_add_f32_dpp v128, v128, v128 row_half_mirror row_mask:0xf bank_mask:0xf
    s_nop 1
    v_add_f32_dpp v128, v128, v128 row_ror:8 row_mask:0xf bank_mask:0xf
    s_mov_b64 exec, 0x10001
    buffer_store_dwordx2 v[128:129], v7, s[32:35], s16 offen sc1
    s_mov_b64 exec, -1
L_NOC:
    s_waitcnt lgkmcnt(0)
    s_mov_b32 exec_lo, 0xff
    s_mov_b32 exec_hi, 0xff
    buffer_store_dwordx2 v[224:225], v226, s[32:35], 0 offen sc1
    s_mov_b64 exec, -1
    s_add_u32 s13, s81, 8192
    s_lshl2_add_u32 m0, s89, 100352
    s_nop 0
    buffer_load_dwordx4 v73, s[60:63], s13 offen nt lds
    s_load_dwordx8 s[24:31], s[32:33], s92 offset:2560 glc
    v_pk_add_f32 v[76:77], v[28:29], v[20:21] op_sel_hi:[1,0] neg_lo:[0,1] neg_hi:[0,1]
    v_pk_add_f32 v[78:79], v[30:31], v[20:21] op_sel_hi:[1,0] neg_lo:[0,1] neg_hi:[0,1]
    v_pk_add_f32 v[80:81], v[32:33], v[20:21] op_sel_hi:[1,0] neg_lo:[0,1] neg_hi:[0,1]
    v_pk_add_f32 v[82:83], v[34:35], v[20:21] op_sel_hi:[1,0] neg_lo:[0,1] neg_hi:[0,1]
    v_pk_add_f32 v[84:85], v[36:37], v[20:21] op_sel_hi:[1,0] neg_lo:[0,1] neg_hi:[0,1]
    v_pk_add_f32 v[86:87], v[38:39], v[20:21] op_sel_hi:[1,0] neg_lo:[0,1] neg_hi:[0,1]
    v_pk_add_f32 v[88:89], v[40:41], v[20:21] op_sel_hi:[1,0] neg_lo:[0,1] neg_hi:[0,1]
    v_pk_add_f32 v[90:91], v[42:43], v[20:21] op_sel_hi:[1,0] neg_lo:[0,1] neg_hi:[0,1]
    v_cvt_pk_bf16_f32 v76, 0, v76
    v_cvt_pk_bf16_f32 v77, 0, v77
    v_cvt_pk_bf16_f32 v78, 0, v78
    v_cvt_pk_bf16_f32 v79, 0, v79
    v_cvt_pk_bf16_f32 v80, 0, v80
    v_cvt_pk_bf16_f32 v81, 0, v81
    v_cvt_pk_bf16_f32 v82, 0, v82
    v_cvt_pk_bf16_f32 v83, 0, v83
    v_cvt_pk_bf16_f32 v84, 0, v84
    v_cvt_pk_bf16_f32 v85, 0, v85
    v_cvt_pk_bf16_f32 v86, 0, v86
    v_cvt_pk_bf16_f32 v87, 0, v87
    v_cvt_pk_bf16_f32 v88, 0, v88
    v_cvt_pk_bf16_f32 v89, 0, v89
    v_cvt_pk_bf16_f32 v90, 0, v90
    v_cvt_pk_bf16_f32 v91, 0, v91
    v_pk_mul_f32 v[76:77], v[76:77], v[20:21] op_sel:[0,1]
    v_pk_mul_f32 v[78:79], v[78:79], v[20:21] op_sel:[0,1]
    v_pk_mul_f32 v[80:81], v[80:81], v[20:21] op_sel:[0,1]
    v_pk_mul_f32 v[82:83], v[82:83], v[20:21] op_sel:[0,1]
    v_pk_mul_f32 v[84:85], v[84:85], v[20:21] op_sel:[0,1]
    v_pk_mul_f32 v[86:87], v[86:87], v[20:21] op_sel:[0,1]
    v_pk_mul_f32 v[88:89], v[88:89], v[20:21] op_sel:[0,1]
    v_pk_mul_f32 v[90:91], v[90:91], v[20:21] op_sel:[0,1]
    v_cvt_pk_bf16_f32 v76, 0, v76
    v_cvt_pk_bf16_f32 v77, 0, v77
    v_cvt_pk_bf16_f32 v78, 0, v78
    v_cvt_pk_bf16_f32 v79, 0, v79
    v_cvt_pk_bf16_f32 v80, 0, v80
    v_cvt_pk_bf16_f32 v81, 0, v81
    v_cvt_pk_bf16_f32 v82, 0, v82
    v_cvt_pk_bf16_f32 v83, 0, v83
    v_cvt_pk_bf16_f32 v84, 0, v84
    v_cvt_pk_bf16_f32 v85, 0, v85
    v_cvt_pk_bf16_f32 v86, 0, v86
    v_cvt_pk_bf16_f32 v87, 0, v87
    v_cvt_pk_bf16_f32 v88, 0, v88
    v_cvt_pk_bf16_f32 v89, 0, v89
    v_cvt_pk_bf16_f32 v90, 0, v90
    v_cvt_pk_bf16_f32 v91, 0, v91
    v_pk_mul_f32 v[76:77], v[76:77], v[108:109]
    v_pk_mul_f32 v[78:79], v[78:79], v[110:111]
    v_pk_mul_f32 v[80:81], v[80:81], v[112:113]
    v_pk_mul_f32 v[82:83], v[82:83], v[114:115]
    v_pk_mul_f32 v[84:85], v[84:85], v[116:117]
    v_pk_mul_f32 v[86:87], v[86:87], v[118:119]
    v_pk_mul_f32 v[88:89], v[88:89], v[120:121]
    v_pk_mul_f32 v[90:91], v[90:91], v[122:123]
    v_cvt_pk_bf16_f32 v76, 0, v76
    v_cvt_pk_bf16_f32 v77, 0, v77
    v_cvt_pk_bf16_f32 v78, 0, v78
    v_cvt_pk_bf16_f32 v79, 0, v79
    v_cvt_pk_bf16_f32 v80, 0, v80
    v_cvt_pk_bf16_f32 v81, 0, v81
    v_cvt_pk_bf16_f32 v82, 0, v82
    v_cvt_pk_bf16_f32 v83, 0, v83
    v_cvt_pk_bf16_f32 v84, 0, v84
    v_cvt_pk_bf16_f32 v85, 0, v85
    v_cvt_pk_bf16_f32 v86, 0, v86
    v_cvt_pk_bf16_f32 v87, 0, v87
    v_cvt_pk_bf16_f32 v88, 0, v88
    v_cvt_pk_bf16_f32 v89, 0, v89
    v_cvt_pk_bf16_f32 v90, 0, v90
    v_cvt_pk_bf16_f32 v91, 0, v91
    v_pk_add_f32 v[76:77], v[76:77], v[92:93]
    v_pk_add_f32 v[78:79], v[78:79], v[94:95]
    v_pk_add_f32 v[80:81], v[80:81], v[96:97]
    v_pk_add_f32 v[82:83], v[82:83], v[98:99]
    v_pk_add_f32 v[84:85], v[84:85], v[100:101]
    v_pk_add_f32 v[86:87], v[86:87], v[102:103]
    v_pk_add_f32 v[88:89], v[88:89], v[104:105]
    v_pk_add_f32 v[90:91], v[90:91], v[106:107]
    v_cvt_pk_bf16_f32 v76, 0, v76
    v_cvt_pk_bf16_f32 v77, 0, v77
    v_cvt_pk_bf16_f32 v78, 0, v78
    v_cvt_pk_bf16_f32 v79, 0, v79
    v_cvt_pk_bf16_f32 v80, 0, v80
    v_cvt_pk_bf16_f32 v81, 0, v81
    v_cvt_pk_bf16_f32 v82, 0, v82
    v_cvt_pk_bf16_f32 v83, 0, v83
    v_cvt_pk_bf16_f32 v84, 0, v84
    v_cvt_pk_bf16_f32 v85, 0, v85
    v_cvt_pk_bf16_f32 v86, 0, v86
    v_cvt_pk_bf16_f32 v87, 0, v87
    v_cvt_pk_bf16_f32 v88, 0, v88
    v_cvt_pk_bf16_f32 v89, 0, v89
    v_cvt_pk_bf16_f32 v90, 0, v90
    v_cvt_pk_bf16_f32 v91, 0, v91
    s_lshr_b32 s96, s3, 2
    s_lshl_b32 s97, s96, 15
    s_and_b32 s98, s3, 3
    s_lshl_b32 s99, s98, 5
    s_add_u32 s96, s97, s99
    s_add_u32 s13, s96, 32768
    v_lshrrev_b32 v24, 4, v1
    v_lshlrev_b32 v24, 13, v24
    v_bfe_u32 v9, v1, 2, 2
    v_lshl_add_u32 v24, v9, 7, v24
    v_bfe_u32 v9, v1, 3, 2
    v_lshl_add_u32 v24, v9, 5, v24
    v_and_b32 v9, 3, v1
    v_lshl_add_u32 v24, v9, 3, v24
    v_xor_b32 v24, s13, v24
    s_lshl_b32 s13, s3, 6
    v_bfe_u32 v45, v1, 2, 1
    v_lshlrev_b32 v45, 9, v45
    v_bfe_u32 v9, v1, 3, 1
    v_lshl_add_u32 v45, v9, 12, v45
    v_lshrrev_b32 v9, 5, v1
    v_lshl_add_u32 v45, v9, 11, v45
    v_bfe_u32 v9, v1, 2, 2
    v_lshl_add_u32 v45, v9, 6, v45
    v_bfe_u32 v9, v1, 4, 1
    v_lshl_add_u32 v45, v9, 5, v45
    v_and_b32 v9, 3, v1
    v_lshl_add_u32 v45, v9, 3, v45
    v_xor_b32 v45, s13, v45
    v_add_u32 v45, 98304, v45
    v_and_b32 v46, 7, v1
    v_lshlrev_b32 v46, 4, v46
    v_lshrrev_b32 v9, 4, v1
    v_lshl_add_u32 v46, v9, 7, v46
    v_add_u32 v46, 136704, v46
    s_lshl4_add_u32 s13, s3, 136256
    v_mov_b32 v4, s13
    v_and_b32 v5, 7, v1
    v_lshlrev_b32 v5, 4, v5
    v_add_u32 v5, 136256, v5
    v_and_b32 v8, 8, v1
    v_cmp_eq_u32 s[22:23], 0, v8
    s_branch SCHK_46
SPOLL_45:
    s_load_dwordx8 s[24:31], s[32:33], s92 offset:2560 glc
SCHK_46:
    s_add_u32 s5, s5, 1
    s_cmp_ge_u32 s5, 300000
    s_waitcnt lgkmcnt(0)
    s_cbranch_scc1 SDONE_47
    s_cmp_lg_u32 s25, s4
    s_cbranch_scc1 SPOLL_45
    s_cmp_lg_u32 s27, s4
    s_cbranch_scc1 SPOLL_45
    s_cmp_lg_u32 s29, s4
    s_cbranch_scc1 SPOLL_45
    s_cmp_lg_u32 s31, s4
    s_cbranch_scc1 SPOLL_45
SDONE_47:
    s_min_u32 s25, s24, s28
    s_max_u32 s24, s24, s28
    s_max_u32 s27, s26, s30
    s_min_u32 s26, s26, s30
    s_max_u32 s28, s25, s27
    s_min_u32 s25, s25, s27
    v_mov_b32 v148, s24
    v_mov_b32 v151, s26
    v_mov_b32 v149, s28
    v_mov_b32 v150, s25
    ds_write_b128 v4, v[148:151]
    s_waitcnt lgkmcnt(0)
    s_barrier
    s_cmp_lt_u32 s3, 4
    s_cbranch_scc1 L_CSEL
    ds_read_b64_tr_b16 v[164:165], v24
    ds_read_b64_tr_b16 v[166:167], v24 offset:512
    ds_read_b64_tr_b16 v[168:169], v24 offset:1024
    ds_read_b64_tr_b16 v[170:171], v24 offset:1536
    ds_read_b64_tr_b16 v[172:173], v24 offset:2048
    ds_read_b64_tr_b16 v[174:175], v24 offset:2560
    ds_read_b64_tr_b16 v[176:177], v24 offset:3072
    ds_read_b64_tr_b16 v[178:179], v24 offset:3584
    ds_read_b64_tr_b16 v[180:181], v24 offset:4096
    ds_read_b64_tr_b16 v[182:183], v24 offset:4608
    ds_read_b64_tr_b16 v[184:185], v24 offset:5120
    ds_read_b64_tr_b16 v[186:187], v24 offset:5632
    ds_read_b64_tr_b16 v[188:189], v24 offset:6144
    ds_read_b64_tr_b16 v[190:191], v24 offset:6656
    ds_read_b64_tr_b16 v[192:193], v24 offset:7168
    ds_read_b64_tr_b16 v[194:195], v24 offset:7680
    v_mul_u32_u24_dpp v92, v70, v52 row_newbcast:0 row_mask:0xf bank_mask:0xf
    v_and_b32_dpp v93, v70, v53 row_newbcast:0 row_mask:0xf bank_mask:0xf
    v_mul_u32_u24_dpp v94, v70, v52 row_newbcast:1 row_mask:0xf bank_mask:0xf
    v_and_b32_dpp v95, v70, v53 row_newbcast:1 row_mask:0xf bank_mask:0xf
    v_mul_u32_u24_dpp v96, v70, v52 row_newbcast:2 row_mask:0xf bank_mask:0xf
    v_and_b32_dpp v97, v70, v53 row_newbcast:2 row_mask:0xf bank_mask:0xf
    v_mul_u32_u24_dpp v98, v70, v52 row_newbcast:3 row_mask:0xf bank_mask:0xf
    v_and_b32_dpp v99, v70, v53 row_newbcast:3 row_mask:0xf bank_mask:0xf
    v_mul_u32_u24_dpp v100, v70, v52 row_newbcast:4 row_mask:0xf bank_mask:0xf
    v_and_b32_dpp v101, v70, v53 row_newbcast:4 row_mask:0xf bank_mask:0xf
    v_mul_u32_u24_dpp v102, v70, v52 row_newbcast:5 row_mask:0xf bank_mask:0xf
    v_and_b32_dpp v103, v70, v53 row_newbcast:5 row_mask:0xf bank_mask:0xf
    v_mul_u32_u24_dpp v104, v70, v52 row_newbcast:6 row_mask:0xf bank_mask:0xf
    v_and_b32_dpp v105, v70, v53 row_newbcast:6 row_mask:0xf bank_mask:0xf
    v_mul_u32_u24_dpp v106, v70, v52 row_newbcast:7 row_mask:0xf bank_mask:0xf
    v_and_b32_dpp v107, v70, v53 row_newbcast:7 row_mask:0xf bank_mask:0xf
    v_pk_mul_f32 v[76:77], v[76:77], v[92:93]
    v_pk_mul_f32 v[78:79], v[78:79], v[94:95]
    v_pk_mul_f32 v[80:81], v[80:81], v[96:97]
    v_pk_mul_f32 v[82:83], v[82:83], v[98:99]
    v_pk_mul_f32 v[84:85], v[84:85], v[100:101]
    v_pk_mul_f32 v[86:87], v[86:87], v[102:103]
    v_pk_mul_f32 v[88:89], v[88:89], v[104:105]
    v_pk_mul_f32 v[90:91], v[90:91], v[106:107]
    v_cvt_pk_bf16_f32 v76, 0, v76
    v_cvt_pk_bf16_f32 v77, 0, v77
    v_cvt_pk_bf16_f32 v78, 0, v78
    v_cvt_pk_bf16_f32 v79, 0, v79
    v_cvt_pk_bf16_f32 v80, 0, v80
    v_cvt_pk_bf16_f32 v81, 0, v81
    v_cvt_pk_bf16_f32 v82, 0, v82
    v_cvt_pk_bf16_f32 v83, 0, v83
    v_cvt_pk_bf16_f32 v84, 0, v84
    v_cvt_pk_bf16_f32 v85, 0, v85
    v_cvt_pk_bf16_f32 v86, 0, v86
    v_cvt_pk_bf16_f32 v87, 0, v87
    v_cvt_pk_bf16_f32 v88, 0, v88
    v_cvt_pk_bf16_f32 v89, 0, v89
    v_cvt_pk_bf16_f32 v90, 0, v90
    v_cvt_pk_bf16_f32 v91, 0, v91
    v_pk_add_f32 v[76:77], v[76:77], v[28:29]
    v_pk_add_f32 v[78:79], v[78:79], v[30:31]
    v_pk_add_f32 v[80:81], v[80:81], v[32:33]
    v_pk_add_f32 v[82:83], v[82:83], v[34:35]
    v_pk_add_f32 v[84:85], v[84:85], v[36:37]
    v_pk_add_f32 v[86:87], v[86:87], v[38:39]
    v_pk_add_f32 v[88:89], v[88:89], v[40:41]
    v_pk_add_f32 v[90:91], v[90:91], v[42:43]
    v_cvt_pk_bf16_f32 v140, v76, v77
    v_cvt_pk_bf16_f32 v141, v78, v79
    v_cvt_pk_bf16_f32 v142, v80, v81
    v_cvt_pk_bf16_f32 v143, v82, v83
    v_cvt_pk_bf16_f32 v144, v84, v85
    v_cvt_pk_bf16_f32 v145, v86, v87
    v_cvt_pk_bf16_f32 v146, v88, v89
    v_cvt_pk_bf16_f32 v147, v90, v91
    ds_write_b128 v23, v[140:143]
    ds_write_b128 v23, v[144:147] offset:16
    s_mul_i32 s96, s3, 2304
    s_add_u32 s16, s96, 139776
    v_lshrrev_b32 v23, 3, v1
    v_mul_u32_u24 v23, 144, v23
    v_and_b32 v9, 7, v1
    v_lshl_add_u32 v23, v9, 4, v23
    v_add_u32 v23, s16, v23
    s_add_u32 s13, s81, 12288
    s_lshl2_add_u32 m0, s89, 101376
    s_nop 0
    buffer_load_dwordx4 v73, s[60:63], s13 offen nt lds
    s_branch L_CSELD
L_CSEL:
    ds_read_b128 v[148:151], v5
    s_lshl_b32 s96, s3, 9
    s_add_u32 s13, s96, 136704
    v_add_u32 v6, s13, v63
    s_lshl2_add_u32 s13, s3, 136384
    v_mov_b32 v7, s13
    s_waitcnt lgkmcnt(0)
    v_max_u32_dpp v152, v151, v148 quad_perm:[1,0,3,2] row_mask:0xf bank_mask:0xf
    v_max_u32_dpp v153, v150, v149 quad_perm:[1,0,3,2] row_mask:0xf bank_mask:0xf
    v_max_u32_dpp v154, v149, v150 quad_perm:[1,0,3,2] row_mask:0xf bank_mask:0xf
    v_max_u32_dpp v155, v148, v151 quad_perm:[1,0,3,2] row_mask:0xf bank_mask:0xf
    v_max_u32 v156, v152, v154
    v_max_u32 v157, v153, v155
    v_min_u32 v158, v152, v154
    v_min_u32 v159, v153, v155
    v_max_u32 v148, v156, v157
    v_min_u32 v149, v156, v157
    v_max_u32 v150, v158, v159
    v_min_u32 v151, v158, v159
    s_nop 1
    v_max_u32_dpp v152, v151, v148 quad_perm:[2,3,0,1] row_mask:0xf bank_mask:0xf
    v_max_u32_dpp v153, v150, v149 quad_perm:[2,3,0,1] row_mask:0xf bank_mask:0xf
    v_max_u32_dpp v154, v149, v150 quad_perm:[2,3,0,1] row_mask:0xf bank_mask:0xf
    v_max_u32_dpp v155, v148, v151 quad_perm:[2,3,0,1] row_mask:0xf bank_mask:0xf
    v_max_u32 v156, v152, v154
    v_max_u32 v157, v153, v155
    v_min_u32 v158, v152, v154
    v_min_u32 v159, v153, v155
    v_max_u32 v148, v156, v157
    v_min_u32 v149, v156, v157
    v_max_u32 v150, v158, v159
    v_min_u32 v151, v158, v159
    s_nop 1
    v_max_u32_dpp v152, v151, v148 row_half_mirror row_mask:0xf bank_mask:0xf
    v_max_u32_dpp v153, v150, v149 row_half_mirror row_mask:0xf bank_mask:0xf
    v_max_u32_dpp v154, v149, v150 row_half_mirror row_mask:0xf bank_mask:0xf
    v_max_u32_dpp v155, v148, v151 row_half_mirror row_mask:0xf bank_mask:0xf
    v_readfirstlane_b32 s24, v152
    v_readfirstlane_b32 s25, v153
    v_readfirstlane_b32 s26, v154
    v_readfirstlane_b32 s27, v155
    s_bitcmp1_b32 s3, 0
    s_cselect_b32 s24, s25, s24
    s_cselect_b32 s26, s27, s26
    s_bitcmp1_b32 s3, 1
    s_cselect_b32 s24, s26, s24
    s_and_b32 s15, s24, 4095
    s_lshr_b32 s96, s15, 8
    s_sub_u32 s97, 15, s96
    s_and_b32 s98, s15, 1
    s_lshl1_add_u32 s99, s97, s98
    s_lshl_b32 s96, s99, 14
    s_add_u32 s13, s96, 33554432
    s_lshl_b32 s96, s75, 10
    s_add_u32 s14, s96, s13
    s_add_u32 s13, s13, 8192
    v_and_b32 v10, 15, v1
    v_lshlrev_b32 v10, 3, v10
    buffer_load_dwordx2 v[152:153], v10, s[32:35], s13 offen sc1
    buffer_load_dwordx4 v[148:151], v2, s[32:35], s14 offen sc1
    s_add_u32 s16, s81, 12288
    s_lshl2_add_u32 m0, s89, 101376
    s_nop 0
    buffer_load_dwordx4 v73, s[60:63], s16 offen nt lds
    ds_read_b64_tr_b16 v[164:165], v24
    ds_read_b64_tr_b16 v[166:167], v24 offset:512
    ds_read_b64_tr_b16 v[168:169], v24 offset:1024
    ds_read_b64_tr_b16 v[170:171], v24 offset:1536
    ds_read_b64_tr_b16 v[172:173], v24 offset:2048
    ds_read_b64_tr_b16 v[174:175], v24 offset:2560
    ds_read_b64_tr_b16 v[176:177], v24 offset:3072
    ds_read_b64_tr_b16 v[178:179], v24 offset:3584
    ds_read_b64_tr_b16 v[180:181], v24 offset:4096
    ds_read_b64_tr_b16 v[182:183], v24 offset:4608
    ds_read_b64_tr_b16 v[184:185], v24 offset:5120
    ds_read_b64_tr_b16 v[186:187], v24 offset:5632
    ds_read_b64_tr_b16 v[188:189], v24 offset:6144
    ds_read_b64_tr_b16 v[190:191], v24 offset:6656
    ds_read_b64_tr_b16 v[192:193], v24 offset:7168
    ds_read_b64_tr_b16 v[194:195], v24 offset:7680
    v_mul_u32_u24_dpp v92, v70, v52 row_newbcast:0 row_mask:0xf bank_mask:0xf
    v_and_b32_dpp v93, v70, v53 row_newbcast:0 row_mask:0xf bank_mask:0xf
    v_mul_u32_u24_dpp v94, v70, v52 row_newbcast:1 row_mask:0xf bank_mask:0xf
    v_and_b32_dpp v95, v70, v53 row_newbcast:1 row_mask:0xf bank_mask:0xf
    v_mul_u32_u24_dpp v96, v70, v52 row_newbcast:2 row_mask:0xf bank_mask:0xf
    v_and_b32_dpp v97, v70, v53 row_newbcast:2 row_mask:0xf bank_mask:0xf
    v_mul_u32_u24_dpp v98, v70, v52 row_newbcast:3 row_mask:0xf bank_mask:0xf
    v_and_b32_dpp v99, v70, v53 row_newbcast:3 row_mask:0xf bank_mask:0xf
    v_mul_u32_u24_dpp v100, v70, v52 row_newbcast:4 row_mask:0xf bank_mask:0xf
    v_and_b32_dpp v101, v70, v53 row_newbcast:4 row_mask:0xf bank_mask:0xf
    v_mul_u32_u24_dpp v102, v70, v52 row_newbcast:5 row_mask:0xf bank_mask:0xf
    v_and_b32_dpp v103, v70, v53 row_newbcast:5 row_mask:0xf bank_mask:0xf
    v_mul_u32_u24_dpp v104, v70, v52 row_newbcast:6 row_mask:0xf bank_mask:0xf
    v_and_b32_dpp v105, v70, v53 row_newbcast:6 row_mask:0xf bank_mask:0xf
    v_mul_u32_u24_dpp v106, v70, v52 row_newbcast:7 row_mask:0xf bank_mask:0xf
    v_and_b32_dpp v107, v70, v53 row_newbcast:7 row_mask:0xf bank_mask:0xf
    v_pk_mul_f32 v[76:77], v[76:77], v[92:93]
    v_pk_mul_f32 v[78:79], v[78:79], v[94:95]
    v_pk_mul_f32 v[80:81], v[80:81], v[96:97]
    v_pk_mul_f32 v[82:83], v[82:83], v[98:99]
    v_pk_mul_f32 v[84:85], v[84:85], v[100:101]
    v_pk_mul_f32 v[86:87], v[86:87], v[102:103]
    v_pk_mul_f32 v[88:89], v[88:89], v[104:105]
    v_pk_mul_f32 v[90:91], v[90:91], v[106:107]
    v_cvt_pk_bf16_f32 v76, 0, v76
    v_cvt_pk_bf16_f32 v77, 0, v77
    v_cvt_pk_bf16_f32 v78, 0, v78
    v_cvt_pk_bf16_f32 v79, 0, v79
    v_cvt_pk_bf16_f32 v80, 0, v80
    v_cvt_pk_bf16_f32 v81, 0, v81
    v_cvt_pk_bf16_f32 v82, 0, v82
    v_cvt_pk_bf16_f32 v83, 0, v83
    v_cvt_pk_bf16_f32 v84, 0, v84
    v_cvt_pk_bf16_f32 v85, 0, v85
    v_cvt_pk_bf16_f32 v86, 0, v86
    v_cvt_pk_bf16_f32 v87, 0, v87
    v_cvt_pk_bf16_f32 v88, 0, v88
    v_cvt_pk_bf16_f32 v89, 0, v89
    v_cvt_pk_bf16_f32 v90, 0, v90
    v_cvt_pk_bf16_f32 v91, 0, v91
    v_pk_add_f32 v[76:77], v[76:77], v[28:29]
    v_pk_add_f32 v[78:79], v[78:79], v[30:31]
    v_pk_add_f32 v[80:81], v[80:81], v[32:33]
    v_pk_add_f32 v[82:83], v[82:83], v[34:35]
    v_pk_add_f32 v[84:85], v[84:85], v[36:37]
    v_pk_add_f32 v[86:87], v[86:87], v[38:39]
    v_pk_add_f32 v[88:89], v[88:89], v[40:41]
    v_pk_add_f32 v[90:91], v[90:91], v[42:43]
    v_cvt_pk_bf16_f32 v140, v76, v77
    v_cvt_pk_bf16_f32 v141, v78, v79
    v_cvt_pk_bf16_f32 v142, v80, v81
    v_cvt_pk_bf16_f32 v143, v82, v83
    v_cvt_pk_bf16_f32 v144, v84, v85
    v_cvt_pk_bf16_f32 v145, v86, v87
    v_cvt_pk_bf16_f32 v146, v88, v89
    v_cvt_pk_bf16_f32 v147, v90, v91
    ds_write_b128 v23, v[140:143]
    ds_write_b128 v23, v[144:147] offset:16
    s_mul_i32 s96, s3, 2304
    s_add_u32 s16, s96, 139776
    v_lshrrev_b32 v23, 3, v1
    v_mul_u32_u24 v23, 144, v23
    v_and_b32 v9, 7, v1
    v_lshl_add_u32 v23, v9, 4, v23
    v_add_u32 v23, s16, v23
    s_lshl2_add_u32 s15, s15, s3
    s_waitcnt vmcnt(1)
    v_bitop3_b32 v8, v149, v151, s4 bitop3:0x7e
    v_bitop3_b32 v8, v8, v153, s4 bitop3:0xf6
    v_cmp_ne_u32 vcc, 0, v8
    s_cbranch_vccz TOK_49
POLL_50:
    buffer_load_dwordx2 v[152:153], v10, s[32:35], s13 offen sc1
    buffer_load_dwordx4 v[148:151], v2, s[32:35], s14 offen sc1
    s_waitcnt vmcnt(0)
    v_bitop3_b32 v8, v149, v151, s4 bitop3:0x7e
    v_bitop3_b32 v8, v8, v153, s4 bitop3:0xf6
    v_cmp_ne_u32 vcc, 0, v8
    s_cbranch_vccz PDONE_51
    s_add_u32 s5, s5, 1
    s_cmp_lt_u32 s5, 300000
    s_cbranch_scc1 POLL_50
PDONE_51:
TOK_49:
    ds_write2_b32 v6, v148, v150 offset0:0 offset1:1
    v_add_f32_dpp v152, v152, v152 quad_perm:[1,0,3,2] row_mask:0xf bank_mask:0xf
    s_nop 1
    v_add_f32_dpp v152, v152, v152 quad_perm:[2,3,0,1] row_mask:0xf bank_mask:0xf
    s_nop 1
    v_add_f32_dpp v152, v152, v152 row_half_mirror row_mask:0xf bank_mask:0xf
    s_nop 1
    v_add_f32_dpp v152, v152, v152 row_ror:8 row_mask:0xf bank_mask:0xf
    v_cvt_pk_bf16_f32 v152, 0, v152
    v_ashrrev_i32 v153, 31, v152
    v_or_b32 v153, 0x80000000, v153
    v_xor_b32 v152, v152, v153
    v_and_b32 v152, s6, v152
    v_or_b32 v152, s15, v152
    ds_write_b32 v7, v152
L_CSELD:
    v_mov_b32 v4, 136384
    v_and_b32 v8, 15, v1
    v_lshlrev_b32 v8, 4, v8
    v_lshrrev_b32 v9, 5, v1
    v_lshl_add_u32 v8, v9, 3, v8
    s_lshl_b32 s96, s74, 13
    s_add_u32 s14, s96, 20971520
    s_lshl3_add_u32 s96, s75, s3
    s_lshl_b32 s97, s96, 8
    s_add_u32 s20, s97, s14
    s_waitcnt lgkmcnt(0)
    s_barrier
    ds_read_b128 v[148:151], v4
    s_waitcnt lgkmcnt(0)
    v_max_u32 v152, v148, v149
    v_max_u32 v153, v150, v151
    v_min_u32 v154, v148, v149
    v_min_u32 v155, v150, v151
    v_min_u32 v149, v152, v153
    v_max_u32 v148, v152, v153
    v_max3_u32 v149, v149, v154, v155
    v_cndmask_b32 v4, v149, v148, s[22:23]
    v_readfirstlane_b32 s68, v148
    v_and_b32 v4, 3, v4
    v_readfirstlane_b32 s69, v149
    v_lshl_add_u32 v4, v4, 9, v46
    ds_read_b128 v[152:155], v4
    ds_read_b128 v[140:143], v23
    ds_read_b128 v[144:147], v23 offset:1152
    s_bfe_u32 s70, s68, 720899
    s_bfe_u32 s71, s69, 720899
    s_sub_u32 s70, 2047, s70
    s_sub_u32 s71, 2047, s71
    s_waitcnt lgkmcnt(2)
    v_mfma_f32_16x16x32_bf16 v[212:215], v[152:155], v[164:167], 0
    v_mfma_f32_16x16x32_bf16 v[216:219], v[152:155], v[168:171], 0
    v_mfma_f32_16x16x32_bf16 v[220:223], v[152:155], v[172:175], 0
    v_mfma_f32_16x16x32_bf16 v[224:227], v[152:155], v[176:179], 0
    v_mfma_f32_16x16x32_bf16 v[228:231], v[152:155], v[180:183], 0
    v_mfma_f32_16x16x32_bf16 v[232:235], v[152:155], v[184:187], 0
    v_mfma_f32_16x16x32_bf16 v[236:239], v[152:155], v[188:191], 0
    v_mfma_f32_16x16x32_bf16 v[240:243], v[152:155], v[192:195], 0
    s_nop 1
    v_add_f32 v148, v212, v217
    s_nop 0
    v_add_f32 v149, v222, v227
    s_nop 0
    v_add_f32 v150, v228, v233
    s_nop 0
    v_add_f32 v151, v238, v243
    v_add_f32 v148, v148, v149
    v_add_f32 v150, v150, v151
    v_mov_b32 v149, s4
    s_nop 0
    v_permlane16_swap_b32 v150, v151
    s_cmp_ge_u32 s9, 28
    s_cbranch_scc1 L_NOHP
    v_add_f32 v148, v148, v151
    s_mov_b32 exec_lo, 0xffff
    s_mov_b32 exec_hi, 0xffff
    s_cmp_lg_u32 s93, 0
    s_cbranch_scc1 LOC_52
    buffer_store_dwordx2 v[148:149], v8, s[32:35], s20 offen sc1
    s_branch LOCD_53
LOC_52:
    buffer_store_dwordx2 v[148:149], v8, s[32:35], s20 offen
LOCD_53:
    s_mov_b64 exec, -1
L_NOHP:
    v_mov_b32 v56, v148
    v_mov_b32 v57, v149
    v_add_u32 v58, s20, v8
    s_waitcnt lgkmcnt(0)
    s_bitcmp1_b32 s21, 2
    s_cselect_b32 s17, s71, s70
    s_cselect_b32 s18, s69, s68
    s_cmp_lg_u32 s3, 7
    s_cbranch_scc1 L_NOFZ
    s_cmp_lg_u32 s2, 0
    s_cbranch_scc1 L_NONON
    v_mov_b32 v6, s4
    s_mov_b64 exec, 1
    buffer_store_dword v6, v3, s[32:35], 0 offen sc1
    s_mov_b64 exec, -1
L_NONON:
    s_lshr_b32 s96, s21, 3
    s_and_b32 s97, s21, 1
    s_lshl1_add_u32 s19, s96, s97
    s_lshr_b32 s96, s21, 2
    s_lshl_b32 s97, s96, 1
    s_lshl3_add_u32 s98, s12, s97
    s_and_b32 s99, s21, 1
    s_add_u32 s96, s98, s99
    s_mul_i32 s97, s96, 7168
    s_add_u32 s20, s97, 22020096
    s_lshl_b32 s96, s17, 11
    s_lshl_b32 s97, s12, 7
    s_add_u32 s98, s96, s97
    s_lshl_b32 s99, s19, 5
    s_add_u32 s82, s98, s99
    v_and_b32 v10, 7, v1
    v_lshlrev_b32 v10, 2, v10
    s_lshl_b32 s96, s19, 5
    s_add_u32 s13, s96, 139264
    v_add_u32 v5, s13, v10
    ds_read_b32 v74, v5
    s_lshr_b32 s96, s17, 7
    s_bfe_u32 s97, s18, 65538
    s_lshl1_add_u32 s98, s96, s97
    s_lshl_b32 s99, s98, 14
    s_lshl_b32 s96, s12, 8
    s_add_u32 s97, s99, s96
    s_lshl_b32 s98, s19, 6
    s_add_u32 s99, s97, s98
    s_add_u32 s68, s99, 33554432
    s_add_u32 s69, s68, 4096
    v_and_b32 v11, 7, v1
    v_lshlrev_b32 v11, 3, v11
    buffer_load_dwordx2 v[20:21], v11, s[32:35], s68 offen sc1
    buffer_load_dwordx2 v[72:73], v11, s[32:35], s69 offen sc1
    s_and_b32 s13, s18, s6
    s_ashr_i32 s15, s13, 31
    s_andn2_b32 s15, 0x7fff0000, s15
    s_or_b32 s15, s15, 0x80000000
    s_xor_b32 s13, s13, s15
    v_mov_b32 v75, s13
    v_mul_f32 v75, s7, v75
    v_exp_f32 v75, -v75
    s_nop 0
    v_add_f32 v75, 1.0, v75
    v_rcp_f32 v75, v75
    s_nop 0
    v_cvt_pk_bf16_f32 v75, 0, v75
L_NOFZ:
    s_cmp_lt_u32 s9, 28
    s_cbranch_scc1 L_HSEC
    s_branch L_GSEC
L_HSEC:
    s_cmp_lt_u32 s3, 4
    s_cbranch_scc1 L_HW
    s_branch L_NOH
L_HW:
    s_lshl_b32 s96, s3, 8
    s_add_u32 s13, s96, s14
    v_lshrrev_b32 v4, 4, v1
    v_lshlrev_b32 v4, 11, v4
    v_and_b32 v9, 15, v1
    v_lshl_add_u32 v4, v9, 4, v4
    s_lshl_b32 s96, s3, 5
    s_add_u32 s15, s96, 138752
    v_lshrrev_b32 v5, 5, v1
    v_lshl_add_u32 v5, v5, 7, s15
    v_bfe_u32 v9, v1, 2, 1
    v_lshl_add_u32 v5, v9, 4, v5
    v_bfe_u32 v9, v1, 1, 1
    v_lshl_add_u32 v5, v9, 3, v5
    v_bfe_u32 v9, v1, 3, 1
    v_lshl_add_u32 v5, v9, 2, v5
    v_and_b32 v9, 1, v1
    v_lshl_add_u32 v5, v9, 1, v5
    s_cmp_lg_u32 s93, 0
    s_cbranch_scc1 L_HLOC
SPOLL_54:
    s_load_dword s24, s[32:33], s13 offset:1276 glc
    s_load_dword s25, s[32:33], s13 offset:3324 glc
    s_load_dword s26, s[32:33], s13 offset:5372 glc
    s_load_dword s27, s[32:33], s13 offset:7420 glc
SCHK_55:
    s_add_u32 s5, s5, 1
    s_cmp_ge_u32 s5, 300000
    s_waitcnt lgkmcnt(0)
    s_cbranch_scc1 SDONE_56
    s_cmp_lg_u32 s24, s4
    s_cbranch_scc1 SPOLL_54
    s_cmp_lg_u32 s25, s4
    s_cbranch_scc1 SPOLL_54
    s_cmp_lg_u32 s26, s4
    s_cbranch_scc1 SPOLL_54
    s_cmp_lg_u32 s27, s4
    s_cbranch_scc1 SPOLL_54
SDONE_56:
L_HLOC:
    buffer_load_dwordx4 v[212:215], v4, s[32:35], s13 offen sc1
    buffer_load_dwordx4 v[216:219], v4, s[32:35], s13 offen offset:1024 sc1
    s_waitcnt vmcnt(0)
    v_bitop3_b32 v6, v213, v215, s4 bitop3:0x7e
    v_bitop3_b32 v6, v6, v217, s4 bitop3:0xf6
    v_bitop3_b32 v6, v6, v219, s4 bitop3:0xf6
    v_cmp_ne_u32 vcc, 0, v6
    s_cbranch_vccz TOK_58
POLL_59:
    buffer_load_dwordx4 v[212:215], v4, s[32:35], s13 offen sc1
    buffer_load_dwordx4 v[216:219], v4, s[32:35], s13 offen offset:1024 sc1
    s_waitcnt vmcnt(0)
    v_bitop3_b32 v6, v213, v215, s4 bitop3:0x7e
    v_bitop3_b32 v6, v6, v217, s4 bitop3:0xf6
    v_bitop3_b32 v6, v6, v219, s4 bitop3:0xf6
    v_cmp_ne_u32 vcc, 0, v6
    s_cbranch_vccz PDONE_60
    s_add_u32 s5, s5, 1
    s_cmp_lt_u32 s5, 300000
    s_cbranch_scc1 POLL_59
PDONE_60:
TOK_58:
    v_permlane32_swap_b32 v212, v214
    v_permlane32_swap_b32 v216, v218
    v_add_f32 v212, v212, v214
    v_add_f32 v216, v216, v218
    v_mov_b32 v214, v212
    v_mov_b32 v218, v216
    s_nop 0
    v_permlane16_swap_b32 v212, v214
    v_permlane16_swap_b32 v216, v218
    v_add_f32 v212, v212, v214
    v_add_f32 v216, v216, v218
    v_cvt_pk_bf16_f32 v212, 0, v212
    v_cvt_pk_bf16_f32 v216, 0, v216
    v_mul_f32 v6, s7, v212
    v_exp_f32 v6, -v6
    s_nop 0
    v_add_f32 v6, 1.0, v6
    v_rcp_f32 v6, v6
    s_nop 0
    v_mul_f32 v212, v212, v6
    v_cvt_pk_bf16_f32 v212, 0, v212
    v_mul_f32 v212, v212, v216
    v_cvt_pk_bf16_f32 v212, v212, v212
    ds_write_b16 v5, v212
L_NOH:
    v_bfe_u32 v4, v1, 2, 1
    v_lshlrev_b32 v4, 7, v4
    v_lshrrev_b32 v9, 5, v1
    v_lshl_add_u32 v4, v9, 4, v4
    v_add_u32 v4, 138752, v4
    v_lshrrev_b32 v5, 4, v1
    v_mul_u32_u24 v5, 7168, v5
    v_and_b32 v9, 15, v1
    v_lshl_add_u32 v5, v9, 3, v5
    v_and_b32 v6, 1, v1
    v_lshlrev_b32 v6, 18, v6
    v_bfe_u32 v9, v1, 1, 1
    v_lshl_add_u32 v6, v9, 13, v6
    s_lshl3_add_u32 s96, s75, s3
    s_mul_i32 s97, s96, 28672
    s_lshl_b32 s98, s74, 7
    s_add_u32 s99, s97, s98
    s_add_u32 s13, s99, 22020096
    s_lshr_b32 s96, s9, 2
    s_and_b32 s97, s75, 1
    s_lshr_b32 s98, s3, 1
    s_lshl2_add_u32 s99, s97, s98
    s_and_b32 s97, s3, 1
    s_lshl_b32 s98, s97, 2
    s_lshl3_add_u32 s97, s99, s98
    s_lshr_b32 s99, s75, 1
    s_add_u32 s98, s97, s99
    s_lshl_b32 s97, s98, 12
    s_lshl_b32 s99, s8, 6
    s_add_u32 s98, s97, s99
    s_lshl2_add_u32 s97, s96, s98
    s_add_u32 s99, s97, 1048576
    s_add_u32 s14, s99, 3072
    s_waitcnt vmcnt(0)
    s_waitcnt lgkmcnt(0)
    s_barrier
    ds_read_b128 v[212:215], v4
    ds_read_b64_tr_b16 v[196:197], v45
    ds_read_b64_tr_b16 v[198:199], v45 offset:1024
    ds_read_b128 v[216:219], v4 offset:32
    ds_read_b64_tr_b16 v[200:201], v45 offset:8192
    ds_read_b64_tr_b16 v[202:203], v45 offset:9216
    ds_read_b128 v[220:223], v4 offset:64
    ds_read_b64_tr_b16 v[204:205], v45 offset:16384
    ds_read_b64_tr_b16 v[206:207], v45 offset:17408
    ds_read_b128 v[224:227], v4 offset:96
    ds_read_b64_tr_b16 v[208:209], v45 offset:24576
    ds_read_b64_tr_b16 v[210:211], v45 offset:25600
    s_waitcnt lgkmcnt(9)
    v_mfma_f32_32x32x16_bf16 v[228:243], v[212:215], v[196:199], 0
    s_waitcnt lgkmcnt(6)
    v_mfma_f32_32x32x16_bf16 v[228:243], v[216:219], v[200:203], v[228:243]
    s_waitcnt lgkmcnt(3)
    v_mfma_f32_32x32x16_bf16 v[228:243], v[220:223], v[204:207], v[228:243]
    s_waitcnt lgkmcnt(0)
    v_mfma_f32_32x32x16_bf16 v[228:243], v[224:227], v[208:211], v[228:243]
    s_nop 11
    v_mov_b32 v229, s4
    buffer_store_dwordx2 v[228:229], v5, s[32:35], s13 offen sc1
    s_mov_b64 exec, 15
    buffer_store_dword v229, v6, s[32:35], s14 offen sc1
    s_mov_b64 exec, -1
    s_waitcnt lgkmcnt(0)
L_GSEC:
    s_lshl_b32 s96, s21, 7
    s_lshl4_add_u32 s13, s3, s96
    v_lshrrev_b32 v22, 3, v1
    v_lshl_add_u32 v22, v22, 0, s13
    s_lshl_b32 s96, s13, 11
    s_lshl_b32 s97, s12, 7
    s_add_u32 s15, s96, s97
    s_add_u32 s16, s15, 16384
    v_lshrrev_b32 v25, 3, v1
    v_lshlrev_b32 v25, 11, v25
    v_and_b32 v9, 7, v1
    v_lshl_add_u32 v25, v9, 4, v25
    v_cmp_ne_u32 vcc, s70, v22
    v_cmp_ne_u32 s[22:23], s71, v22
    s_nop 0
    s_and_b64 exec, vcc, s[22:23]
    buffer_store_dwordx4 v[140:143], v25, s[64:67], s15 offen sc1
    s_mov_b64 exec, -1
    v_add_u32 v22, 8, v22
    v_cmp_ne_u32 vcc, s70, v22
    v_cmp_ne_u32 s[22:23], s71, v22
    s_nop 0
    s_and_b64 exec, vcc, s[22:23]
    buffer_store_dwordx4 v[144:147], v25, s[64:67], s16 offen sc1
    s_mov_b64 exec, -1
    s_cmp_lt_u32 s9, 16
    s_cbranch_scc1 L_GF
    s_cmp_ge_u32 s9, 28
    s_cbranch_scc1 L_FIN
    s_waitcnt vmcnt(0)
    s_mov_b32 exec_lo, 0xffff
    s_mov_b32 exec_hi, 0xffff
    buffer_store_dwordx2 v[56:57], v58, s[32:35], 0 offen sc1
    s_mov_b64 exec, -1
    s_branch L_FIN
L_GF:
SPOLL_61:
    s_load_dwordx8 s[24:31], s[32:33], s92 offset:3072 glc
SCHK_62:
    s_add_u32 s5, s5, 1
    s_cmp_ge_u32 s5, 300000
    s_waitcnt lgkmcnt(0)
    s_cbranch_scc1 SDONE_63
    s_cmp_lg_u32 s24, s4
    s_cbranch_scc1 SPOLL_61
    s_cmp_lg_u32 s25, s4
    s_cbranch_scc1 SPOLL_61
    s_cmp_lg_u32 s26, s4
    s_cbranch_scc1 SPOLL_61
    s_cmp_lg_u32 s27, s4
    s_cbranch_scc1 SPOLL_61
    s_cmp_lg_u32 s28, s4
    s_cbranch_scc1 SPOLL_61
    s_cmp_lg_u32 s29, s4
    s_cbranch_scc1 SPOLL_61
    s_cmp_lg_u32 s30, s4
    s_cbranch_scc1 SPOLL_61
SDONE_63:
    s_barrier
    s_cmp_eq_u32 s3, 7
    s_cbranch_scc1 L_G7
    s_barrier
    s_mov_b32 exec_lo, 0xffff
    s_mov_b32 exec_hi, 0xffff
    buffer_store_dwordx2 v[56:57], v58, s[32:35], 0 offen sc1
    s_mov_b64 exec, -1
    s_branch L_FIN
L_G7:
    s_cmp_lg_u32 s3, 7
    s_cbranch_scc1 L_FIN
    s_add_u32 s13, s20, 4096
POLL_64:
    buffer_load_dwordx4 v[212:215], v2, s[32:35], s20 offen sc1
    buffer_load_dwordx4 v[216:219], v2, s[32:35], s20 offen offset:1024 sc1
    buffer_load_dwordx4 v[220:223], v2, s[32:35], s20 offen offset:2048 sc1
    buffer_load_dwordx4 v[224:227], v2, s[32:35], s20 offen offset:3072 sc1
    buffer_load_dwordx4 v[148:151], v2, s[32:35], s13 offen sc1
    buffer_load_dwordx4 v[152:155], v2, s[32:35], s13 offen offset:1024 sc1
    buffer_load_dwordx4 v[156:159], v2, s[32:35], s13 offen offset:2048 sc1
    s_waitcnt vmcnt(0)
    v_bitop3_b32 v4, v213, v215, s4 bitop3:0x7e
    v_bitop3_b32 v4, v4, v217, s4 bitop3:0xf6
    v_bitop3_b32 v4, v4, v219, s4 bitop3:0xf6
    v_bitop3_b32 v4, v4, v221, s4 bitop3:0xf6
    v_bitop3_b32 v4, v4, v223, s4 bitop3:0xf6
    v_bitop3_b32 v4, v4, v225, s4 bitop3:0xf6
    v_bitop3_b32 v4, v4, v227, s4 bitop3:0xf6
    v_bitop3_b32 v4, v4, v149, s4 bitop3:0xf6
    v_bitop3_b32 v4, v4, v151, s4 bitop3:0xf6
    v_bitop3_b32 v4, v4, v153, s4 bitop3:0xf6
    v_bitop3_b32 v4, v4, v155, s4 bitop3:0xf6
    v_bitop3_b32 v4, v4, v157, s4 bitop3:0xf6
    v_bitop3_b32 v4, v4, v159, s4 bitop3:0xf6
    v_cmp_ne_u32 vcc, 0, v4
    s_cbranch_vccz PDONE_65
    s_add_u32 s5, s5, 1
    s_cmp_lt_u32 s5, 300000
    s_cbranch_scc1 POLL_64
PDONE_65:
    v_bitop3_b32 v4, v21, v73, s4 bitop3:0x7e
    v_cmp_ne_u32 vcc, 0, v4
    s_cbranch_vccz TOK_66
POLL_67:
    buffer_load_dwordx2 v[20:21], v11, s[32:35], s68 offen sc1
    buffer_load_dwordx2 v[72:73], v11, s[32:35], s69 offen sc1
    s_waitcnt vmcnt(0)
    v_bitop3_b32 v4, v21, v73, s4 bitop3:0x7e
    v_cmp_ne_u32 vcc, 0, v4
    s_cbranch_vccz PDONE_68
    s_add_u32 s5, s5, 1
    s_cmp_lt_u32 s5, 300000
    s_cbranch_scc1 POLL_67
PDONE_68:
TOK_66:
    s_barrier
    v_add_f32 v212, v212, v216
    v_add_f32 v214, v214, v218
    v_add_f32 v220, v220, v224
    v_add_f32 v222, v222, v226
    v_add_f32 v148, v148, v152
    v_add_f32 v150, v150, v154
    v_add_f32 v212, v212, v220
    v_add_f32 v214, v214, v222
    v_add_f32 v148, v148, v156
    v_add_f32 v150, v150, v158
    v_add_f32 v212, v212, v148
    v_add_f32 v214, v214, v150
    v_mov_b32 v213, v214
    v_add_f32_dpp v212, v212, v212 row_ror:8 row_mask:0xf bank_mask:0xf
    s_nop 0
    v_add_f32_dpp v213, v213, v213 row_ror:8 row_mask:0xf bank_mask:0xf
    v_mov_b32 v214, v212
    v_mov_b32 v215, v213
    s_nop 0
    v_permlane16_swap_b32 v212, v214
    v_permlane16_swap_b32 v213, v215
    v_pk_add_f32 v[212:213], v[212:213], v[214:215]
    v_mov_b32 v214, v212
    v_mov_b32 v215, v213
    s_nop 0
    v_permlane32_swap_b32 v212, v214
    v_permlane32_swap_b32 v213, v215
    v_pk_add_f32 v[212:213], v[212:213], v[214:215]
    v_cvt_pk_bf16_f32 v212, 0, v212
    v_cvt_pk_bf16_f32 v213, 0, v213
    v_pk_mul_f32 v[212:213], v[212:213], v[74:75] op_sel:[0,1]
    v_lshlrev_b32 v4, 16, v20
    v_and_b32 v5, s6, v20
    v_cvt_pk_bf16_f32 v212, 0, v212
    v_cvt_pk_bf16_f32 v213, 0, v213
    v_pk_add_f32 v[212:213], v[212:213], v[4:5]
    v_lshlrev_b32 v4, 16, v74
    v_and_b32 v5, s6, v74
    v_cvt_pk_bf16_f32 v212, 0, v212
    v_cvt_pk_bf16_f32 v213, 0, v213
    v_pk_mul_f32 v[212:213], v[212:213], v[4:5]
    v_lshlrev_b32 v4, 16, v72
    v_and_b32 v5, s6, v72
    v_cvt_pk_bf16_f32 v212, 0, v212
    v_cvt_pk_bf16_f32 v213, 0, v213
    v_pk_add_f32 v[212:213], v[212:213], v[4:5]
    v_cvt_pk_bf16_f32 v212, v212, v213
    s_mov_b64 exec, 0xff
    buffer_store_dword v212, v10, s[64:67], s82 offen sc1
    s_mov_b64 exec, -1
    s_mov_b32 exec_lo, 0xffff
    s_mov_b32 exec_hi, 0xffff
    buffer_store_dwordx2 v[56:57], v58, s[32:35], 0 offen sc1
    s_mov_b64 exec, -1
L_FIN:
L_END:
    s_endpgm
.p2align 10
.fill 768, 4, 0xbf800000
.section .rodata,"a"
.p2align 6
.amdhsa_kernel adaLN_cond__linear_kernel_hedgehog__moe_arch_mod__prompt_kernel
  .amdhsa_next_free_vgpr 256
  .amdhsa_next_free_sgpr 102
  .amdhsa_accum_offset 256
  .amdhsa_group_segment_fixed_size 0
  .amdhsa_kernarg_size 112
  .amdhsa_user_sgpr_count 2
  .amdhsa_user_sgpr_kernarg_segment_ptr 1
  .amdhsa_system_sgpr_workgroup_id_x 1
  .amdhsa_float_denorm_mode_32 3
  .amdhsa_float_denorm_mode_16_64 3
.end_amdhsa_kernel
```

```asm
; @launch grid=(256,1,1) block=(512,1,1) lds=163840
.amdgcn_target "amdgcn-amd-amdhsa--gfx950"
.text
.globl adaLN_cond__linear_kernel_hedgehog__moe_arch_mod__prompt_kernel
.p2align 8
.type adaLN_cond__linear_kernel_hedgehog__moe_arch_mod__prompt_kernel,@function
adaLN_cond__linear_kernel_hedgehog__moe_arch_mod__prompt_kernel:
    s_load_dwordx16 s[68:83], s[0:1], 0
    s_load_dwordx8 s[84:91], s[0:1], 64
    s_load_dwordx2 s[32:33], s[0:1], 104
    s_load_dwordx2 s[30:31], s[0:1], 96
    s_cmp_ge_u32 s2, 256
    s_cbranch_scc1 L_END
    v_lshrrev_b32 v4, 6, v0
    v_and_b32 v1, 63, v0
    v_mov_b32 v3, 0
    v_readfirstlane_b32 s3, v4
    v_lshlrev_b32 v2, 4, v1
    s_and_b32 s8, s2, 7
    s_lshr_b32 s9, s2, 3
    s_lshl2_add_u32 s96, s8, s3
    s_lshl_b32 s15, s96, 6
    s_mul_i32 s96, s15, 6144
    s_xor_b32 s97, s9, 1
    s_lshl_b32 s98, s97, 7
    s_add_u32 s13, s96, s98
    v_lshrrev_b32 v60, 3, v1
    v_mul_u32_u24 v60, 49152, v60
    v_and_b32 v9, 7, v1
    v_lshl_add_u32 v60, v9, 4, v60
    v_lshrrev_b32 v61, 3, v1
    v_lshl_add_u32 v61, v61, 3, s15
    s_lshl_b32 s96, s8, 5
    s_add_u32 s97, s96, s9
    s_lshl2_add_u32 s98, s97, s3
    s_sub_u32 s99, s98, 4
    s_lshl_b32 s16, s99, 12
    s_mov_b32 s50, 12582912
    s_mov_b32 s51, 0x20000
    s_mov_b32 s38, 4194304
    s_mov_b32 s39, 0x20000
    s_mov_b32 s34, 268435456
    s_mov_b32 s35, 0x20000
    s_getreg_b32 s94, hwreg(HW_REG_XCC_ID, 0, 3)
    s_getpc_b64 s[22:23]
    s_mul_i32 s96, s9, 7
    s_add_u32 s97, s96, s3
    s_lshl_b32 s19, s97, 7
    v_lshrrev_b32 v10, 5, v1
    v_mul_u32_u24 v10, 28672, v10
    v_add_u32 v10, s19, v10
    v_min_u32 v10, 44032, v10
    s_cmp_ge_u32 s3, 4
    s_waitcnt lgkmcnt(0)
    s_mov_b64 s[48:49], s[88:89]
    s_mov_b64 s[36:37], s[68:69]
    s_load_dword s4, s[32:33], 0
    s_cbranch_scc1 L_FS
    global_load_dwordx2 v[96:97], v61, s[86:87]
    buffer_load_dwordx4 v[80:83], v60, s[48:51], s13 offen nt
    s_add_u32 s13, s13, 12288
    buffer_load_dwordx4 v[84:87], v60, s[48:51], s13 offen nt
    s_add_u32 s13, s13, 12288
    buffer_load_dwordx4 v[88:91], v60, s[48:51], s13 offen nt
    s_add_u32 s13, s13, 12288
    buffer_load_dwordx4 v[92:95], v60, s[48:51], s13 offen nt
    s_barrier
    s_barrier
    s_and_b32 s22, s22, 0xfffffc00
    global_load_dword v78, v10, s[22:23]
    s_mov_b32 s42, 6291456
    s_mov_b32 s43, 0x20000
    s_mov_b32 s46, 2097152
    s_mov_b32 s47, 0x20000
    s_mov_b32 s54, 7340032
    s_mov_b32 s55, 0x20000
    s_mov_b32 s58, 7340032
    s_mov_b32 s59, 0x20000
    s_mov_b32 s62, 7340032
    s_mov_b32 s63, 0x20000
    s_mov_b32 s66, 4194304
    s_mov_b32 s67, 0x20000
    s_mov_b64 s[40:41], s[70:71]
    s_mov_b64 s[44:45], s[74:75]
    s_mov_b64 s[52:53], s[80:81]
    s_mov_b64 s[56:57], s[82:83]
    s_mov_b64 s[60:61], s[84:85]
    s_mov_b64 s[64:65], s[90:91]
    s_mov_b32 s5, 0
    s_mov_b32 s6, 0xffff0000
    s_mov_b32 s7, 0x3fb8aa3b
    s_lshr_b32 s76, s3, 2
    v_bfe_u32 v6, v1, 4, 1
    v_lshlrev_b32 v6, 6, v6
    v_and_b32 v62, 7, v1
    v_lshlrev_b32 v62, 4, v62
    v_xor_b32 v62, v62, v6
    v_lshrrev_b32 v6, 3, v1
    v_mul_u32_u24 v6, 6144, v6
    v_add_u32 v62, v62, v6
    v_lshlrev_b32 v63, 3, v1
    v_add_u32 v64, 149760, v2
    s_and_b32 s96, s3, 3
    s_lshl2_add_u32 s13, s96, 149760
    v_lshrrev_b32 v65, 4, v1
    v_lshl_add_u32 v65, v65, 5, s13
    v_and_b32 v9, 7, v1
    v_lshl_add_u32 v65, v9, 7, v65
    v_bfe_u32 v9, v1, 3, 1
    v_lshl_add_u32 v65, v9, 4, v65
    s_and_b32 s96, s8, 6
    s_and_b32 s97, s8, 1
    s_lshr_b32 s98, s9, 4
    s_lshl1_add_u32 s99, s97, s98
    s_lshl_b32 s97, s99, 6
    s_add_u32 s98, s96, s97
    s_lshl3_add_u32 s99, s3, s98
    s_lshl_b32 s96, s99, 10
    s_and_b32 s97, s9, 15
    s_lshl_b32 s98, s97, 6
    s_add_u32 s99, s96, s98
    s_add_u32 s14, s99, 262144
    s_xor_b32 s96, s9, 1
    s_and_b32 s97, s96, 15
    s_lshl4_add_u32 s98, s3, s97
    s_lshr_b32 s99, s9, 4
    s_lshl1_add_u32 s96, s98, s99
    s_lshl3_add_u32 s97, s96, s8
    s_lshl_b32 s98, s97, 9
    s_add_u32 s13, s98, 524288
    s_lshr_b32 s96, s9, 4
    s_xor_b32 s97, s9, 1
    s_and_b32 s98, s97, 7
    s_lshl_b32 s99, s3, 1
    s_lshl3_add_u32 s97, s98, s99
    s_bfe_u32 s98, s9, 65539
    s_add_u32 s99, s97, s98
    s_lshl_b32 s97, s99, 9
    s_lshl_b32 s98, s8, 6
    s_add_u32 s99, s97, s98
    s_lshl2_add_u32 s97, s96, s99
    s_add_u32 s15, s97, 2097152
    v_and_b32 v10, 3, v1
    v_lshlrev_b32 v10, 15, v10
    s_waitcnt vmcnt(5)
    v_lshlrev_b32 v98, 16, v97
    v_and_b32 v99, s6, v97
    v_and_b32 v97, s6, v96
    v_lshlrev_b32 v96, 16, v96
    v_mul_f32 v4, s7, v96
    v_exp_f32 v4, -v4
    s_nop 0
    v_add_f32 v4, 1.0, v4
    v_rcp_f32 v4, v4
    s_nop 0
    v_mul_f32 v96, v96, v4
    v_cvt_pk_bf16_f32 v96, 0, v96
    v_mul_f32 v5, s7, v97
    v_exp_f32 v5, -v5
    s_nop 0
    v_add_f32 v5, 1.0, v5
    v_rcp_f32 v5, v5
    s_nop 0
    v_mul_f32 v97, v97, v5
    v_cvt_pk_bf16_f32 v97, 0, v97
    v_mul_f32 v4, s7, v98
    v_exp_f32 v4, -v4
    s_nop 0
    v_add_f32 v4, 1.0, v4
    v_rcp_f32 v4, v4
    s_nop 0
    v_mul_f32 v98, v98, v4
    v_cvt_pk_bf16_f32 v98, 0, v98
    v_mul_f32 v5, s7, v99
    v_exp_f32 v5, -v5
    s_nop 0
    v_add_f32 v5, 1.0, v5
    v_rcp_f32 v5, v5
    s_nop 0
    v_mul_f32 v99, v99, v5
    v_cvt_pk_bf16_f32 v99, 0, v99
    s_waitcnt vmcnt(4)
    v_lshlrev_b32 v4, 16, v80
    v_and_b32 v5, s6, v80
    v_pk_mul_f32 v[20:21], v[4:5], v[96:97] op_sel:[0,0] op_sel_hi:[1,0]
    v_lshlrev_b32 v6, 16, v81
    v_and_b32 v7, s6, v81
    v_pk_mul_f32 v[22:23], v[6:7], v[96:97] op_sel:[0,0] op_sel_hi:[1,0]
    v_lshlrev_b32 v4, 16, v82
    v_and_b32 v5, s6, v82
    v_pk_mul_f32 v[24:25], v[4:5], v[96:97] op_sel:[0,0] op_sel_hi:[1,0]
    v_lshlrev_b32 v6, 16, v83
    v_and_b32 v7, s6, v83
    v_pk_mul_f32 v[26:27], v[6:7], v[96:97] op_sel:[0,0] op_sel_hi:[1,0]
    s_waitcnt vmcnt(3)
    v_lshlrev_b32 v4, 16, v84
    v_and_b32 v5, s6, v84
    v_pk_fma_f32 v[20:21], v[4:5], v[96:97], v[20:21] op_sel:[0,1,0] op_sel_hi:[1,1,1]
    v_lshlrev_b32 v6, 16, v85
    v_and_b32 v7, s6, v85
    v_pk_fma_f32 v[22:23], v[6:7], v[96:97], v[22:23] op_sel:[0,1,0] op_sel_hi:[1,1,1]
    v_lshlrev_b32 v4, 16, v86
    v_and_b32 v5, s6, v86
    v_pk_fma_f32 v[24:25], v[4:5], v[96:97], v[24:25] op_sel:[0,1,0] op_sel_hi:[1,1,1]
    v_lshlrev_b32 v6, 16, v87
    v_and_b32 v7, s6, v87
    v_pk_fma_f32 v[26:27], v[6:7], v[96:97], v[26:27] op_sel:[0,1,0] op_sel_hi:[1,1,1]
    s_waitcnt vmcnt(2)
    v_lshlrev_b32 v4, 16, v88
    v_and_b32 v5, s6, v88
    v_pk_fma_f32 v[20:21], v[4:5], v[98:99], v[20:21] op_sel:[0,0,0] op_sel_hi:[1,0,1]
    v_lshlrev_b32 v6, 16, v89
    v_and_b32 v7, s6, v89
    v_pk_fma_f32 v[22:23], v[6:7], v[98:99], v[22:23] op_sel:[0,0,0] op_sel_hi:[1,0,1]
    v_lshlrev_b32 v4, 16, v90
    v_and_b32 v5, s6, v90
    v_pk_fma_f32 v[24:25], v[4:5], v[98:99], v[24:25] op_sel:[0,0,0] op_sel_hi:[1,0,1]
    v_lshlrev_b32 v6, 16, v91
    v_and_b32 v7, s6, v91
    v_pk_fma_f32 v[26:27], v[6:7], v[98:99], v[26:27] op_sel:[0,0,0] op_sel_hi:[1,0,1]
    s_waitcnt vmcnt(1)
    v_lshlrev_b32 v4, 16, v92
    v_and_b32 v5, s6, v92
    v_pk_fma_f32 v[20:21], v[4:5], v[98:99], v[20:21] op_sel:[0,1,0] op_sel_hi:[1,1,1]
    v_lshlrev_b32 v6, 16, v93
    v_and_b32 v7, s6, v93
    v_pk_fma_f32 v[22:23], v[6:7], v[98:99], v[22:23] op_sel:[0,1,0] op_sel_hi:[1,1,1]
    v_lshlrev_b32 v4, 16, v94
    v_and_b32 v5, s6, v94
    v_pk_fma_f32 v[24:25], v[4:5], v[98:99], v[24:25] op_sel:[0,1,0] op_sel_hi:[1,1,1]
    v_lshlrev_b32 v6, 16, v95
    v_and_b32 v7, s6, v95
    v_pk_fma_f32 v[26:27], v[6:7], v[98:99], v[26:27] op_sel:[0,1,0] op_sel_hi:[1,1,1]
    v_permlane32_swap_b32 v20, v24
    v_permlane32_swap_b32 v21, v25
    v_permlane32_swap_b32 v22, v26
    v_permlane32_swap_b32 v23, v27
    v_add_f32 v20, v20, v24
    v_add_f32 v21, v21, v25
    v_add_f32 v22, v22, v26
    v_add_f32 v23, v23, v27
    s_nop 0
    v_permlane16_swap_b32 v20, v22
    v_permlane16_swap_b32 v21, v23
    v_add_f32 v20, v20, v22
    v_add_f32 v21, v21, v23
    s_nop 0
    v_add_f32_dpp v20, v20, v20 row_ror:8 row_mask:0xf bank_mask:0xf
    v_add_f32_dpp v21, v21, v21 row_ror:8 row_mask:0xf bank_mask:0xf
    s_nop 1
    v_mov_b32_dpp v20, v21 quad_perm:[0,1,2,3] row_mask:0xf bank_mask:0xc
    ds_write_b32 v65, v20
    s_waitcnt lgkmcnt(0)
    s_barrier
    ds_read_b128 v[20:23], v64 offset:0
    s_mul_i32 s4, s4, 0x9e3779b1
    s_add_u32 s4, s4, 0x7f4a7c15
    s_waitcnt lgkmcnt(0)
    v_pk_add_f32 v[20:21], v[20:21], v[22:23]
    v_add_f32 v20, v20, v21
    v_mov_b32 v21, s4
    buffer_store_dwordx2 v[20:21], v63, s[32:35], s13 offen sc1
    s_mov_b64 exec, 15
    buffer_store_dword v21, v10, s[32:35], s15 offen sc1
    s_mov_b64 exec, -1
    s_branch L_FJ
L_FS:
    s_barrier
    buffer_load_dwordx4 v[80:83], v2, s[36:39], s16 offen
    buffer_load_dwordx4 v[84:87], v2, s[36:39], s16 offen offset:1024
    buffer_load_dwordx4 v[88:91], v2, s[36:39], s16 offen offset:2048
    buffer_load_dwordx4 v[92:95], v2, s[36:39], s16 offen offset:3072
    s_lshl2_add_u32 s96, s2, s3
    s_sub_u32 s97, s96, 4
    s_lshl_b32 s98, s97, 7
    s_add_u32 s17, s98, 2097152
    s_load_dword s24, s[32:33], s17 offset:0 glc
    s_load_dword s25, s[32:33], s17 offset:64 glc
    s_lshl_b32 s96, s2, 5
    s_add_u32 s97, s96, s3
    s_sub_u32 s98, s97, 4
    s_lshl_b32 s99, s98, 7
    s_add_u32 s17, s99, 1048576
    s_load_dword s24, s[32:33], s17 offset:0 glc
    s_load_dword s25, s[32:33], s17 offset:64 glc
    s_lshl_b32 s19, s94, 5
    v_mov_b32 v78, 1
    v_mov_b32 v79, s19
    s_barrier
    s_cmp_lg_u32 s3, 7
    s_cbranch_scc1 L_NOTK
    s_mov_b64 exec, 1
    global_atomic_add v78, v79, v78, s[30:31] sc0 sc1
    s_mov_b64 exec, -1
    s_branch L_TK0
L_NOTK:
    s_and_b32 s22, s22, 0xfffffc00
    global_load_dword v78, v10, s[22:23]
L_TK0:
    s_mov_b32 s42, 6291456
    s_mov_b32 s43, 0x20000
    s_mov_b32 s46, 2097152
    s_mov_b32 s47, 0x20000
    s_mov_b32 s54, 7340032
    s_mov_b32 s55, 0x20000
    s_mov_b32 s58, 7340032
    s_mov_b32 s59, 0x20000
    s_mov_b32 s62, 7340032
    s_mov_b32 s63, 0x20000
    s_mov_b32 s66, 4194304
    s_mov_b32 s67, 0x20000
    s_mov_b64 s[40:41], s[70:71]
    s_mov_b64 s[44:45], s[74:75]
    s_mov_b64 s[52:53], s[80:81]
    s_mov_b64 s[56:57], s[82:83]
    s_mov_b64 s[60:61], s[84:85]
    s_mov_b64 s[64:65], s[90:91]
    s_mov_b32 s5, 0
    s_mov_b32 s6, 0xffff0000
    s_mov_b32 s7, 0x3fb8aa3b
    s_lshr_b32 s76, s3, 2
    v_bfe_u32 v6, v1, 4, 1
    v_lshlrev_b32 v6, 6, v6
    v_and_b32 v62, 7, v1
    v_lshlrev_b32 v62, 4, v62
    v_xor_b32 v62, v62, v6
    v_lshrrev_b32 v6, 3, v1
    v_mul_u32_u24 v6, 6144, v6
    v_add_u32 v62, v62, v6
    v_lshlrev_b32 v63, 3, v1
    v_add_u32 v64, 149760, v2
    s_and_b32 s96, s3, 3
    s_lshl2_add_u32 s13, s96, 149760
    v_lshrrev_b32 v65, 4, v1
    v_lshl_add_u32 v65, v65, 5, s13
    v_and_b32 v9, 7, v1
    v_lshl_add_u32 v65, v9, 7, v65
    v_bfe_u32 v9, v1, 3, 1
    v_lshl_add_u32 v65, v9, 4, v65
    s_and_b32 s96, s8, 6
    s_and_b32 s97, s8, 1
    s_lshr_b32 s98, s9, 4
    s_lshl1_add_u32 s99, s97, s98
    s_lshl_b32 s97, s99, 6
    s_add_u32 s98, s96, s97
    s_lshl3_add_u32 s99, s3, s98
    s_lshl_b32 s96, s99, 10
    s_and_b32 s97, s9, 15
    s_lshl_b32 s98, s97, 6
    s_add_u32 s99, s96, s98
    s_add_u32 s14, s99, 262144
    s_sub_u32 s96, s3, 4
    s_lshl4_add_u32 s13, s96, 151808
    v_lshrrev_b32 v10, 5, v1
    v_lshl_add_u32 v10, v10, 3, s13
    s_barrier
    s_waitcnt vmcnt(1)
    s_waitcnt lgkmcnt(0)
    s_mul_i32 s4, s4, 0x9e3779b1
    s_add_u32 s4, s4, 0x7f4a7c15
    v_mov_b32 v104, 0x3f803f80
    v_dot2_f32_bf16 v100, v80, v104, 0
    v_dot2_f32_bf16 v102, v80, v80, 0
    v_dot2_f32_bf16 v101, v88, v104, 0
    v_dot2_f32_bf16 v103, v88, v88, 0
    v_dot2_f32_bf16 v100, v81, v104, v100
    v_dot2_f32_bf16 v102, v81, v81, v102
    v_dot2_f32_bf16 v101, v89, v104, v101
    v_dot2_f32_bf16 v103, v89, v89, v103
    v_dot2_f32_bf16 v100, v82, v104, v100
    v_dot2_f32_bf16 v102, v82, v82, v102
    v_dot2_f32_bf16 v101, v90, v104, v101
    v_dot2_f32_bf16 v103, v90, v90, v103
    v_dot2_f32_bf16 v100, v83, v104, v100
    v_dot2_f32_bf16 v102, v83, v83, v102
    v_dot2_f32_bf16 v101, v91, v104, v101
    v_dot2_f32_bf16 v103, v91, v91, v103
    v_dot2_f32_bf16 v100, v84, v104, v100
    v_dot2_f32_bf16 v102, v84, v84, v102
    v_dot2_f32_bf16 v101, v92, v104, v101
    v_dot2_f32_bf16 v103, v92, v92, v103
    v_dot2_f32_bf16 v100, v85, v104, v100
    v_dot2_f32_bf16 v102, v85, v85, v102
    v_dot2_f32_bf16 v101, v93, v104, v101
    v_dot2_f32_bf16 v103, v93, v93, v103
    v_dot2_f32_bf16 v100, v86, v104, v100
    v_dot2_f32_bf16 v102, v86, v86, v102
    v_dot2_f32_bf16 v101, v94, v104, v101
    v_dot2_f32_bf16 v103, v94, v94, v103
    v_dot2_f32_bf16 v100, v87, v104, v100
    v_dot2_f32_bf16 v102, v87, v87, v102
    v_dot2_f32_bf16 v101, v95, v104, v101
    v_dot2_f32_bf16 v103, v95, v95, v103
    s_nop 1
    v_permlane32_swap_b32 v100, v101
    v_permlane32_swap_b32 v102, v103
    v_add_f32 v100, v100, v101
    v_add_f32 v102, v102, v103
    s_nop 1
    v_permlane16_swap_b32 v100, v102
    v_add_f32 v100, v100, v102
    s_nop 1
    v_add_f32_dpp v100, v100, v100 quad_perm:[1,0,3,2] row_mask:0xf bank_mask:0xf
    s_nop 1
    v_add_f32_dpp v100, v100, v100 quad_perm:[2,3,0,1] row_mask:0xf bank_mask:0xf
    s_nop 1
    v_add_f32_dpp v100, v100, v100 row_half_mirror row_mask:0xf bank_mask:0xf
    s_nop 1
    v_add_f32_dpp v100, v100, v100 row_ror:8 row_mask:0xf bank_mask:0xf
    v_mul_f32 v102, 0x3a800000, v100
    v_mul_f32 v100, 0x3a800000, v100
    s_nop 1
    v_permlane16_swap_b32 v100, v102
    v_fma_f32 v117, -v100, v100, v102
    v_cvt_pk_bf16_f32 v116, 0, v100
    v_max_f32 v117, 0, v117
    v_cvt_pk_bf16_f32 v117, 0, v117
    v_add_f32 v117, 0x3727c5ac, v117
    v_cvt_pk_bf16_f32 v117, 0, v117
    v_sqrt_f32 v117, v117
    s_nop 0
    v_cvt_pk_bf16_f32 v117, 0, v117
    v_lshrrev_b32 v116, 16, v116
    v_or_b32 v116, v116, v117
    v_mov_b32 v117, s4
    ds_write_b64 v10, v[116:117]
L_FJ:
    v_and_b32 v5, 3, v1
    v_lshlrev_b32 v5, 4, v5
    v_add_u32 v5, 151808, v5
    v_and_b32 v4, 3, v1
    v_lshlrev_b32 v4, 4, v4
    v_bfe_u32 v9, v1, 2, 1
    v_lshl_add_u32 v4, v9, 10, v4
    v_and_b32 v10, 31, v1
    v_lshlrev_b32 v10, 11, v10
    v_lshrrev_b32 v9, 5, v1
    v_lshl_add_u32 v10, v9, 5, v10
    v_and_b32 v6, 1, v1
    v_lshlrev_b32 v6, 9, v6
    v_bfe_u32 v9, v1, 1, 1
    v_lshl_add_u32 v6, v9, 8, v6
    s_and_b32 s96, s9, 3
    s_and_b32 s97, s8, 6
    s_and_b32 s98, s8, 1
    s_lshr_b32 s99, s9, 4
    s_lshl1_add_u32 s98, s98, s99
    s_lshl_b32 s99, s98, 6
    s_add_u32 s98, s97, s99
    s_lshl3_add_u32 s97, s3, s98
    s_lshl_b32 s99, s97, 9
    s_bfe_u32 s98, s9, 131074
    s_lshl_b32 s97, s98, 6
    s_add_u32 s98, s99, s97
    s_lshl2_add_u32 s99, s96, s98
    s_add_u32 s97, s99, 16
    s_add_u32 s15, s97, 2097152
    s_waitcnt lgkmcnt(0)
    s_barrier
    ds_read_b128 v[116:119], v5
    s_waitcnt lgkmcnt(0)
    s_mov_b64 exec, 0xff
    buffer_store_dwordx4 v[116:119], v4, s[32:35], s14 offen sc1
    s_mov_b64 exec, 15
    buffer_store_dword v117, v6, s[32:35], s15 offen sc1
    s_mov_b64 exec, -1
    s_cmp_lg_u32 s3, 7
    s_cbranch_scc1 L_NOTK2
    s_mov_b32 s13, 0
    s_waitcnt vmcnt(2)
L_TK:
    v_readfirstlane_b32 s15, v78
    s_nop 0
    s_cmp_lt_u32 s15, 32
    s_cbranch_scc1 L_TKOK
    v_mov_b32 v78, s4
    s_mov_b64 exec, 1
    buffer_store_dword v78, v3, s[32:35], 0 offen offset:256 sc1
    s_mov_b64 exec, -1
    s_add_u32 s13, s13, 1
    s_cmp_lt_u32 s13, 8
    s_cbranch_scc0 L_TKNO
    s_add_u32 s94, s94, 1
    s_and_b32 s94, s94, 7
    s_lshl_b32 s19, s94, 5
    v_mov_b32 v78, 1
    v_mov_b32 v79, s19
    s_mov_b64 exec, 1
    global_atomic_add v78, v79, v78, s[30:31] sc0 sc1
    s_mov_b64 exec, -1
    s_waitcnt vmcnt(0)
    s_branch L_TK
L_TKNO:
    s_and_b32 s94, s2, 7
    s_lshr_b32 s15, s2, 3
L_TKOK:
    s_lshl3_add_u32 s15, s15, s94
    v_mov_b32 v78, s15
    ds_write_b32 v5, v78 offset:64
L_NOTK2:
    s_waitcnt lgkmcnt(0)
    s_barrier
    ds_read_b32 v120, v5 offset:64
    s_waitcnt lgkmcnt(0)
    v_readfirstlane_b32 s2, v120
    s_nop 0
    s_and_b32 s8, s2, 7
    s_lshr_b32 s9, s2, 3
    s_and_b32 s96, s8, 1
    s_and_b32 s97, s9, 7
    s_lshl3_add_u32 s12, s96, s97
    s_lshr_b32 s96, s8, 1
    s_lshr_b32 s97, s9, 3
    s_lshl2_add_u32 s21, s96, s97
    s_and_b32 s96, s3, 3
    s_lshl2_add_u32 s94, s21, s96
    s_lshl1_add_u32 s95, s12, s76
    s_lshl_b32 s96, s94, 16
    s_lshl_b32 s97, s95, 6
    s_add_u32 s18, s96, s97
    buffer_load_dwordx4 v[12:15], v10, s[36:39], s18 offen
    buffer_load_dwordx4 v[16:19], v10, s[36:39], s18 offen offset:16
    s_lshr_b32 s96, s8, 1
    s_lshl4_add_u32 s97, s96, s12
    s_lshl4_add_u32 s98, s97, s3
    s_lshl_b32 s99, s98, 9
    s_add_u32 s13, s99, 524288
    s_lshl3_add_u32 s96, s2, s3
    s_lshl_b32 s97, s96, 6
    s_add_u32 s15, s97, 2097152
    s_and_b32 s96, s3, 3
    s_lshl2_add_u32 s97, s2, s96
    s_lshl_b32 s98, s97, 8
    s_add_u32 s14, s98, 262144
    s_load_dwordx8 s[24:31], s[32:33], s15 offset:0 glc
    s_and_b32 s10, s9, 15
    s_lshr_b32 s96, s8, 2
    s_and_b32 s97, s8, 1
    s_lshl1_add_u32 s98, s96, s97
    s_and_b32 s99, s8, 2
    s_lshl2_add_u32 s96, s98, s99
    s_lshr_b32 s97, s9, 4
    s_add_u32 s11, s96, s97
    s_and_b32 s85, s9, 12
    s_lshl_b32 s96, s2, 6
    s_add_u32 s97, s96, s3
    s_lshl_b32 s98, s97, 6
    s_add_u32 s92, s98, 1048576
    s_lshr_b32 s96, s9, 4
    s_xor_b32 s77, s76, s96
    s_lshr_b32 s96, s9, 3
    s_xor_b32 s97, s96, s9
    s_and_b32 s98, s97, 1
    s_lshl2_add_u32 s83, s98, 8
    s_mul_i32 s96, s8, 7
    s_lshr_b32 s97, s9, 2
    s_add_u32 s74, s96, s97
    s_and_b32 s75, s9, 3
    v_and_b32 v8, 31, v1
    v_lshlrev_b32 v8, 3, v8
    v_and_b32 v4, 31, v1
    v_lshlrev_b32 v4, 4, v4
    v_lshrrev_b32 v9, 5, v1
    v_lshl_add_u32 v4, v9, 12, v4
    s_lshl2_add_u32 s16, s3, 152320
    v_lshl_add_u32 v5, v1, 6, s16
    s_lshl_b32 s96, s76, 10
    s_add_u32 s16, s96, 152320
    v_and_b32 v6, 15, v1
    v_lshl_add_u32 v6, v6, 5, s16
    v_lshrrev_b32 v9, 5, v1
    v_lshl_add_u32 v6, v9, 9, v6
    s_branch SCHK_2
SPOLL_1:
    s_load_dwordx8 s[24:31], s[32:33], s15 offset:0 glc
SCHK_2:
    s_add_u32 s5, s5, 1
    s_cmp_ge_u32 s5, 300000
    s_waitcnt lgkmcnt(0)
    s_cbranch_scc1 SDONE_3
    s_cmp_lg_u32 s24, s4
    s_cbranch_scc1 SPOLL_1
    s_cmp_lg_u32 s25, s4
    s_cbranch_scc1 SPOLL_1
    s_cmp_lg_u32 s28, s4
    s_cbranch_scc1 SPOLL_1
    s_cmp_lg_u32 s29, s4
    s_cbranch_scc1 SPOLL_1
    s_cmp_lg_u32 s30, s4
    s_cbranch_scc1 SPOLL_1
    s_cmp_lg_u32 s31, s4
    s_cbranch_scc1 SPOLL_1
SDONE_3:
    buffer_load_dwordx4 v[120:123], v4, s[32:35], s13 offen sc1
    buffer_load_dwordx2 v[116:117], v8, s[32:35], s14 offen sc1
    s_barrier
    s_lshl_b32 s96, s11, 12
    s_lshl_b32 s97, s3, 9
    s_add_u32 s16, s96, s97
    v_add_u32 v10, s16, v2
    s_lshl_b32 s96, s3, 9
    s_add_u32 m0, s96, 156416
    s_mov_b32 exec_hi, 0
    global_load_lds_dwordx4 v10, s[72:73]
    s_mov_b32 exec_hi, -1
    s_and_b32 s20, s9, 3
    s_add_u32 s96, s20, s85
    s_and_b32 s97, s96, 15
    s_lshl3_add_u32 s98, s97, s3
    s_mul_i32 s99, s98, 49152
    s_lshl_b32 s96, s11, 7
    s_add_u32 s82, s99, s96
    s_mul_i32 s96, s20, 24960
    s_lshr_b32 s97, s3, 1
    s_mul_i32 s98, s97, 2080
    s_add_u32 s99, s96, s98
    s_and_b32 s97, s3, 1
    s_mul_i32 s96, s97, 1056
    s_add_u32 s20, s99, s96
    s_mov_b32 m0, s20
    s_nop 0
    buffer_load_dwordx4 v62, s[40:43], s82 offen lds
    s_add_u32 s82, s82, 2048
    s_add_u32 m0, s20, 8320
    s_nop 0
    buffer_load_dwordx4 v62, s[40:43], s82 offen lds
    s_add_u32 s82, s82, 2048
    s_add_u32 m0, s20, 16640
    s_nop 0
    buffer_load_dwordx4 v62, s[40:43], s82 offen lds
    s_waitcnt vmcnt(5)
    v_bitop3_b32 v7, v121, v123, s4 bitop3:0x7e
    v_cmp_ne_u32 vcc, 0, v7
    s_cbranch_vccz TOK_5
POLL_6:
    buffer_load_dwordx4 v[120:123], v4, s[32:35], s13 offen sc1
    s_waitcnt vmcnt(0)
    v_bitop3_b32 v7, v121, v123, s4 bitop3:0x7e
    v_cmp_ne_u32 vcc, 0, v7
    s_cbranch_vccz PDONE_7
    s_add_u32 s5, s5, 1
    s_cmp_lt_u32 s5, 300000
    s_cbranch_scc1 POLL_6
PDONE_7:
TOK_5:
    ds_write2_b32 v5, v120, v122 offset0:0 offset1:8
    v_lshlrev_b32 v100, 16, v12
    v_and_b32 v101, s6, v12
    v_lshlrev_b32 v102, 16, v13
    v_and_b32 v103, s6, v13
    v_lshlrev_b32 v104, 16, v14
    v_and_b32 v105, s6, v14
    v_lshlrev_b32 v106, 16, v15
    v_and_b32 v107, s6, v15
    v_lshlrev_b32 v108, 16, v16
    v_and_b32 v109, s6, v16
    v_lshlrev_b32 v110, 16, v17
    v_and_b32 v111, s6, v17
    v_lshlrev_b32 v112, 16, v18
    v_and_b32 v113, s6, v18
    v_lshlrev_b32 v114, 16, v19
    v_and_b32 v115, s6, v19
    s_waitcnt lgkmcnt(0)
    s_barrier
    ds_read_b128 v[88:91], v6 offset:2048
    ds_read_b128 v[92:95], v6 offset:2064
    ds_read_b128 v[80:83], v6
    ds_read_b128 v[84:87], v6 offset:16
    s_waitcnt vmcnt(4)
    v_cmp_ne_u32 vcc, s4, v117
    s_cbranch_vccz TOK_8
POLL_9:
    buffer_load_dwordx2 v[116:117], v8, s[32:35], s14 offen sc1
    s_waitcnt vmcnt(0)
    v_cmp_ne_u32 vcc, s4, v117
    s_cbranch_vccz PDONE_10
    s_add_u32 s5, s5, 1
    s_cmp_lt_u32 s5, 300000
    s_cbranch_scc1 POLL_9
PDONE_10:
TOK_8:
    v_lshlrev_b32 v117, 16, v116
    v_and_b32 v116, s6, v116
    v_rcp_f32 v116, v116
    s_nop 0
    v_pk_add_f32 v[100:101], v[100:101], v[116:117] op_sel:[0,1] neg_lo:[0,1] neg_hi:[0,1]
    v_pk_add_f32 v[102:103], v[102:103], v[116:117] op_sel:[0,1] neg_lo:[0,1] neg_hi:[0,1]
    v_pk_add_f32 v[104:105], v[104:105], v[116:117] op_sel:[0,1] neg_lo:[0,1] neg_hi:[0,1]
    v_pk_add_f32 v[106:107], v[106:107], v[116:117] op_sel:[0,1] neg_lo:[0,1] neg_hi:[0,1]
    v_pk_add_f32 v[108:109], v[108:109], v[116:117] op_sel:[0,1] neg_lo:[0,1] neg_hi:[0,1]
    v_pk_add_f32 v[110:111], v[110:111], v[116:117] op_sel:[0,1] neg_lo:[0,1] neg_hi:[0,1]
    v_pk_add_f32 v[112:113], v[112:113], v[116:117] op_sel:[0,1] neg_lo:[0,1] neg_hi:[0,1]
    v_pk_add_f32 v[114:115], v[114:115], v[116:117] op_sel:[0,1] neg_lo:[0,1] neg_hi:[0,1]
    s_lshl4_add_u32 s96, s21, s12
    s_and_b32 s97, s3, 3
    s_lshl2_add_u32 s98, s96, s97
    s_lshl1_add_u32 s99, s98, s76
    s_lshl_b32 s96, s99, 11
    s_add_u32 s13, s96, 4194304
    v_and_b32 v8, 15, v1
    v_lshlrev_b32 v8, 4, v8
    v_bfe_u32 v9, v1, 4, 1
    v_lshl_add_u32 v8, v9, 10, v8
    v_lshrrev_b32 v9, 5, v1
    v_lshl_add_u32 v8, v9, 9, v8
    s_waitcnt lgkmcnt(2)
    v_pk_add_f32 v[88:89], v[88:89], v[90:91]
    v_pk_add_f32 v[92:93], v[92:93], v[94:95]
    v_pk_add_f32 v[88:89], v[88:89], v[92:93]
    v_add_f32 v88, v88, v89
    v_cvt_pk_bf16_f32 v88, 0, v88
    s_waitcnt lgkmcnt(0)
    v_pk_add_f32 v[80:81], v[80:81], v[82:83]
    v_pk_add_f32 v[84:85], v[84:85], v[86:87]
    v_pk_add_f32 v[80:81], v[80:81], v[84:85]
    v_add_f32 v80, v80, v81
    v_add_f32 v88, 1.0, v88
    v_cvt_pk_bf16_f32 v88, 0, v88
    v_cvt_pk_bf16_f32 v80, 0, v80
    s_lshl_b32 s96, s3, 8
    s_add_u32 s16, s96, 160512
    v_and_b32 v4, 15, v1
    v_lshl_add_u32 v4, v4, 2, s16
    v_lshrrev_b32 v9, 5, v1
    v_lshl_add_u32 v4, v9, 6, v4
    v_lshrrev_b32 v5, 5, v1
    v_lshl_add_u32 v5, v5, 6, s16
    ds_write2_b32 v4, v88, v80 offset0:0 offset1:32
    ds_read_b128 v[132:135], v5
    ds_read_b128 v[136:139], v5 offset:16
    ds_read_b128 v[140:143], v5 offset:32
    ds_read_b128 v[144:147], v5 offset:48
    ds_read_b128 v[148:151], v5 offset:128
    ds_read_b128 v[152:155], v5 offset:144
    ds_read_b128 v[156:159], v5 offset:160
    ds_read_b128 v[160:163], v5 offset:176
    v_cvt_pk_bf16_f32 v100, 0, v100
    v_cvt_pk_bf16_f32 v101, 0, v101
    v_cvt_pk_bf16_f32 v102, 0, v102
    v_cvt_pk_bf16_f32 v103, 0, v103
    v_cvt_pk_bf16_f32 v104, 0, v104
    v_cvt_pk_bf16_f32 v105, 0, v105
    v_cvt_pk_bf16_f32 v106, 0, v106
    v_cvt_pk_bf16_f32 v107, 0, v107
    v_pk_mul_f32 v[100:101], v[100:101], v[116:117] op_sel_hi:[1,0]
    v_pk_mul_f32 v[102:103], v[102:103], v[116:117] op_sel_hi:[1,0]
    v_pk_mul_f32 v[104:105], v[104:105], v[116:117] op_sel_hi:[1,0]
    v_pk_mul_f32 v[106:107], v[106:107], v[116:117] op_sel_hi:[1,0]
    v_cvt_pk_bf16_f32 v100, 0, v100
    v_cvt_pk_bf16_f32 v101, 0, v101
    v_cvt_pk_bf16_f32 v102, 0, v102
    v_cvt_pk_bf16_f32 v103, 0, v103
    v_cvt_pk_bf16_f32 v104, 0, v104
    v_cvt_pk_bf16_f32 v105, 0, v105
    v_cvt_pk_bf16_f32 v106, 0, v106
    v_cvt_pk_bf16_f32 v107, 0, v107
    v_cvt_pk_bf16_f32 v108, 0, v108
    v_cvt_pk_bf16_f32 v109, 0, v109
    v_cvt_pk_bf16_f32 v110, 0, v110
    v_cvt_pk_bf16_f32 v111, 0, v111
    v_cvt_pk_bf16_f32 v112, 0, v112
    v_cvt_pk_bf16_f32 v113, 0, v113
    v_cvt_pk_bf16_f32 v114, 0, v114
    v_cvt_pk_bf16_f32 v115, 0, v115
    v_pk_mul_f32 v[108:109], v[108:109], v[116:117] op_sel_hi:[1,0]
    v_pk_mul_f32 v[110:111], v[110:111], v[116:117] op_sel_hi:[1,0]
    v_pk_mul_f32 v[112:113], v[112:113], v[116:117] op_sel_hi:[1,0]
    v_pk_mul_f32 v[114:115], v[114:115], v[116:117] op_sel_hi:[1,0]
    v_cvt_pk_bf16_f32 v108, 0, v108
    v_cvt_pk_bf16_f32 v109, 0, v109
    v_cvt_pk_bf16_f32 v110, 0, v110
    v_cvt_pk_bf16_f32 v111, 0, v111
    v_cvt_pk_bf16_f32 v112, 0, v112
    v_cvt_pk_bf16_f32 v113, 0, v113
    v_cvt_pk_bf16_f32 v114, 0, v114
    v_cvt_pk_bf16_f32 v115, 0, v115
    s_waitcnt lgkmcnt(6)
    v_pk_mul_f32 v[100:101], v[100:101], v[132:133]
    v_pk_mul_f32 v[102:103], v[102:103], v[134:135]
    v_pk_mul_f32 v[104:105], v[104:105], v[136:137]
    v_pk_mul_f32 v[106:107], v[106:107], v[138:139]
    v_cvt_pk_bf16_f32 v100, 0, v100
    v_cvt_pk_bf16_f32 v101, 0, v101
    v_cvt_pk_bf16_f32 v102, 0, v102
    v_cvt_pk_bf16_f32 v103, 0, v103
    v_cvt_pk_bf16_f32 v104, 0, v104
    v_cvt_pk_bf16_f32 v105, 0, v105
    v_cvt_pk_bf16_f32 v106, 0, v106
    v_cvt_pk_bf16_f32 v107, 0, v107
    s_waitcnt lgkmcnt(2)
    v_pk_add_f32 v[100:101], v[100:101], v[148:149]
    v_pk_add_f32 v[102:103], v[102:103], v[150:151]
    v_pk_add_f32 v[104:105], v[104:105], v[152:153]
    v_pk_add_f32 v[106:107], v[106:107], v[154:155]
    v_cvt_pk_bf16_f32 v124, v100, v101
    v_cvt_pk_bf16_f32 v125, v102, v103
    v_cvt_pk_bf16_f32 v126, v104, v105
    v_cvt_pk_bf16_f32 v127, v106, v107
    buffer_store_dwordx4 v[124:127], v8, s[32:35], s13 offen sc1
    v_pk_mul_f32 v[108:109], v[108:109], v[140:141]
    v_pk_mul_f32 v[110:111], v[110:111], v[142:143]
    v_pk_mul_f32 v[112:113], v[112:113], v[144:145]
    v_pk_mul_f32 v[114:115], v[114:115], v[146:147]
    v_cvt_pk_bf16_f32 v108, 0, v108
    v_cvt_pk_bf16_f32 v109, 0, v109
    v_cvt_pk_bf16_f32 v110, 0, v110
    v_cvt_pk_bf16_f32 v111, 0, v111
    v_cvt_pk_bf16_f32 v112, 0, v112
    v_cvt_pk_bf16_f32 v113, 0, v113
    v_cvt_pk_bf16_f32 v114, 0, v114
    v_cvt_pk_bf16_f32 v115, 0, v115
    s_waitcnt lgkmcnt(0)
    v_pk_add_f32 v[108:109], v[108:109], v[156:157]
    v_pk_add_f32 v[110:111], v[110:111], v[158:159]
    v_pk_add_f32 v[112:113], v[112:113], v[160:161]
    v_pk_add_f32 v[114:115], v[114:115], v[162:163]
    v_cvt_pk_bf16_f32 v128, v108, v109
    v_cvt_pk_bf16_f32 v129, v110, v111
    v_cvt_pk_bf16_f32 v130, v112, v113
    v_cvt_pk_bf16_f32 v131, v114, v115
    buffer_store_dwordx4 v[128:131], v8, s[32:35], s13 offen offset:256 sc1
    v_lshrrev_b32 v66, 5, v1
    v_mul_u32_u24 v66, 2080, v66
    v_bfe_u32 v9, v1, 2, 2
    v_lshl_add_u32 v66, v9, 7, v66
    v_bfe_u32 v9, v1, 3, 1
    v_lshl_add_u32 v66, v9, 6, v66
    v_and_b32 v9, 3, v1
    v_lshl_add_u32 v66, v9, 3, v66
    v_bfe_u32 v67, v1, 4, 1
    v_mul_u32_u24 v67, 1056, v67
    v_bfe_u32 v68, v1, 3, 1
    v_lshlrev_b32 v68, 7, v68
    v_add_u32 v66, v66, v67
    v_sub_u32 v67, v66, v68
    v_add_u32 v67, 64, v67
    v_add_u32 v68, 49920, v66
    v_add_u32 v69, 49920, v67
    v_add_u32 v70, 99840, v66
    v_add_u32 v71, 99840, v67
    s_lshl_b32 s96, s76, 11
    s_add_u32 s14, s96, 156416
    v_bfe_u32 v4, v1, 2, 2
    v_lshl_add_u32 v4, v4, 6, s14
    v_bfe_u32 v9, v1, 4, 1
    v_lshl_add_u32 v4, v9, 5, v4
    v_and_b32 v9, 3, v1
    v_lshl_add_u32 v4, v9, 3, v4
    v_lshrrev_b32 v9, 5, v1
    v_lshl_add_u32 v4, v9, 9, v4
    v_and_b32 v5, 7, v1
    v_lshlrev_b32 v5, 12, v5
    v_bfe_u32 v9, v1, 3, 1
    v_lshl_add_u32 v5, v9, 19, v5
    s_and_b32 s96, s12, 1
    s_lshl_b32 s97, s21, 15
    s_lshr_b32 s98, s12, 1
    s_lshl_b32 s99, s98, 6
    s_add_u32 s98, s97, s99
    s_lshl2_add_u32 s97, s96, s98
    s_add_u32 s13, s97, 1048576
    v_bfe_u32 v6, v1, 4, 1
    v_lshlrev_b32 v6, 6, v6
    v_lshrrev_b32 v9, 5, v1
    v_lshl_add_u32 v6, v9, 4, v6
    v_and_b32 v74, 7, v1
    v_lshlrev_b32 v74, 4, v74
    v_xor_b32 v74, v74, v6
    v_lshrrev_b32 v6, 3, v1
    v_lshlrev_b32 v6, 11, v6
    v_add_u32 v74, v74, v6
    s_and_b32 s96, s3, 2
    s_lshl_b32 s14, s96, 5
    v_bfe_u32 v6, v1, 4, 1
    v_lshl_add_u32 v6, v6, 5, s14
    v_and_b32 v72, 7, v1
    v_lshlrev_b32 v72, 4, v72
    v_xor_b32 v72, v72, v6
    v_lshrrev_b32 v6, 3, v1
    v_mul_u32_u24 v6, 7168, v6
    v_add_u32 v72, v72, v6
    s_and_b32 s96, s3, 1
    s_lshl_b32 s14, s96, 7
    v_lshrrev_b32 v6, 5, v1
    v_lshl_add_u32 v6, v6, 6, s14
    v_and_b32 v73, 31, v1
    v_lshlrev_b32 v73, 4, v73
    v_lshrrev_b32 v9, 5, v1
    v_lshl_add_u32 v73, v9, 11, v73
    v_xor_b32 v73, v73, v6
    s_lshl3_add_u32 s96, s75, s3
    s_mul_i32 s97, s96, 229376
    s_lshl_b32 s98, s74, 7
    s_add_u32 s80, s97, s98
    s_lshl3_add_u32 s96, s74, s3
    s_lshl_b32 s97, s96, 14
    s_lshl_b32 s98, s75, 9
    s_add_u32 s81, s97, s98
    s_cmp_ge_u32 s9, 28
    s_cselect_b32 s54, 0, s54
    s_cselect_b32 s58, 0, s58
    s_cselect_b32 s62, 0, s62
    s_waitcnt vmcnt(0)
    s_barrier
    s_cmp_lg_u32 s3, 0
    s_cbranch_scc1 L_PB
    v_mov_b32 v6, s4
    s_mov_b32 exec_hi, 0
    s_mov_b32 exec_lo, 65535
    buffer_store_dword v6, v5, s[32:35], s13 offen sc1
    s_mov_b64 exec, -1
L_PB:
    s_and_b32 s20, s9, 3
    s_cmp_le_u32 s20, 0
    s_cselect_b32 s20, 1, 0
    s_add_u32 s96, s20, s85
    s_and_b32 s97, s96, 15
    s_lshl3_add_u32 s98, s97, s3
    s_mul_i32 s99, s98, 49152
    s_lshl_b32 s96, s11, 7
    s_add_u32 s82, s99, s96
    s_mul_i32 s96, s20, 24960
    s_lshr_b32 s97, s3, 1
    s_mul_i32 s98, s97, 2080
    s_add_u32 s99, s96, s98
    s_and_b32 s97, s3, 1
    s_mul_i32 s96, s97, 1056
    s_add_u32 s20, s99, s96
    s_mov_b32 m0, s20
    s_nop 0
    buffer_load_dwordx4 v62, s[40:43], s82 offen lds
    s_add_u32 s82, s82, 2048
    s_add_u32 m0, s20, 8320
    s_nop 0
    buffer_load_dwordx4 v62, s[40:43], s82 offen lds
    s_add_u32 s82, s82, 2048
    s_add_u32 m0, s20, 16640
    s_nop 0
    buffer_load_dwordx4 v62, s[40:43], s82 offen lds
    s_and_b32 s20, s9, 3
    s_cmp_le_u32 s20, 1
    s_cselect_b32 s20, 2, 1
    s_add_u32 s96, s20, s85
    s_and_b32 s97, s96, 15
    s_lshl3_add_u32 s98, s97, s3
    s_mul_i32 s99, s98, 49152
    s_lshl_b32 s96, s11, 7
    s_add_u32 s82, s99, s96
    s_mul_i32 s96, s20, 24960
    s_lshr_b32 s97, s3, 1
    s_mul_i32 s98, s97, 2080
    s_add_u32 s99, s96, s98
    s_and_b32 s97, s3, 1
    s_mul_i32 s96, s97, 1056
    s_add_u32 s20, s99, s96
    s_mov_b32 m0, s20
    s_nop 0
    buffer_load_dwordx4 v62, s[40:43], s82 offen lds
    s_add_u32 s82, s82, 2048
    s_add_u32 m0, s20, 8320
    s_nop 0
    buffer_load_dwordx4 v62, s[40:43], s82 offen lds
    s_add_u32 s82, s82, 2048
    s_add_u32 m0, s20, 16640
    s_nop 0
    buffer_load_dwordx4 v62, s[40:43], s82 offen lds
    ds_read_b64_tr_b16 v[28:29], v4
    ds_read_b64_tr_b16 v[30:31], v4 offset:256
    ds_read_b64_tr_b16 v[32:33], v4 offset:1024
    ds_read_b64_tr_b16 v[34:35], v4 offset:1280
    s_lshl_b32 s96, s10, 6
    s_add_u32 s97, s96, s3
    s_lshl_b32 s98, s97, 12
    s_add_u32 s15, s98, 4194304
    s_and_b32 s96, s3, 3
    s_lshl_b32 s97, s96, 12
    s_add_u32 s13, s97, 147456
    v_add_u32 v76, s13, v2
    v_and_b32 v77, 15, v1
    v_lshl_add_u32 v77, v77, 4, s13
    v_lshrrev_b32 v9, 5, v1
    v_lshl_add_u32 v77, v9, 9, v77
    v_bfe_u32 v9, v1, 4, 1
    v_lshl_add_u32 v77, v9, 3, v77
    s_and_b32 s96, s3, 3
    s_lshl_b32 s97, s96, 10
    s_add_u32 s13, s97, 32768
    v_and_b32 v78, 15, v1
    v_lshl_add_u32 v78, v78, 5, s13
    v_lshrrev_b32 v9, 4, v1
    v_lshl_add_u32 v78, v9, 3, v78
    s_and_b32 s96, s3, 3
    s_lshl_b32 s97, s96, 10
    s_lshl_b32 s98, s76, 14
    s_add_u32 s13, s97, s98
    v_and_b32 v75, 31, v1
    v_lshl_add_u32 v75, v75, 5, s13
    v_lshrrev_b32 v9, 5, v1
    v_lshl_add_u32 v75, v9, 4, v75
    s_lshl_b32 s84, s3, 14
    s_lshr_b32 s96, s9, 4
    s_lshl_b32 s97, s96, 20
    s_lshl_b32 s98, s12, 7
    s_add_u32 s88, s97, s98
    s_lshl_b32 s89, s3, 10
    s_load_dwordx2 s[24:25], s[32:33], s92 offset:0 glc
    s_and_b32 s20, s9, 3
    s_cmp_le_u32 s20, 2
    s_cselect_b32 s20, 3, 2
    s_add_u32 s96, s20, s85
    s_and_b32 s97, s96, 15
    s_lshl3_add_u32 s98, s97, s3
    s_mul_i32 s99, s98, 49152
    s_lshl_b32 s96, s11, 7
    s_add_u32 s82, s99, s96
    s_mul_i32 s96, s20, 24960
    s_lshr_b32 s97, s3, 1
    s_mul_i32 s98, s97, 2080
    s_add_u32 s99, s96, s98
    s_and_b32 s97, s3, 1
    s_mul_i32 s96, s97, 1056
    s_add_u32 s20, s99, s96
    s_mov_b32 m0, s20
    s_nop 0
    buffer_load_dwordx4 v62, s[40:43], s82 offen lds
    s_add_u32 s82, s82, 2048
    s_add_u32 m0, s20, 8320
    s_nop 0
    buffer_load_dwordx4 v62, s[40:43], s82 offen lds
    s_add_u32 s82, s82, 2048
    s_add_u32 m0, s20, 16640
    s_nop 0
    buffer_load_dwordx4 v62, s[40:43], s82 offen lds
    s_add_u32 s96, s85, 4
    s_and_b32 s97, s96, 15
    s_lshl3_add_u32 s98, s97, s3
    s_mul_i32 s99, s98, 49152
    s_lshl_b32 s96, s11, 7
    s_add_u32 s82, s99, s96
    s_lshr_b32 s96, s3, 1
    s_mul_i32 s97, s96, 2080
    s_and_b32 s98, s3, 1
    s_mul_i32 s99, s98, 1056
    s_add_u32 s96, s97, s99
    s_add_u32 s20, s96, 99840
    s_mov_b32 m0, s20
    s_nop 0
    buffer_load_dwordx4 v62, s[40:43], s82 offen lds
    s_add_u32 s82, s82, 2048
    s_add_u32 m0, s20, 8320
    s_nop 0
    buffer_load_dwordx4 v62, s[40:43], s82 offen lds
    s_add_u32 s82, s82, 2048
    s_add_u32 m0, s20, 16640
    s_nop 0
    buffer_load_dwordx4 v62, s[40:43], s82 offen lds
    s_branch SCHK_12
SPOLL_11:
    s_load_dwordx2 s[24:25], s[32:33], s92 offset:0 glc
SCHK_12:
    s_add_u32 s5, s5, 1
    s_cmp_ge_u32 s5, 300000
    s_waitcnt lgkmcnt(0)
    s_cbranch_scc1 SDONE_13
    s_cmp_lg_u32 s24, s4
    s_cbranch_scc1 SPOLL_11
    s_cmp_lg_u32 s25, s4
    s_cbranch_scc1 SPOLL_11
SDONE_13:
    s_waitcnt vmcnt(9)
    s_barrier
    s_cmp_ge_u32 s3, 4
    s_cbranch_scc1 L_HELP
    s_setprio 2
    s_and_b32 s96, s85, 15
    s_lshl_b32 s97, s96, 14
    s_add_u32 s16, s97, s15
    buffer_load_dwordx4 v[176:179], v2, s[32:35], s16 offen sc1
    buffer_load_dwordx4 v[180:183], v2, s[32:35], s16 offen offset:1024 sc1
    ds_read_b64_tr_b16 v[224:225], v67 offset:8320
    ds_read_b64_tr_b16 v[226:227], v67 offset:8832
    ds_read_b64_tr_b16 v[228:229], v67 offset:8352
    ds_read_b64_tr_b16 v[230:231], v67 offset:8864
    ds_read_b64_tr_b16 v[232:233], v66 offset:8320
    ds_read_b64_tr_b16 v[234:235], v66 offset:8832
    ds_read_b64_tr_b16 v[236:237], v66 offset:8352
    ds_read_b64_tr_b16 v[238:239], v66 offset:8864
    ds_read_b64_tr_b16 v[240:241], v66
    ds_read_b64_tr_b16 v[242:243], v66 offset:512
    ds_read_b64_tr_b16 v[244:245], v66 offset:32
    ds_read_b64_tr_b16 v[246:247], v66 offset:544
    buffer_load_dwordx4 v[184:187], v2, s[32:35], s16 offen offset:2048 sc1
    buffer_load_dwordx4 v[188:191], v2, s[32:35], s16 offen offset:3072 sc1
    s_waitcnt lgkmcnt(8)
    s_waitcnt vmcnt(3)
    v_mfma_f32_16x16x32_bf16 v[128:131], v[224:227], v[176:179], 0
    ds_read_b64_tr_b16 v[248:249], v67
    s_waitcnt vmcnt(2)
    v_mfma_f32_16x16x32_bf16 v[132:135], v[224:227], v[180:183], 0
    ds_read_b64_tr_b16 v[250:251], v67 offset:512
    s_add_u32 s96, s85, 1
    s_and_b32 s97, s96, 15
    s_lshl_b32 s98, s97, 14
    s_add_u32 s16, s98, s15
    buffer_load_dwordx4 v[192:195], v2, s[32:35], s16 offen sc1
    v_mfma_f32_16x16x32_bf16 v[136:139], v[228:231], v[176:179], 0
    ds_read_b64_tr_b16 v[224:225], v67 offset:32
    v_mfma_f32_16x16x32_bf16 v[140:143], v[228:231], v[180:183], 0
    ds_read_b64_tr_b16 v[226:227], v67 offset:544
    s_waitcnt lgkmcnt(8)
    v_mfma_f32_16x16x32_bf16 v[112:115], v[232:235], v[176:179], 0
    ds_read_b64_tr_b16 v[228:229], v66 offset:16640
    v_mfma_f32_16x16x32_bf16 v[116:119], v[232:235], v[180:183], 0
    ds_read_b64_tr_b16 v[230:231], v66 offset:17152
    v_mfma_f32_16x16x32_bf16 v[120:123], v[236:239], v[176:179], 0
    ds_read_b64_tr_b16 v[232:233], v66 offset:16672
    v_mfma_f32_16x16x32_bf16 v[124:127], v[236:239], v[180:183], 0
    ds_read_b64_tr_b16 v[234:235], v66 offset:17184
    buffer_load_dwordx4 v[196:199], v2, s[32:35], s16 offen offset:1024 sc1
    s_waitcnt lgkmcnt(8)
    v_mfma_f32_16x16x32_bf16 v[80:83], v[240:243], v[176:179], 0
    ds_read_b64_tr_b16 v[236:237], v67 offset:16640
    v_mfma_f32_16x16x32_bf16 v[84:87], v[240:243], v[180:183], 0
    ds_read_b64_tr_b16 v[238:239], v67 offset:17152
    v_mfma_f32_16x16x32_bf16 v[88:91], v[244:247], v[176:179], 0
    ds_read_b64_tr_b16 v[240:241], v67 offset:16672
    v_mfma_f32_16x16x32_bf16 v[92:95], v[244:247], v[180:183], 0
    ds_read_b64_tr_b16 v[242:243], v67 offset:17184
    s_waitcnt lgkmcnt(8)
    v_mfma_f32_16x16x32_bf16 v[96:99], v[248:251], v[176:179], 0
    ds_read_b64_tr_b16 v[244:245], v67 offset:12480
    v_mfma_f32_16x16x32_bf16 v[100:103], v[248:251], v[180:183], 0
    ds_read_b64_tr_b16 v[246:247], v67 offset:12992
    buffer_load_dwordx4 v[200:203], v2, s[32:35], s16 offen offset:2048 sc1
    v_mfma_f32_16x16x32_bf16 v[104:107], v[224:227], v[176:179], 0
    ds_read_b64_tr_b16 v[248:249], v67 offset:12512
    v_mfma_f32_16x16x32_bf16 v[108:111], v[224:227], v[180:183], 0
    ds_read_b64_tr_b16 v[250:251], v67 offset:13024
    s_waitcnt lgkmcnt(8)
    v_mfma_f32_16x16x32_bf16 v[144:147], v[228:231], v[176:179], 0
    ds_read_b64_tr_b16 v[224:225], v66 offset:12480
    v_mfma_f32_16x16x32_bf16 v[148:151], v[228:231], v[180:183], 0
    ds_read_b64_tr_b16 v[226:227], v66 offset:12992
    v_mfma_f32_16x16x32_bf16 v[152:155], v[232:235], v[176:179], 0
    ds_read_b64_tr_b16 v[228:229], v66 offset:12512
    v_mfma_f32_16x16x32_bf16 v[156:159], v[232:235], v[180:183], 0
    ds_read_b64_tr_b16 v[230:231], v66 offset:13024
    buffer_load_dwordx4 v[204:207], v2, s[32:35], s16 offen offset:3072 sc1
    s_waitcnt lgkmcnt(8)
    v_mfma_f32_16x16x32_bf16 v[160:163], v[236:239], v[176:179], 0
    ds_read_b64_tr_b16 v[232:233], v66 offset:4160
    v_mfma_f32_16x16x32_bf16 v[164:167], v[236:239], v[180:183], 0
    ds_read_b64_tr_b16 v[234:235], v66 offset:4672
    v_mfma_f32_16x16x32_bf16 v[168:171], v[240:243], v[176:179], 0
    ds_read_b64_tr_b16 v[236:237], v66 offset:4192
    v_mfma_f32_16x16x32_bf16 v[172:175], v[240:243], v[180:183], 0
    ds_read_b64_tr_b16 v[238:239], v66 offset:4704
    s_waitcnt lgkmcnt(8)
    s_waitcnt vmcnt(5)
    v_mfma_f32_16x16x32_bf16 v[128:131], v[244:247], v[184:187], v[128:131]
    ds_read_b64_tr_b16 v[240:241], v67 offset:4160
    s_waitcnt vmcnt(4)
    v_mfma_f32_16x16x32_bf16 v[132:135], v[244:247], v[188:191], v[132:135]
    ds_read_b64_tr_b16 v[242:243], v67 offset:4672
    s_add_u32 s96, s85, 2
    s_and_b32 s97, s96, 15
    s_lshl_b32 s98, s97, 14
    s_add_u32 s16, s98, s15
    buffer_load_dwordx4 v[208:211], v2, s[32:35], s16 offen sc1
    v_mfma_f32_16x16x32_bf16 v[136:139], v[248:251], v[184:187], v[136:139]
    ds_read_b64_tr_b16 v[244:245], v67 offset:4192
    v_mfma_f32_16x16x32_bf16 v[140:143], v[248:251], v[188:191], v[140:143]
    ds_read_b64_tr_b16 v[246:247], v67 offset:4704
    s_waitcnt lgkmcnt(8)
    v_mfma_f32_16x16x32_bf16 v[112:115], v[224:227], v[184:187], v[112:115]
    ds_read_b64_tr_b16 v[248:249], v66 offset:20800
    v_mfma_f32_16x16x32_bf16 v[116:119], v[224:227], v[188:191], v[116:119]
    ds_read_b64_tr_b16 v[250:251], v66 offset:21312
    v_mfma_f32_16x16x32_bf16 v[120:123], v[228:231], v[184:187], v[120:123]
    ds_read_b64_tr_b16 v[224:225], v66 offset:20832
    v_mfma_f32_16x16x32_bf16 v[124:127], v[228:231], v[188:191], v[124:127]
    ds_read_b64_tr_b16 v[226:227], v66 offset:21344
    buffer_load_dwordx4 v[212:215], v2, s[32:35], s16 offen offset:1024 sc1
    s_waitcnt lgkmcnt(8)
    v_mfma_f32_16x16x32_bf16 v[80:83], v[232:235], v[184:187], v[80:83]
    ds_read_b64_tr_b16 v[228:229], v67 offset:20800
    v_mfma_f32_16x16x32_bf16 v[84:87], v[232:235], v[188:191], v[84:87]
    ds_read_b64_tr_b16 v[230:231], v67 offset:21312
    v_mfma_f32_16x16x32_bf16 v[88:91], v[236:239], v[184:187], v[88:91]
    ds_read_b64_tr_b16 v[232:233], v67 offset:20832
    v_mfma_f32_16x16x32_bf16 v[92:95], v[236:239], v[188:191], v[92:95]
    ds_read_b64_tr_b16 v[234:235], v67 offset:21344
    s_waitcnt lgkmcnt(8)
    v_mfma_f32_16x16x32_bf16 v[96:99], v[240:243], v[184:187], v[96:99]
    s_barrier
    ds_read_b64_tr_b16 v[236:237], v67 offset:33280
    v_mfma_f32_16x16x32_bf16 v[100:103], v[240:243], v[188:191], v[100:103]
    ds_read_b64_tr_b16 v[238:239], v67 offset:33792
    buffer_load_dwordx4 v[216:219], v2, s[32:35], s16 offen offset:2048 sc1
    v_mfma_f32_16x16x32_bf16 v[104:107], v[244:247], v[184:187], v[104:107]
    ds_read_b64_tr_b16 v[240:241], v67 offset:33312
    v_mfma_f32_16x16x32_bf16 v[108:111], v[244:247], v[188:191], v[108:111]
    ds_read_b64_tr_b16 v[242:243], v67 offset:33824
    s_waitcnt lgkmcnt(8)
    v_mfma_f32_16x16x32_bf16 v[144:147], v[248:251], v[184:187], v[144:147]
    ds_read_b64_tr_b16 v[244:245], v66 offset:33280
    v_mfma_f32_16x16x32_bf16 v[148:151], v[248:251], v[188:191], v[148:151]
    ds_read_b64_tr_b16 v[246:247], v66 offset:33792
    v_mfma_f32_16x16x32_bf16 v[152:155], v[224:227], v[184:187], v[152:155]
    ds_read_b64_tr_b16 v[248:249], v66 offset:33312
    v_mfma_f32_16x16x32_bf16 v[156:159], v[224:227], v[188:191], v[156:159]
    ds_read_b64_tr_b16 v[250:251], v66 offset:33824
    buffer_load_dwordx4 v[220:223], v2, s[32:35], s16 offen offset:3072 sc1
    s_waitcnt lgkmcnt(8)
    v_mfma_f32_16x16x32_bf16 v[160:163], v[228:231], v[184:187], v[160:163]
    ds_read_b64_tr_b16 v[224:225], v66 offset:24960
    v_mfma_f32_16x16x32_bf16 v[164:167], v[228:231], v[188:191], v[164:167]
    ds_read_b64_tr_b16 v[226:227], v66 offset:25472
    v_mfma_f32_16x16x32_bf16 v[168:171], v[232:235], v[184:187], v[168:171]
    ds_read_b64_tr_b16 v[228:229], v66 offset:24992
    v_mfma_f32_16x16x32_bf16 v[172:175], v[232:235], v[188:191], v[172:175]
    ds_read_b64_tr_b16 v[230:231], v66 offset:25504
    s_waitcnt lgkmcnt(8)
    s_waitcnt vmcnt(6)
    v_mfma_f32_16x16x32_bf16 v[128:131], v[236:239], v[192:195], v[128:131]
    ds_read_b64_tr_b16 v[232:233], v67 offset:24960
    v_mfma_f32_16x16x32_bf16 v[132:135], v[236:239], v[196:199], v[132:135]
    ds_read_b64_tr_b16 v[234:235], v67 offset:25472
    s_add_u32 s96, s85, 3
    s_and_b32 s97, s96, 15
    s_lshl_b32 s98, s97, 14
    s_add_u32 s16, s98, s15
    buffer_load_dwordx4 v[36:39], v2, s[32:35], s16 offen sc1
    v_mfma_f32_16x16x32_bf16 v[136:139], v[240:243], v[192:195], v[136:139]
    ds_read_b64_tr_b16 v[236:237], v67 offset:24992
    v_mfma_f32_16x16x32_bf16 v[140:143], v[240:243], v[196:199], v[140:143]
    ds_read_b64_tr_b16 v[238:239], v67 offset:25504
    s_waitcnt lgkmcnt(8)
    v_mfma_f32_16x16x32_bf16 v[112:115], v[244:247], v[192:195], v[112:115]
    ds_read_b64_tr_b16 v[240:241], v66 offset:41600
    v_mfma_f32_16x16x32_bf16 v[116:119], v[244:247], v[196:199], v[116:119]
    ds_read_b64_tr_b16 v[242:243], v66 offset:42112
    v_mfma_f32_16x16x32_bf16 v[120:123], v[248:251], v[192:195], v[120:123]
    ds_read_b64_tr_b16 v[244:245], v66 offset:41632
    v_mfma_f32_16x16x32_bf16 v[124:127], v[248:251], v[196:199], v[124:127]
    ds_read_b64_tr_b16 v[246:247], v66 offset:42144
    buffer_load_dwordx4 v[176:179], v2, s[32:35], s16 offen offset:1024 sc1
    s_waitcnt lgkmcnt(8)
    v_mfma_f32_16x16x32_bf16 v[80:83], v[224:227], v[192:195], v[80:83]
    ds_read_b64_tr_b16 v[248:249], v67 offset:41600
    v_mfma_f32_16x16x32_bf16 v[84:87], v[224:227], v[196:199], v[84:87]
    ds_read_b64_tr_b16 v[250:251], v67 offset:42112
    v_mfma_f32_16x16x32_bf16 v[88:91], v[228:231], v[192:195], v[88:91]
    ds_read_b64_tr_b16 v[224:225], v67 offset:41632
    v_mfma_f32_16x16x32_bf16 v[92:95], v[228:231], v[196:199], v[92:95]
    ds_read_b64_tr_b16 v[226:227], v67 offset:42144
    s_waitcnt lgkmcnt(8)
    v_mfma_f32_16x16x32_bf16 v[96:99], v[232:235], v[192:195], v[96:99]
    ds_read_b64_tr_b16 v[228:229], v67 offset:37440
    v_mfma_f32_16x16x32_bf16 v[100:103], v[232:235], v[196:199], v[100:103]
    ds_read_b64_tr_b16 v[230:231], v67 offset:37952
    buffer_load_dwordx4 v[180:183], v2, s[32:35], s16 offen offset:2048 sc1
    v_mfma_f32_16x16x32_bf16 v[104:107], v[236:239], v[192:195], v[104:107]
    ds_read_b64_tr_b16 v[232:233], v67 offset:37472
    v_mfma_f32_16x16x32_bf16 v[108:111], v[236:239], v[196:199], v[108:111]
    ds_read_b64_tr_b16 v[234:235], v67 offset:37984
    s_waitcnt lgkmcnt(8)
    v_mfma_f32_16x16x32_bf16 v[144:147], v[240:243], v[192:195], v[144:147]
    ds_read_b64_tr_b16 v[236:237], v66 offset:37440
    v_mfma_f32_16x16x32_bf16 v[148:151], v[240:243], v[196:199], v[148:151]
    ds_read_b64_tr_b16 v[238:239], v66 offset:37952
    v_mfma_f32_16x16x32_bf16 v[152:155], v[244:247], v[192:195], v[152:155]
    ds_read_b64_tr_b16 v[240:241], v66 offset:37472
    v_mfma_f32_16x16x32_bf16 v[156:159], v[244:247], v[196:199], v[156:159]
    ds_read_b64_tr_b16 v[242:243], v66 offset:37984
    buffer_load_dwordx4 v[184:187], v2, s[32:35], s16 offen offset:3072 sc1
    s_waitcnt lgkmcnt(8)
    v_mfma_f32_16x16x32_bf16 v[160:163], v[248:251], v[192:195], v[160:163]
    ds_read_b64_tr_b16 v[244:245], v66 offset:29120
    v_mfma_f32_16x16x32_bf16 v[164:167], v[248:251], v[196:199], v[164:167]
    ds_read_b64_tr_b16 v[246:247], v66 offset:29632
    v_mfma_f32_16x16x32_bf16 v[168:171], v[224:227], v[192:195], v[168:171]
    ds_read_b64_tr_b16 v[248:249], v66 offset:29152
    v_mfma_f32_16x16x32_bf16 v[172:175], v[224:227], v[196:199], v[172:175]
    ds_read_b64_tr_b16 v[250:251], v66 offset:29664
    s_waitcnt lgkmcnt(8)
    s_waitcnt vmcnt(8)
    v_mfma_f32_16x16x32_bf16 v[128:131], v[228:231], v[200:203], v[128:131]
    ds_read_b64_tr_b16 v[224:225], v67 offset:29120
    v_mfma_f32_16x16x32_bf16 v[132:135], v[228:231], v[204:207], v[132:135]
    ds_read_b64_tr_b16 v[226:227], v67 offset:29632
    s_add_u32 s96, s85, 4
    s_and_b32 s97, s96, 15
    s_lshl_b32 s98, s97, 14
    s_add_u32 s16, s98, s15
    buffer_load_dwordx4 v[188:191], v2, s[32:35], s16 offen sc1
    v_mfma_f32_16x16x32_bf16 v[136:139], v[232:235], v[200:203], v[136:139]
    ds_read_b64_tr_b16 v[228:229], v67 offset:29152
    v_mfma_f32_16x16x32_bf16 v[140:143], v[232:235], v[204:207], v[140:143]
    ds_read_b64_tr_b16 v[230:231], v67 offset:29664
    s_waitcnt lgkmcnt(8)
    v_mfma_f32_16x16x32_bf16 v[112:115], v[236:239], v[200:203], v[112:115]
    ds_read_b64_tr_b16 v[232:233], v66 offset:45760
    v_mfma_f32_16x16x32_bf16 v[116:119], v[236:239], v[204:207], v[116:119]
    ds_read_b64_tr_b16 v[234:235], v66 offset:46272
    v_mfma_f32_16x16x32_bf16 v[120:123], v[240:243], v[200:203], v[120:123]
    ds_read_b64_tr_b16 v[236:237], v66 offset:45792
    v_mfma_f32_16x16x32_bf16 v[124:127], v[240:243], v[204:207], v[124:127]
    ds_read_b64_tr_b16 v[238:239], v66 offset:46304
    buffer_load_dwordx4 v[192:195], v2, s[32:35], s16 offen offset:1024 sc1
    s_waitcnt lgkmcnt(8)
    v_mfma_f32_16x16x32_bf16 v[80:83], v[244:247], v[200:203], v[80:83]
    ds_read_b64_tr_b16 v[240:241], v67 offset:45760
    v_mfma_f32_16x16x32_bf16 v[84:87], v[244:247], v[204:207], v[84:87]
    ds_read_b64_tr_b16 v[242:243], v67 offset:46272
    v_mfma_f32_16x16x32_bf16 v[88:91], v[248:251], v[200:203], v[88:91]
    ds_read_b64_tr_b16 v[244:245], v67 offset:45792
    v_mfma_f32_16x16x32_bf16 v[92:95], v[248:251], v[204:207], v[92:95]
    ds_read_b64_tr_b16 v[246:247], v67 offset:46304
    s_waitcnt lgkmcnt(8)
    v_mfma_f32_16x16x32_bf16 v[96:99], v[224:227], v[200:203], v[96:99]
    s_barrier
    ds_read_b64_tr_b16 v[248:249], v69 offset:8320
    v_mfma_f32_16x16x32_bf16 v[100:103], v[224:227], v[204:207], v[100:103]
    ds_read_b64_tr_b16 v[250:251], v69 offset:8832
    buffer_load_dwordx4 v[196:199], v2, s[32:35], s16 offen offset:2048 sc1
    v_mfma_f32_16x16x32_bf16 v[104:107], v[228:231], v[200:203], v[104:107]
    ds_read_b64_tr_b16 v[224:225], v69 offset:8352
    v_mfma_f32_16x16x32_bf16 v[108:111], v[228:231], v[204:207], v[108:111]
    ds_read_b64_tr_b16 v[226:227], v69 offset:8864
    s_waitcnt lgkmcnt(8)
    v_mfma_f32_16x16x32_bf16 v[144:147], v[232:235], v[200:203], v[144:147]
    ds_read_b64_tr_b16 v[228:229], v68 offset:8320
    v_mfma_f32_16x16x32_bf16 v[148:151], v[232:235], v[204:207], v[148:151]
    ds_read_b64_tr_b16 v[230:231], v68 offset:8832
    v_mfma_f32_16x16x32_bf16 v[152:155], v[236:239], v[200:203], v[152:155]
    ds_read_b64_tr_b16 v[232:233], v68 offset:8352
    v_mfma_f32_16x16x32_bf16 v[156:159], v[236:239], v[204:207], v[156:159]
    ds_read_b64_tr_b16 v[234:235], v68 offset:8864
    s_waitcnt lgkmcnt(8)
    v_mfma_f32_16x16x32_bf16 v[160:163], v[240:243], v[200:203], v[160:163]
    ds_read_b64_tr_b16 v[236:237], v68
    v_mfma_f32_16x16x32_bf16 v[164:167], v[240:243], v[204:207], v[164:167]
    ds_read_b64_tr_b16 v[238:239], v68 offset:512
    v_mfma_f32_16x16x32_bf16 v[168:171], v[244:247], v[200:203], v[168:171]
    ds_read_b64_tr_b16 v[240:241], v68 offset:32
    v_mfma_f32_16x16x32_bf16 v[172:175], v[244:247], v[204:207], v[172:175]
    ds_read_b64_tr_b16 v[242:243], v68 offset:544
    s_waitcnt lgkmcnt(8)
    s_waitcnt vmcnt(9)
    v_mfma_f32_16x16x32_bf16 v[128:131], v[248:251], v[208:211], v[128:131]
    ds_read_b64_tr_b16 v[244:245], v69
    v_mfma_f32_16x16x32_bf16 v[132:135], v[248:251], v[212:215], v[132:135]
    ds_read_b64_tr_b16 v[246:247], v69 offset:512
    buffer_load_dwordx4 v[200:203], v2, s[32:35], s16 offen offset:3072 sc1
    v_mfma_f32_16x16x32_bf16 v[136:139], v[224:227], v[208:211], v[136:139]
    ds_read_b64_tr_b16 v[248:249], v69 offset:32
    v_mfma_f32_16x16x32_bf16 v[140:143], v[224:227], v[212:215], v[140:143]
    ds_read_b64_tr_b16 v[250:251], v69 offset:544
    s_waitcnt lgkmcnt(8)
    v_mfma_f32_16x16x32_bf16 v[112:115], v[228:231], v[208:211], v[112:115]
    ds_read_b64_tr_b16 v[224:225], v68 offset:16640
    v_mfma_f32_16x16x32_bf16 v[116:119], v[228:231], v[212:215], v[116:119]
    ds_read_b64_tr_b16 v[226:227], v68 offset:17152
    v_mfma_f32_16x16x32_bf16 v[120:123], v[232:235], v[208:211], v[120:123]
    ds_read_b64_tr_b16 v[228:229], v68 offset:16672
    v_mfma_f32_16x16x32_bf16 v[124:127], v[232:235], v[212:215], v[124:127]
    ds_read_b64_tr_b16 v[230:231], v68 offset:17184
    s_add_u32 s96, s85, 5
    s_and_b32 s97, s96, 15
    s_lshl_b32 s98, s97, 14
    s_add_u32 s16, s98, s15
    buffer_load_dwordx4 v[204:207], v2, s[32:35], s16 offen sc1
    s_waitcnt lgkmcnt(8)
    v_mfma_f32_16x16x32_bf16 v[80:83], v[236:239], v[208:211], v[80:83]
    ds_read_b64_tr_b16 v[232:233], v69 offset:16640
    v_mfma_f32_16x16x32_bf16 v[84:87], v[236:239], v[212:215], v[84:87]
    ds_read_b64_tr_b16 v[234:235], v69 offset:17152
    v_mfma_f32_16x16x32_bf16 v[88:91], v[240:243], v[208:211], v[88:91]
    ds_read_b64_tr_b16 v[236:237], v69 offset:16672
    v_mfma_f32_16x16x32_bf16 v[92:95], v[240:243], v[212:215], v[92:95]
    ds_read_b64_tr_b16 v[238:239], v69 offset:17184
    s_waitcnt lgkmcnt(8)
    v_mfma_f32_16x16x32_bf16 v[96:99], v[244:247], v[208:211], v[96:99]
    ds_read_b64_tr_b16 v[240:241], v69 offset:12480
    v_mfma_f32_16x16x32_bf16 v[100:103], v[244:247], v[212:215], v[100:103]
    ds_read_b64_tr_b16 v[242:243], v69 offset:12992
    v_mfma_f32_16x16x32_bf16 v[104:107], v[248:251], v[208:211], v[104:107]
    ds_read_b64_tr_b16 v[244:245], v69 offset:12512
    v_mfma_f32_16x16x32_bf16 v[108:111], v[248:251], v[212:215], v[108:111]
    ds_read_b64_tr_b16 v[246:247], v69 offset:13024
    s_waitcnt lgkmcnt(8)
    v_mfma_f32_16x16x32_bf16 v[144:147], v[224:227], v[208:211], v[144:147]
    ds_read_b64_tr_b16 v[248:249], v68 offset:12480
    v_mfma_f32_16x16x32_bf16 v[148:151], v[224:227], v[212:215], v[148:151]
    ds_read_b64_tr_b16 v[250:251], v68 offset:12992
    v_mfma_f32_16x16x32_bf16 v[152:155], v[228:231], v[208:211], v[152:155]
    ds_read_b64_tr_b16 v[224:225], v68 offset:12512
    v_mfma_f32_16x16x32_bf16 v[156:159], v[228:231], v[212:215], v[156:159]
    ds_read_b64_tr_b16 v[226:227], v68 offset:13024
    s_waitcnt lgkmcnt(8)
    v_mfma_f32_16x16x32_bf16 v[160:163], v[232:235], v[208:211], v[160:163]
    ds_read_b64_tr_b16 v[228:229], v68 offset:4160
    v_mfma_f32_16x16x32_bf16 v[164:167], v[232:235], v[212:215], v[164:167]
    ds_read_b64_tr_b16 v[230:231], v68 offset:4672
    v_mfma_f32_16x16x32_bf16 v[168:171], v[236:239], v[208:211], v[168:171]
    ds_read_b64_tr_b16 v[232:233], v68 offset:4192
    v_mfma_f32_16x16x32_bf16 v[172:175], v[236:239], v[212:215], v[172:175]
    ds_read_b64_tr_b16 v[234:235], v68 offset:4704
    s_waitcnt lgkmcnt(8)
    s_waitcnt vmcnt(9)
    v_mfma_f32_16x16x32_bf16 v[128:131], v[240:243], v[216:219], v[128:131]
    ds_read_b64_tr_b16 v[236:237], v69 offset:4160
    v_mfma_f32_16x16x32_bf16 v[132:135], v[240:243], v[220:223], v[132:135]
    ds_read_b64_tr_b16 v[238:239], v69 offset:4672
    buffer_load_dwordx4 v[208:211], v2, s[32:35], s16 offen offset:1024 sc1
    v_mfma_f32_16x16x32_bf16 v[136:139], v[244:247], v[216:219], v[136:139]
    ds_read_b64_tr_b16 v[240:241], v69 offset:4192
    v_mfma_f32_16x16x32_bf16 v[140:143], v[244:247], v[220:223], v[140:143]
    ds_read_b64_tr_b16 v[242:243], v69 offset:4704
    s_waitcnt lgkmcnt(8)
    v_mfma_f32_16x16x32_bf16 v[112:115], v[248:251], v[216:219], v[112:115]
    ds_read_b64_tr_b16 v[244:245], v68 offset:20800
    v_mfma_f32_16x16x32_bf16 v[116:119], v[248:251], v[220:223], v[116:119]
    ds_read_b64_tr_b16 v[246:247], v68 offset:21312
    v_mfma_f32_16x16x32_bf16 v[120:123], v[224:227], v[216:219], v[120:123]
    ds_read_b64_tr_b16 v[248:249], v68 offset:20832
    v_mfma_f32_16x16x32_bf16 v[124:127], v[224:227], v[220:223], v[124:127]
    ds_read_b64_tr_b16 v[250:251], v68 offset:21344
    buffer_load_dwordx4 v[212:215], v2, s[32:35], s16 offen offset:2048 sc1
    s_waitcnt lgkmcnt(8)
    v_mfma_f32_16x16x32_bf16 v[80:83], v[228:231], v[216:219], v[80:83]
    ds_read_b64_tr_b16 v[224:225], v69 offset:20800
    v_mfma_f32_16x16x32_bf16 v[84:87], v[228:231], v[220:223], v[84:87]
    ds_read_b64_tr_b16 v[226:227], v69 offset:21312
    v_mfma_f32_16x16x32_bf16 v[88:91], v[232:235], v[216:219], v[88:91]
    ds_read_b64_tr_b16 v[228:229], v69 offset:20832
    v_mfma_f32_16x16x32_bf16 v[92:95], v[232:235], v[220:223], v[92:95]
    ds_read_b64_tr_b16 v[230:231], v69 offset:21344
    s_waitcnt lgkmcnt(8)
    v_mfma_f32_16x16x32_bf16 v[96:99], v[236:239], v[216:219], v[96:99]
    s_barrier
    ds_read_b64_tr_b16 v[232:233], v69 offset:33280
    v_mfma_f32_16x16x32_bf16 v[100:103], v[236:239], v[220:223], v[100:103]
    ds_read_b64_tr_b16 v[234:235], v69 offset:33792
    v_mfma_f32_16x16x32_bf16 v[104:107], v[240:243], v[216:219], v[104:107]
    ds_read_b64_tr_b16 v[236:237], v69 offset:33312
    v_mfma_f32_16x16x32_bf16 v[108:111], v[240:243], v[220:223], v[108:111]
    ds_read_b64_tr_b16 v[238:239], v69 offset:33824
    s_waitcnt lgkmcnt(8)
    v_mfma_f32_16x16x32_bf16 v[144:147], v[244:247], v[216:219], v[144:147]
    ds_read_b64_tr_b16 v[240:241], v68 offset:33280
    v_mfma_f32_16x16x32_bf16 v[148:151], v[244:247], v[220:223], v[148:151]
    ds_read_b64_tr_b16 v[242:243], v68 offset:33792
    v_mfma_f32_16x16x32_bf16 v[152:155], v[248:251], v[216:219], v[152:155]
    ds_read_b64_tr_b16 v[244:245], v68 offset:33312
    v_mfma_f32_16x16x32_bf16 v[156:159], v[248:251], v[220:223], v[156:159]
    ds_read_b64_tr_b16 v[246:247], v68 offset:33824
    s_waitcnt lgkmcnt(8)
    v_mfma_f32_16x16x32_bf16 v[160:163], v[224:227], v[216:219], v[160:163]
    ds_read_b64_tr_b16 v[248:249], v68 offset:24960
    v_mfma_f32_16x16x32_bf16 v[164:167], v[224:227], v[220:223], v[164:167]
    ds_read_b64_tr_b16 v[250:251], v68 offset:25472
    v_mfma_f32_16x16x32_bf16 v[168:171], v[228:231], v[216:219], v[168:171]
    ds_read_b64_tr_b16 v[224:225], v68 offset:24992
    v_mfma_f32_16x16x32_bf16 v[172:175], v[228:231], v[220:223], v[172:175]
    ds_read_b64_tr_b16 v[226:227], v68 offset:25504
    s_waitcnt lgkmcnt(8)
    s_waitcnt vmcnt(9)
    v_mfma_f32_16x16x32_bf16 v[128:131], v[232:235], v[36:39], v[128:131]
    ds_read_b64_tr_b16 v[228:229], v69 offset:24960
    v_mfma_f32_16x16x32_bf16 v[132:135], v[232:235], v[176:179], v[132:135]
    ds_read_b64_tr_b16 v[230:231], v69 offset:25472
    buffer_load_dwordx4 v[216:219], v2, s[32:35], s16 offen offset:3072 sc1
    v_mfma_f32_16x16x32_bf16 v[136:139], v[236:239], v[36:39], v[136:139]
    ds_read_b64_tr_b16 v[232:233], v69 offset:24992
    v_mfma_f32_16x16x32_bf16 v[140:143], v[236:239], v[176:179], v[140:143]
    ds_read_b64_tr_b16 v[234:235], v69 offset:25504
    s_waitcnt lgkmcnt(8)
    v_mfma_f32_16x16x32_bf16 v[112:115], v[240:243], v[36:39], v[112:115]
    ds_read_b64_tr_b16 v[236:237], v68 offset:41600
    v_mfma_f32_16x16x32_bf16 v[116:119], v[240:243], v[176:179], v[116:119]
    ds_read_b64_tr_b16 v[238:239], v68 offset:42112
    v_mfma_f32_16x16x32_bf16 v[120:123], v[244:247], v[36:39], v[120:123]
    ds_read_b64_tr_b16 v[240:241], v68 offset:41632
    v_mfma_f32_16x16x32_bf16 v[124:127], v[244:247], v[176:179], v[124:127]
    ds_read_b64_tr_b16 v[242:243], v68 offset:42144
    s_add_u32 s96, s85, 6
    s_and_b32 s97, s96, 15
    s_lshl_b32 s98, s97, 14
    s_add_u32 s16, s98, s15
    buffer_load_dwordx4 v[220:223], v2, s[32:35], s16 offen sc1
    s_waitcnt lgkmcnt(8)
    v_mfma_f32_16x16x32_bf16 v[80:83], v[248:251], v[36:39], v[80:83]
    ds_read_b64_tr_b16 v[244:245], v69 offset:41600
    v_mfma_f32_16x16x32_bf16 v[84:87], v[248:251], v[176:179], v[84:87]
    ds_read_b64_tr_b16 v[246:247], v69 offset:42112
    v_mfma_f32_16x16x32_bf16 v[88:91], v[224:227], v[36:39], v[88:91]
    ds_read_b64_tr_b16 v[248:249], v69 offset:41632
    v_mfma_f32_16x16x32_bf16 v[92:95], v[224:227], v[176:179], v[92:95]
    ds_read_b64_tr_b16 v[250:251], v69 offset:42144
    s_waitcnt lgkmcnt(8)
    v_mfma_f32_16x16x32_bf16 v[96:99], v[228:231], v[36:39], v[96:99]
    ds_read_b64_tr_b16 v[224:225], v69 offset:37440
    v_mfma_f32_16x16x32_bf16 v[100:103], v[228:231], v[176:179], v[100:103]
    ds_read_b64_tr_b16 v[226:227], v69 offset:37952
    v_mfma_f32_16x16x32_bf16 v[104:107], v[232:235], v[36:39], v[104:107]
    ds_read_b64_tr_b16 v[228:229], v69 offset:37472
    v_mfma_f32_16x16x32_bf16 v[108:111], v[232:235], v[176:179], v[108:111]
    ds_read_b64_tr_b16 v[230:231], v69 offset:37984
    s_waitcnt lgkmcnt(8)
    v_mfma_f32_16x16x32_bf16 v[144:147], v[236:239], v[36:39], v[144:147]
    ds_read_b64_tr_b16 v[232:233], v68 offset:37440
    v_mfma_f32_16x16x32_bf16 v[148:151], v[236:239], v[176:179], v[148:151]
    ds_read_b64_tr_b16 v[234:235], v68 offset:37952
    v_mfma_f32_16x16x32_bf16 v[152:155], v[240:243], v[36:39], v[152:155]
    ds_read_b64_tr_b16 v[236:237], v68 offset:37472
    v_mfma_f32_16x16x32_bf16 v[156:159], v[240:243], v[176:179], v[156:159]
    ds_read_b64_tr_b16 v[238:239], v68 offset:37984
    s_waitcnt lgkmcnt(8)
    v_mfma_f32_16x16x32_bf16 v[160:163], v[244:247], v[36:39], v[160:163]
    ds_read_b64_tr_b16 v[240:241], v68 offset:29120
    v_mfma_f32_16x16x32_bf16 v[164:167], v[244:247], v[176:179], v[164:167]
    ds_read_b64_tr_b16 v[242:243], v68 offset:29632
    v_mfma_f32_16x16x32_bf16 v[168:171], v[248:251], v[36:39], v[168:171]
    ds_read_b64_tr_b16 v[244:245], v68 offset:29152
    v_mfma_f32_16x16x32_bf16 v[172:175], v[248:251], v[176:179], v[172:175]
    ds_read_b64_tr_b16 v[246:247], v68 offset:29664
    s_waitcnt lgkmcnt(8)
    s_waitcnt vmcnt(9)
    v_mfma_f32_16x16x32_bf16 v[128:131], v[224:227], v[180:183], v[128:131]
    ds_read_b64_tr_b16 v[248:249], v69 offset:29120
    v_mfma_f32_16x16x32_bf16 v[132:135], v[224:227], v[184:187], v[132:135]
    ds_read_b64_tr_b16 v[250:251], v69 offset:29632
    buffer_load_dwordx4 v[36:39], v2, s[32:35], s16 offen offset:1024 sc1
    v_mfma_f32_16x16x32_bf16 v[136:139], v[228:231], v[180:183], v[136:139]
    ds_read_b64_tr_b16 v[224:225], v69 offset:29152
    v_mfma_f32_16x16x32_bf16 v[140:143], v[228:231], v[184:187], v[140:143]
    ds_read_b64_tr_b16 v[226:227], v69 offset:29664
    s_waitcnt lgkmcnt(8)
    v_mfma_f32_16x16x32_bf16 v[112:115], v[232:235], v[180:183], v[112:115]
    ds_read_b64_tr_b16 v[228:229], v68 offset:45760
    v_mfma_f32_16x16x32_bf16 v[116:119], v[232:235], v[184:187], v[116:119]
    ds_read_b64_tr_b16 v[230:231], v68 offset:46272
    v_mfma_f32_16x16x32_bf16 v[120:123], v[236:239], v[180:183], v[120:123]
    ds_read_b64_tr_b16 v[232:233], v68 offset:45792
    v_mfma_f32_16x16x32_bf16 v[124:127], v[236:239], v[184:187], v[124:127]
    ds_read_b64_tr_b16 v[234:235], v68 offset:46304
    buffer_load_dwordx4 v[176:179], v2, s[32:35], s16 offen offset:2048 sc1
    s_waitcnt lgkmcnt(8)
    v_mfma_f32_16x16x32_bf16 v[80:83], v[240:243], v[180:183], v[80:83]
    ds_read_b64_tr_b16 v[236:237], v69 offset:45760
    v_mfma_f32_16x16x32_bf16 v[84:87], v[240:243], v[184:187], v[84:87]
    ds_read_b64_tr_b16 v[238:239], v69 offset:46272
    v_mfma_f32_16x16x32_bf16 v[88:91], v[244:247], v[180:183], v[88:91]
    ds_read_b64_tr_b16 v[240:241], v69 offset:45792
    v_mfma_f32_16x16x32_bf16 v[92:95], v[244:247], v[184:187], v[92:95]
    ds_read_b64_tr_b16 v[242:243], v69 offset:46304
    s_waitcnt lgkmcnt(8)
    v_mfma_f32_16x16x32_bf16 v[96:99], v[248:251], v[180:183], v[96:99]
    s_barrier
    ds_read_b64_tr_b16 v[244:245], v71 offset:8320
    v_mfma_f32_16x16x32_bf16 v[100:103], v[248:251], v[184:187], v[100:103]
    ds_read_b64_tr_b16 v[246:247], v71 offset:8832
    v_mfma_f32_16x16x32_bf16 v[104:107], v[224:227], v[180:183], v[104:107]
    ds_read_b64_tr_b16 v[248:249], v71 offset:8352
    v_mfma_f32_16x16x32_bf16 v[108:111], v[224:227], v[184:187], v[108:111]
    ds_read_b64_tr_b16 v[250:251], v71 offset:8864
    s_waitcnt lgkmcnt(8)
    v_mfma_f32_16x16x32_bf16 v[144:147], v[228:231], v[180:183], v[144:147]
    ds_read_b64_tr_b16 v[224:225], v70 offset:8320
    v_mfma_f32_16x16x32_bf16 v[148:151], v[228:231], v[184:187], v[148:151]
    ds_read_b64_tr_b16 v[226:227], v70 offset:8832
    v_mfma_f32_16x16x32_bf16 v[152:155], v[232:235], v[180:183], v[152:155]
    ds_read_b64_tr_b16 v[228:229], v70 offset:8352
    v_mfma_f32_16x16x32_bf16 v[156:159], v[232:235], v[184:187], v[156:159]
    ds_read_b64_tr_b16 v[230:231], v70 offset:8864
    s_waitcnt lgkmcnt(8)
    v_mfma_f32_16x16x32_bf16 v[160:163], v[236:239], v[180:183], v[160:163]
    ds_read_b64_tr_b16 v[232:233], v70
    v_mfma_f32_16x16x32_bf16 v[164:167], v[236:239], v[184:187], v[164:167]
    ds_read_b64_tr_b16 v[234:235], v70 offset:512
    v_mfma_f32_16x16x32_bf16 v[168:171], v[240:243], v[180:183], v[168:171]
    ds_read_b64_tr_b16 v[236:237], v70 offset:32
    v_mfma_f32_16x16x32_bf16 v[172:175], v[240:243], v[184:187], v[172:175]
    ds_read_b64_tr_b16 v[238:239], v70 offset:544
    s_waitcnt lgkmcnt(8)
    s_waitcnt vmcnt(9)
    v_mfma_f32_16x16x32_bf16 v[128:131], v[244:247], v[188:191], v[128:131]
    ds_read_b64_tr_b16 v[240:241], v71
    v_mfma_f32_16x16x32_bf16 v[132:135], v[244:247], v[192:195], v[132:135]
    ds_read_b64_tr_b16 v[242:243], v71 offset:512
    buffer_load_dwordx4 v[180:183], v2, s[32:35], s16 offen offset:3072 sc1
    v_mfma_f32_16x16x32_bf16 v[136:139], v[248:251], v[188:191], v[136:139]
    ds_read_b64_tr_b16 v[244:245], v71 offset:32
    v_mfma_f32_16x16x32_bf16 v[140:143], v[248:251], v[192:195], v[140:143]
    ds_read_b64_tr_b16 v[246:247], v71 offset:544
    s_waitcnt lgkmcnt(8)
    v_mfma_f32_16x16x32_bf16 v[112:115], v[224:227], v[188:191], v[112:115]
    ds_read_b64_tr_b16 v[248:249], v70 offset:16640
    v_mfma_f32_16x16x32_bf16 v[116:119], v[224:227], v[192:195], v[116:119]
    ds_read_b64_tr_b16 v[250:251], v70 offset:17152
    v_mfma_f32_16x16x32_bf16 v[120:123], v[228:231], v[188:191], v[120:123]
    ds_read_b64_tr_b16 v[224:225], v70 offset:16672
    v_mfma_f32_16x16x32_bf16 v[124:127], v[228:231], v[192:195], v[124:127]
    ds_read_b64_tr_b16 v[226:227], v70 offset:17184
    s_add_u32 s96, s85, 7
    s_and_b32 s97, s96, 15
    s_lshl_b32 s98, s97, 14
    s_add_u32 s16, s98, s15
    buffer_load_dwordx4 v[184:187], v2, s[32:35], s16 offen sc1
    s_waitcnt lgkmcnt(8)
    v_mfma_f32_16x16x32_bf16 v[80:83], v[232:235], v[188:191], v[80:83]
    ds_read_b64_tr_b16 v[228:229], v71 offset:16640
    v_mfma_f32_16x16x32_bf16 v[84:87], v[232:235], v[192:195], v[84:87]
    ds_read_b64_tr_b16 v[230:231], v71 offset:17152
    v_mfma_f32_16x16x32_bf16 v[88:91], v[236:239], v[188:191], v[88:91]
    ds_read_b64_tr_b16 v[232:233], v71 offset:16672
    v_mfma_f32_16x16x32_bf16 v[92:95], v[236:239], v[192:195], v[92:95]
    ds_read_b64_tr_b16 v[234:235], v71 offset:17184
    s_waitcnt lgkmcnt(8)
    v_mfma_f32_16x16x32_bf16 v[96:99], v[240:243], v[188:191], v[96:99]
    ds_read_b64_tr_b16 v[236:237], v71 offset:12480
    v_mfma_f32_16x16x32_bf16 v[100:103], v[240:243], v[192:195], v[100:103]
    ds_read_b64_tr_b16 v[238:239], v71 offset:12992
    v_mfma_f32_16x16x32_bf16 v[104:107], v[244:247], v[188:191], v[104:107]
    ds_read_b64_tr_b16 v[240:241], v71 offset:12512
    v_mfma_f32_16x16x32_bf16 v[108:111], v[244:247], v[192:195], v[108:111]
    ds_read_b64_tr_b16 v[242:243], v71 offset:13024
    s_waitcnt lgkmcnt(8)
    v_mfma_f32_16x16x32_bf16 v[144:147], v[248:251], v[188:191], v[144:147]
    ds_read_b64_tr_b16 v[244:245], v70 offset:12480
    v_mfma_f32_16x16x32_bf16 v[148:151], v[248:251], v[192:195], v[148:151]
    ds_read_b64_tr_b16 v[246:247], v70 offset:12992
    v_mfma_f32_16x16x32_bf16 v[152:155], v[224:227], v[188:191], v[152:155]
    ds_read_b64_tr_b16 v[248:249], v70 offset:12512
    v_mfma_f32_16x16x32_bf16 v[156:159], v[224:227], v[192:195], v[156:159]
    ds_read_b64_tr_b16 v[250:251], v70 offset:13024
    s_waitcnt lgkmcnt(8)
    v_mfma_f32_16x16x32_bf16 v[160:163], v[228:231], v[188:191], v[160:163]
    ds_read_b64_tr_b16 v[224:225], v70 offset:4160
    v_mfma_f32_16x16x32_bf16 v[164:167], v[228:231], v[192:195], v[164:167]
    ds_read_b64_tr_b16 v[226:227], v70 offset:4672
    v_mfma_f32_16x16x32_bf16 v[168:171], v[232:235], v[188:191], v[168:171]
    ds_read_b64_tr_b16 v[228:229], v70 offset:4192
    v_mfma_f32_16x16x32_bf16 v[172:175], v[232:235], v[192:195], v[172:175]
    ds_read_b64_tr_b16 v[230:231], v70 offset:4704
    s_waitcnt lgkmcnt(8)
    s_waitcnt vmcnt(9)
    v_mfma_f32_16x16x32_bf16 v[128:131], v[236:239], v[196:199], v[128:131]
    ds_read_b64_tr_b16 v[232:233], v71 offset:4160
    v_mfma_f32_16x16x32_bf16 v[132:135], v[236:239], v[200:203], v[132:135]
    ds_read_b64_tr_b16 v[234:235], v71 offset:4672
    buffer_load_dwordx4 v[188:191], v2, s[32:35], s16 offen offset:1024 sc1
    v_mfma_f32_16x16x32_bf16 v[136:139], v[240:243], v[196:199], v[136:139]
    ds_read_b64_tr_b16 v[236:237], v71 offset:4192
    v_mfma_f32_16x16x32_bf16 v[140:143], v[240:243], v[200:203], v[140:143]
    ds_read_b64_tr_b16 v[238:239], v71 offset:4704
    s_waitcnt lgkmcnt(8)
    v_mfma_f32_16x16x32_bf16 v[112:115], v[244:247], v[196:199], v[112:115]
    ds_read_b64_tr_b16 v[240:241], v70 offset:20800
    v_mfma_f32_16x16x32_bf16 v[116:119], v[244:247], v[200:203], v[116:119]
    ds_read_b64_tr_b16 v[242:243], v70 offset:21312
    v_mfma_f32_16x16x32_bf16 v[120:123], v[248:251], v[196:199], v[120:123]
    ds_read_b64_tr_b16 v[244:245], v70 offset:20832
    v_mfma_f32_16x16x32_bf16 v[124:127], v[248:251], v[200:203], v[124:127]
    ds_read_b64_tr_b16 v[246:247], v70 offset:21344
    buffer_load_dwordx4 v[192:195], v2, s[32:35], s16 offen offset:2048 sc1
    s_waitcnt lgkmcnt(8)
    v_mfma_f32_16x16x32_bf16 v[80:83], v[224:227], v[196:199], v[80:83]
    ds_read_b64_tr_b16 v[248:249], v71 offset:20800
    v_mfma_f32_16x16x32_bf16 v[84:87], v[224:227], v[200:203], v[84:87]
    ds_read_b64_tr_b16 v[250:251], v71 offset:21312
    v_mfma_f32_16x16x32_bf16 v[88:91], v[228:231], v[196:199], v[88:91]
    ds_read_b64_tr_b16 v[224:225], v71 offset:20832
    v_mfma_f32_16x16x32_bf16 v[92:95], v[228:231], v[200:203], v[92:95]
    ds_read_b64_tr_b16 v[226:227], v71 offset:21344
    s_waitcnt lgkmcnt(8)
    v_mfma_f32_16x16x32_bf16 v[96:99], v[232:235], v[196:199], v[96:99]
    s_barrier
    ds_read_b64_tr_b16 v[228:229], v71 offset:33280
    v_mfma_f32_16x16x32_bf16 v[100:103], v[232:235], v[200:203], v[100:103]
    ds_read_b64_tr_b16 v[230:231], v71 offset:33792
    v_mfma_f32_16x16x32_bf16 v[104:107], v[236:239], v[196:199], v[104:107]
    ds_read_b64_tr_b16 v[232:233], v71 offset:33312
    v_mfma_f32_16x16x32_bf16 v[108:111], v[236:239], v[200:203], v[108:111]
    ds_read_b64_tr_b16 v[234:235], v71 offset:33824
    s_waitcnt lgkmcnt(8)
    v_mfma_f32_16x16x32_bf16 v[144:147], v[240:243], v[196:199], v[144:147]
    ds_read_b64_tr_b16 v[236:237], v70 offset:33280
    v_mfma_f32_16x16x32_bf16 v[148:151], v[240:243], v[200:203], v[148:151]
    ds_read_b64_tr_b16 v[238:239], v70 offset:33792
    v_mfma_f32_16x16x32_bf16 v[152:155], v[244:247], v[196:199], v[152:155]
    ds_read_b64_tr_b16 v[240:241], v70 offset:33312
    v_mfma_f32_16x16x32_bf16 v[156:159], v[244:247], v[200:203], v[156:159]
    ds_read_b64_tr_b16 v[242:243], v70 offset:33824
    s_waitcnt lgkmcnt(8)
    v_mfma_f32_16x16x32_bf16 v[160:163], v[248:251], v[196:199], v[160:163]
    ds_read_b64_tr_b16 v[244:245], v70 offset:24960
    v_mfma_f32_16x16x32_bf16 v[164:167], v[248:251], v[200:203], v[164:167]
    ds_read_b64_tr_b16 v[246:247], v70 offset:25472
    v_mfma_f32_16x16x32_bf16 v[168:171], v[224:227], v[196:199], v[168:171]
    ds_read_b64_tr_b16 v[248:249], v70 offset:24992
    v_mfma_f32_16x16x32_bf16 v[172:175], v[224:227], v[200:203], v[172:175]
    ds_read_b64_tr_b16 v[250:251], v70 offset:25504
    s_waitcnt lgkmcnt(8)
    s_waitcnt vmcnt(9)
    v_mfma_f32_16x16x32_bf16 v[128:131], v[228:231], v[204:207], v[128:131]
    ds_read_b64_tr_b16 v[224:225], v71 offset:24960
    v_mfma_f32_16x16x32_bf16 v[132:135], v[228:231], v[208:211], v[132:135]
    ds_read_b64_tr_b16 v[226:227], v71 offset:25472
    buffer_load_dwordx4 v[196:199], v2, s[32:35], s16 offen offset:3072 sc1
    v_mfma_f32_16x16x32_bf16 v[136:139], v[232:235], v[204:207], v[136:139]
    ds_read_b64_tr_b16 v[228:229], v71 offset:24992
    v_mfma_f32_16x16x32_bf16 v[140:143], v[232:235], v[208:211], v[140:143]
    ds_read_b64_tr_b16 v[230:231], v71 offset:25504
    s_waitcnt lgkmcnt(8)
    v_mfma_f32_16x16x32_bf16 v[112:115], v[236:239], v[204:207], v[112:115]
    ds_read_b64_tr_b16 v[232:233], v70 offset:41600
    v_mfma_f32_16x16x32_bf16 v[116:119], v[236:239], v[208:211], v[116:119]
    ds_read_b64_tr_b16 v[234:235], v70 offset:42112
    v_mfma_f32_16x16x32_bf16 v[120:123], v[240:243], v[204:207], v[120:123]
    ds_read_b64_tr_b16 v[236:237], v70 offset:41632
    v_mfma_f32_16x16x32_bf16 v[124:127], v[240:243], v[208:211], v[124:127]
    ds_read_b64_tr_b16 v[238:239], v70 offset:42144
    s_add_u32 s96, s85, 8
    s_and_b32 s97, s96, 15
    s_lshl_b32 s98, s97, 14
    s_add_u32 s16, s98, s15
    buffer_load_dwordx4 v[200:203], v2, s[32:35], s16 offen sc1
    s_waitcnt lgkmcnt(8)
    v_mfma_f32_16x16x32_bf16 v[80:83], v[244:247], v[204:207], v[80:83]
    ds_read_b64_tr_b16 v[240:241], v71 offset:41600
    v_mfma_f32_16x16x32_bf16 v[84:87], v[244:247], v[208:211], v[84:87]
    ds_read_b64_tr_b16 v[242:243], v71 offset:42112
    v_mfma_f32_16x16x32_bf16 v[88:91], v[248:251], v[204:207], v[88:91]
    ds_read_b64_tr_b16 v[244:245], v71 offset:41632
    v_mfma_f32_16x16x32_bf16 v[92:95], v[248:251], v[208:211], v[92:95]
    ds_read_b64_tr_b16 v[246:247], v71 offset:42144
    s_waitcnt lgkmcnt(8)
    v_mfma_f32_16x16x32_bf16 v[96:99], v[224:227], v[204:207], v[96:99]
    ds_read_b64_tr_b16 v[248:249], v71 offset:37440
    v_mfma_f32_16x16x32_bf16 v[100:103], v[224:227], v[208:211], v[100:103]
    ds_read_b64_tr_b16 v[250:251], v71 offset:37952
    v_mfma_f32_16x16x32_bf16 v[104:107], v[228:231], v[204:207], v[104:107]
    ds_read_b64_tr_b16 v[224:225], v71 offset:37472
    v_mfma_f32_16x16x32_bf16 v[108:111], v[228:231], v[208:211], v[108:111]
    ds_read_b64_tr_b16 v[226:227], v71 offset:37984
    s_waitcnt lgkmcnt(8)
    v_mfma_f32_16x16x32_bf16 v[144:147], v[232:235], v[204:207], v[144:147]
    ds_read_b64_tr_b16 v[228:229], v70 offset:37440
    v_mfma_f32_16x16x32_bf16 v[148:151], v[232:235], v[208:211], v[148:151]
    ds_read_b64_tr_b16 v[230:231], v70 offset:37952
    v_mfma_f32_16x16x32_bf16 v[152:155], v[236:239], v[204:207], v[152:155]
    ds_read_b64_tr_b16 v[232:233], v70 offset:37472
    v_mfma_f32_16x16x32_bf16 v[156:159], v[236:239], v[208:211], v[156:159]
    ds_read_b64_tr_b16 v[234:235], v70 offset:37984
    s_waitcnt lgkmcnt(8)
    v_mfma_f32_16x16x32_bf16 v[160:163], v[240:243], v[204:207], v[160:163]
    ds_read_b64_tr_b16 v[236:237], v70 offset:29120
    v_mfma_f32_16x16x32_bf16 v[164:167], v[240:243], v[208:211], v[164:167]
    ds_read_b64_tr_b16 v[238:239], v70 offset:29632
    v_mfma_f32_16x16x32_bf16 v[168:171], v[244:247], v[204:207], v[168:171]
    ds_read_b64_tr_b16 v[240:241], v70 offset:29152
    v_mfma_f32_16x16x32_bf16 v[172:175], v[244:247], v[208:211], v[172:175]
    ds_read_b64_tr_b16 v[242:243], v70 offset:29664
    s_waitcnt lgkmcnt(8)
    s_waitcnt vmcnt(9)
    v_mfma_f32_16x16x32_bf16 v[128:131], v[248:251], v[212:215], v[128:131]
    ds_read_b64_tr_b16 v[244:245], v71 offset:29120
    v_mfma_f32_16x16x32_bf16 v[132:135], v[248:251], v[216:219], v[132:135]
    ds_read_b64_tr_b16 v[246:247], v71 offset:29632
    buffer_load_dwordx4 v[204:207], v2, s[32:35], s16 offen offset:1024 sc1
    v_mfma_f32_16x16x32_bf16 v[136:139], v[224:227], v[212:215], v[136:139]
    ds_read_b64_tr_b16 v[248:249], v71 offset:29152
    v_mfma_f32_16x16x32_bf16 v[140:143], v[224:227], v[216:219], v[140:143]
    ds_read_b64_tr_b16 v[250:251], v71 offset:29664
    s_waitcnt lgkmcnt(8)
    v_mfma_f32_16x16x32_bf16 v[112:115], v[228:231], v[212:215], v[112:115]
    ds_read_b64_tr_b16 v[224:225], v70 offset:45760
    v_mfma_f32_16x16x32_bf16 v[116:119], v[228:231], v[216:219], v[116:119]
    ds_read_b64_tr_b16 v[226:227], v70 offset:46272
    v_mfma_f32_16x16x32_bf16 v[120:123], v[232:235], v[212:215], v[120:123]
    ds_read_b64_tr_b16 v[228:229], v70 offset:45792
    v_mfma_f32_16x16x32_bf16 v[124:127], v[232:235], v[216:219], v[124:127]
    ds_read_b64_tr_b16 v[230:231], v70 offset:46304
    buffer_load_dwordx4 v[208:211], v2, s[32:35], s16 offen offset:2048 sc1
    s_waitcnt lgkmcnt(8)
    v_mfma_f32_16x16x32_bf16 v[80:83], v[236:239], v[212:215], v[80:83]
    ds_read_b64_tr_b16 v[232:233], v71 offset:45760
    v_mfma_f32_16x16x32_bf16 v[84:87], v[236:239], v[216:219], v[84:87]
    ds_read_b64_tr_b16 v[234:235], v71 offset:46272
    v_mfma_f32_16x16x32_bf16 v[88:91], v[240:243], v[212:215], v[88:91]
    ds_read_b64_tr_b16 v[236:237], v71 offset:45792
    v_mfma_f32_16x16x32_bf16 v[92:95], v[240:243], v[216:219], v[92:95]
    ds_read_b64_tr_b16 v[238:239], v71 offset:46304
    s_waitcnt lgkmcnt(8)
    v_mfma_f32_16x16x32_bf16 v[96:99], v[244:247], v[212:215], v[96:99]
    s_barrier
    ds_read_b64_tr_b16 v[240:241], v67 offset:8320
    v_mfma_f32_16x16x32_bf16 v[100:103], v[244:247], v[216:219], v[100:103]
    ds_read_b64_tr_b16 v[242:243], v67 offset:8832
    v_mfma_f32_16x16x32_bf16 v[104:107], v[248:251], v[212:215], v[104:107]
    ds_read_b64_tr_b16 v[244:245], v67 offset:8352
    v_mfma_f32_16x16x32_bf16 v[108:111], v[248:251], v[216:219], v[108:111]
    ds_read_b64_tr_b16 v[246:247], v67 offset:8864
    s_waitcnt lgkmcnt(8)
    v_mfma_f32_16x16x32_bf16 v[144:147], v[224:227], v[212:215], v[144:147]
    ds_read_b64_tr_b16 v[248:249], v66 offset:8320
    v_mfma_f32_16x16x32_bf16 v[148:151], v[224:227], v[216:219], v[148:151]
    ds_read_b64_tr_b16 v[250:251], v66 offset:8832
    v_mfma_f32_16x16x32_bf16 v[152:155], v[228:231], v[212:215], v[152:155]
    ds_read_b64_tr_b16 v[224:225], v66 offset:8352
    v_mfma_f32_16x16x32_bf16 v[156:159], v[228:231], v[216:219], v[156:159]
    ds_read_b64_tr_b16 v[226:227], v66 offset:8864
    s_waitcnt lgkmcnt(8)
    v_mfma_f32_16x16x32_bf16 v[160:163], v[232:235], v[212:215], v[160:163]
    ds_read_b64_tr_b16 v[228:229], v66
    v_mfma_f32_16x16x32_bf16 v[164:167], v[232:235], v[216:219], v[164:167]
    ds_read_b64_tr_b16 v[230:231], v66 offset:512
    v_mfma_f32_16x16x32_bf16 v[168:171], v[236:239], v[212:215], v[168:171]
    ds_read_b64_tr_b16 v[232:233], v66 offset:32
    v_mfma_f32_16x16x32_bf16 v[172:175], v[236:239], v[216:219], v[172:175]
    ds_read_b64_tr_b16 v[234:235], v66 offset:544
    s_waitcnt lgkmcnt(8)
    s_waitcnt vmcnt(9)
    v_mfma_f32_16x16x32_bf16 v[128:131], v[240:243], v[220:223], v[128:131]
    ds_read_b64_tr_b16 v[236:237], v67
    v_mfma_f32_16x16x32_bf16 v[132:135], v[240:243], v[36:39], v[132:135]
    ds_read_b64_tr_b16 v[238:239], v67 offset:512
    buffer_load_dwordx4 v[212:215], v2, s[32:35], s16 offen offset:3072 sc1
    v_mfma_f32_16x16x32_bf16 v[136:139], v[244:247], v[220:223], v[136:139]
    ds_read_b64_tr_b16 v[240:241], v67 offset:32
    v_mfma_f32_16x16x32_bf16 v[140:143], v[244:247], v[36:39], v[140:143]
    ds_read_b64_tr_b16 v[242:243], v67 offset:544
    s_waitcnt lgkmcnt(8)
    v_mfma_f32_16x16x32_bf16 v[112:115], v[248:251], v[220:223], v[112:115]
    ds_read_b64_tr_b16 v[244:245], v66 offset:16640
    v_mfma_f32_16x16x32_bf16 v[116:119], v[248:251], v[36:39], v[116:119]
    ds_read_b64_tr_b16 v[246:247], v66 offset:17152
    v_mfma_f32_16x16x32_bf16 v[120:123], v[224:227], v[220:223], v[120:123]
    ds_read_b64_tr_b16 v[248:249], v66 offset:16672
    v_mfma_f32_16x16x32_bf16 v[124:127], v[224:227], v[36:39], v[124:127]
    ds_read_b64_tr_b16 v[250:251], v66 offset:17184
    s_add_u32 s96, s85, 9
    s_and_b32 s97, s96, 15
    s_lshl_b32 s98, s97, 14
    s_add_u32 s16, s98, s15
    buffer_load_dwordx4 v[216:219], v2, s[32:35], s16 offen sc1
    s_waitcnt lgkmcnt(8)
    v_mfma_f32_16x16x32_bf16 v[80:83], v[228:231], v[220:223], v[80:83]
    ds_read_b64_tr_b16 v[224:225], v67 offset:16640
    v_mfma_f32_16x16x32_bf16 v[84:87], v[228:231], v[36:39], v[84:87]
    ds_read_b64_tr_b16 v[226:227], v67 offset:17152
    v_mfma_f32_16x16x32_bf16 v[88:91], v[232:235], v[220:223], v[88:91]
    ds_read_b64_tr_b16 v[228:229], v67 offset:16672
    v_mfma_f32_16x16x32_bf16 v[92:95], v[232:235], v[36:39], v[92:95]
    ds_read_b64_tr_b16 v[230:231], v67 offset:17184
    s_waitcnt lgkmcnt(8)
    v_mfma_f32_16x16x32_bf16 v[96:99], v[236:239], v[220:223], v[96:99]
    ds_read_b64_tr_b16 v[232:233], v67 offset:12480
    v_mfma_f32_16x16x32_bf16 v[100:103], v[236:239], v[36:39], v[100:103]
    ds_read_b64_tr_b16 v[234:235], v67 offset:12992
    v_mfma_f32_16x16x32_bf16 v[104:107], v[240:243], v[220:223], v[104:107]
    ds_read_b64_tr_b16 v[236:237], v67 offset:12512
    v_mfma_f32_16x16x32_bf16 v[108:111], v[240:243], v[36:39], v[108:111]
    ds_read_b64_tr_b16 v[238:239], v67 offset:13024
    s_waitcnt lgkmcnt(8)
    v_mfma_f32_16x16x32_bf16 v[144:147], v[244:247], v[220:223], v[144:147]
    ds_read_b64_tr_b16 v[240:241], v66 offset:12480
    v_mfma_f32_16x16x32_bf16 v[148:151], v[244:247], v[36:39], v[148:151]
    ds_read_b64_tr_b16 v[242:243], v66 offset:12992
    v_mfma_f32_16x16x32_bf16 v[152:155], v[248:251], v[220:223], v[152:155]
    ds_read_b64_tr_b16 v[244:245], v66 offset:12512
    v_mfma_f32_16x16x32_bf16 v[156:159], v[248:251], v[36:39], v[156:159]
    ds_read_b64_tr_b16 v[246:247], v66 offset:13024
    s_waitcnt lgkmcnt(8)
    v_mfma_f32_16x16x32_bf16 v[160:163], v[224:227], v[220:223], v[160:163]
    ds_read_b64_tr_b16 v[248:249], v66 offset:4160
    v_mfma_f32_16x16x32_bf16 v[164:167], v[224:227], v[36:39], v[164:167]
    ds_read_b64_tr_b16 v[250:251], v66 offset:4672
    v_mfma_f32_16x16x32_bf16 v[168:171], v[228:231], v[220:223], v[168:171]
    ds_read_b64_tr_b16 v[224:225], v66 offset:4192
    v_mfma_f32_16x16x32_bf16 v[172:175], v[228:231], v[36:39], v[172:175]
    ds_read_b64_tr_b16 v[226:227], v66 offset:4704
    s_waitcnt lgkmcnt(8)
    s_waitcnt vmcnt(9)
    v_mfma_f32_16x16x32_bf16 v[128:131], v[232:235], v[176:179], v[128:131]
    ds_read_b64_tr_b16 v[228:229], v67 offset:4160
    v_mfma_f32_16x16x32_bf16 v[132:135], v[232:235], v[180:183], v[132:135]
    ds_read_b64_tr_b16 v[230:231], v67 offset:4672
    buffer_load_dwordx4 v[220:223], v2, s[32:35], s16 offen offset:1024 sc1
    v_mfma_f32_16x16x32_bf16 v[136:139], v[236:239], v[176:179], v[136:139]
    ds_read_b64_tr_b16 v[232:233], v67 offset:4192
    v_mfma_f32_16x16x32_bf16 v[140:143], v[236:239], v[180:183], v[140:143]
    ds_read_b64_tr_b16 v[234:235], v67 offset:4704
    s_waitcnt lgkmcnt(8)
    v_mfma_f32_16x16x32_bf16 v[112:115], v[240:243], v[176:179], v[112:115]
    ds_read_b64_tr_b16 v[236:237], v66 offset:20800
    v_mfma_f32_16x16x32_bf16 v[116:119], v[240:243], v[180:183], v[116:119]
    ds_read_b64_tr_b16 v[238:239], v66 offset:21312
    v_mfma_f32_16x16x32_bf16 v[120:123], v[244:247], v[176:179], v[120:123]
    ds_read_b64_tr_b16 v[240:241], v66 offset:20832
    v_mfma_f32_16x16x32_bf16 v[124:127], v[244:247], v[180:183], v[124:127]
    ds_read_b64_tr_b16 v[242:243], v66 offset:21344
    buffer_load_dwordx4 v[36:39], v2, s[32:35], s16 offen offset:2048 sc1
    s_waitcnt lgkmcnt(8)
    v_mfma_f32_16x16x32_bf16 v[80:83], v[248:251], v[176:179], v[80:83]
    ds_read_b64_tr_b16 v[244:245], v67 offset:20800
    v_mfma_f32_16x16x32_bf16 v[84:87], v[248:251], v[180:183], v[84:87]
    ds_read_b64_tr_b16 v[246:247], v67 offset:21312
    v_mfma_f32_16x16x32_bf16 v[88:91], v[224:227], v[176:179], v[88:91]
    ds_read_b64_tr_b16 v[248:249], v67 offset:20832
    v_mfma_f32_16x16x32_bf16 v[92:95], v[224:227], v[180:183], v[92:95]
    ds_read_b64_tr_b16 v[250:251], v67 offset:21344
    s_waitcnt lgkmcnt(8)
    v_mfma_f32_16x16x32_bf16 v[96:99], v[228:231], v[176:179], v[96:99]
    s_barrier
    ds_read_b64_tr_b16 v[224:225], v67 offset:33280
    v_mfma_f32_16x16x32_bf16 v[100:103], v[228:231], v[180:183], v[100:103]
    ds_read_b64_tr_b16 v[226:227], v67 offset:33792
    v_mfma_f32_16x16x32_bf16 v[104:107], v[232:235], v[176:179], v[104:107]
    ds_read_b64_tr_b16 v[228:229], v67 offset:33312
    v_mfma_f32_16x16x32_bf16 v[108:111], v[232:235], v[180:183], v[108:111]
    ds_read_b64_tr_b16 v[230:231], v67 offset:33824
    s_waitcnt lgkmcnt(8)
    v_mfma_f32_16x16x32_bf16 v[144:147], v[236:239], v[176:179], v[144:147]
    ds_read_b64_tr_b16 v[232:233], v66 offset:33280
    v_mfma_f32_16x16x32_bf16 v[148:151], v[236:239], v[180:183], v[148:151]
    ds_read_b64_tr_b16 v[234:235], v66 offset:33792
    v_mfma_f32_16x16x32_bf16 v[152:155], v[240:243], v[176:179], v[152:155]
    ds_read_b64_tr_b16 v[236:237], v66 offset:33312
    v_mfma_f32_16x16x32_bf16 v[156:159], v[240:243], v[180:183], v[156:159]
    ds_read_b64_tr_b16 v[238:239], v66 offset:33824
    s_waitcnt lgkmcnt(8)
    v_mfma_f32_16x16x32_bf16 v[160:163], v[244:247], v[176:179], v[160:163]
    ds_read_b64_tr_b16 v[240:241], v66 offset:24960
    v_mfma_f32_16x16x32_bf16 v[164:167], v[244:247], v[180:183], v[164:167]
    ds_read_b64_tr_b16 v[242:243], v66 offset:25472
    v_mfma_f32_16x16x32_bf16 v[168:171], v[248:251], v[176:179], v[168:171]
    ds_read_b64_tr_b16 v[244:245], v66 offset:24992
    v_mfma_f32_16x16x32_bf16 v[172:175], v[248:251], v[180:183], v[172:175]
    ds_read_b64_tr_b16 v[246:247], v66 offset:25504
    s_waitcnt lgkmcnt(8)
    s_waitcnt vmcnt(9)
    v_mfma_f32_16x16x32_bf16 v[128:131], v[224:227], v[184:187], v[128:131]
    ds_read_b64_tr_b16 v[248:249], v67 offset:24960
    v_mfma_f32_16x16x32_bf16 v[132:135], v[224:227], v[188:191], v[132:135]
    ds_read_b64_tr_b16 v[250:251], v67 offset:25472
    buffer_load_dwordx4 v[176:179], v2, s[32:35], s16 offen offset:3072 sc1
    v_mfma_f32_16x16x32_bf16 v[136:139], v[228:231], v[184:187], v[136:139]
    ds_read_b64_tr_b16 v[224:225], v67 offset:24992
    v_mfma_f32_16x16x32_bf16 v[140:143], v[228:231], v[188:191], v[140:143]
    ds_read_b64_tr_b16 v[226:227], v67 offset:25504
    s_waitcnt lgkmcnt(8)
    v_mfma_f32_16x16x32_bf16 v[112:115], v[232:235], v[184:187], v[112:115]
    ds_read_b64_tr_b16 v[228:229], v66 offset:41600
    v_mfma_f32_16x16x32_bf16 v[116:119], v[232:235], v[188:191], v[116:119]
    ds_read_b64_tr_b16 v[230:231], v66 offset:42112
    v_mfma_f32_16x16x32_bf16 v[120:123], v[236:239], v[184:187], v[120:123]
    ds_read_b64_tr_b16 v[232:233], v66 offset:41632
    v_mfma_f32_16x16x32_bf16 v[124:127], v[236:239], v[188:191], v[124:127]
    ds_read_b64_tr_b16 v[234:235], v66 offset:42144
    s_add_u32 s96, s85, 10
    s_and_b32 s97, s96, 15
    s_lshl_b32 s98, s97, 14
    s_add_u32 s16, s98, s15
    buffer_load_dwordx4 v[180:183], v2, s[32:35], s16 offen sc1
    s_waitcnt lgkmcnt(8)
    v_mfma_f32_16x16x32_bf16 v[80:83], v[240:243], v[184:187], v[80:83]
    ds_read_b64_tr_b16 v[236:237], v67 offset:41600
    v_mfma_f32_16x16x32_bf16 v[84:87], v[240:243], v[188:191], v[84:87]
    ds_read_b64_tr_b16 v[238:239], v67 offset:42112
    v_mfma_f32_16x16x32_bf16 v[88:91], v[244:247], v[184:187], v[88:91]
    ds_read_b64_tr_b16 v[240:241], v67 offset:41632
    v_mfma_f32_16x16x32_bf16 v[92:95], v[244:247], v[188:191], v[92:95]
    ds_read_b64_tr_b16 v[242:243], v67 offset:42144
    s_waitcnt lgkmcnt(8)
    v_mfma_f32_16x16x32_bf16 v[96:99], v[248:251], v[184:187], v[96:99]
    ds_read_b64_tr_b16 v[244:245], v67 offset:37440
    v_mfma_f32_16x16x32_bf16 v[100:103], v[248:251], v[188:191], v[100:103]
    ds_read_b64_tr_b16 v[246:247], v67 offset:37952
    v_mfma_f32_16x16x32_bf16 v[104:107], v[224:227], v[184:187], v[104:107]
    ds_read_b64_tr_b16 v[248:249], v67 offset:37472
    v_mfma_f32_16x16x32_bf16 v[108:111], v[224:227], v[188:191], v[108:111]
    ds_read_b64_tr_b16 v[250:251], v67 offset:37984
    s_waitcnt lgkmcnt(8)
    v_mfma_f32_16x16x32_bf16 v[144:147], v[228:231], v[184:187], v[144:147]
    ds_read_b64_tr_b16 v[224:225], v66 offset:37440
    v_mfma_f32_16x16x32_bf16 v[148:151], v[228:231], v[188:191], v[148:151]
    ds_read_b64_tr_b16 v[226:227], v66 offset:37952
    v_mfma_f32_16x16x32_bf16 v[152:155], v[232:235], v[184:187], v[152:155]
    ds_read_b64_tr_b16 v[228:229], v66 offset:37472
    v_mfma_f32_16x16x32_bf16 v[156:159], v[232:235], v[188:191], v[156:159]
    ds_read_b64_tr_b16 v[230:231], v66 offset:37984
    s_waitcnt lgkmcnt(8)
    v_mfma_f32_16x16x32_bf16 v[160:163], v[236:239], v[184:187], v[160:163]
    ds_read_b64_tr_b16 v[232:233], v66 offset:29120
    v_mfma_f32_16x16x32_bf16 v[164:167], v[236:239], v[188:191], v[164:167]
    ds_read_b64_tr_b16 v[234:235], v66 offset:29632
    v_mfma_f32_16x16x32_bf16 v[168:171], v[240:243], v[184:187], v[168:171]
    ds_read_b64_tr_b16 v[236:237], v66 offset:29152
    v_mfma_f32_16x16x32_bf16 v[172:175], v[240:243], v[188:191], v[172:175]
    ds_read_b64_tr_b16 v[238:239], v66 offset:29664
    s_waitcnt lgkmcnt(8)
    s_waitcnt vmcnt(9)
    v_mfma_f32_16x16x32_bf16 v[128:131], v[244:247], v[192:195], v[128:131]
    ds_read_b64_tr_b16 v[240:241], v67 offset:29120
    v_mfma_f32_16x16x32_bf16 v[132:135], v[244:247], v[196:199], v[132:135]
    ds_read_b64_tr_b16 v[242:243], v67 offset:29632
    buffer_load_dwordx4 v[184:187], v2, s[32:35], s16 offen offset:1024 sc1
    v_mfma_f32_16x16x32_bf16 v[136:139], v[248:251], v[192:195], v[136:139]
    ds_read_b64_tr_b16 v[244:245], v67 offset:29152
    v_mfma_f32_16x16x32_bf16 v[140:143], v[248:251], v[196:199], v[140:143]
    ds_read_b64_tr_b16 v[246:247], v67 offset:29664
    s_waitcnt lgkmcnt(8)
    v_mfma_f32_16x16x32_bf16 v[112:115], v[224:227], v[192:195], v[112:115]
    ds_read_b64_tr_b16 v[248:249], v66 offset:45760
    v_mfma_f32_16x16x32_bf16 v[116:119], v[224:227], v[196:199], v[116:119]
    ds_read_b64_tr_b16 v[250:251], v66 offset:46272
    v_mfma_f32_16x16x32_bf16 v[120:123], v[228:231], v[192:195], v[120:123]
    ds_read_b64_tr_b16 v[224:225], v66 offset:45792
    v_mfma_f32_16x16x32_bf16 v[124:127], v[228:231], v[196:199], v[124:127]
    ds_read_b64_tr_b16 v[226:227], v66 offset:46304
    buffer_load_dwordx4 v[188:191], v2, s[32:35], s16 offen offset:2048 sc1
    s_waitcnt lgkmcnt(8)
    v_mfma_f32_16x16x32_bf16 v[80:83], v[232:235], v[192:195], v[80:83]
    ds_read_b64_tr_b16 v[228:229], v67 offset:45760
    v_mfma_f32_16x16x32_bf16 v[84:87], v[232:235], v[196:199], v[84:87]
    ds_read_b64_tr_b16 v[230:231], v67 offset:46272
    v_mfma_f32_16x16x32_bf16 v[88:91], v[236:239], v[192:195], v[88:91]
    ds_read_b64_tr_b16 v[232:233], v67 offset:45792
    v_mfma_f32_16x16x32_bf16 v[92:95], v[236:239], v[196:199], v[92:95]
    ds_read_b64_tr_b16 v[234:235], v67 offset:46304
    s_waitcnt lgkmcnt(8)
    v_mfma_f32_16x16x32_bf16 v[96:99], v[240:243], v[192:195], v[96:99]
    s_barrier
    ds_read_b64_tr_b16 v[236:237], v69 offset:8320
    v_mfma_f32_16x16x32_bf16 v[100:103], v[240:243], v[196:199], v[100:103]
    ds_read_b64_tr_b16 v[238:239], v69 offset:8832
    v_mfma_f32_16x16x32_bf16 v[104:107], v[244:247], v[192:195], v[104:107]
    ds_read_b64_tr_b16 v[240:241], v69 offset:8352
    v_mfma_f32_16x16x32_bf16 v[108:111], v[244:247], v[196:199], v[108:111]
    ds_read_b64_tr_b16 v[242:243], v69 offset:8864
    s_waitcnt lgkmcnt(8)
    v_mfma_f32_16x16x32_bf16 v[144:147], v[248:251], v[192:195], v[144:147]
    ds_read_b64_tr_b16 v[244:245], v68 offset:8320
    v_mfma_f32_16x16x32_bf16 v[148:151], v[248:251], v[196:199], v[148:151]
    ds_read_b64_tr_b16 v[246:247], v68 offset:8832
    v_mfma_f32_16x16x32_bf16 v[152:155], v[224:227], v[192:195], v[152:155]
    ds_read_b64_tr_b16 v[248:249], v68 offset:8352
    v_mfma_f32_16x16x32_bf16 v[156:159], v[224:227], v[196:199], v[156:159]
    ds_read_b64_tr_b16 v[250:251], v68 offset:8864
    s_waitcnt lgkmcnt(8)
    v_mfma_f32_16x16x32_bf16 v[160:163], v[228:231], v[192:195], v[160:163]
    ds_read_b64_tr_b16 v[224:225], v68
    v_mfma_f32_16x16x32_bf16 v[164:167], v[228:231], v[196:199], v[164:167]
    ds_read_b64_tr_b16 v[226:227], v68 offset:512
    v_mfma_f32_16x16x32_bf16 v[168:171], v[232:235], v[192:195], v[168:171]
    ds_read_b64_tr_b16 v[228:229], v68 offset:32
    v_mfma_f32_16x16x32_bf16 v[172:175], v[232:235], v[196:199], v[172:175]
    ds_read_b64_tr_b16 v[230:231], v68 offset:544
    s_waitcnt lgkmcnt(8)
    s_waitcnt vmcnt(9)
    v_mfma_f32_16x16x32_bf16 v[128:131], v[236:239], v[200:203], v[128:131]
    ds_read_b64_tr_b16 v[232:233], v69
    v_mfma_f32_16x16x32_bf16 v[132:135], v[236:239], v[204:207], v[132:135]
    ds_read_b64_tr_b16 v[234:235], v69 offset:512
    buffer_load_dwordx4 v[192:195], v2, s[32:35], s16 offen offset:3072 sc1
    v_mfma_f32_16x16x32_bf16 v[136:139], v[240:243], v[200:203], v[136:139]
    ds_read_b64_tr_b16 v[236:237], v69 offset:32
    v_mfma_f32_16x16x32_bf16 v[140:143], v[240:243], v[204:207], v[140:143]
    ds_read_b64_tr_b16 v[238:239], v69 offset:544
    s_waitcnt lgkmcnt(8)
    v_mfma_f32_16x16x32_bf16 v[112:115], v[244:247], v[200:203], v[112:115]
    ds_read_b64_tr_b16 v[240:241], v68 offset:16640
    v_mfma_f32_16x16x32_bf16 v[116:119], v[244:247], v[204:207], v[116:119]
    ds_read_b64_tr_b16 v[242:243], v68 offset:17152
    v_mfma_f32_16x16x32_bf16 v[120:123], v[248:251], v[200:203], v[120:123]
    ds_read_b64_tr_b16 v[244:245], v68 offset:16672
    v_mfma_f32_16x16x32_bf16 v[124:127], v[248:251], v[204:207], v[124:127]
    ds_read_b64_tr_b16 v[246:247], v68 offset:17184
    s_add_u32 s96, s85, 11
    s_and_b32 s97, s96, 15
    s_lshl_b32 s98, s97, 14
    s_add_u32 s16, s98, s15
    buffer_load_dwordx4 v[196:199], v2, s[32:35], s16 offen sc1
    s_waitcnt lgkmcnt(8)
    v_mfma_f32_16x16x32_bf16 v[80:83], v[224:227], v[200:203], v[80:83]
    ds_read_b64_tr_b16 v[248:249], v69 offset:16640
    v_mfma_f32_16x16x32_bf16 v[84:87], v[224:227], v[204:207], v[84:87]
    ds_read_b64_tr_b16 v[250:251], v69 offset:17152
    v_mfma_f32_16x16x32_bf16 v[88:91], v[228:231], v[200:203], v[88:91]
    ds_read_b64_tr_b16 v[224:225], v69 offset:16672
    v_mfma_f32_16x16x32_bf16 v[92:95], v[228:231], v[204:207], v[92:95]
    ds_read_b64_tr_b16 v[226:227], v69 offset:17184
    s_waitcnt lgkmcnt(8)
    v_mfma_f32_16x16x32_bf16 v[96:99], v[232:235], v[200:203], v[96:99]
    ds_read_b64_tr_b16 v[228:229], v69 offset:12480
    v_mfma_f32_16x16x32_bf16 v[100:103], v[232:235], v[204:207], v[100:103]
    ds_read_b64_tr_b16 v[230:231], v69 offset:12992
    v_mfma_f32_16x16x32_bf16 v[104:107], v[236:239], v[200:203], v[104:107]
    ds_read_b64_tr_b16 v[232:233], v69 offset:12512
    v_mfma_f32_16x16x32_bf16 v[108:111], v[236:239], v[204:207], v[108:111]
    ds_read_b64_tr_b16 v[234:235], v69 offset:13024
    s_waitcnt lgkmcnt(8)
    v_mfma_f32_16x16x32_bf16 v[144:147], v[240:243], v[200:203], v[144:147]
    ds_read_b64_tr_b16 v[236:237], v68 offset:12480
    v_mfma_f32_16x16x32_bf16 v[148:151], v[240:243], v[204:207], v[148:151]
    ds_read_b64_tr_b16 v[238:239], v68 offset:12992
    v_mfma_f32_16x16x32_bf16 v[152:155], v[244:247], v[200:203], v[152:155]
    ds_read_b64_tr_b16 v[240:241], v68 offset:12512
    v_mfma_f32_16x16x32_bf16 v[156:159], v[244:247], v[204:207], v[156:159]
    ds_read_b64_tr_b16 v[242:243], v68 offset:13024
    s_waitcnt lgkmcnt(8)
    v_mfma_f32_16x16x32_bf16 v[160:163], v[248:251], v[200:203], v[160:163]
    ds_read_b64_tr_b16 v[244:245], v68 offset:4160
    v_mfma_f32_16x16x32_bf16 v[164:167], v[248:251], v[204:207], v[164:167]
    ds_read_b64_tr_b16 v[246:247], v68 offset:4672
    v_mfma_f32_16x16x32_bf16 v[168:171], v[224:227], v[200:203], v[168:171]
    ds_read_b64_tr_b16 v[248:249], v68 offset:4192
    v_mfma_f32_16x16x32_bf16 v[172:175], v[224:227], v[204:207], v[172:175]
    ds_read_b64_tr_b16 v[250:251], v68 offset:4704
    s_waitcnt lgkmcnt(8)
    s_waitcnt vmcnt(9)
    v_mfma_f32_16x16x32_bf16 v[128:131], v[228:231], v[208:211], v[128:131]
    ds_read_b64_tr_b16 v[224:225], v69 offset:4160
    v_mfma_f32_16x16x32_bf16 v[132:135], v[228:231], v[212:215], v[132:135]
    ds_read_b64_tr_b16 v[226:227], v69 offset:4672
    buffer_load_dwordx4 v[200:203], v2, s[32:35], s16 offen offset:1024 sc1
    v_mfma_f32_16x16x32_bf16 v[136:139], v[232:235], v[208:211], v[136:139]
    ds_read_b64_tr_b16 v[228:229], v69 offset:4192
    v_mfma_f32_16x16x32_bf16 v[140:143], v[232:235], v[212:215], v[140:143]
    ds_read_b64_tr_b16 v[230:231], v69 offset:4704
    s_waitcnt lgkmcnt(8)
    v_mfma_f32_16x16x32_bf16 v[112:115], v[236:239], v[208:211], v[112:115]
    ds_read_b64_tr_b16 v[232:233], v68 offset:20800
    v_mfma_f32_16x16x32_bf16 v[116:119], v[236:239], v[212:215], v[116:119]
    ds_read_b64_tr_b16 v[234:235], v68 offset:21312
    v_mfma_f32_16x16x32_bf16 v[120:123], v[240:243], v[208:211], v[120:123]
    ds_read_b64_tr_b16 v[236:237], v68 offset:20832
    v_mfma_f32_16x16x32_bf16 v[124:127], v[240:243], v[212:215], v[124:127]
    ds_read_b64_tr_b16 v[238:239], v68 offset:21344
    buffer_load_dwordx4 v[204:207], v2, s[32:35], s16 offen offset:2048 sc1
    s_waitcnt lgkmcnt(8)
    v_mfma_f32_16x16x32_bf16 v[80:83], v[244:247], v[208:211], v[80:83]
    ds_read_b64_tr_b16 v[240:241], v69 offset:20800
    v_mfma_f32_16x16x32_bf16 v[84:87], v[244:247], v[212:215], v[84:87]
    ds_read_b64_tr_b16 v[242:243], v69 offset:21312
    v_mfma_f32_16x16x32_bf16 v[88:91], v[248:251], v[208:211], v[88:91]
    ds_read_b64_tr_b16 v[244:245], v69 offset:20832
    v_mfma_f32_16x16x32_bf16 v[92:95], v[248:251], v[212:215], v[92:95]
    ds_read_b64_tr_b16 v[246:247], v69 offset:21344
    s_waitcnt lgkmcnt(8)
    v_mfma_f32_16x16x32_bf16 v[96:99], v[224:227], v[208:211], v[96:99]
    s_barrier
    ds_read_b64_tr_b16 v[248:249], v69 offset:33280
    v_mfma_f32_16x16x32_bf16 v[100:103], v[224:227], v[212:215], v[100:103]
    ds_read_b64_tr_b16 v[250:251], v69 offset:33792
    v_mfma_f32_16x16x32_bf16 v[104:107], v[228:231], v[208:211], v[104:107]
    ds_read_b64_tr_b16 v[224:225], v69 offset:33312
    v_mfma_f32_16x16x32_bf16 v[108:111], v[228:231], v[212:215], v[108:111]
    ds_read_b64_tr_b16 v[226:227], v69 offset:33824
    s_waitcnt lgkmcnt(8)
    v_mfma_f32_16x16x32_bf16 v[144:147], v[232:235], v[208:211], v[144:147]
    ds_read_b64_tr_b16 v[228:229], v68 offset:33280
    v_mfma_f32_16x16x32_bf16 v[148:151], v[232:235], v[212:215], v[148:151]
    ds_read_b64_tr_b16 v[230:231], v68 offset:33792
    v_mfma_f32_16x16x32_bf16 v[152:155], v[236:239], v[208:211], v[152:155]
    ds_read_b64_tr_b16 v[232:233], v68 offset:33312
    v_mfma_f32_16x16x32_bf16 v[156:159], v[236:239], v[212:215], v[156:159]
    ds_read_b64_tr_b16 v[234:235], v68 offset:33824
    s_waitcnt lgkmcnt(8)
    v_mfma_f32_16x16x32_bf16 v[160:163], v[240:243], v[208:211], v[160:163]
    ds_read_b64_tr_b16 v[236:237], v68 offset:24960
    v_mfma_f32_16x16x32_bf16 v[164:167], v[240:243], v[212:215], v[164:167]
    ds_read_b64_tr_b16 v[238:239], v68 offset:25472
    v_mfma_f32_16x16x32_bf16 v[168:171], v[244:247], v[208:211], v[168:171]
    ds_read_b64_tr_b16 v[240:241], v68 offset:24992
    v_mfma_f32_16x16x32_bf16 v[172:175], v[244:247], v[212:215], v[172:175]
    ds_read_b64_tr_b16 v[242:243], v68 offset:25504
    s_waitcnt lgkmcnt(8)
    s_waitcnt vmcnt(9)
    v_mfma_f32_16x16x32_bf16 v[128:131], v[248:251], v[216:219], v[128:131]
    ds_read_b64_tr_b16 v[244:245], v69 offset:24960
    v_mfma_f32_16x16x32_bf16 v[132:135], v[248:251], v[220:223], v[132:135]
    ds_read_b64_tr_b16 v[246:247], v69 offset:25472
    buffer_load_dwordx4 v[208:211], v2, s[32:35], s16 offen offset:3072 sc1
    v_mfma_f32_16x16x32_bf16 v[136:139], v[224:227], v[216:219], v[136:139]
    ds_read_b64_tr_b16 v[248:249], v69 offset:24992
    v_mfma_f32_16x16x32_bf16 v[140:143], v[224:227], v[220:223], v[140:143]
    ds_read_b64_tr_b16 v[250:251], v69 offset:25504
    s_waitcnt lgkmcnt(8)
    v_mfma_f32_16x16x32_bf16 v[112:115], v[228:231], v[216:219], v[112:115]
    ds_read_b64_tr_b16 v[224:225], v68 offset:41600
    v_mfma_f32_16x16x32_bf16 v[116:119], v[228:231], v[220:223], v[116:119]
    ds_read_b64_tr_b16 v[226:227], v68 offset:42112
    v_mfma_f32_16x16x32_bf16 v[120:123], v[232:235], v[216:219], v[120:123]
    ds_read_b64_tr_b16 v[228:229], v68 offset:41632
    v_mfma_f32_16x16x32_bf16 v[124:127], v[232:235], v[220:223], v[124:127]
    ds_read_b64_tr_b16 v[230:231], v68 offset:42144
    s_add_u32 s96, s85, 12
    s_and_b32 s97, s96, 15
    s_lshl_b32 s98, s97, 14
    s_add_u32 s16, s98, s15
    buffer_load_dwordx4 v[212:215], v2, s[32:35], s16 offen sc1
    s_waitcnt lgkmcnt(8)
    v_mfma_f32_16x16x32_bf16 v[80:83], v[236:239], v[216:219], v[80:83]
    ds_read_b64_tr_b16 v[232:233], v69 offset:41600
    v_mfma_f32_16x16x32_bf16 v[84:87], v[236:239], v[220:223], v[84:87]
    ds_read_b64_tr_b16 v[234:235], v69 offset:42112
    v_mfma_f32_16x16x32_bf16 v[88:91], v[240:243], v[216:219], v[88:91]
    ds_read_b64_tr_b16 v[236:237], v69 offset:41632
    v_mfma_f32_16x16x32_bf16 v[92:95], v[240:243], v[220:223], v[92:95]
    ds_read_b64_tr_b16 v[238:239], v69 offset:42144
    s_waitcnt lgkmcnt(8)
    v_mfma_f32_16x16x32_bf16 v[96:99], v[244:247], v[216:219], v[96:99]
    ds_read_b64_tr_b16 v[240:241], v69 offset:37440
    v_mfma_f32_16x16x32_bf16 v[100:103], v[244:247], v[220:223], v[100:103]
    ds_read_b64_tr_b16 v[242:243], v69 offset:37952
    v_mfma_f32_16x16x32_bf16 v[104:107], v[248:251], v[216:219], v[104:107]
    ds_read_b64_tr_b16 v[244:245], v69 offset:37472
    v_mfma_f32_16x16x32_bf16 v[108:111], v[248:251], v[220:223], v[108:111]
    ds_read_b64_tr_b16 v[246:247], v69 offset:37984
    s_waitcnt lgkmcnt(8)
    v_mfma_f32_16x16x32_bf16 v[144:147], v[224:227], v[216:219], v[144:147]
    ds_read_b64_tr_b16 v[248:249], v68 offset:37440
    v_mfma_f32_16x16x32_bf16 v[148:151], v[224:227], v[220:223], v[148:151]
    ds_read_b64_tr_b16 v[250:251], v68 offset:37952
    v_mfma_f32_16x16x32_bf16 v[152:155], v[228:231], v[216:219], v[152:155]
    ds_read_b64_tr_b16 v[224:225], v68 offset:37472
    v_mfma_f32_16x16x32_bf16 v[156:159], v[228:231], v[220:223], v[156:159]
    ds_read_b64_tr_b16 v[226:227], v68 offset:37984
    s_waitcnt lgkmcnt(8)
    v_mfma_f32_16x16x32_bf16 v[160:163], v[232:235], v[216:219], v[160:163]
    ds_read_b64_tr_b16 v[228:229], v68 offset:29120
    v_mfma_f32_16x16x32_bf16 v[164:167], v[232:235], v[220:223], v[164:167]
    ds_read_b64_tr_b16 v[230:231], v68 offset:29632
    v_mfma_f32_16x16x32_bf16 v[168:171], v[236:239], v[216:219], v[168:171]
    ds_read_b64_tr_b16 v[232:233], v68 offset:29152
    v_mfma_f32_16x16x32_bf16 v[172:175], v[236:239], v[220:223], v[172:175]
    ds_read_b64_tr_b16 v[234:235], v68 offset:29664
    s_waitcnt lgkmcnt(8)
    s_waitcnt vmcnt(9)
    v_mfma_f32_16x16x32_bf16 v[128:131], v[240:243], v[36:39], v[128:131]
    ds_read_b64_tr_b16 v[236:237], v69 offset:29120
    v_mfma_f32_16x16x32_bf16 v[132:135], v[240:243], v[176:179], v[132:135]
    ds_read_b64_tr_b16 v[238:239], v69 offset:29632
    buffer_load_dwordx4 v[216:219], v2, s[32:35], s16 offen offset:1024 sc1
    v_mfma_f32_16x16x32_bf16 v[136:139], v[244:247], v[36:39], v[136:139]
    ds_read_b64_tr_b16 v[240:241], v69 offset:29152
    v_mfma_f32_16x16x32_bf16 v[140:143], v[244:247], v[176:179], v[140:143]
    ds_read_b64_tr_b16 v[242:243], v69 offset:29664
    s_waitcnt lgkmcnt(8)
    v_mfma_f32_16x16x32_bf16 v[112:115], v[248:251], v[36:39], v[112:115]
    ds_read_b64_tr_b16 v[244:245], v68 offset:45760
    v_mfma_f32_16x16x32_bf16 v[116:119], v[248:251], v[176:179], v[116:119]
    ds_read_b64_tr_b16 v[246:247], v68 offset:46272
    v_mfma_f32_16x16x32_bf16 v[120:123], v[224:227], v[36:39], v[120:123]
    ds_read_b64_tr_b16 v[248:249], v68 offset:45792
    v_mfma_f32_16x16x32_bf16 v[124:127], v[224:227], v[176:179], v[124:127]
    ds_read_b64_tr_b16 v[250:251], v68 offset:46304
    buffer_load_dwordx4 v[220:223], v2, s[32:35], s16 offen offset:2048 sc1
    s_waitcnt lgkmcnt(8)
    v_mfma_f32_16x16x32_bf16 v[80:83], v[228:231], v[36:39], v[80:83]
    ds_read_b64_tr_b16 v[224:225], v69 offset:45760
    v_mfma_f32_16x16x32_bf16 v[84:87], v[228:231], v[176:179], v[84:87]
    ds_read_b64_tr_b16 v[226:227], v69 offset:46272
    v_mfma_f32_16x16x32_bf16 v[88:91], v[232:235], v[36:39], v[88:91]
    ds_read_b64_tr_b16 v[228:229], v69 offset:45792
    v_mfma_f32_16x16x32_bf16 v[92:95], v[232:235], v[176:179], v[92:95]
    ds_read_b64_tr_b16 v[230:231], v69 offset:46304
    s_waitcnt lgkmcnt(8)
    v_mfma_f32_16x16x32_bf16 v[96:99], v[236:239], v[36:39], v[96:99]
    s_barrier
    ds_read_b64_tr_b16 v[232:233], v71 offset:8320
    v_mfma_f32_16x16x32_bf16 v[100:103], v[236:239], v[176:179], v[100:103]
    ds_read_b64_tr_b16 v[234:235], v71 offset:8832
    v_mfma_f32_16x16x32_bf16 v[104:107], v[240:243], v[36:39], v[104:107]
    ds_read_b64_tr_b16 v[236:237], v71 offset:8352
    v_mfma_f32_16x16x32_bf16 v[108:111], v[240:243], v[176:179], v[108:111]
    ds_read_b64_tr_b16 v[238:239], v71 offset:8864
    s_waitcnt lgkmcnt(8)
    v_mfma_f32_16x16x32_bf16 v[144:147], v[244:247], v[36:39], v[144:147]
    ds_read_b64_tr_b16 v[240:241], v70 offset:8320
    v_mfma_f32_16x16x32_bf16 v[148:151], v[244:247], v[176:179], v[148:151]
    ds_read_b64_tr_b16 v[242:243], v70 offset:8832
    v_mfma_f32_16x16x32_bf16 v[152:155], v[248:251], v[36:39], v[152:155]
    ds_read_b64_tr_b16 v[244:245], v70 offset:8352
    v_mfma_f32_16x16x32_bf16 v[156:159], v[248:251], v[176:179], v[156:159]
    ds_read_b64_tr_b16 v[246:247], v70 offset:8864
    s_waitcnt lgkmcnt(8)
    v_mfma_f32_16x16x32_bf16 v[160:163], v[224:227], v[36:39], v[160:163]
    ds_read_b64_tr_b16 v[248:249], v70
    v_mfma_f32_16x16x32_bf16 v[164:167], v[224:227], v[176:179], v[164:167]
    ds_read_b64_tr_b16 v[250:251], v70 offset:512
    v_mfma_f32_16x16x32_bf16 v[168:171], v[228:231], v[36:39], v[168:171]
    ds_read_b64_tr_b16 v[224:225], v70 offset:32
    v_mfma_f32_16x16x32_bf16 v[172:175], v[228:231], v[176:179], v[172:175]
    ds_read_b64_tr_b16 v[226:227], v70 offset:544
    s_waitcnt lgkmcnt(8)
    s_waitcnt vmcnt(9)
    v_mfma_f32_16x16x32_bf16 v[128:131], v[232:235], v[180:183], v[128:131]
    ds_read_b64_tr_b16 v[228:229], v71
    v_mfma_f32_16x16x32_bf16 v[132:135], v[232:235], v[184:187], v[132:135]
    ds_read_b64_tr_b16 v[230:231], v71 offset:512
    buffer_load_dwordx4 v[36:39], v2, s[32:35], s16 offen offset:3072 sc1
    v_mfma_f32_16x16x32_bf16 v[136:139], v[236:239], v[180:183], v[136:139]
    ds_read_b64_tr_b16 v[232:233], v71 offset:32
    v_mfma_f32_16x16x32_bf16 v[140:143], v[236:239], v[184:187], v[140:143]
    ds_read_b64_tr_b16 v[234:235], v71 offset:544
    s_waitcnt lgkmcnt(8)
    v_mfma_f32_16x16x32_bf16 v[112:115], v[240:243], v[180:183], v[112:115]
    ds_read_b64_tr_b16 v[236:237], v70 offset:16640
    v_mfma_f32_16x16x32_bf16 v[116:119], v[240:243], v[184:187], v[116:119]
    ds_read_b64_tr_b16 v[238:239], v70 offset:17152
    v_mfma_f32_16x16x32_bf16 v[120:123], v[244:247], v[180:183], v[120:123]
    ds_read_b64_tr_b16 v[240:241], v70 offset:16672
    v_mfma_f32_16x16x32_bf16 v[124:127], v[244:247], v[184:187], v[124:127]
    ds_read_b64_tr_b16 v[242:243], v70 offset:17184
    s_add_u32 s96, s85, 13
    s_and_b32 s97, s96, 15
    s_lshl_b32 s98, s97, 14
    s_add_u32 s16, s98, s15
    buffer_load_dwordx4 v[176:179], v2, s[32:35], s16 offen sc1
    s_waitcnt lgkmcnt(8)
    v_mfma_f32_16x16x32_bf16 v[80:83], v[248:251], v[180:183], v[80:83]
    ds_read_b64_tr_b16 v[244:245], v71 offset:16640
    v_mfma_f32_16x16x32_bf16 v[84:87], v[248:251], v[184:187], v[84:87]
    ds_read_b64_tr_b16 v[246:247], v71 offset:17152
    v_mfma_f32_16x16x32_bf16 v[88:91], v[224:227], v[180:183], v[88:91]
    ds_read_b64_tr_b16 v[248:249], v71 offset:16672
    v_mfma_f32_16x16x32_bf16 v[92:95], v[224:227], v[184:187], v[92:95]
    ds_read_b64_tr_b16 v[250:251], v71 offset:17184
    s_waitcnt lgkmcnt(8)
    v_mfma_f32_16x16x32_bf16 v[96:99], v[228:231], v[180:183], v[96:99]
    ds_read_b64_tr_b16 v[224:225], v71 offset:12480
    v_mfma_f32_16x16x32_bf16 v[100:103], v[228:231], v[184:187], v[100:103]
    ds_read_b64_tr_b16 v[226:227], v71 offset:12992
    v_mfma_f32_16x16x32_bf16 v[104:107], v[232:235], v[180:183], v[104:107]
    ds_read_b64_tr_b16 v[228:229], v71 offset:12512
    v_mfma_f32_16x16x32_bf16 v[108:111], v[232:235], v[184:187], v[108:111]
    ds_read_b64_tr_b16 v[230:231], v71 offset:13024
    s_waitcnt lgkmcnt(8)
    v_mfma_f32_16x16x32_bf16 v[144:147], v[236:239], v[180:183], v[144:147]
    ds_read_b64_tr_b16 v[232:233], v70 offset:12480
    v_mfma_f32_16x16x32_bf16 v[148:151], v[236:239], v[184:187], v[148:151]
    ds_read_b64_tr_b16 v[234:235], v70 offset:12992
    v_mfma_f32_16x16x32_bf16 v[152:155], v[240:243], v[180:183], v[152:155]
    ds_read_b64_tr_b16 v[236:237], v70 offset:12512
    v_mfma_f32_16x16x32_bf16 v[156:159], v[240:243], v[184:187], v[156:159]
    ds_read_b64_tr_b16 v[238:239], v70 offset:13024
    s_waitcnt lgkmcnt(8)
    v_mfma_f32_16x16x32_bf16 v[160:163], v[244:247], v[180:183], v[160:163]
    ds_read_b64_tr_b16 v[240:241], v70 offset:4160
    v_mfma_f32_16x16x32_bf16 v[164:167], v[244:247], v[184:187], v[164:167]
    ds_read_b64_tr_b16 v[242:243], v70 offset:4672
    v_mfma_f32_16x16x32_bf16 v[168:171], v[248:251], v[180:183], v[168:171]
    ds_read_b64_tr_b16 v[244:245], v70 offset:4192
    v_mfma_f32_16x16x32_bf16 v[172:175], v[248:251], v[184:187], v[172:175]
    ds_read_b64_tr_b16 v[246:247], v70 offset:4704
    s_waitcnt lgkmcnt(8)
    s_waitcnt vmcnt(9)
    v_mfma_f32_16x16x32_bf16 v[128:131], v[224:227], v[188:191], v[128:131]
    ds_read_b64_tr_b16 v[248:249], v71 offset:4160
    v_mfma_f32_16x16x32_bf16 v[132:135], v[224:227], v[192:195], v[132:135]
    ds_read_b64_tr_b16 v[250:251], v71 offset:4672
    buffer_load_dwordx4 v[180:183], v2, s[32:35], s16 offen offset:1024 sc1
    v_mfma_f32_16x16x32_bf16 v[136:139], v[228:231], v[188:191], v[136:139]
    ds_read_b64_tr_b16 v[224:225], v71 offset:4192
    v_mfma_f32_16x16x32_bf16 v[140:143], v[228:231], v[192:195], v[140:143]
    ds_read_b64_tr_b16 v[226:227], v71 offset:4704
    s_waitcnt lgkmcnt(8)
    v_mfma_f32_16x16x32_bf16 v[112:115], v[232:235], v[188:191], v[112:115]
    ds_read_b64_tr_b16 v[228:229], v70 offset:20800
    v_mfma_f32_16x16x32_bf16 v[116:119], v[232:235], v[192:195], v[116:119]
    ds_read_b64_tr_b16 v[230:231], v70 offset:21312
    v_mfma_f32_16x16x32_bf16 v[120:123], v[236:239], v[188:191], v[120:123]
    ds_read_b64_tr_b16 v[232:233], v70 offset:20832
    v_mfma_f32_16x16x32_bf16 v[124:127], v[236:239], v[192:195], v[124:127]
    ds_read_b64_tr_b16 v[234:235], v70 offset:21344
    buffer_load_dwordx4 v[184:187], v2, s[32:35], s16 offen offset:2048 sc1
    s_waitcnt lgkmcnt(8)
    v_mfma_f32_16x16x32_bf16 v[80:83], v[240:243], v[188:191], v[80:83]
    ds_read_b64_tr_b16 v[236:237], v71 offset:20800
    v_mfma_f32_16x16x32_bf16 v[84:87], v[240:243], v[192:195], v[84:87]
    ds_read_b64_tr_b16 v[238:239], v71 offset:21312
    v_mfma_f32_16x16x32_bf16 v[88:91], v[244:247], v[188:191], v[88:91]
    ds_read_b64_tr_b16 v[240:241], v71 offset:20832
    v_mfma_f32_16x16x32_bf16 v[92:95], v[244:247], v[192:195], v[92:95]
    ds_read_b64_tr_b16 v[242:243], v71 offset:21344
    s_waitcnt lgkmcnt(8)
    v_mfma_f32_16x16x32_bf16 v[96:99], v[248:251], v[188:191], v[96:99]
    s_barrier
    ds_read_b64_tr_b16 v[244:245], v71 offset:33280
    v_mfma_f32_16x16x32_bf16 v[100:103], v[248:251], v[192:195], v[100:103]
    ds_read_b64_tr_b16 v[246:247], v71 offset:33792
    v_mfma_f32_16x16x32_bf16 v[104:107], v[224:227], v[188:191], v[104:107]
    ds_read_b64_tr_b16 v[248:249], v71 offset:33312
    v_mfma_f32_16x16x32_bf16 v[108:111], v[224:227], v[192:195], v[108:111]
    ds_read_b64_tr_b16 v[250:251], v71 offset:33824
    s_waitcnt lgkmcnt(8)
    v_mfma_f32_16x16x32_bf16 v[144:147], v[228:231], v[188:191], v[144:147]
    ds_read_b64_tr_b16 v[224:225], v70 offset:33280
    v_mfma_f32_16x16x32_bf16 v[148:151], v[228:231], v[192:195], v[148:151]
    ds_read_b64_tr_b16 v[226:227], v70 offset:33792
    v_mfma_f32_16x16x32_bf16 v[152:155], v[232:235], v[188:191], v[152:155]
    ds_read_b64_tr_b16 v[228:229], v70 offset:33312
    v_mfma_f32_16x16x32_bf16 v[156:159], v[232:235], v[192:195], v[156:159]
    ds_read_b64_tr_b16 v[230:231], v70 offset:33824
    s_waitcnt lgkmcnt(8)
    v_mfma_f32_16x16x32_bf16 v[160:163], v[236:239], v[188:191], v[160:163]
    ds_read_b64_tr_b16 v[232:233], v70 offset:24960
    v_mfma_f32_16x16x32_bf16 v[164:167], v[236:239], v[192:195], v[164:167]
    ds_read_b64_tr_b16 v[234:235], v70 offset:25472
    v_mfma_f32_16x16x32_bf16 v[168:171], v[240:243], v[188:191], v[168:171]
    ds_read_b64_tr_b16 v[236:237], v70 offset:24992
    v_mfma_f32_16x16x32_bf16 v[172:175], v[240:243], v[192:195], v[172:175]
    ds_read_b64_tr_b16 v[238:239], v70 offset:25504
    s_waitcnt lgkmcnt(8)
    s_waitcnt vmcnt(9)
    v_mfma_f32_16x16x32_bf16 v[128:131], v[244:247], v[196:199], v[128:131]
    ds_read_b64_tr_b16 v[240:241], v71 offset:24960
    v_mfma_f32_16x16x32_bf16 v[132:135], v[244:247], v[200:203], v[132:135]
    ds_read_b64_tr_b16 v[242:243], v71 offset:25472
    buffer_load_dwordx4 v[188:191], v2, s[32:35], s16 offen offset:3072 sc1
    v_mfma_f32_16x16x32_bf16 v[136:139], v[248:251], v[196:199], v[136:139]
    ds_read_b64_tr_b16 v[244:245], v71 offset:24992
    v_mfma_f32_16x16x32_bf16 v[140:143], v[248:251], v[200:203], v[140:143]
    ds_read_b64_tr_b16 v[246:247], v71 offset:25504
    s_waitcnt lgkmcnt(8)
    v_mfma_f32_16x16x32_bf16 v[112:115], v[224:227], v[196:199], v[112:115]
    ds_read_b64_tr_b16 v[248:249], v70 offset:41600
    v_mfma_f32_16x16x32_bf16 v[116:119], v[224:227], v[200:203], v[116:119]
    ds_read_b64_tr_b16 v[250:251], v70 offset:42112
    v_mfma_f32_16x16x32_bf16 v[120:123], v[228:231], v[196:199], v[120:123]
    ds_read_b64_tr_b16 v[224:225], v70 offset:41632
    v_mfma_f32_16x16x32_bf16 v[124:127], v[228:231], v[200:203], v[124:127]
    ds_read_b64_tr_b16 v[226:227], v70 offset:42144
    s_add_u32 s96, s85, 14
    s_and_b32 s97, s96, 15
    s_lshl_b32 s98, s97, 14
    s_add_u32 s16, s98, s15
    buffer_load_dwordx4 v[192:195], v2, s[32:35], s16 offen sc1
    s_waitcnt lgkmcnt(8)
    v_mfma_f32_16x16x32_bf16 v[80:83], v[232:235], v[196:199], v[80:83]
    ds_read_b64_tr_b16 v[228:229], v71 offset:41600
    v_mfma_f32_16x16x32_bf16 v[84:87], v[232:235], v[200:203], v[84:87]
    ds_read_b64_tr_b16 v[230:231], v71 offset:42112
    v_mfma_f32_16x16x32_bf16 v[88:91], v[236:239], v[196:199], v[88:91]
    ds_read_b64_tr_b16 v[232:233], v71 offset:41632
    v_mfma_f32_16x16x32_bf16 v[92:95], v[236:239], v[200:203], v[92:95]
    ds_read_b64_tr_b16 v[234:235], v71 offset:42144
    s_waitcnt lgkmcnt(8)
    v_mfma_f32_16x16x32_bf16 v[96:99], v[240:243], v[196:199], v[96:99]
    ds_read_b64_tr_b16 v[236:237], v71 offset:37440
    v_mfma_f32_16x16x32_bf16 v[100:103], v[240:243], v[200:203], v[100:103]
    ds_read_b64_tr_b16 v[238:239], v71 offset:37952
    v_mfma_f32_16x16x32_bf16 v[104:107], v[244:247], v[196:199], v[104:107]
    ds_read_b64_tr_b16 v[240:241], v71 offset:37472
    v_mfma_f32_16x16x32_bf16 v[108:111], v[244:247], v[200:203], v[108:111]
    ds_read_b64_tr_b16 v[242:243], v71 offset:37984
    s_waitcnt lgkmcnt(8)
    v_mfma_f32_16x16x32_bf16 v[144:147], v[248:251], v[196:199], v[144:147]
    ds_read_b64_tr_b16 v[244:245], v70 offset:37440
    v_mfma_f32_16x16x32_bf16 v[148:151], v[248:251], v[200:203], v[148:151]
    ds_read_b64_tr_b16 v[246:247], v70 offset:37952
    v_mfma_f32_16x16x32_bf16 v[152:155], v[224:227], v[196:199], v[152:155]
    ds_read_b64_tr_b16 v[248:249], v70 offset:37472
    v_mfma_f32_16x16x32_bf16 v[156:159], v[224:227], v[200:203], v[156:159]
    ds_read_b64_tr_b16 v[250:251], v70 offset:37984
    s_waitcnt lgkmcnt(8)
    v_mfma_f32_16x16x32_bf16 v[160:163], v[228:231], v[196:199], v[160:163]
    ds_read_b64_tr_b16 v[224:225], v70 offset:29120
    v_mfma_f32_16x16x32_bf16 v[164:167], v[228:231], v[200:203], v[164:167]
    ds_read_b64_tr_b16 v[226:227], v70 offset:29632
    v_mfma_f32_16x16x32_bf16 v[168:171], v[232:235], v[196:199], v[168:171]
    ds_read_b64_tr_b16 v[228:229], v70 offset:29152
    v_mfma_f32_16x16x32_bf16 v[172:175], v[232:235], v[200:203], v[172:175]
    ds_read_b64_tr_b16 v[230:231], v70 offset:29664
    s_waitcnt lgkmcnt(8)
    s_waitcnt vmcnt(9)
    v_mfma_f32_16x16x32_bf16 v[128:131], v[236:239], v[204:207], v[128:131]
    ds_read_b64_tr_b16 v[232:233], v71 offset:29120
    v_mfma_f32_16x16x32_bf16 v[132:135], v[236:239], v[208:211], v[132:135]
    ds_read_b64_tr_b16 v[234:235], v71 offset:29632
    buffer_load_dwordx4 v[196:199], v2, s[32:35], s16 offen offset:1024 sc1
    v_mfma_f32_16x16x32_bf16 v[136:139], v[240:243], v[204:207], v[136:139]
    ds_read_b64_tr_b16 v[236:237], v71 offset:29152
    v_mfma_f32_16x16x32_bf16 v[140:143], v[240:243], v[208:211], v[140:143]
    ds_read_b64_tr_b16 v[238:239], v71 offset:29664
    s_waitcnt lgkmcnt(8)
    v_mfma_f32_16x16x32_bf16 v[112:115], v[244:247], v[204:207], v[112:115]
    ds_read_b64_tr_b16 v[240:241], v70 offset:45760
    v_mfma_f32_16x16x32_bf16 v[116:119], v[244:247], v[208:211], v[116:119]
    ds_read_b64_tr_b16 v[242:243], v70 offset:46272
    v_mfma_f32_16x16x32_bf16 v[120:123], v[248:251], v[204:207], v[120:123]
    ds_read_b64_tr_b16 v[244:245], v70 offset:45792
    v_mfma_f32_16x16x32_bf16 v[124:127], v[248:251], v[208:211], v[124:127]
    ds_read_b64_tr_b16 v[246:247], v70 offset:46304
    buffer_load_dwordx4 v[200:203], v2, s[32:35], s16 offen offset:2048 sc1
    s_waitcnt lgkmcnt(8)
    v_mfma_f32_16x16x32_bf16 v[80:83], v[224:227], v[204:207], v[80:83]
    ds_read_b64_tr_b16 v[248:249], v71 offset:45760
    v_mfma_f32_16x16x32_bf16 v[84:87], v[224:227], v[208:211], v[84:87]
    ds_read_b64_tr_b16 v[250:251], v71 offset:46272
    v_mfma_f32_16x16x32_bf16 v[88:91], v[228:231], v[204:207], v[88:91]
    ds_read_b64_tr_b16 v[224:225], v71 offset:45792
    v_mfma_f32_16x16x32_bf16 v[92:95], v[228:231], v[208:211], v[92:95]
    ds_read_b64_tr_b16 v[226:227], v71 offset:46304
    s_waitcnt lgkmcnt(8)
    v_mfma_f32_16x16x32_bf16 v[96:99], v[232:235], v[204:207], v[96:99]
    s_barrier
    ds_read_b64_tr_b16 v[228:229], v67 offset:8320
    v_mfma_f32_16x16x32_bf16 v[100:103], v[232:235], v[208:211], v[100:103]
    ds_read_b64_tr_b16 v[230:231], v67 offset:8832
    v_mfma_f32_16x16x32_bf16 v[104:107], v[236:239], v[204:207], v[104:107]
    ds_read_b64_tr_b16 v[232:233], v67 offset:8352
    v_mfma_f32_16x16x32_bf16 v[108:111], v[236:239], v[208:211], v[108:111]
    ds_read_b64_tr_b16 v[234:235], v67 offset:8864
    s_waitcnt lgkmcnt(8)
    v_mfma_f32_16x16x32_bf16 v[144:147], v[240:243], v[204:207], v[144:147]
    ds_read_b64_tr_b16 v[236:237], v66 offset:8320
    v_mfma_f32_16x16x32_bf16 v[148:151], v[240:243], v[208:211], v[148:151]
    ds_read_b64_tr_b16 v[238:239], v66 offset:8832
    v_mfma_f32_16x16x32_bf16 v[152:155], v[244:247], v[204:207], v[152:155]
    ds_read_b64_tr_b16 v[240:241], v66 offset:8352
    v_mfma_f32_16x16x32_bf16 v[156:159], v[244:247], v[208:211], v[156:159]
    ds_read_b64_tr_b16 v[242:243], v66 offset:8864
    s_waitcnt lgkmcnt(8)
    v_mfma_f32_16x16x32_bf16 v[160:163], v[248:251], v[204:207], v[160:163]
    ds_read_b64_tr_b16 v[244:245], v66
    v_mfma_f32_16x16x32_bf16 v[164:167], v[248:251], v[208:211], v[164:167]
    ds_read_b64_tr_b16 v[246:247], v66 offset:512
    v_mfma_f32_16x16x32_bf16 v[168:171], v[224:227], v[204:207], v[168:171]
    ds_read_b64_tr_b16 v[248:249], v66 offset:32
    v_mfma_f32_16x16x32_bf16 v[172:175], v[224:227], v[208:211], v[172:175]
    ds_read_b64_tr_b16 v[250:251], v66 offset:544
    s_waitcnt lgkmcnt(8)
    s_waitcnt vmcnt(9)
    v_mfma_f32_16x16x32_bf16 v[128:131], v[228:231], v[212:215], v[128:131]
    ds_read_b64_tr_b16 v[224:225], v67
    v_mfma_f32_16x16x32_bf16 v[132:135], v[228:231], v[216:219], v[132:135]
    ds_read_b64_tr_b16 v[226:227], v67 offset:512
    buffer_load_dwordx4 v[204:207], v2, s[32:35], s16 offen offset:3072 sc1
    v_mfma_f32_16x16x32_bf16 v[136:139], v[232:235], v[212:215], v[136:139]
    ds_read_b64_tr_b16 v[228:229], v67 offset:32
    v_mfma_f32_16x16x32_bf16 v[140:143], v[232:235], v[216:219], v[140:143]
    ds_read_b64_tr_b16 v[230:231], v67 offset:544
    s_waitcnt lgkmcnt(8)
    v_mfma_f32_16x16x32_bf16 v[112:115], v[236:239], v[212:215], v[112:115]
    ds_read_b64_tr_b16 v[232:233], v66 offset:16640
    v_mfma_f32_16x16x32_bf16 v[116:119], v[236:239], v[216:219], v[116:119]
    ds_read_b64_tr_b16 v[234:235], v66 offset:17152
    v_mfma_f32_16x16x32_bf16 v[120:123], v[240:243], v[212:215], v[120:123]
    ds_read_b64_tr_b16 v[236:237], v66 offset:16672
    v_mfma_f32_16x16x32_bf16 v[124:127], v[240:243], v[216:219], v[124:127]
    ds_read_b64_tr_b16 v[238:239], v66 offset:17184
    s_add_u32 s96, s85, 15
    s_and_b32 s97, s96, 15
    s_lshl_b32 s98, s97, 14
    s_add_u32 s16, s98, s15
    buffer_load_dwordx4 v[208:211], v2, s[32:35], s16 offen sc1
    s_waitcnt lgkmcnt(8)
    v_mfma_f32_16x16x32_bf16 v[80:83], v[244:247], v[212:215], v[80:83]
    ds_read_b64_tr_b16 v[240:241], v67 offset:16640
    v_mfma_f32_16x16x32_bf16 v[84:87], v[244:247], v[216:219], v[84:87]
    ds_read_b64_tr_b16 v[242:243], v67 offset:17152
    v_mfma_f32_16x16x32_bf16 v[88:91], v[248:251], v[212:215], v[88:91]
    ds_read_b64_tr_b16 v[244:245], v67 offset:16672
    v_mfma_f32_16x16x32_bf16 v[92:95], v[248:251], v[216:219], v[92:95]
    ds_read_b64_tr_b16 v[246:247], v67 offset:17184
    s_waitcnt lgkmcnt(8)
    v_mfma_f32_16x16x32_bf16 v[96:99], v[224:227], v[212:215], v[96:99]
    ds_read_b64_tr_b16 v[248:249], v67 offset:12480
    v_mfma_f32_16x16x32_bf16 v[100:103], v[224:227], v[216:219], v[100:103]
    ds_read_b64_tr_b16 v[250:251], v67 offset:12992
    v_mfma_f32_16x16x32_bf16 v[104:107], v[228:231], v[212:215], v[104:107]
    ds_read_b64_tr_b16 v[224:225], v67 offset:12512
    v_mfma_f32_16x16x32_bf16 v[108:111], v[228:231], v[216:219], v[108:111]
    ds_read_b64_tr_b16 v[226:227], v67 offset:13024
    s_waitcnt lgkmcnt(8)
    v_mfma_f32_16x16x32_bf16 v[144:147], v[232:235], v[212:215], v[144:147]
    ds_read_b64_tr_b16 v[228:229], v66 offset:12480
    v_mfma_f32_16x16x32_bf16 v[148:151], v[232:235], v[216:219], v[148:151]
    ds_read_b64_tr_b16 v[230:231], v66 offset:12992
    v_mfma_f32_16x16x32_bf16 v[152:155], v[236:239], v[212:215], v[152:155]
    ds_read_b64_tr_b16 v[232:233], v66 offset:12512
    v_mfma_f32_16x16x32_bf16 v[156:159], v[236:239], v[216:219], v[156:159]
    ds_read_b64_tr_b16 v[234:235], v66 offset:13024
    s_waitcnt lgkmcnt(8)
    v_mfma_f32_16x16x32_bf16 v[160:163], v[240:243], v[212:215], v[160:163]
    ds_read_b64_tr_b16 v[236:237], v66 offset:4160
    v_mfma_f32_16x16x32_bf16 v[164:167], v[240:243], v[216:219], v[164:167]
    ds_read_b64_tr_b16 v[238:239], v66 offset:4672
    v_mfma_f32_16x16x32_bf16 v[168:171], v[244:247], v[212:215], v[168:171]
    ds_read_b64_tr_b16 v[240:241], v66 offset:4192
    v_mfma_f32_16x16x32_bf16 v[172:175], v[244:247], v[216:219], v[172:175]
    ds_read_b64_tr_b16 v[242:243], v66 offset:4704
    s_waitcnt lgkmcnt(8)
    s_waitcnt vmcnt(9)
    v_mfma_f32_16x16x32_bf16 v[128:131], v[248:251], v[220:223], v[128:131]
    ds_read_b64_tr_b16 v[244:245], v67 offset:4160
    v_mfma_f32_16x16x32_bf16 v[132:135], v[248:251], v[36:39], v[132:135]
    ds_read_b64_tr_b16 v[246:247], v67 offset:4672
    buffer_load_dwordx4 v[212:215], v2, s[32:35], s16 offen offset:1024 sc1
    v_mfma_f32_16x16x32_bf16 v[136:139], v[224:227], v[220:223], v[136:139]
    ds_read_b64_tr_b16 v[248:249], v67 offset:4192
    v_mfma_f32_16x16x32_bf16 v[140:143], v[224:227], v[36:39], v[140:143]
    ds_read_b64_tr_b16 v[250:251], v67 offset:4704
    s_waitcnt lgkmcnt(8)
    v_mfma_f32_16x16x32_bf16 v[112:115], v[228:231], v[220:223], v[112:115]
    ds_read_b64_tr_b16 v[224:225], v66 offset:20800
    v_mfma_f32_16x16x32_bf16 v[116:119], v[228:231], v[36:39], v[116:119]
    ds_read_b64_tr_b16 v[226:227], v66 offset:21312
    v_mfma_f32_16x16x32_bf16 v[120:123], v[232:235], v[220:223], v[120:123]
    ds_read_b64_tr_b16 v[228:229], v66 offset:20832
    v_mfma_f32_16x16x32_bf16 v[124:127], v[232:235], v[36:39], v[124:127]
    ds_read_b64_tr_b16 v[230:231], v66 offset:21344
    buffer_load_dwordx4 v[216:219], v2, s[32:35], s16 offen offset:2048 sc1
    s_waitcnt lgkmcnt(8)
    v_mfma_f32_16x16x32_bf16 v[80:83], v[236:239], v[220:223], v[80:83]
    ds_read_b64_tr_b16 v[232:233], v67 offset:20800
    v_mfma_f32_16x16x32_bf16 v[84:87], v[236:239], v[36:39], v[84:87]
    ds_read_b64_tr_b16 v[234:235], v67 offset:21312
    v_mfma_f32_16x16x32_bf16 v[88:91], v[240:243], v[220:223], v[88:91]
    ds_read_b64_tr_b16 v[236:237], v67 offset:20832
    v_mfma_f32_16x16x32_bf16 v[92:95], v[240:243], v[36:39], v[92:95]
    ds_read_b64_tr_b16 v[238:239], v67 offset:21344
    s_waitcnt lgkmcnt(8)
    v_mfma_f32_16x16x32_bf16 v[96:99], v[244:247], v[220:223], v[96:99]
    s_barrier
    ds_read_b64_tr_b16 v[240:241], v67 offset:33280
    v_mfma_f32_16x16x32_bf16 v[100:103], v[244:247], v[36:39], v[100:103]
    ds_read_b64_tr_b16 v[242:243], v67 offset:33792
    v_mfma_f32_16x16x32_bf16 v[104:107], v[248:251], v[220:223], v[104:107]
    ds_read_b64_tr_b16 v[244:245], v67 offset:33312
    v_mfma_f32_16x16x32_bf16 v[108:111], v[248:251], v[36:39], v[108:111]
    ds_read_b64_tr_b16 v[246:247], v67 offset:33824
    s_waitcnt lgkmcnt(8)
    v_mfma_f32_16x16x32_bf16 v[144:147], v[224:227], v[220:223], v[144:147]
    ds_read_b64_tr_b16 v[248:249], v66 offset:33280
    v_mfma_f32_16x16x32_bf16 v[148:151], v[224:227], v[36:39], v[148:151]
    ds_read_b64_tr_b16 v[250:251], v66 offset:33792
    v_mfma_f32_16x16x32_bf16 v[152:155], v[228:231], v[220:223], v[152:155]
    ds_read_b64_tr_b16 v[224:225], v66 offset:33312
    v_mfma_f32_16x16x32_bf16 v[156:159], v[228:231], v[36:39], v[156:159]
    ds_read_b64_tr_b16 v[226:227], v66 offset:33824
    s_waitcnt lgkmcnt(8)
    v_mfma_f32_16x16x32_bf16 v[160:163], v[232:235], v[220:223], v[160:163]
    ds_read_b64_tr_b16 v[228:229], v66 offset:24960
    v_mfma_f32_16x16x32_bf16 v[164:167], v[232:235], v[36:39], v[164:167]
    ds_read_b64_tr_b16 v[230:231], v66 offset:25472
    v_mfma_f32_16x16x32_bf16 v[168:171], v[236:239], v[220:223], v[168:171]
    ds_read_b64_tr_b16 v[232:233], v66 offset:24992
    v_mfma_f32_16x16x32_bf16 v[172:175], v[236:239], v[36:39], v[172:175]
    ds_read_b64_tr_b16 v[234:235], v66 offset:25504
    s_waitcnt lgkmcnt(8)
    s_waitcnt vmcnt(9)
    v_mfma_f32_16x16x32_bf16 v[128:131], v[240:243], v[176:179], v[128:131]
    ds_read_b64_tr_b16 v[236:237], v67 offset:24960
    v_mfma_f32_16x16x32_bf16 v[132:135], v[240:243], v[180:183], v[132:135]
    ds_read_b64_tr_b16 v[238:239], v67 offset:25472
    buffer_load_dwordx4 v[220:223], v2, s[32:35], s16 offen offset:3072 sc1
    s_barrier
    v_mfma_f32_16x16x32_bf16 v[136:139], v[244:247], v[176:179], v[136:139]
    ds_read_b64_tr_b16 v[240:241], v67 offset:24992
    v_mfma_f32_16x16x32_bf16 v[140:143], v[244:247], v[180:183], v[140:143]
    ds_read_b64_tr_b16 v[242:243], v67 offset:25504
    s_waitcnt lgkmcnt(8)
    v_mfma_f32_16x16x32_bf16 v[112:115], v[248:251], v[176:179], v[112:115]
    ds_read_b64_tr_b16 v[244:245], v66 offset:41600
    v_mfma_f32_16x16x32_bf16 v[116:119], v[248:251], v[180:183], v[116:119]
    ds_read_b64_tr_b16 v[246:247], v66 offset:42112
    v_mfma_f32_16x16x32_bf16 v[120:123], v[224:227], v[176:179], v[120:123]
    ds_read_b64_tr_b16 v[248:249], v66 offset:41632
    v_mfma_f32_16x16x32_bf16 v[124:127], v[224:227], v[180:183], v[124:127]
    ds_read_b64_tr_b16 v[250:251], v66 offset:42144
    s_waitcnt lgkmcnt(8)
    v_mfma_f32_16x16x32_bf16 v[80:83], v[228:231], v[176:179], v[80:83]
    ds_read_b64_tr_b16 v[224:225], v67 offset:41600
    v_mfma_f32_16x16x32_bf16 v[84:87], v[228:231], v[180:183], v[84:87]
    ds_read_b64_tr_b16 v[226:227], v67 offset:42112
    v_mfma_f32_16x16x32_bf16 v[88:91], v[232:235], v[176:179], v[88:91]
    ds_read_b64_tr_b16 v[228:229], v67 offset:41632
    v_mfma_f32_16x16x32_bf16 v[92:95], v[232:235], v[180:183], v[92:95]
    ds_read_b64_tr_b16 v[230:231], v67 offset:42144
    s_waitcnt lgkmcnt(8)
    v_mfma_f32_16x16x32_bf16 v[96:99], v[236:239], v[176:179], v[96:99]
    ds_read_b64_tr_b16 v[232:233], v67 offset:37440
    v_mfma_f32_16x16x32_bf16 v[100:103], v[236:239], v[180:183], v[100:103]
    ds_read_b64_tr_b16 v[234:235], v67 offset:37952
    v_mfma_f32_16x16x32_bf16 v[104:107], v[240:243], v[176:179], v[104:107]
    ds_read_b64_tr_b16 v[236:237], v67 offset:37472
    v_mfma_f32_16x16x32_bf16 v[108:111], v[240:243], v[180:183], v[108:111]
    ds_read_b64_tr_b16 v[238:239], v67 offset:37984
    s_waitcnt lgkmcnt(8)
    v_mfma_f32_16x16x32_bf16 v[144:147], v[244:247], v[176:179], v[144:147]
    ds_read_b64_tr_b16 v[240:241], v66 offset:37440
    v_mfma_f32_16x16x32_bf16 v[148:151], v[244:247], v[180:183], v[148:151]
    ds_read_b64_tr_b16 v[242:243], v66 offset:37952
    v_mfma_f32_16x16x32_bf16 v[152:155], v[248:251], v[176:179], v[152:155]
    ds_read_b64_tr_b16 v[244:245], v66 offset:37472
    v_mfma_f32_16x16x32_bf16 v[156:159], v[248:251], v[180:183], v[156:159]
    ds_read_b64_tr_b16 v[246:247], v66 offset:37984
    s_waitcnt lgkmcnt(8)
    v_mfma_f32_16x16x32_bf16 v[160:163], v[224:227], v[176:179], v[160:163]
    ds_read_b64_tr_b16 v[248:249], v66 offset:29120
    v_mfma_f32_16x16x32_bf16 v[164:167], v[224:227], v[180:183], v[164:167]
    ds_read_b64_tr_b16 v[250:251], v66 offset:29632
    v_mfma_f32_16x16x32_bf16 v[168:171], v[228:231], v[176:179], v[168:171]
    ds_read_b64_tr_b16 v[224:225], v66 offset:29152
    v_mfma_f32_16x16x32_bf16 v[172:175], v[228:231], v[180:183], v[172:175]
    ds_read_b64_tr_b16 v[226:227], v66 offset:29664
    s_waitcnt lgkmcnt(8)
    s_waitcnt vmcnt(8)
    v_mfma_f32_16x16x32_bf16 v[128:131], v[232:235], v[184:187], v[128:131]
    ds_read_b64_tr_b16 v[228:229], v67 offset:29120
    v_mfma_f32_16x16x32_bf16 v[132:135], v[232:235], v[188:191], v[132:135]
    ds_read_b64_tr_b16 v[230:231], v67 offset:29632
    v_mfma_f32_16x16x32_bf16 v[136:139], v[236:239], v[184:187], v[136:139]
    ds_read_b64_tr_b16 v[232:233], v67 offset:29152
    v_mfma_f32_16x16x32_bf16 v[140:143], v[236:239], v[188:191], v[140:143]
    ds_read_b64_tr_b16 v[234:235], v67 offset:29664
    s_waitcnt lgkmcnt(8)
    v_mfma_f32_16x16x32_bf16 v[112:115], v[240:243], v[184:187], v[112:115]
    ds_read_b64_tr_b16 v[236:237], v66 offset:45760
    v_mfma_f32_16x16x32_bf16 v[116:119], v[240:243], v[188:191], v[116:119]
    ds_read_b64_tr_b16 v[238:239], v66 offset:46272
    v_mfma_f32_16x16x32_bf16 v[120:123], v[244:247], v[184:187], v[120:123]
    ds_read_b64_tr_b16 v[240:241], v66 offset:45792
    v_mfma_f32_16x16x32_bf16 v[124:127], v[244:247], v[188:191], v[124:127]
    ds_read_b64_tr_b16 v[242:243], v66 offset:46304
    s_waitcnt lgkmcnt(8)
    v_mfma_f32_16x16x32_bf16 v[80:83], v[248:251], v[184:187], v[80:83]
    ds_read_b64_tr_b16 v[244:245], v67 offset:45760
    v_mfma_f32_16x16x32_bf16 v[84:87], v[248:251], v[188:191], v[84:87]
    ds_read_b64_tr_b16 v[246:247], v67 offset:46272
    v_mfma_f32_16x16x32_bf16 v[88:91], v[224:227], v[184:187], v[88:91]
    ds_read_b64_tr_b16 v[248:249], v67 offset:45792
    v_mfma_f32_16x16x32_bf16 v[92:95], v[224:227], v[188:191], v[92:95]
    ds_read_b64_tr_b16 v[250:251], v67 offset:46304
    s_waitcnt lgkmcnt(8)
    v_mfma_f32_16x16x32_bf16 v[96:99], v[228:231], v[184:187], v[96:99]
    s_barrier
    ds_read_b64_tr_b16 v[224:225], v69 offset:8320
    v_mfma_f32_16x16x32_bf16 v[100:103], v[228:231], v[188:191], v[100:103]
    ds_read_b64_tr_b16 v[226:227], v69 offset:8832
    v_mfma_f32_16x16x32_bf16 v[104:107], v[232:235], v[184:187], v[104:107]
    ds_read_b64_tr_b16 v[228:229], v69 offset:8352
    v_mfma_f32_16x16x32_bf16 v[108:111], v[232:235], v[188:191], v[108:111]
    ds_read_b64_tr_b16 v[230:231], v69 offset:8864
    s_waitcnt lgkmcnt(8)
    v_mfma_f32_16x16x32_bf16 v[144:147], v[236:239], v[184:187], v[144:147]
    ds_read_b64_tr_b16 v[232:233], v68 offset:8320
    v_mfma_f32_16x16x32_bf16 v[148:151], v[236:239], v[188:191], v[148:151]
    ds_read_b64_tr_b16 v[234:235], v68 offset:8832
    v_mfma_f32_16x16x32_bf16 v[152:155], v[240:243], v[184:187], v[152:155]
    ds_read_b64_tr_b16 v[236:237], v68 offset:8352
    v_mfma_f32_16x16x32_bf16 v[156:159], v[240:243], v[188:191], v[156:159]
    ds_read_b64_tr_b16 v[238:239], v68 offset:8864
    s_waitcnt lgkmcnt(8)
    v_mfma_f32_16x16x32_bf16 v[160:163], v[244:247], v[184:187], v[160:163]
    ds_read_b64_tr_b16 v[240:241], v68
    v_mfma_f32_16x16x32_bf16 v[164:167], v[244:247], v[188:191], v[164:167]
    ds_read_b64_tr_b16 v[242:243], v68 offset:512
    v_mfma_f32_16x16x32_bf16 v[168:171], v[248:251], v[184:187], v[168:171]
    ds_read_b64_tr_b16 v[244:245], v68 offset:32
    v_mfma_f32_16x16x32_bf16 v[172:175], v[248:251], v[188:191], v[172:175]
    ds_read_b64_tr_b16 v[246:247], v68 offset:544
    s_waitcnt lgkmcnt(8)
    s_waitcnt vmcnt(6)
    v_mfma_f32_16x16x32_bf16 v[128:131], v[224:227], v[192:195], v[128:131]
    ds_read_b64_tr_b16 v[248:249], v69
    v_mfma_f32_16x16x32_bf16 v[132:135], v[224:227], v[196:199], v[132:135]
    ds_read_b64_tr_b16 v[250:251], v69 offset:512
    v_mfma_f32_16x16x32_bf16 v[136:139], v[228:231], v[192:195], v[136:139]
    ds_read_b64_tr_b16 v[224:225], v69 offset:32
    v_mfma_f32_16x16x32_bf16 v[140:143], v[228:231], v[196:199], v[140:143]
    ds_read_b64_tr_b16 v[226:227], v69 offset:544
    s_waitcnt lgkmcnt(8)
    v_mfma_f32_16x16x32_bf16 v[112:115], v[232:235], v[192:195], v[112:115]
    ds_read_b64_tr_b16 v[228:229], v68 offset:16640
    v_mfma_f32_16x16x32_bf16 v[116:119], v[232:235], v[196:199], v[116:119]
    ds_read_b64_tr_b16 v[230:231], v68 offset:17152
    v_mfma_f32_16x16x32_bf16 v[120:123], v[236:239], v[192:195], v[120:123]
    ds_read_b64_tr_b16 v[232:233], v68 offset:16672
    v_mfma_f32_16x16x32_bf16 v[124:127], v[236:239], v[196:199], v[124:127]
    ds_read_b64_tr_b16 v[234:235], v68 offset:17184
    s_waitcnt lgkmcnt(8)
    v_mfma_f32_16x16x32_bf16 v[80:83], v[240:243], v[192:195], v[80:83]
    ds_read_b64_tr_b16 v[236:237], v69 offset:16640
    v_mfma_f32_16x16x32_bf16 v[84:87], v[240:243], v[196:199], v[84:87]
    ds_read_b64_tr_b16 v[238:239], v69 offset:17152
    v_mfma_f32_16x16x32_bf16 v[88:91], v[244:247], v[192:195], v[88:91]
    ds_read_b64_tr_b16 v[240:241], v69 offset:16672
    v_mfma_f32_16x16x32_bf16 v[92:95], v[244:247], v[196:199], v[92:95]
    ds_read_b64_tr_b16 v[242:243], v69 offset:17184
    s_waitcnt lgkmcnt(8)
    v_mfma_f32_16x16x32_bf16 v[96:99], v[248:251], v[192:195], v[96:99]
    ds_read_b64_tr_b16 v[244:245], v69 offset:12480
    v_mfma_f32_16x16x32_bf16 v[100:103], v[248:251], v[196:199], v[100:103]
    ds_read_b64_tr_b16 v[246:247], v69 offset:12992
    v_mfma_f32_16x16x32_bf16 v[104:107], v[224:227], v[192:195], v[104:107]
    ds_read_b64_tr_b16 v[248:249], v69 offset:12512
    v_mfma_f32_16x16x32_bf16 v[108:111], v[224:227], v[196:199], v[108:111]
    ds_read_b64_tr_b16 v[250:251], v69 offset:13024
    s_waitcnt lgkmcnt(8)
    v_mfma_f32_16x16x32_bf16 v[144:147], v[228:231], v[192:195], v[144:147]
    ds_read_b64_tr_b16 v[224:225], v68 offset:12480
    v_mfma_f32_16x16x32_bf16 v[148:151], v[228:231], v[196:199], v[148:151]
    ds_read_b64_tr_b16 v[226:227], v68 offset:12992
    v_mfma_f32_16x16x32_bf16 v[152:155], v[232:235], v[192:195], v[152:155]
    ds_read_b64_tr_b16 v[228:229], v68 offset:12512
    v_mfma_f32_16x16x32_bf16 v[156:159], v[232:235], v[196:199], v[156:159]
    ds_read_b64_tr_b16 v[230:231], v68 offset:13024
    s_waitcnt lgkmcnt(8)
    v_mfma_f32_16x16x32_bf16 v[160:163], v[236:239], v[192:195], v[160:163]
    ds_read_b64_tr_b16 v[232:233], v68 offset:4160
    v_mfma_f32_16x16x32_bf16 v[164:167], v[236:239], v[196:199], v[164:167]
    ds_read_b64_tr_b16 v[234:235], v68 offset:4672
    v_mfma_f32_16x16x32_bf16 v[168:171], v[240:243], v[192:195], v[168:171]
    ds_read_b64_tr_b16 v[236:237], v68 offset:4192
    v_mfma_f32_16x16x32_bf16 v[172:175], v[240:243], v[196:199], v[172:175]
    ds_read_b64_tr_b16 v[238:239], v68 offset:4704
    s_waitcnt lgkmcnt(8)
    s_waitcnt vmcnt(4)
    v_mfma_f32_16x16x32_bf16 v[128:131], v[244:247], v[200:203], v[128:131]
    ds_read_b64_tr_b16 v[240:241], v69 offset:4160
    v_mfma_f32_16x16x32_bf16 v[132:135], v[244:247], v[204:207], v[132:135]
    ds_read_b64_tr_b16 v[242:243], v69 offset:4672
    v_mfma_f32_16x16x32_bf16 v[136:139], v[248:251], v[200:203], v[136:139]
    ds_read_b64_tr_b16 v[244:245], v69 offset:4192
    v_mfma_f32_16x16x32_bf16 v[140:143], v[248:251], v[204:207], v[140:143]
    ds_read_b64_tr_b16 v[246:247], v69 offset:4704
    s_waitcnt lgkmcnt(8)
    v_mfma_f32_16x16x32_bf16 v[112:115], v[224:227], v[200:203], v[112:115]
    ds_read_b64_tr_b16 v[248:249], v68 offset:20800
    v_mfma_f32_16x16x32_bf16 v[116:119], v[224:227], v[204:207], v[116:119]
    ds_read_b64_tr_b16 v[250:251], v68 offset:21312
    v_mfma_f32_16x16x32_bf16 v[120:123], v[228:231], v[200:203], v[120:123]
    ds_read_b64_tr_b16 v[224:225], v68 offset:20832
    v_mfma_f32_16x16x32_bf16 v[124:127], v[228:231], v[204:207], v[124:127]
    ds_read_b64_tr_b16 v[226:227], v68 offset:21344
    s_waitcnt lgkmcnt(8)
    v_mfma_f32_16x16x32_bf16 v[80:83], v[232:235], v[200:203], v[80:83]
    ds_read_b64_tr_b16 v[228:229], v69 offset:20800
    v_mfma_f32_16x16x32_bf16 v[84:87], v[232:235], v[204:207], v[84:87]
    ds_read_b64_tr_b16 v[230:231], v69 offset:21312
    v_mfma_f32_16x16x32_bf16 v[88:91], v[236:239], v[200:203], v[88:91]
    ds_read_b64_tr_b16 v[232:233], v69 offset:20832
    v_mfma_f32_16x16x32_bf16 v[92:95], v[236:239], v[204:207], v[92:95]
    ds_read_b64_tr_b16 v[234:235], v69 offset:21344
    s_waitcnt lgkmcnt(8)
    v_mfma_f32_16x16x32_bf16 v[96:99], v[240:243], v[200:203], v[96:99]
    ds_read_b64_tr_b16 v[236:237], v69 offset:33280
    v_mfma_f32_16x16x32_bf16 v[100:103], v[240:243], v[204:207], v[100:103]
    ds_read_b64_tr_b16 v[238:239], v69 offset:33792
    v_mfma_f32_16x16x32_bf16 v[104:107], v[244:247], v[200:203], v[104:107]
    ds_read_b64_tr_b16 v[240:241], v69 offset:33312
    v_mfma_f32_16x16x32_bf16 v[108:111], v[244:247], v[204:207], v[108:111]
    ds_read_b64_tr_b16 v[242:243], v69 offset:33824
    s_waitcnt lgkmcnt(8)
    v_mfma_f32_16x16x32_bf16 v[144:147], v[248:251], v[200:203], v[144:147]
    ds_read_b64_tr_b16 v[244:245], v68 offset:33280
    v_mfma_f32_16x16x32_bf16 v[148:151], v[248:251], v[204:207], v[148:151]
    ds_read_b64_tr_b16 v[246:247], v68 offset:33792
    v_mfma_f32_16x16x32_bf16 v[152:155], v[224:227], v[200:203], v[152:155]
    ds_read_b64_tr_b16 v[248:249], v68 offset:33312
    v_mfma_f32_16x16x32_bf16 v[156:159], v[224:227], v[204:207], v[156:159]
    ds_read_b64_tr_b16 v[250:251], v68 offset:33824
    s_waitcnt lgkmcnt(8)
    v_mfma_f32_16x16x32_bf16 v[160:163], v[228:231], v[200:203], v[160:163]
    ds_read_b64_tr_b16 v[224:225], v68 offset:24960
    v_mfma_f32_16x16x32_bf16 v[164:167], v[228:231], v[204:207], v[164:167]
    ds_read_b64_tr_b16 v[226:227], v68 offset:25472
    v_mfma_f32_16x16x32_bf16 v[168:171], v[232:235], v[200:203], v[168:171]
    ds_read_b64_tr_b16 v[228:229], v68 offset:24992
    v_mfma_f32_16x16x32_bf16 v[172:175], v[232:235], v[204:207], v[172:175]
    ds_read_b64_tr_b16 v[230:231], v68 offset:25504
    s_waitcnt lgkmcnt(8)
    s_waitcnt vmcnt(2)
    v_mfma_f32_16x16x32_bf16 v[128:131], v[236:239], v[208:211], v[128:131]
    ds_read_b64_tr_b16 v[232:233], v69 offset:24960
    v_mfma_f32_16x16x32_bf16 v[132:135], v[236:239], v[212:215], v[132:135]
    ds_read_b64_tr_b16 v[234:235], v69 offset:25472
    v_mfma_f32_16x16x32_bf16 v[136:139], v[240:243], v[208:211], v[136:139]
    ds_read_b64_tr_b16 v[236:237], v69 offset:24992
    v_mfma_f32_16x16x32_bf16 v[140:143], v[240:243], v[212:215], v[140:143]
    ds_read_b64_tr_b16 v[238:239], v69 offset:25504
    s_waitcnt lgkmcnt(8)
    v_mfma_f32_16x16x32_bf16 v[112:115], v[244:247], v[208:211], v[112:115]
    ds_read_b64_tr_b16 v[240:241], v68 offset:41600
    v_mfma_f32_16x16x32_bf16 v[116:119], v[244:247], v[212:215], v[116:119]
    ds_read_b64_tr_b16 v[242:243], v68 offset:42112
    v_mfma_f32_16x16x32_bf16 v[120:123], v[248:251], v[208:211], v[120:123]
    ds_read_b64_tr_b16 v[244:245], v68 offset:41632
    v_mfma_f32_16x16x32_bf16 v[124:127], v[248:251], v[212:215], v[124:127]
    ds_read_b64_tr_b16 v[246:247], v68 offset:42144
    s_waitcnt lgkmcnt(8)
    v_mfma_f32_16x16x32_bf16 v[80:83], v[224:227], v[208:211], v[80:83]
    ds_read_b64_tr_b16 v[248:249], v69 offset:41600
    v_mfma_f32_16x16x32_bf16 v[84:87], v[224:227], v[212:215], v[84:87]
    ds_read_b64_tr_b16 v[250:251], v69 offset:42112
    v_mfma_f32_16x16x32_bf16 v[88:91], v[228:231], v[208:211], v[88:91]
    ds_read_b64_tr_b16 v[224:225], v69 offset:41632
    v_mfma_f32_16x16x32_bf16 v[92:95], v[228:231], v[212:215], v[92:95]
    ds_read_b64_tr_b16 v[226:227], v69 offset:42144
    s_waitcnt lgkmcnt(8)
    v_mfma_f32_16x16x32_bf16 v[96:99], v[232:235], v[208:211], v[96:99]
    ds_read_b64_tr_b16 v[228:229], v69 offset:37440
    v_mfma_f32_16x16x32_bf16 v[100:103], v[232:235], v[212:215], v[100:103]
    ds_read_b64_tr_b16 v[230:231], v69 offset:37952
    v_mfma_f32_16x16x32_bf16 v[104:107], v[236:239], v[208:211], v[104:107]
    ds_read_b64_tr_b16 v[232:233], v69 offset:37472
    v_mfma_f32_16x16x32_bf16 v[108:111], v[236:239], v[212:215], v[108:111]
    ds_read_b64_tr_b16 v[234:235], v69 offset:37984
    s_waitcnt lgkmcnt(8)
    v_mfma_f32_16x16x32_bf16 v[144:147], v[240:243], v[208:211], v[144:147]
    ds_read_b64_tr_b16 v[236:237], v68 offset:37440
    v_mfma_f32_16x16x32_bf16 v[148:151], v[240:243], v[212:215], v[148:151]
    ds_read_b64_tr_b16 v[238:239], v68 offset:37952
    v_mfma_f32_16x16x32_bf16 v[152:155], v[244:247], v[208:211], v[152:155]
    ds_read_b64_tr_b16 v[240:241], v68 offset:37472
    v_mfma_f32_16x16x32_bf16 v[156:159], v[244:247], v[212:215], v[156:159]
    ds_read_b64_tr_b16 v[242:243], v68 offset:37984
    s_waitcnt lgkmcnt(8)
    v_mfma_f32_16x16x32_bf16 v[160:163], v[248:251], v[208:211], v[160:163]
    ds_read_b64_tr_b16 v[244:245], v68 offset:29120
    v_mfma_f32_16x16x32_bf16 v[164:167], v[248:251], v[212:215], v[164:167]
    ds_read_b64_tr_b16 v[246:247], v68 offset:29632
    v_mfma_f32_16x16x32_bf16 v[168:171], v[224:227], v[208:211], v[168:171]
    ds_read_b64_tr_b16 v[248:249], v68 offset:29152
    v_mfma_f32_16x16x32_bf16 v[172:175], v[224:227], v[212:215], v[172:175]
    ds_read_b64_tr_b16 v[250:251], v68 offset:29664
    s_waitcnt lgkmcnt(8)
    s_waitcnt vmcnt(0)
    v_mfma_f32_16x16x32_bf16 v[128:131], v[228:231], v[216:219], v[128:131]
    ds_read_b64_tr_b16 v[224:225], v69 offset:29120
    v_mfma_f32_16x16x32_bf16 v[132:135], v[228:231], v[220:223], v[132:135]
    ds_read_b64_tr_b16 v[226:227], v69 offset:29632
    v_mfma_f32_16x16x32_bf16 v[136:139], v[232:235], v[216:219], v[136:139]
    ds_read_b64_tr_b16 v[228:229], v69 offset:29152
    v_mfma_f32_16x16x32_bf16 v[140:143], v[232:235], v[220:223], v[140:143]
    ds_read_b64_tr_b16 v[230:231], v69 offset:29664
    s_waitcnt lgkmcnt(8)
    v_mfma_f32_16x16x32_bf16 v[112:115], v[236:239], v[216:219], v[112:115]
    ds_read_b64_tr_b16 v[232:233], v68 offset:45760
    v_mfma_f32_16x16x32_bf16 v[116:119], v[236:239], v[220:223], v[116:119]
    ds_read_b64_tr_b16 v[234:235], v68 offset:46272
    v_mfma_f32_16x16x32_bf16 v[120:123], v[240:243], v[216:219], v[120:123]
    ds_read_b64_tr_b16 v[236:237], v68 offset:45792
    v_mfma_f32_16x16x32_bf16 v[124:127], v[240:243], v[220:223], v[124:127]
    ds_read_b64_tr_b16 v[238:239], v68 offset:46304
    s_waitcnt lgkmcnt(8)
    v_mfma_f32_16x16x32_bf16 v[80:83], v[244:247], v[216:219], v[80:83]
    ds_read_b64_tr_b16 v[240:241], v69 offset:45760
    v_mfma_f32_16x16x32_bf16 v[84:87], v[244:247], v[220:223], v[84:87]
    ds_read_b64_tr_b16 v[242:243], v69 offset:46272
    v_mfma_f32_16x16x32_bf16 v[88:91], v[248:251], v[216:219], v[88:91]
    ds_read_b64_tr_b16 v[244:245], v69 offset:45792
    v_mfma_f32_16x16x32_bf16 v[92:95], v[248:251], v[220:223], v[92:95]
    ds_read_b64_tr_b16 v[246:247], v69 offset:46304
    s_waitcnt lgkmcnt(8)
    v_mfma_f32_16x16x32_bf16 v[96:99], v[224:227], v[216:219], v[96:99]
    v_mfma_f32_16x16x32_bf16 v[100:103], v[224:227], v[220:223], v[100:103]
    v_mfma_f32_16x16x32_bf16 v[104:107], v[228:231], v[216:219], v[104:107]
    v_mfma_f32_16x16x32_bf16 v[108:111], v[228:231], v[220:223], v[108:111]
    s_waitcnt lgkmcnt(4)
    v_mfma_f32_16x16x32_bf16 v[144:147], v[232:235], v[216:219], v[144:147]
    v_mfma_f32_16x16x32_bf16 v[148:151], v[232:235], v[220:223], v[148:151]
    v_mfma_f32_16x16x32_bf16 v[152:155], v[236:239], v[216:219], v[152:155]
    v_mfma_f32_16x16x32_bf16 v[156:159], v[236:239], v[220:223], v[156:159]
    s_waitcnt lgkmcnt(0)
    v_mfma_f32_16x16x32_bf16 v[160:163], v[240:243], v[216:219], v[160:163]
    v_mfma_f32_16x16x32_bf16 v[164:167], v[240:243], v[220:223], v[164:167]
    v_mfma_f32_16x16x32_bf16 v[168:171], v[244:247], v[216:219], v[168:171]
    v_mfma_f32_16x16x32_bf16 v[172:175], v[244:247], v[220:223], v[172:175]
    v_cvt_pk_bf16_f32 v52, v128, v129
    v_cvt_pk_bf16_f32 v53, v130, v131
    v_cvt_pk_bf16_f32 v54, v132, v133
    v_cvt_pk_bf16_f32 v55, v134, v135
    v_cvt_pk_bf16_f32 v56, v136, v137
    v_cvt_pk_bf16_f32 v57, v138, v139
    v_cvt_pk_bf16_f32 v58, v140, v141
    v_cvt_pk_bf16_f32 v59, v142, v143
    ds_write_b64 v77, v[52:53]
    ds_write_b64 v77, v[54:55] offset:256
    ds_write_b64 v77, v[56:57] offset:1024
    ds_write_b64 v77, v[58:59] offset:1280
    v_cvt_pk_bf16_f32 v36, v112, v113
    v_cvt_pk_bf16_f32 v37, v114, v115
    v_cvt_pk_bf16_f32 v38, v116, v117
    v_cvt_pk_bf16_f32 v39, v118, v119
    v_cvt_pk_bf16_f32 v40, v120, v121
    v_cvt_pk_bf16_f32 v41, v122, v123
    v_cvt_pk_bf16_f32 v42, v124, v125
    v_cvt_pk_bf16_f32 v43, v126, v127
    v_permlane16_swap_b32 v36, v38
    v_permlane16_swap_b32 v37, v39
    v_permlane16_swap_b32 v40, v42
    v_permlane16_swap_b32 v41, v43
    s_waitcnt lgkmcnt(0)
    s_barrier
    s_setprio 0
    v_mfma_f32_32x32x16_bf16 v[112:127], v[28:31], v[36:39], 0
    v_mfma_f32_32x32x16_bf16 v[112:127], v[32:35], v[40:43], v[112:127]
    v_cvt_pk_bf16_f32 v52, v144, v145
    v_cvt_pk_bf16_f32 v53, v146, v147
    v_cvt_pk_bf16_f32 v54, v148, v149
    v_cvt_pk_bf16_f32 v55, v150, v151
    v_cvt_pk_bf16_f32 v56, v152, v153
    v_cvt_pk_bf16_f32 v57, v154, v155
    v_cvt_pk_bf16_f32 v58, v156, v157
    v_cvt_pk_bf16_f32 v59, v158, v159
    ds_write_b64 v78, v[52:53]
    ds_write_b64 v78, v[54:55] offset:512
    ds_write_b64 v78, v[56:57] offset:4096
    ds_write_b64 v78, v[58:59] offset:4608
    v_cvt_pk_bf16_f32 v44, v160, v161
    v_cvt_pk_bf16_f32 v45, v162, v163
    v_cvt_pk_bf16_f32 v46, v164, v165
    v_cvt_pk_bf16_f32 v47, v166, v167
    v_cvt_pk_bf16_f32 v48, v168, v169
    v_cvt_pk_bf16_f32 v49, v170, v171
    v_cvt_pk_bf16_f32 v50, v172, v173
    v_cvt_pk_bf16_f32 v51, v174, v175
    ds_write_b64 v78, v[44:45] offset:8192
    ds_write_b64 v78, v[46:47] offset:8704
    ds_write_b64 v78, v[48:49] offset:12288
    ds_write_b64 v78, v[50:51] offset:12800
    v_cvt_pk_bf16_f32 v36, v96, v97
    v_cvt_pk_bf16_f32 v37, v98, v99
    v_cvt_pk_bf16_f32 v38, v100, v101
    v_cvt_pk_bf16_f32 v39, v102, v103
    v_cvt_pk_bf16_f32 v40, v104, v105
    v_cvt_pk_bf16_f32 v41, v106, v107
    v_cvt_pk_bf16_f32 v42, v108, v109
    v_cvt_pk_bf16_f32 v43, v110, v111
    ds_write_b64 v77, v[36:37] offset:2048
    ds_write_b64 v77, v[38:39] offset:2304
    ds_write_b64 v77, v[40:41] offset:3072
    ds_write_b64 v77, v[42:43] offset:3328
    v_cvt_pk_bf16_f32 v44, v80, v81
    v_cvt_pk_bf16_f32 v45, v82, v83
    v_cvt_pk_bf16_f32 v46, v84, v85
    v_cvt_pk_bf16_f32 v47, v86, v87
    v_cvt_pk_bf16_f32 v48, v88, v89
    v_cvt_pk_bf16_f32 v49, v90, v91
    v_cvt_pk_bf16_f32 v50, v92, v93
    v_cvt_pk_bf16_f32 v51, v94, v95
    v_permlane16_swap_b32 v44, v46
    v_permlane16_swap_b32 v45, v47
    v_permlane16_swap_b32 v48, v50
    v_permlane16_swap_b32 v49, v51
    s_branch L_JOIN
L_HELP:
    s_add_u32 s96, s85, 5
    s_and_b32 s97, s96, 15
    s_lshl3_add_u32 s98, s97, s3
    s_sub_u32 s99, s98, 4
    s_mul_i32 s96, s99, 49152
    s_lshl_b32 s97, s11, 7
    s_add_u32 s82, s96, s97
    s_sub_u32 s96, s3, 4
    s_lshr_b32 s97, s96, 1
    s_mul_i32 s98, s97, 2080
    s_sub_u32 s99, s3, 4
    s_and_b32 s96, s99, 1
    s_mul_i32 s97, s96, 1056
    s_add_u32 s99, s98, s97
    s_add_u32 s20, s99, 124800
    s_mov_b32 m0, s20
    s_nop 0
    buffer_load_dwordx4 v62, s[40:43], s82 offen lds
    s_add_u32 s82, s82, 2048
    s_add_u32 m0, s20, 8320
    s_nop 0
    buffer_load_dwordx4 v62, s[40:43], s82 offen lds
    s_add_u32 s82, s82, 2048
    s_add_u32 m0, s20, 16640
    s_nop 0
    buffer_load_dwordx4 v62, s[40:43], s82 offen lds
    s_add_u32 s96, s85, 5
    s_and_b32 s97, s96, 15
    s_lshl3_add_u32 s98, s97, s3
    s_mul_i32 s99, s98, 49152
    s_lshl_b32 s96, s11, 7
    s_add_u32 s82, s99, s96
    s_lshr_b32 s96, s3, 1
    s_mul_i32 s97, s96, 2080
    s_and_b32 s98, s3, 1
    s_mul_i32 s99, s98, 1056
    s_add_u32 s96, s97, s99
    s_add_u32 s20, s96, 124800
    s_mov_b32 m0, s20
    s_nop 0
    buffer_load_dwordx4 v62, s[40:43], s82 offen lds
    s_add_u32 s82, s82, 2048
    s_add_u32 m0, s20, 8320
    s_nop 0
    buffer_load_dwordx4 v62, s[40:43], s82 offen lds
    s_add_u32 s82, s82, 2048
    s_add_u32 m0, s20, 16640
    s_nop 0
    buffer_load_dwordx4 v62, s[40:43], s82 offen lds
    s_and_b32 s96, s9, 3
    s_lshl2_add_u32 s97, s96, s3
    s_sub_u32 s98, s97, 4
    s_lshl_b32 s13, s98, 7
    v_lshrrev_b32 v61, 3, v1
    v_lshl_add_u32 v61, v61, 4, s13
    v_lshrrev_b32 v60, 3, v1
    v_mul_u32_u24 v60, 98304, v60
    v_and_b32 v9, 7, v1
    v_lshl_add_u32 v60, v9, 4, v60
    s_mul_i32 s96, s13, 6144
    s_bfe_u32 s97, s9, 131074
    s_lshl_b32 s98, s8, 1
    s_lshl4_add_u32 s99, s97, s98
    s_lshr_b32 s97, s9, 4
    s_add_u32 s98, s99, s97
    s_lshl_b32 s99, s98, 7
    s_add_u32 s97, s96, s99
    s_add_u32 s17, s97, 4096
    global_load_dwordx4 v[120:123], v61, s[86:87]
    s_waitcnt vmcnt(13)
    s_barrier
    buffer_load_dwordx4 v[80:83], v60, s[48:51], s17 offen nt
    s_add_u32 s17, s17, 12288
    buffer_load_dwordx4 v[84:87], v60, s[48:51], s17 offen nt
    s_add_u32 s17, s17, 12288
    s_waitcnt lgkmcnt(0)
    s_load_dword s24, s[32:33], s92 offset:512 glc
    s_load_dword s25, s[32:33], s92 offset:256 glc
    s_load_dword s26, s[32:33], s92 offset:1024 glc
    s_load_dword s27, s[32:33], s92 offset:768 glc
    s_waitcnt vmcnt(12)
    s_barrier
    s_add_u32 s96, s85, 6
    s_and_b32 s97, s96, 15
    s_lshl3_add_u32 s98, s97, s3
    s_sub_u32 s99, s98, 4
    s_mul_i32 s96, s99, 49152
    s_lshl_b32 s97, s11, 7
    s_add_u32 s82, s96, s97
    s_sub_u32 s96, s3, 4
    s_lshr_b32 s97, s96, 1
    s_mul_i32 s98, s97, 2080
    s_sub_u32 s99, s3, 4
    s_and_b32 s96, s99, 1
    s_mul_i32 s97, s96, 1056
    s_add_u32 s20, s98, s97
    s_mov_b32 m0, s20
    s_nop 0
    buffer_load_dwordx4 v62, s[40:43], s82 offen lds
    s_add_u32 s82, s82, 2048
    s_add_u32 m0, s20, 8320
    s_nop 0
    buffer_load_dwordx4 v62, s[40:43], s82 offen lds
    s_add_u32 s82, s82, 2048
    s_add_u32 m0, s20, 16640
    s_nop 0
    buffer_load_dwordx4 v62, s[40:43], s82 offen lds
    s_add_u32 s96, s85, 6
    s_and_b32 s97, s96, 15
    s_lshl3_add_u32 s98, s97, s3
    s_mul_i32 s99, s98, 49152
    s_lshl_b32 s96, s11, 7
    s_add_u32 s82, s99, s96
    s_lshr_b32 s96, s3, 1
    s_mul_i32 s97, s96, 2080
    s_and_b32 s98, s3, 1
    s_mul_i32 s99, s98, 1056
    s_add_u32 s20, s97, s99
    s_mov_b32 m0, s20
    s_nop 0
    buffer_load_dwordx4 v62, s[40:43], s82 offen lds
    s_add_u32 s82, s82, 2048
    s_add_u32 m0, s20, 8320
    s_nop 0
    buffer_load_dwordx4 v62, s[40:43], s82 offen lds
    s_add_u32 s82, s82, 2048
    s_add_u32 m0, s20, 16640
    s_nop 0
    buffer_load_dwordx4 v62, s[40:43], s82 offen lds
    s_waitcnt vmcnt(8)
    v_lshlrev_b32 v112, 16, v120
    v_mul_f32 v4, s7, v112
    v_exp_f32 v4, -v4
    s_nop 0
    v_add_f32 v4, 1.0, v4
    v_rcp_f32 v4, v4
    s_nop 0
    v_mul_f32 v112, v112, v4
    v_cvt_pk_bf16_f32 v112, 0, v112
    v_and_b32 v113, s6, v120
    v_mul_f32 v5, s7, v113
    v_exp_f32 v5, -v5
    s_nop 0
    v_add_f32 v5, 1.0, v5
    v_rcp_f32 v5, v5
    s_nop 0
    v_mul_f32 v113, v113, v5
    v_cvt_pk_bf16_f32 v113, 0, v113
    v_lshlrev_b32 v114, 16, v121
    v_mul_f32 v4, s7, v114
    v_exp_f32 v4, -v4
    s_nop 0
    v_add_f32 v4, 1.0, v4
    v_rcp_f32 v4, v4
    s_nop 0
    v_mul_f32 v114, v114, v4
    v_cvt_pk_bf16_f32 v114, 0, v114
    v_and_b32 v115, s6, v121
    v_mul_f32 v5, s7, v115
    v_exp_f32 v5, -v5
    s_nop 0
    v_add_f32 v5, 1.0, v5
    v_rcp_f32 v5, v5
    s_nop 0
    v_mul_f32 v115, v115, v5
    v_cvt_pk_bf16_f32 v115, 0, v115
    s_barrier
    s_add_u32 s96, s85, 7
    s_and_b32 s97, s96, 15
    s_lshl3_add_u32 s98, s97, s3
    s_sub_u32 s99, s98, 4
    s_mul_i32 s96, s99, 49152
    s_lshl_b32 s97, s11, 7
    s_add_u32 s82, s96, s97
    s_sub_u32 s96, s3, 4
    s_lshr_b32 s97, s96, 1
    s_mul_i32 s98, s97, 2080
    s_sub_u32 s99, s3, 4
    s_and_b32 s96, s99, 1
    s_mul_i32 s97, s96, 1056
    s_add_u32 s99, s98, s97
    s_add_u32 s20, s99, 24960
    s_mov_b32 m0, s20
    s_nop 0
    buffer_load_dwordx4 v62, s[40:43], s82 offen lds
    s_add_u32 s82, s82, 2048
    s_add_u32 m0, s20, 8320
    s_nop 0
    buffer_load_dwordx4 v62, s[40:43], s82 offen lds
    s_add_u32 s82, s82, 2048
    s_add_u32 m0, s20, 16640
    s_nop 0
    buffer_load_dwordx4 v62, s[40:43], s82 offen lds
    buffer_load_dwordx4 v[88:91], v60, s[48:51], s17 offen nt
    s_add_u32 s17, s17, 12288
    buffer_load_dwordx4 v[92:95], v60, s[48:51], s17 offen nt
    s_add_u32 s17, s17, 12288
    v_lshlrev_b32 v116, 16, v122
    v_mul_f32 v4, s7, v116
    v_exp_f32 v4, -v4
    s_nop 0
    v_add_f32 v4, 1.0, v4
    v_rcp_f32 v4, v4
    s_nop 0
    v_mul_f32 v116, v116, v4
    v_cvt_pk_bf16_f32 v116, 0, v116
    v_and_b32 v117, s6, v122
    v_mul_f32 v5, s7, v117
    v_exp_f32 v5, -v5
    s_nop 0
    v_add_f32 v5, 1.0, v5
    v_rcp_f32 v5, v5
    s_nop 0
    v_mul_f32 v117, v117, v5
    v_cvt_pk_bf16_f32 v117, 0, v117
    v_lshlrev_b32 v118, 16, v123
    v_mul_f32 v4, s7, v118
    v_exp_f32 v4, -v4
    s_nop 0
    v_add_f32 v4, 1.0, v4
    v_rcp_f32 v4, v4
    s_nop 0
    v_mul_f32 v118, v118, v4
    v_cvt_pk_bf16_f32 v118, 0, v118
    v_and_b32 v119, s6, v123
    v_mul_f32 v5, s7, v119
    v_exp_f32 v5, -v5
    s_nop 0
    v_add_f32 v5, 1.0, v5
    v_rcp_f32 v5, v5
    s_nop 0
    v_mul_f32 v119, v119, v5
    v_cvt_pk_bf16_f32 v119, 0, v119
    s_barrier
    s_add_u32 s96, s85, 7
    s_and_b32 s97, s96, 15
    s_lshl3_add_u32 s98, s97, s3
    s_mul_i32 s99, s98, 49152
    s_lshl_b32 s96, s11, 7
    s_add_u32 s82, s99, s96
    s_lshr_b32 s96, s3, 1
    s_mul_i32 s97, s96, 2080
    s_and_b32 s98, s3, 1
    s_mul_i32 s99, s98, 1056
    s_add_u32 s96, s97, s99
    s_add_u32 s20, s96, 24960
    s_mov_b32 m0, s20
    s_nop 0
    buffer_load_dwordx4 v62, s[40:43], s82 offen lds
    s_add_u32 s82, s82, 2048
    s_add_u32 m0, s20, 8320
    s_nop 0
    buffer_load_dwordx4 v62, s[40:43], s82 offen lds
    s_add_u32 s82, s82, 2048
    s_add_u32 m0, s20, 16640
    s_nop 0
    buffer_load_dwordx4 v62, s[40:43], s82 offen lds
    s_add_u32 s96, s85, 8
    s_and_b32 s97, s96, 15
    s_lshl3_add_u32 s98, s97, s3
    s_sub_u32 s99, s98, 4
    s_mul_i32 s96, s99, 49152
    s_lshl_b32 s97, s11, 7
    s_add_u32 s82, s96, s97
    s_sub_u32 s96, s3, 4
    s_lshr_b32 s97, s96, 1
    s_mul_i32 s98, s97, 2080
    s_sub_u32 s99, s3, 4
    s_and_b32 s96, s99, 1
    s_mul_i32 s97, s96, 1056
    s_add_u32 s99, s98, s97
    s_add_u32 s20, s99, 49920
    s_mov_b32 m0, s20
    s_nop 0
    buffer_load_dwordx4 v62, s[40:43], s82 offen lds
    s_add_u32 s82, s82, 2048
    s_add_u32 m0, s20, 8320
    s_nop 0
    buffer_load_dwordx4 v62, s[40:43], s82 offen lds
    s_add_u32 s82, s82, 2048
    s_add_u32 m0, s20, 16640
    s_nop 0
    buffer_load_dwordx4 v62, s[40:43], s82 offen lds
    s_waitcnt lgkmcnt(0)
    s_load_dword s24, s[32:33], s92 offset:1536 glc
    s_load_dword s25, s[32:33], s92 offset:1280 glc
    s_load_dword s26, s[32:33], s92 offset:2048 glc
    s_load_dword s27, s[32:33], s92 offset:1792 glc
    s_waitcnt vmcnt(18)
    v_lshlrev_b32 v4, 16, v80
    v_and_b32 v5, s6, v80
    v_mul_f32 v20, v4, v112
    v_mul_f32 v21, v5, v112
    v_lshlrev_b32 v6, 16, v81
    v_and_b32 v7, s6, v81
    v_mul_f32 v22, v6, v112
    v_mul_f32 v23, v7, v112
    v_lshlrev_b32 v4, 16, v82
    v_and_b32 v5, s6, v82
    v_mul_f32 v24, v4, v112
    v_mul_f32 v25, v5, v112
    v_lshlrev_b32 v6, 16, v83
    v_and_b32 v7, s6, v83
    v_mul_f32 v26, v6, v112
    v_mul_f32 v27, v7, v112
    s_barrier
    s_add_u32 s96, s85, 8
    s_and_b32 s97, s96, 15
    s_lshl3_add_u32 s98, s97, s3
    s_mul_i32 s99, s98, 49152
    s_lshl_b32 s96, s11, 7
    s_add_u32 s82, s99, s96
    s_lshr_b32 s96, s3, 1
    s_mul_i32 s97, s96, 2080
    s_and_b32 s98, s3, 1
    s_mul_i32 s99, s98, 1056
    s_add_u32 s96, s97, s99
    s_add_u32 s20, s96, 49920
    s_mov_b32 m0, s20
    s_nop 0
    buffer_load_dwordx4 v62, s[40:43], s82 offen lds
    s_add_u32 s82, s82, 2048
    s_add_u32 m0, s20, 8320
    s_nop 0
    buffer_load_dwordx4 v62, s[40:43], s82 offen lds
    s_add_u32 s82, s82, 2048
    s_add_u32 m0, s20, 16640
    s_nop 0
    buffer_load_dwordx4 v62, s[40:43], s82 offen lds
    buffer_load_dwordx4 v[96:99], v60, s[48:51], s17 offen nt
    s_add_u32 s17, s17, 12288
    buffer_load_dwordx4 v[100:103], v60, s[48:51], s17 offen nt
    s_add_u32 s17, s17, 12288
    s_waitcnt vmcnt(22)
    v_lshlrev_b32 v4, 16, v84
    v_and_b32 v5, s6, v84
    v_fmac_f32 v20, v4, v113
    v_fmac_f32 v21, v5, v113
    v_lshlrev_b32 v6, 16, v85
    v_and_b32 v7, s6, v85
    v_fmac_f32 v22, v6, v113
    v_fmac_f32 v23, v7, v113
    v_lshlrev_b32 v4, 16, v86
    v_and_b32 v5, s6, v86
    v_fmac_f32 v24, v4, v113
    v_fmac_f32 v25, v5, v113
    v_lshlrev_b32 v6, 16, v87
    v_and_b32 v7, s6, v87
    v_fmac_f32 v26, v6, v113
    v_fmac_f32 v27, v7, v113
    s_waitcnt vmcnt(16)
    s_barrier
    s_add_u32 s96, s85, 9
    s_and_b32 s97, s96, 15
    s_lshl3_add_u32 s98, s97, s3
    s_sub_u32 s99, s98, 4
    s_mul_i32 s96, s99, 49152
    s_lshl_b32 s97, s11, 7
    s_add_u32 s82, s96, s97
    s_sub_u32 s96, s3, 4
    s_lshr_b32 s97, s96, 1
    s_mul_i32 s98, s97, 2080
    s_sub_u32 s99, s3, 4
    s_and_b32 s96, s99, 1
    s_mul_i32 s97, s96, 1056
    s_add_u32 s99, s98, s97
    s_add_u32 s20, s99, 74880
    s_mov_b32 m0, s20
    s_nop 0
    buffer_load_dwordx4 v62, s[40:43], s82 offen lds
    s_add_u32 s82, s82, 2048
    s_add_u32 m0, s20, 8320
    s_nop 0
    buffer_load_dwordx4 v62, s[40:43], s82 offen lds
    s_add_u32 s82, s82, 2048
    s_add_u32 m0, s20, 16640
    s_nop 0
    buffer_load_dwordx4 v62, s[40:43], s82 offen lds
    s_add_u32 s96, s85, 9
    s_and_b32 s97, s96, 15
    s_lshl3_add_u32 s98, s97, s3
    s_mul_i32 s99, s98, 49152
    s_lshl_b32 s96, s11, 7
    s_add_u32 s82, s99, s96
    s_lshr_b32 s96, s3, 1
    s_mul_i32 s97, s96, 2080
    s_and_b32 s98, s3, 1
    s_mul_i32 s99, s98, 1056
    s_add_u32 s96, s97, s99
    s_add_u32 s20, s96, 74880
    s_mov_b32 m0, s20
    s_nop 0
    buffer_load_dwordx4 v62, s[40:43], s82 offen lds
    s_add_u32 s82, s82, 2048
    s_add_u32 m0, s20, 8320
    s_nop 0
    buffer_load_dwordx4 v62, s[40:43], s82 offen lds
    s_add_u32 s82, s82, 2048
    s_add_u32 m0, s20, 16640
    s_nop 0
    buffer_load_dwordx4 v62, s[40:43], s82 offen lds
    s_waitcnt vmcnt(18)
    v_lshlrev_b32 v4, 16, v88
    v_and_b32 v5, s6, v88
    v_fmac_f32 v20, v4, v114
    v_fmac_f32 v21, v5, v114
    v_lshlrev_b32 v6, 16, v89
    v_and_b32 v7, s6, v89
    v_fmac_f32 v22, v6, v114
    v_fmac_f32 v23, v7, v114
    v_lshlrev_b32 v4, 16, v90
    v_and_b32 v5, s6, v90
    v_fmac_f32 v24, v4, v114
    v_fmac_f32 v25, v5, v114
    v_lshlrev_b32 v6, 16, v91
    v_and_b32 v7, s6, v91
    v_fmac_f32 v26, v6, v114
    v_fmac_f32 v27, v7, v114
    s_waitcnt vmcnt(14)
    s_barrier
    s_add_u32 s96, s85, 10
    s_and_b32 s97, s96, 15
    s_lshl3_add_u32 s98, s97, s3
    s_sub_u32 s99, s98, 4
    s_mul_i32 s96, s99, 49152
    s_lshl_b32 s97, s11, 7
    s_add_u32 s82, s96, s97
    s_sub_u32 s96, s3, 4
    s_lshr_b32 s97, s96, 1
    s_mul_i32 s98, s97, 2080
    s_sub_u32 s99, s3, 4
    s_and_b32 s96, s99, 1
    s_mul_i32 s97, s96, 1056
    s_add_u32 s99, s98, s97
    s_add_u32 s20, s99, 99840
    s_mov_b32 m0, s20
    s_nop 0
    buffer_load_dwordx4 v62, s[40:43], s82 offen lds
    s_add_u32 s82, s82, 2048
    s_add_u32 m0, s20, 8320
    s_nop 0
    buffer_load_dwordx4 v62, s[40:43], s82 offen lds
    s_add_u32 s82, s82, 2048
    s_add_u32 m0, s20, 16640
    s_nop 0
    buffer_load_dwordx4 v62, s[40:43], s82 offen lds
    buffer_load_dwordx4 v[104:107], v60, s[48:51], s17 offen nt
    s_add_u32 s17, s17, 12288
    buffer_load_dwordx4 v[108:111], v60, s[48:51], s17 offen nt
    s_lshl2_add_u32 s96, s74, s75
    s_lshl_b32 s97, s96, 11
    s_and_b32 s98, s3, 1
    s_lshl_b32 s99, s98, 10
    s_add_u32 s96, s97, s99
    s_add_u32 s13, s96, 20971520
    s_lshl4_add_u32 s96, s21, s12
    s_lshl_b32 s97, s96, 11
    s_and_b32 s98, s3, 1
    s_lshl_b32 s99, s98, 10
    s_add_u32 s96, s97, s99
    s_add_u32 s14, s96, 12582912
    buffer_load_dwordx4 v[124:127], v2, s[32:35], s13 offen
    v_lshlrev_b32 v4, 16, v92
    v_and_b32 v5, s6, v92
    v_fmac_f32 v20, v4, v115
    v_fmac_f32 v21, v5, v115
    v_lshlrev_b32 v6, 16, v93
    v_and_b32 v7, s6, v93
    v_fmac_f32 v22, v6, v115
    v_fmac_f32 v23, v7, v115
    v_lshlrev_b32 v4, 16, v94
    v_and_b32 v5, s6, v94
    v_fmac_f32 v24, v4, v115
    v_fmac_f32 v25, v5, v115
    v_lshlrev_b32 v6, 16, v95
    v_and_b32 v7, s6, v95
    v_fmac_f32 v26, v6, v115
    v_fmac_f32 v27, v7, v115
    s_waitcnt lgkmcnt(0)
    s_load_dword s24, s[32:33], s92 offset:2560 glc
    s_load_dword s25, s[32:33], s92 offset:2304 glc
    s_load_dword s26, s[32:33], s92 offset:3072 glc
    s_load_dword s27, s[32:33], s92 offset:2816 glc
    s_load_dword s28, s[32:33], s92 offset:3584 glc
    s_load_dword s29, s[32:33], s92 offset:3328 glc
    s_waitcnt vmcnt(14)
    s_barrier
    s_add_u32 s96, s85, 10
    s_and_b32 s97, s96, 15
    s_lshl3_add_u32 s98, s97, s3
    s_mul_i32 s99, s98, 49152
    s_lshl_b32 s96, s11, 7
    s_add_u32 s82, s99, s96
    s_lshr_b32 s96, s3, 1
    s_mul_i32 s97, s96, 2080
    s_and_b32 s98, s3, 1
    s_mul_i32 s99, s98, 1056
    s_add_u32 s96, s97, s99
    s_add_u32 s20, s96, 99840
    s_mov_b32 m0, s20
    s_nop 0
    buffer_load_dwordx4 v62, s[40:43], s82 offen lds
    s_add_u32 s82, s82, 2048
    s_add_u32 m0, s20, 8320
    s_nop 0
    buffer_load_dwordx4 v62, s[40:43], s82 offen lds
    s_add_u32 s82, s82, 2048
    s_add_u32 m0, s20, 16640
    s_nop 0
    buffer_load_dwordx4 v62, s[40:43], s82 offen lds
    s_add_u32 s96, s85, 11
    s_and_b32 s97, s96, 15
    s_lshl3_add_u32 s98, s97, s3
    s_sub_u32 s99, s98, 4
    s_mul_i32 s96, s99, 49152
    s_lshl_b32 s97, s11, 7
    s_add_u32 s82, s96, s97
    s_sub_u32 s96, s3, 4
    s_lshr_b32 s97, s96, 1
    s_mul_i32 s98, s97, 2080
    s_sub_u32 s99, s3, 4
    s_and_b32 s96, s99, 1
    s_mul_i32 s97, s96, 1056
    s_add_u32 s99, s98, s97
    s_add_u32 s20, s99, 124800
    s_mov_b32 m0, s20
    s_nop 0
    buffer_load_dwordx4 v62, s[40:43], s82 offen lds
    s_add_u32 s82, s82, 2048
    s_add_u32 m0, s20, 8320
    s_nop 0
    buffer_load_dwordx4 v62, s[40:43], s82 offen lds
    s_add_u32 s82, s82, 2048
    s_add_u32 m0, s20, 16640
    s_nop 0
    buffer_load_dwordx4 v62, s[40:43], s82 offen lds
    s_waitcnt vmcnt(19)
    v_lshlrev_b32 v4, 16, v96
    v_and_b32 v5, s6, v96
    v_fmac_f32 v20, v4, v116
    v_fmac_f32 v21, v5, v116
    v_lshlrev_b32 v6, 16, v97
    v_and_b32 v7, s6, v97
    v_fmac_f32 v22, v6, v116
    v_fmac_f32 v23, v7, v116
    v_lshlrev_b32 v4, 16, v98
    v_and_b32 v5, s6, v98
    v_fmac_f32 v24, v4, v116
    v_fmac_f32 v25, v5, v116
    v_lshlrev_b32 v6, 16, v99
    v_and_b32 v7, s6, v99
    v_fmac_f32 v26, v6, v116
    v_fmac_f32 v27, v7, v116
    s_waitcnt vmcnt(18)
    v_lshlrev_b32 v4, 16, v100
    v_and_b32 v5, s6, v100
    v_fmac_f32 v20, v4, v117
    v_fmac_f32 v21, v5, v117
    v_lshlrev_b32 v6, 16, v101
    v_and_b32 v7, s6, v101
    v_fmac_f32 v22, v6, v117
    v_fmac_f32 v23, v7, v117
    v_lshlrev_b32 v4, 16, v102
    v_and_b32 v5, s6, v102
    v_fmac_f32 v24, v4, v117
    v_fmac_f32 v25, v5, v117
    v_lshlrev_b32 v6, 16, v103
    v_and_b32 v7, s6, v103
    v_fmac_f32 v26, v6, v117
    v_fmac_f32 v27, v7, v117
    s_waitcnt vmcnt(12)
    s_barrier
    s_add_u32 s96, s85, 11
    s_and_b32 s97, s96, 15
    s_lshl3_add_u32 s98, s97, s3
    s_mul_i32 s99, s98, 49152
    s_lshl_b32 s96, s11, 7
    s_add_u32 s82, s99, s96
    s_lshr_b32 s96, s3, 1
    s_mul_i32 s97, s96, 2080
    s_and_b32 s98, s3, 1
    s_mul_i32 s99, s98, 1056
    s_add_u32 s96, s97, s99
    s_add_u32 s20, s96, 124800
    s_mov_b32 m0, s20
    s_nop 0
    buffer_load_dwordx4 v62, s[40:43], s82 offen lds
    s_add_u32 s82, s82, 2048
    s_add_u32 m0, s20, 8320
    s_nop 0
    buffer_load_dwordx4 v62, s[40:43], s82 offen lds
    s_add_u32 s82, s82, 2048
    s_add_u32 m0, s20, 16640
    s_nop 0
    buffer_load_dwordx4 v62, s[40:43], s82 offen lds
    s_add_u32 s96, s85, 12
    s_and_b32 s97, s96, 15
    s_lshl3_add_u32 s98, s97, s3
    s_sub_u32 s99, s98, 4
    s_mul_i32 s96, s99, 49152
    s_lshl_b32 s97, s11, 7
    s_add_u32 s82, s96, s97
    s_sub_u32 s96, s3, 4
    s_lshr_b32 s97, s96, 1
    s_mul_i32 s98, s97, 2080
    s_sub_u32 s99, s3, 4
    s_and_b32 s96, s99, 1
    s_mul_i32 s97, s96, 1056
    s_add_u32 s20, s98, s97
    s_mov_b32 m0, s20
    s_nop 0
    buffer_load_dwordx4 v62, s[40:43], s82 offen lds
    s_add_u32 s82, s82, 2048
    s_add_u32 m0, s20, 8320
    s_nop 0
    buffer_load_dwordx4 v62, s[40:43], s82 offen lds
    s_add_u32 s82, s82, 2048
    s_add_u32 m0, s20, 16640
    s_nop 0
    buffer_load_dwordx4 v62, s[40:43], s82 offen lds
    s_waitcnt vmcnt(14)
    v_lshlrev_b32 v4, 16, v104
    v_and_b32 v5, s6, v104
    v_fmac_f32 v20, v4, v118
    v_fmac_f32 v21, v5, v118
    v_lshlrev_b32 v6, 16, v105
    v_and_b32 v7, s6, v105
    v_fmac_f32 v22, v6, v118
    v_fmac_f32 v23, v7, v118
    v_lshlrev_b32 v4, 16, v106
    v_and_b32 v5, s6, v106
    v_fmac_f32 v24, v4, v118
    v_fmac_f32 v25, v5, v118
    v_lshlrev_b32 v6, 16, v107
    v_and_b32 v7, s6, v107
    v_fmac_f32 v26, v6, v118
    v_fmac_f32 v27, v7, v118
    s_waitcnt vmcnt(13)
    v_lshlrev_b32 v4, 16, v108
    v_and_b32 v5, s6, v108
    v_fmac_f32 v20, v4, v119
    v_fmac_f32 v21, v5, v119
    v_lshlrev_b32 v6, 16, v109
    v_and_b32 v7, s6, v109
    v_fmac_f32 v22, v6, v119
    v_fmac_f32 v23, v7, v119
    v_lshlrev_b32 v4, 16, v110
    v_and_b32 v5, s6, v110
    v_fmac_f32 v24, v4, v119
    v_fmac_f32 v25, v5, v119
    v_lshlrev_b32 v6, 16, v111
    v_and_b32 v7, s6, v111
    v_fmac_f32 v26, v6, v119
    v_fmac_f32 v27, v7, v119
    v_permlane32_swap_b32 v20, v24
    v_permlane32_swap_b32 v21, v25
    v_permlane32_swap_b32 v22, v26
    v_permlane32_swap_b32 v23, v27
    v_add_f32 v20, v20, v24
    v_add_f32 v21, v21, v25
    v_add_f32 v22, v22, v26
    v_add_f32 v23, v23, v27
    s_nop 0
    v_permlane16_swap_b32 v20, v22
    v_permlane16_swap_b32 v21, v23
    v_add_f32 v20, v20, v22
    v_add_f32 v21, v21, v23
    s_nop 0
    v_add_f32_dpp v20, v20, v20 row_ror:8 row_mask:0xf bank_mask:0xf
    v_add_f32_dpp v21, v21, v21 row_ror:8 row_mask:0xf bank_mask:0xf
    s_nop 1
    v_mov_b32_dpp v20, v21 quad_perm:[0,1,2,3] row_mask:0xf bank_mask:0xc
    ds_write_b32 v65, v20 offset:1024
    s_waitcnt lgkmcnt(0)
    s_waitcnt vmcnt(9)
    s_barrier
    s_add_u32 s96, s85, 12
    s_and_b32 s97, s96, 15
    s_lshl3_add_u32 s98, s97, s3
    s_mul_i32 s99, s98, 49152
    s_lshl_b32 s96, s11, 7
    s_add_u32 s82, s99, s96
    s_lshr_b32 s96, s3, 1
    s_mul_i32 s97, s96, 2080
    s_and_b32 s98, s3, 1
    s_mul_i32 s99, s98, 1056
    s_add_u32 s20, s97, s99
    s_mov_b32 m0, s20
    s_nop 0
    buffer_load_dwordx4 v62, s[40:43], s82 offen lds
    s_add_u32 s82, s82, 2048
    s_add_u32 m0, s20, 8320
    s_nop 0
    buffer_load_dwordx4 v62, s[40:43], s82 offen lds
    s_add_u32 s82, s82, 2048
    s_add_u32 m0, s20, 16640
    s_nop 0
    buffer_load_dwordx4 v62, s[40:43], s82 offen lds
    s_add_u32 s96, s85, 13
    s_and_b32 s97, s96, 15
    s_lshl3_add_u32 s98, s97, s3
    s_sub_u32 s99, s98, 4
    s_mul_i32 s96, s99, 49152
    s_lshl_b32 s97, s11, 7
    s_add_u32 s82, s96, s97
    s_sub_u32 s96, s3, 4
    s_lshr_b32 s97, s96, 1
    s_mul_i32 s98, s97, 2080
    s_sub_u32 s99, s3, 4
    s_and_b32 s96, s99, 1
    s_mul_i32 s97, s96, 1056
    s_add_u32 s99, s98, s97
    s_add_u32 s20, s99, 24960
    s_mov_b32 m0, s20
    s_nop 0
    buffer_load_dwordx4 v62, s[40:43], s82 offen lds
    s_add_u32 s82, s82, 2048
    s_add_u32 m0, s20, 8320
    s_nop 0
    buffer_load_dwordx4 v62, s[40:43], s82 offen lds
    s_add_u32 s82, s82, 2048
    s_add_u32 m0, s20, 16640
    s_nop 0
    buffer_load_dwordx4 v62, s[40:43], s82 offen lds
    s_cmp_lg_u32 s3, 4
    s_cbranch_scc1 L_M2F
    ds_read_b128 v[20:23], v64 offset:1024
    s_bfe_u32 s96, s9, 131074
    s_lshl_b32 s97, s8, 1
    s_lshl4_add_u32 s98, s96, s97
    s_lshr_b32 s99, s9, 4
    s_add_u32 s96, s98, s99
    s_and_b32 s97, s9, 3
    s_lshl2_add_u32 s98, s96, s97
    s_lshl_b32 s99, s98, 9
    s_add_u32 s13, s99, 131072
    s_waitcnt lgkmcnt(0)
    v_add_f32 v20, v20, v21
    v_add_f32 v22, v22, v23
    v_mov_b32 v21, s4
    v_add_f32 v20, v20, v22
    buffer_store_dwordx2 v[20:21], v63, s[32:35], s13 offen sc1
L_M2F:
    s_waitcnt vmcnt(9)
    s_barrier
    s_add_u32 s96, s85, 13
    s_and_b32 s97, s96, 15
    s_lshl3_add_u32 s98, s97, s3
    s_mul_i32 s99, s98, 49152
    s_lshl_b32 s96, s11, 7
    s_add_u32 s82, s99, s96
    s_lshr_b32 s96, s3, 1
    s_mul_i32 s97, s96, 2080
    s_and_b32 s98, s3, 1
    s_mul_i32 s99, s98, 1056
    s_add_u32 s96, s97, s99
    s_add_u32 s20, s96, 24960
    s_mov_b32 m0, s20
    s_nop 0
    buffer_load_dwordx4 v62, s[40:43], s82 offen lds
    s_add_u32 s82, s82, 2048
    s_add_u32 m0, s20, 8320
    s_nop 0
    buffer_load_dwordx4 v62, s[40:43], s82 offen lds
    s_add_u32 s82, s82, 2048
    s_add_u32 m0, s20, 16640
    s_nop 0
    buffer_load_dwordx4 v62, s[40:43], s82 offen lds
    s_add_u32 s96, s85, 14
    s_and_b32 s97, s96, 15
    s_lshl3_add_u32 s98, s97, s3
    s_sub_u32 s99, s98, 4
    s_mul_i32 s96, s99, 49152
    s_lshl_b32 s97, s11, 7
    s_add_u32 s82, s96, s97
    s_sub_u32 s96, s3, 4
    s_lshr_b32 s97, s96, 1
    s_mul_i32 s98, s97, 2080
    s_sub_u32 s99, s3, 4
    s_and_b32 s96, s99, 1
    s_mul_i32 s97, s96, 1056
    s_add_u32 s99, s98, s97
    s_add_u32 s20, s99, 49920
    s_mov_b32 m0, s20
    s_nop 0
    buffer_load_dwordx4 v62, s[40:43], s82 offen lds
    s_add_u32 s82, s82, 2048
    s_add_u32 m0, s20, 8320
    s_nop 0
    buffer_load_dwordx4 v62, s[40:43], s82 offen lds
    s_add_u32 s82, s82, 2048
    s_add_u32 m0, s20, 16640
    s_nop 0
    buffer_load_dwordx4 v62, s[40:43], s82 offen lds
    s_waitcnt vmcnt(9)
    s_barrier
    s_add_u32 s96, s85, 14
    s_and_b32 s97, s96, 15
    s_lshl3_add_u32 s98, s97, s3
    s_mul_i32 s99, s98, 49152
    s_lshl_b32 s96, s11, 7
    s_add_u32 s82, s99, s96
    s_lshr_b32 s96, s3, 1
    s_mul_i32 s97, s96, 2080
    s_and_b32 s98, s3, 1
    s_mul_i32 s99, s98, 1056
    s_add_u32 s96, s97, s99
    s_add_u32 s20, s96, 49920
    s_mov_b32 m0, s20
    s_nop 0
    buffer_load_dwordx4 v62, s[40:43], s82 offen lds
    s_add_u32 s82, s82, 2048
    s_add_u32 m0, s20, 8320
    s_nop 0
    buffer_load_dwordx4 v62, s[40:43], s82 offen lds
    s_add_u32 s82, s82, 2048
    s_add_u32 m0, s20, 16640
    s_nop 0
    buffer_load_dwordx4 v62, s[40:43], s82 offen lds
    s_add_u32 s96, s85, 15
    s_and_b32 s97, s96, 15
    s_lshl3_add_u32 s98, s97, s3
    s_sub_u32 s99, s98, 4
    s_mul_i32 s96, s99, 49152
    s_lshl_b32 s97, s11, 7
    s_add_u32 s82, s96, s97
    s_sub_u32 s96, s3, 4
    s_lshr_b32 s97, s96, 1
    s_mul_i32 s98, s97, 2080
    s_sub_u32 s99, s3, 4
    s_and_b32 s96, s99, 1
    s_mul_i32 s97, s96, 1056
    s_add_u32 s99, s98, s97
    s_add_u32 s20, s99, 74880
    s_mov_b32 m0, s20
    s_nop 0
    buffer_load_dwordx4 v62, s[40:43], s82 offen lds
    s_add_u32 s82, s82, 2048
    s_add_u32 m0, s20, 8320
    s_nop 0
    buffer_load_dwordx4 v62, s[40:43], s82 offen lds
    s_add_u32 s82, s82, 2048
    s_add_u32 m0, s20, 16640
    s_nop 0
    buffer_load_dwordx4 v62, s[40:43], s82 offen lds
    s_waitcnt vmcnt(9)
    s_barrier
    s_add_u32 s96, s85, 15
    s_and_b32 s97, s96, 15
    s_lshl3_add_u32 s98, s97, s3
    s_mul_i32 s99, s98, 49152
    s_lshl_b32 s96, s11, 7
    s_add_u32 s82, s99, s96
    s_lshr_b32 s96, s3, 1
    s_mul_i32 s97, s96, 2080
    s_and_b32 s98, s3, 1
    s_mul_i32 s99, s98, 1056
    s_add_u32 s96, s97, s99
    s_add_u32 s20, s96, 74880
    s_mov_b32 m0, s20
    s_nop 0
    buffer_load_dwordx4 v62, s[40:43], s82 offen lds
    s_add_u32 s82, s82, 2048
    s_add_u32 m0, s20, 8320
    s_nop 0
    buffer_load_dwordx4 v62, s[40:43], s82 offen lds
    s_add_u32 s82, s82, 2048
    s_add_u32 m0, s20, 16640
    s_nop 0
    buffer_load_dwordx4 v62, s[40:43], s82 offen lds
    v_and_b32 v89, 31, v1
    v_lshlrev_b32 v89, 4, v89
    v_lshrrev_b32 v9, 5, v1
    v_lshl_add_u32 v89, v9, 9, v89
    s_and_b32 s96, s3, 3
    s_lshl4_add_u32 s97, s96, s12
    s_lshl_b32 s98, s97, 11
    s_add_u32 s18, s98, 131072
    s_lshl_b32 s13, s12, 7
    v_and_b32 v4, 31, v1
    v_lshl_add_u32 v4, v4, 2, s13
    global_load_dword v88, v4, s[78:79]
    buffer_load_dwordx4 v[80:83], v89, s[32:35], s18 offen sc1
    buffer_load_dwordx4 v[84:87], v89, s[32:35], s18 offen offset:1024 sc1
    s_barrier
    s_waitcnt vmcnt(9)
    s_waitcnt vmcnt(3)
    s_barrier
    s_lshl4_add_u32 s96, s11, s10
    s_lshl_b32 s97, s96, 10
    s_and_b32 s98, s3, 3
    s_lshl_b32 s99, s98, 8
    s_add_u32 s96, s97, s99
    s_add_u32 s13, s96, 29360128
    s_lshl_b32 s96, s11, 7
    s_add_u32 s14, s96, 32768
    v_lshlrev_b32 v60, 7, v1
    s_mov_b64 exec, 3
    buffer_load_dword v60, v60, s[32:35], s13 offen
    buffer_load_dword v61, v3, s[32:35], s14 offen
    s_mov_b64 exec, -1
    s_add_u32 s96, s84, 1114112
    s_and_b32 s97, s96, 1048575
    s_lshl_b32 s98, s83, 16
    s_xor_b32 s99, s97, s98
    s_xor_b32 s96, s88, 1048576
    s_add_u32 s13, s99, s96
    s_add_u32 m0, s89, 102400
    s_nop 0
    buffer_load_dwordx4 v74, s[44:47], s13 offen lds
    s_add_u32 s96, s84, 1179648
    s_and_b32 s97, s96, 1048575
    s_lshl_b32 s98, s83, 16
    s_xor_b32 s99, s97, s98
    s_xor_b32 s96, s88, 1048576
    s_add_u32 s13, s99, s96
    s_add_u32 m0, s89, 106496
    s_nop 0
    buffer_load_dwordx4 v74, s[44:47], s13 offen lds
    s_add_u32 s96, s84, 1245184
    s_and_b32 s97, s96, 1048575
    s_lshl_b32 s98, s83, 16
    s_xor_b32 s99, s97, s98
    s_xor_b32 s96, s88, 1048576
    s_add_u32 s13, s99, s96
    s_add_u32 m0, s89, 110592
    s_nop 0
    buffer_load_dwordx4 v74, s[44:47], s13 offen lds
    s_add_u32 s96, s84, 1310720
    s_and_b32 s97, s96, 1048575
    s_lshl_b32 s98, s83, 16
    s_xor_b32 s99, s97, s98
    s_xor_b32 s96, s88, 1048576
    s_add_u32 s13, s99, s96
    s_add_u32 m0, s89, 114688
    s_nop 0
    buffer_load_dwordx4 v74, s[44:47], s13 offen lds
    s_add_u32 s96, s84, 1376256
    s_and_b32 s97, s96, 1048575
    s_lshl_b32 s98, s83, 16
    s_xor_b32 s99, s97, s98
    s_xor_b32 s96, s88, 1048576
    s_add_u32 s13, s99, s96
    s_add_u32 m0, s89, 118784
    s_nop 0
    buffer_load_dwordx4 v74, s[44:47], s13 offen lds
    s_add_u32 s96, s84, 1441792
    s_and_b32 s97, s96, 1048575
    s_lshl_b32 s98, s83, 16
    s_xor_b32 s99, s97, s98
    s_xor_b32 s96, s88, 1048576
    s_add_u32 s13, s99, s96
    s_add_u32 m0, s89, 122880
    s_nop 0
    buffer_load_dwordx4 v74, s[44:47], s13 offen lds
    s_add_u32 s96, s84, 1507328
    s_and_b32 s97, s96, 1048575
    s_lshl_b32 s98, s83, 16
    s_xor_b32 s99, s97, s98
    s_xor_b32 s96, s88, 1048576
    s_add_u32 s13, s99, s96
    s_add_u32 m0, s89, 126976
    s_nop 0
    buffer_load_dwordx4 v74, s[44:47], s13 offen lds
    s_add_u32 s96, s84, 1572864
    s_and_b32 s97, s96, 1048575
    s_lshl_b32 s98, s83, 16
    s_xor_b32 s99, s97, s98
    s_xor_b32 s96, s88, 1048576
    s_add_u32 s13, s99, s96
    s_add_u32 m0, s89, 131072
    s_nop 0
    buffer_load_dwordx4 v74, s[44:47], s13 offen lds
    s_mov_b32 s13, s80
    buffer_load_dwordx4 v[176:179], v72, s[52:55], s13 offen nt
    s_add_u32 s13, s80, 4294049792
    buffer_load_dwordx4 v[180:183], v72, s[52:55], s13 offen nt
    s_add_u32 s13, s80, 57344
    buffer_load_dwordx4 v[184:187], v72, s[52:55], s13 offen nt
    s_add_u32 s13, s80, 4294107136
    buffer_load_dwordx4 v[188:191], v72, s[52:55], s13 offen nt
    s_add_u32 s13, s80, 114688
    buffer_load_dwordx4 v[192:195], v72, s[52:55], s13 offen nt
    s_add_u32 s13, s80, 4294164480
    buffer_load_dwordx4 v[196:199], v72, s[52:55], s13 offen nt
    s_add_u32 s13, s80, 172032
    buffer_load_dwordx4 v[200:203], v72, s[52:55], s13 offen nt
    s_add_u32 s13, s80, 4294221824
    buffer_load_dwordx4 v[204:207], v72, s[52:55], s13 offen nt
    s_waitcnt vmcnt(18)
    v_bitop3_b32 v4, v81, v83, s4 bitop3:0x7e
    v_bitop3_b32 v4, v4, v85, s4 bitop3:0xf6
    v_bitop3_b32 v4, v4, v87, s4 bitop3:0xf6
    v_cmp_ne_u32 vcc, 0, v4
    s_cbranch_vccz TOK_14
POLL_15:
    buffer_load_dwordx4 v[80:83], v89, s[32:35], s18 offen sc1
    buffer_load_dwordx4 v[84:87], v89, s[32:35], s18 offen offset:1024 sc1
    s_waitcnt vmcnt(0)
    v_bitop3_b32 v4, v81, v83, s4 bitop3:0x7e
    v_bitop3_b32 v4, v4, v85, s4 bitop3:0xf6
    v_bitop3_b32 v4, v4, v87, s4 bitop3:0xf6
    v_cmp_ne_u32 vcc, 0, v4
    s_cbranch_vccz PDONE_16
    s_add_u32 s5, s5, 1
    s_cmp_lt_u32 s5, 300000
    s_cbranch_scc1 POLL_15
PDONE_16:
TOK_14:
    s_and_b32 s96, s3, 3
    s_lshl_b32 s97, s96, 7
    s_add_u32 s13, s97, 139264
    v_and_b32 v4, 31, v1
    v_lshl_add_u32 v4, v4, 2, s13
    s_and_b32 s14, s3, 3
    v_add_f32 v80, v80, v84
    v_add_f32 v81, v82, v86
    v_mov_b32 v82, v80
    v_mov_b32 v83, v81
    s_cmp_eq_u32 s14, 2
    s_cselect_b32 s15, 1.0, 0
    v_permlane32_swap_b32 v80, v82
    v_permlane32_swap_b32 v81, v83
    v_pk_add_f32 v[80:81], v[80:81], v[82:83]
    v_cvt_pk_bf16_f32 v80, 0, v80
    v_cvt_pk_bf16_f32 v81, 0, v81
    v_add_f32 v80, s15, v80
    v_add_f32 v81, s15, v81
    v_cvt_pk_bf16_f32 v82, v80, v81
    ds_write_b32 v4, v82
    s_cbranch_scc0 L_NOG
    v_lshlrev_b32 v80, 16, v82
    v_and_b32 v81, s6, v82
    v_lshlrev_b32 v84, 16, v88
    v_and_b32 v85, s6, v88
    v_pk_mul_f32 v[84:85], v[84:85], v[80:81]
    v_cvt_pk_bf16_f32 v86, v84, v85
    v_lshlrev_b32 v80, 16, v86
    v_and_b32 v81, s6, v86
    v_pk_add_f32 v[80:81], v[84:85], v[80:81] neg_lo:[0,1] neg_hi:[0,1]
    v_cvt_pk_bf16_f32 v87, v80, v81
    v_add_f32 v80, v84, v85
    ds_write2_b32 v4, v86, v87 offset0:64 offset1:96
    ds_write_b32 v4, v88 offset:512
    v_add_f32_dpp v80, v80, v80 quad_perm:[1,0,3,2] row_mask:0xf bank_mask:0xf
    s_nop 1
    v_add_f32_dpp v80, v80, v80 quad_perm:[2,3,0,1] row_mask:0xf bank_mask:0xf
    s_nop 1
    v_add_f32_dpp v80, v80, v80 row_half_mirror row_mask:0xf bank_mask:0xf
    s_nop 1
    v_add_f32_dpp v80, v80, v80 row_ror:8 row_mask:0xf bank_mask:0xf
    s_lshl4_add_u32 s96, s21, s12
    s_lshl3_add_u32 s13, s96, 65536
    v_mov_b32 v82, v80
    v_mov_b32 v81, s4
    s_nop 0
    v_permlane16_swap_b32 v80, v82
    v_add_f32 v80, v80, v82
    s_mov_b64 exec, 1
    buffer_store_dwordx2 v[80:81], v3, s[32:35], s13 offen sc1
    s_mov_b64 exec, -1
L_NOG:
    s_waitcnt lgkmcnt(0)
    s_barrier
    ds_read_b128 v[36:39], v76
    ds_read_b128 v[40:43], v76 offset:1024
    s_waitcnt lgkmcnt(0)
    v_mfma_f32_32x32x16_bf16 v[112:127], v[28:31], v[36:39], 0
    v_mfma_f32_32x32x16_bf16 v[112:127], v[32:35], v[40:43], v[112:127]
    s_mov_b32 s13, s80
    buffer_load_dwordx4 v[208:211], v72, s[56:59], s13 offen nt
    s_add_u32 s13, s80, 4294049792
    buffer_load_dwordx4 v[212:215], v72, s[56:59], s13 offen nt
    s_add_u32 s13, s80, 57344
    buffer_load_dwordx4 v[216:219], v72, s[56:59], s13 offen nt
    s_add_u32 s13, s80, 4294107136
    buffer_load_dwordx4 v[220:223], v72, s[56:59], s13 offen nt
L_JOIN:
    s_nop 3
    v_cvt_pk_bf16_f32 v112, 0, v112
    v_cvt_pk_bf16_f32 v113, 0, v113
    v_cvt_pk_bf16_f32 v114, 0, v114
    v_cvt_pk_bf16_f32 v115, 0, v115
    v_cvt_pk_bf16_f32 v116, 0, v116
    v_cvt_pk_bf16_f32 v117, 0, v117
    v_cvt_pk_bf16_f32 v118, 0, v118
    v_cvt_pk_bf16_f32 v119, 0, v119
    v_cvt_pk_bf16_f32 v120, 0, v120
    v_cvt_pk_bf16_f32 v121, 0, v121
    v_cvt_pk_bf16_f32 v122, 0, v122
    v_cvt_pk_bf16_f32 v123, 0, v123
    v_cvt_pk_bf16_f32 v124, 0, v124
    v_cvt_pk_bf16_f32 v125, 0, v125
    v_cvt_pk_bf16_f32 v126, 0, v126
    v_cvt_pk_bf16_f32 v127, 0, v127
    v_max3_f32 v4, v112, v113, v114
    v_min3_f32 v5, v112, v113, v114
    v_max3_f32 v4, v4, v115, v116
    v_min3_f32 v5, v5, v115, v116
    v_max3_f32 v4, v4, v117, v118
    v_min3_f32 v5, v5, v117, v118
    v_max3_f32 v4, v4, v119, v120
    v_min3_f32 v5, v5, v119, v120
    v_max3_f32 v4, v4, v121, v122
    v_min3_f32 v5, v5, v121, v122
    v_max3_f32 v4, v4, v123, v124
    v_min3_f32 v5, v5, v123, v124
    v_max3_f32 v4, v4, v125, v126
    v_min3_f32 v5, v5, v125, v126
    v_max_f32 v6, v4, v127
    v_min_f32 v7, v5, v127
    v_max_f32 v4, v4, v127
    v_min_f32 v5, v5, v127
    s_nop 0
    v_permlane32_swap_b32 v4, v6
    v_permlane32_swap_b32 v5, v7
    v_max_f32 v4, v4, v6
    v_min_f32 v5, v5, v7
    v_pk_mul_f32 v[4:5], v[4:5], s[6:7] op_sel:[0,1]
    v_pk_fma_f32 v[128:129], v[112:113], s[6:7], v[4:5] op_sel:[0,1,0] op_sel_hi:[1,1,0] neg_lo:[0,0,1] neg_hi:[0,0,1]
    v_pk_fma_f32 v[112:113], v[112:113], s[6:7], v[4:5] op_sel:[0,1,1] neg_lo:[1,0,0] neg_hi:[1,0,0]
    v_pk_fma_f32 v[130:131], v[114:115], s[6:7], v[4:5] op_sel:[0,1,0] op_sel_hi:[1,1,0] neg_lo:[0,0,1] neg_hi:[0,0,1]
    v_pk_fma_f32 v[114:115], v[114:115], s[6:7], v[4:5] op_sel:[0,1,1] neg_lo:[1,0,0] neg_hi:[1,0,0]
    v_pk_fma_f32 v[132:133], v[116:117], s[6:7], v[4:5] op_sel:[0,1,0] op_sel_hi:[1,1,0] neg_lo:[0,0,1] neg_hi:[0,0,1]
    v_pk_fma_f32 v[116:117], v[116:117], s[6:7], v[4:5] op_sel:[0,1,1] neg_lo:[1,0,0] neg_hi:[1,0,0]
    v_pk_fma_f32 v[134:135], v[118:119], s[6:7], v[4:5] op_sel:[0,1,0] op_sel_hi:[1,1,0] neg_lo:[0,0,1] neg_hi:[0,0,1]
    v_pk_fma_f32 v[118:119], v[118:119], s[6:7], v[4:5] op_sel:[0,1,1] neg_lo:[1,0,0] neg_hi:[1,0,0]
    v_pk_fma_f32 v[136:137], v[120:121], s[6:7], v[4:5] op_sel:[0,1,0] op_sel_hi:[1,1,0] neg_lo:[0,0,1] neg_hi:[0,0,1]
    v_pk_fma_f32 v[120:121], v[120:121], s[6:7], v[4:5] op_sel:[0,1,1] neg_lo:[1,0,0] neg_hi:[1,0,0]
    v_pk_fma_f32 v[138:139], v[122:123], s[6:7], v[4:5] op_sel:[0,1,0] op_sel_hi:[1,1,0] neg_lo:[0,0,1] neg_hi:[0,0,1]
    v_pk_fma_f32 v[122:123], v[122:123], s[6:7], v[4:5] op_sel:[0,1,1] neg_lo:[1,0,0] neg_hi:[1,0,0]
    v_pk_fma_f32 v[140:141], v[124:125], s[6:7], v[4:5] op_sel:[0,1,0] op_sel_hi:[1,1,0] neg_lo:[0,0,1] neg_hi:[0,0,1]
    v_pk_fma_f32 v[124:125], v[124:125], s[6:7], v[4:5] op_sel:[0,1,1] neg_lo:[1,0,0] neg_hi:[1,0,0]
    v_pk_fma_f32 v[142:143], v[126:127], s[6:7], v[4:5] op_sel:[0,1,0] op_sel_hi:[1,1,0] neg_lo:[0,0,1] neg_hi:[0,0,1]
    v_pk_fma_f32 v[126:127], v[126:127], s[6:7], v[4:5] op_sel:[0,1,1] neg_lo:[1,0,0] neg_hi:[1,0,0]
    v_exp_f32 v128, v128
    v_exp_f32 v112, v112
    v_exp_f32 v129, v129
    v_exp_f32 v113, v113
    v_exp_f32 v130, v130
    v_exp_f32 v114, v114
    v_exp_f32 v131, v131
    v_exp_f32 v115, v115
    v_exp_f32 v132, v132
    v_exp_f32 v116, v116
    v_exp_f32 v133, v133
    v_exp_f32 v117, v117
    v_exp_f32 v134, v134
    v_exp_f32 v118, v118
    v_exp_f32 v135, v135
    v_exp_f32 v119, v119
    v_exp_f32 v136, v136
    v_exp_f32 v120, v120
    v_exp_f32 v137, v137
    v_exp_f32 v121, v121
    v_exp_f32 v138, v138
    v_exp_f32 v122, v122
    v_exp_f32 v139, v139
    v_exp_f32 v123, v123
    v_exp_f32 v140, v140
    v_exp_f32 v124, v124
    v_exp_f32 v141, v141
    v_exp_f32 v125, v125
    v_exp_f32 v142, v142
    v_exp_f32 v126, v126
    v_exp_f32 v143, v143
    v_exp_f32 v127, v127
    v_pk_add_f32 v[8:9], v[128:129], v[130:131]
    v_pk_add_f32 v[10:11], v[112:113], v[114:115]
    v_pk_add_f32 v[8:9], v[8:9], v[132:133]
    v_pk_add_f32 v[10:11], v[10:11], v[116:117]
    v_pk_add_f32 v[8:9], v[8:9], v[134:135]
    v_pk_add_f32 v[10:11], v[10:11], v[118:119]
    v_pk_add_f32 v[8:9], v[8:9], v[136:137]
    v_pk_add_f32 v[10:11], v[10:11], v[120:121]
    v_pk_add_f32 v[8:9], v[8:9], v[138:139]
    v_pk_add_f32 v[10:11], v[10:11], v[122:123]
    v_pk_add_f32 v[8:9], v[8:9], v[140:141]
    v_pk_add_f32 v[10:11], v[10:11], v[124:125]
    v_pk_add_f32 v[8:9], v[8:9], v[142:143]
    v_pk_add_f32 v[10:11], v[10:11], v[126:127]
    v_add_f32 v6, v8, v9
    v_add_f32 v7, v10, v11
    v_add_f32 v4, v8, v9
    v_add_f32 v5, v10, v11
    s_nop 0
    v_permlane32_swap_b32 v4, v6
    v_permlane32_swap_b32 v5, v7
    v_pk_add_f32 v[4:5], v[4:5], v[6:7]
    v_rcp_f32 v4, v4
    v_rcp_f32 v5, v5
    s_nop 0
    v_pk_mul_f32 v[128:129], v[128:129], v[4:5] op_sel_hi:[1,0]
    v_pk_mul_f32 v[112:113], v[112:113], v[4:5] op_sel:[0,1]
    v_pk_mul_f32 v[130:131], v[130:131], v[4:5] op_sel_hi:[1,0]
    v_pk_mul_f32 v[114:115], v[114:115], v[4:5] op_sel:[0,1]
    v_pk_mul_f32 v[132:133], v[132:133], v[4:5] op_sel_hi:[1,0]
    v_pk_mul_f32 v[116:117], v[116:117], v[4:5] op_sel:[0,1]
    v_pk_mul_f32 v[134:135], v[134:135], v[4:5] op_sel_hi:[1,0]
    v_pk_mul_f32 v[118:119], v[118:119], v[4:5] op_sel:[0,1]
    v_pk_mul_f32 v[136:137], v[136:137], v[4:5] op_sel_hi:[1,0]
    v_pk_mul_f32 v[120:121], v[120:121], v[4:5] op_sel:[0,1]
    v_pk_mul_f32 v[138:139], v[138:139], v[4:5] op_sel_hi:[1,0]
    v_pk_mul_f32 v[122:123], v[122:123], v[4:5] op_sel:[0,1]
    v_pk_mul_f32 v[140:141], v[140:141], v[4:5] op_sel_hi:[1,0]
    v_pk_mul_f32 v[124:125], v[124:125], v[4:5] op_sel:[0,1]
    v_pk_mul_f32 v[142:143], v[142:143], v[4:5] op_sel_hi:[1,0]
    v_pk_mul_f32 v[126:127], v[126:127], v[4:5] op_sel:[0,1]
    v_cvt_pk_bf16_f32 v80, v128, v129
    v_cvt_pk_bf16_f32 v88, v112, v113
    v_cvt_pk_bf16_f32 v81, v130, v131
    v_cvt_pk_bf16_f32 v89, v114, v115
    v_cvt_pk_bf16_f32 v82, v132, v133
    v_cvt_pk_bf16_f32 v90, v116, v117
    v_cvt_pk_bf16_f32 v83, v134, v135
    v_cvt_pk_bf16_f32 v91, v118, v119
    v_cvt_pk_bf16_f32 v84, v136, v137
    v_cvt_pk_bf16_f32 v92, v120, v121
    v_cvt_pk_bf16_f32 v85, v138, v139
    v_cvt_pk_bf16_f32 v93, v122, v123
    v_cvt_pk_bf16_f32 v86, v140, v141
    v_cvt_pk_bf16_f32 v94, v124, v125
    v_cvt_pk_bf16_f32 v87, v142, v143
    v_cvt_pk_bf16_f32 v95, v126, v127
    ds_write_b128 v75, v[80:83]
    ds_write_b128 v75, v[84:87] offset:4096
    ds_write_b128 v75, v[88:91] offset:8192
    ds_write_b128 v75, v[92:95] offset:12288
    s_lshl_b32 s13, s3, 12
    v_add_u32 v20, s13, v63
    s_lshl_b32 s96, s76, 13
    s_add_u32 s13, s96, 32768
    v_add_u32 v21, s13, v63
    v_mov_b32 v36, 0x3f803f80
    v_mov_b32 v37, 0x3f803f80
    v_mov_b32 v38, 0x3f803f80
    v_mov_b32 v39, 0x3f803f80
    s_lshl3_add_u32 s96, s11, s3
    s_lshl_b32 s97, s96, 5
    s_add_u32 s98, s97, s10
    s_lshl_b32 s99, s98, 10
    s_add_u32 s13, s99, 25165824
    s_add_u32 s15, s13, 16384
    s_lshl3_add_u32 s96, s11, s3
    s_lshl_b32 s97, s96, 10
    s_add_u32 s16, s97, 21495808
    s_lshl_b32 s96, s10, 6
    s_add_u32 s14, s96, s16
    s_waitcnt lgkmcnt(0)
    s_barrier
    s_lshl_b32 s96, s76, 6
    s_add_u32 s18, s96, 139264
    v_and_b32 v67, 7, v1
    v_lshl_add_u32 v67, v67, 2, s18
    v_lshrrev_b32 v9, 5, v1
    v_lshl_add_u32 v67, v9, 5, v67
    ds_read_b32 v64, v67
    ds_read_b32 v65, v67 offset:512
    ds_read_b32 v66, v67 offset:640
    ds_read_b32 v68, v67 offset:128
    ds_read_b32 v69, v67 offset:256
    ds_read_b32 v70, v67 offset:384
    ds_read_b32 v71, v67 offset:768
    ds_read_b64_tr_b16 v[128:129], v20
    ds_read_b64_tr_b16 v[130:131], v20 offset:512
    ds_read_b64_tr_b16 v[144:145], v21
    ds_read_b64_tr_b16 v[146:147], v21 offset:512
    ds_read_b64_tr_b16 v[148:149], v21 offset:4096
    ds_read_b64_tr_b16 v[150:151], v21 offset:4608
    ds_read_b64_tr_b16 v[132:133], v20 offset:1024
    ds_read_b64_tr_b16 v[134:135], v20 offset:1536
    ds_read_b64_tr_b16 v[152:153], v21 offset:1024
    ds_read_b64_tr_b16 v[154:155], v21 offset:1536
    ds_read_b64_tr_b16 v[156:157], v21 offset:5120
    ds_read_b64_tr_b16 v[158:159], v21 offset:5632
    ds_read_b64_tr_b16 v[136:137], v20 offset:2048
    ds_read_b64_tr_b16 v[138:139], v20 offset:2560
    ds_read_b64_tr_b16 v[160:161], v21 offset:2048
    ds_read_b64_tr_b16 v[162:163], v21 offset:2560
    ds_read_b64_tr_b16 v[164:165], v21 offset:6144
    ds_read_b64_tr_b16 v[166:167], v21 offset:6656
    s_waitcnt lgkmcnt(12)
    v_mfma_f32_16x16x32_bf16 v[52:55], v[128:131], v[144:147], 0
    v_mfma_f32_16x16x32_bf16 v[56:59], v[128:131], v[148:151], 0
    v_mfma_f32_16x16x32_bf16 v[40:43], v[128:131], v[36:39], 0
    ds_read_b64_tr_b16 v[140:141], v20 offset:3072
    ds_read_b64_tr_b16 v[142:143], v20 offset:3584
    ds_read_b64_tr_b16 v[168:169], v21 offset:3072
    ds_read_b64_tr_b16 v[170:171], v21 offset:3584
    ds_read_b64_tr_b16 v[172:173], v21 offset:7168
    ds_read_b64_tr_b16 v[174:175], v21 offset:7680
    s_waitcnt lgkmcnt(12)
    v_mfma_f32_16x16x32_bf16 v[52:55], v[132:135], v[152:155], v[52:55]
    v_mfma_f32_16x16x32_bf16 v[56:59], v[132:135], v[156:159], v[56:59]
    v_mfma_f32_16x16x32_bf16 v[40:43], v[132:135], v[36:39], v[40:43]
    v_and_b32 v75, 15, v1
    v_lshlrev_b32 v75, 15, v75
    s_and_b32 s96, s10, 1
    s_and_b32 s97, s2, 135
    s_lshl_b32 s98, s97, 12
    s_lshr_b32 s99, s10, 1
    s_lshl_b32 s97, s99, 6
    s_add_u32 s99, s98, s97
    s_lshl2_add_u32 s98, s96, s99
    s_add_u32 s97, s98, 1048576
    s_add_u32 s17, s97, 512
    s_waitcnt lgkmcnt(6)
    v_mfma_f32_16x16x32_bf16 v[52:55], v[136:139], v[160:163], v[52:55]
    v_mfma_f32_16x16x32_bf16 v[56:59], v[136:139], v[164:167], v[56:59]
    v_mfma_f32_16x16x32_bf16 v[40:43], v[136:139], v[36:39], v[40:43]
    s_waitcnt lgkmcnt(0)
    v_mfma_f32_16x16x32_bf16 v[52:55], v[140:143], v[168:171], v[52:55]
    v_mfma_f32_16x16x32_bf16 v[56:59], v[140:143], v[172:175], v[56:59]
    v_mfma_f32_16x16x32_bf16 v[40:43], v[140:143], v[36:39], v[40:43]
    s_cmp_lt_u32 s3, 4
    s_cbranch_scc1 L_NOQX
    ds_read_b128 v[44:47], v76 offset:2048
    ds_read_b128 v[48:51], v76 offset:3072
L_NOQX:
    s_nop 3
    buffer_store_dwordx4 v[52:55], v2, s[32:35], s13 offen sc1
    buffer_store_dwordx4 v[56:59], v2, s[32:35], s15 offen sc1
    s_mov_b32 exec_lo, 0x00010001
    s_mov_b32 exec_hi, 0x00010001
    buffer_store_dwordx4 v[40:43], v1, s[32:35], s14 offen sc1
    s_mov_b64 exec, -1
    s_waitcnt lgkmcnt(0)
    v_mfma_f32_32x32x16_bf16 v[112:127], v[28:31], v[44:47], 0
    v_mfma_f32_32x32x16_bf16 v[112:127], v[32:35], v[48:51], v[112:127]
    v_lshrrev_b32 v22, 3, v1
    v_lshlrev_b32 v22, 10, v22
    v_and_b32 v9, 7, v1
    v_lshl_add_u32 v22, v9, 4, v22
    v_and_b32 v76, 7, v1
    v_lshlrev_b32 v76, 4, v76
    v_lshrrev_b32 v9, 5, v1
    v_lshl_add_u32 v76, v9, 3, v76
    s_nop 3
    v_cvt_pk_bf16_f32 v112, 0, v112
    v_cvt_pk_bf16_f32 v113, 0, v113
    v_cvt_pk_bf16_f32 v114, 0, v114
    v_cvt_pk_bf16_f32 v115, 0, v115
    v_cvt_pk_bf16_f32 v116, 0, v116
    v_cvt_pk_bf16_f32 v117, 0, v117
    v_cvt_pk_bf16_f32 v118, 0, v118
    v_cvt_pk_bf16_f32 v119, 0, v119
    v_cvt_pk_bf16_f32 v120, 0, v120
    v_cvt_pk_bf16_f32 v121, 0, v121
    v_cvt_pk_bf16_f32 v122, 0, v122
    v_cvt_pk_bf16_f32 v123, 0, v123
    v_cvt_pk_bf16_f32 v124, 0, v124
    v_cvt_pk_bf16_f32 v125, 0, v125
    v_cvt_pk_bf16_f32 v126, 0, v126
    v_cvt_pk_bf16_f32 v127, 0, v127
    v_max3_f32 v52, v112, v113, v114
    v_min3_f32 v53, v112, v113, v114
    v_max3_f32 v52, v52, v115, v116
    v_min3_f32 v53, v53, v115, v116
    v_max3_f32 v52, v52, v117, v118
    v_min3_f32 v53, v53, v117, v118
    v_max3_f32 v52, v52, v119, v120
    v_min3_f32 v53, v53, v119, v120
    v_max3_f32 v52, v52, v121, v122
    v_min3_f32 v53, v53, v121, v122
    v_max3_f32 v52, v52, v123, v124
    v_min3_f32 v53, v53, v123, v124
    v_max3_f32 v52, v52, v125, v126
    v_min3_f32 v53, v53, v125, v126
    v_max_f32 v54, v52, v127
    v_min_f32 v55, v53, v127
    v_max_f32 v52, v52, v127
    v_min_f32 v53, v53, v127
    s_nop 0
    v_permlane32_swap_b32 v52, v54
    v_permlane32_swap_b32 v53, v55
    v_max_f32 v52, v52, v54
    v_min_f32 v53, v53, v55
    v_pk_mul_f32 v[52:53], v[52:53], s[6:7] op_sel:[0,1]
    v_pk_fma_f32 v[128:129], v[112:113], s[6:7], v[52:53] op_sel:[0,1,0] op_sel_hi:[1,1,0] neg_lo:[0,0,1] neg_hi:[0,0,1]
    v_pk_fma_f32 v[112:113], v[112:113], s[6:7], v[52:53] op_sel:[0,1,1] neg_lo:[1,0,0] neg_hi:[1,0,0]
    v_pk_fma_f32 v[130:131], v[114:115], s[6:7], v[52:53] op_sel:[0,1,0] op_sel_hi:[1,1,0] neg_lo:[0,0,1] neg_hi:[0,0,1]
    v_pk_fma_f32 v[114:115], v[114:115], s[6:7], v[52:53] op_sel:[0,1,1] neg_lo:[1,0,0] neg_hi:[1,0,0]
    v_pk_fma_f32 v[132:133], v[116:117], s[6:7], v[52:53] op_sel:[0,1,0] op_sel_hi:[1,1,0] neg_lo:[0,0,1] neg_hi:[0,0,1]
    v_pk_fma_f32 v[116:117], v[116:117], s[6:7], v[52:53] op_sel:[0,1,1] neg_lo:[1,0,0] neg_hi:[1,0,0]
    v_pk_fma_f32 v[134:135], v[118:119], s[6:7], v[52:53] op_sel:[0,1,0] op_sel_hi:[1,1,0] neg_lo:[0,0,1] neg_hi:[0,0,1]
    v_pk_fma_f32 v[118:119], v[118:119], s[6:7], v[52:53] op_sel:[0,1,1] neg_lo:[1,0,0] neg_hi:[1,0,0]
    v_pk_fma_f32 v[136:137], v[120:121], s[6:7], v[52:53] op_sel:[0,1,0] op_sel_hi:[1,1,0] neg_lo:[0,0,1] neg_hi:[0,0,1]
    v_pk_fma_f32 v[120:121], v[120:121], s[6:7], v[52:53] op_sel:[0,1,1] neg_lo:[1,0,0] neg_hi:[1,0,0]
    v_pk_fma_f32 v[138:139], v[122:123], s[6:7], v[52:53] op_sel:[0,1,0] op_sel_hi:[1,1,0] neg_lo:[0,0,1] neg_hi:[0,0,1]
    v_pk_fma_f32 v[122:123], v[122:123], s[6:7], v[52:53] op_sel:[0,1,1] neg_lo:[1,0,0] neg_hi:[1,0,0]
    v_pk_fma_f32 v[140:141], v[124:125], s[6:7], v[52:53] op_sel:[0,1,0] op_sel_hi:[1,1,0] neg_lo:[0,0,1] neg_hi:[0,0,1]
    v_pk_fma_f32 v[124:125], v[124:125], s[6:7], v[52:53] op_sel:[0,1,1] neg_lo:[1,0,0] neg_hi:[1,0,0]
    v_pk_fma_f32 v[142:143], v[126:127], s[6:7], v[52:53] op_sel:[0,1,0] op_sel_hi:[1,1,0] neg_lo:[0,0,1] neg_hi:[0,0,1]
    v_pk_fma_f32 v[126:127], v[126:127], s[6:7], v[52:53] op_sel:[0,1,1] neg_lo:[1,0,0] neg_hi:[1,0,0]
    v_exp_f32 v128, v128
    v_exp_f32 v112, v112
    v_exp_f32 v129, v129
    s_lshl_b32 s96, s11, 7
    s_add_u32 s18, s96, 32768
    s_lshl3_add_u32 s14, s10, s18
    v_and_b32 v23, 15, v1
    v_lshlrev_b32 v23, 3, v23
    s_waitcnt vmcnt(0)
    s_barrier
    s_cmp_lg_u32 s3, 0
    s_cbranch_scc1 L_PC
    v_mov_b32 v21, s4
    s_mov_b32 exec_hi, 0
    s_mov_b32 exec_lo, 65535
    buffer_store_dword v21, v75, s[32:35], s17 offen sc1
    s_mov_b64 exec, -1
L_PC:
    buffer_load_dword v67, v3, s[32:35], 0 offen offset:256 sc1
    s_lshl4_add_u32 s96, s11, s10
    s_lshl_b32 s97, s96, 14
    s_lshl_b32 s98, s3, 7
    s_add_u32 s99, s97, s98
    s_add_u32 s13, s99, 25165824
    s_lshl4_add_u32 s96, s11, s10
    s_lshl_b32 s97, s96, 10
    s_lshl_b32 s98, s3, 7
    s_add_u32 s99, s97, s98
    s_add_u32 s15, s99, 29360128
    s_add_u32 s17, s17, 3072
    s_load_dwordx2 s[24:25], s[32:33], s92 offset:512 glc
    s_add_u32 s96, s84, 262144
    s_and_b32 s97, s96, 1048575
    s_lshl_b32 s98, s83, 16
    s_xor_b32 s99, s97, s98
    s_add_u32 s19, s99, s88
    s_add_u32 m0, s89, 49152
    s_nop 0
    buffer_load_dwordx4 v74, s[44:47], s19 offen lds
    v_exp_f32 v113, v113
    v_exp_f32 v130, v130
    v_exp_f32 v114, v114
    v_exp_f32 v131, v131
    v_exp_f32 v115, v115
    v_exp_f32 v132, v132
    v_exp_f32 v116, v116
    v_exp_f32 v133, v133
    v_exp_f32 v117, v117
    v_exp_f32 v134, v134
    s_add_u32 s96, s84, 393216
    s_and_b32 s97, s96, 1048575
    s_lshl_b32 s98, s83, 16
    s_xor_b32 s99, s97, s98
    s_add_u32 s19, s99, s88
    s_add_u32 m0, s89, 57344
    s_nop 0
    buffer_load_dwordx4 v74, s[44:47], s19 offen lds
    v_exp_f32 v118, v118
    v_exp_f32 v135, v135
    v_exp_f32 v119, v119
    v_exp_f32 v136, v136
    v_exp_f32 v120, v120
    v_exp_f32 v137, v137
    v_exp_f32 v121, v121
    v_exp_f32 v138, v138
    v_exp_f32 v122, v122
    s_add_u32 s96, s84, 524288
    s_and_b32 s97, s96, 1048575
    s_lshl_b32 s98, s83, 16
    s_xor_b32 s99, s97, s98
    s_add_u32 s19, s99, s88
    s_add_u32 m0, s89, 65536
    s_nop 0
    buffer_load_dwordx4 v74, s[44:47], s19 offen lds
    v_exp_f32 v139, v139
    v_exp_f32 v123, v123
    v_exp_f32 v140, v140
    v_exp_f32 v124, v124
    v_exp_f32 v141, v141
    v_exp_f32 v125, v125
    v_exp_f32 v142, v142
    v_exp_f32 v126, v126
    v_exp_f32 v143, v143
    v_exp_f32 v127, v127
    s_add_u32 s96, s84, 655360
    s_and_b32 s97, s96, 1048575
    s_lshl_b32 s98, s83, 16
    s_xor_b32 s99, s97, s98
    s_add_u32 s19, s99, s88
    s_add_u32 m0, s89, 73728
    s_nop 0
    buffer_load_dwordx4 v74, s[44:47], s19 offen lds
    v_pk_add_f32 v[56:57], v[128:129], v[130:131]
    v_pk_add_f32 v[58:59], v[112:113], v[114:115]
    v_pk_add_f32 v[56:57], v[56:57], v[132:133]
    v_pk_add_f32 v[58:59], v[58:59], v[116:117]
    v_pk_add_f32 v[56:57], v[56:57], v[134:135]
    v_pk_add_f32 v[58:59], v[58:59], v[118:119]
    v_pk_add_f32 v[56:57], v[56:57], v[136:137]
    v_pk_add_f32 v[58:59], v[58:59], v[120:121]
    v_pk_add_f32 v[56:57], v[56:57], v[138:139]
    s_add_u32 s96, s84, 786432
    s_and_b32 s97, s96, 1048575
    s_lshl_b32 s98, s83, 16
    s_xor_b32 s99, s97, s98
    s_add_u32 s19, s99, s88
    s_add_u32 m0, s89, 81920
    s_nop 0
    buffer_load_dwordx4 v74, s[44:47], s19 offen lds
    v_pk_add_f32 v[58:59], v[58:59], v[122:123]
    v_pk_add_f32 v[56:57], v[56:57], v[140:141]
    v_pk_add_f32 v[58:59], v[58:59], v[124:125]
    v_pk_add_f32 v[56:57], v[56:57], v[142:143]
    v_pk_add_f32 v[58:59], v[58:59], v[126:127]
    v_add_f32 v54, v56, v57
    v_add_f32 v55, v58, v59
    v_add_f32 v52, v56, v57
    v_add_f32 v53, v58, v59
    s_nop 0
    v_permlane32_swap_b32 v52, v54
    s_add_u32 s96, s84, 917504
    s_and_b32 s97, s96, 1048575
    s_lshl_b32 s98, s83, 16
    s_xor_b32 s99, s97, s98
    s_add_u32 s19, s99, s88
    s_add_u32 m0, s89, 90112
    s_nop 0
    buffer_load_dwordx4 v74, s[44:47], s19 offen lds
    v_permlane32_swap_b32 v53, v55
    v_pk_add_f32 v[52:53], v[52:53], v[54:55]
    v_rcp_f32 v52, v52
    v_rcp_f32 v53, v53
    s_nop 0
    v_pk_mul_f32 v[128:129], v[128:129], v[52:53] op_sel_hi:[1,0]
    v_pk_mul_f32 v[112:113], v[112:113], v[52:53] op_sel:[0,1]
    v_pk_mul_f32 v[130:131], v[130:131], v[52:53] op_sel_hi:[1,0]
    v_pk_mul_f32 v[114:115], v[114:115], v[52:53] op_sel:[0,1]
    v_pk_mul_f32 v[132:133], v[132:133], v[52:53] op_sel_hi:[1,0]
    s_branch SCHK_18
SPOLL_17:
    s_load_dwordx2 s[24:25], s[32:33], s92 offset:512 glc
SCHK_18:
    s_add_u32 s5, s5, 1
    s_cmp_ge_u32 s5, 300000
    s_waitcnt lgkmcnt(0)
    s_cbranch_scc1 SDONE_19
    s_cmp_lg_u32 s24, s4
    s_cbranch_scc1 SPOLL_17
    s_cmp_lg_u32 s25, s4
    s_cbranch_scc1 SPOLL_17
SDONE_19:
    s_barrier
    s_add_u32 s18, s13, 8192
    buffer_load_dwordx4 v[144:147], v22, s[32:35], s13 offen sc1
    buffer_load_dwordx4 v[148:151], v22, s[32:35], s18 offen sc1
    buffer_load_dwordx4 v[160:163], v2, s[32:35], s16 offen sc1
    s_lshl_b32 s96, s3, 5
    s_add_u32 s14, s96, 8192
    v_and_b32 v6, 3, v1
    v_lshl_add_u32 v6, v6, 3, s14
    v_lshrrev_b32 v9, 5, v1
    v_lshl_add_u32 v6, v9, 2, v6
    s_lshl_b32 s14, s3, 10
    v_and_b32 v5, 15, v1
    v_lshl_add_u32 v5, v5, 4, s14
    v_lshrrev_b32 v9, 5, v1
    v_lshl_add_u32 v5, v9, 9, v5
    v_bfe_u32 v9, v1, 4, 1
    v_lshl_add_u32 v5, v9, 3, v5
    s_lshl_b32 s96, s76, 7
    s_add_u32 s14, s96, 8192
    v_lshrrev_b32 v7, 5, v1
    v_lshl_add_u32 v7, v7, 4, s14
    s_lshl_b32 s14, s76, 12
    v_add_u32 v20, s14, v2
    v_pk_mul_f32 v[116:117], v[116:117], v[52:53] op_sel:[0,1]
    v_pk_mul_f32 v[134:135], v[134:135], v[52:53] op_sel_hi:[1,0]
    v_pk_mul_f32 v[118:119], v[118:119], v[52:53] op_sel:[0,1]
    v_pk_mul_f32 v[136:137], v[136:137], v[52:53] op_sel_hi:[1,0]
    v_pk_mul_f32 v[120:121], v[120:121], v[52:53] op_sel:[0,1]
    v_pk_mul_f32 v[138:139], v[138:139], v[52:53] op_sel_hi:[1,0]
    v_pk_mul_f32 v[122:123], v[122:123], v[52:53] op_sel:[0,1]
    v_pk_mul_f32 v[140:141], v[140:141], v[52:53] op_sel_hi:[1,0]
    v_pk_mul_f32 v[124:125], v[124:125], v[52:53] op_sel:[0,1]
    v_pk_mul_f32 v[142:143], v[142:143], v[52:53] op_sel_hi:[1,0]
    v_pk_mul_f32 v[126:127], v[126:127], v[52:53] op_sel:[0,1]
    v_cvt_pk_bf16_f32 v80, v128, v129
    v_cvt_pk_bf16_f32 v88, v112, v113
    v_cvt_pk_bf16_f32 v81, v130, v131
    v_cvt_pk_bf16_f32 v89, v114, v115
    v_cvt_pk_bf16_f32 v82, v132, v133
    v_cvt_pk_bf16_f32 v90, v116, v117
    v_cvt_pk_bf16_f32 v83, v134, v135
    v_cvt_pk_bf16_f32 v91, v118, v119
    v_cvt_pk_bf16_f32 v84, v136, v137
    v_cvt_pk_bf16_f32 v92, v120, v121
    v_cvt_pk_bf16_f32 v85, v138, v139
    v_cvt_pk_bf16_f32 v93, v122, v123
    v_cvt_pk_bf16_f32 v86, v140, v141
    v_cvt_pk_bf16_f32 v94, v124, v125
    v_cvt_pk_bf16_f32 v87, v142, v143
    v_cvt_pk_bf16_f32 v95, v126, v127
    s_waitcnt vmcnt(1)
    v_cmp_eq_u32 vcc, s4, v67
    s_nop 0
    s_cmp_eq_u32 vcc_lo, 0
    s_cselect_b32 s93, 1, 0
    v_pk_add_f32 v[144:145], v[144:145], v[148:149]
    v_pk_add_f32 v[146:147], v[146:147], v[150:151]
    s_nop 1
    v_permlane32_swap_b32 v144, v146
    v_permlane32_swap_b32 v145, v147
    v_pk_add_f32 v[144:145], v[144:145], v[146:147]
    s_nop 1
    v_add_f32_dpp v144, v144, v144 row_ror:8 row_mask:0xf bank_mask:0xf
    v_add_f32_dpp v145, v145, v145 row_ror:8 row_mask:0xf bank_mask:0xf
    v_mov_b32 v146, v144
    v_mov_b32 v147, v145
    s_nop 0
    v_permlane16_swap_b32 v144, v146
    v_permlane16_swap_b32 v145, v147
    v_pk_add_f32 v[144:145], v[144:145], v[146:147]
    v_cvt_pk_bf16_f32 v144, v144, v145
    v_mov_b32 v145, s4
    s_mov_b32 exec_lo, 0xff
    s_mov_b32 exec_hi, 0xff
    s_cmp_lg_u32 s93, 0
    s_cbranch_scc1 LOC_20
    buffer_store_dwordx2 v[144:145], v76, s[32:35], s15 offen sc1
    s_branch LOCD_21
LOC_20:
    buffer_store_dwordx2 v[144:145], v76, s[32:35], s15 offen
LOCD_21:
    s_mov_b64 exec, -1
    v_mov_b32 v224, v144
    v_mov_b32 v225, v145
    v_add_u32 v226, s15, v76
    s_cbranch_scc1 L_PC2
    s_barrier
    s_cmp_lg_u32 s3, 0
    s_cbranch_scc1 L_PC2
    v_mov_b32 v21, s4
    s_mov_b32 exec_hi, 0
    s_mov_b32 exec_lo, 65535
    buffer_store_dword v21, v75, s[32:35], s17 offen sc1
    s_mov_b64 exec, -1
L_PC2:
    s_lshl3_add_u32 s96, s11, s3
    s_lshl_b32 s97, s96, 11
    s_add_u32 s13, s97, 29360128
    s_waitcnt vmcnt(0)
    v_permlane32_swap_b32 v160, v162
    v_permlane32_swap_b32 v161, v163
    v_pk_add_f32 v[160:161], v[160:161], v[162:163]
    s_nop 1
    v_add_f32_dpp v160, v160, v160 row_ror:4 row_mask:0xf bank_mask:0xf
    v_add_f32_dpp v161, v161, v161 row_ror:4 row_mask:0xf bank_mask:0xf
    s_nop 0
    v_add_f32_dpp v160, v160, v160 row_ror:8 row_mask:0xf bank_mask:0xf
    v_add_f32_dpp v161, v161, v161 row_ror:8 row_mask:0xf bank_mask:0xf
    v_mov_b32 v162, v160
    v_mov_b32 v163, v161
    s_nop 0
    v_permlane16_swap_b32 v160, v162
    v_permlane16_swap_b32 v161, v163
    v_pk_add_f32 v[160:161], v[160:161], v[162:163]
    v_cvt_pk_bf16_f32 v160, v160, v161
    ds_write_b32 v6, v160
    s_cmp_lg_u32 s93, 0
    s_cbranch_scc1 L_C2L
SPOLL_22:
    s_load_dwordx2 s[24:25], s[32:33], s92 offset:3584 glc
SCHK_23:
    s_add_u32 s5, s5, 1
    s_cmp_ge_u32 s5, 300000
    s_waitcnt lgkmcnt(0)
    s_cbranch_scc1 SDONE_24
    s_cmp_lg_u32 s24, s4
    s_cbranch_scc1 SPOLL_22
    s_cmp_lg_u32 s25, s4
    s_cbranch_scc1 SPOLL_22
SDONE_24:
L_C2L:
    buffer_load_dwordx4 v[152:155], v2, s[32:35], s13 offen sc1
    buffer_load_dwordx4 v[156:159], v2, s[32:35], s13 offen offset:1024 sc1
    s_waitcnt vmcnt(0)
    v_bitop3_b32 v4, v153, v155, s4 bitop3:0x7e
    v_bitop3_b32 v4, v4, v157, s4 bitop3:0xf6
    v_bitop3_b32 v4, v4, v159, s4 bitop3:0xf6
    v_cmp_ne_u32 vcc, 0, v4
    s_cbranch_vccz TOK_26
POLL_27:
    buffer_load_dwordx4 v[152:155], v2, s[32:35], s13 offen sc1
    buffer_load_dwordx4 v[156:159], v2, s[32:35], s13 offen offset:1024 sc1
    s_waitcnt vmcnt(0)
    v_bitop3_b32 v4, v153, v155, s4 bitop3:0x7e
    v_bitop3_b32 v4, v4, v157, s4 bitop3:0xf6
    v_bitop3_b32 v4, v4, v159, s4 bitop3:0xf6
    v_cmp_ne_u32 vcc, 0, v4
    s_cbranch_vccz PDONE_28
    s_add_u32 s5, s5, 1
    s_cmp_lt_u32 s5, 300000
    s_cbranch_scc1 POLL_27
PDONE_28:
TOK_26:
    ds_write2_b32 v5, v152, v154 offset0:0 offset1:1
    ds_write2_b32 v5, v156, v158 offset0:64 offset1:65
    s_waitcnt lgkmcnt(0)
    s_barrier
    ds_read_b128 v[160:163], v7
    ds_read_b128 v[164:167], v7 offset:32
    ds_read_b128 v[168:171], v7 offset:64
    ds_read_b128 v[172:175], v7 offset:96
    ds_read_b128 v[144:147], v20
    ds_read_b128 v[148:151], v20 offset:1024
    ds_read_b128 v[152:155], v20 offset:2048
    ds_read_b128 v[156:159], v20 offset:3072
    s_add_u32 s96, s84, 1048576
    s_and_b32 s97, s96, 1048575
    s_lshl_b32 s98, s83, 16
    s_xor_b32 s99, s97, s98
    s_xor_b32 s96, s88, 1048576
    s_add_u32 s19, s99, s96
    s_add_u32 m0, s89, 98304
    s_nop 0
    buffer_load_dwordx4 v74, s[44:47], s19 offen lds
    s_add_u32 s96, s84, 1703936
    s_and_b32 s97, s96, 1048575
    s_lshl_b32 s98, s83, 16
    s_xor_b32 s99, s97, s98
    s_xor_b32 s96, s88, 1048576
    s_add_u32 s19, s99, s96
    s_add_u32 m0, s89, 139264
    s_nop 0
    buffer_load_dwordx4 v74, s[44:47], s19 offen lds
    s_add_u32 s96, s84, 1835008
    s_and_b32 s97, s96, 1048575
    s_lshl_b32 s98, s83, 16
    s_xor_b32 s99, s97, s98
    s_xor_b32 s96, s88, 1048576
    s_add_u32 s19, s99, s96
    s_add_u32 m0, s89, 147456
    s_nop 0
    buffer_load_dwordx4 v74, s[44:47], s19 offen lds
    s_and_b32 s96, s3, 3
    s_lshl2_add_u32 s97, s10, s96
    s_lshl4_add_u32 s98, s97, s11
    s_lshl1_add_u32 s99, s98, s76
    s_lshl_b32 s96, s99, 11
    s_add_u32 s13, s96, 8388608
    v_and_b32 v8, 15, v1
    v_lshlrev_b32 v8, 4, v8
    v_bfe_u32 v9, v1, 4, 1
    v_lshl_add_u32 v8, v9, 10, v8
    v_lshrrev_b32 v9, 5, v1
    v_lshl_add_u32 v8, v9, 8, v8
    s_waitcnt lgkmcnt(7)
    v_mfma_f32_32x32x16_bf16 v[128:143], v[160:163], v[80:83], 0
    s_waitcnt lgkmcnt(6)
    v_mfma_f32_32x32x16_bf16 v[128:143], v[164:167], v[84:87], v[128:143]
    s_waitcnt lgkmcnt(5)
    v_mfma_f32_32x32x16_bf16 v[128:143], v[168:171], v[88:91], v[128:143]
    s_waitcnt lgkmcnt(4)
    v_mfma_f32_32x32x16_bf16 v[128:143], v[172:175], v[92:95], v[128:143]
    s_waitcnt lgkmcnt(3)
    v_mfma_f32_32x32x16_bf16 v[112:127], v[144:147], v[80:83], 0
    s_waitcnt lgkmcnt(2)
    v_mfma_f32_32x32x16_bf16 v[112:127], v[148:151], v[84:87], v[112:127]
    s_waitcnt lgkmcnt(1)
    v_mfma_f32_32x32x16_bf16 v[112:127], v[152:155], v[88:91], v[112:127]
    s_waitcnt lgkmcnt(0)
    v_mfma_f32_32x32x16_bf16 v[112:127], v[156:159], v[92:95], v[112:127]
    s_nop 3
    v_cvt_pk_bf16_f32 v128, 0, v128
    v_add_f32 v128, 0x358637bd, v128
    v_cvt_pk_bf16_f32 v128, 0, v128
    v_rcp_f32 v128, v128
    s_nop 3
    v_cvt_pk_bf16_f32 v112, 0, v112
    v_cvt_pk_bf16_f32 v113, 0, v113
    v_cvt_pk_bf16_f32 v114, 0, v114
    v_cvt_pk_bf16_f32 v115, 0, v115
    v_cvt_pk_bf16_f32 v116, 0, v116
    v_cvt_pk_bf16_f32 v117, 0, v117
    v_cvt_pk_bf16_f32 v118, 0, v118
    v_cvt_pk_bf16_f32 v119, 0, v119
    v_pk_mul_f32 v[112:113], v[112:113], v[128:129] op_sel_hi:[1,0]
    v_pk_mul_f32 v[114:115], v[114:115], v[128:129] op_sel_hi:[1,0]
    v_pk_mul_f32 v[116:117], v[116:117], v[128:129] op_sel_hi:[1,0]
    v_pk_mul_f32 v[118:119], v[118:119], v[128:129] op_sel_hi:[1,0]
    v_cvt_pk_bf16_f32 v44, v112, v113
    v_cvt_pk_bf16_f32 v45, v114, v115
    v_cvt_pk_bf16_f32 v46, v116, v117
    v_cvt_pk_bf16_f32 v47, v118, v119
    buffer_store_dwordx4 v[44:47], v8, s[32:35], s13 offen sc1
    v_cvt_pk_bf16_f32 v120, 0, v120
    v_cvt_pk_bf16_f32 v121, 0, v121
    v_cvt_pk_bf16_f32 v122, 0, v122
    v_cvt_pk_bf16_f32 v123, 0, v123
    v_cvt_pk_bf16_f32 v124, 0, v124
    v_cvt_pk_bf16_f32 v125, 0, v125
    v_cvt_pk_bf16_f32 v126, 0, v126
    v_cvt_pk_bf16_f32 v127, 0, v127
    v_pk_mul_f32 v[120:121], v[120:121], v[128:129] op_sel_hi:[1,0]
    v_pk_mul_f32 v[122:123], v[122:123], v[128:129] op_sel_hi:[1,0]
    v_pk_mul_f32 v[124:125], v[124:125], v[128:129] op_sel_hi:[1,0]
    v_pk_mul_f32 v[126:127], v[126:127], v[128:129] op_sel_hi:[1,0]
    v_cvt_pk_bf16_f32 v48, v120, v121
    v_cvt_pk_bf16_f32 v49, v122, v123
    v_cvt_pk_bf16_f32 v50, v124, v125
    v_cvt_pk_bf16_f32 v51, v126, v127
    buffer_store_dwordx4 v[48:51], v8, s[32:35], s13 offen offset:512 sc1
    s_mul_i32 s96, s76, 65600
    s_add_u32 s17, s96, 32768
    v_lshrrev_b32 v20, 5, v1
    v_lshlrev_b32 v20, 11, v20
    v_bfe_u32 v9, v1, 4, 1
    v_lshl_add_u32 v20, v9, 9, v20
    v_bfe_u32 v9, v1, 2, 2
    v_lshl_add_u32 v20, v9, 7, v20
    v_bfe_u32 v9, v1, 3, 1
    v_lshl_add_u32 v20, v9, 6, v20
    v_bfe_u32 v9, v1, 1, 1
    v_lshl_add_u32 v20, v9, 5, v20
    v_bfe_u32 v9, v1, 4, 1
    v_lshl_add_u32 v20, v9, 4, v20
    v_and_b32 v9, 1, v1
    v_lshl_add_u32 v20, v9, 3, v20
    v_xor_b32 v20, s17, v20
    v_xor_b32 v21, 16, v20
    v_xor_b32 v22, 64, v20
    v_xor_b32 v23, 80, v20
    v_and_b32 v5, 7, v1
    v_lshlrev_b32 v5, 15, v5
    v_bfe_u32 v9, v1, 3, 1
    v_lshl_add_u32 v5, v9, 12, v5
    s_lshr_b32 s96, s11, 2
    s_xor_b32 s97, s96, 1
    s_and_b32 s98, s97, 1
    s_lshr_b32 s99, s10, 2
    s_and_b32 s96, s10, 3
    s_lshl_b32 s97, s96, 6
    s_lshl1_add_u32 s96, s99, s97
    s_lshl_b32 s99, s96, 12
    s_lshr_b32 s97, s11, 3
    s_and_b32 s96, s11, 3
    s_lshl2_add_u32 s97, s97, s96
    s_lshl_b32 s96, s97, 6
    s_add_u32 s97, s99, s96
    s_lshl2_add_u32 s99, s98, s97
    s_add_u32 s96, s99, 1048576
    s_add_u32 s15, s96, 1024
    v_mov_b32 v52, 0x10000
    v_mov_b32 v53, s6
    v_lshlrev_b32 v28, 16, v12
    v_and_b32 v29, s6, v12
    v_lshlrev_b32 v30, 16, v13
    v_and_b32 v31, s6, v13
    v_lshlrev_b32 v32, 16, v14
    v_and_b32 v33, s6, v14
    v_lshlrev_b32 v34, 16, v15
    v_and_b32 v35, s6, v15
    v_lshlrev_b32 v36, 16, v16
    v_and_b32 v37, s6, v16
    v_lshlrev_b32 v38, 16, v17
    v_and_b32 v39, s6, v17
    v_lshlrev_b32 v40, 16, v18
    v_and_b32 v41, s6, v18
    v_lshlrev_b32 v42, 16, v19
    v_and_b32 v43, s6, v19
    v_mul_u32_u24_dpp v76, v64, v52 row_newbcast:0 row_mask:0xf bank_mask:0xf
    v_and_b32_dpp v77, v64, v53 row_newbcast:0 row_mask:0xf bank_mask:0xf
    v_mul_u32_u24_dpp v78, v64, v52 row_newbcast:1 row_mask:0xf bank_mask:0xf
    v_and_b32_dpp v79, v64, v53 row_newbcast:1 row_mask:0xf bank_mask:0xf
    v_mul_u32_u24_dpp v80, v64, v52 row_newbcast:2 row_mask:0xf bank_mask:0xf
    v_and_b32_dpp v81, v64, v53 row_newbcast:2 row_mask:0xf bank_mask:0xf
    v_mul_u32_u24_dpp v82, v64, v52 row_newbcast:3 row_mask:0xf bank_mask:0xf
    v_and_b32_dpp v83, v64, v53 row_newbcast:3 row_mask:0xf bank_mask:0xf
    v_mul_u32_u24_dpp v84, v64, v52 row_newbcast:4 row_mask:0xf bank_mask:0xf
    v_and_b32_dpp v85, v64, v53 row_newbcast:4 row_mask:0xf bank_mask:0xf
    v_mul_u32_u24_dpp v86, v64, v52 row_newbcast:5 row_mask:0xf bank_mask:0xf
    v_and_b32_dpp v87, v64, v53 row_newbcast:5 row_mask:0xf bank_mask:0xf
    v_mul_u32_u24_dpp v88, v64, v52 row_newbcast:6 row_mask:0xf bank_mask:0xf
    v_and_b32_dpp v89, v64, v53 row_newbcast:6 row_mask:0xf bank_mask:0xf
    v_mul_u32_u24_dpp v90, v64, v52 row_newbcast:7 row_mask:0xf bank_mask:0xf
    v_and_b32_dpp v91, v64, v53 row_newbcast:7 row_mask:0xf bank_mask:0xf
    s_lshl1_add_u32 s96, s94, s77
    s_lshl_b32 s97, s96, 15
    s_add_u32 s19, s97, 8388608
    v_and_b32 v25, 15, v1
    v_lshlrev_b32 v25, 3, v25
    s_waitcnt vmcnt(0)
    s_waitcnt lgkmcnt(0)
    s_barrier
    s_cmp_lg_u32 s3, 0
    s_cbranch_scc1 L_PD
    v_mov_b32 v6, s4
    s_mov_b32 exec_hi, 0
    s_mov_b32 exec_lo, 65535
    buffer_store_dword v6, v5, s[32:35], s15 offen sc1
    s_mov_b64 exec, -1
L_PD:
    s_add_u32 s96, s84, 1966080
    s_and_b32 s97, s96, 1048575
    s_lshl_b32 s98, s83, 16
    s_xor_b32 s99, s97, s98
    s_xor_b32 s96, s88, 1048576
    s_add_u32 s13, s99, s96
    s_add_u32 m0, s89, 155648
    s_nop 0
    buffer_load_dwordx4 v74, s[44:47], s13 offen lds
    s_and_b32 s96, s84, 1048575
    s_lshl_b32 s97, s83, 16
    s_xor_b32 s98, s96, s97
    s_add_u32 s13, s98, s88
    s_add_u32 m0, s89, 32768
    s_nop 0
    buffer_load_dwordx4 v74, s[44:47], s13 offen lds
    s_add_u32 s96, s84, 131072
    s_and_b32 s97, s96, 1048575
    s_lshl_b32 s98, s83, 16
    s_xor_b32 s99, s97, s98
    s_add_u32 s13, s99, s88
    s_add_u32 m0, s89, 40960
    s_nop 0
    buffer_load_dwordx4 v74, s[44:47], s13 offen lds
    s_load_dwordx2 s[24:25], s[32:33], s92 offset:1024 glc
    v_mov_b32_dpp v92, v65 row_newbcast:0 row_mask:0xf bank_mask:0xf
    v_mov_b32_dpp v93, v65 row_newbcast:1 row_mask:0xf bank_mask:0xf
    v_mov_b32_dpp v94, v65 row_newbcast:2 row_mask:0xf bank_mask:0xf
    v_mov_b32_dpp v95, v65 row_newbcast:3 row_mask:0xf bank_mask:0xf
    v_mov_b32_dpp v96, v65 row_newbcast:4 row_mask:0xf bank_mask:0xf
    v_mov_b32_dpp v97, v65 row_newbcast:5 row_mask:0xf bank_mask:0xf
    v_mov_b32_dpp v98, v65 row_newbcast:6 row_mask:0xf bank_mask:0xf
    v_mov_b32_dpp v99, v65 row_newbcast:7 row_mask:0xf bank_mask:0xf
    v_mov_b32_dpp v100, v66 row_newbcast:0 row_mask:0xf bank_mask:0xf
    v_mov_b32_dpp v101, v66 row_newbcast:1 row_mask:0xf bank_mask:0xf
    v_mov_b32_dpp v102, v66 row_newbcast:2 row_mask:0xf bank_mask:0xf
    v_mov_b32_dpp v103, v66 row_newbcast:3 row_mask:0xf bank_mask:0xf
    v_mov_b32_dpp v104, v66 row_newbcast:4 row_mask:0xf bank_mask:0xf
    v_mov_b32_dpp v105, v66 row_newbcast:5 row_mask:0xf bank_mask:0xf
    v_mov_b32_dpp v106, v66 row_newbcast:6 row_mask:0xf bank_mask:0xf
    v_mov_b32_dpp v107, v66 row_newbcast:7 row_mask:0xf bank_mask:0xf
    v_and_b32 v4, 3, v1
    v_cmp_eq_u32 vcc, 1, v4
    v_cmp_eq_u32 s[22:23], 0, v4
    v_mov_b32 v5, 0x3f803f80
    v_cndmask_b32 v92, v100, v92, vcc
    v_cndmask_b32 v93, v101, v93, vcc
    v_cndmask_b32 v94, v102, v94, vcc
    v_cndmask_b32 v95, v103, v95, vcc
    v_cndmask_b32 v96, v104, v96, vcc
    v_cndmask_b32 v97, v105, v97, vcc
    v_cndmask_b32 v98, v106, v98, vcc
    v_cndmask_b32 v99, v107, v99, vcc
    v_cndmask_b32 v92, v92, v5, s[22:23]
    v_cndmask_b32 v93, v93, v5, s[22:23]
    v_cndmask_b32 v94, v94, v5, s[22:23]
    v_cndmask_b32 v95, v95, v5, s[22:23]
    v_cndmask_b32 v96, v96, v5, s[22:23]
    v_cndmask_b32 v97, v97, v5, s[22:23]
    v_cndmask_b32 v98, v98, v5, s[22:23]
    v_cndmask_b32 v99, v99, v5, s[22:23]
    s_waitcnt vmcnt(0)
    s_branch SCHK_30
SPOLL_29:
    s_load_dwordx2 s[24:25], s[32:33], s92 offset:1024 glc
SCHK_30:
    s_add_u32 s5, s5, 1
    s_cmp_ge_u32 s5, 300000
    s_waitcnt lgkmcnt(0)
    s_cbranch_scc1 SDONE_31
    s_cmp_lg_u32 s24, s4
    s_cbranch_scc1 SPOLL_29
SDONE_31:
    s_barrier
    s_cmp_lt_u32 s3, 4
    s_cbranch_scc1 L_P2
    s_setprio 1
L_P2:
    s_lshl_b32 s96, s21, 7
    s_add_u32 s18, s96, 65536
    s_lshl_b32 s96, s83, 11
    s_add_u32 s20, s96, s19
    buffer_load_dwordx4 v[140:143], v2, s[32:35], s20 offen sc1
    buffer_load_dwordx4 v[144:147], v2, s[32:35], s20 offen offset:1024 sc1
    ds_read_b64_tr_b16 v[228:229], v22
    ds_read_b64_tr_b16 v[230:231], v22 offset:1024
    ds_read_b64_tr_b16 v[232:233], v23
    ds_read_b64_tr_b16 v[234:235], v23 offset:1024
    ds_read_b64_tr_b16 v[236:237], v20
    ds_read_b64_tr_b16 v[238:239], v20 offset:1024
    ds_read_b64_tr_b16 v[240:241], v21
    ds_read_b64_tr_b16 v[242:243], v21 offset:1024
    s_xor_b32 s96, s83, 1
    s_lshl_b32 s97, s96, 11
    s_add_u32 s20, s97, s19
    buffer_load_dwordx4 v[148:151], v2, s[32:35], s20 offen sc1
    buffer_load_dwordx4 v[152:155], v2, s[32:35], s20 offen offset:1024 sc1
    s_xor_b32 s96, s83, 2
    s_lshl_b32 s97, s96, 11
    s_add_u32 s20, s97, s19
    buffer_load_dwordx4 v[156:159], v2, s[32:35], s20 offen sc1
    buffer_load_dwordx4 v[160:163], v2, s[32:35], s20 offen offset:1024 sc1
    s_waitcnt lgkmcnt(6)
    s_waitcnt vmcnt(5)
    v_mfma_f32_16x16x32_bf16 v[124:127], v[228:231], v[140:143], 0
    ds_read_b64_tr_b16 v[244:245], v22 offset:4096
    s_waitcnt vmcnt(4)
    v_mfma_f32_16x16x32_bf16 v[128:131], v[228:231], v[144:147], 0
    ds_read_b64_tr_b16 v[246:247], v22 offset:5120
    s_xor_b32 s96, s83, 3
    s_lshl_b32 s97, s96, 11
    s_add_u32 s20, s97, s19
    buffer_load_dwordx4 v[164:167], v2, s[32:35], s20 offen sc1
    s_waitcnt lgkmcnt(6)
    v_mfma_f32_16x16x32_bf16 v[132:135], v[232:235], v[140:143], 0
    ds_read_b64_tr_b16 v[228:229], v23 offset:4096
    v_mfma_f32_16x16x32_bf16 v[136:139], v[232:235], v[144:147], 0
    ds_read_b64_tr_b16 v[230:231], v23 offset:5120
    buffer_load_dwordx4 v[168:171], v2, s[32:35], s20 offen offset:1024 sc1
    s_waitcnt lgkmcnt(6)
    v_mfma_f32_16x16x32_bf16 v[108:111], v[236:239], v[140:143], 0
    ds_read_b64_tr_b16 v[232:233], v20 offset:4096
    v_mfma_f32_16x16x32_bf16 v[112:115], v[236:239], v[144:147], 0
    ds_read_b64_tr_b16 v[234:235], v20 offset:5120
    s_waitcnt lgkmcnt(6)
    v_mfma_f32_16x16x32_bf16 v[116:119], v[240:243], v[140:143], 0
    ds_read_b64_tr_b16 v[236:237], v21 offset:4096
    v_mfma_f32_16x16x32_bf16 v[120:123], v[240:243], v[144:147], 0
    ds_read_b64_tr_b16 v[238:239], v21 offset:5120
    s_waitcnt lgkmcnt(6)
    s_waitcnt vmcnt(4)
    v_mfma_f32_16x16x32_bf16 v[124:127], v[244:247], v[148:151], v[124:127]
    ds_read_b64_tr_b16 v[240:241], v22 offset:8192
    v_mfma_f32_16x16x32_bf16 v[128:131], v[244:247], v[152:155], v[128:131]
    ds_read_b64_tr_b16 v[242:243], v22 offset:9216
    s_xor_b32 s96, s83, 4
    s_lshl_b32 s97, s96, 11
    s_add_u32 s20, s97, s19
    buffer_load_dwordx4 v[140:143], v2, s[32:35], s20 offen sc1
    s_waitcnt lgkmcnt(6)
    v_mfma_f32_16x16x32_bf16 v[132:135], v[228:231], v[148:151], v[132:135]
    ds_read_b64_tr_b16 v[244:245], v23 offset:8192
    v_mfma_f32_16x16x32_bf16 v[136:139], v[228:231], v[152:155], v[136:139]
    ds_read_b64_tr_b16 v[246:247], v23 offset:9216
    buffer_load_dwordx4 v[144:147], v2, s[32:35], s20 offen offset:1024 sc1
    s_waitcnt lgkmcnt(6)
    v_mfma_f32_16x16x32_bf16 v[108:111], v[232:235], v[148:151], v[108:111]
    ds_read_b64_tr_b16 v[228:229], v20 offset:8192
    v_mfma_f32_16x16x32_bf16 v[112:115], v[232:235], v[152:155], v[112:115]
    ds_read_b64_tr_b16 v[230:231], v20 offset:9216
    s_waitcnt lgkmcnt(6)
    v_mfma_f32_16x16x32_bf16 v[116:119], v[236:239], v[148:151], v[116:119]
    ds_read_b64_tr_b16 v[232:233], v21 offset:8192
    v_mfma_f32_16x16x32_bf16 v[120:123], v[236:239], v[152:155], v[120:123]
    ds_read_b64_tr_b16 v[234:235], v21 offset:9216
    s_waitcnt lgkmcnt(6)
    s_waitcnt vmcnt(4)
    v_mfma_f32_16x16x32_bf16 v[124:127], v[240:243], v[156:159], v[124:127]
    ds_read_b64_tr_b16 v[236:237], v22 offset:12288
    v_mfma_f32_16x16x32_bf16 v[128:131], v[240:243], v[160:163], v[128:131]
    ds_read_b64_tr_b16 v[238:239], v22 offset:13312
    s_xor_b32 s96, s83, 5
    s_lshl_b32 s97, s96, 11
    s_add_u32 s20, s97, s19
    buffer_load_dwordx4 v[148:151], v2, s[32:35], s20 offen sc1
    s_waitcnt lgkmcnt(6)
    v_mfma_f32_16x16x32_bf16 v[132:135], v[244:247], v[156:159], v[132:135]
    ds_read_b64_tr_b16 v[240:241], v23 offset:12288
    v_mfma_f32_16x16x32_bf16 v[136:139], v[244:247], v[160:163], v[136:139]
    ds_read_b64_tr_b16 v[242:243], v23 offset:13312
    buffer_load_dwordx4 v[152:155], v2, s[32:35], s20 offen offset:1024 sc1
    s_waitcnt lgkmcnt(6)
    v_mfma_f32_16x16x32_bf16 v[108:111], v[228:231], v[156:159], v[108:111]
    ds_read_b64_tr_b16 v[244:245], v20 offset:12288
    v_mfma_f32_16x16x32_bf16 v[112:115], v[228:231], v[160:163], v[112:115]
    ds_read_b64_tr_b16 v[246:247], v20 offset:13312
    s_waitcnt lgkmcnt(6)
    v_mfma_f32_16x16x32_bf16 v[116:119], v[232:235], v[156:159], v[116:119]
    ds_read_b64_tr_b16 v[228:229], v21 offset:12288
    v_mfma_f32_16x16x32_bf16 v[120:123], v[232:235], v[160:163], v[120:123]
    ds_read_b64_tr_b16 v[230:231], v21 offset:13312
    s_waitcnt lgkmcnt(6)
    s_waitcnt vmcnt(4)
    v_mfma_f32_16x16x32_bf16 v[124:127], v[236:239], v[164:167], v[124:127]
    ds_read_b64_tr_b16 v[232:233], v22 offset:16384
    v_mfma_f32_16x16x32_bf16 v[128:131], v[236:239], v[168:171], v[128:131]
    ds_read_b64_tr_b16 v[234:235], v22 offset:17408
    s_xor_b32 s96, s83, 6
    s_lshl_b32 s97, s96, 11
    s_add_u32 s20, s97, s19
    buffer_load_dwordx4 v[156:159], v2, s[32:35], s20 offen sc1
    s_waitcnt lgkmcnt(6)
    v_mfma_f32_16x16x32_bf16 v[132:135], v[240:243], v[164:167], v[132:135]
    ds_read_b64_tr_b16 v[236:237], v23 offset:16384
    v_mfma_f32_16x16x32_bf16 v[136:139], v[240:243], v[168:171], v[136:139]
    ds_read_b64_tr_b16 v[238:239], v23 offset:17408
    buffer_load_dwordx4 v[160:163], v2, s[32:35], s20 offen offset:1024 sc1
    s_waitcnt lgkmcnt(6)
    v_mfma_f32_16x16x32_bf16 v[108:111], v[244:247], v[164:167], v[108:111]
    ds_read_b64_tr_b16 v[240:241], v20 offset:16384
    v_mfma_f32_16x16x32_bf16 v[112:115], v[244:247], v[168:171], v[112:115]
    ds_read_b64_tr_b16 v[242:243], v20 offset:17408
    s_waitcnt lgkmcnt(6)
    v_mfma_f32_16x16x32_bf16 v[116:119], v[228:231], v[164:167], v[116:119]
    ds_read_b64_tr_b16 v[244:245], v21 offset:16384
    v_mfma_f32_16x16x32_bf16 v[120:123], v[228:231], v[168:171], v[120:123]
    ds_read_b64_tr_b16 v[246:247], v21 offset:17408
    s_waitcnt lgkmcnt(6)
    s_waitcnt vmcnt(4)
    v_mfma_f32_16x16x32_bf16 v[124:127], v[232:235], v[140:143], v[124:127]
    ds_read_b64_tr_b16 v[228:229], v22 offset:20480
    v_mfma_f32_16x16x32_bf16 v[128:131], v[232:235], v[144:147], v[128:131]
    ds_read_b64_tr_b16 v[230:231], v22 offset:21504
    s_xor_b32 s96, s83, 7
    s_lshl_b32 s97, s96, 11
    s_add_u32 s20, s97, s19
    buffer_load_dwordx4 v[164:167], v2, s[32:35], s20 offen sc1
    s_waitcnt lgkmcnt(6)
    v_mfma_f32_16x16x32_bf16 v[132:135], v[236:239], v[140:143], v[132:135]
    ds_read_b64_tr_b16 v[232:233], v23 offset:20480
    v_mfma_f32_16x16x32_bf16 v[136:139], v[236:239], v[144:147], v[136:139]
    ds_read_b64_tr_b16 v[234:235], v23 offset:21504
    buffer_load_dwordx4 v[168:171], v2, s[32:35], s20 offen offset:1024 sc1
    s_waitcnt lgkmcnt(6)
    v_mfma_f32_16x16x32_bf16 v[108:111], v[240:243], v[140:143], v[108:111]
    ds_read_b64_tr_b16 v[236:237], v20 offset:20480
    v_mfma_f32_16x16x32_bf16 v[112:115], v[240:243], v[144:147], v[112:115]
    ds_read_b64_tr_b16 v[238:239], v20 offset:21504
    s_setprio 0
    s_waitcnt lgkmcnt(6)
    v_mfma_f32_16x16x32_bf16 v[116:119], v[244:247], v[140:143], v[116:119]
    ds_read_b64_tr_b16 v[240:241], v21 offset:20480
    v_mfma_f32_16x16x32_bf16 v[120:123], v[244:247], v[144:147], v[120:123]
    ds_read_b64_tr_b16 v[242:243], v21 offset:21504
    s_waitcnt lgkmcnt(6)
    s_waitcnt vmcnt(4)
    v_mfma_f32_16x16x32_bf16 v[124:127], v[228:231], v[148:151], v[124:127]
    ds_read_b64_tr_b16 v[244:245], v22 offset:24576
    v_mfma_f32_16x16x32_bf16 v[128:131], v[228:231], v[152:155], v[128:131]
    ds_read_b64_tr_b16 v[246:247], v22 offset:25600
    s_cmp_eq_u32 s25, s4
    s_cbranch_scc1 L_D2
SPOLL_32:
    s_load_dwordx2 s[24:25], s[32:33], s92 offset:1024 glc
SCHK_33:
    s_add_u32 s5, s5, 1
    s_cmp_ge_u32 s5, 300000
    s_waitcnt lgkmcnt(0)
    s_cbranch_scc1 SDONE_34
    s_cmp_lg_u32 s25, s4
    s_cbranch_scc1 SPOLL_32
SDONE_34:
L_D2:
    s_barrier
    s_xor_b32 s96, s83, 8
    s_lshl_b32 s97, s96, 11
    s_add_u32 s20, s97, s19
    buffer_load_dwordx4 v[140:143], v2, s[32:35], s20 offen sc1
    s_waitcnt lgkmcnt(6)
    v_mfma_f32_16x16x32_bf16 v[132:135], v[232:235], v[148:151], v[132:135]
    ds_read_b64_tr_b16 v[228:229], v23 offset:24576
    v_mfma_f32_16x16x32_bf16 v[136:139], v[232:235], v[152:155], v[136:139]
    ds_read_b64_tr_b16 v[230:231], v23 offset:25600
    buffer_load_dwordx4 v[144:147], v2, s[32:35], s20 offen offset:1024 sc1
    s_waitcnt lgkmcnt(6)
    v_mfma_f32_16x16x32_bf16 v[108:111], v[236:239], v[148:151], v[108:111]
    ds_read_b64_tr_b16 v[232:233], v20 offset:24576
    v_mfma_f32_16x16x32_bf16 v[112:115], v[236:239], v[152:155], v[112:115]
    ds_read_b64_tr_b16 v[234:235], v20 offset:25600
    s_waitcnt lgkmcnt(6)
    v_mfma_f32_16x16x32_bf16 v[116:119], v[240:243], v[148:151], v[116:119]
    ds_read_b64_tr_b16 v[236:237], v21 offset:24576
    v_mfma_f32_16x16x32_bf16 v[120:123], v[240:243], v[152:155], v[120:123]
    ds_read_b64_tr_b16 v[238:239], v21 offset:25600
    s_waitcnt lgkmcnt(6)
    s_waitcnt vmcnt(4)
    v_mfma_f32_16x16x32_bf16 v[124:127], v[244:247], v[156:159], v[124:127]
    ds_read_b64_tr_b16 v[240:241], v22 offset:28672
    v_mfma_f32_16x16x32_bf16 v[128:131], v[244:247], v[160:163], v[128:131]
    ds_read_b64_tr_b16 v[242:243], v22 offset:29696
    s_xor_b32 s96, s83, 9
    s_lshl_b32 s97, s96, 11
    s_add_u32 s20, s97, s19
    buffer_load_dwordx4 v[148:151], v2, s[32:35], s20 offen sc1
    s_waitcnt lgkmcnt(6)
    v_mfma_f32_16x16x32_bf16 v[132:135], v[228:231], v[156:159], v[132:135]
    ds_read_b64_tr_b16 v[244:245], v23 offset:28672
    v_mfma_f32_16x16x32_bf16 v[136:139], v[228:231], v[160:163], v[136:139]
    ds_read_b64_tr_b16 v[246:247], v23 offset:29696
    buffer_load_dwordx4 v[152:155], v2, s[32:35], s20 offen offset:1024 sc1
    s_waitcnt lgkmcnt(6)
    v_mfma_f32_16x16x32_bf16 v[108:111], v[232:235], v[156:159], v[108:111]
    ds_read_b64_tr_b16 v[228:229], v20 offset:28672
    v_mfma_f32_16x16x32_bf16 v[112:115], v[232:235], v[160:163], v[112:115]
    ds_read_b64_tr_b16 v[230:231], v20 offset:29696
    s_waitcnt lgkmcnt(6)
    v_mfma_f32_16x16x32_bf16 v[116:119], v[236:239], v[156:159], v[116:119]
    ds_read_b64_tr_b16 v[232:233], v21 offset:28672
    v_mfma_f32_16x16x32_bf16 v[120:123], v[236:239], v[160:163], v[120:123]
    ds_read_b64_tr_b16 v[234:235], v21 offset:29696
    s_waitcnt lgkmcnt(6)
    s_waitcnt vmcnt(4)
    v_mfma_f32_16x16x32_bf16 v[124:127], v[240:243], v[164:167], v[124:127]
    ds_read_b64_tr_b16 v[236:237], v22 offset:32768
    v_mfma_f32_16x16x32_bf16 v[128:131], v[240:243], v[168:171], v[128:131]
    ds_read_b64_tr_b16 v[238:239], v22 offset:33792
    s_xor_b32 s96, s83, 10
    s_lshl_b32 s97, s96, 11
    s_add_u32 s20, s97, s19
    buffer_load_dwordx4 v[156:159], v2, s[32:35], s20 offen sc1
    s_waitcnt lgkmcnt(6)
    v_mfma_f32_16x16x32_bf16 v[132:135], v[244:247], v[164:167], v[132:135]
    ds_read_b64_tr_b16 v[240:241], v23 offset:32768
    v_mfma_f32_16x16x32_bf16 v[136:139], v[244:247], v[168:171], v[136:139]
    ds_read_b64_tr_b16 v[242:243], v23 offset:33792
    buffer_load_dwordx4 v[160:163], v2, s[32:35], s20 offen offset:1024 sc1
    s_waitcnt lgkmcnt(6)
    v_mfma_f32_16x16x32_bf16 v[108:111], v[228:231], v[164:167], v[108:111]
    ds_read_b64_tr_b16 v[244:245], v20 offset:32768
    v_mfma_f32_16x16x32_bf16 v[112:115], v[228:231], v[168:171], v[112:115]
    ds_read_b64_tr_b16 v[246:247], v20 offset:33792
    s_waitcnt lgkmcnt(6)
    v_mfma_f32_16x16x32_bf16 v[116:119], v[232:235], v[164:167], v[116:119]
    ds_read_b64_tr_b16 v[228:229], v21 offset:32768
    v_mfma_f32_16x16x32_bf16 v[120:123], v[232:235], v[168:171], v[120:123]
    ds_read_b64_tr_b16 v[230:231], v21 offset:33792
    s_waitcnt lgkmcnt(6)
    s_waitcnt vmcnt(4)
    v_mfma_f32_16x16x32_bf16 v[124:127], v[236:239], v[140:143], v[124:127]
    ds_read_b64_tr_b16 v[232:233], v22 offset:36864
    v_mfma_f32_16x16x32_bf16 v[128:131], v[236:239], v[144:147], v[128:131]
    ds_read_b64_tr_b16 v[234:235], v22 offset:37888
    s_xor_b32 s96, s83, 11
    s_lshl_b32 s97, s96, 11
    s_add_u32 s20, s97, s19
    buffer_load_dwordx4 v[164:167], v2, s[32:35], s20 offen sc1
    s_waitcnt lgkmcnt(6)
    v_mfma_f32_16x16x32_bf16 v[132:135], v[240:243], v[140:143], v[132:135]
    ds_read_b64_tr_b16 v[236:237], v23 offset:36864
    v_mfma_f32_16x16x32_bf16 v[136:139], v[240:243], v[144:147], v[136:139]
    ds_read_b64_tr_b16 v[238:239], v23 offset:37888
    buffer_load_dwordx4 v[168:171], v2, s[32:35], s20 offen offset:1024 sc1
    s_waitcnt lgkmcnt(6)
    v_mfma_f32_16x16x32_bf16 v[108:111], v[244:247], v[140:143], v[108:111]
    ds_read_b64_tr_b16 v[240:241], v20 offset:36864
    v_mfma_f32_16x16x32_bf16 v[112:115], v[244:247], v[144:147], v[112:115]
    ds_read_b64_tr_b16 v[242:243], v20 offset:37888
    s_waitcnt lgkmcnt(6)
    v_mfma_f32_16x16x32_bf16 v[116:119], v[228:231], v[140:143], v[116:119]
    ds_read_b64_tr_b16 v[244:245], v21 offset:36864
    v_mfma_f32_16x16x32_bf16 v[120:123], v[228:231], v[144:147], v[120:123]
    ds_read_b64_tr_b16 v[246:247], v21 offset:37888
    s_waitcnt lgkmcnt(6)
    s_waitcnt vmcnt(4)
    v_mfma_f32_16x16x32_bf16 v[124:127], v[232:235], v[148:151], v[124:127]
    ds_read_b64_tr_b16 v[228:229], v22 offset:40960
    v_mfma_f32_16x16x32_bf16 v[128:131], v[232:235], v[152:155], v[128:131]
    ds_read_b64_tr_b16 v[230:231], v22 offset:41984
    s_xor_b32 s96, s83, 12
    s_lshl_b32 s97, s96, 11
    s_add_u32 s20, s97, s19
    buffer_load_dwordx4 v[140:143], v2, s[32:35], s20 offen sc1
    s_waitcnt lgkmcnt(6)
    v_mfma_f32_16x16x32_bf16 v[132:135], v[236:239], v[148:151], v[132:135]
    ds_read_b64_tr_b16 v[232:233], v23 offset:40960
    v_mfma_f32_16x16x32_bf16 v[136:139], v[236:239], v[152:155], v[136:139]
    ds_read_b64_tr_b16 v[234:235], v23 offset:41984
    buffer_load_dwordx4 v[144:147], v2, s[32:35], s20 offen offset:1024 sc1
    s_waitcnt lgkmcnt(6)
    v_mfma_f32_16x16x32_bf16 v[108:111], v[240:243], v[148:151], v[108:111]
    ds_read_b64_tr_b16 v[236:237], v20 offset:40960
    v_mfma_f32_16x16x32_bf16 v[112:115], v[240:243], v[152:155], v[112:115]
    ds_read_b64_tr_b16 v[238:239], v20 offset:41984
    s_waitcnt lgkmcnt(6)
    v_mfma_f32_16x16x32_bf16 v[116:119], v[244:247], v[148:151], v[116:119]
    ds_read_b64_tr_b16 v[240:241], v21 offset:40960
    v_mfma_f32_16x16x32_bf16 v[120:123], v[244:247], v[152:155], v[120:123]
    ds_read_b64_tr_b16 v[242:243], v21 offset:41984
    s_waitcnt lgkmcnt(6)
    s_waitcnt vmcnt(4)
    v_mfma_f32_16x16x32_bf16 v[124:127], v[228:231], v[156:159], v[124:127]
    ds_read_b64_tr_b16 v[244:245], v22 offset:45056
    v_mfma_f32_16x16x32_bf16 v[128:131], v[228:231], v[160:163], v[128:131]
    ds_read_b64_tr_b16 v[246:247], v22 offset:46080
    s_xor_b32 s96, s83, 13
    s_lshl_b32 s97, s96, 11
    s_add_u32 s20, s97, s19
    buffer_load_dwordx4 v[148:151], v2, s[32:35], s20 offen sc1
    s_waitcnt lgkmcnt(6)
    v_mfma_f32_16x16x32_bf16 v[132:135], v[232:235], v[156:159], v[132:135]
    ds_read_b64_tr_b16 v[228:229], v23 offset:45056
    v_mfma_f32_16x16x32_bf16 v[136:139], v[232:235], v[160:163], v[136:139]
    ds_read_b64_tr_b16 v[230:231], v23 offset:46080
    buffer_load_dwordx4 v[152:155], v2, s[32:35], s20 offen offset:1024 sc1
    s_waitcnt lgkmcnt(6)
    v_mfma_f32_16x16x32_bf16 v[108:111], v[236:239], v[156:159], v[108:111]
    ds_read_b64_tr_b16 v[232:233], v20 offset:45056
    v_mfma_f32_16x16x32_bf16 v[112:115], v[236:239], v[160:163], v[112:115]
    ds_read_b64_tr_b16 v[234:235], v20 offset:46080
    s_waitcnt lgkmcnt(6)
    v_mfma_f32_16x16x32_bf16 v[116:119], v[240:243], v[156:159], v[116:119]
    ds_read_b64_tr_b16 v[236:237], v21 offset:45056
    v_mfma_f32_16x16x32_bf16 v[120:123], v[240:243], v[160:163], v[120:123]
    ds_read_b64_tr_b16 v[238:239], v21 offset:46080
    s_waitcnt lgkmcnt(6)
    s_waitcnt vmcnt(4)
    v_mfma_f32_16x16x32_bf16 v[124:127], v[244:247], v[164:167], v[124:127]
    ds_read_b64_tr_b16 v[240:241], v22 offset:49152
    v_mfma_f32_16x16x32_bf16 v[128:131], v[244:247], v[168:171], v[128:131]
    ds_read_b64_tr_b16 v[242:243], v22 offset:50176
    s_xor_b32 s96, s83, 14
    s_lshl_b32 s97, s96, 11
    s_add_u32 s20, s97, s19
    buffer_load_dwordx4 v[156:159], v2, s[32:35], s20 offen sc1
    s_waitcnt lgkmcnt(6)
    v_mfma_f32_16x16x32_bf16 v[132:135], v[228:231], v[164:167], v[132:135]
    ds_read_b64_tr_b16 v[244:245], v23 offset:49152
    v_mfma_f32_16x16x32_bf16 v[136:139], v[228:231], v[168:171], v[136:139]
    ds_read_b64_tr_b16 v[246:247], v23 offset:50176
    buffer_load_dwordx4 v[160:163], v2, s[32:35], s20 offen offset:1024 sc1
    s_waitcnt lgkmcnt(6)
    v_mfma_f32_16x16x32_bf16 v[108:111], v[232:235], v[164:167], v[108:111]
    ds_read_b64_tr_b16 v[228:229], v20 offset:49152
    v_mfma_f32_16x16x32_bf16 v[112:115], v[232:235], v[168:171], v[112:115]
    ds_read_b64_tr_b16 v[230:231], v20 offset:50176
    s_waitcnt lgkmcnt(6)
    v_mfma_f32_16x16x32_bf16 v[116:119], v[236:239], v[164:167], v[116:119]
    ds_read_b64_tr_b16 v[232:233], v21 offset:49152
    v_mfma_f32_16x16x32_bf16 v[120:123], v[236:239], v[168:171], v[120:123]
    ds_read_b64_tr_b16 v[234:235], v21 offset:50176
    s_waitcnt lgkmcnt(6)
    s_waitcnt vmcnt(4)
    v_mfma_f32_16x16x32_bf16 v[124:127], v[240:243], v[140:143], v[124:127]
    ds_read_b64_tr_b16 v[236:237], v22 offset:53248
    v_mfma_f32_16x16x32_bf16 v[128:131], v[240:243], v[144:147], v[128:131]
    ds_read_b64_tr_b16 v[238:239], v22 offset:54272
    s_xor_b32 s96, s83, 15
    s_lshl_b32 s97, s96, 11
    s_add_u32 s20, s97, s19
    buffer_load_dwordx4 v[164:167], v2, s[32:35], s20 offen sc1
    s_waitcnt lgkmcnt(6)
    v_mfma_f32_16x16x32_bf16 v[132:135], v[244:247], v[140:143], v[132:135]
    ds_read_b64_tr_b16 v[240:241], v23 offset:53248
    v_mfma_f32_16x16x32_bf16 v[136:139], v[244:247], v[144:147], v[136:139]
    ds_read_b64_tr_b16 v[242:243], v23 offset:54272
    buffer_load_dwordx4 v[168:171], v2, s[32:35], s20 offen offset:1024 sc1
    buffer_load_dwordx2 v[26:27], v25, s[32:35], s18 offen sc1
    s_waitcnt lgkmcnt(6)
    v_mfma_f32_16x16x32_bf16 v[108:111], v[228:231], v[140:143], v[108:111]
    ds_read_b64_tr_b16 v[244:245], v20 offset:53248
    v_mfma_f32_16x16x32_bf16 v[112:115], v[228:231], v[144:147], v[112:115]
    ds_read_b64_tr_b16 v[246:247], v20 offset:54272
    s_waitcnt lgkmcnt(6)
    v_mfma_f32_16x16x32_bf16 v[116:119], v[232:235], v[140:143], v[116:119]
    ds_read_b64_tr_b16 v[228:229], v21 offset:53248
    v_mfma_f32_16x16x32_bf16 v[120:123], v[232:235], v[144:147], v[120:123]
    ds_read_b64_tr_b16 v[230:231], v21 offset:54272
    s_waitcnt lgkmcnt(6)
    s_waitcnt vmcnt(5)
    v_mfma_f32_16x16x32_bf16 v[124:127], v[236:239], v[148:151], v[124:127]
    ds_read_b64_tr_b16 v[232:233], v22 offset:57344
    v_mfma_f32_16x16x32_bf16 v[128:131], v[236:239], v[152:155], v[128:131]
    ds_read_b64_tr_b16 v[234:235], v22 offset:58368
    s_waitcnt lgkmcnt(6)
    v_mfma_f32_16x16x32_bf16 v[132:135], v[240:243], v[148:151], v[132:135]
    ds_read_b64_tr_b16 v[236:237], v23 offset:57344
    v_mfma_f32_16x16x32_bf16 v[136:139], v[240:243], v[152:155], v[136:139]
    ds_read_b64_tr_b16 v[238:239], v23 offset:58368
    s_waitcnt lgkmcnt(6)
    v_mfma_f32_16x16x32_bf16 v[108:111], v[244:247], v[148:151], v[108:111]
    ds_read_b64_tr_b16 v[240:241], v20 offset:57344
    v_mfma_f32_16x16x32_bf16 v[112:115], v[244:247], v[152:155], v[112:115]
    ds_read_b64_tr_b16 v[242:243], v20 offset:58368
    s_waitcnt lgkmcnt(6)
    v_mfma_f32_16x16x32_bf16 v[116:119], v[228:231], v[148:151], v[116:119]
    ds_read_b64_tr_b16 v[244:245], v21 offset:57344
    v_mfma_f32_16x16x32_bf16 v[120:123], v[228:231], v[152:155], v[120:123]
    ds_read_b64_tr_b16 v[246:247], v21 offset:58368
    s_waitcnt lgkmcnt(6)
    s_waitcnt vmcnt(3)
    v_mfma_f32_16x16x32_bf16 v[124:127], v[232:235], v[156:159], v[124:127]
    ds_read_b64_tr_b16 v[228:229], v22 offset:61440
    v_mfma_f32_16x16x32_bf16 v[128:131], v[232:235], v[160:163], v[128:131]
    ds_read_b64_tr_b16 v[230:231], v22 offset:62464
    s_waitcnt lgkmcnt(6)
    v_mfma_f32_16x16x32_bf16 v[132:135], v[236:239], v[156:159], v[132:135]
    ds_read_b64_tr_b16 v[232:233], v23 offset:61440
    v_mfma_f32_16x16x32_bf16 v[136:139], v[236:239], v[160:163], v[136:139]
    ds_read_b64_tr_b16 v[234:235], v23 offset:62464
    s_waitcnt lgkmcnt(6)
    v_mfma_f32_16x16x32_bf16 v[108:111], v[240:243], v[156:159], v[108:111]
    ds_read_b64_tr_b16 v[236:237], v20 offset:61440
    v_mfma_f32_16x16x32_bf16 v[112:115], v[240:243], v[160:163], v[112:115]
    ds_read_b64_tr_b16 v[238:239], v20 offset:62464
    s_waitcnt lgkmcnt(6)
    v_mfma_f32_16x16x32_bf16 v[116:119], v[244:247], v[156:159], v[116:119]
    ds_read_b64_tr_b16 v[240:241], v21 offset:61440
    v_mfma_f32_16x16x32_bf16 v[120:123], v[244:247], v[160:163], v[120:123]
    ds_read_b64_tr_b16 v[242:243], v21 offset:62464
    s_waitcnt lgkmcnt(6)
    s_waitcnt vmcnt(1)
    v_mfma_f32_16x16x32_bf16 v[124:127], v[228:231], v[164:167], v[124:127]
    v_mfma_f32_16x16x32_bf16 v[128:131], v[228:231], v[168:171], v[128:131]
    s_waitcnt lgkmcnt(4)
    v_mfma_f32_16x16x32_bf16 v[132:135], v[232:235], v[164:167], v[132:135]
    v_mfma_f32_16x16x32_bf16 v[136:139], v[232:235], v[168:171], v[136:139]
    s_waitcnt lgkmcnt(2)
    v_mfma_f32_16x16x32_bf16 v[108:111], v[236:239], v[164:167], v[108:111]
    v_mfma_f32_16x16x32_bf16 v[112:115], v[236:239], v[168:171], v[112:115]
    s_waitcnt lgkmcnt(0)
    v_mfma_f32_16x16x32_bf16 v[116:119], v[240:243], v[164:167], v[116:119]
    v_mfma_f32_16x16x32_bf16 v[120:123], v[240:243], v[168:171], v[120:123]
    s_setprio 0
    s_lshl_b32 s13, s3, 12
    v_add_u32 v4, s13, v2
    ds_write_b128 v4, v[124:127]
    ds_write_b128 v4, v[128:131] offset:1024
    ds_write_b128 v4, v[132:135] offset:2048
    ds_write_b128 v4, v[136:139] offset:3072
    v_permlane16_swap_b32 v108, v112
    v_permlane16_swap_b32 v109, v113
    v_permlane16_swap_b32 v110, v114
    v_permlane16_swap_b32 v111, v115
    v_permlane16_swap_b32 v116, v120
    v_permlane16_swap_b32 v117, v121
    v_permlane16_swap_b32 v118, v122
    v_permlane16_swap_b32 v119, v123
    s_xor_b32 s96, s3, 4
    s_lshl_b32 s13, s96, 12
    v_and_b32 v5, 15, v1
    v_lshl_add_u32 v5, v5, 4, s13
    v_bfe_u32 v9, v1, 4, 1
    v_lshl_add_u32 v5, v9, 10, v5
    v_lshrrev_b32 v9, 5, v1
    v_lshl_add_u32 v5, v9, 9, v5
    s_lshl_b32 s96, s76, 11
    s_and_b32 s97, s3, 3
    s_lshl_b32 s98, s97, 9
    s_add_u32 s99, s96, s98
    s_add_u32 s13, s99, 131072
    v_and_b32 v6, 31, v1
    v_lshl_add_u32 v6, v6, 4, s13
    v_lshrrev_b32 v9, 5, v1
    v_lshl_add_u32 v6, v9, 3, v6
    s_lshl_b32 s96, s76, 6
    s_add_u32 s13, s96, 139008
    v_and_b32 v7, 7, v1
    v_lshl_add_u32 v7, v7, 2, s13
    v_lshrrev_b32 v9, 5, v1
    v_lshl_add_u32 v7, v9, 5, v7
    s_lshl_b32 s96, s21, 15
    s_lshl_b32 s97, s3, 8
    s_add_u32 s98, s96, s97
    s_add_u32 s19, s98, 12582912
    v_and_b32 v44, 15, v1
    v_lshlrev_b32 v44, 4, v44
    v_lshrrev_b32 v9, 4, v1
    v_lshl_add_u32 v44, v9, 11, v44
    v_mov_b32 v232, 0x3f803f80
    s_waitcnt lgkmcnt(0)
    s_barrier
    ds_read_b128 v[124:127], v5
    ds_read_b128 v[128:131], v5 offset:256
    ds_read_b128 v[132:135], v5 offset:2048
    ds_read_b128 v[136:139], v5 offset:2304
    s_add_u32 s14, s80, 114688
    s_lshl2_add_u32 m0, s89, 67584
    s_nop 0
    buffer_load_dwordx4 v72, s[56:59], s14 offen nt lds
    s_add_u32 s14, s80, 172032
    s_lshl2_add_u32 m0, s89, 68608
    s_nop 0
    buffer_load_dwordx4 v72, s[56:59], s14 offen nt lds
    s_mov_b32 s14, s81
    s_lshl2_add_u32 m0, s89, 98304
    s_nop 0
    buffer_load_dwordx4 v73, s[60:63], s14 offen nt lds
    s_waitcnt lgkmcnt(3)
    v_pk_add_f32 v[108:109], v[108:109], v[124:125]
    v_pk_add_f32 v[110:111], v[110:111], v[126:127]
    s_waitcnt lgkmcnt(2)
    v_pk_add_f32 v[112:113], v[112:113], v[128:129]
    v_pk_add_f32 v[114:115], v[114:115], v[130:131]
    v_cvt_pk_bf16_f32 v108, 0, v108
    v_cvt_pk_bf16_f32 v109, 0, v109
    v_cvt_pk_bf16_f32 v110, 0, v110
    v_cvt_pk_bf16_f32 v111, 0, v111
    v_cvt_pk_bf16_f32 v112, 0, v112
    v_cvt_pk_bf16_f32 v113, 0, v113
    v_cvt_pk_bf16_f32 v114, 0, v114
    v_cvt_pk_bf16_f32 v115, 0, v115
    v_pk_mul_f32 v[108:109], v[108:109], v[76:77]
    v_pk_mul_f32 v[110:111], v[110:111], v[78:79]
    v_pk_mul_f32 v[112:113], v[112:113], v[80:81]
    v_pk_mul_f32 v[114:115], v[114:115], v[82:83]
    v_cvt_pk_bf16_f32 v108, 0, v108
    v_cvt_pk_bf16_f32 v109, 0, v109
    v_cvt_pk_bf16_f32 v110, 0, v110
    v_cvt_pk_bf16_f32 v111, 0, v111
    v_cvt_pk_bf16_f32 v112, 0, v112
    v_cvt_pk_bf16_f32 v113, 0, v113
    v_cvt_pk_bf16_f32 v114, 0, v114
    v_cvt_pk_bf16_f32 v115, 0, v115
    v_pk_add_f32 v[108:109], v[108:109], v[28:29]
    v_pk_add_f32 v[110:111], v[110:111], v[30:31]
    v_pk_add_f32 v[112:113], v[112:113], v[32:33]
    v_pk_add_f32 v[114:115], v[114:115], v[34:35]
    v_cvt_pk_bf16_f32 v12, v108, v109
    v_cvt_pk_bf16_f32 v13, v110, v111
    v_cvt_pk_bf16_f32 v14, v112, v113
    v_cvt_pk_bf16_f32 v15, v114, v115
    s_waitcnt lgkmcnt(1)
    v_pk_add_f32 v[116:117], v[116:117], v[132:133]
    v_pk_add_f32 v[118:119], v[118:119], v[134:135]
    s_waitcnt lgkmcnt(0)
    v_pk_add_f32 v[120:121], v[120:121], v[136:137]
    v_pk_add_f32 v[122:123], v[122:123], v[138:139]
    v_cvt_pk_bf16_f32 v116, 0, v116
    v_cvt_pk_bf16_f32 v117, 0, v117
    v_cvt_pk_bf16_f32 v118, 0, v118
    v_cvt_pk_bf16_f32 v119, 0, v119
    v_cvt_pk_bf16_f32 v120, 0, v120
    v_cvt_pk_bf16_f32 v121, 0, v121
    v_cvt_pk_bf16_f32 v122, 0, v122
    v_cvt_pk_bf16_f32 v123, 0, v123
    v_pk_mul_f32 v[116:117], v[116:117], v[84:85]
    v_pk_mul_f32 v[118:119], v[118:119], v[86:87]
    v_pk_mul_f32 v[120:121], v[120:121], v[88:89]
    v_pk_mul_f32 v[122:123], v[122:123], v[90:91]
    v_cvt_pk_bf16_f32 v116, 0, v116
    v_cvt_pk_bf16_f32 v117, 0, v117
    v_cvt_pk_bf16_f32 v118, 0, v118
    v_cvt_pk_bf16_f32 v119, 0, v119
    v_cvt_pk_bf16_f32 v120, 0, v120
    v_cvt_pk_bf16_f32 v121, 0, v121
    v_cvt_pk_bf16_f32 v122, 0, v122
    v_cvt_pk_bf16_f32 v123, 0, v123
    v_pk_add_f32 v[116:117], v[116:117], v[36:37]
    v_pk_add_f32 v[118:119], v[118:119], v[38:39]
    v_pk_add_f32 v[120:121], v[120:121], v[40:41]
    v_pk_add_f32 v[122:123], v[122:123], v[42:43]
    v_cvt_pk_bf16_f32 v16, v116, v117
    v_cvt_pk_bf16_f32 v17, v118, v119
    v_cvt_pk_bf16_f32 v18, v120, v121
    v_cvt_pk_bf16_f32 v19, v122, v123
    v_mfma_f32_32x32x16_bf16 v[124:139], v[92:95], v[12:15], 0
    s_nop 0
    v_mfma_f32_32x32x16_bf16 v[124:139], v[96:99], v[16:19], v[124:139]
    v_dot2_f32_bf16 v228, v12, v12, 0
    v_dot2_f32_bf16 v229, v13, v13, 0
    v_dot2_f32_bf16 v228, v14, v14, v228
    v_dot2_f32_bf16 v229, v15, v15, v229
    v_dot2_f32_bf16 v228, v16, v16, v228
    v_dot2_f32_bf16 v229, v17, v17, v229
    v_dot2_f32_bf16 v228, v18, v18, v228
    v_dot2_f32_bf16 v229, v19, v19, v229
    s_nop 2
    v_add_f32 v230, v228, v229
    v_add_f32 v228, v228, v229
    s_nop 1
    v_permlane32_swap_b32 v228, v230
    s_mov_b32 exec_lo, 0
    v_add_f32 v124, v228, v230
    v_mov_b32 v125, v126
    s_mov_b32 exec_lo, -1
    ds_write_b64 v6, v[124:125]
    ds_write_b32 v7, v68
    ds_write_b32 v7, v69 offset:128
    ds_write_b32 v7, v70 offset:256
    ds_write_b32 v7, v71 offset:384
    v_add_u32 v4, 131072, v2
    v_and_b32 v5, 7, v1
    v_lshlrev_b32 v5, 15, v5
    v_bfe_u32 v9, v1, 3, 1
    v_lshl_add_u32 v5, v9, 12, v5
    s_lshl4_add_u32 s96, s21, s12
    s_lshl_b32 s97, s96, 11
    s_add_u32 s13, s97, 12582912
    s_and_b32 s96, s12, 1
    s_lshr_b32 s97, s21, 2
    s_and_b32 s98, s21, 3
    s_lshl_b32 s99, s98, 6
    s_lshl1_add_u32 s98, s97, s99
    s_lshl_b32 s97, s98, 12
    s_lshr_b32 s99, s12, 1
    s_lshl_b32 s98, s99, 6
    s_add_u32 s99, s97, s98
    s_lshl2_add_u32 s97, s96, s99
    s_add_u32 s98, s97, 1048576
    s_add_u32 s16, s98, 1536
    s_waitcnt lgkmcnt(0)
    s_barrier
    s_cmp_lg_u32 s3, 0
    s_cbranch_scc1 L_PE
    ds_read_b128 v[124:127], v4 offset:0
    ds_read_b128 v[128:131], v4 offset:2048
    ds_read_b128 v[132:135], v4 offset:1024
    ds_read_b128 v[136:139], v4 offset:3072
    s_waitcnt lgkmcnt(2)
    v_pk_add_f32 v[124:125], v[124:125], v[128:129]
    v_pk_add_f32 v[126:127], v[126:127], v[130:131]
    v_add_f32 v125, v125, v127
    v_mov_b32 v127, s4
    s_waitcnt lgkmcnt(0)
    v_pk_add_f32 v[132:133], v[132:133], v[136:137]
    v_pk_add_f32 v[134:135], v[134:135], v[138:139]
    v_add_f32 v133, v133, v135
    v_mov_b32 v135, s4
    buffer_store_dwordx4 v[124:127], v2, s[32:35], s13 offen sc1
    buffer_store_dwordx4 v[132:135], v2, s[32:35], s13 offen offset:1024 sc1
    s_mov_b64 exec, 0xffff
    buffer_store_dword v127, v5, s[32:35], s16 offen sc1
    s_mov_b64 exec, -1
L_PE:
    s_load_dwordx2 s[24:25], s[32:33], s92 offset:1536 glc
    s_and_b32 s96, s3, 3
    s_mul_i32 s97, s96, 4608
    s_lshl_b32 s98, s76, 6
    s_add_u32 s16, s97, s98
    v_and_b32 v23, 31, v1
    v_mul_u32_u24 v23, 144, v23
    v_lshrrev_b32 v9, 5, v1
    v_lshl_add_u32 v23, v9, 5, v23
    v_add_u32 v23, s16, v23
    ds_write_b128 v23, v[12:15]
    ds_write_b128 v23, v[16:19] offset:16
    v_add_u32 v23, 139776, v23
    s_lshl3_add_u32 s96, s21, s3
    s_lshl_b32 s97, s96, 5
    s_sub_u32 s15, 4094, s97
    v_and_b32 v22, 15, v1
    v_lshlrev_b32 v22, 1, v22
    v_sub_u32 v22, s15, v22
    s_lshl_b32 s96, s3, 7
    s_add_u32 s15, s96, 135168
    v_and_b32 v8, 15, v1
    v_lshl_add_u32 v8, v8, 3, s15
    s_and_b32 s96, s3, 3
    s_lshl_b32 s97, s96, 8
    s_add_u32 s15, s97, 135168
    v_and_b32 v10, 31, v1
    v_lshl_add_u32 v10, v10, 3, s15
    v_and_b32 v11, 7, v1
    v_lshlrev_b32 v11, 3, v11
    v_add_u32 v11, 136192, v11
    s_waitcnt vmcnt(3)
    v_cmp_ne_u32 vcc, s4, v27
    s_cbranch_vccz TOK_38
POLL_39:
    buffer_load_dwordx2 v[26:27], v25, s[32:35], s18 offen sc1
    s_waitcnt vmcnt(0)
    v_cmp_ne_u32 vcc, s4, v27
    s_cbranch_vccz PDONE_40
    s_add_u32 s5, s5, 1
    s_cmp_lt_u32 s5, 300000
    s_cbranch_scc1 POLL_39
PDONE_40:
TOK_38:
    v_add_f32_dpp v26, v26, v26 quad_perm:[1,0,3,2] row_mask:0xf bank_mask:0xf
    s_nop 1
    v_add_f32_dpp v26, v26, v26 quad_perm:[2,3,0,1] row_mask:0xf bank_mask:0xf
    s_nop 1
    v_add_f32_dpp v26, v26, v26 row_half_mirror row_mask:0xf bank_mask:0xf
    s_nop 1
    v_add_f32_dpp v26, v26, v26 row_ror:8 row_mask:0xf bank_mask:0xf
    s_cmp_lg_u32 s3, 1
    s_cbranch_scc1 L_NOCT
    v_and_b32 v5, 15, v1
    v_lshlrev_b32 v5, 3, v5
    v_add_u32 v5, 139008, v5
    ds_read_b64 v[150:151], v5
    ds_read_b64 v[154:155], v5 offset:128
    ds_read_b64 v[156:157], v5 offset:384
    s_waitcnt lgkmcnt(0)
    v_lshlrev_b32 v148, 16, v150
    v_and_b32 v149, s6, v150
    v_lshlrev_b32 v150, 16, v151
    v_and_b32 v151, s6, v151
    v_lshlrev_b32 v152, 16, v154
    v_and_b32 v153, s6, v154
    v_lshlrev_b32 v154, 16, v155
    v_and_b32 v155, s6, v155
L_NOCT:
    s_cmp_lt_u32 s3, 4
    s_cbranch_scc1 L_NOST
    s_sub_u32 s96, s3, 4
    s_lshl_b32 s97, s96, 12
    s_add_u32 s13, s97, 32768
    v_add_u32 v4, s13, v2
    v_add_u32 v7, 65536, v4
    ds_write_b128 v4, v[176:179] offset:16384
    ds_write_b128 v4, v[180:183]
    ds_write_b128 v4, v[184:187] offset:17408
    ds_write_b128 v4, v[188:191] offset:1024
    ds_write_b128 v4, v[192:195] offset:18432
    ds_write_b128 v4, v[196:199] offset:2048
    ds_write_b128 v4, v[200:203] offset:19456
    ds_write_b128 v4, v[204:207] offset:3072
    ds_write_b128 v4, v[208:211] offset:49152
    ds_write_b128 v4, v[212:215] offset:32768
    ds_write_b128 v4, v[216:219] offset:50176
    ds_write_b128 v4, v[220:223] offset:33792
L_NOST:
    s_branch SCHK_36
SPOLL_35:
    s_load_dwordx2 s[24:25], s[32:33], s92 offset:1536 glc
SCHK_36:
    s_add_u32 s5, s5, 1
    s_cmp_ge_u32 s5, 300000
    s_waitcnt lgkmcnt(0)
    s_cbranch_scc1 SDONE_37
    s_cmp_lg_u32 s24, s4
    s_cbranch_scc1 SPOLL_35
    s_cmp_lg_u32 s25, s4
    s_cbranch_scc1 SPOLL_35
SDONE_37:
    s_barrier
    s_mov_b32 s13, s19
    buffer_load_dwordx4 v[124:127], v44, s[32:35], s13 offen sc1
    s_add_u32 s13, s19, 8192
    buffer_load_dwordx4 v[128:131], v44, s[32:35], s13 offen sc1
    s_add_u32 s13, s19, 16384
    buffer_load_dwordx4 v[132:135], v44, s[32:35], s13 offen sc1
    s_add_u32 s13, s19, 24576
    buffer_load_dwordx4 v[136:139], v44, s[32:35], s13 offen sc1
    v_lshlrev_b32 v28, 16, v12
    v_and_b32 v29, s6, v12
    v_lshlrev_b32 v30, 16, v13
    v_and_b32 v31, s6, v13
    v_lshlrev_b32 v32, 16, v14
    v_and_b32 v33, s6, v14
    v_lshlrev_b32 v34, 16, v15
    v_and_b32 v35, s6, v15
    v_lshlrev_b32 v36, 16, v16
    v_and_b32 v37, s6, v16
    v_lshlrev_b32 v38, 16, v17
    v_and_b32 v39, s6, v17
    v_lshlrev_b32 v40, 16, v18
    v_and_b32 v41, s6, v18
    v_lshlrev_b32 v42, 16, v19
    v_and_b32 v43, s6, v19
    v_mul_u32_u24_dpp v92, v68, v52 row_newbcast:0 row_mask:0xf bank_mask:0xf
    v_and_b32_dpp v93, v68, v53 row_newbcast:0 row_mask:0xf bank_mask:0xf
    v_mul_u32_u24_dpp v94, v68, v52 row_newbcast:1 row_mask:0xf bank_mask:0xf
    v_and_b32_dpp v95, v68, v53 row_newbcast:1 row_mask:0xf bank_mask:0xf
    v_mul_u32_u24_dpp v96, v68, v52 row_newbcast:2 row_mask:0xf bank_mask:0xf
    v_and_b32_dpp v97, v68, v53 row_newbcast:2 row_mask:0xf bank_mask:0xf
    v_mul_u32_u24_dpp v98, v68, v52 row_newbcast:3 row_mask:0xf bank_mask:0xf
    v_and_b32_dpp v99, v68, v53 row_newbcast:3 row_mask:0xf bank_mask:0xf
    v_mul_u32_u24_dpp v100, v68, v52 row_newbcast:4 row_mask:0xf bank_mask:0xf
    v_and_b32_dpp v101, v68, v53 row_newbcast:4 row_mask:0xf bank_mask:0xf
    v_mul_u32_u24_dpp v102, v68, v52 row_newbcast:5 row_mask:0xf bank_mask:0xf
    v_and_b32_dpp v103, v68, v53 row_newbcast:5 row_mask:0xf bank_mask:0xf
    v_mul_u32_u24_dpp v104, v68, v52 row_newbcast:6 row_mask:0xf bank_mask:0xf
    v_and_b32_dpp v105, v68, v53 row_newbcast:6 row_mask:0xf bank_mask:0xf
    v_mul_u32_u24_dpp v106, v68, v52 row_newbcast:7 row_mask:0xf bank_mask:0xf
    v_and_b32_dpp v107, v68, v53 row_newbcast:7 row_mask:0xf bank_mask:0xf
    v_mul_u32_u24_dpp v108, v69, v52 row_newbcast:0 row_mask:0xf bank_mask:0xf
    v_and_b32_dpp v109, v69, v53 row_newbcast:0 row_mask:0xf bank_mask:0xf
    v_mul_u32_u24_dpp v110, v69, v52 row_newbcast:1 row_mask:0xf bank_mask:0xf
    v_and_b32_dpp v111, v69, v53 row_newbcast:1 row_mask:0xf bank_mask:0xf
    v_mul_u32_u24_dpp v112, v69, v52 row_newbcast:2 row_mask:0xf bank_mask:0xf
    v_and_b32_dpp v113, v69, v53 row_newbcast:2 row_mask:0xf bank_mask:0xf
    v_mul_u32_u24_dpp v114, v69, v52 row_newbcast:3 row_mask:0xf bank_mask:0xf
    v_and_b32_dpp v115, v69, v53 row_newbcast:3 row_mask:0xf bank_mask:0xf
    v_mul_u32_u24_dpp v116, v69, v52 row_newbcast:4 row_mask:0xf bank_mask:0xf
    v_and_b32_dpp v117, v69, v53 row_newbcast:4 row_mask:0xf bank_mask:0xf
    v_mul_u32_u24_dpp v118, v69, v52 row_newbcast:5 row_mask:0xf bank_mask:0xf
    v_and_b32_dpp v119, v69, v53 row_newbcast:5 row_mask:0xf bank_mask:0xf
    v_mul_u32_u24_dpp v120, v69, v52 row_newbcast:6 row_mask:0xf bank_mask:0xf
    v_and_b32_dpp v121, v69, v53 row_newbcast:6 row_mask:0xf bank_mask:0xf
    v_mul_u32_u24_dpp v122, v69, v52 row_newbcast:7 row_mask:0xf bank_mask:0xf
    v_and_b32_dpp v123, v69, v53 row_newbcast:7 row_mask:0xf bank_mask:0xf
    s_waitcnt vmcnt(0)
    v_bitop3_b32 v4, v127, v131, s4 bitop3:0x7e
    v_bitop3_b32 v4, v4, v135, s4 bitop3:0xf6
    v_bitop3_b32 v4, v4, v139, s4 bitop3:0xf6
    v_cmp_ne_u32 vcc, 0, v4
    s_cbranch_vccz TOK_42
POLL_43:
    s_mov_b32 s13, s19
    buffer_load_dwordx4 v[124:127], v44, s[32:35], s13 offen sc1
    s_add_u32 s13, s19, 8192
    buffer_load_dwordx4 v[128:131], v44, s[32:35], s13 offen sc1
    s_add_u32 s13, s19, 16384
    buffer_load_dwordx4 v[132:135], v44, s[32:35], s13 offen sc1
    s_add_u32 s13, s19, 24576
    buffer_load_dwordx4 v[136:139], v44, s[32:35], s13 offen sc1
    s_waitcnt vmcnt(0)
    v_bitop3_b32 v4, v127, v131, s4 bitop3:0x7e
    v_bitop3_b32 v4, v4, v135, s4 bitop3:0xf6
    v_bitop3_b32 v4, v4, v139, s4 bitop3:0xf6
    v_cmp_ne_u32 vcc, 0, v4
    s_cbranch_vccz PDONE_44
    s_add_u32 s5, s5, 1
    s_cmp_lt_u32 s5, 300000
    s_cbranch_scc1 POLL_43
PDONE_44:
TOK_42:
    s_lshl2_add_u32 s96, s74, s75
    s_lshl_b32 s97, s96, 11
    s_lshl_b32 s98, s3, 8
    s_add_u32 s99, s97, s98
    s_add_u32 s15, s99, 20971520
    v_lshlrev_b32 v44, 7, v1
    s_mov_b64 exec, 3
    buffer_load_dword v44, v44, s[32:35], s15 offen
    s_mov_b64 exec, -1
    s_add_u32 s15, s81, 4096
    s_lshl2_add_u32 m0, s89, 99328
    s_nop 0
    buffer_load_dwordx4 v73, s[60:63], s15 offen nt lds
    v_pk_add_f32 v[124:125], v[124:125], v[128:129]
    v_pk_add_f32 v[132:133], v[132:133], v[136:137]
    v_add_f32 v126, v126, v130
    v_add_f32 v134, v134, v138
    v_pk_add_f32 v[124:125], v[124:125], v[132:133]
    v_add_f32 v126, v126, v134
    v_mov_b32 v127, v125
    s_nop 0
    v_permlane32_swap_b32 v124, v126
    v_permlane32_swap_b32 v125, v127
    v_add_f32 v124, v124, v126
    v_add_f32 v125, v125, v127
    s_nop 1
    v_permlane16_swap_b32 v124, v125
    v_add_f32 v127, v124, v125
    v_add_f32 v124, v124, v125
    s_nop 1
    v_permlane16_swap_b32 v124, v127
    v_mul_f32 v126, 0x3a800000, v124
    v_mul_f32 v124, 0x3a800000, v124
    s_nop 1
    v_permlane32_swap_b32 v124, v126
    v_fma_f32 v21, -v124, v124, v126
    v_cvt_pk_bf16_f32 v20, 0, v124
    v_max_f32 v21, 0, v21
    v_cvt_pk_bf16_f32 v21, 0, v21
    v_add_f32 v21, 0x3727c5ac, v21
    v_cvt_pk_bf16_f32 v21, 0, v21
    v_sqrt_f32 v21, v21
    s_nop 0
    v_cvt_pk_bf16_f32 v21, 0, v21
    s_lshl3_add_u32 s13, s3, 136192
    v_rcp_f32 v21, v21
    v_fma_f32 v127, -v20, v26, v127
    v_mov_b32 v5, s13
    v_mul_f32 v127, v127, v21
    ds_write_b64 v8, v[20:21]
    s_movk_i32 s13, 0xfff
    v_ashrrev_i32 v124, 31, v127
    v_or_b32 v124, 0x80000000, v124
    v_xor_b32 v124, v124, v127
    v_bfi_b32 v48, s13, v22, v124
    s_nop 1
    v_min_u32_dpp v49, v48, v48 row_ror:8 row_mask:0xf bank_mask:0xf
    v_max_u32_dpp v48, v48, v48 row_ror:8 row_mask:0xf bank_mask:0xf
    s_nop 1
    v_min_u32_dpp v50, v48, v48 row_ror:4 row_mask:0xf bank_mask:0xf
    v_max_u32_dpp v49, v49, v49 row_ror:4 row_mask:0xf bank_mask:0xf
    v_max_u32_dpp v48, v48, v48 row_ror:4 row_mask:0xf bank_mask:0xf
    v_max_u32 v49, v49, v50
    s_nop 0
    v_min_u32_dpp v50, v48, v48 row_ror:2 row_mask:0xf bank_mask:0xf
    v_max_u32_dpp v49, v49, v49 row_ror:2 row_mask:0xf bank_mask:0xf
    v_max_u32_dpp v48, v48, v48 row_ror:2 row_mask:0xf bank_mask:0xf
    v_max_u32 v49, v49, v50
    s_nop 0
    v_min_u32_dpp v50, v48, v48 row_ror:1 row_mask:0xf bank_mask:0xf
    v_max_u32_dpp v49, v49, v49 row_ror:1 row_mask:0xf bank_mask:0xf
    v_max_u32_dpp v48, v48, v48 row_ror:1 row_mask:0xf bank_mask:0xf
    v_max_u32 v49, v49, v50
    ds_write_b64 v5, v[48:49]
    v_and_b32 v6, 3, v1
    v_lshlrev_b32 v6, 18, v6
    v_bfe_u32 v9, v1, 2, 2
    v_lshl_add_u32 v6, v9, 13, v6
    s_and_b32 s96, s21, 1
    s_and_b32 s97, s12, 7
    s_lshr_b32 s98, s12, 3
    s_lshl3_add_u32 s99, s97, s98
    s_lshl_b32 s97, s99, 12
    s_lshr_b32 s98, s21, 1
    s_lshl_b32 s99, s98, 6
    s_add_u32 s98, s97, s99
    s_lshl4_add_u32 s97, s96, s98
    s_add_u32 s99, s97, 1048576
    s_add_u32 s14, s99, 2560
    s_waitcnt lgkmcnt(0)
    s_barrier
    ds_read_b64 v[48:49], v11
    ds_read_b64 v[20:21], v10
    s_waitcnt lgkmcnt(1)
    v_min_u32_dpp v50, v48, v48 quad_perm:[1,0,3,2] row_mask:0xf bank_mask:0xf
    v_max_u32_dpp v49, v49, v49 quad_perm:[1,0,3,2] row_mask:0xf bank_mask:0xf
    v_max_u32_dpp v48, v48, v48 quad_perm:[1,0,3,2] row_mask:0xf bank_mask:0xf
    v_max_u32 v49, v49, v50
    s_nop 0
    v_min_u32_dpp v50, v48, v48 quad_perm:[2,3,0,1] row_mask:0xf bank_mask:0xf
    v_max_u32_dpp v49, v49, v49 quad_perm:[2,3,0,1] row_mask:0xf bank_mask:0xf
    v_max_u32_dpp v48, v48, v48 quad_perm:[2,3,0,1] row_mask:0xf bank_mask:0xf
    v_max_u32 v49, v49, v50
    s_nop 0
    v_min_u32_dpp v50, v48, v48 row_half_mirror row_mask:0xf bank_mask:0xf
    v_max_u32_dpp v49, v49, v49 row_half_mirror row_mask:0xf bank_mask:0xf
    v_max_u32_dpp v48, v48, v48 row_half_mirror row_mask:0xf bank_mask:0xf
    v_max_u32 v49, v49, v50
    v_or_b32 v50, 1, v49
    v_mov_b32 v49, s4
    v_mov_b32 v51, s4
    s_cmp_lg_u32 s3, 0
    s_cbranch_scc1 L_NOF
    s_mov_b64 exec, 0xffff
    buffer_store_dwordx4 v[48:51], v6, s[32:35], s14 offen sc1
    s_mov_b64 exec, -1
L_NOF:
    s_cmp_lg_u32 s3, 1
    s_cbranch_scc1 L_NOC
    v_and_b32 v4, 16, v1
    v_cmp_eq_u32 vcc, 0, v4
    s_nop 1
    v_cndmask_b32 v4, v50, v48, vcc
    v_not_b32 v4, v4
    v_bfe_u32 v4, v4, 1, 7
    v_lshlrev_b32 v6, 3, v4
    v_mul_u32_u24 v4, 144, v4
    v_add_u32 v6, 135168, v6
    v_and_b32 v5, 15, v1
    v_lshlrev_b32 v5, 3, v5
    v_add_u32 v4, v4, v5
    ds_read_b64 v[128:129], v6
    ds_read_b64 v[124:125], v4 offset:0
    v_and_b32 v6, 15, v1
    v_lshlrev_b32 v6, 4, v6
    v_bfe_u32 v9, v1, 4, 1
    v_lshl_add_u32 v6, v9, 14, v6
    v_lshrrev_b32 v9, 5, v1
    v_lshl_add_u32 v6, v9, 12, v6
    v_bfe_u32 v7, v1, 4, 1
    v_lshlrev_b32 v7, 14, v7
    s_lshl_b32 s96, s21, 15
    s_lshl_b32 s97, s12, 8
    s_add_u32 s98, s96, s97
    s_add_u32 s13, s98, 33554432
    s_lshl_b32 s96, s21, 15
    s_lshl3_add_u32 s97, s12, s96
    s_add_u32 s98, s97, 8192
    s_add_u32 s16, s98, 33554432
    v_mov_b32 v127, s4
    s_waitcnt lgkmcnt(0)
    v_lshlrev_b32 v132, 16, v124
    v_and_b32 v133, s6, v124
    v_lshlrev_b32 v134, 16, v125
    v_and_b32 v135, s6, v125
    v_pk_add_f32 v[132:133], v[132:133], v[128:129] op_sel_hi:[1,0] neg_lo:[0,1] neg_hi:[0,1]
    v_pk_add_f32 v[134:135], v[134:135], v[128:129] op_sel_hi:[1,0] neg_lo:[0,1] neg_hi:[0,1]
    v_cvt_pk_bf16_f32 v132, 0, v132
    v_cvt_pk_bf16_f32 v133, 0, v133
    v_cvt_pk_bf16_f32 v134, 0, v134
    v_cvt_pk_bf16_f32 v135, 0, v135
    v_pk_mul_f32 v[132:133], v[132:133], v[128:129] op_sel:[0,1]
    v_pk_mul_f32 v[134:135], v[134:135], v[128:129] op_sel:[0,1]
    v_cvt_pk_bf16_f32 v132, 0, v132
    v_cvt_pk_bf16_f32 v133, 0, v133
    v_cvt_pk_bf16_f32 v134, 0, v134
    v_cvt_pk_bf16_f32 v135, 0, v135
    v_pk_mul_f32 v[132:133], v[132:133], v[152:153]
    v_pk_mul_f32 v[134:135], v[134:135], v[154:155]
    v_cvt_pk_bf16_f32 v132, 0, v132
    v_cvt_pk_bf16_f32 v133, 0, v133
    v_cvt_pk_bf16_f32 v134, 0, v134
    v_cvt_pk_bf16_f32 v135, 0, v135
    v_pk_add_f32 v[132:133], v[132:133], v[148:149]
    v_pk_add_f32 v[134:135], v[134:135], v[150:151]
    v_mov_b32 v126, v125
    v_mov_b32 v125, s4
    s_mov_b32 exec_hi, 0
    v_cvt_pk_bf16_f32 v124, v132, v133
    v_cvt_pk_bf16_f32 v126, v134, v135
    s_mov_b32 exec_hi, -1
    v_dot2_f32_bf16 v128, v124, v156, 0
    v_mov_b32 v129, s4
    v_dot2_f32_bf16 v128, v126, v157, v128
    buffer_store_dwordx4 v[124:127], v6, s[32:35], s13 offen sc1
    s_nop 1
    v_add_f32_dpp v128, v128, v128 quad_perm:[1,0,3,2] row_mask:0xf bank_mask:0xf
    s_nop 1
    v_add_f32_dpp v128, v128, v128 quad_perm:[2,3,0,1] row_mask:0xf bank_mask:0xf
    s_nop 1
    v_add_f32_dpp v128, v128, v128 row_half_mirror row_mask:0xf bank_mask:0xf
    s_nop 1
    v_add_f32_dpp v128, v128, v128 row_ror:8 row_mask:0xf bank_mask:0xf
    s_mov_b64 exec, 0x10001
    buffer_store_dwordx2 v[128:129], v7, s[32:35], s16 offen sc1
    s_mov_b64 exec, -1
L_NOC:
    s_waitcnt lgkmcnt(0)
    s_mov_b32 exec_lo, 0xff
    s_mov_b32 exec_hi, 0xff
    buffer_store_dwordx2 v[224:225], v226, s[32:35], 0 offen sc1
    s_mov_b64 exec, -1
    s_add_u32 s13, s81, 8192
    s_lshl2_add_u32 m0, s89, 100352
    s_nop 0
    buffer_load_dwordx4 v73, s[60:63], s13 offen nt lds
    s_load_dwordx8 s[24:31], s[32:33], s92 offset:2560 glc
    v_pk_add_f32 v[76:77], v[28:29], v[20:21] op_sel_hi:[1,0] neg_lo:[0,1] neg_hi:[0,1]
    v_pk_add_f32 v[78:79], v[30:31], v[20:21] op_sel_hi:[1,0] neg_lo:[0,1] neg_hi:[0,1]
    v_pk_add_f32 v[80:81], v[32:33], v[20:21] op_sel_hi:[1,0] neg_lo:[0,1] neg_hi:[0,1]
    v_pk_add_f32 v[82:83], v[34:35], v[20:21] op_sel_hi:[1,0] neg_lo:[0,1] neg_hi:[0,1]
    v_pk_add_f32 v[84:85], v[36:37], v[20:21] op_sel_hi:[1,0] neg_lo:[0,1] neg_hi:[0,1]
    v_pk_add_f32 v[86:87], v[38:39], v[20:21] op_sel_hi:[1,0] neg_lo:[0,1] neg_hi:[0,1]
    v_pk_add_f32 v[88:89], v[40:41], v[20:21] op_sel_hi:[1,0] neg_lo:[0,1] neg_hi:[0,1]
    v_pk_add_f32 v[90:91], v[42:43], v[20:21] op_sel_hi:[1,0] neg_lo:[0,1] neg_hi:[0,1]
    v_cvt_pk_bf16_f32 v76, 0, v76
    v_cvt_pk_bf16_f32 v77, 0, v77
    v_cvt_pk_bf16_f32 v78, 0, v78
    v_cvt_pk_bf16_f32 v79, 0, v79
    v_cvt_pk_bf16_f32 v80, 0, v80
    v_cvt_pk_bf16_f32 v81, 0, v81
    v_cvt_pk_bf16_f32 v82, 0, v82
    v_cvt_pk_bf16_f32 v83, 0, v83
    v_cvt_pk_bf16_f32 v84, 0, v84
    v_cvt_pk_bf16_f32 v85, 0, v85
    v_cvt_pk_bf16_f32 v86, 0, v86
    v_cvt_pk_bf16_f32 v87, 0, v87
    v_cvt_pk_bf16_f32 v88, 0, v88
    v_cvt_pk_bf16_f32 v89, 0, v89
    v_cvt_pk_bf16_f32 v90, 0, v90
    v_cvt_pk_bf16_f32 v91, 0, v91
    v_pk_mul_f32 v[76:77], v[76:77], v[20:21] op_sel:[0,1]
    v_pk_mul_f32 v[78:79], v[78:79], v[20:21] op_sel:[0,1]
    v_pk_mul_f32 v[80:81], v[80:81], v[20:21] op_sel:[0,1]
    v_pk_mul_f32 v[82:83], v[82:83], v[20:21] op_sel:[0,1]
    v_pk_mul_f32 v[84:85], v[84:85], v[20:21] op_sel:[0,1]
    v_pk_mul_f32 v[86:87], v[86:87], v[20:21] op_sel:[0,1]
    v_pk_mul_f32 v[88:89], v[88:89], v[20:21] op_sel:[0,1]
    v_pk_mul_f32 v[90:91], v[90:91], v[20:21] op_sel:[0,1]
    v_cvt_pk_bf16_f32 v76, 0, v76
    v_cvt_pk_bf16_f32 v77, 0, v77
    v_cvt_pk_bf16_f32 v78, 0, v78
    v_cvt_pk_bf16_f32 v79, 0, v79
    v_cvt_pk_bf16_f32 v80, 0, v80
    v_cvt_pk_bf16_f32 v81, 0, v81
    v_cvt_pk_bf16_f32 v82, 0, v82
    v_cvt_pk_bf16_f32 v83, 0, v83
    v_cvt_pk_bf16_f32 v84, 0, v84
    v_cvt_pk_bf16_f32 v85, 0, v85
    v_cvt_pk_bf16_f32 v86, 0, v86
    v_cvt_pk_bf16_f32 v87, 0, v87
    v_cvt_pk_bf16_f32 v88, 0, v88
    v_cvt_pk_bf16_f32 v89, 0, v89
    v_cvt_pk_bf16_f32 v90, 0, v90
    v_cvt_pk_bf16_f32 v91, 0, v91
    v_pk_mul_f32 v[76:77], v[76:77], v[108:109]
    v_pk_mul_f32 v[78:79], v[78:79], v[110:111]
    v_pk_mul_f32 v[80:81], v[80:81], v[112:113]
    v_pk_mul_f32 v[82:83], v[82:83], v[114:115]
    v_pk_mul_f32 v[84:85], v[84:85], v[116:117]
    v_pk_mul_f32 v[86:87], v[86:87], v[118:119]
    v_pk_mul_f32 v[88:89], v[88:89], v[120:121]
    v_pk_mul_f32 v[90:91], v[90:91], v[122:123]
    v_cvt_pk_bf16_f32 v76, 0, v76
    v_cvt_pk_bf16_f32 v77, 0, v77
    v_cvt_pk_bf16_f32 v78, 0, v78
    v_cvt_pk_bf16_f32 v79, 0, v79
    v_cvt_pk_bf16_f32 v80, 0, v80
    v_cvt_pk_bf16_f32 v81, 0, v81
    v_cvt_pk_bf16_f32 v82, 0, v82
    v_cvt_pk_bf16_f32 v83, 0, v83
    v_cvt_pk_bf16_f32 v84, 0, v84
    v_cvt_pk_bf16_f32 v85, 0, v85
    v_cvt_pk_bf16_f32 v86, 0, v86
    v_cvt_pk_bf16_f32 v87, 0, v87
    v_cvt_pk_bf16_f32 v88, 0, v88
    v_cvt_pk_bf16_f32 v89, 0, v89
    v_cvt_pk_bf16_f32 v90, 0, v90
    v_cvt_pk_bf16_f32 v91, 0, v91
    v_pk_add_f32 v[76:77], v[76:77], v[92:93]
    v_pk_add_f32 v[78:79], v[78:79], v[94:95]
    v_pk_add_f32 v[80:81], v[80:81], v[96:97]
    v_pk_add_f32 v[82:83], v[82:83], v[98:99]
    v_pk_add_f32 v[84:85], v[84:85], v[100:101]
    v_pk_add_f32 v[86:87], v[86:87], v[102:103]
    v_pk_add_f32 v[88:89], v[88:89], v[104:105]
    v_pk_add_f32 v[90:91], v[90:91], v[106:107]
    v_cvt_pk_bf16_f32 v76, 0, v76
    v_cvt_pk_bf16_f32 v77, 0, v77
    v_cvt_pk_bf16_f32 v78, 0, v78
    v_cvt_pk_bf16_f32 v79, 0, v79
    v_cvt_pk_bf16_f32 v80, 0, v80
    v_cvt_pk_bf16_f32 v81, 0, v81
    v_cvt_pk_bf16_f32 v82, 0, v82
    v_cvt_pk_bf16_f32 v83, 0, v83
    v_cvt_pk_bf16_f32 v84, 0, v84
    v_cvt_pk_bf16_f32 v85, 0, v85
    v_cvt_pk_bf16_f32 v86, 0, v86
    v_cvt_pk_bf16_f32 v87, 0, v87
    v_cvt_pk_bf16_f32 v88, 0, v88
    v_cvt_pk_bf16_f32 v89, 0, v89
    v_cvt_pk_bf16_f32 v90, 0, v90
    v_cvt_pk_bf16_f32 v91, 0, v91
    s_lshr_b32 s96, s3, 2
    s_lshl_b32 s97, s96, 15
    s_and_b32 s98, s3, 3
    s_lshl_b32 s99, s98, 5
    s_add_u32 s96, s97, s99
    s_add_u32 s13, s96, 32768
    v_lshrrev_b32 v24, 4, v1
    v_lshlrev_b32 v24, 13, v24
    v_bfe_u32 v9, v1, 2, 2
    v_lshl_add_u32 v24, v9, 7, v24
    v_bfe_u32 v9, v1, 3, 2
    v_lshl_add_u32 v24, v9, 5, v24
    v_and_b32 v9, 3, v1
    v_lshl_add_u32 v24, v9, 3, v24
    v_xor_b32 v24, s13, v24
    s_lshl_b32 s13, s3, 6
    v_bfe_u32 v45, v1, 2, 1
    v_lshlrev_b32 v45, 9, v45
    v_bfe_u32 v9, v1, 3, 1
    v_lshl_add_u32 v45, v9, 12, v45
    v_lshrrev_b32 v9, 5, v1
    v_lshl_add_u32 v45, v9, 11, v45
    v_bfe_u32 v9, v1, 2, 2
    v_lshl_add_u32 v45, v9, 6, v45
    v_bfe_u32 v9, v1, 4, 1
    v_lshl_add_u32 v45, v9, 5, v45
    v_and_b32 v9, 3, v1
    v_lshl_add_u32 v45, v9, 3, v45
    v_xor_b32 v45, s13, v45
    v_add_u32 v45, 98304, v45
    v_and_b32 v46, 7, v1
    v_lshlrev_b32 v46, 4, v46
    v_lshrrev_b32 v9, 4, v1
    v_lshl_add_u32 v46, v9, 7, v46
    v_add_u32 v46, 136704, v46
    s_lshl4_add_u32 s13, s3, 136256
    v_mov_b32 v4, s13
    v_and_b32 v5, 7, v1
    v_lshlrev_b32 v5, 4, v5
    v_add_u32 v5, 136256, v5
    v_and_b32 v8, 8, v1
    v_cmp_eq_u32 s[22:23], 0, v8
    s_branch SCHK_46
SPOLL_45:
    s_load_dwordx8 s[24:31], s[32:33], s92 offset:2560 glc
SCHK_46:
    s_add_u32 s5, s5, 1
    s_cmp_ge_u32 s5, 300000
    s_waitcnt lgkmcnt(0)
    s_cbranch_scc1 SDONE_47
    s_cmp_lg_u32 s25, s4
    s_cbranch_scc1 SPOLL_45
    s_cmp_lg_u32 s27, s4
    s_cbranch_scc1 SPOLL_45
    s_cmp_lg_u32 s29, s4
    s_cbranch_scc1 SPOLL_45
    s_cmp_lg_u32 s31, s4
    s_cbranch_scc1 SPOLL_45
SDONE_47:
    s_min_u32 s25, s24, s28
    s_max_u32 s24, s24, s28
    s_max_u32 s27, s26, s30
    s_min_u32 s26, s26, s30
    s_max_u32 s28, s25, s27
    s_min_u32 s25, s25, s27
    v_mov_b32 v148, s24
    v_mov_b32 v151, s26
    v_mov_b32 v149, s28
    v_mov_b32 v150, s25
    ds_write_b128 v4, v[148:151]
    s_waitcnt lgkmcnt(0)
    s_barrier
    s_cmp_lt_u32 s3, 4
    s_cbranch_scc1 L_CSEL
    ds_read_b64_tr_b16 v[164:165], v24
    ds_read_b64_tr_b16 v[166:167], v24 offset:512
    ds_read_b64_tr_b16 v[168:169], v24 offset:1024
    ds_read_b64_tr_b16 v[170:171], v24 offset:1536
    ds_read_b64_tr_b16 v[172:173], v24 offset:2048
    ds_read_b64_tr_b16 v[174:175], v24 offset:2560
    ds_read_b64_tr_b16 v[176:177], v24 offset:3072
    ds_read_b64_tr_b16 v[178:179], v24 offset:3584
    ds_read_b64_tr_b16 v[180:181], v24 offset:4096
    ds_read_b64_tr_b16 v[182:183], v24 offset:4608
    ds_read_b64_tr_b16 v[184:185], v24 offset:5120
    ds_read_b64_tr_b16 v[186:187], v24 offset:5632
    ds_read_b64_tr_b16 v[188:189], v24 offset:6144
    ds_read_b64_tr_b16 v[190:191], v24 offset:6656
    ds_read_b64_tr_b16 v[192:193], v24 offset:7168
    ds_read_b64_tr_b16 v[194:195], v24 offset:7680
    v_mul_u32_u24_dpp v92, v70, v52 row_newbcast:0 row_mask:0xf bank_mask:0xf
    v_and_b32_dpp v93, v70, v53 row_newbcast:0 row_mask:0xf bank_mask:0xf
    v_mul_u32_u24_dpp v94, v70, v52 row_newbcast:1 row_mask:0xf bank_mask:0xf
    v_and_b32_dpp v95, v70, v53 row_newbcast:1 row_mask:0xf bank_mask:0xf
    v_mul_u32_u24_dpp v96, v70, v52 row_newbcast:2 row_mask:0xf bank_mask:0xf
    v_and_b32_dpp v97, v70, v53 row_newbcast:2 row_mask:0xf bank_mask:0xf
    v_mul_u32_u24_dpp v98, v70, v52 row_newbcast:3 row_mask:0xf bank_mask:0xf
    v_and_b32_dpp v99, v70, v53 row_newbcast:3 row_mask:0xf bank_mask:0xf
    v_mul_u32_u24_dpp v100, v70, v52 row_newbcast:4 row_mask:0xf bank_mask:0xf
    v_and_b32_dpp v101, v70, v53 row_newbcast:4 row_mask:0xf bank_mask:0xf
    v_mul_u32_u24_dpp v102, v70, v52 row_newbcast:5 row_mask:0xf bank_mask:0xf
    v_and_b32_dpp v103, v70, v53 row_newbcast:5 row_mask:0xf bank_mask:0xf
    v_mul_u32_u24_dpp v104, v70, v52 row_newbcast:6 row_mask:0xf bank_mask:0xf
    v_and_b32_dpp v105, v70, v53 row_newbcast:6 row_mask:0xf bank_mask:0xf
    v_mul_u32_u24_dpp v106, v70, v52 row_newbcast:7 row_mask:0xf bank_mask:0xf
    v_and_b32_dpp v107, v70, v53 row_newbcast:7 row_mask:0xf bank_mask:0xf
    v_pk_mul_f32 v[76:77], v[76:77], v[92:93]
    v_pk_mul_f32 v[78:79], v[78:79], v[94:95]
    v_pk_mul_f32 v[80:81], v[80:81], v[96:97]
    v_pk_mul_f32 v[82:83], v[82:83], v[98:99]
    v_pk_mul_f32 v[84:85], v[84:85], v[100:101]
    v_pk_mul_f32 v[86:87], v[86:87], v[102:103]
    v_pk_mul_f32 v[88:89], v[88:89], v[104:105]
    v_pk_mul_f32 v[90:91], v[90:91], v[106:107]
    v_cvt_pk_bf16_f32 v76, 0, v76
    v_cvt_pk_bf16_f32 v77, 0, v77
    v_cvt_pk_bf16_f32 v78, 0, v78
    v_cvt_pk_bf16_f32 v79, 0, v79
    v_cvt_pk_bf16_f32 v80, 0, v80
    v_cvt_pk_bf16_f32 v81, 0, v81
    v_cvt_pk_bf16_f32 v82, 0, v82
    v_cvt_pk_bf16_f32 v83, 0, v83
    v_cvt_pk_bf16_f32 v84, 0, v84
    v_cvt_pk_bf16_f32 v85, 0, v85
    v_cvt_pk_bf16_f32 v86, 0, v86
    v_cvt_pk_bf16_f32 v87, 0, v87
    v_cvt_pk_bf16_f32 v88, 0, v88
    v_cvt_pk_bf16_f32 v89, 0, v89
    v_cvt_pk_bf16_f32 v90, 0, v90
    v_cvt_pk_bf16_f32 v91, 0, v91
    v_pk_add_f32 v[76:77], v[76:77], v[28:29]
    v_pk_add_f32 v[78:79], v[78:79], v[30:31]
    v_pk_add_f32 v[80:81], v[80:81], v[32:33]
    v_pk_add_f32 v[82:83], v[82:83], v[34:35]
    v_pk_add_f32 v[84:85], v[84:85], v[36:37]
    v_pk_add_f32 v[86:87], v[86:87], v[38:39]
    v_pk_add_f32 v[88:89], v[88:89], v[40:41]
    v_pk_add_f32 v[90:91], v[90:91], v[42:43]
    v_cvt_pk_bf16_f32 v140, v76, v77
    v_cvt_pk_bf16_f32 v141, v78, v79
    v_cvt_pk_bf16_f32 v142, v80, v81
    v_cvt_pk_bf16_f32 v143, v82, v83
    v_cvt_pk_bf16_f32 v144, v84, v85
    v_cvt_pk_bf16_f32 v145, v86, v87
    v_cvt_pk_bf16_f32 v146, v88, v89
    v_cvt_pk_bf16_f32 v147, v90, v91
    ds_write_b128 v23, v[140:143]
    ds_write_b128 v23, v[144:147] offset:16
    s_mul_i32 s96, s3, 2304
    s_add_u32 s16, s96, 139776
    v_lshrrev_b32 v23, 3, v1
    v_mul_u32_u24 v23, 144, v23
    v_and_b32 v9, 7, v1
    v_lshl_add_u32 v23, v9, 4, v23
    v_add_u32 v23, s16, v23
    s_add_u32 s13, s81, 12288
    s_lshl2_add_u32 m0, s89, 101376
    s_nop 0
    buffer_load_dwordx4 v73, s[60:63], s13 offen nt lds
    s_branch L_CSELD
L_CSEL:
    ds_read_b128 v[148:151], v5
    s_lshl_b32 s96, s3, 9
    s_add_u32 s13, s96, 136704
    v_add_u32 v6, s13, v63
    s_lshl2_add_u32 s13, s3, 136384
    v_mov_b32 v7, s13
    s_waitcnt lgkmcnt(0)
    v_max_u32_dpp v152, v151, v148 quad_perm:[1,0,3,2] row_mask:0xf bank_mask:0xf
    v_max_u32_dpp v153, v150, v149 quad_perm:[1,0,3,2] row_mask:0xf bank_mask:0xf
    v_max_u32_dpp v154, v149, v150 quad_perm:[1,0,3,2] row_mask:0xf bank_mask:0xf
    v_max_u32_dpp v155, v148, v151 quad_perm:[1,0,3,2] row_mask:0xf bank_mask:0xf
    v_max_u32 v156, v152, v154
    v_max_u32 v157, v153, v155
    v_min_u32 v158, v152, v154
    v_min_u32 v159, v153, v155
    v_max_u32 v148, v156, v157
    v_min_u32 v149, v156, v157
    v_max_u32 v150, v158, v159
    v_min_u32 v151, v158, v159
    s_nop 1
    v_max_u32_dpp v152, v151, v148 quad_perm:[2,3,0,1] row_mask:0xf bank_mask:0xf
    v_max_u32_dpp v153, v150, v149 quad_perm:[2,3,0,1] row_mask:0xf bank_mask:0xf
    v_max_u32_dpp v154, v149, v150 quad_perm:[2,3,0,1] row_mask:0xf bank_mask:0xf
    v_max_u32_dpp v155, v148, v151 quad_perm:[2,3,0,1] row_mask:0xf bank_mask:0xf
    v_max_u32 v156, v152, v154
    v_max_u32 v157, v153, v155
    v_min_u32 v158, v152, v154
    v_min_u32 v159, v153, v155
    v_max_u32 v148, v156, v157
    v_min_u32 v149, v156, v157
    v_max_u32 v150, v158, v159
    v_min_u32 v151, v158, v159
    s_nop 1
    v_max_u32_dpp v152, v151, v148 row_half_mirror row_mask:0xf bank_mask:0xf
    v_max_u32_dpp v153, v150, v149 row_half_mirror row_mask:0xf bank_mask:0xf
    v_max_u32_dpp v154, v149, v150 row_half_mirror row_mask:0xf bank_mask:0xf
    v_max_u32_dpp v155, v148, v151 row_half_mirror row_mask:0xf bank_mask:0xf
    v_readfirstlane_b32 s24, v152
    v_readfirstlane_b32 s25, v153
    v_readfirstlane_b32 s26, v154
    v_readfirstlane_b32 s27, v155
    s_bitcmp1_b32 s3, 0
    s_cselect_b32 s24, s25, s24
    s_cselect_b32 s26, s27, s26
    s_bitcmp1_b32 s3, 1
    s_cselect_b32 s24, s26, s24
    s_and_b32 s15, s24, 4095
    s_lshr_b32 s96, s15, 8
    s_sub_u32 s97, 15, s96
    s_and_b32 s98, s15, 1
    s_lshl1_add_u32 s99, s97, s98
    s_lshl_b32 s96, s99, 14
    s_add_u32 s13, s96, 33554432
    s_lshl_b32 s96, s75, 10
    s_add_u32 s14, s96, s13
    s_add_u32 s13, s13, 8192
    v_and_b32 v10, 15, v1
    v_lshlrev_b32 v10, 3, v10
    buffer_load_dwordx2 v[152:153], v10, s[32:35], s13 offen sc1
    buffer_load_dwordx4 v[148:151], v2, s[32:35], s14 offen sc1
    s_add_u32 s16, s81, 12288
    s_lshl2_add_u32 m0, s89, 101376
    s_nop 0
    buffer_load_dwordx4 v73, s[60:63], s16 offen nt lds
    ds_read_b64_tr_b16 v[164:165], v24
    ds_read_b64_tr_b16 v[166:167], v24 offset:512
    ds_read_b64_tr_b16 v[168:169], v24 offset:1024
    ds_read_b64_tr_b16 v[170:171], v24 offset:1536
    ds_read_b64_tr_b16 v[172:173], v24 offset:2048
    ds_read_b64_tr_b16 v[174:175], v24 offset:2560
    ds_read_b64_tr_b16 v[176:177], v24 offset:3072
    ds_read_b64_tr_b16 v[178:179], v24 offset:3584
    ds_read_b64_tr_b16 v[180:181], v24 offset:4096
    ds_read_b64_tr_b16 v[182:183], v24 offset:4608
    ds_read_b64_tr_b16 v[184:185], v24 offset:5120
    ds_read_b64_tr_b16 v[186:187], v24 offset:5632
    ds_read_b64_tr_b16 v[188:189], v24 offset:6144
    ds_read_b64_tr_b16 v[190:191], v24 offset:6656
    ds_read_b64_tr_b16 v[192:193], v24 offset:7168
    ds_read_b64_tr_b16 v[194:195], v24 offset:7680
    v_mul_u32_u24_dpp v92, v70, v52 row_newbcast:0 row_mask:0xf bank_mask:0xf
    v_and_b32_dpp v93, v70, v53 row_newbcast:0 row_mask:0xf bank_mask:0xf
    v_mul_u32_u24_dpp v94, v70, v52 row_newbcast:1 row_mask:0xf bank_mask:0xf
    v_and_b32_dpp v95, v70, v53 row_newbcast:1 row_mask:0xf bank_mask:0xf
    v_mul_u32_u24_dpp v96, v70, v52 row_newbcast:2 row_mask:0xf bank_mask:0xf
    v_and_b32_dpp v97, v70, v53 row_newbcast:2 row_mask:0xf bank_mask:0xf
    v_mul_u32_u24_dpp v98, v70, v52 row_newbcast:3 row_mask:0xf bank_mask:0xf
    v_and_b32_dpp v99, v70, v53 row_newbcast:3 row_mask:0xf bank_mask:0xf
    v_mul_u32_u24_dpp v100, v70, v52 row_newbcast:4 row_mask:0xf bank_mask:0xf
    v_and_b32_dpp v101, v70, v53 row_newbcast:4 row_mask:0xf bank_mask:0xf
    v_mul_u32_u24_dpp v102, v70, v52 row_newbcast:5 row_mask:0xf bank_mask:0xf
    v_and_b32_dpp v103, v70, v53 row_newbcast:5 row_mask:0xf bank_mask:0xf
    v_mul_u32_u24_dpp v104, v70, v52 row_newbcast:6 row_mask:0xf bank_mask:0xf
    v_and_b32_dpp v105, v70, v53 row_newbcast:6 row_mask:0xf bank_mask:0xf
    v_mul_u32_u24_dpp v106, v70, v52 row_newbcast:7 row_mask:0xf bank_mask:0xf
    v_and_b32_dpp v107, v70, v53 row_newbcast:7 row_mask:0xf bank_mask:0xf
    v_pk_mul_f32 v[76:77], v[76:77], v[92:93]
    v_pk_mul_f32 v[78:79], v[78:79], v[94:95]
    v_pk_mul_f32 v[80:81], v[80:81], v[96:97]
    v_pk_mul_f32 v[82:83], v[82:83], v[98:99]
    v_pk_mul_f32 v[84:85], v[84:85], v[100:101]
    v_pk_mul_f32 v[86:87], v[86:87], v[102:103]
    v_pk_mul_f32 v[88:89], v[88:89], v[104:105]
    v_pk_mul_f32 v[90:91], v[90:91], v[106:107]
    v_cvt_pk_bf16_f32 v76, 0, v76
    v_cvt_pk_bf16_f32 v77, 0, v77
    v_cvt_pk_bf16_f32 v78, 0, v78
    v_cvt_pk_bf16_f32 v79, 0, v79
    v_cvt_pk_bf16_f32 v80, 0, v80
    v_cvt_pk_bf16_f32 v81, 0, v81
    v_cvt_pk_bf16_f32 v82, 0, v82
    v_cvt_pk_bf16_f32 v83, 0, v83
    v_cvt_pk_bf16_f32 v84, 0, v84
    v_cvt_pk_bf16_f32 v85, 0, v85
    v_cvt_pk_bf16_f32 v86, 0, v86
    v_cvt_pk_bf16_f32 v87, 0, v87
    v_cvt_pk_bf16_f32 v88, 0, v88
    v_cvt_pk_bf16_f32 v89, 0, v89
    v_cvt_pk_bf16_f32 v90, 0, v90
    v_cvt_pk_bf16_f32 v91, 0, v91
    v_pk_add_f32 v[76:77], v[76:77], v[28:29]
    v_pk_add_f32 v[78:79], v[78:79], v[30:31]
    v_pk_add_f32 v[80:81], v[80:81], v[32:33]
    v_pk_add_f32 v[82:83], v[82:83], v[34:35]
    v_pk_add_f32 v[84:85], v[84:85], v[36:37]
    v_pk_add_f32 v[86:87], v[86:87], v[38:39]
    v_pk_add_f32 v[88:89], v[88:89], v[40:41]
    v_pk_add_f32 v[90:91], v[90:91], v[42:43]
    v_cvt_pk_bf16_f32 v140, v76, v77
    v_cvt_pk_bf16_f32 v141, v78, v79
    v_cvt_pk_bf16_f32 v142, v80, v81
    v_cvt_pk_bf16_f32 v143, v82, v83
    v_cvt_pk_bf16_f32 v144, v84, v85
    v_cvt_pk_bf16_f32 v145, v86, v87
    v_cvt_pk_bf16_f32 v146, v88, v89
    v_cvt_pk_bf16_f32 v147, v90, v91
    ds_write_b128 v23, v[140:143]
    ds_write_b128 v23, v[144:147] offset:16
    s_mul_i32 s96, s3, 2304
    s_add_u32 s16, s96, 139776
    v_lshrrev_b32 v23, 3, v1
    v_mul_u32_u24 v23, 144, v23
    v_and_b32 v9, 7, v1
    v_lshl_add_u32 v23, v9, 4, v23
    v_add_u32 v23, s16, v23
    s_lshl2_add_u32 s15, s15, s3
    s_waitcnt vmcnt(1)
    v_bitop3_b32 v8, v149, v151, s4 bitop3:0x7e
    v_bitop3_b32 v8, v8, v153, s4 bitop3:0xf6
    v_cmp_ne_u32 vcc, 0, v8
    s_cbranch_vccz TOK_49
POLL_50:
    buffer_load_dwordx2 v[152:153], v10, s[32:35], s13 offen sc1
    buffer_load_dwordx4 v[148:151], v2, s[32:35], s14 offen sc1
    s_waitcnt vmcnt(0)
    v_bitop3_b32 v8, v149, v151, s4 bitop3:0x7e
    v_bitop3_b32 v8, v8, v153, s4 bitop3:0xf6
    v_cmp_ne_u32 vcc, 0, v8
    s_cbranch_vccz PDONE_51
    s_add_u32 s5, s5, 1
    s_cmp_lt_u32 s5, 300000
    s_cbranch_scc1 POLL_50
PDONE_51:
TOK_49:
    ds_write2_b32 v6, v148, v150 offset0:0 offset1:1
    v_add_f32_dpp v152, v152, v152 quad_perm:[1,0,3,2] row_mask:0xf bank_mask:0xf
    s_nop 1
    v_add_f32_dpp v152, v152, v152 quad_perm:[2,3,0,1] row_mask:0xf bank_mask:0xf
    s_nop 1
    v_add_f32_dpp v152, v152, v152 row_half_mirror row_mask:0xf bank_mask:0xf
    s_nop 1
    v_add_f32_dpp v152, v152, v152 row_ror:8 row_mask:0xf bank_mask:0xf
    v_cvt_pk_bf16_f32 v152, 0, v152
    v_ashrrev_i32 v153, 31, v152
    v_or_b32 v153, 0x80000000, v153
    v_xor_b32 v152, v152, v153
    v_and_b32 v152, s6, v152
    v_or_b32 v152, s15, v152
    ds_write_b32 v7, v152
L_CSELD:
    v_mov_b32 v4, 136384
    v_and_b32 v8, 15, v1
    v_lshlrev_b32 v8, 4, v8
    v_lshrrev_b32 v9, 5, v1
    v_lshl_add_u32 v8, v9, 3, v8
    s_lshl_b32 s96, s74, 13
    s_add_u32 s14, s96, 20971520
    s_lshl3_add_u32 s96, s75, s3
    s_lshl_b32 s97, s96, 8
    s_add_u32 s20, s97, s14
    s_waitcnt lgkmcnt(0)
    s_barrier
    ds_read_b128 v[148:151], v4
    s_waitcnt lgkmcnt(0)
    v_max_u32 v152, v148, v149
    v_max_u32 v153, v150, v151
    v_min_u32 v154, v148, v149
    v_min_u32 v155, v150, v151
    v_min_u32 v149, v152, v153
    v_max_u32 v148, v152, v153
    v_max3_u32 v149, v149, v154, v155
    v_cndmask_b32 v4, v149, v148, s[22:23]
    v_readfirstlane_b32 s68, v148
    v_and_b32 v4, 3, v4
    v_readfirstlane_b32 s69, v149
    v_lshl_add_u32 v4, v4, 9, v46
    ds_read_b128 v[152:155], v4
    ds_read_b128 v[140:143], v23
    ds_read_b128 v[144:147], v23 offset:1152
    s_bfe_u32 s70, s68, 720899
    s_bfe_u32 s71, s69, 720899
    s_sub_u32 s70, 2047, s70
    s_sub_u32 s71, 2047, s71
    s_waitcnt lgkmcnt(2)
    v_mfma_f32_16x16x32_bf16 v[212:215], v[152:155], v[164:167], 0
    v_mfma_f32_16x16x32_bf16 v[216:219], v[152:155], v[168:171], 0
    v_mfma_f32_16x16x32_bf16 v[220:223], v[152:155], v[172:175], 0
    v_mfma_f32_16x16x32_bf16 v[224:227], v[152:155], v[176:179], 0
    v_mfma_f32_16x16x32_bf16 v[228:231], v[152:155], v[180:183], 0
    v_mfma_f32_16x16x32_bf16 v[232:235], v[152:155], v[184:187], 0
    v_mfma_f32_16x16x32_bf16 v[236:239], v[152:155], v[188:191], 0
    v_mfma_f32_16x16x32_bf16 v[240:243], v[152:155], v[192:195], 0
    s_nop 1
    v_add_f32 v148, v212, v217
    s_nop 0
    v_add_f32 v149, v222, v227
    s_nop 0
    v_add_f32 v150, v228, v233
    s_nop 0
    v_add_f32 v151, v238, v243
    v_add_f32 v148, v148, v149
    v_add_f32 v150, v150, v151
    v_mov_b32 v149, s4
    s_nop 0
    v_permlane16_swap_b32 v150, v151
    s_cmp_ge_u32 s9, 28
    s_cbranch_scc1 L_NOHP
    v_add_f32 v148, v148, v151
    s_mov_b32 exec_lo, 0xffff
    s_mov_b32 exec_hi, 0xffff
    s_cmp_lg_u32 s93, 0
    s_cbranch_scc1 LOC_52
    buffer_store_dwordx2 v[148:149], v8, s[32:35], s20 offen sc1
    s_branch LOCD_53
LOC_52:
    buffer_store_dwordx2 v[148:149], v8, s[32:35], s20 offen
LOCD_53:
    s_mov_b64 exec, -1
L_NOHP:
    v_mov_b32 v56, v148
    v_mov_b32 v57, v149
    v_add_u32 v58, s20, v8
    s_waitcnt lgkmcnt(0)
    s_bitcmp1_b32 s21, 2
    s_cselect_b32 s17, s71, s70
    s_cselect_b32 s18, s69, s68
    s_cmp_lg_u32 s3, 7
    s_cbranch_scc1 L_NOFZ
    s_cmp_lg_u32 s2, 0
    s_cbranch_scc1 L_NONON
    v_mov_b32 v6, s4
    s_mov_b64 exec, 1
    buffer_store_dword v6, v3, s[32:35], 0 offen sc1
    s_mov_b64 exec, -1
L_NONON:
    s_lshr_b32 s96, s21, 3
    s_and_b32 s97, s21, 1
    s_lshl1_add_u32 s19, s96, s97
    s_lshr_b32 s96, s21, 2
    s_lshl_b32 s97, s96, 1
    s_lshl3_add_u32 s98, s12, s97
    s_and_b32 s99, s21, 1
    s_add_u32 s96, s98, s99
    s_mul_i32 s97, s96, 7168
    s_add_u32 s20, s97, 22020096
    s_lshl_b32 s96, s17, 11
    s_lshl_b32 s97, s12, 7
    s_add_u32 s98, s96, s97
    s_lshl_b32 s99, s19, 5
    s_add_u32 s82, s98, s99
    v_and_b32 v10, 7, v1
    v_lshlrev_b32 v10, 2, v10
    s_lshl_b32 s96, s19, 5
    s_add_u32 s13, s96, 139264
    v_add_u32 v5, s13, v10
    ds_read_b32 v74, v5
    s_lshr_b32 s96, s17, 7
    s_bfe_u32 s97, s18, 65538
    s_lshl1_add_u32 s98, s96, s97
    s_lshl_b32 s99, s98, 14
    s_lshl_b32 s96, s12, 8
    s_add_u32 s97, s99, s96
    s_lshl_b32 s98, s19, 6
    s_add_u32 s99, s97, s98
    s_add_u32 s68, s99, 33554432
    s_add_u32 s69, s68, 4096
    v_and_b32 v11, 7, v1
    v_lshlrev_b32 v11, 3, v11
    buffer_load_dwordx2 v[20:21], v11, s[32:35], s68 offen sc1
    buffer_load_dwordx2 v[72:73], v11, s[32:35], s69 offen sc1
    s_and_b32 s13, s18, s6
    s_ashr_i32 s15, s13, 31
    s_andn2_b32 s15, 0x7fff0000, s15
    s_or_b32 s15, s15, 0x80000000
    s_xor_b32 s13, s13, s15
    v_mov_b32 v75, s13
    v_mul_f32 v75, s7, v75
    v_exp_f32 v75, -v75
    s_nop 0
    v_add_f32 v75, 1.0, v75
    v_rcp_f32 v75, v75
    s_nop 0
    v_cvt_pk_bf16_f32 v75, 0, v75
L_NOFZ:
    s_cmp_lt_u32 s9, 28
    s_cbranch_scc1 L_HSEC
    s_branch L_GSEC
L_HSEC:
    s_cmp_lt_u32 s3, 4
    s_cbranch_scc1 L_HW
    s_branch L_NOH
L_HW:
    s_lshl_b32 s96, s3, 8
    s_add_u32 s13, s96, s14
    v_lshrrev_b32 v4, 4, v1
    v_lshlrev_b32 v4, 11, v4
    v_and_b32 v9, 15, v1
    v_lshl_add_u32 v4, v9, 4, v4
    s_lshl_b32 s96, s3, 5
    s_add_u32 s15, s96, 138752
    v_lshrrev_b32 v5, 5, v1
    v_lshl_add_u32 v5, v5, 7, s15
    v_bfe_u32 v9, v1, 2, 1
    v_lshl_add_u32 v5, v9, 4, v5
    v_bfe_u32 v9, v1, 1, 1
    v_lshl_add_u32 v5, v9, 3, v5
    v_bfe_u32 v9, v1, 3, 1
    v_lshl_add_u32 v5, v9, 2, v5
    v_and_b32 v9, 1, v1
    v_lshl_add_u32 v5, v9, 1, v5
    s_cmp_lg_u32 s93, 0
    s_cbranch_scc1 L_HLOC
SPOLL_54:
    s_load_dword s24, s[32:33], s13 offset:1276 glc
    s_load_dword s25, s[32:33], s13 offset:3324 glc
    s_load_dword s26, s[32:33], s13 offset:5372 glc
    s_load_dword s27, s[32:33], s13 offset:7420 glc
SCHK_55:
    s_add_u32 s5, s5, 1
    s_cmp_ge_u32 s5, 300000
    s_waitcnt lgkmcnt(0)
    s_cbranch_scc1 SDONE_56
    s_cmp_lg_u32 s24, s4
    s_cbranch_scc1 SPOLL_54
    s_cmp_lg_u32 s25, s4
    s_cbranch_scc1 SPOLL_54
    s_cmp_lg_u32 s26, s4
    s_cbranch_scc1 SPOLL_54
    s_cmp_lg_u32 s27, s4
    s_cbranch_scc1 SPOLL_54
SDONE_56:
L_HLOC:
    buffer_load_dwordx4 v[212:215], v4, s[32:35], s13 offen sc1
    buffer_load_dwordx4 v[216:219], v4, s[32:35], s13 offen offset:1024 sc1
    s_waitcnt vmcnt(0)
    v_bitop3_b32 v6, v213, v215, s4 bitop3:0x7e
    v_bitop3_b32 v6, v6, v217, s4 bitop3:0xf6
    v_bitop3_b32 v6, v6, v219, s4 bitop3:0xf6
    v_cmp_ne_u32 vcc, 0, v6
    s_cbranch_vccz TOK_58
POLL_59:
    buffer_load_dwordx4 v[212:215], v4, s[32:35], s13 offen sc1
    buffer_load_dwordx4 v[216:219], v4, s[32:35], s13 offen offset:1024 sc1
    s_waitcnt vmcnt(0)
    v_bitop3_b32 v6, v213, v215, s4 bitop3:0x7e
    v_bitop3_b32 v6, v6, v217, s4 bitop3:0xf6
    v_bitop3_b32 v6, v6, v219, s4 bitop3:0xf6
    v_cmp_ne_u32 vcc, 0, v6
    s_cbranch_vccz PDONE_60
    s_add_u32 s5, s5, 1
    s_cmp_lt_u32 s5, 300000
    s_cbranch_scc1 POLL_59
PDONE_60:
TOK_58:
    v_permlane32_swap_b32 v212, v214
    v_permlane32_swap_b32 v216, v218
    v_add_f32 v212, v212, v214
    v_add_f32 v216, v216, v218
    v_mov_b32 v214, v212
    v_mov_b32 v218, v216
    s_nop 0
    v_permlane16_swap_b32 v212, v214
    v_permlane16_swap_b32 v216, v218
    v_add_f32 v212, v212, v214
    v_add_f32 v216, v216, v218
    v_cvt_pk_bf16_f32 v212, 0, v212
    v_cvt_pk_bf16_f32 v216, 0, v216
    v_mul_f32 v6, s7, v212
    v_exp_f32 v6, -v6
    s_nop 0
    v_add_f32 v6, 1.0, v6
    v_rcp_f32 v6, v6
    s_nop 0
    v_mul_f32 v212, v212, v6
    v_cvt_pk_bf16_f32 v212, 0, v212
    v_mul_f32 v212, v212, v216
    v_cvt_pk_bf16_f32 v212, v212, v212
    ds_write_b16 v5, v212
L_NOH:
    v_bfe_u32 v4, v1, 2, 1
    v_lshlrev_b32 v4, 7, v4
    v_lshrrev_b32 v9, 5, v1
    v_lshl_add_u32 v4, v9, 4, v4
    v_add_u32 v4, 138752, v4
    v_lshrrev_b32 v5, 4, v1
    v_mul_u32_u24 v5, 7168, v5
    v_and_b32 v9, 15, v1
    v_lshl_add_u32 v5, v9, 3, v5
    v_and_b32 v6, 1, v1
    v_lshlrev_b32 v6, 18, v6
    v_bfe_u32 v9, v1, 1, 1
    v_lshl_add_u32 v6, v9, 13, v6
    s_lshl3_add_u32 s96, s75, s3
    s_mul_i32 s97, s96, 28672
    s_lshl_b32 s98, s74, 7
    s_add_u32 s99, s97, s98
    s_add_u32 s13, s99, 22020096
    s_lshr_b32 s96, s9, 2
    s_and_b32 s97, s75, 1
    s_lshr_b32 s98, s3, 1
    s_lshl2_add_u32 s99, s97, s98
    s_and_b32 s97, s3, 1
    s_lshl_b32 s98, s97, 2
    s_lshl3_add_u32 s97, s99, s98
    s_lshr_b32 s99, s75, 1
    s_add_u32 s98, s97, s99
    s_lshl_b32 s97, s98, 12
    s_lshl_b32 s99, s8, 6
    s_add_u32 s98, s97, s99
    s_lshl2_add_u32 s97, s96, s98
    s_add_u32 s99, s97, 1048576
    s_add_u32 s14, s99, 3072
    s_waitcnt vmcnt(0)
    s_waitcnt lgkmcnt(0)
    s_barrier
    ds_read_b128 v[212:215], v4
    ds_read_b64_tr_b16 v[196:197], v45
    ds_read_b64_tr_b16 v[198:199], v45 offset:1024
    ds_read_b128 v[216:219], v4 offset:32
    ds_read_b64_tr_b16 v[200:201], v45 offset:8192
    ds_read_b64_tr_b16 v[202:203], v45 offset:9216
    ds_read_b128 v[220:223], v4 offset:64
    ds_read_b64_tr_b16 v[204:205], v45 offset:16384
    ds_read_b64_tr_b16 v[206:207], v45 offset:17408
    ds_read_b128 v[224:227], v4 offset:96
    ds_read_b64_tr_b16 v[208:209], v45 offset:24576
    ds_read_b64_tr_b16 v[210:211], v45 offset:25600
    s_waitcnt lgkmcnt(9)
    v_mfma_f32_32x32x16_bf16 v[228:243], v[212:215], v[196:199], 0
    s_waitcnt lgkmcnt(6)
    v_mfma_f32_32x32x16_bf16 v[228:243], v[216:219], v[200:203], v[228:243]
    s_waitcnt lgkmcnt(3)
    v_mfma_f32_32x32x16_bf16 v[228:243], v[220:223], v[204:207], v[228:243]
    s_waitcnt lgkmcnt(0)
    v_mfma_f32_32x32x16_bf16 v[228:243], v[224:227], v[208:211], v[228:243]
    s_nop 11
    v_mov_b32 v229, s4
    buffer_store_dwordx2 v[228:229], v5, s[32:35], s13 offen sc1
    s_mov_b64 exec, 15
    buffer_store_dword v229, v6, s[32:35], s14 offen sc1
    s_mov_b64 exec, -1
    s_waitcnt lgkmcnt(0)
L_GSEC:
    s_lshl_b32 s96, s21, 7
    s_lshl4_add_u32 s13, s3, s96
    v_lshrrev_b32 v22, 3, v1
    v_lshl_add_u32 v22, v22, 0, s13
    s_lshl_b32 s96, s13, 11
    s_lshl_b32 s97, s12, 7
    s_add_u32 s15, s96, s97
    s_add_u32 s16, s15, 16384
    v_lshrrev_b32 v25, 3, v1
    v_lshlrev_b32 v25, 11, v25
    v_and_b32 v9, 7, v1
    v_lshl_add_u32 v25, v9, 4, v25
    v_cmp_ne_u32 vcc, s70, v22
    v_cmp_ne_u32 s[22:23], s71, v22
    s_nop 0
    s_and_b64 exec, vcc, s[22:23]
    buffer_store_dwordx4 v[140:143], v25, s[64:67], s15 offen sc1
    s_mov_b64 exec, -1
    v_add_u32 v22, 8, v22
    v_cmp_ne_u32 vcc, s70, v22
    v_cmp_ne_u32 s[22:23], s71, v22
    s_nop 0
    s_and_b64 exec, vcc, s[22:23]
    buffer_store_dwordx4 v[144:147], v25, s[64:67], s16 offen sc1
    s_mov_b64 exec, -1
    s_cmp_lt_u32 s9, 16
    s_cbranch_scc1 L_GF
    s_cmp_ge_u32 s9, 28
    s_cbranch_scc1 L_FIN
    s_waitcnt vmcnt(0)
    s_mov_b32 exec_lo, 0xffff
    s_mov_b32 exec_hi, 0xffff
    buffer_store_dwordx2 v[56:57], v58, s[32:35], 0 offen sc1
    s_mov_b64 exec, -1
    s_branch L_FIN
L_GF:
SPOLL_61:
    s_load_dwordx8 s[24:31], s[32:33], s92 offset:3072 glc
SCHK_62:
    s_add_u32 s5, s5, 1
    s_cmp_ge_u32 s5, 300000
    s_waitcnt lgkmcnt(0)
    s_cbranch_scc1 SDONE_63
    s_cmp_lg_u32 s24, s4
    s_cbranch_scc1 SPOLL_61
    s_cmp_lg_u32 s25, s4
    s_cbranch_scc1 SPOLL_61
    s_cmp_lg_u32 s26, s4
    s_cbranch_scc1 SPOLL_61
    s_cmp_lg_u32 s27, s4
    s_cbranch_scc1 SPOLL_61
    s_cmp_lg_u32 s28, s4
    s_cbranch_scc1 SPOLL_61
    s_cmp_lg_u32 s29, s4
    s_cbranch_scc1 SPOLL_61
    s_cmp_lg_u32 s30, s4
    s_cbranch_scc1 SPOLL_61
SDONE_63:
    s_barrier
    s_cmp_eq_u32 s3, 7
    s_cbranch_scc1 L_G7
    s_barrier
    s_mov_b32 exec_lo, 0xffff
    s_mov_b32 exec_hi, 0xffff
    buffer_store_dwordx2 v[56:57], v58, s[32:35], 0 offen sc1
    s_mov_b64 exec, -1
    s_branch L_FIN
L_G7:
    s_cmp_lg_u32 s3, 7
    s_cbranch_scc1 L_FIN
    s_add_u32 s13, s20, 4096
POLL_64:
    buffer_load_dwordx4 v[212:215], v2, s[32:35], s20 offen sc1
    buffer_load_dwordx4 v[216:219], v2, s[32:35], s20 offen offset:1024 sc1
    buffer_load_dwordx4 v[220:223], v2, s[32:35], s20 offen offset:2048 sc1
    buffer_load_dwordx4 v[224:227], v2, s[32:35], s20 offen offset:3072 sc1
    buffer_load_dwordx4 v[148:151], v2, s[32:35], s13 offen sc1
    buffer_load_dwordx4 v[152:155], v2, s[32:35], s13 offen offset:1024 sc1
    buffer_load_dwordx4 v[156:159], v2, s[32:35], s13 offen offset:2048 sc1
    s_waitcnt vmcnt(0)
    v_bitop3_b32 v4, v213, v215, s4 bitop3:0x7e
    v_bitop3_b32 v4, v4, v217, s4 bitop3:0xf6
    v_bitop3_b32 v4, v4, v219, s4 bitop3:0xf6
    v_bitop3_b32 v4, v4, v221, s4 bitop3:0xf6
    v_bitop3_b32 v4, v4, v223, s4 bitop3:0xf6
    v_bitop3_b32 v4, v4, v225, s4 bitop3:0xf6
    v_bitop3_b32 v4, v4, v227, s4 bitop3:0xf6
    v_bitop3_b32 v4, v4, v149, s4 bitop3:0xf6
    v_bitop3_b32 v4, v4, v151, s4 bitop3:0xf6
    v_bitop3_b32 v4, v4, v153, s4 bitop3:0xf6
    v_bitop3_b32 v4, v4, v155, s4 bitop3:0xf6
    v_bitop3_b32 v4, v4, v157, s4 bitop3:0xf6
    v_bitop3_b32 v4, v4, v159, s4 bitop3:0xf6
    v_cmp_ne_u32 vcc, 0, v4
    s_cbranch_vccz PDONE_65
    s_add_u32 s5, s5, 1
    s_cmp_lt_u32 s5, 300000
    s_cbranch_scc1 POLL_64
PDONE_65:
    v_bitop3_b32 v4, v21, v73, s4 bitop3:0x7e
    v_cmp_ne_u32 vcc, 0, v4
    s_cbranch_vccz TOK_66
POLL_67:
    buffer_load_dwordx2 v[20:21], v11, s[32:35], s68 offen sc1
    buffer_load_dwordx2 v[72:73], v11, s[32:35], s69 offen sc1
    s_waitcnt vmcnt(0)
    v_bitop3_b32 v4, v21, v73, s4 bitop3:0x7e
    v_cmp_ne_u32 vcc, 0, v4
    s_cbranch_vccz PDONE_68
    s_add_u32 s5, s5, 1
    s_cmp_lt_u32 s5, 300000
    s_cbranch_scc1 POLL_67
PDONE_68:
TOK_66:
    s_barrier
    v_add_f32 v212, v212, v216
    v_add_f32 v214, v214, v218
    v_add_f32 v220, v220, v224
    v_add_f32 v222, v222, v226
    v_add_f32 v148, v148, v152
    v_add_f32 v150, v150, v154
    v_add_f32 v212, v212, v220
    v_add_f32 v214, v214, v222
    v_add_f32 v148, v148, v156
    v_add_f32 v150, v150, v158
    v_add_f32 v212, v212, v148
    v_add_f32 v214, v214, v150
    v_mov_b32 v213, v214
    v_add_f32_dpp v212, v212, v212 row_ror:8 row_mask:0xf bank_mask:0xf
    s_nop 0
    v_add_f32_dpp v213, v213, v213 row_ror:8 row_mask:0xf bank_mask:0xf
    v_mov_b32 v214, v212
    v_mov_b32 v215, v213
    s_nop 0
    v_permlane16_swap_b32 v212, v214
    v_permlane16_swap_b32 v213, v215
    v_pk_add_f32 v[212:213], v[212:213], v[214:215]
    v_mov_b32 v214, v212
    v_mov_b32 v215, v213
    s_nop 0
    v_permlane32_swap_b32 v212, v214
    v_permlane32_swap_b32 v213, v215
    v_pk_add_f32 v[212:213], v[212:213], v[214:215]
    v_cvt_pk_bf16_f32 v212, 0, v212
    v_cvt_pk_bf16_f32 v213, 0, v213
    v_pk_mul_f32 v[212:213], v[212:213], v[74:75] op_sel:[0,1]
    v_lshlrev_b32 v4, 16, v20
    v_and_b32 v5, s6, v20
    v_cvt_pk_bf16_f32 v212, 0, v212
    v_cvt_pk_bf16_f32 v213, 0, v213
    v_pk_add_f32 v[212:213], v[212:213], v[4:5]
    v_lshlrev_b32 v4, 16, v74
    v_and_b32 v5, s6, v74
    v_cvt_pk_bf16_f32 v212, 0, v212
    v_cvt_pk_bf16_f32 v213, 0, v213
    v_pk_mul_f32 v[212:213], v[212:213], v[4:5]
    v_lshlrev_b32 v4, 16, v72
    v_and_b32 v5, s6, v72
    v_cvt_pk_bf16_f32 v212, 0, v212
    v_cvt_pk_bf16_f32 v213, 0, v213
    v_pk_add_f32 v[212:213], v[212:213], v[4:5]
    v_cvt_pk_bf16_f32 v212, v212, v213
    s_mov_b64 exec, 0xff
    buffer_store_dword v212, v10, s[64:67], s82 offen sc1
    s_mov_b64 exec, -1
    s_mov_b32 exec_lo, 0xffff
    s_mov_b32 exec_hi, 0xffff
    buffer_store_dwordx2 v[56:57], v58, s[32:35], 0 offen sc1
    s_mov_b64 exec, -1
L_FIN:
L_END:
    s_endpgm
.p2align 10
.fill 768, 4, 0xbf800000
.section .rodata,"a"
.p2align 6
.amdhsa_kernel adaLN_cond__linear_kernel_hedgehog__moe_arch_mod__prompt_kernel
  .amdhsa_next_free_vgpr 256
  .amdhsa_next_free_sgpr 102
  .amdhsa_accum_offset 256
  .amdhsa_group_segment_fixed_size 0
  .amdhsa_kernarg_size 112
  .amdhsa_user_sgpr_count 2
  .amdhsa_user_sgpr_kernarg_segment_ptr 1
  .amdhsa_system_sgpr_workgroup_id_x 1
  .amdhsa_float_denorm_mode_32 3
  .amdhsa_float_denorm_mode_16_64 3
.end_amdhsa_kernel
```

```asm
; @launch grid=(256,1,1) block=(512,1,1) lds=163840
.amdgcn_target "amdgcn-amd-amdhsa--gfx950"
.text
.globl adaLN_cond__linear_kernel_hedgehog__moe_arch_mod__prompt_kernel
.p2align 8
.type adaLN_cond__linear_kernel_hedgehog__moe_arch_mod__prompt_kernel,@function
adaLN_cond__linear_kernel_hedgehog__moe_arch_mod__prompt_kernel:
    s_load_dwordx16 s[68:83], s[0:1], 0
    s_load_dwordx8 s[84:91], s[0:1], 64
    s_load_dwordx2 s[32:33], s[0:1], 104
    s_load_dwordx2 s[30:31], s[0:1], 96
    s_cmp_ge_u32 s2, 256
    s_cbranch_scc1 L_END
    v_lshrrev_b32 v4, 6, v0
    v_and_b32 v1, 63, v0
    v_mov_b32 v3, 0
    v_readfirstlane_b32 s3, v4
    v_lshlrev_b32 v2, 4, v1
    s_and_b32 s8, s2, 7
    s_lshr_b32 s9, s2, 3
    s_lshl2_add_u32 s96, s8, s3
    s_lshl_b32 s15, s96, 6
    s_mul_i32 s96, s15, 6144
    s_xor_b32 s97, s9, 1
    s_lshl_b32 s98, s97, 7
    s_add_u32 s13, s96, s98
    v_lshrrev_b32 v60, 3, v1
    v_mul_u32_u24 v60, 49152, v60
    v_and_b32 v9, 7, v1
    v_lshl_add_u32 v60, v9, 4, v60
    v_lshrrev_b32 v61, 3, v1
    v_lshl_add_u32 v61, v61, 3, s15
    s_lshl_b32 s96, s8, 5
    s_add_u32 s97, s96, s9
    s_lshl2_add_u32 s98, s97, s3
    s_sub_u32 s99, s98, 4
    s_lshl_b32 s16, s99, 12
    s_mov_b32 s50, 12582912
    s_mov_b32 s51, 0x20000
    s_mov_b32 s38, 4194304
    s_mov_b32 s39, 0x20000
    s_mov_b32 s34, 268435456
    s_mov_b32 s35, 0x20000
    s_getreg_b32 s94, hwreg(HW_REG_XCC_ID, 0, 3)
    s_getpc_b64 s[22:23]
    s_mul_i32 s96, s9, 7
    s_add_u32 s97, s96, s3
    s_lshl_b32 s19, s97, 7
    v_lshrrev_b32 v10, 5, v1
    v_mul_u32_u24 v10, 28672, v10
    v_add_u32 v10, s19, v10
    v_min_u32 v10, 44032, v10
    s_cmp_ge_u32 s3, 4
    s_waitcnt lgkmcnt(0)
    s_mov_b64 s[48:49], s[88:89]
    s_mov_b64 s[36:37], s[68:69]
    s_load_dword s4, s[32:33], 0
    s_cbranch_scc1 L_FS
    global_load_dwordx2 v[96:97], v61, s[86:87]
    buffer_load_dwordx4 v[80:83], v60, s[48:51], s13 offen nt
    s_add_u32 s13, s13, 12288
    buffer_load_dwordx4 v[84:87], v60, s[48:51], s13 offen nt
    s_add_u32 s13, s13, 12288
    buffer_load_dwordx4 v[88:91], v60, s[48:51], s13 offen nt
    s_add_u32 s13, s13, 12288
    buffer_load_dwordx4 v[92:95], v60, s[48:51], s13 offen nt
    s_barrier
    s_barrier
    s_and_b32 s22, s22, 0xfffffc00
    global_load_dword v78, v10, s[22:23]
    s_mov_b32 s42, 6291456
    s_mov_b32 s43, 0x20000
    s_mov_b32 s46, 2097152
    s_mov_b32 s47, 0x20000
    s_mov_b32 s54, 7340032
    s_mov_b32 s55, 0x20000
    s_mov_b32 s58, 7340032
    s_mov_b32 s59, 0x20000
    s_mov_b32 s62, 7340032
    s_mov_b32 s63, 0x20000
    s_mov_b32 s66, 4194304
    s_mov_b32 s67, 0x20000
    s_mov_b64 s[40:41], s[70:71]
    s_mov_b64 s[44:45], s[74:75]
    s_mov_b64 s[52:53], s[80:81]
    s_mov_b64 s[56:57], s[82:83]
    s_mov_b64 s[60:61], s[84:85]
    s_mov_b64 s[64:65], s[90:91]
    s_mov_b32 s5, 0
    s_mov_b32 s6, 0xffff0000
    s_mov_b32 s7, 0x3fb8aa3b
    s_lshr_b32 s76, s3, 2
    v_bfe_u32 v6, v1, 4, 1
    v_lshlrev_b32 v6, 6, v6
    v_and_b32 v62, 7, v1
    v_lshlrev_b32 v62, 4, v62
    v_xor_b32 v62, v62, v6
    v_lshrrev_b32 v6, 3, v1
    v_mul_u32_u24 v6, 6144, v6
    v_add_u32 v62, v62, v6
    v_lshlrev_b32 v63, 3, v1
    v_add_u32 v64, 149760, v2
    s_and_b32 s96, s3, 3
    s_lshl2_add_u32 s13, s96, 149760
    v_lshrrev_b32 v65, 4, v1
    v_lshl_add_u32 v65, v65, 5, s13
    v_and_b32 v9, 7, v1
    v_lshl_add_u32 v65, v9, 7, v65
    v_bfe_u32 v9, v1, 3, 1
    v_lshl_add_u32 v65, v9, 4, v65
    s_and_b32 s96, s8, 6
    s_and_b32 s97, s8, 1
    s_lshr_b32 s98, s9, 4
    s_lshl1_add_u32 s99, s97, s98
    s_lshl_b32 s97, s99, 6
    s_add_u32 s98, s96, s97
    s_lshl3_add_u32 s99, s3, s98
    s_lshl_b32 s96, s99, 10
    s_and_b32 s97, s9, 15
    s_lshl_b32 s98, s97, 6
    s_add_u32 s99, s96, s98
    s_add_u32 s14, s99, 262144
    s_xor_b32 s96, s9, 1
    s_and_b32 s97, s96, 15
    s_lshl4_add_u32 s98, s3, s97
    s_lshr_b32 s99, s9, 4
    s_lshl1_add_u32 s96, s98, s99
    s_lshl3_add_u32 s97, s96, s8
    s_lshl_b32 s98, s97, 9
    s_add_u32 s13, s98, 524288
    s_lshr_b32 s96, s9, 4
    s_xor_b32 s97, s9, 1
    s_and_b32 s98, s97, 7
    s_lshl_b32 s99, s3, 1
    s_lshl3_add_u32 s97, s98, s99
    s_bfe_u32 s98, s9, 65539
    s_add_u32 s99, s97, s98
    s_lshl_b32 s97, s99, 9
    s_lshl_b32 s98, s8, 6
    s_add_u32 s99, s97, s98
    s_lshl2_add_u32 s97, s96, s99
    s_add_u32 s15, s97, 2097152
    v_and_b32 v10, 3, v1
    v_lshlrev_b32 v10, 15, v10
    s_waitcnt vmcnt(5)
    v_lshlrev_b32 v98, 16, v97
    v_and_b32 v99, s6, v97
    v_and_b32 v97, s6, v96
    v_lshlrev_b32 v96, 16, v96
    v_mul_f32 v4, s7, v96
    v_exp_f32 v4, -v4
    s_nop 0
    v_add_f32 v4, 1.0, v4
    v_rcp_f32 v4, v4
    s_nop 0
    v_mul_f32 v96, v96, v4
    v_cvt_pk_bf16_f32 v96, 0, v96
    v_mul_f32 v5, s7, v97
    v_exp_f32 v5, -v5
    s_nop 0
    v_add_f32 v5, 1.0, v5
    v_rcp_f32 v5, v5
    s_nop 0
    v_mul_f32 v97, v97, v5
    v_cvt_pk_bf16_f32 v97, 0, v97
    v_mul_f32 v4, s7, v98
    v_exp_f32 v4, -v4
    s_nop 0
    v_add_f32 v4, 1.0, v4
    v_rcp_f32 v4, v4
    s_nop 0
    v_mul_f32 v98, v98, v4
    v_cvt_pk_bf16_f32 v98, 0, v98
    v_mul_f32 v5, s7, v99
    v_exp_f32 v5, -v5
    s_nop 0
    v_add_f32 v5, 1.0, v5
    v_rcp_f32 v5, v5
    s_nop 0
    v_mul_f32 v99, v99, v5
    v_cvt_pk_bf16_f32 v99, 0, v99
    s_waitcnt vmcnt(4)
    v_lshlrev_b32 v4, 16, v80
    v_and_b32 v5, s6, v80
    v_pk_mul_f32 v[20:21], v[4:5], v[96:97] op_sel:[0,0] op_sel_hi:[1,0]
    v_lshlrev_b32 v6, 16, v81
    v_and_b32 v7, s6, v81
    v_pk_mul_f32 v[22:23], v[6:7], v[96:97] op_sel:[0,0] op_sel_hi:[1,0]
    v_lshlrev_b32 v4, 16, v82
    v_and_b32 v5, s6, v82
    v_pk_mul_f32 v[24:25], v[4:5], v[96:97] op_sel:[0,0] op_sel_hi:[1,0]
    v_lshlrev_b32 v6, 16, v83
    v_and_b32 v7, s6, v83
    v_pk_mul_f32 v[26:27], v[6:7], v[96:97] op_sel:[0,0] op_sel_hi:[1,0]
    s_waitcnt vmcnt(3)
    v_lshlrev_b32 v4, 16, v84
    v_and_b32 v5, s6, v84
    v_pk_fma_f32 v[20:21], v[4:5], v[96:97], v[20:21] op_sel:[0,1,0] op_sel_hi:[1,1,1]
    v_lshlrev_b32 v6, 16, v85
    v_and_b32 v7, s6, v85
    v_pk_fma_f32 v[22:23], v[6:7], v[96:97], v[22:23] op_sel:[0,1,0] op_sel_hi:[1,1,1]
    v_lshlrev_b32 v4, 16, v86
    v_and_b32 v5, s6, v86
    v_pk_fma_f32 v[24:25], v[4:5], v[96:97], v[24:25] op_sel:[0,1,0] op_sel_hi:[1,1,1]
    v_lshlrev_b32 v6, 16, v87
    v_and_b32 v7, s6, v87
    v_pk_fma_f32 v[26:27], v[6:7], v[96:97], v[26:27] op_sel:[0,1,0] op_sel_hi:[1,1,1]
    s_waitcnt vmcnt(2)
    v_lshlrev_b32 v4, 16, v88
    v_and_b32 v5, s6, v88
    v_pk_fma_f32 v[20:21], v[4:5], v[98:99], v[20:21] op_sel:[0,0,0] op_sel_hi:[1,0,1]
    v_lshlrev_b32 v6, 16, v89
    v_and_b32 v7, s6, v89
    v_pk_fma_f32 v[22:23], v[6:7], v[98:99], v[22:23] op_sel:[0,0,0] op_sel_hi:[1,0,1]
    v_lshlrev_b32 v4, 16, v90
    v_and_b32 v5, s6, v90
    v_pk_fma_f32 v[24:25], v[4:5], v[98:99], v[24:25] op_sel:[0,0,0] op_sel_hi:[1,0,1]
    v_lshlrev_b32 v6, 16, v91
    v_and_b32 v7, s6, v91
    v_pk_fma_f32 v[26:27], v[6:7], v[98:99], v[26:27] op_sel:[0,0,0] op_sel_hi:[1,0,1]
    s_waitcnt vmcnt(1)
    v_lshlrev_b32 v4, 16, v92
    v_and_b32 v5, s6, v92
    v_pk_fma_f32 v[20:21], v[4:5], v[98:99], v[20:21] op_sel:[0,1,0] op_sel_hi:[1,1,1]
    v_lshlrev_b32 v6, 16, v93
    v_and_b32 v7, s6, v93
    v_pk_fma_f32 v[22:23], v[6:7], v[98:99], v[22:23] op_sel:[0,1,0] op_sel_hi:[1,1,1]
    v_lshlrev_b32 v4, 16, v94
    v_and_b32 v5, s6, v94
    v_pk_fma_f32 v[24:25], v[4:5], v[98:99], v[24:25] op_sel:[0,1,0] op_sel_hi:[1,1,1]
    v_lshlrev_b32 v6, 16, v95
    v_and_b32 v7, s6, v95
    v_pk_fma_f32 v[26:27], v[6:7], v[98:99], v[26:27] op_sel:[0,1,0] op_sel_hi:[1,1,1]
    v_permlane32_swap_b32 v20, v24
    v_permlane32_swap_b32 v21, v25
    v_permlane32_swap_b32 v22, v26
    v_permlane32_swap_b32 v23, v27
    v_add_f32 v20, v20, v24
    v_add_f32 v21, v21, v25
    v_add_f32 v22, v22, v26
    v_add_f32 v23, v23, v27
    s_nop 0
    v_permlane16_swap_b32 v20, v22
    v_permlane16_swap_b32 v21, v23
    v_add_f32 v20, v20, v22
    v_add_f32 v21, v21, v23
    s_nop 0
    v_add_f32_dpp v20, v20, v20 row_ror:8 row_mask:0xf bank_mask:0xf
    v_add_f32_dpp v21, v21, v21 row_ror:8 row_mask:0xf bank_mask:0xf
    s_nop 1
    v_mov_b32_dpp v20, v21 quad_perm:[0,1,2,3] row_mask:0xf bank_mask:0xc
    ds_write_b32 v65, v20
    s_waitcnt lgkmcnt(0)
    s_barrier
    ds_read_b128 v[20:23], v64 offset:0
    s_mul_i32 s4, s4, 0x9e3779b1
    s_add_u32 s4, s4, 0x7f4a7c15
    s_waitcnt lgkmcnt(0)
    v_pk_add_f32 v[20:21], v[20:21], v[22:23]
    v_add_f32 v20, v20, v21
    v_mov_b32 v21, s4
    buffer_store_dwordx2 v[20:21], v63, s[32:35], s13 offen sc1
    s_mov_b64 exec, 15
    buffer_store_dword v21, v10, s[32:35], s15 offen sc1
    s_mov_b64 exec, -1
    s_branch L_FJ
L_FS:
    s_barrier
    buffer_load_dwordx4 v[80:83], v2, s[36:39], s16 offen
    buffer_load_dwordx4 v[84:87], v2, s[36:39], s16 offen offset:1024
    buffer_load_dwordx4 v[88:91], v2, s[36:39], s16 offen offset:2048
    buffer_load_dwordx4 v[92:95], v2, s[36:39], s16 offen offset:3072
    s_lshl2_add_u32 s96, s2, s3
    s_sub_u32 s97, s96, 4
    s_lshl_b32 s98, s97, 7
    s_add_u32 s17, s98, 2097152
    s_load_dword s24, s[32:33], s17 offset:0 glc
    s_load_dword s25, s[32:33], s17 offset:64 glc
    s_lshl_b32 s96, s2, 5
    s_add_u32 s97, s96, s3
    s_sub_u32 s98, s97, 4
    s_lshl_b32 s99, s98, 7
    s_add_u32 s17, s99, 1048576
    s_load_dword s24, s[32:33], s17 offset:0 glc
    s_load_dword s25, s[32:33], s17 offset:64 glc
    s_lshl_b32 s19, s94, 5
    v_mov_b32 v78, 1
    v_mov_b32 v79, s19
    s_barrier
    s_cmp_lg_u32 s3, 7
    s_cbranch_scc1 L_NOTK
    s_mov_b64 exec, 1
    global_atomic_add v78, v79, v78, s[30:31] sc0 sc1
    s_mov_b64 exec, -1
    s_branch L_TK0
L_NOTK:
    s_and_b32 s22, s22, 0xfffffc00
    global_load_dword v78, v10, s[22:23]
L_TK0:
    s_mov_b32 s42, 6291456
    s_mov_b32 s43, 0x20000
    s_mov_b32 s46, 2097152
    s_mov_b32 s47, 0x20000
    s_mov_b32 s54, 7340032
    s_mov_b32 s55, 0x20000
    s_mov_b32 s58, 7340032
    s_mov_b32 s59, 0x20000
    s_mov_b32 s62, 7340032
    s_mov_b32 s63, 0x20000
    s_mov_b32 s66, 4194304
    s_mov_b32 s67, 0x20000
    s_mov_b64 s[40:41], s[70:71]
    s_mov_b64 s[44:45], s[74:75]
    s_mov_b64 s[52:53], s[80:81]
    s_mov_b64 s[56:57], s[82:83]
    s_mov_b64 s[60:61], s[84:85]
    s_mov_b64 s[64:65], s[90:91]
    s_mov_b32 s5, 0
    s_mov_b32 s6, 0xffff0000
    s_mov_b32 s7, 0x3fb8aa3b
    s_lshr_b32 s76, s3, 2
    v_bfe_u32 v6, v1, 4, 1
    v_lshlrev_b32 v6, 6, v6
    v_and_b32 v62, 7, v1
    v_lshlrev_b32 v62, 4, v62
    v_xor_b32 v62, v62, v6
    v_lshrrev_b32 v6, 3, v1
    v_mul_u32_u24 v6, 6144, v6
    v_add_u32 v62, v62, v6
    v_lshlrev_b32 v63, 3, v1
    v_add_u32 v64, 149760, v2
    s_and_b32 s96, s3, 3
    s_lshl2_add_u32 s13, s96, 149760
    v_lshrrev_b32 v65, 4, v1
    v_lshl_add_u32 v65, v65, 5, s13
    v_and_b32 v9, 7, v1
    v_lshl_add_u32 v65, v9, 7, v65
    v_bfe_u32 v9, v1, 3, 1
    v_lshl_add_u32 v65, v9, 4, v65
    s_and_b32 s96, s8, 6
    s_and_b32 s97, s8, 1
    s_lshr_b32 s98, s9, 4
    s_lshl1_add_u32 s99, s97, s98
    s_lshl_b32 s97, s99, 6
    s_add_u32 s98, s96, s97
    s_lshl3_add_u32 s99, s3, s98
    s_lshl_b32 s96, s99, 10
    s_and_b32 s97, s9, 15
    s_lshl_b32 s98, s97, 6
    s_add_u32 s99, s96, s98
    s_add_u32 s14, s99, 262144
    s_sub_u32 s96, s3, 4
    s_lshl4_add_u32 s13, s96, 151808
    v_lshrrev_b32 v10, 5, v1
    v_lshl_add_u32 v10, v10, 3, s13
    s_barrier
    s_waitcnt vmcnt(1)
    s_waitcnt lgkmcnt(0)
    s_mul_i32 s4, s4, 0x9e3779b1
    s_add_u32 s4, s4, 0x7f4a7c15
    v_mov_b32 v104, 0x3f803f80
    v_dot2_f32_bf16 v100, v80, v104, 0
    v_dot2_f32_bf16 v102, v80, v80, 0
    v_dot2_f32_bf16 v101, v88, v104, 0
    v_dot2_f32_bf16 v103, v88, v88, 0
    v_dot2_f32_bf16 v100, v81, v104, v100
    v_dot2_f32_bf16 v102, v81, v81, v102
    v_dot2_f32_bf16 v101, v89, v104, v101
    v_dot2_f32_bf16 v103, v89, v89, v103
    v_dot2_f32_bf16 v100, v82, v104, v100
    v_dot2_f32_bf16 v102, v82, v82, v102
    v_dot2_f32_bf16 v101, v90, v104, v101
    v_dot2_f32_bf16 v103, v90, v90, v103
    v_dot2_f32_bf16 v100, v83, v104, v100
    v_dot2_f32_bf16 v102, v83, v83, v102
    v_dot2_f32_bf16 v101, v91, v104, v101
    v_dot2_f32_bf16 v103, v91, v91, v103
    v_dot2_f32_bf16 v100, v84, v104, v100
    v_dot2_f32_bf16 v102, v84, v84, v102
    v_dot2_f32_bf16 v101, v92, v104, v101
    v_dot2_f32_bf16 v103, v92, v92, v103
    v_dot2_f32_bf16 v100, v85, v104, v100
    v_dot2_f32_bf16 v102, v85, v85, v102
    v_dot2_f32_bf16 v101, v93, v104, v101
    v_dot2_f32_bf16 v103, v93, v93, v103
    v_dot2_f32_bf16 v100, v86, v104, v100
    v_dot2_f32_bf16 v102, v86, v86, v102
    v_dot2_f32_bf16 v101, v94, v104, v101
    v_dot2_f32_bf16 v103, v94, v94, v103
    v_dot2_f32_bf16 v100, v87, v104, v100
    v_dot2_f32_bf16 v102, v87, v87, v102
    v_dot2_f32_bf16 v101, v95, v104, v101
    v_dot2_f32_bf16 v103, v95, v95, v103
    s_nop 1
    v_permlane32_swap_b32 v100, v101
    v_permlane32_swap_b32 v102, v103
    v_add_f32 v100, v100, v101
    v_add_f32 v102, v102, v103
    s_nop 1
    v_permlane16_swap_b32 v100, v102
    v_add_f32 v100, v100, v102
    s_nop 1
    v_add_f32_dpp v100, v100, v100 quad_perm:[1,0,3,2] row_mask:0xf bank_mask:0xf
    s_nop 1
    v_add_f32_dpp v100, v100, v100 quad_perm:[2,3,0,1] row_mask:0xf bank_mask:0xf
    s_nop 1
    v_add_f32_dpp v100, v100, v100 row_half_mirror row_mask:0xf bank_mask:0xf
    s_nop 1
    v_add_f32_dpp v100, v100, v100 row_ror:8 row_mask:0xf bank_mask:0xf
    v_mul_f32 v102, 0x3a800000, v100
    v_mul_f32 v100, 0x3a800000, v100
    s_nop 1
    v_permlane16_swap_b32 v100, v102
    v_fma_f32 v117, -v100, v100, v102
    v_cvt_pk_bf16_f32 v116, 0, v100
    v_max_f32 v117, 0, v117
    v_cvt_pk_bf16_f32 v117, 0, v117
    v_add_f32 v117, 0x3727c5ac, v117
    v_cvt_pk_bf16_f32 v117, 0, v117
    v_sqrt_f32 v117, v117
    s_nop 0
    v_cvt_pk_bf16_f32 v117, 0, v117
    v_lshrrev_b32 v116, 16, v116
    v_or_b32 v116, v116, v117
    v_mov_b32 v117, s4
    ds_write_b64 v10, v[116:117]
L_FJ:
    v_and_b32 v5, 3, v1
    v_lshlrev_b32 v5, 4, v5
    v_add_u32 v5, 151808, v5
    v_and_b32 v4, 3, v1
    v_lshlrev_b32 v4, 4, v4
    v_bfe_u32 v9, v1, 2, 1
    v_lshl_add_u32 v4, v9, 10, v4
    v_and_b32 v10, 31, v1
    v_lshlrev_b32 v10, 11, v10
    v_lshrrev_b32 v9, 5, v1
    v_lshl_add_u32 v10, v9, 5, v10
    v_and_b32 v6, 1, v1
    v_lshlrev_b32 v6, 9, v6
    v_bfe_u32 v9, v1, 1, 1
    v_lshl_add_u32 v6, v9, 8, v6
    s_and_b32 s96, s9, 3
    s_and_b32 s97, s8, 6
    s_and_b32 s98, s8, 1
    s_lshr_b32 s99, s9, 4
    s_lshl1_add_u32 s98, s98, s99
    s_lshl_b32 s99, s98, 6
    s_add_u32 s98, s97, s99
    s_lshl3_add_u32 s97, s3, s98
    s_lshl_b32 s99, s97, 9
    s_bfe_u32 s98, s9, 131074
    s_lshl_b32 s97, s98, 6
    s_add_u32 s98, s99, s97
    s_lshl2_add_u32 s99, s96, s98
    s_add_u32 s97, s99, 16
    s_add_u32 s15, s97, 2097152
    s_waitcnt lgkmcnt(0)
    s_barrier
    ds_read_b128 v[116:119], v5
    s_waitcnt lgkmcnt(0)
    s_mov_b64 exec, 0xff
    buffer_store_dwordx4 v[116:119], v4, s[32:35], s14 offen sc1
    s_mov_b64 exec, 15
    buffer_store_dword v117, v6, s[32:35], s15 offen sc1
    s_mov_b64 exec, -1
    s_cmp_lg_u32 s3, 7
    s_cbranch_scc1 L_NOTK2
    s_mov_b32 s13, 0
    s_waitcnt vmcnt(2)
L_TK:
    v_readfirstlane_b32 s15, v78
    s_nop 0
    s_cmp_lt_u32 s15, 32
    s_cbranch_scc1 L_TKOK
    v_mov_b32 v78, s4
    s_mov_b64 exec, 1
    buffer_store_dword v78, v3, s[32:35], 0 offen offset:256 sc1
    s_mov_b64 exec, -1
    s_add_u32 s13, s13, 1
    s_cmp_lt_u32 s13, 8
    s_cbranch_scc0 L_TKNO
    s_add_u32 s94, s94, 1
    s_and_b32 s94, s94, 7
    s_lshl_b32 s19, s94, 5
    v_mov_b32 v78, 1
    v_mov_b32 v79, s19
    s_mov_b64 exec, 1
    global_atomic_add v78, v79, v78, s[30:31] sc0 sc1
    s_mov_b64 exec, -1
    s_waitcnt vmcnt(0)
    s_branch L_TK
L_TKNO:
    s_and_b32 s94, s2, 7
    s_lshr_b32 s15, s2, 3
L_TKOK:
    s_lshl3_add_u32 s15, s15, s94
    v_mov_b32 v78, s15
    ds_write_b32 v5, v78 offset:64
L_NOTK2:
    s_waitcnt lgkmcnt(0)
    s_barrier
    ds_read_b32 v120, v5 offset:64
    s_waitcnt lgkmcnt(0)
    v_readfirstlane_b32 s2, v120
    s_nop 0
    s_and_b32 s8, s2, 7
    s_lshr_b32 s9, s2, 3
    s_and_b32 s96, s8, 1
    s_and_b32 s97, s9, 7
    s_lshl3_add_u32 s12, s96, s97
    s_lshr_b32 s96, s8, 1
    s_lshr_b32 s97, s9, 3
    s_lshl2_add_u32 s21, s96, s97
    s_and_b32 s96, s3, 3
    s_lshl2_add_u32 s94, s21, s96
    s_lshl1_add_u32 s95, s12, s76
    s_lshl_b32 s96, s94, 16
    s_lshl_b32 s97, s95, 6
    s_add_u32 s18, s96, s97
    buffer_load_dwordx4 v[12:15], v10, s[36:39], s18 offen
    buffer_load_dwordx4 v[16:19], v10, s[36:39], s18 offen offset:16
    s_lshr_b32 s96, s8, 1
    s_lshl4_add_u32 s97, s96, s12
    s_lshl4_add_u32 s98, s97, s3
    s_lshl_b32 s99, s98, 9
    s_add_u32 s13, s99, 524288
    s_lshl3_add_u32 s96, s2, s3
    s_lshl_b32 s97, s96, 6
    s_add_u32 s15, s97, 2097152
    s_and_b32 s96, s3, 3
    s_lshl2_add_u32 s97, s2, s96
    s_lshl_b32 s98, s97, 8
    s_add_u32 s14, s98, 262144
    s_load_dwordx8 s[24:31], s[32:33], s15 offset:0 glc
    s_and_b32 s10, s9, 15
    s_lshr_b32 s96, s8, 2
    s_and_b32 s97, s8, 1
    s_lshl1_add_u32 s98, s96, s97
    s_and_b32 s99, s8, 2
    s_lshl2_add_u32 s96, s98, s99
    s_lshr_b32 s97, s9, 4
    s_add_u32 s11, s96, s97
    s_and_b32 s85, s9, 12
    s_lshl_b32 s96, s2, 6
    s_add_u32 s97, s96, s3
    s_lshl_b32 s98, s97, 6
    s_add_u32 s92, s98, 1048576
    s_lshr_b32 s96, s9, 4
    s_xor_b32 s77, s76, s96
    s_lshr_b32 s96, s9, 3
    s_xor_b32 s97, s96, s9
    s_and_b32 s98, s97, 1
    s_lshl2_add_u32 s83, s98, 8
    s_mul_i32 s96, s8, 7
    s_lshr_b32 s97, s9, 2
    s_add_u32 s74, s96, s97
    s_and_b32 s75, s9, 3
    v_and_b32 v8, 31, v1
    v_lshlrev_b32 v8, 3, v8
    v_and_b32 v4, 31, v1
    v_lshlrev_b32 v4, 4, v4
    v_lshrrev_b32 v9, 5, v1
    v_lshl_add_u32 v4, v9, 12, v4
    s_lshl2_add_u32 s16, s3, 152320
    v_lshl_add_u32 v5, v1, 6, s16
    s_lshl_b32 s96, s76, 10
    s_add_u32 s16, s96, 152320
    v_and_b32 v6, 15, v1
    v_lshl_add_u32 v6, v6, 5, s16
    v_lshrrev_b32 v9, 5, v1
    v_lshl_add_u32 v6, v9, 9, v6
    s_branch SCHK_2
SPOLL_1:
    s_load_dwordx8 s[24:31], s[32:33], s15 offset:0 glc
SCHK_2:
    s_add_u32 s5, s5, 1
    s_cmp_ge_u32 s5, 300000
    s_waitcnt lgkmcnt(0)
    s_cbranch_scc1 SDONE_3
    s_cmp_lg_u32 s24, s4
    s_cbranch_scc1 SPOLL_1
    s_cmp_lg_u32 s25, s4
    s_cbranch_scc1 SPOLL_1
    s_cmp_lg_u32 s28, s4
    s_cbranch_scc1 SPOLL_1
    s_cmp_lg_u32 s29, s4
    s_cbranch_scc1 SPOLL_1
    s_cmp_lg_u32 s30, s4
    s_cbranch_scc1 SPOLL_1
    s_cmp_lg_u32 s31, s4
    s_cbranch_scc1 SPOLL_1
SDONE_3:
    buffer_load_dwordx4 v[120:123], v4, s[32:35], s13 offen sc1
    buffer_load_dwordx2 v[116:117], v8, s[32:35], s14 offen sc1
    s_barrier
    s_lshl_b32 s96, s11, 12
    s_lshl_b32 s97, s3, 9
    s_add_u32 s16, s96, s97
    v_add_u32 v10, s16, v2
    s_lshl_b32 s96, s3, 9
    s_add_u32 m0, s96, 156416
    s_mov_b32 exec_hi, 0
    global_load_lds_dwordx4 v10, s[72:73]
    s_mov_b32 exec_hi, -1
    s_and_b32 s20, s9, 3
    s_add_u32 s96, s20, s85
    s_and_b32 s97, s96, 15
    s_lshl3_add_u32 s98, s97, s3
    s_mul_i32 s99, s98, 49152
    s_lshl_b32 s96, s11, 7
    s_add_u32 s82, s99, s96
    s_mul_i32 s96, s20, 24960
    s_lshr_b32 s97, s3, 1
    s_mul_i32 s98, s97, 2080
    s_add_u32 s99, s96, s98
    s_and_b32 s97, s3, 1
    s_mul_i32 s96, s97, 1056
    s_add_u32 s20, s99, s96
    s_mov_b32 m0, s20
    s_nop 0
    buffer_load_dwordx4 v62, s[40:43], s82 offen lds
    s_add_u32 s82, s82, 2048
    s_add_u32 m0, s20, 8320
    s_nop 0
    buffer_load_dwordx4 v62, s[40:43], s82 offen lds
    s_add_u32 s82, s82, 2048
    s_add_u32 m0, s20, 16640
    s_nop 0
    buffer_load_dwordx4 v62, s[40:43], s82 offen lds
    s_waitcnt vmcnt(5)
    v_bitop3_b32 v7, v121, v123, s4 bitop3:0x7e
    v_cmp_ne_u32 vcc, 0, v7
    s_cbranch_vccz TOK_5
POLL_6:
    buffer_load_dwordx4 v[120:123], v4, s[32:35], s13 offen sc1
    s_waitcnt vmcnt(0)
    v_bitop3_b32 v7, v121, v123, s4 bitop3:0x7e
    v_cmp_ne_u32 vcc, 0, v7
    s_cbranch_vccz PDONE_7
    s_add_u32 s5, s5, 1
    s_cmp_lt_u32 s5, 300000
    s_cbranch_scc1 POLL_6
PDONE_7:
TOK_5:
    ds_write2_b32 v5, v120, v122 offset0:0 offset1:8
    v_lshlrev_b32 v100, 16, v12
    v_and_b32 v101, s6, v12
    v_lshlrev_b32 v102, 16, v13
    v_and_b32 v103, s6, v13
    v_lshlrev_b32 v104, 16, v14
    v_and_b32 v105, s6, v14
    v_lshlrev_b32 v106, 16, v15
    v_and_b32 v107, s6, v15
    v_lshlrev_b32 v108, 16, v16
    v_and_b32 v109, s6, v16
    v_lshlrev_b32 v110, 16, v17
    v_and_b32 v111, s6, v17
    v_lshlrev_b32 v112, 16, v18
    v_and_b32 v113, s6, v18
    v_lshlrev_b32 v114, 16, v19
    v_and_b32 v115, s6, v19
    s_waitcnt lgkmcnt(0)
    s_barrier
    ds_read_b128 v[88:91], v6 offset:2048
    ds_read_b128 v[92:95], v6 offset:2064
    ds_read_b128 v[80:83], v6
    ds_read_b128 v[84:87], v6 offset:16
    s_waitcnt vmcnt(4)
    v_cmp_ne_u32 vcc, s4, v117
    s_cbranch_vccz TOK_8
POLL_9:
    buffer_load_dwordx2 v[116:117], v8, s[32:35], s14 offen sc1
    s_waitcnt vmcnt(0)
    v_cmp_ne_u32 vcc, s4, v117
    s_cbranch_vccz PDONE_10
    s_add_u32 s5, s5, 1
    s_cmp_lt_u32 s5, 300000
    s_cbranch_scc1 POLL_9
PDONE_10:
TOK_8:
    v_lshlrev_b32 v117, 16, v116
    v_and_b32 v116, s6, v116
    v_rcp_f32 v116, v116
    s_nop 0
    v_pk_add_f32 v[100:101], v[100:101], v[116:117] op_sel:[0,1] neg_lo:[0,1] neg_hi:[0,1]
    v_pk_add_f32 v[102:103], v[102:103], v[116:117] op_sel:[0,1] neg_lo:[0,1] neg_hi:[0,1]
    v_pk_add_f32 v[104:105], v[104:105], v[116:117] op_sel:[0,1] neg_lo:[0,1] neg_hi:[0,1]
    v_pk_add_f32 v[106:107], v[106:107], v[116:117] op_sel:[0,1] neg_lo:[0,1] neg_hi:[0,1]
    v_pk_add_f32 v[108:109], v[108:109], v[116:117] op_sel:[0,1] neg_lo:[0,1] neg_hi:[0,1]
    v_pk_add_f32 v[110:111], v[110:111], v[116:117] op_sel:[0,1] neg_lo:[0,1] neg_hi:[0,1]
    v_pk_add_f32 v[112:113], v[112:113], v[116:117] op_sel:[0,1] neg_lo:[0,1] neg_hi:[0,1]
    v_pk_add_f32 v[114:115], v[114:115], v[116:117] op_sel:[0,1] neg_lo:[0,1] neg_hi:[0,1]
    s_lshl4_add_u32 s96, s21, s12
    s_and_b32 s97, s3, 3
    s_lshl2_add_u32 s98, s96, s97
    s_lshl1_add_u32 s99, s98, s76
    s_lshl_b32 s96, s99, 11
    s_add_u32 s13, s96, 4194304
    v_and_b32 v8, 15, v1
    v_lshlrev_b32 v8, 4, v8
    v_bfe_u32 v9, v1, 4, 1
    v_lshl_add_u32 v8, v9, 10, v8
    v_lshrrev_b32 v9, 5, v1
    v_lshl_add_u32 v8, v9, 9, v8
    s_waitcnt lgkmcnt(2)
    v_pk_add_f32 v[88:89], v[88:89], v[90:91]
    v_pk_add_f32 v[92:93], v[92:93], v[94:95]
    v_pk_add_f32 v[88:89], v[88:89], v[92:93]
    v_add_f32 v88, v88, v89
    v_cvt_pk_bf16_f32 v88, 0, v88
    s_waitcnt lgkmcnt(0)
    v_pk_add_f32 v[80:81], v[80:81], v[82:83]
    v_pk_add_f32 v[84:85], v[84:85], v[86:87]
    v_pk_add_f32 v[80:81], v[80:81], v[84:85]
    v_add_f32 v80, v80, v81
    v_add_f32 v88, 1.0, v88
    v_cvt_pk_bf16_f32 v88, 0, v88
    v_cvt_pk_bf16_f32 v80, 0, v80
    s_lshl_b32 s96, s3, 8
    s_add_u32 s16, s96, 160512
    v_and_b32 v4, 15, v1
    v_lshl_add_u32 v4, v4, 2, s16
    v_lshrrev_b32 v9, 5, v1
    v_lshl_add_u32 v4, v9, 6, v4
    v_lshrrev_b32 v5, 5, v1
    v_lshl_add_u32 v5, v5, 6, s16
    ds_write2_b32 v4, v88, v80 offset0:0 offset1:32
    ds_read_b128 v[132:135], v5
    ds_read_b128 v[136:139], v5 offset:16
    ds_read_b128 v[140:143], v5 offset:32
    ds_read_b128 v[144:147], v5 offset:48
    ds_read_b128 v[148:151], v5 offset:128
    ds_read_b128 v[152:155], v5 offset:144
    ds_read_b128 v[156:159], v5 offset:160
    ds_read_b128 v[160:163], v5 offset:176
    v_cvt_pk_bf16_f32 v100, 0, v100
    v_cvt_pk_bf16_f32 v101, 0, v101
    v_cvt_pk_bf16_f32 v102, 0, v102
    v_cvt_pk_bf16_f32 v103, 0, v103
    v_cvt_pk_bf16_f32 v104, 0, v104
    v_cvt_pk_bf16_f32 v105, 0, v105
    v_cvt_pk_bf16_f32 v106, 0, v106
    v_cvt_pk_bf16_f32 v107, 0, v107
    v_pk_mul_f32 v[100:101], v[100:101], v[116:117] op_sel_hi:[1,0]
    v_pk_mul_f32 v[102:103], v[102:103], v[116:117] op_sel_hi:[1,0]
    v_pk_mul_f32 v[104:105], v[104:105], v[116:117] op_sel_hi:[1,0]
    v_pk_mul_f32 v[106:107], v[106:107], v[116:117] op_sel_hi:[1,0]
    v_cvt_pk_bf16_f32 v100, 0, v100
    v_cvt_pk_bf16_f32 v101, 0, v101
    v_cvt_pk_bf16_f32 v102, 0, v102
    v_cvt_pk_bf16_f32 v103, 0, v103
    v_cvt_pk_bf16_f32 v104, 0, v104
    v_cvt_pk_bf16_f32 v105, 0, v105
    v_cvt_pk_bf16_f32 v106, 0, v106
    v_cvt_pk_bf16_f32 v107, 0, v107
    v_cvt_pk_bf16_f32 v108, 0, v108
    v_cvt_pk_bf16_f32 v109, 0, v109
    v_cvt_pk_bf16_f32 v110, 0, v110
    v_cvt_pk_bf16_f32 v111, 0, v111
    v_cvt_pk_bf16_f32 v112, 0, v112
    v_cvt_pk_bf16_f32 v113, 0, v113
    v_cvt_pk_bf16_f32 v114, 0, v114
    v_cvt_pk_bf16_f32 v115, 0, v115
    v_pk_mul_f32 v[108:109], v[108:109], v[116:117] op_sel_hi:[1,0]
    v_pk_mul_f32 v[110:111], v[110:111], v[116:117] op_sel_hi:[1,0]
    v_pk_mul_f32 v[112:113], v[112:113], v[116:117] op_sel_hi:[1,0]
    v_pk_mul_f32 v[114:115], v[114:115], v[116:117] op_sel_hi:[1,0]
    v_cvt_pk_bf16_f32 v108, 0, v108
    v_cvt_pk_bf16_f32 v109, 0, v109
    v_cvt_pk_bf16_f32 v110, 0, v110
    v_cvt_pk_bf16_f32 v111, 0, v111
    v_cvt_pk_bf16_f32 v112, 0, v112
    v_cvt_pk_bf16_f32 v113, 0, v113
    v_cvt_pk_bf16_f32 v114, 0, v114
    v_cvt_pk_bf16_f32 v115, 0, v115
    s_waitcnt lgkmcnt(6)
    v_pk_mul_f32 v[100:101], v[100:101], v[132:133]
    v_pk_mul_f32 v[102:103], v[102:103], v[134:135]
    v_pk_mul_f32 v[104:105], v[104:105], v[136:137]
    v_pk_mul_f32 v[106:107], v[106:107], v[138:139]
    v_cvt_pk_bf16_f32 v100, 0, v100
    v_cvt_pk_bf16_f32 v101, 0, v101
    v_cvt_pk_bf16_f32 v102, 0, v102
    v_cvt_pk_bf16_f32 v103, 0, v103
    v_cvt_pk_bf16_f32 v104, 0, v104
    v_cvt_pk_bf16_f32 v105, 0, v105
    v_cvt_pk_bf16_f32 v106, 0, v106
    v_cvt_pk_bf16_f32 v107, 0, v107
    s_waitcnt lgkmcnt(2)
    v_pk_add_f32 v[100:101], v[100:101], v[148:149]
    v_pk_add_f32 v[102:103], v[102:103], v[150:151]
    v_pk_add_f32 v[104:105], v[104:105], v[152:153]
    v_pk_add_f32 v[106:107], v[106:107], v[154:155]
    v_cvt_pk_bf16_f32 v124, v100, v101
    v_cvt_pk_bf16_f32 v125, v102, v103
    v_cvt_pk_bf16_f32 v126, v104, v105
    v_cvt_pk_bf16_f32 v127, v106, v107
    buffer_store_dwordx4 v[124:127], v8, s[32:35], s13 offen sc1
    v_pk_mul_f32 v[108:109], v[108:109], v[140:141]
    v_pk_mul_f32 v[110:111], v[110:111], v[142:143]
    v_pk_mul_f32 v[112:113], v[112:113], v[144:145]
    v_pk_mul_f32 v[114:115], v[114:115], v[146:147]
    v_cvt_pk_bf16_f32 v108, 0, v108
    v_cvt_pk_bf16_f32 v109, 0, v109
    v_cvt_pk_bf16_f32 v110, 0, v110
    v_cvt_pk_bf16_f32 v111, 0, v111
    v_cvt_pk_bf16_f32 v112, 0, v112
    v_cvt_pk_bf16_f32 v113, 0, v113
    v_cvt_pk_bf16_f32 v114, 0, v114
    v_cvt_pk_bf16_f32 v115, 0, v115
    s_waitcnt lgkmcnt(0)
    v_pk_add_f32 v[108:109], v[108:109], v[156:157]
    v_pk_add_f32 v[110:111], v[110:111], v[158:159]
    v_pk_add_f32 v[112:113], v[112:113], v[160:161]
    v_pk_add_f32 v[114:115], v[114:115], v[162:163]
    v_cvt_pk_bf16_f32 v128, v108, v109
    v_cvt_pk_bf16_f32 v129, v110, v111
    v_cvt_pk_bf16_f32 v130, v112, v113
    v_cvt_pk_bf16_f32 v131, v114, v115
    buffer_store_dwordx4 v[128:131], v8, s[32:35], s13 offen offset:256 sc1
    v_lshrrev_b32 v66, 5, v1
    v_mul_u32_u24 v66, 2080, v66
    v_bfe_u32 v9, v1, 2, 2
    v_lshl_add_u32 v66, v9, 7, v66
    v_bfe_u32 v9, v1, 3, 1
    v_lshl_add_u32 v66, v9, 6, v66
    v_and_b32 v9, 3, v1
    v_lshl_add_u32 v66, v9, 3, v66
    v_bfe_u32 v67, v1, 4, 1
    v_mul_u32_u24 v67, 1056, v67
    v_bfe_u32 v68, v1, 3, 1
    v_lshlrev_b32 v68, 7, v68
    v_add_u32 v66, v66, v67
    v_sub_u32 v67, v66, v68
    v_add_u32 v67, 64, v67
    v_add_u32 v68, 49920, v66
    v_add_u32 v69, 49920, v67
    v_add_u32 v70, 99840, v66
    v_add_u32 v71, 99840, v67
    s_lshl_b32 s96, s76, 11
    s_add_u32 s14, s96, 156416
    v_bfe_u32 v4, v1, 2, 2
    v_lshl_add_u32 v4, v4, 6, s14
    v_bfe_u32 v9, v1, 4, 1
    v_lshl_add_u32 v4, v9, 5, v4
    v_and_b32 v9, 3, v1
    v_lshl_add_u32 v4, v9, 3, v4
    v_lshrrev_b32 v9, 5, v1
    v_lshl_add_u32 v4, v9, 9, v4
    v_and_b32 v5, 7, v1
    v_lshlrev_b32 v5, 12, v5
    v_bfe_u32 v9, v1, 3, 1
    v_lshl_add_u32 v5, v9, 19, v5
    s_and_b32 s96, s12, 1
    s_lshl_b32 s97, s21, 15
    s_lshr_b32 s98, s12, 1
    s_lshl_b32 s99, s98, 6
    s_add_u32 s98, s97, s99
    s_lshl2_add_u32 s97, s96, s98
    s_add_u32 s13, s97, 1048576
    v_bfe_u32 v6, v1, 4, 1
    v_lshlrev_b32 v6, 6, v6
    v_lshrrev_b32 v9, 5, v1
    v_lshl_add_u32 v6, v9, 4, v6
    v_and_b32 v74, 7, v1
    v_lshlrev_b32 v74, 4, v74
    v_xor_b32 v74, v74, v6
    v_lshrrev_b32 v6, 3, v1
    v_lshlrev_b32 v6, 11, v6
    v_add_u32 v74, v74, v6
    s_and_b32 s96, s3, 2
    s_lshl_b32 s14, s96, 5
    v_bfe_u32 v6, v1, 4, 1
    v_lshl_add_u32 v6, v6, 5, s14
    v_and_b32 v72, 7, v1
    v_lshlrev_b32 v72, 4, v72
    v_xor_b32 v72, v72, v6
    v_lshrrev_b32 v6, 3, v1
    v_mul_u32_u24 v6, 7168, v6
    v_add_u32 v72, v72, v6
    s_and_b32 s96, s3, 1
    s_lshl_b32 s14, s96, 7
    v_lshrrev_b32 v6, 5, v1
    v_lshl_add_u32 v6, v6, 6, s14
    v_and_b32 v73, 31, v1
    v_lshlrev_b32 v73, 4, v73
    v_lshrrev_b32 v9, 5, v1
    v_lshl_add_u32 v73, v9, 11, v73
    v_xor_b32 v73, v73, v6
    s_lshl3_add_u32 s96, s75, s3
    s_mul_i32 s97, s96, 229376
    s_lshl_b32 s98, s74, 7
    s_add_u32 s80, s97, s98
    s_lshl3_add_u32 s96, s74, s3
    s_lshl_b32 s97, s96, 14
    s_lshl_b32 s98, s75, 9
    s_add_u32 s81, s97, s98
    s_cmp_ge_u32 s9, 28
    s_cselect_b32 s54, 0, s54
    s_cselect_b32 s58, 0, s58
    s_cselect_b32 s62, 0, s62
    s_waitcnt vmcnt(0)
    s_barrier
    s_cmp_lg_u32 s3, 0
    s_cbranch_scc1 L_PB
    v_mov_b32 v6, s4
    s_mov_b32 exec_hi, 0
    s_mov_b32 exec_lo, 65535
    buffer_store_dword v6, v5, s[32:35], s13 offen sc1
    s_mov_b64 exec, -1
L_PB:
    s_and_b32 s20, s9, 3
    s_cmp_le_u32 s20, 0
    s_cselect_b32 s20, 1, 0
    s_add_u32 s96, s20, s85
    s_and_b32 s97, s96, 15
    s_lshl3_add_u32 s98, s97, s3
    s_mul_i32 s99, s98, 49152
    s_lshl_b32 s96, s11, 7
    s_add_u32 s82, s99, s96
    s_mul_i32 s96, s20, 24960
    s_lshr_b32 s97, s3, 1
    s_mul_i32 s98, s97, 2080
    s_add_u32 s99, s96, s98
    s_and_b32 s97, s3, 1
    s_mul_i32 s96, s97, 1056
    s_add_u32 s20, s99, s96
    s_mov_b32 m0, s20
    s_nop 0
    buffer_load_dwordx4 v62, s[40:43], s82 offen lds
    s_add_u32 s82, s82, 2048
    s_add_u32 m0, s20, 8320
    s_nop 0
    buffer_load_dwordx4 v62, s[40:43], s82 offen lds
    s_add_u32 s82, s82, 2048
    s_add_u32 m0, s20, 16640
    s_nop 0
    buffer_load_dwordx4 v62, s[40:43], s82 offen lds
    s_and_b32 s20, s9, 3
    s_cmp_le_u32 s20, 1
    s_cselect_b32 s20, 2, 1
    s_add_u32 s96, s20, s85
    s_and_b32 s97, s96, 15
    s_lshl3_add_u32 s98, s97, s3
    s_mul_i32 s99, s98, 49152
    s_lshl_b32 s96, s11, 7
    s_add_u32 s82, s99, s96
    s_mul_i32 s96, s20, 24960
    s_lshr_b32 s97, s3, 1
    s_mul_i32 s98, s97, 2080
    s_add_u32 s99, s96, s98
    s_and_b32 s97, s3, 1
    s_mul_i32 s96, s97, 1056
    s_add_u32 s20, s99, s96
    s_mov_b32 m0, s20
    s_nop 0
    buffer_load_dwordx4 v62, s[40:43], s82 offen lds
    s_add_u32 s82, s82, 2048
    s_add_u32 m0, s20, 8320
    s_nop 0
    buffer_load_dwordx4 v62, s[40:43], s82 offen lds
    s_add_u32 s82, s82, 2048
    s_add_u32 m0, s20, 16640
    s_nop 0
    buffer_load_dwordx4 v62, s[40:43], s82 offen lds
    ds_read_b64_tr_b16 v[28:29], v4
    ds_read_b64_tr_b16 v[30:31], v4 offset:256
    ds_read_b64_tr_b16 v[32:33], v4 offset:1024
    ds_read_b64_tr_b16 v[34:35], v4 offset:1280
    s_lshl_b32 s96, s10, 6
    s_add_u32 s97, s96, s3
    s_lshl_b32 s98, s97, 12
    s_add_u32 s15, s98, 4194304
    s_and_b32 s96, s3, 3
    s_lshl_b32 s97, s96, 12
    s_add_u32 s13, s97, 147456
    v_add_u32 v76, s13, v2
    v_and_b32 v77, 15, v1
    v_lshl_add_u32 v77, v77, 4, s13
    v_lshrrev_b32 v9, 5, v1
    v_lshl_add_u32 v77, v9, 9, v77
    v_bfe_u32 v9, v1, 4, 1
    v_lshl_add_u32 v77, v9, 3, v77
    s_and_b32 s96, s3, 3
    s_lshl_b32 s97, s96, 10
    s_add_u32 s13, s97, 32768
    v_and_b32 v78, 15, v1
    v_lshl_add_u32 v78, v78, 5, s13
    v_lshrrev_b32 v9, 4, v1
    v_lshl_add_u32 v78, v9, 3, v78
    s_and_b32 s96, s3, 3
    s_lshl_b32 s97, s96, 10
    s_lshl_b32 s98, s76, 14
    s_add_u32 s13, s97, s98
    v_and_b32 v75, 31, v1
    v_lshl_add_u32 v75, v75, 5, s13
    v_lshrrev_b32 v9, 5, v1
    v_lshl_add_u32 v75, v9, 4, v75
    s_lshl_b32 s84, s3, 14
    s_lshr_b32 s96, s9, 4
    s_lshl_b32 s97, s96, 20
    s_lshl_b32 s98, s12, 7
    s_add_u32 s88, s97, s98
    s_lshl_b32 s89, s3, 10
    s_load_dwordx2 s[24:25], s[32:33], s92 offset:0 glc
    s_and_b32 s20, s9, 3
    s_cmp_le_u32 s20, 2
    s_cselect_b32 s20, 3, 2
    s_add_u32 s96, s20, s85
    s_and_b32 s97, s96, 15
    s_lshl3_add_u32 s98, s97, s3
    s_mul_i32 s99, s98, 49152
    s_lshl_b32 s96, s11, 7
    s_add_u32 s82, s99, s96
    s_mul_i32 s96, s20, 24960
    s_lshr_b32 s97, s3, 1
    s_mul_i32 s98, s97, 2080
    s_add_u32 s99, s96, s98
    s_and_b32 s97, s3, 1
    s_mul_i32 s96, s97, 1056
    s_add_u32 s20, s99, s96
    s_mov_b32 m0, s20
    s_nop 0
    buffer_load_dwordx4 v62, s[40:43], s82 offen lds
    s_add_u32 s82, s82, 2048
    s_add_u32 m0, s20, 8320
    s_nop 0
    buffer_load_dwordx4 v62, s[40:43], s82 offen lds
    s_add_u32 s82, s82, 2048
    s_add_u32 m0, s20, 16640
    s_nop 0
    buffer_load_dwordx4 v62, s[40:43], s82 offen lds
    s_add_u32 s96, s85, 4
    s_and_b32 s97, s96, 15
    s_lshl3_add_u32 s98, s97, s3
    s_mul_i32 s99, s98, 49152
    s_lshl_b32 s96, s11, 7
    s_add_u32 s82, s99, s96
    s_lshr_b32 s96, s3, 1
    s_mul_i32 s97, s96, 2080
    s_and_b32 s98, s3, 1
    s_mul_i32 s99, s98, 1056
    s_add_u32 s96, s97, s99
    s_add_u32 s20, s96, 99840
    s_mov_b32 m0, s20
    s_nop 0
    buffer_load_dwordx4 v62, s[40:43], s82 offen lds
    s_add_u32 s82, s82, 2048
    s_add_u32 m0, s20, 8320
    s_nop 0
    buffer_load_dwordx4 v62, s[40:43], s82 offen lds
    s_add_u32 s82, s82, 2048
    s_add_u32 m0, s20, 16640
    s_nop 0
    buffer_load_dwordx4 v62, s[40:43], s82 offen lds
    s_branch SCHK_12
SPOLL_11:
    s_load_dwordx2 s[24:25], s[32:33], s92 offset:0 glc
SCHK_12:
    s_add_u32 s5, s5, 1
    s_cmp_ge_u32 s5, 300000
    s_waitcnt lgkmcnt(0)
    s_cbranch_scc1 SDONE_13
    s_cmp_lg_u32 s24, s4
    s_cbranch_scc1 SPOLL_11
    s_cmp_lg_u32 s25, s4
    s_cbranch_scc1 SPOLL_11
SDONE_13:
    s_waitcnt vmcnt(9)
    s_barrier
    s_cmp_ge_u32 s3, 4
    s_cbranch_scc1 L_HELP
    s_setprio 2
    s_and_b32 s96, s85, 15
    s_lshl_b32 s97, s96, 14
    s_add_u32 s16, s97, s15
    buffer_load_dwordx4 v[176:179], v2, s[32:35], s16 offen sc1
    buffer_load_dwordx4 v[180:183], v2, s[32:35], s16 offen offset:1024 sc1
    ds_read_b64_tr_b16 v[224:225], v67 offset:8320
    ds_read_b64_tr_b16 v[226:227], v67 offset:8832
    ds_read_b64_tr_b16 v[228:229], v67 offset:8352
    ds_read_b64_tr_b16 v[230:231], v67 offset:8864
    ds_read_b64_tr_b16 v[232:233], v66 offset:8320
    ds_read_b64_tr_b16 v[234:235], v66 offset:8832
    ds_read_b64_tr_b16 v[236:237], v66 offset:8352
    ds_read_b64_tr_b16 v[238:239], v66 offset:8864
    ds_read_b64_tr_b16 v[240:241], v66
    ds_read_b64_tr_b16 v[242:243], v66 offset:512
    ds_read_b64_tr_b16 v[244:245], v66 offset:32
    ds_read_b64_tr_b16 v[246:247], v66 offset:544
    buffer_load_dwordx4 v[184:187], v2, s[32:35], s16 offen offset:2048 sc1
    buffer_load_dwordx4 v[188:191], v2, s[32:35], s16 offen offset:3072 sc1
    s_waitcnt lgkmcnt(8)
    s_waitcnt vmcnt(3)
    v_mfma_f32_16x16x32_bf16 v[128:131], v[224:227], v[176:179], 0
    ds_read_b64_tr_b16 v[248:249], v67
    s_waitcnt vmcnt(2)
    v_mfma_f32_16x16x32_bf16 v[132:135], v[224:227], v[180:183], 0
    ds_read_b64_tr_b16 v[250:251], v67 offset:512
    s_add_u32 s96, s85, 1
    s_and_b32 s97, s96, 15
    s_lshl_b32 s98, s97, 14
    s_add_u32 s16, s98, s15
    buffer_load_dwordx4 v[192:195], v2, s[32:35], s16 offen sc1
    v_mfma_f32_16x16x32_bf16 v[136:139], v[228:231], v[176:179], 0
    ds_read_b64_tr_b16 v[224:225], v67 offset:32
    v_mfma_f32_16x16x32_bf16 v[140:143], v[228:231], v[180:183], 0
    ds_read_b64_tr_b16 v[226:227], v67 offset:544
    s_waitcnt lgkmcnt(8)
    v_mfma_f32_16x16x32_bf16 v[112:115], v[232:235], v[176:179], 0
    ds_read_b64_tr_b16 v[228:229], v66 offset:16640
    v_mfma_f32_16x16x32_bf16 v[116:119], v[232:235], v[180:183], 0
    ds_read_b64_tr_b16 v[230:231], v66 offset:17152
    v_mfma_f32_16x16x32_bf16 v[120:123], v[236:239], v[176:179], 0
    ds_read_b64_tr_b16 v[232:233], v66 offset:16672
    v_mfma_f32_16x16x32_bf16 v[124:127], v[236:239], v[180:183], 0
    ds_read_b64_tr_b16 v[234:235], v66 offset:17184
    buffer_load_dwordx4 v[196:199], v2, s[32:35], s16 offen offset:1024 sc1
    s_waitcnt lgkmcnt(8)
    v_mfma_f32_16x16x32_bf16 v[80:83], v[240:243], v[176:179], 0
    ds_read_b64_tr_b16 v[236:237], v67 offset:16640
    v_mfma_f32_16x16x32_bf16 v[84:87], v[240:243], v[180:183], 0
    ds_read_b64_tr_b16 v[238:239], v67 offset:17152
    v_mfma_f32_16x16x32_bf16 v[88:91], v[244:247], v[176:179], 0
    ds_read_b64_tr_b16 v[240:241], v67 offset:16672
    v_mfma_f32_16x16x32_bf16 v[92:95], v[244:247], v[180:183], 0
    ds_read_b64_tr_b16 v[242:243], v67 offset:17184
    s_waitcnt lgkmcnt(8)
    v_mfma_f32_16x16x32_bf16 v[96:99], v[248:251], v[176:179], 0
    ds_read_b64_tr_b16 v[244:245], v67 offset:12480
    v_mfma_f32_16x16x32_bf16 v[100:103], v[248:251], v[180:183], 0
    ds_read_b64_tr_b16 v[246:247], v67 offset:12992
    buffer_load_dwordx4 v[200:203], v2, s[32:35], s16 offen offset:2048 sc1
    v_mfma_f32_16x16x32_bf16 v[104:107], v[224:227], v[176:179], 0
    ds_read_b64_tr_b16 v[248:249], v67 offset:12512
    v_mfma_f32_16x16x32_bf16 v[108:111], v[224:227], v[180:183], 0
    ds_read_b64_tr_b16 v[250:251], v67 offset:13024
    s_waitcnt lgkmcnt(8)
    v_mfma_f32_16x16x32_bf16 v[144:147], v[228:231], v[176:179], 0
    ds_read_b64_tr_b16 v[224:225], v66 offset:12480
    v_mfma_f32_16x16x32_bf16 v[148:151], v[228:231], v[180:183], 0
    ds_read_b64_tr_b16 v[226:227], v66 offset:12992
    v_mfma_f32_16x16x32_bf16 v[152:155], v[232:235], v[176:179], 0
    ds_read_b64_tr_b16 v[228:229], v66 offset:12512
    v_mfma_f32_16x16x32_bf16 v[156:159], v[232:235], v[180:183], 0
    ds_read_b64_tr_b16 v[230:231], v66 offset:13024
    buffer_load_dwordx4 v[204:207], v2, s[32:35], s16 offen offset:3072 sc1
    s_waitcnt lgkmcnt(8)
    v_mfma_f32_16x16x32_bf16 v[160:163], v[236:239], v[176:179], 0
    ds_read_b64_tr_b16 v[232:233], v66 offset:4160
    v_mfma_f32_16x16x32_bf16 v[164:167], v[236:239], v[180:183], 0
    ds_read_b64_tr_b16 v[234:235], v66 offset:4672
    v_mfma_f32_16x16x32_bf16 v[168:171], v[240:243], v[176:179], 0
    ds_read_b64_tr_b16 v[236:237], v66 offset:4192
    v_mfma_f32_16x16x32_bf16 v[172:175], v[240:243], v[180:183], 0
    ds_read_b64_tr_b16 v[238:239], v66 offset:4704
    s_waitcnt lgkmcnt(8)
    s_waitcnt vmcnt(5)
    v_mfma_f32_16x16x32_bf16 v[128:131], v[244:247], v[184:187], v[128:131]
    ds_read_b64_tr_b16 v[240:241], v67 offset:4160
    s_waitcnt vmcnt(4)
    v_mfma_f32_16x16x32_bf16 v[132:135], v[244:247], v[188:191], v[132:135]
    ds_read_b64_tr_b16 v[242:243], v67 offset:4672
    s_add_u32 s96, s85, 2
    s_and_b32 s97, s96, 15
    s_lshl_b32 s98, s97, 14
    s_add_u32 s16, s98, s15
    buffer_load_dwordx4 v[208:211], v2, s[32:35], s16 offen sc1
    v_mfma_f32_16x16x32_bf16 v[136:139], v[248:251], v[184:187], v[136:139]
    ds_read_b64_tr_b16 v[244:245], v67 offset:4192
    v_mfma_f32_16x16x32_bf16 v[140:143], v[248:251], v[188:191], v[140:143]
    ds_read_b64_tr_b16 v[246:247], v67 offset:4704
    s_waitcnt lgkmcnt(8)
    v_mfma_f32_16x16x32_bf16 v[112:115], v[224:227], v[184:187], v[112:115]
    ds_read_b64_tr_b16 v[248:249], v66 offset:20800
    v_mfma_f32_16x16x32_bf16 v[116:119], v[224:227], v[188:191], v[116:119]
    ds_read_b64_tr_b16 v[250:251], v66 offset:21312
    v_mfma_f32_16x16x32_bf16 v[120:123], v[228:231], v[184:187], v[120:123]
    ds_read_b64_tr_b16 v[224:225], v66 offset:20832
    v_mfma_f32_16x16x32_bf16 v[124:127], v[228:231], v[188:191], v[124:127]
    ds_read_b64_tr_b16 v[226:227], v66 offset:21344
    buffer_load_dwordx4 v[212:215], v2, s[32:35], s16 offen offset:1024 sc1
    s_waitcnt lgkmcnt(8)
    v_mfma_f32_16x16x32_bf16 v[80:83], v[232:235], v[184:187], v[80:83]
    ds_read_b64_tr_b16 v[228:229], v67 offset:20800
    v_mfma_f32_16x16x32_bf16 v[84:87], v[232:235], v[188:191], v[84:87]
    ds_read_b64_tr_b16 v[230:231], v67 offset:21312
    v_mfma_f32_16x16x32_bf16 v[88:91], v[236:239], v[184:187], v[88:91]
    ds_read_b64_tr_b16 v[232:233], v67 offset:20832
    v_mfma_f32_16x16x32_bf16 v[92:95], v[236:239], v[188:191], v[92:95]
    ds_read_b64_tr_b16 v[234:235], v67 offset:21344
    s_waitcnt lgkmcnt(8)
    v_mfma_f32_16x16x32_bf16 v[96:99], v[240:243], v[184:187], v[96:99]
    s_barrier
    ds_read_b64_tr_b16 v[236:237], v67 offset:33280
    v_mfma_f32_16x16x32_bf16 v[100:103], v[240:243], v[188:191], v[100:103]
    ds_read_b64_tr_b16 v[238:239], v67 offset:33792
    buffer_load_dwordx4 v[216:219], v2, s[32:35], s16 offen offset:2048 sc1
    v_mfma_f32_16x16x32_bf16 v[104:107], v[244:247], v[184:187], v[104:107]
    ds_read_b64_tr_b16 v[240:241], v67 offset:33312
    v_mfma_f32_16x16x32_bf16 v[108:111], v[244:247], v[188:191], v[108:111]
    ds_read_b64_tr_b16 v[242:243], v67 offset:33824
    s_waitcnt lgkmcnt(8)
    v_mfma_f32_16x16x32_bf16 v[144:147], v[248:251], v[184:187], v[144:147]
    ds_read_b64_tr_b16 v[244:245], v66 offset:33280
    v_mfma_f32_16x16x32_bf16 v[148:151], v[248:251], v[188:191], v[148:151]
    ds_read_b64_tr_b16 v[246:247], v66 offset:33792
    v_mfma_f32_16x16x32_bf16 v[152:155], v[224:227], v[184:187], v[152:155]
    ds_read_b64_tr_b16 v[248:249], v66 offset:33312
    v_mfma_f32_16x16x32_bf16 v[156:159], v[224:227], v[188:191], v[156:159]
    ds_read_b64_tr_b16 v[250:251], v66 offset:33824
    buffer_load_dwordx4 v[220:223], v2, s[32:35], s16 offen offset:3072 sc1
    s_waitcnt lgkmcnt(8)
    v_mfma_f32_16x16x32_bf16 v[160:163], v[228:231], v[184:187], v[160:163]
    ds_read_b64_tr_b16 v[224:225], v66 offset:24960
    v_mfma_f32_16x16x32_bf16 v[164:167], v[228:231], v[188:191], v[164:167]
    ds_read_b64_tr_b16 v[226:227], v66 offset:25472
    v_mfma_f32_16x16x32_bf16 v[168:171], v[232:235], v[184:187], v[168:171]
    ds_read_b64_tr_b16 v[228:229], v66 offset:24992
    v_mfma_f32_16x16x32_bf16 v[172:175], v[232:235], v[188:191], v[172:175]
    ds_read_b64_tr_b16 v[230:231], v66 offset:25504
    s_waitcnt lgkmcnt(8)
    s_waitcnt vmcnt(6)
    v_mfma_f32_16x16x32_bf16 v[128:131], v[236:239], v[192:195], v[128:131]
    ds_read_b64_tr_b16 v[232:233], v67 offset:24960
    v_mfma_f32_16x16x32_bf16 v[132:135], v[236:239], v[196:199], v[132:135]
    ds_read_b64_tr_b16 v[234:235], v67 offset:25472
    s_add_u32 s96, s85, 3
    s_and_b32 s97, s96, 15
    s_lshl_b32 s98, s97, 14
    s_add_u32 s16, s98, s15
    buffer_load_dwordx4 v[36:39], v2, s[32:35], s16 offen sc1
    v_mfma_f32_16x16x32_bf16 v[136:139], v[240:243], v[192:195], v[136:139]
    ds_read_b64_tr_b16 v[236:237], v67 offset:24992
    v_mfma_f32_16x16x32_bf16 v[140:143], v[240:243], v[196:199], v[140:143]
    ds_read_b64_tr_b16 v[238:239], v67 offset:25504
    s_waitcnt lgkmcnt(8)
    v_mfma_f32_16x16x32_bf16 v[112:115], v[244:247], v[192:195], v[112:115]
    ds_read_b64_tr_b16 v[240:241], v66 offset:41600
    v_mfma_f32_16x16x32_bf16 v[116:119], v[244:247], v[196:199], v[116:119]
    ds_read_b64_tr_b16 v[242:243], v66 offset:42112
    v_mfma_f32_16x16x32_bf16 v[120:123], v[248:251], v[192:195], v[120:123]
    ds_read_b64_tr_b16 v[244:245], v66 offset:41632
    v_mfma_f32_16x16x32_bf16 v[124:127], v[248:251], v[196:199], v[124:127]
    ds_read_b64_tr_b16 v[246:247], v66 offset:42144
    buffer_load_dwordx4 v[176:179], v2, s[32:35], s16 offen offset:1024 sc1
    s_waitcnt lgkmcnt(8)
    v_mfma_f32_16x16x32_bf16 v[80:83], v[224:227], v[192:195], v[80:83]
    ds_read_b64_tr_b16 v[248:249], v67 offset:41600
    v_mfma_f32_16x16x32_bf16 v[84:87], v[224:227], v[196:199], v[84:87]
    ds_read_b64_tr_b16 v[250:251], v67 offset:42112
    v_mfma_f32_16x16x32_bf16 v[88:91], v[228:231], v[192:195], v[88:91]
    ds_read_b64_tr_b16 v[224:225], v67 offset:41632
    v_mfma_f32_16x16x32_bf16 v[92:95], v[228:231], v[196:199], v[92:95]
    ds_read_b64_tr_b16 v[226:227], v67 offset:42144
    s_waitcnt lgkmcnt(8)
    v_mfma_f32_16x16x32_bf16 v[96:99], v[232:235], v[192:195], v[96:99]
    ds_read_b64_tr_b16 v[228:229], v67 offset:37440
    v_mfma_f32_16x16x32_bf16 v[100:103], v[232:235], v[196:199], v[100:103]
    ds_read_b64_tr_b16 v[230:231], v67 offset:37952
    buffer_load_dwordx4 v[180:183], v2, s[32:35], s16 offen offset:2048 sc1
    v_mfma_f32_16x16x32_bf16 v[104:107], v[236:239], v[192:195], v[104:107]
    ds_read_b64_tr_b16 v[232:233], v67 offset:37472
    v_mfma_f32_16x16x32_bf16 v[108:111], v[236:239], v[196:199], v[108:111]
    ds_read_b64_tr_b16 v[234:235], v67 offset:37984
    s_waitcnt lgkmcnt(8)
    v_mfma_f32_16x16x32_bf16 v[144:147], v[240:243], v[192:195], v[144:147]
    ds_read_b64_tr_b16 v[236:237], v66 offset:37440
    v_mfma_f32_16x16x32_bf16 v[148:151], v[240:243], v[196:199], v[148:151]
    ds_read_b64_tr_b16 v[238:239], v66 offset:37952
    v_mfma_f32_16x16x32_bf16 v[152:155], v[244:247], v[192:195], v[152:155]
    ds_read_b64_tr_b16 v[240:241], v66 offset:37472
    v_mfma_f32_16x16x32_bf16 v[156:159], v[244:247], v[196:199], v[156:159]
    ds_read_b64_tr_b16 v[242:243], v66 offset:37984
    buffer_load_dwordx4 v[184:187], v2, s[32:35], s16 offen offset:3072 sc1
    s_waitcnt lgkmcnt(8)
    v_mfma_f32_16x16x32_bf16 v[160:163], v[248:251], v[192:195], v[160:163]
    ds_read_b64_tr_b16 v[244:245], v66 offset:29120
    v_mfma_f32_16x16x32_bf16 v[164:167], v[248:251], v[196:199], v[164:167]
    ds_read_b64_tr_b16 v[246:247], v66 offset:29632
    v_mfma_f32_16x16x32_bf16 v[168:171], v[224:227], v[192:195], v[168:171]
    ds_read_b64_tr_b16 v[248:249], v66 offset:29152
    v_mfma_f32_16x16x32_bf16 v[172:175], v[224:227], v[196:199], v[172:175]
    ds_read_b64_tr_b16 v[250:251], v66 offset:29664
    s_waitcnt lgkmcnt(8)
    s_waitcnt vmcnt(8)
    v_mfma_f32_16x16x32_bf16 v[128:131], v[228:231], v[200:203], v[128:131]
    ds_read_b64_tr_b16 v[224:225], v67 offset:29120
    v_mfma_f32_16x16x32_bf16 v[132:135], v[228:231], v[204:207], v[132:135]
    ds_read_b64_tr_b16 v[226:227], v67 offset:29632
    s_add_u32 s96, s85, 4
    s_and_b32 s97, s96, 15
    s_lshl_b32 s98, s97, 14
    s_add_u32 s16, s98, s15
    buffer_load_dwordx4 v[188:191], v2, s[32:35], s16 offen sc1
    v_mfma_f32_16x16x32_bf16 v[136:139], v[232:235], v[200:203], v[136:139]
    ds_read_b64_tr_b16 v[228:229], v67 offset:29152
    v_mfma_f32_16x16x32_bf16 v[140:143], v[232:235], v[204:207], v[140:143]
    ds_read_b64_tr_b16 v[230:231], v67 offset:29664
    s_waitcnt lgkmcnt(8)
    v_mfma_f32_16x16x32_bf16 v[112:115], v[236:239], v[200:203], v[112:115]
    ds_read_b64_tr_b16 v[232:233], v66 offset:45760
    v_mfma_f32_16x16x32_bf16 v[116:119], v[236:239], v[204:207], v[116:119]
    ds_read_b64_tr_b16 v[234:235], v66 offset:46272
    v_mfma_f32_16x16x32_bf16 v[120:123], v[240:243], v[200:203], v[120:123]
    ds_read_b64_tr_b16 v[236:237], v66 offset:45792
    v_mfma_f32_16x16x32_bf16 v[124:127], v[240:243], v[204:207], v[124:127]
    ds_read_b64_tr_b16 v[238:239], v66 offset:46304
    buffer_load_dwordx4 v[192:195], v2, s[32:35], s16 offen offset:1024 sc1
    s_waitcnt lgkmcnt(8)
    v_mfma_f32_16x16x32_bf16 v[80:83], v[244:247], v[200:203], v[80:83]
    ds_read_b64_tr_b16 v[240:241], v67 offset:45760
    v_mfma_f32_16x16x32_bf16 v[84:87], v[244:247], v[204:207], v[84:87]
    ds_read_b64_tr_b16 v[242:243], v67 offset:46272
    v_mfma_f32_16x16x32_bf16 v[88:91], v[248:251], v[200:203], v[88:91]
    ds_read_b64_tr_b16 v[244:245], v67 offset:45792
    v_mfma_f32_16x16x32_bf16 v[92:95], v[248:251], v[204:207], v[92:95]
    ds_read_b64_tr_b16 v[246:247], v67 offset:46304
    s_waitcnt lgkmcnt(8)
    v_mfma_f32_16x16x32_bf16 v[96:99], v[224:227], v[200:203], v[96:99]
    s_barrier
    ds_read_b64_tr_b16 v[248:249], v69 offset:8320
    v_mfma_f32_16x16x32_bf16 v[100:103], v[224:227], v[204:207], v[100:103]
    ds_read_b64_tr_b16 v[250:251], v69 offset:8832
    buffer_load_dwordx4 v[196:199], v2, s[32:35], s16 offen offset:2048 sc1
    v_mfma_f32_16x16x32_bf16 v[104:107], v[228:231], v[200:203], v[104:107]
    ds_read_b64_tr_b16 v[224:225], v69 offset:8352
    v_mfma_f32_16x16x32_bf16 v[108:111], v[228:231], v[204:207], v[108:111]
    ds_read_b64_tr_b16 v[226:227], v69 offset:8864
    s_waitcnt lgkmcnt(8)
    v_mfma_f32_16x16x32_bf16 v[144:147], v[232:235], v[200:203], v[144:147]
    ds_read_b64_tr_b16 v[228:229], v68 offset:8320
    v_mfma_f32_16x16x32_bf16 v[148:151], v[232:235], v[204:207], v[148:151]
    ds_read_b64_tr_b16 v[230:231], v68 offset:8832
    v_mfma_f32_16x16x32_bf16 v[152:155], v[236:239], v[200:203], v[152:155]
    ds_read_b64_tr_b16 v[232:233], v68 offset:8352
    v_mfma_f32_16x16x32_bf16 v[156:159], v[236:239], v[204:207], v[156:159]
    ds_read_b64_tr_b16 v[234:235], v68 offset:8864
    s_waitcnt lgkmcnt(8)
    v_mfma_f32_16x16x32_bf16 v[160:163], v[240:243], v[200:203], v[160:163]
    ds_read_b64_tr_b16 v[236:237], v68
    v_mfma_f32_16x16x32_bf16 v[164:167], v[240:243], v[204:207], v[164:167]
    ds_read_b64_tr_b16 v[238:239], v68 offset:512
    v_mfma_f32_16x16x32_bf16 v[168:171], v[244:247], v[200:203], v[168:171]
    ds_read_b64_tr_b16 v[240:241], v68 offset:32
    v_mfma_f32_16x16x32_bf16 v[172:175], v[244:247], v[204:207], v[172:175]
    ds_read_b64_tr_b16 v[242:243], v68 offset:544
    s_waitcnt lgkmcnt(8)
    s_waitcnt vmcnt(9)
    v_mfma_f32_16x16x32_bf16 v[128:131], v[248:251], v[208:211], v[128:131]
    ds_read_b64_tr_b16 v[244:245], v69
    v_mfma_f32_16x16x32_bf16 v[132:135], v[248:251], v[212:215], v[132:135]
    ds_read_b64_tr_b16 v[246:247], v69 offset:512
    buffer_load_dwordx4 v[200:203], v2, s[32:35], s16 offen offset:3072 sc1
    v_mfma_f32_16x16x32_bf16 v[136:139], v[224:227], v[208:211], v[136:139]
    ds_read_b64_tr_b16 v[248:249], v69 offset:32
    v_mfma_f32_16x16x32_bf16 v[140:143], v[224:227], v[212:215], v[140:143]
    ds_read_b64_tr_b16 v[250:251], v69 offset:544
    s_waitcnt lgkmcnt(8)
    v_mfma_f32_16x16x32_bf16 v[112:115], v[228:231], v[208:211], v[112:115]
    ds_read_b64_tr_b16 v[224:225], v68 offset:16640
    v_mfma_f32_16x16x32_bf16 v[116:119], v[228:231], v[212:215], v[116:119]
    ds_read_b64_tr_b16 v[226:227], v68 offset:17152
    v_mfma_f32_16x16x32_bf16 v[120:123], v[232:235], v[208:211], v[120:123]
    ds_read_b64_tr_b16 v[228:229], v68 offset:16672
    v_mfma_f32_16x16x32_bf16 v[124:127], v[232:235], v[212:215], v[124:127]
    ds_read_b64_tr_b16 v[230:231], v68 offset:17184
    s_add_u32 s96, s85, 5
    s_and_b32 s97, s96, 15
    s_lshl_b32 s98, s97, 14
    s_add_u32 s16, s98, s15
    buffer_load_dwordx4 v[204:207], v2, s[32:35], s16 offen sc1
    s_waitcnt lgkmcnt(8)
    v_mfma_f32_16x16x32_bf16 v[80:83], v[236:239], v[208:211], v[80:83]
    ds_read_b64_tr_b16 v[232:233], v69 offset:16640
    v_mfma_f32_16x16x32_bf16 v[84:87], v[236:239], v[212:215], v[84:87]
    ds_read_b64_tr_b16 v[234:235], v69 offset:17152
    v_mfma_f32_16x16x32_bf16 v[88:91], v[240:243], v[208:211], v[88:91]
    ds_read_b64_tr_b16 v[236:237], v69 offset:16672
    v_mfma_f32_16x16x32_bf16 v[92:95], v[240:243], v[212:215], v[92:95]
    ds_read_b64_tr_b16 v[238:239], v69 offset:17184
    s_waitcnt lgkmcnt(8)
    v_mfma_f32_16x16x32_bf16 v[96:99], v[244:247], v[208:211], v[96:99]
    ds_read_b64_tr_b16 v[240:241], v69 offset:12480
    v_mfma_f32_16x16x32_bf16 v[100:103], v[244:247], v[212:215], v[100:103]
    ds_read_b64_tr_b16 v[242:243], v69 offset:12992
    v_mfma_f32_16x16x32_bf16 v[104:107], v[248:251], v[208:211], v[104:107]
    ds_read_b64_tr_b16 v[244:245], v69 offset:12512
    v_mfma_f32_16x16x32_bf16 v[108:111], v[248:251], v[212:215], v[108:111]
    ds_read_b64_tr_b16 v[246:247], v69 offset:13024
    s_waitcnt lgkmcnt(8)
    v_mfma_f32_16x16x32_bf16 v[144:147], v[224:227], v[208:211], v[144:147]
    ds_read_b64_tr_b16 v[248:249], v68 offset:12480
    v_mfma_f32_16x16x32_bf16 v[148:151], v[224:227], v[212:215], v[148:151]
    ds_read_b64_tr_b16 v[250:251], v68 offset:12992
    v_mfma_f32_16x16x32_bf16 v[152:155], v[228:231], v[208:211], v[152:155]
    ds_read_b64_tr_b16 v[224:225], v68 offset:12512
    v_mfma_f32_16x16x32_bf16 v[156:159], v[228:231], v[212:215], v[156:159]
    ds_read_b64_tr_b16 v[226:227], v68 offset:13024
    s_waitcnt lgkmcnt(8)
    v_mfma_f32_16x16x32_bf16 v[160:163], v[232:235], v[208:211], v[160:163]
    ds_read_b64_tr_b16 v[228:229], v68 offset:4160
    v_mfma_f32_16x16x32_bf16 v[164:167], v[232:235], v[212:215], v[164:167]
    ds_read_b64_tr_b16 v[230:231], v68 offset:4672
    v_mfma_f32_16x16x32_bf16 v[168:171], v[236:239], v[208:211], v[168:171]
    ds_read_b64_tr_b16 v[232:233], v68 offset:4192
    v_mfma_f32_16x16x32_bf16 v[172:175], v[236:239], v[212:215], v[172:175]
    ds_read_b64_tr_b16 v[234:235], v68 offset:4704
    s_waitcnt lgkmcnt(8)
    s_waitcnt vmcnt(9)
    v_mfma_f32_16x16x32_bf16 v[128:131], v[240:243], v[216:219], v[128:131]
    ds_read_b64_tr_b16 v[236:237], v69 offset:4160
    v_mfma_f32_16x16x32_bf16 v[132:135], v[240:243], v[220:223], v[132:135]
    ds_read_b64_tr_b16 v[238:239], v69 offset:4672
    buffer_load_dwordx4 v[208:211], v2, s[32:35], s16 offen offset:1024 sc1
    v_mfma_f32_16x16x32_bf16 v[136:139], v[244:247], v[216:219], v[136:139]
    ds_read_b64_tr_b16 v[240:241], v69 offset:4192
    v_mfma_f32_16x16x32_bf16 v[140:143], v[244:247], v[220:223], v[140:143]
    ds_read_b64_tr_b16 v[242:243], v69 offset:4704
    s_waitcnt lgkmcnt(8)
    v_mfma_f32_16x16x32_bf16 v[112:115], v[248:251], v[216:219], v[112:115]
    ds_read_b64_tr_b16 v[244:245], v68 offset:20800
    v_mfma_f32_16x16x32_bf16 v[116:119], v[248:251], v[220:223], v[116:119]
    ds_read_b64_tr_b16 v[246:247], v68 offset:21312
    v_mfma_f32_16x16x32_bf16 v[120:123], v[224:227], v[216:219], v[120:123]
    ds_read_b64_tr_b16 v[248:249], v68 offset:20832
    v_mfma_f32_16x16x32_bf16 v[124:127], v[224:227], v[220:223], v[124:127]
    ds_read_b64_tr_b16 v[250:251], v68 offset:21344
    buffer_load_dwordx4 v[212:215], v2, s[32:35], s16 offen offset:2048 sc1
    s_waitcnt lgkmcnt(8)
    v_mfma_f32_16x16x32_bf16 v[80:83], v[228:231], v[216:219], v[80:83]
    ds_read_b64_tr_b16 v[224:225], v69 offset:20800
    v_mfma_f32_16x16x32_bf16 v[84:87], v[228:231], v[220:223], v[84:87]
    ds_read_b64_tr_b16 v[226:227], v69 offset:21312
    v_mfma_f32_16x16x32_bf16 v[88:91], v[232:235], v[216:219], v[88:91]
    ds_read_b64_tr_b16 v[228:229], v69 offset:20832
    v_mfma_f32_16x16x32_bf16 v[92:95], v[232:235], v[220:223], v[92:95]
    ds_read_b64_tr_b16 v[230:231], v69 offset:21344
    s_waitcnt lgkmcnt(8)
    v_mfma_f32_16x16x32_bf16 v[96:99], v[236:239], v[216:219], v[96:99]
    s_barrier
    ds_read_b64_tr_b16 v[232:233], v69 offset:33280
    v_mfma_f32_16x16x32_bf16 v[100:103], v[236:239], v[220:223], v[100:103]
    ds_read_b64_tr_b16 v[234:235], v69 offset:33792
    v_mfma_f32_16x16x32_bf16 v[104:107], v[240:243], v[216:219], v[104:107]
    ds_read_b64_tr_b16 v[236:237], v69 offset:33312
    v_mfma_f32_16x16x32_bf16 v[108:111], v[240:243], v[220:223], v[108:111]
    ds_read_b64_tr_b16 v[238:239], v69 offset:33824
    s_waitcnt lgkmcnt(8)
    v_mfma_f32_16x16x32_bf16 v[144:147], v[244:247], v[216:219], v[144:147]
    ds_read_b64_tr_b16 v[240:241], v68 offset:33280
    v_mfma_f32_16x16x32_bf16 v[148:151], v[244:247], v[220:223], v[148:151]
    ds_read_b64_tr_b16 v[242:243], v68 offset:33792
    v_mfma_f32_16x16x32_bf16 v[152:155], v[248:251], v[216:219], v[152:155]
    ds_read_b64_tr_b16 v[244:245], v68 offset:33312
    v_mfma_f32_16x16x32_bf16 v[156:159], v[248:251], v[220:223], v[156:159]
    ds_read_b64_tr_b16 v[246:247], v68 offset:33824
    s_waitcnt lgkmcnt(8)
    v_mfma_f32_16x16x32_bf16 v[160:163], v[224:227], v[216:219], v[160:163]
    ds_read_b64_tr_b16 v[248:249], v68 offset:24960
    v_mfma_f32_16x16x32_bf16 v[164:167], v[224:227], v[220:223], v[164:167]
    ds_read_b64_tr_b16 v[250:251], v68 offset:25472
    v_mfma_f32_16x16x32_bf16 v[168:171], v[228:231], v[216:219], v[168:171]
    ds_read_b64_tr_b16 v[224:225], v68 offset:24992
    v_mfma_f32_16x16x32_bf16 v[172:175], v[228:231], v[220:223], v[172:175]
    ds_read_b64_tr_b16 v[226:227], v68 offset:25504
    s_waitcnt lgkmcnt(8)
    s_waitcnt vmcnt(9)
    v_mfma_f32_16x16x32_bf16 v[128:131], v[232:235], v[36:39], v[128:131]
    ds_read_b64_tr_b16 v[228:229], v69 offset:24960
    v_mfma_f32_16x16x32_bf16 v[132:135], v[232:235], v[176:179], v[132:135]
    ds_read_b64_tr_b16 v[230:231], v69 offset:25472
    buffer_load_dwordx4 v[216:219], v2, s[32:35], s16 offen offset:3072 sc1
    v_mfma_f32_16x16x32_bf16 v[136:139], v[236:239], v[36:39], v[136:139]
    ds_read_b64_tr_b16 v[232:233], v69 offset:24992
    v_mfma_f32_16x16x32_bf16 v[140:143], v[236:239], v[176:179], v[140:143]
    ds_read_b64_tr_b16 v[234:235], v69 offset:25504
    s_waitcnt lgkmcnt(8)
    v_mfma_f32_16x16x32_bf16 v[112:115], v[240:243], v[36:39], v[112:115]
    ds_read_b64_tr_b16 v[236:237], v68 offset:41600
    v_mfma_f32_16x16x32_bf16 v[116:119], v[240:243], v[176:179], v[116:119]
    ds_read_b64_tr_b16 v[238:239], v68 offset:42112
    v_mfma_f32_16x16x32_bf16 v[120:123], v[244:247], v[36:39], v[120:123]
    ds_read_b64_tr_b16 v[240:241], v68 offset:41632
    v_mfma_f32_16x16x32_bf16 v[124:127], v[244:247], v[176:179], v[124:127]
    ds_read_b64_tr_b16 v[242:243], v68 offset:42144
    s_add_u32 s96, s85, 6
    s_and_b32 s97, s96, 15
    s_lshl_b32 s98, s97, 14
    s_add_u32 s16, s98, s15
    buffer_load_dwordx4 v[220:223], v2, s[32:35], s16 offen sc1
    s_waitcnt lgkmcnt(8)
    v_mfma_f32_16x16x32_bf16 v[80:83], v[248:251], v[36:39], v[80:83]
    ds_read_b64_tr_b16 v[244:245], v69 offset:41600
    v_mfma_f32_16x16x32_bf16 v[84:87], v[248:251], v[176:179], v[84:87]
    ds_read_b64_tr_b16 v[246:247], v69 offset:42112
    v_mfma_f32_16x16x32_bf16 v[88:91], v[224:227], v[36:39], v[88:91]
    ds_read_b64_tr_b16 v[248:249], v69 offset:41632
    v_mfma_f32_16x16x32_bf16 v[92:95], v[224:227], v[176:179], v[92:95]
    ds_read_b64_tr_b16 v[250:251], v69 offset:42144
    s_waitcnt lgkmcnt(8)
    v_mfma_f32_16x16x32_bf16 v[96:99], v[228:231], v[36:39], v[96:99]
    ds_read_b64_tr_b16 v[224:225], v69 offset:37440
    v_mfma_f32_16x16x32_bf16 v[100:103], v[228:231], v[176:179], v[100:103]
    ds_read_b64_tr_b16 v[226:227], v69 offset:37952
    v_mfma_f32_16x16x32_bf16 v[104:107], v[232:235], v[36:39], v[104:107]
    ds_read_b64_tr_b16 v[228:229], v69 offset:37472
    v_mfma_f32_16x16x32_bf16 v[108:111], v[232:235], v[176:179], v[108:111]
    ds_read_b64_tr_b16 v[230:231], v69 offset:37984
    s_waitcnt lgkmcnt(8)
    v_mfma_f32_16x16x32_bf16 v[144:147], v[236:239], v[36:39], v[144:147]
    ds_read_b64_tr_b16 v[232:233], v68 offset:37440
    v_mfma_f32_16x16x32_bf16 v[148:151], v[236:239], v[176:179], v[148:151]
    ds_read_b64_tr_b16 v[234:235], v68 offset:37952
    v_mfma_f32_16x16x32_bf16 v[152:155], v[240:243], v[36:39], v[152:155]
    ds_read_b64_tr_b16 v[236:237], v68 offset:37472
    v_mfma_f32_16x16x32_bf16 v[156:159], v[240:243], v[176:179], v[156:159]
    ds_read_b64_tr_b16 v[238:239], v68 offset:37984
    s_waitcnt lgkmcnt(8)
    v_mfma_f32_16x16x32_bf16 v[160:163], v[244:247], v[36:39], v[160:163]
    ds_read_b64_tr_b16 v[240:241], v68 offset:29120
    v_mfma_f32_16x16x32_bf16 v[164:167], v[244:247], v[176:179], v[164:167]
    ds_read_b64_tr_b16 v[242:243], v68 offset:29632
    v_mfma_f32_16x16x32_bf16 v[168:171], v[248:251], v[36:39], v[168:171]
    ds_read_b64_tr_b16 v[244:245], v68 offset:29152
    v_mfma_f32_16x16x32_bf16 v[172:175], v[248:251], v[176:179], v[172:175]
    ds_read_b64_tr_b16 v[246:247], v68 offset:29664
    s_waitcnt lgkmcnt(8)
    s_waitcnt vmcnt(9)
    v_mfma_f32_16x16x32_bf16 v[128:131], v[224:227], v[180:183], v[128:131]
    ds_read_b64_tr_b16 v[248:249], v69 offset:29120
    v_mfma_f32_16x16x32_bf16 v[132:135], v[224:227], v[184:187], v[132:135]
    ds_read_b64_tr_b16 v[250:251], v69 offset:29632
    buffer_load_dwordx4 v[36:39], v2, s[32:35], s16 offen offset:1024 sc1
    v_mfma_f32_16x16x32_bf16 v[136:139], v[228:231], v[180:183], v[136:139]
    ds_read_b64_tr_b16 v[224:225], v69 offset:29152
    v_mfma_f32_16x16x32_bf16 v[140:143], v[228:231], v[184:187], v[140:143]
    ds_read_b64_tr_b16 v[226:227], v69 offset:29664
    s_waitcnt lgkmcnt(8)
    v_mfma_f32_16x16x32_bf16 v[112:115], v[232:235], v[180:183], v[112:115]
    ds_read_b64_tr_b16 v[228:229], v68 offset:45760
    v_mfma_f32_16x16x32_bf16 v[116:119], v[232:235], v[184:187], v[116:119]
    ds_read_b64_tr_b16 v[230:231], v68 offset:46272
    v_mfma_f32_16x16x32_bf16 v[120:123], v[236:239], v[180:183], v[120:123]
    ds_read_b64_tr_b16 v[232:233], v68 offset:45792
    v_mfma_f32_16x16x32_bf16 v[124:127], v[236:239], v[184:187], v[124:127]
    ds_read_b64_tr_b16 v[234:235], v68 offset:46304
    buffer_load_dwordx4 v[176:179], v2, s[32:35], s16 offen offset:2048 sc1
    s_waitcnt lgkmcnt(8)
    v_mfma_f32_16x16x32_bf16 v[80:83], v[240:243], v[180:183], v[80:83]
    ds_read_b64_tr_b16 v[236:237], v69 offset:45760
    v_mfma_f32_16x16x32_bf16 v[84:87], v[240:243], v[184:187], v[84:87]
    ds_read_b64_tr_b16 v[238:239], v69 offset:46272
    v_mfma_f32_16x16x32_bf16 v[88:91], v[244:247], v[180:183], v[88:91]
    ds_read_b64_tr_b16 v[240:241], v69 offset:45792
    v_mfma_f32_16x16x32_bf16 v[92:95], v[244:247], v[184:187], v[92:95]
    ds_read_b64_tr_b16 v[242:243], v69 offset:46304
    s_waitcnt lgkmcnt(8)
    v_mfma_f32_16x16x32_bf16 v[96:99], v[248:251], v[180:183], v[96:99]
    s_barrier
    ds_read_b64_tr_b16 v[244:245], v71 offset:8320
    v_mfma_f32_16x16x32_bf16 v[100:103], v[248:251], v[184:187], v[100:103]
    ds_read_b64_tr_b16 v[246:247], v71 offset:8832
    v_mfma_f32_16x16x32_bf16 v[104:107], v[224:227], v[180:183], v[104:107]
    ds_read_b64_tr_b16 v[248:249], v71 offset:8352
    v_mfma_f32_16x16x32_bf16 v[108:111], v[224:227], v[184:187], v[108:111]
    ds_read_b64_tr_b16 v[250:251], v71 offset:8864
    s_waitcnt lgkmcnt(8)
    v_mfma_f32_16x16x32_bf16 v[144:147], v[228:231], v[180:183], v[144:147]
    ds_read_b64_tr_b16 v[224:225], v70 offset:8320
    v_mfma_f32_16x16x32_bf16 v[148:151], v[228:231], v[184:187], v[148:151]
    ds_read_b64_tr_b16 v[226:227], v70 offset:8832
    v_mfma_f32_16x16x32_bf16 v[152:155], v[232:235], v[180:183], v[152:155]
    ds_read_b64_tr_b16 v[228:229], v70 offset:8352
    v_mfma_f32_16x16x32_bf16 v[156:159], v[232:235], v[184:187], v[156:159]
    ds_read_b64_tr_b16 v[230:231], v70 offset:8864
    s_waitcnt lgkmcnt(8)
    v_mfma_f32_16x16x32_bf16 v[160:163], v[236:239], v[180:183], v[160:163]
    ds_read_b64_tr_b16 v[232:233], v70
    v_mfma_f32_16x16x32_bf16 v[164:167], v[236:239], v[184:187], v[164:167]
    ds_read_b64_tr_b16 v[234:235], v70 offset:512
    v_mfma_f32_16x16x32_bf16 v[168:171], v[240:243], v[180:183], v[168:171]
    ds_read_b64_tr_b16 v[236:237], v70 offset:32
    v_mfma_f32_16x16x32_bf16 v[172:175], v[240:243], v[184:187], v[172:175]
    ds_read_b64_tr_b16 v[238:239], v70 offset:544
    s_waitcnt lgkmcnt(8)
    s_waitcnt vmcnt(9)
    v_mfma_f32_16x16x32_bf16 v[128:131], v[244:247], v[188:191], v[128:131]
    ds_read_b64_tr_b16 v[240:241], v71
    v_mfma_f32_16x16x32_bf16 v[132:135], v[244:247], v[192:195], v[132:135]
    ds_read_b64_tr_b16 v[242:243], v71 offset:512
    buffer_load_dwordx4 v[180:183], v2, s[32:35], s16 offen offset:3072 sc1
    v_mfma_f32_16x16x32_bf16 v[136:139], v[248:251], v[188:191], v[136:139]
    ds_read_b64_tr_b16 v[244:245], v71 offset:32
    v_mfma_f32_16x16x32_bf16 v[140:143], v[248:251], v[192:195], v[140:143]
    ds_read_b64_tr_b16 v[246:247], v71 offset:544
    s_waitcnt lgkmcnt(8)
    v_mfma_f32_16x16x32_bf16 v[112:115], v[224:227], v[188:191], v[112:115]
    ds_read_b64_tr_b16 v[248:249], v70 offset:16640
    v_mfma_f32_16x16x32_bf16 v[116:119], v[224:227], v[192:195], v[116:119]
    ds_read_b64_tr_b16 v[250:251], v70 offset:17152
    v_mfma_f32_16x16x32_bf16 v[120:123], v[228:231], v[188:191], v[120:123]
    ds_read_b64_tr_b16 v[224:225], v70 offset:16672
    v_mfma_f32_16x16x32_bf16 v[124:127], v[228:231], v[192:195], v[124:127]
    ds_read_b64_tr_b16 v[226:227], v70 offset:17184
    s_add_u32 s96, s85, 7
    s_and_b32 s97, s96, 15
    s_lshl_b32 s98, s97, 14
    s_add_u32 s16, s98, s15
    buffer_load_dwordx4 v[184:187], v2, s[32:35], s16 offen sc1
    s_waitcnt lgkmcnt(8)
    v_mfma_f32_16x16x32_bf16 v[80:83], v[232:235], v[188:191], v[80:83]
    ds_read_b64_tr_b16 v[228:229], v71 offset:16640
    v_mfma_f32_16x16x32_bf16 v[84:87], v[232:235], v[192:195], v[84:87]
    ds_read_b64_tr_b16 v[230:231], v71 offset:17152
    v_mfma_f32_16x16x32_bf16 v[88:91], v[236:239], v[188:191], v[88:91]
    ds_read_b64_tr_b16 v[232:233], v71 offset:16672
    v_mfma_f32_16x16x32_bf16 v[92:95], v[236:239], v[192:195], v[92:95]
    ds_read_b64_tr_b16 v[234:235], v71 offset:17184
    s_waitcnt lgkmcnt(8)
    v_mfma_f32_16x16x32_bf16 v[96:99], v[240:243], v[188:191], v[96:99]
    ds_read_b64_tr_b16 v[236:237], v71 offset:12480
    v_mfma_f32_16x16x32_bf16 v[100:103], v[240:243], v[192:195], v[100:103]
    ds_read_b64_tr_b16 v[238:239], v71 offset:12992
    v_mfma_f32_16x16x32_bf16 v[104:107], v[244:247], v[188:191], v[104:107]
    ds_read_b64_tr_b16 v[240:241], v71 offset:12512
    v_mfma_f32_16x16x32_bf16 v[108:111], v[244:247], v[192:195], v[108:111]
    ds_read_b64_tr_b16 v[242:243], v71 offset:13024
    s_waitcnt lgkmcnt(8)
    v_mfma_f32_16x16x32_bf16 v[144:147], v[248:251], v[188:191], v[144:147]
    ds_read_b64_tr_b16 v[244:245], v70 offset:12480
    v_mfma_f32_16x16x32_bf16 v[148:151], v[248:251], v[192:195], v[148:151]
    ds_read_b64_tr_b16 v[246:247], v70 offset:12992
    v_mfma_f32_16x16x32_bf16 v[152:155], v[224:227], v[188:191], v[152:155]
    ds_read_b64_tr_b16 v[248:249], v70 offset:12512
    v_mfma_f32_16x16x32_bf16 v[156:159], v[224:227], v[192:195], v[156:159]
    ds_read_b64_tr_b16 v[250:251], v70 offset:13024
    s_waitcnt lgkmcnt(8)
    v_mfma_f32_16x16x32_bf16 v[160:163], v[228:231], v[188:191], v[160:163]
    ds_read_b64_tr_b16 v[224:225], v70 offset:4160
    v_mfma_f32_16x16x32_bf16 v[164:167], v[228:231], v[192:195], v[164:167]
    ds_read_b64_tr_b16 v[226:227], v70 offset:4672
    v_mfma_f32_16x16x32_bf16 v[168:171], v[232:235], v[188:191], v[168:171]
    ds_read_b64_tr_b16 v[228:229], v70 offset:4192
    v_mfma_f32_16x16x32_bf16 v[172:175], v[232:235], v[192:195], v[172:175]
    ds_read_b64_tr_b16 v[230:231], v70 offset:4704
    s_waitcnt lgkmcnt(8)
    s_waitcnt vmcnt(9)
    v_mfma_f32_16x16x32_bf16 v[128:131], v[236:239], v[196:199], v[128:131]
    ds_read_b64_tr_b16 v[232:233], v71 offset:4160
    v_mfma_f32_16x16x32_bf16 v[132:135], v[236:239], v[200:203], v[132:135]
    ds_read_b64_tr_b16 v[234:235], v71 offset:4672
    buffer_load_dwordx4 v[188:191], v2, s[32:35], s16 offen offset:1024 sc1
    v_mfma_f32_16x16x32_bf16 v[136:139], v[240:243], v[196:199], v[136:139]
    ds_read_b64_tr_b16 v[236:237], v71 offset:4192
    v_mfma_f32_16x16x32_bf16 v[140:143], v[240:243], v[200:203], v[140:143]
    ds_read_b64_tr_b16 v[238:239], v71 offset:4704
    s_waitcnt lgkmcnt(8)
    v_mfma_f32_16x16x32_bf16 v[112:115], v[244:247], v[196:199], v[112:115]
    ds_read_b64_tr_b16 v[240:241], v70 offset:20800
    v_mfma_f32_16x16x32_bf16 v[116:119], v[244:247], v[200:203], v[116:119]
    ds_read_b64_tr_b16 v[242:243], v70 offset:21312
    v_mfma_f32_16x16x32_bf16 v[120:123], v[248:251], v[196:199], v[120:123]
    ds_read_b64_tr_b16 v[244:245], v70 offset:20832
    v_mfma_f32_16x16x32_bf16 v[124:127], v[248:251], v[200:203], v[124:127]
    ds_read_b64_tr_b16 v[246:247], v70 offset:21344
    buffer_load_dwordx4 v[192:195], v2, s[32:35], s16 offen offset:2048 sc1
    s_waitcnt lgkmcnt(8)
    v_mfma_f32_16x16x32_bf16 v[80:83], v[224:227], v[196:199], v[80:83]
    ds_read_b64_tr_b16 v[248:249], v71 offset:20800
    v_mfma_f32_16x16x32_bf16 v[84:87], v[224:227], v[200:203], v[84:87]
    ds_read_b64_tr_b16 v[250:251], v71 offset:21312
    v_mfma_f32_16x16x32_bf16 v[88:91], v[228:231], v[196:199], v[88:91]
    ds_read_b64_tr_b16 v[224:225], v71 offset:20832
    v_mfma_f32_16x16x32_bf16 v[92:95], v[228:231], v[200:203], v[92:95]
    ds_read_b64_tr_b16 v[226:227], v71 offset:21344
    s_waitcnt lgkmcnt(8)
    v_mfma_f32_16x16x32_bf16 v[96:99], v[232:235], v[196:199], v[96:99]
    s_barrier
    ds_read_b64_tr_b16 v[228:229], v71 offset:33280
    v_mfma_f32_16x16x32_bf16 v[100:103], v[232:235], v[200:203], v[100:103]
    ds_read_b64_tr_b16 v[230:231], v71 offset:33792
    v_mfma_f32_16x16x32_bf16 v[104:107], v[236:239], v[196:199], v[104:107]
    ds_read_b64_tr_b16 v[232:233], v71 offset:33312
    v_mfma_f32_16x16x32_bf16 v[108:111], v[236:239], v[200:203], v[108:111]
    ds_read_b64_tr_b16 v[234:235], v71 offset:33824
    s_waitcnt lgkmcnt(8)
    v_mfma_f32_16x16x32_bf16 v[144:147], v[240:243], v[196:199], v[144:147]
    ds_read_b64_tr_b16 v[236:237], v70 offset:33280
    v_mfma_f32_16x16x32_bf16 v[148:151], v[240:243], v[200:203], v[148:151]
    ds_read_b64_tr_b16 v[238:239], v70 offset:33792
    v_mfma_f32_16x16x32_bf16 v[152:155], v[244:247], v[196:199], v[152:155]
    ds_read_b64_tr_b16 v[240:241], v70 offset:33312
    v_mfma_f32_16x16x32_bf16 v[156:159], v[244:247], v[200:203], v[156:159]
    ds_read_b64_tr_b16 v[242:243], v70 offset:33824
    s_waitcnt lgkmcnt(8)
    v_mfma_f32_16x16x32_bf16 v[160:163], v[248:251], v[196:199], v[160:163]
    ds_read_b64_tr_b16 v[244:245], v70 offset:24960
    v_mfma_f32_16x16x32_bf16 v[164:167], v[248:251], v[200:203], v[164:167]
    ds_read_b64_tr_b16 v[246:247], v70 offset:25472
    v_mfma_f32_16x16x32_bf16 v[168:171], v[224:227], v[196:199], v[168:171]
    ds_read_b64_tr_b16 v[248:249], v70 offset:24992
    v_mfma_f32_16x16x32_bf16 v[172:175], v[224:227], v[200:203], v[172:175]
    ds_read_b64_tr_b16 v[250:251], v70 offset:25504
    s_waitcnt lgkmcnt(8)
    s_waitcnt vmcnt(9)
    v_mfma_f32_16x16x32_bf16 v[128:131], v[228:231], v[204:207], v[128:131]
    ds_read_b64_tr_b16 v[224:225], v71 offset:24960
    v_mfma_f32_16x16x32_bf16 v[132:135], v[228:231], v[208:211], v[132:135]
    ds_read_b64_tr_b16 v[226:227], v71 offset:25472
    buffer_load_dwordx4 v[196:199], v2, s[32:35], s16 offen offset:3072 sc1
    v_mfma_f32_16x16x32_bf16 v[136:139], v[232:235], v[204:207], v[136:139]
    ds_read_b64_tr_b16 v[228:229], v71 offset:24992
    v_mfma_f32_16x16x32_bf16 v[140:143], v[232:235], v[208:211], v[140:143]
    ds_read_b64_tr_b16 v[230:231], v71 offset:25504
    s_waitcnt lgkmcnt(8)
    v_mfma_f32_16x16x32_bf16 v[112:115], v[236:239], v[204:207], v[112:115]
    ds_read_b64_tr_b16 v[232:233], v70 offset:41600
    v_mfma_f32_16x16x32_bf16 v[116:119], v[236:239], v[208:211], v[116:119]
    ds_read_b64_tr_b16 v[234:235], v70 offset:42112
    v_mfma_f32_16x16x32_bf16 v[120:123], v[240:243], v[204:207], v[120:123]
    ds_read_b64_tr_b16 v[236:237], v70 offset:41632
    v_mfma_f32_16x16x32_bf16 v[124:127], v[240:243], v[208:211], v[124:127]
    ds_read_b64_tr_b16 v[238:239], v70 offset:42144
    s_add_u32 s96, s85, 8
    s_and_b32 s97, s96, 15
    s_lshl_b32 s98, s97, 14
    s_add_u32 s16, s98, s15
    buffer_load_dwordx4 v[200:203], v2, s[32:35], s16 offen sc1
    s_waitcnt lgkmcnt(8)
    v_mfma_f32_16x16x32_bf16 v[80:83], v[244:247], v[204:207], v[80:83]
    ds_read_b64_tr_b16 v[240:241], v71 offset:41600
    v_mfma_f32_16x16x32_bf16 v[84:87], v[244:247], v[208:211], v[84:87]
    ds_read_b64_tr_b16 v[242:243], v71 offset:42112
    v_mfma_f32_16x16x32_bf16 v[88:91], v[248:251], v[204:207], v[88:91]
    ds_read_b64_tr_b16 v[244:245], v71 offset:41632
    v_mfma_f32_16x16x32_bf16 v[92:95], v[248:251], v[208:211], v[92:95]
    ds_read_b64_tr_b16 v[246:247], v71 offset:42144
    s_waitcnt lgkmcnt(8)
    v_mfma_f32_16x16x32_bf16 v[96:99], v[224:227], v[204:207], v[96:99]
    ds_read_b64_tr_b16 v[248:249], v71 offset:37440
    v_mfma_f32_16x16x32_bf16 v[100:103], v[224:227], v[208:211], v[100:103]
    ds_read_b64_tr_b16 v[250:251], v71 offset:37952
    v_mfma_f32_16x16x32_bf16 v[104:107], v[228:231], v[204:207], v[104:107]
    ds_read_b64_tr_b16 v[224:225], v71 offset:37472
    v_mfma_f32_16x16x32_bf16 v[108:111], v[228:231], v[208:211], v[108:111]
    ds_read_b64_tr_b16 v[226:227], v71 offset:37984
    s_waitcnt lgkmcnt(8)
    v_mfma_f32_16x16x32_bf16 v[144:147], v[232:235], v[204:207], v[144:147]
    ds_read_b64_tr_b16 v[228:229], v70 offset:37440
    v_mfma_f32_16x16x32_bf16 v[148:151], v[232:235], v[208:211], v[148:151]
    ds_read_b64_tr_b16 v[230:231], v70 offset:37952
    v_mfma_f32_16x16x32_bf16 v[152:155], v[236:239], v[204:207], v[152:155]
    ds_read_b64_tr_b16 v[232:233], v70 offset:37472
    v_mfma_f32_16x16x32_bf16 v[156:159], v[236:239], v[208:211], v[156:159]
    ds_read_b64_tr_b16 v[234:235], v70 offset:37984
    s_waitcnt lgkmcnt(8)
    v_mfma_f32_16x16x32_bf16 v[160:163], v[240:243], v[204:207], v[160:163]
    ds_read_b64_tr_b16 v[236:237], v70 offset:29120
    v_mfma_f32_16x16x32_bf16 v[164:167], v[240:243], v[208:211], v[164:167]
    ds_read_b64_tr_b16 v[238:239], v70 offset:29632
    v_mfma_f32_16x16x32_bf16 v[168:171], v[244:247], v[204:207], v[168:171]
    ds_read_b64_tr_b16 v[240:241], v70 offset:29152
    v_mfma_f32_16x16x32_bf16 v[172:175], v[244:247], v[208:211], v[172:175]
    ds_read_b64_tr_b16 v[242:243], v70 offset:29664
    s_waitcnt lgkmcnt(8)
    s_waitcnt vmcnt(9)
    v_mfma_f32_16x16x32_bf16 v[128:131], v[248:251], v[212:215], v[128:131]
    ds_read_b64_tr_b16 v[244:245], v71 offset:29120
    v_mfma_f32_16x16x32_bf16 v[132:135], v[248:251], v[216:219], v[132:135]
    ds_read_b64_tr_b16 v[246:247], v71 offset:29632
    buffer_load_dwordx4 v[204:207], v2, s[32:35], s16 offen offset:1024 sc1
    v_mfma_f32_16x16x32_bf16 v[136:139], v[224:227], v[212:215], v[136:139]
    ds_read_b64_tr_b16 v[248:249], v71 offset:29152
    v_mfma_f32_16x16x32_bf16 v[140:143], v[224:227], v[216:219], v[140:143]
    ds_read_b64_tr_b16 v[250:251], v71 offset:29664
    s_waitcnt lgkmcnt(8)
    v_mfma_f32_16x16x32_bf16 v[112:115], v[228:231], v[212:215], v[112:115]
    ds_read_b64_tr_b16 v[224:225], v70 offset:45760
    v_mfma_f32_16x16x32_bf16 v[116:119], v[228:231], v[216:219], v[116:119]
    ds_read_b64_tr_b16 v[226:227], v70 offset:46272
    v_mfma_f32_16x16x32_bf16 v[120:123], v[232:235], v[212:215], v[120:123]
    ds_read_b64_tr_b16 v[228:229], v70 offset:45792
    v_mfma_f32_16x16x32_bf16 v[124:127], v[232:235], v[216:219], v[124:127]
    ds_read_b64_tr_b16 v[230:231], v70 offset:46304
    buffer_load_dwordx4 v[208:211], v2, s[32:35], s16 offen offset:2048 sc1
    s_waitcnt lgkmcnt(8)
    v_mfma_f32_16x16x32_bf16 v[80:83], v[236:239], v[212:215], v[80:83]
    ds_read_b64_tr_b16 v[232:233], v71 offset:45760
    v_mfma_f32_16x16x32_bf16 v[84:87], v[236:239], v[216:219], v[84:87]
    ds_read_b64_tr_b16 v[234:235], v71 offset:46272
    v_mfma_f32_16x16x32_bf16 v[88:91], v[240:243], v[212:215], v[88:91]
    ds_read_b64_tr_b16 v[236:237], v71 offset:45792
    v_mfma_f32_16x16x32_bf16 v[92:95], v[240:243], v[216:219], v[92:95]
    ds_read_b64_tr_b16 v[238:239], v71 offset:46304
    s_waitcnt lgkmcnt(8)
    v_mfma_f32_16x16x32_bf16 v[96:99], v[244:247], v[212:215], v[96:99]
    s_barrier
    ds_read_b64_tr_b16 v[240:241], v67 offset:8320
    v_mfma_f32_16x16x32_bf16 v[100:103], v[244:247], v[216:219], v[100:103]
    ds_read_b64_tr_b16 v[242:243], v67 offset:8832
    v_mfma_f32_16x16x32_bf16 v[104:107], v[248:251], v[212:215], v[104:107]
    ds_read_b64_tr_b16 v[244:245], v67 offset:8352
    v_mfma_f32_16x16x32_bf16 v[108:111], v[248:251], v[216:219], v[108:111]
    ds_read_b64_tr_b16 v[246:247], v67 offset:8864
    s_waitcnt lgkmcnt(8)
    v_mfma_f32_16x16x32_bf16 v[144:147], v[224:227], v[212:215], v[144:147]
    ds_read_b64_tr_b16 v[248:249], v66 offset:8320
    v_mfma_f32_16x16x32_bf16 v[148:151], v[224:227], v[216:219], v[148:151]
    ds_read_b64_tr_b16 v[250:251], v66 offset:8832
    v_mfma_f32_16x16x32_bf16 v[152:155], v[228:231], v[212:215], v[152:155]
    ds_read_b64_tr_b16 v[224:225], v66 offset:8352
    v_mfma_f32_16x16x32_bf16 v[156:159], v[228:231], v[216:219], v[156:159]
    ds_read_b64_tr_b16 v[226:227], v66 offset:8864
    s_waitcnt lgkmcnt(8)
    v_mfma_f32_16x16x32_bf16 v[160:163], v[232:235], v[212:215], v[160:163]
    ds_read_b64_tr_b16 v[228:229], v66
    v_mfma_f32_16x16x32_bf16 v[164:167], v[232:235], v[216:219], v[164:167]
    ds_read_b64_tr_b16 v[230:231], v66 offset:512
    v_mfma_f32_16x16x32_bf16 v[168:171], v[236:239], v[212:215], v[168:171]
    ds_read_b64_tr_b16 v[232:233], v66 offset:32
    v_mfma_f32_16x16x32_bf16 v[172:175], v[236:239], v[216:219], v[172:175]
    ds_read_b64_tr_b16 v[234:235], v66 offset:544
    s_waitcnt lgkmcnt(8)
    s_waitcnt vmcnt(9)
    v_mfma_f32_16x16x32_bf16 v[128:131], v[240:243], v[220:223], v[128:131]
    ds_read_b64_tr_b16 v[236:237], v67
    v_mfma_f32_16x16x32_bf16 v[132:135], v[240:243], v[36:39], v[132:135]
    ds_read_b64_tr_b16 v[238:239], v67 offset:512
    buffer_load_dwordx4 v[212:215], v2, s[32:35], s16 offen offset:3072 sc1
    v_mfma_f32_16x16x32_bf16 v[136:139], v[244:247], v[220:223], v[136:139]
    ds_read_b64_tr_b16 v[240:241], v67 offset:32
    v_mfma_f32_16x16x32_bf16 v[140:143], v[244:247], v[36:39], v[140:143]
    ds_read_b64_tr_b16 v[242:243], v67 offset:544
    s_waitcnt lgkmcnt(8)
    v_mfma_f32_16x16x32_bf16 v[112:115], v[248:251], v[220:223], v[112:115]
    ds_read_b64_tr_b16 v[244:245], v66 offset:16640
    v_mfma_f32_16x16x32_bf16 v[116:119], v[248:251], v[36:39], v[116:119]
    ds_read_b64_tr_b16 v[246:247], v66 offset:17152
    v_mfma_f32_16x16x32_bf16 v[120:123], v[224:227], v[220:223], v[120:123]
    ds_read_b64_tr_b16 v[248:249], v66 offset:16672
    v_mfma_f32_16x16x32_bf16 v[124:127], v[224:227], v[36:39], v[124:127]
    ds_read_b64_tr_b16 v[250:251], v66 offset:17184
    s_add_u32 s96, s85, 9
    s_and_b32 s97, s96, 15
    s_lshl_b32 s98, s97, 14
    s_add_u32 s16, s98, s15
    buffer_load_dwordx4 v[216:219], v2, s[32:35], s16 offen sc1
    s_waitcnt lgkmcnt(8)
    v_mfma_f32_16x16x32_bf16 v[80:83], v[228:231], v[220:223], v[80:83]
    ds_read_b64_tr_b16 v[224:225], v67 offset:16640
    v_mfma_f32_16x16x32_bf16 v[84:87], v[228:231], v[36:39], v[84:87]
    ds_read_b64_tr_b16 v[226:227], v67 offset:17152
    v_mfma_f32_16x16x32_bf16 v[88:91], v[232:235], v[220:223], v[88:91]
    ds_read_b64_tr_b16 v[228:229], v67 offset:16672
    v_mfma_f32_16x16x32_bf16 v[92:95], v[232:235], v[36:39], v[92:95]
    ds_read_b64_tr_b16 v[230:231], v67 offset:17184
    s_waitcnt lgkmcnt(8)
    v_mfma_f32_16x16x32_bf16 v[96:99], v[236:239], v[220:223], v[96:99]
    ds_read_b64_tr_b16 v[232:233], v67 offset:12480
    v_mfma_f32_16x16x32_bf16 v[100:103], v[236:239], v[36:39], v[100:103]
    ds_read_b64_tr_b16 v[234:235], v67 offset:12992
    v_mfma_f32_16x16x32_bf16 v[104:107], v[240:243], v[220:223], v[104:107]
    ds_read_b64_tr_b16 v[236:237], v67 offset:12512
    v_mfma_f32_16x16x32_bf16 v[108:111], v[240:243], v[36:39], v[108:111]
    ds_read_b64_tr_b16 v[238:239], v67 offset:13024
    s_waitcnt lgkmcnt(8)
    v_mfma_f32_16x16x32_bf16 v[144:147], v[244:247], v[220:223], v[144:147]
    ds_read_b64_tr_b16 v[240:241], v66 offset:12480
    v_mfma_f32_16x16x32_bf16 v[148:151], v[244:247], v[36:39], v[148:151]
    ds_read_b64_tr_b16 v[242:243], v66 offset:12992
    v_mfma_f32_16x16x32_bf16 v[152:155], v[248:251], v[220:223], v[152:155]
    ds_read_b64_tr_b16 v[244:245], v66 offset:12512
    v_mfma_f32_16x16x32_bf16 v[156:159], v[248:251], v[36:39], v[156:159]
    ds_read_b64_tr_b16 v[246:247], v66 offset:13024
    s_waitcnt lgkmcnt(8)
    v_mfma_f32_16x16x32_bf16 v[160:163], v[224:227], v[220:223], v[160:163]
    ds_read_b64_tr_b16 v[248:249], v66 offset:4160
    v_mfma_f32_16x16x32_bf16 v[164:167], v[224:227], v[36:39], v[164:167]
    ds_read_b64_tr_b16 v[250:251], v66 offset:4672
    v_mfma_f32_16x16x32_bf16 v[168:171], v[228:231], v[220:223], v[168:171]
    ds_read_b64_tr_b16 v[224:225], v66 offset:4192
    v_mfma_f32_16x16x32_bf16 v[172:175], v[228:231], v[36:39], v[172:175]
    ds_read_b64_tr_b16 v[226:227], v66 offset:4704
    s_waitcnt lgkmcnt(8)
    s_waitcnt vmcnt(9)
    v_mfma_f32_16x16x32_bf16 v[128:131], v[232:235], v[176:179], v[128:131]
    ds_read_b64_tr_b16 v[228:229], v67 offset:4160
    v_mfma_f32_16x16x32_bf16 v[132:135], v[232:235], v[180:183], v[132:135]
    ds_read_b64_tr_b16 v[230:231], v67 offset:4672
    buffer_load_dwordx4 v[220:223], v2, s[32:35], s16 offen offset:1024 sc1
    v_mfma_f32_16x16x32_bf16 v[136:139], v[236:239], v[176:179], v[136:139]
    ds_read_b64_tr_b16 v[232:233], v67 offset:4192
    v_mfma_f32_16x16x32_bf16 v[140:143], v[236:239], v[180:183], v[140:143]
    ds_read_b64_tr_b16 v[234:235], v67 offset:4704
    s_waitcnt lgkmcnt(8)
    v_mfma_f32_16x16x32_bf16 v[112:115], v[240:243], v[176:179], v[112:115]
    ds_read_b64_tr_b16 v[236:237], v66 offset:20800
    v_mfma_f32_16x16x32_bf16 v[116:119], v[240:243], v[180:183], v[116:119]
    ds_read_b64_tr_b16 v[238:239], v66 offset:21312
    v_mfma_f32_16x16x32_bf16 v[120:123], v[244:247], v[176:179], v[120:123]
    ds_read_b64_tr_b16 v[240:241], v66 offset:20832
    v_mfma_f32_16x16x32_bf16 v[124:127], v[244:247], v[180:183], v[124:127]
    ds_read_b64_tr_b16 v[242:243], v66 offset:21344
    buffer_load_dwordx4 v[36:39], v2, s[32:35], s16 offen offset:2048 sc1
    s_waitcnt lgkmcnt(8)
    v_mfma_f32_16x16x32_bf16 v[80:83], v[248:251], v[176:179], v[80:83]
    ds_read_b64_tr_b16 v[244:245], v67 offset:20800
    v_mfma_f32_16x16x32_bf16 v[84:87], v[248:251], v[180:183], v[84:87]
    ds_read_b64_tr_b16 v[246:247], v67 offset:21312
    v_mfma_f32_16x16x32_bf16 v[88:91], v[224:227], v[176:179], v[88:91]
    ds_read_b64_tr_b16 v[248:249], v67 offset:20832
    v_mfma_f32_16x16x32_bf16 v[92:95], v[224:227], v[180:183], v[92:95]
    ds_read_b64_tr_b16 v[250:251], v67 offset:21344
    s_waitcnt lgkmcnt(8)
    v_mfma_f32_16x16x32_bf16 v[96:99], v[228:231], v[176:179], v[96:99]
    s_barrier
    ds_read_b64_tr_b16 v[224:225], v67 offset:33280
    v_mfma_f32_16x16x32_bf16 v[100:103], v[228:231], v[180:183], v[100:103]
    ds_read_b64_tr_b16 v[226:227], v67 offset:33792
    v_mfma_f32_16x16x32_bf16 v[104:107], v[232:235], v[176:179], v[104:107]
    ds_read_b64_tr_b16 v[228:229], v67 offset:33312
    v_mfma_f32_16x16x32_bf16 v[108:111], v[232:235], v[180:183], v[108:111]
    ds_read_b64_tr_b16 v[230:231], v67 offset:33824
    s_waitcnt lgkmcnt(8)
    v_mfma_f32_16x16x32_bf16 v[144:147], v[236:239], v[176:179], v[144:147]
    ds_read_b64_tr_b16 v[232:233], v66 offset:33280
    v_mfma_f32_16x16x32_bf16 v[148:151], v[236:239], v[180:183], v[148:151]
    ds_read_b64_tr_b16 v[234:235], v66 offset:33792
    v_mfma_f32_16x16x32_bf16 v[152:155], v[240:243], v[176:179], v[152:155]
    ds_read_b64_tr_b16 v[236:237], v66 offset:33312
    v_mfma_f32_16x16x32_bf16 v[156:159], v[240:243], v[180:183], v[156:159]
    ds_read_b64_tr_b16 v[238:239], v66 offset:33824
    s_waitcnt lgkmcnt(8)
    v_mfma_f32_16x16x32_bf16 v[160:163], v[244:247], v[176:179], v[160:163]
    ds_read_b64_tr_b16 v[240:241], v66 offset:24960
    v_mfma_f32_16x16x32_bf16 v[164:167], v[244:247], v[180:183], v[164:167]
    ds_read_b64_tr_b16 v[242:243], v66 offset:25472
    v_mfma_f32_16x16x32_bf16 v[168:171], v[248:251], v[176:179], v[168:171]
    ds_read_b64_tr_b16 v[244:245], v66 offset:24992
    v_mfma_f32_16x16x32_bf16 v[172:175], v[248:251], v[180:183], v[172:175]
    ds_read_b64_tr_b16 v[246:247], v66 offset:25504
    s_waitcnt lgkmcnt(8)
    s_waitcnt vmcnt(9)
    v_mfma_f32_16x16x32_bf16 v[128:131], v[224:227], v[184:187], v[128:131]
    ds_read_b64_tr_b16 v[248:249], v67 offset:24960
    v_mfma_f32_16x16x32_bf16 v[132:135], v[224:227], v[188:191], v[132:135]
    ds_read_b64_tr_b16 v[250:251], v67 offset:25472
    buffer_load_dwordx4 v[176:179], v2, s[32:35], s16 offen offset:3072 sc1
    v_mfma_f32_16x16x32_bf16 v[136:139], v[228:231], v[184:187], v[136:139]
    ds_read_b64_tr_b16 v[224:225], v67 offset:24992
    v_mfma_f32_16x16x32_bf16 v[140:143], v[228:231], v[188:191], v[140:143]
    ds_read_b64_tr_b16 v[226:227], v67 offset:25504
    s_waitcnt lgkmcnt(8)
    v_mfma_f32_16x16x32_bf16 v[112:115], v[232:235], v[184:187], v[112:115]
    ds_read_b64_tr_b16 v[228:229], v66 offset:41600
    v_mfma_f32_16x16x32_bf16 v[116:119], v[232:235], v[188:191], v[116:119]
    ds_read_b64_tr_b16 v[230:231], v66 offset:42112
    v_mfma_f32_16x16x32_bf16 v[120:123], v[236:239], v[184:187], v[120:123]
    ds_read_b64_tr_b16 v[232:233], v66 offset:41632
    v_mfma_f32_16x16x32_bf16 v[124:127], v[236:239], v[188:191], v[124:127]
    ds_read_b64_tr_b16 v[234:235], v66 offset:42144
    s_add_u32 s96, s85, 10
    s_and_b32 s97, s96, 15
    s_lshl_b32 s98, s97, 14
    s_add_u32 s16, s98, s15
    buffer_load_dwordx4 v[180:183], v2, s[32:35], s16 offen sc1
    s_waitcnt lgkmcnt(8)
    v_mfma_f32_16x16x32_bf16 v[80:83], v[240:243], v[184:187], v[80:83]
    ds_read_b64_tr_b16 v[236:237], v67 offset:41600
    v_mfma_f32_16x16x32_bf16 v[84:87], v[240:243], v[188:191], v[84:87]
    ds_read_b64_tr_b16 v[238:239], v67 offset:42112
    v_mfma_f32_16x16x32_bf16 v[88:91], v[244:247], v[184:187], v[88:91]
    ds_read_b64_tr_b16 v[240:241], v67 offset:41632
    v_mfma_f32_16x16x32_bf16 v[92:95], v[244:247], v[188:191], v[92:95]
    ds_read_b64_tr_b16 v[242:243], v67 offset:42144
    s_waitcnt lgkmcnt(8)
    v_mfma_f32_16x16x32_bf16 v[96:99], v[248:251], v[184:187], v[96:99]
    ds_read_b64_tr_b16 v[244:245], v67 offset:37440
    v_mfma_f32_16x16x32_bf16 v[100:103], v[248:251], v[188:191], v[100:103]
    ds_read_b64_tr_b16 v[246:247], v67 offset:37952
    v_mfma_f32_16x16x32_bf16 v[104:107], v[224:227], v[184:187], v[104:107]
    ds_read_b64_tr_b16 v[248:249], v67 offset:37472
    v_mfma_f32_16x16x32_bf16 v[108:111], v[224:227], v[188:191], v[108:111]
    ds_read_b64_tr_b16 v[250:251], v67 offset:37984
    s_waitcnt lgkmcnt(8)
    v_mfma_f32_16x16x32_bf16 v[144:147], v[228:231], v[184:187], v[144:147]
    ds_read_b64_tr_b16 v[224:225], v66 offset:37440
    v_mfma_f32_16x16x32_bf16 v[148:151], v[228:231], v[188:191], v[148:151]
    ds_read_b64_tr_b16 v[226:227], v66 offset:37952
    v_mfma_f32_16x16x32_bf16 v[152:155], v[232:235], v[184:187], v[152:155]
    ds_read_b64_tr_b16 v[228:229], v66 offset:37472
    v_mfma_f32_16x16x32_bf16 v[156:159], v[232:235], v[188:191], v[156:159]
    ds_read_b64_tr_b16 v[230:231], v66 offset:37984
    s_waitcnt lgkmcnt(8)
    v_mfma_f32_16x16x32_bf16 v[160:163], v[236:239], v[184:187], v[160:163]
    ds_read_b64_tr_b16 v[232:233], v66 offset:29120
    v_mfma_f32_16x16x32_bf16 v[164:167], v[236:239], v[188:191], v[164:167]
    ds_read_b64_tr_b16 v[234:235], v66 offset:29632
    v_mfma_f32_16x16x32_bf16 v[168:171], v[240:243], v[184:187], v[168:171]
    ds_read_b64_tr_b16 v[236:237], v66 offset:29152
    v_mfma_f32_16x16x32_bf16 v[172:175], v[240:243], v[188:191], v[172:175]
    ds_read_b64_tr_b16 v[238:239], v66 offset:29664
    s_waitcnt lgkmcnt(8)
    s_waitcnt vmcnt(9)
    v_mfma_f32_16x16x32_bf16 v[128:131], v[244:247], v[192:195], v[128:131]
    ds_read_b64_tr_b16 v[240:241], v67 offset:29120
    v_mfma_f32_16x16x32_bf16 v[132:135], v[244:247], v[196:199], v[132:135]
    ds_read_b64_tr_b16 v[242:243], v67 offset:29632
    buffer_load_dwordx4 v[184:187], v2, s[32:35], s16 offen offset:1024 sc1
    v_mfma_f32_16x16x32_bf16 v[136:139], v[248:251], v[192:195], v[136:139]
    ds_read_b64_tr_b16 v[244:245], v67 offset:29152
    v_mfma_f32_16x16x32_bf16 v[140:143], v[248:251], v[196:199], v[140:143]
    ds_read_b64_tr_b16 v[246:247], v67 offset:29664
    s_waitcnt lgkmcnt(8)
    v_mfma_f32_16x16x32_bf16 v[112:115], v[224:227], v[192:195], v[112:115]
    ds_read_b64_tr_b16 v[248:249], v66 offset:45760
    v_mfma_f32_16x16x32_bf16 v[116:119], v[224:227], v[196:199], v[116:119]
    ds_read_b64_tr_b16 v[250:251], v66 offset:46272
    v_mfma_f32_16x16x32_bf16 v[120:123], v[228:231], v[192:195], v[120:123]
    ds_read_b64_tr_b16 v[224:225], v66 offset:45792
    v_mfma_f32_16x16x32_bf16 v[124:127], v[228:231], v[196:199], v[124:127]
    ds_read_b64_tr_b16 v[226:227], v66 offset:46304
    buffer_load_dwordx4 v[188:191], v2, s[32:35], s16 offen offset:2048 sc1
    s_waitcnt lgkmcnt(8)
    v_mfma_f32_16x16x32_bf16 v[80:83], v[232:235], v[192:195], v[80:83]
    ds_read_b64_tr_b16 v[228:229], v67 offset:45760
    v_mfma_f32_16x16x32_bf16 v[84:87], v[232:235], v[196:199], v[84:87]
    ds_read_b64_tr_b16 v[230:231], v67 offset:46272
    v_mfma_f32_16x16x32_bf16 v[88:91], v[236:239], v[192:195], v[88:91]
    ds_read_b64_tr_b16 v[232:233], v67 offset:45792
    v_mfma_f32_16x16x32_bf16 v[92:95], v[236:239], v[196:199], v[92:95]
    ds_read_b64_tr_b16 v[234:235], v67 offset:46304
    s_waitcnt lgkmcnt(8)
    v_mfma_f32_16x16x32_bf16 v[96:99], v[240:243], v[192:195], v[96:99]
    s_barrier
    ds_read_b64_tr_b16 v[236:237], v69 offset:8320
    v_mfma_f32_16x16x32_bf16 v[100:103], v[240:243], v[196:199], v[100:103]
    ds_read_b64_tr_b16 v[238:239], v69 offset:8832
    v_mfma_f32_16x16x32_bf16 v[104:107], v[244:247], v[192:195], v[104:107]
    ds_read_b64_tr_b16 v[240:241], v69 offset:8352
    v_mfma_f32_16x16x32_bf16 v[108:111], v[244:247], v[196:199], v[108:111]
    ds_read_b64_tr_b16 v[242:243], v69 offset:8864
    s_waitcnt lgkmcnt(8)
    v_mfma_f32_16x16x32_bf16 v[144:147], v[248:251], v[192:195], v[144:147]
    ds_read_b64_tr_b16 v[244:245], v68 offset:8320
    v_mfma_f32_16x16x32_bf16 v[148:151], v[248:251], v[196:199], v[148:151]
    ds_read_b64_tr_b16 v[246:247], v68 offset:8832
    v_mfma_f32_16x16x32_bf16 v[152:155], v[224:227], v[192:195], v[152:155]
    ds_read_b64_tr_b16 v[248:249], v68 offset:8352
    v_mfma_f32_16x16x32_bf16 v[156:159], v[224:227], v[196:199], v[156:159]
    ds_read_b64_tr_b16 v[250:251], v68 offset:8864
    s_waitcnt lgkmcnt(8)
    v_mfma_f32_16x16x32_bf16 v[160:163], v[228:231], v[192:195], v[160:163]
    ds_read_b64_tr_b16 v[224:225], v68
    v_mfma_f32_16x16x32_bf16 v[164:167], v[228:231], v[196:199], v[164:167]
    ds_read_b64_tr_b16 v[226:227], v68 offset:512
    v_mfma_f32_16x16x32_bf16 v[168:171], v[232:235], v[192:195], v[168:171]
    ds_read_b64_tr_b16 v[228:229], v68 offset:32
    v_mfma_f32_16x16x32_bf16 v[172:175], v[232:235], v[196:199], v[172:175]
    ds_read_b64_tr_b16 v[230:231], v68 offset:544
    s_waitcnt lgkmcnt(8)
    s_waitcnt vmcnt(9)
    v_mfma_f32_16x16x32_bf16 v[128:131], v[236:239], v[200:203], v[128:131]
    ds_read_b64_tr_b16 v[232:233], v69
    v_mfma_f32_16x16x32_bf16 v[132:135], v[236:239], v[204:207], v[132:135]
    ds_read_b64_tr_b16 v[234:235], v69 offset:512
    buffer_load_dwordx4 v[192:195], v2, s[32:35], s16 offen offset:3072 sc1
    v_mfma_f32_16x16x32_bf16 v[136:139], v[240:243], v[200:203], v[136:139]
    ds_read_b64_tr_b16 v[236:237], v69 offset:32
    v_mfma_f32_16x16x32_bf16 v[140:143], v[240:243], v[204:207], v[140:143]
    ds_read_b64_tr_b16 v[238:239], v69 offset:544
    s_waitcnt lgkmcnt(8)
    v_mfma_f32_16x16x32_bf16 v[112:115], v[244:247], v[200:203], v[112:115]
    ds_read_b64_tr_b16 v[240:241], v68 offset:16640
    v_mfma_f32_16x16x32_bf16 v[116:119], v[244:247], v[204:207], v[116:119]
    ds_read_b64_tr_b16 v[242:243], v68 offset:17152
    v_mfma_f32_16x16x32_bf16 v[120:123], v[248:251], v[200:203], v[120:123]
    ds_read_b64_tr_b16 v[244:245], v68 offset:16672
    v_mfma_f32_16x16x32_bf16 v[124:127], v[248:251], v[204:207], v[124:127]
    ds_read_b64_tr_b16 v[246:247], v68 offset:17184
    s_add_u32 s96, s85, 11
    s_and_b32 s97, s96, 15
    s_lshl_b32 s98, s97, 14
    s_add_u32 s16, s98, s15
    buffer_load_dwordx4 v[196:199], v2, s[32:35], s16 offen sc1
    s_waitcnt lgkmcnt(8)
    v_mfma_f32_16x16x32_bf16 v[80:83], v[224:227], v[200:203], v[80:83]
    ds_read_b64_tr_b16 v[248:249], v69 offset:16640
    v_mfma_f32_16x16x32_bf16 v[84:87], v[224:227], v[204:207], v[84:87]
    ds_read_b64_tr_b16 v[250:251], v69 offset:17152
    v_mfma_f32_16x16x32_bf16 v[88:91], v[228:231], v[200:203], v[88:91]
    ds_read_b64_tr_b16 v[224:225], v69 offset:16672
    v_mfma_f32_16x16x32_bf16 v[92:95], v[228:231], v[204:207], v[92:95]
    ds_read_b64_tr_b16 v[226:227], v69 offset:17184
    s_waitcnt lgkmcnt(8)
    v_mfma_f32_16x16x32_bf16 v[96:99], v[232:235], v[200:203], v[96:99]
    ds_read_b64_tr_b16 v[228:229], v69 offset:12480
    v_mfma_f32_16x16x32_bf16 v[100:103], v[232:235], v[204:207], v[100:103]
    ds_read_b64_tr_b16 v[230:231], v69 offset:12992
    v_mfma_f32_16x16x32_bf16 v[104:107], v[236:239], v[200:203], v[104:107]
    ds_read_b64_tr_b16 v[232:233], v69 offset:12512
    v_mfma_f32_16x16x32_bf16 v[108:111], v[236:239], v[204:207], v[108:111]
    ds_read_b64_tr_b16 v[234:235], v69 offset:13024
    s_waitcnt lgkmcnt(8)
    v_mfma_f32_16x16x32_bf16 v[144:147], v[240:243], v[200:203], v[144:147]
    ds_read_b64_tr_b16 v[236:237], v68 offset:12480
    v_mfma_f32_16x16x32_bf16 v[148:151], v[240:243], v[204:207], v[148:151]
    ds_read_b64_tr_b16 v[238:239], v68 offset:12992
    v_mfma_f32_16x16x32_bf16 v[152:155], v[244:247], v[200:203], v[152:155]
    ds_read_b64_tr_b16 v[240:241], v68 offset:12512
    v_mfma_f32_16x16x32_bf16 v[156:159], v[244:247], v[204:207], v[156:159]
    ds_read_b64_tr_b16 v[242:243], v68 offset:13024
    s_waitcnt lgkmcnt(8)
    v_mfma_f32_16x16x32_bf16 v[160:163], v[248:251], v[200:203], v[160:163]
    ds_read_b64_tr_b16 v[244:245], v68 offset:4160
    v_mfma_f32_16x16x32_bf16 v[164:167], v[248:251], v[204:207], v[164:167]
    ds_read_b64_tr_b16 v[246:247], v68 offset:4672
    v_mfma_f32_16x16x32_bf16 v[168:171], v[224:227], v[200:203], v[168:171]
    ds_read_b64_tr_b16 v[248:249], v68 offset:4192
    v_mfma_f32_16x16x32_bf16 v[172:175], v[224:227], v[204:207], v[172:175]
    ds_read_b64_tr_b16 v[250:251], v68 offset:4704
    s_waitcnt lgkmcnt(8)
    s_waitcnt vmcnt(9)
    v_mfma_f32_16x16x32_bf16 v[128:131], v[228:231], v[208:211], v[128:131]
    ds_read_b64_tr_b16 v[224:225], v69 offset:4160
    v_mfma_f32_16x16x32_bf16 v[132:135], v[228:231], v[212:215], v[132:135]
    ds_read_b64_tr_b16 v[226:227], v69 offset:4672
    buffer_load_dwordx4 v[200:203], v2, s[32:35], s16 offen offset:1024 sc1
    v_mfma_f32_16x16x32_bf16 v[136:139], v[232:235], v[208:211], v[136:139]
    ds_read_b64_tr_b16 v[228:229], v69 offset:4192
    v_mfma_f32_16x16x32_bf16 v[140:143], v[232:235], v[212:215], v[140:143]
    ds_read_b64_tr_b16 v[230:231], v69 offset:4704
    s_waitcnt lgkmcnt(8)
    v_mfma_f32_16x16x32_bf16 v[112:115], v[236:239], v[208:211], v[112:115]
    ds_read_b64_tr_b16 v[232:233], v68 offset:20800
    v_mfma_f32_16x16x32_bf16 v[116:119], v[236:239], v[212:215], v[116:119]
    ds_read_b64_tr_b16 v[234:235], v68 offset:21312
    v_mfma_f32_16x16x32_bf16 v[120:123], v[240:243], v[208:211], v[120:123]
    ds_read_b64_tr_b16 v[236:237], v68 offset:20832
    v_mfma_f32_16x16x32_bf16 v[124:127], v[240:243], v[212:215], v[124:127]
    ds_read_b64_tr_b16 v[238:239], v68 offset:21344
    buffer_load_dwordx4 v[204:207], v2, s[32:35], s16 offen offset:2048 sc1
    s_waitcnt lgkmcnt(8)
    v_mfma_f32_16x16x32_bf16 v[80:83], v[244:247], v[208:211], v[80:83]
    ds_read_b64_tr_b16 v[240:241], v69 offset:20800
    v_mfma_f32_16x16x32_bf16 v[84:87], v[244:247], v[212:215], v[84:87]
    ds_read_b64_tr_b16 v[242:243], v69 offset:21312
    v_mfma_f32_16x16x32_bf16 v[88:91], v[248:251], v[208:211], v[88:91]
    ds_read_b64_tr_b16 v[244:245], v69 offset:20832
    v_mfma_f32_16x16x32_bf16 v[92:95], v[248:251], v[212:215], v[92:95]
    ds_read_b64_tr_b16 v[246:247], v69 offset:21344
    s_waitcnt lgkmcnt(8)
    v_mfma_f32_16x16x32_bf16 v[96:99], v[224:227], v[208:211], v[96:99]
    s_barrier
    ds_read_b64_tr_b16 v[248:249], v69 offset:33280
    v_mfma_f32_16x16x32_bf16 v[100:103], v[224:227], v[212:215], v[100:103]
    ds_read_b64_tr_b16 v[250:251], v69 offset:33792
    v_mfma_f32_16x16x32_bf16 v[104:107], v[228:231], v[208:211], v[104:107]
    ds_read_b64_tr_b16 v[224:225], v69 offset:33312
    v_mfma_f32_16x16x32_bf16 v[108:111], v[228:231], v[212:215], v[108:111]
    ds_read_b64_tr_b16 v[226:227], v69 offset:33824
    s_waitcnt lgkmcnt(8)
    v_mfma_f32_16x16x32_bf16 v[144:147], v[232:235], v[208:211], v[144:147]
    ds_read_b64_tr_b16 v[228:229], v68 offset:33280
    v_mfma_f32_16x16x32_bf16 v[148:151], v[232:235], v[212:215], v[148:151]
    ds_read_b64_tr_b16 v[230:231], v68 offset:33792
    v_mfma_f32_16x16x32_bf16 v[152:155], v[236:239], v[208:211], v[152:155]
    ds_read_b64_tr_b16 v[232:233], v68 offset:33312
    v_mfma_f32_16x16x32_bf16 v[156:159], v[236:239], v[212:215], v[156:159]
    ds_read_b64_tr_b16 v[234:235], v68 offset:33824
    s_waitcnt lgkmcnt(8)
    v_mfma_f32_16x16x32_bf16 v[160:163], v[240:243], v[208:211], v[160:163]
    ds_read_b64_tr_b16 v[236:237], v68 offset:24960
    v_mfma_f32_16x16x32_bf16 v[164:167], v[240:243], v[212:215], v[164:167]
    ds_read_b64_tr_b16 v[238:239], v68 offset:25472
    v_mfma_f32_16x16x32_bf16 v[168:171], v[244:247], v[208:211], v[168:171]
    ds_read_b64_tr_b16 v[240:241], v68 offset:24992
    v_mfma_f32_16x16x32_bf16 v[172:175], v[244:247], v[212:215], v[172:175]
    ds_read_b64_tr_b16 v[242:243], v68 offset:25504
    s_waitcnt lgkmcnt(8)
    s_waitcnt vmcnt(9)
    v_mfma_f32_16x16x32_bf16 v[128:131], v[248:251], v[216:219], v[128:131]
    ds_read_b64_tr_b16 v[244:245], v69 offset:24960
    v_mfma_f32_16x16x32_bf16 v[132:135], v[248:251], v[220:223], v[132:135]
    ds_read_b64_tr_b16 v[246:247], v69 offset:25472
    buffer_load_dwordx4 v[208:211], v2, s[32:35], s16 offen offset:3072 sc1
    v_mfma_f32_16x16x32_bf16 v[136:139], v[224:227], v[216:219], v[136:139]
    ds_read_b64_tr_b16 v[248:249], v69 offset:24992
    v_mfma_f32_16x16x32_bf16 v[140:143], v[224:227], v[220:223], v[140:143]
    ds_read_b64_tr_b16 v[250:251], v69 offset:25504
    s_waitcnt lgkmcnt(8)
    v_mfma_f32_16x16x32_bf16 v[112:115], v[228:231], v[216:219], v[112:115]
    ds_read_b64_tr_b16 v[224:225], v68 offset:41600
    v_mfma_f32_16x16x32_bf16 v[116:119], v[228:231], v[220:223], v[116:119]
    ds_read_b64_tr_b16 v[226:227], v68 offset:42112
    v_mfma_f32_16x16x32_bf16 v[120:123], v[232:235], v[216:219], v[120:123]
    ds_read_b64_tr_b16 v[228:229], v68 offset:41632
    v_mfma_f32_16x16x32_bf16 v[124:127], v[232:235], v[220:223], v[124:127]
    ds_read_b64_tr_b16 v[230:231], v68 offset:42144
    s_add_u32 s96, s85, 12
    s_and_b32 s97, s96, 15
    s_lshl_b32 s98, s97, 14
    s_add_u32 s16, s98, s15
    buffer_load_dwordx4 v[212:215], v2, s[32:35], s16 offen sc1
    s_waitcnt lgkmcnt(8)
    v_mfma_f32_16x16x32_bf16 v[80:83], v[236:239], v[216:219], v[80:83]
    ds_read_b64_tr_b16 v[232:233], v69 offset:41600
    v_mfma_f32_16x16x32_bf16 v[84:87], v[236:239], v[220:223], v[84:87]
    ds_read_b64_tr_b16 v[234:235], v69 offset:42112
    v_mfma_f32_16x16x32_bf16 v[88:91], v[240:243], v[216:219], v[88:91]
    ds_read_b64_tr_b16 v[236:237], v69 offset:41632
    v_mfma_f32_16x16x32_bf16 v[92:95], v[240:243], v[220:223], v[92:95]
    ds_read_b64_tr_b16 v[238:239], v69 offset:42144
    s_waitcnt lgkmcnt(8)
    v_mfma_f32_16x16x32_bf16 v[96:99], v[244:247], v[216:219], v[96:99]
    ds_read_b64_tr_b16 v[240:241], v69 offset:37440
    v_mfma_f32_16x16x32_bf16 v[100:103], v[244:247], v[220:223], v[100:103]
    ds_read_b64_tr_b16 v[242:243], v69 offset:37952
    v_mfma_f32_16x16x32_bf16 v[104:107], v[248:251], v[216:219], v[104:107]
    ds_read_b64_tr_b16 v[244:245], v69 offset:37472
    v_mfma_f32_16x16x32_bf16 v[108:111], v[248:251], v[220:223], v[108:111]
    ds_read_b64_tr_b16 v[246:247], v69 offset:37984
    s_waitcnt lgkmcnt(8)
    v_mfma_f32_16x16x32_bf16 v[144:147], v[224:227], v[216:219], v[144:147]
    ds_read_b64_tr_b16 v[248:249], v68 offset:37440
    v_mfma_f32_16x16x32_bf16 v[148:151], v[224:227], v[220:223], v[148:151]
    ds_read_b64_tr_b16 v[250:251], v68 offset:37952
    v_mfma_f32_16x16x32_bf16 v[152:155], v[228:231], v[216:219], v[152:155]
    ds_read_b64_tr_b16 v[224:225], v68 offset:37472
    v_mfma_f32_16x16x32_bf16 v[156:159], v[228:231], v[220:223], v[156:159]
    ds_read_b64_tr_b16 v[226:227], v68 offset:37984
    s_waitcnt lgkmcnt(8)
    v_mfma_f32_16x16x32_bf16 v[160:163], v[232:235], v[216:219], v[160:163]
    ds_read_b64_tr_b16 v[228:229], v68 offset:29120
    v_mfma_f32_16x16x32_bf16 v[164:167], v[232:235], v[220:223], v[164:167]
    ds_read_b64_tr_b16 v[230:231], v68 offset:29632
    v_mfma_f32_16x16x32_bf16 v[168:171], v[236:239], v[216:219], v[168:171]
    ds_read_b64_tr_b16 v[232:233], v68 offset:29152
    v_mfma_f32_16x16x32_bf16 v[172:175], v[236:239], v[220:223], v[172:175]
    ds_read_b64_tr_b16 v[234:235], v68 offset:29664
    s_waitcnt lgkmcnt(8)
    s_waitcnt vmcnt(9)
    v_mfma_f32_16x16x32_bf16 v[128:131], v[240:243], v[36:39], v[128:131]
    ds_read_b64_tr_b16 v[236:237], v69 offset:29120
    v_mfma_f32_16x16x32_bf16 v[132:135], v[240:243], v[176:179], v[132:135]
    ds_read_b64_tr_b16 v[238:239], v69 offset:29632
    buffer_load_dwordx4 v[216:219], v2, s[32:35], s16 offen offset:1024 sc1
    v_mfma_f32_16x16x32_bf16 v[136:139], v[244:247], v[36:39], v[136:139]
    ds_read_b64_tr_b16 v[240:241], v69 offset:29152
    v_mfma_f32_16x16x32_bf16 v[140:143], v[244:247], v[176:179], v[140:143]
    ds_read_b64_tr_b16 v[242:243], v69 offset:29664
    s_waitcnt lgkmcnt(8)
    v_mfma_f32_16x16x32_bf16 v[112:115], v[248:251], v[36:39], v[112:115]
    ds_read_b64_tr_b16 v[244:245], v68 offset:45760
    v_mfma_f32_16x16x32_bf16 v[116:119], v[248:251], v[176:179], v[116:119]
    ds_read_b64_tr_b16 v[246:247], v68 offset:46272
    v_mfma_f32_16x16x32_bf16 v[120:123], v[224:227], v[36:39], v[120:123]
    ds_read_b64_tr_b16 v[248:249], v68 offset:45792
    v_mfma_f32_16x16x32_bf16 v[124:127], v[224:227], v[176:179], v[124:127]
    ds_read_b64_tr_b16 v[250:251], v68 offset:46304
    buffer_load_dwordx4 v[220:223], v2, s[32:35], s16 offen offset:2048 sc1
    s_waitcnt lgkmcnt(8)
    v_mfma_f32_16x16x32_bf16 v[80:83], v[228:231], v[36:39], v[80:83]
    ds_read_b64_tr_b16 v[224:225], v69 offset:45760
    v_mfma_f32_16x16x32_bf16 v[84:87], v[228:231], v[176:179], v[84:87]
    ds_read_b64_tr_b16 v[226:227], v69 offset:46272
    v_mfma_f32_16x16x32_bf16 v[88:91], v[232:235], v[36:39], v[88:91]
    ds_read_b64_tr_b16 v[228:229], v69 offset:45792
    v_mfma_f32_16x16x32_bf16 v[92:95], v[232:235], v[176:179], v[92:95]
    ds_read_b64_tr_b16 v[230:231], v69 offset:46304
    s_waitcnt lgkmcnt(8)
    v_mfma_f32_16x16x32_bf16 v[96:99], v[236:239], v[36:39], v[96:99]
    s_barrier
    ds_read_b64_tr_b16 v[232:233], v71 offset:8320
    v_mfma_f32_16x16x32_bf16 v[100:103], v[236:239], v[176:179], v[100:103]
    ds_read_b64_tr_b16 v[234:235], v71 offset:8832
    v_mfma_f32_16x16x32_bf16 v[104:107], v[240:243], v[36:39], v[104:107]
    ds_read_b64_tr_b16 v[236:237], v71 offset:8352
    v_mfma_f32_16x16x32_bf16 v[108:111], v[240:243], v[176:179], v[108:111]
    ds_read_b64_tr_b16 v[238:239], v71 offset:8864
    s_waitcnt lgkmcnt(8)
    v_mfma_f32_16x16x32_bf16 v[144:147], v[244:247], v[36:39], v[144:147]
    ds_read_b64_tr_b16 v[240:241], v70 offset:8320
    v_mfma_f32_16x16x32_bf16 v[148:151], v[244:247], v[176:179], v[148:151]
    ds_read_b64_tr_b16 v[242:243], v70 offset:8832
    v_mfma_f32_16x16x32_bf16 v[152:155], v[248:251], v[36:39], v[152:155]
    ds_read_b64_tr_b16 v[244:245], v70 offset:8352
    v_mfma_f32_16x16x32_bf16 v[156:159], v[248:251], v[176:179], v[156:159]
    ds_read_b64_tr_b16 v[246:247], v70 offset:8864
    s_waitcnt lgkmcnt(8)
    v_mfma_f32_16x16x32_bf16 v[160:163], v[224:227], v[36:39], v[160:163]
    ds_read_b64_tr_b16 v[248:249], v70
    v_mfma_f32_16x16x32_bf16 v[164:167], v[224:227], v[176:179], v[164:167]
    ds_read_b64_tr_b16 v[250:251], v70 offset:512
    v_mfma_f32_16x16x32_bf16 v[168:171], v[228:231], v[36:39], v[168:171]
    ds_read_b64_tr_b16 v[224:225], v70 offset:32
    v_mfma_f32_16x16x32_bf16 v[172:175], v[228:231], v[176:179], v[172:175]
    ds_read_b64_tr_b16 v[226:227], v70 offset:544
    s_waitcnt lgkmcnt(8)
    s_waitcnt vmcnt(9)
    v_mfma_f32_16x16x32_bf16 v[128:131], v[232:235], v[180:183], v[128:131]
    ds_read_b64_tr_b16 v[228:229], v71
    v_mfma_f32_16x16x32_bf16 v[132:135], v[232:235], v[184:187], v[132:135]
    ds_read_b64_tr_b16 v[230:231], v71 offset:512
    buffer_load_dwordx4 v[36:39], v2, s[32:35], s16 offen offset:3072 sc1
    v_mfma_f32_16x16x32_bf16 v[136:139], v[236:239], v[180:183], v[136:139]
    ds_read_b64_tr_b16 v[232:233], v71 offset:32
    v_mfma_f32_16x16x32_bf16 v[140:143], v[236:239], v[184:187], v[140:143]
    ds_read_b64_tr_b16 v[234:235], v71 offset:544
    s_waitcnt lgkmcnt(8)
    v_mfma_f32_16x16x32_bf16 v[112:115], v[240:243], v[180:183], v[112:115]
    ds_read_b64_tr_b16 v[236:237], v70 offset:16640
    v_mfma_f32_16x16x32_bf16 v[116:119], v[240:243], v[184:187], v[116:119]
    ds_read_b64_tr_b16 v[238:239], v70 offset:17152
    v_mfma_f32_16x16x32_bf16 v[120:123], v[244:247], v[180:183], v[120:123]
    ds_read_b64_tr_b16 v[240:241], v70 offset:16672
    v_mfma_f32_16x16x32_bf16 v[124:127], v[244:247], v[184:187], v[124:127]
    ds_read_b64_tr_b16 v[242:243], v70 offset:17184
    s_add_u32 s96, s85, 13
    s_and_b32 s97, s96, 15
    s_lshl_b32 s98, s97, 14
    s_add_u32 s16, s98, s15
    buffer_load_dwordx4 v[176:179], v2, s[32:35], s16 offen sc1
    s_waitcnt lgkmcnt(8)
    v_mfma_f32_16x16x32_bf16 v[80:83], v[248:251], v[180:183], v[80:83]
    ds_read_b64_tr_b16 v[244:245], v71 offset:16640
    v_mfma_f32_16x16x32_bf16 v[84:87], v[248:251], v[184:187], v[84:87]
    ds_read_b64_tr_b16 v[246:247], v71 offset:17152
    v_mfma_f32_16x16x32_bf16 v[88:91], v[224:227], v[180:183], v[88:91]
    ds_read_b64_tr_b16 v[248:249], v71 offset:16672
    v_mfma_f32_16x16x32_bf16 v[92:95], v[224:227], v[184:187], v[92:95]
    ds_read_b64_tr_b16 v[250:251], v71 offset:17184
    s_waitcnt lgkmcnt(8)
    v_mfma_f32_16x16x32_bf16 v[96:99], v[228:231], v[180:183], v[96:99]
    ds_read_b64_tr_b16 v[224:225], v71 offset:12480
    v_mfma_f32_16x16x32_bf16 v[100:103], v[228:231], v[184:187], v[100:103]
    ds_read_b64_tr_b16 v[226:227], v71 offset:12992
    v_mfma_f32_16x16x32_bf16 v[104:107], v[232:235], v[180:183], v[104:107]
    ds_read_b64_tr_b16 v[228:229], v71 offset:12512
    v_mfma_f32_16x16x32_bf16 v[108:111], v[232:235], v[184:187], v[108:111]
    ds_read_b64_tr_b16 v[230:231], v71 offset:13024
    s_waitcnt lgkmcnt(8)
    v_mfma_f32_16x16x32_bf16 v[144:147], v[236:239], v[180:183], v[144:147]
    ds_read_b64_tr_b16 v[232:233], v70 offset:12480
    v_mfma_f32_16x16x32_bf16 v[148:151], v[236:239], v[184:187], v[148:151]
    ds_read_b64_tr_b16 v[234:235], v70 offset:12992
    v_mfma_f32_16x16x32_bf16 v[152:155], v[240:243], v[180:183], v[152:155]
    ds_read_b64_tr_b16 v[236:237], v70 offset:12512
    v_mfma_f32_16x16x32_bf16 v[156:159], v[240:243], v[184:187], v[156:159]
    ds_read_b64_tr_b16 v[238:239], v70 offset:13024
    s_waitcnt lgkmcnt(8)
    v_mfma_f32_16x16x32_bf16 v[160:163], v[244:247], v[180:183], v[160:163]
    ds_read_b64_tr_b16 v[240:241], v70 offset:4160
    v_mfma_f32_16x16x32_bf16 v[164:167], v[244:247], v[184:187], v[164:167]
    ds_read_b64_tr_b16 v[242:243], v70 offset:4672
    v_mfma_f32_16x16x32_bf16 v[168:171], v[248:251], v[180:183], v[168:171]
    ds_read_b64_tr_b16 v[244:245], v70 offset:4192
    v_mfma_f32_16x16x32_bf16 v[172:175], v[248:251], v[184:187], v[172:175]
    ds_read_b64_tr_b16 v[246:247], v70 offset:4704
    s_waitcnt lgkmcnt(8)
    s_waitcnt vmcnt(9)
    v_mfma_f32_16x16x32_bf16 v[128:131], v[224:227], v[188:191], v[128:131]
    ds_read_b64_tr_b16 v[248:249], v71 offset:4160
    v_mfma_f32_16x16x32_bf16 v[132:135], v[224:227], v[192:195], v[132:135]
    ds_read_b64_tr_b16 v[250:251], v71 offset:4672
    buffer_load_dwordx4 v[180:183], v2, s[32:35], s16 offen offset:1024 sc1
    v_mfma_f32_16x16x32_bf16 v[136:139], v[228:231], v[188:191], v[136:139]
    ds_read_b64_tr_b16 v[224:225], v71 offset:4192
    v_mfma_f32_16x16x32_bf16 v[140:143], v[228:231], v[192:195], v[140:143]
    ds_read_b64_tr_b16 v[226:227], v71 offset:4704
    s_waitcnt lgkmcnt(8)
    v_mfma_f32_16x16x32_bf16 v[112:115], v[232:235], v[188:191], v[112:115]
    ds_read_b64_tr_b16 v[228:229], v70 offset:20800
    v_mfma_f32_16x16x32_bf16 v[116:119], v[232:235], v[192:195], v[116:119]
    ds_read_b64_tr_b16 v[230:231], v70 offset:21312
    v_mfma_f32_16x16x32_bf16 v[120:123], v[236:239], v[188:191], v[120:123]
    ds_read_b64_tr_b16 v[232:233], v70 offset:20832
    v_mfma_f32_16x16x32_bf16 v[124:127], v[236:239], v[192:195], v[124:127]
    ds_read_b64_tr_b16 v[234:235], v70 offset:21344
    buffer_load_dwordx4 v[184:187], v2, s[32:35], s16 offen offset:2048 sc1
    s_waitcnt lgkmcnt(8)
    v_mfma_f32_16x16x32_bf16 v[80:83], v[240:243], v[188:191], v[80:83]
    ds_read_b64_tr_b16 v[236:237], v71 offset:20800
    v_mfma_f32_16x16x32_bf16 v[84:87], v[240:243], v[192:195], v[84:87]
    ds_read_b64_tr_b16 v[238:239], v71 offset:21312
    v_mfma_f32_16x16x32_bf16 v[88:91], v[244:247], v[188:191], v[88:91]
    ds_read_b64_tr_b16 v[240:241], v71 offset:20832
    v_mfma_f32_16x16x32_bf16 v[92:95], v[244:247], v[192:195], v[92:95]
    ds_read_b64_tr_b16 v[242:243], v71 offset:21344
    s_waitcnt lgkmcnt(8)
    v_mfma_f32_16x16x32_bf16 v[96:99], v[248:251], v[188:191], v[96:99]
    s_barrier
    ds_read_b64_tr_b16 v[244:245], v71 offset:33280
    v_mfma_f32_16x16x32_bf16 v[100:103], v[248:251], v[192:195], v[100:103]
    ds_read_b64_tr_b16 v[246:247], v71 offset:33792
    v_mfma_f32_16x16x32_bf16 v[104:107], v[224:227], v[188:191], v[104:107]
    ds_read_b64_tr_b16 v[248:249], v71 offset:33312
    v_mfma_f32_16x16x32_bf16 v[108:111], v[224:227], v[192:195], v[108:111]
    ds_read_b64_tr_b16 v[250:251], v71 offset:33824
    s_waitcnt lgkmcnt(8)
    v_mfma_f32_16x16x32_bf16 v[144:147], v[228:231], v[188:191], v[144:147]
    ds_read_b64_tr_b16 v[224:225], v70 offset:33280
    v_mfma_f32_16x16x32_bf16 v[148:151], v[228:231], v[192:195], v[148:151]
    ds_read_b64_tr_b16 v[226:227], v70 offset:33792
    v_mfma_f32_16x16x32_bf16 v[152:155], v[232:235], v[188:191], v[152:155]
    ds_read_b64_tr_b16 v[228:229], v70 offset:33312
    v_mfma_f32_16x16x32_bf16 v[156:159], v[232:235], v[192:195], v[156:159]
    ds_read_b64_tr_b16 v[230:231], v70 offset:33824
    s_waitcnt lgkmcnt(8)
    v_mfma_f32_16x16x32_bf16 v[160:163], v[236:239], v[188:191], v[160:163]
    ds_read_b64_tr_b16 v[232:233], v70 offset:24960
    v_mfma_f32_16x16x32_bf16 v[164:167], v[236:239], v[192:195], v[164:167]
    ds_read_b64_tr_b16 v[234:235], v70 offset:25472
    v_mfma_f32_16x16x32_bf16 v[168:171], v[240:243], v[188:191], v[168:171]
    ds_read_b64_tr_b16 v[236:237], v70 offset:24992
    v_mfma_f32_16x16x32_bf16 v[172:175], v[240:243], v[192:195], v[172:175]
    ds_read_b64_tr_b16 v[238:239], v70 offset:25504
    s_waitcnt lgkmcnt(8)
    s_waitcnt vmcnt(9)
    v_mfma_f32_16x16x32_bf16 v[128:131], v[244:247], v[196:199], v[128:131]
    ds_read_b64_tr_b16 v[240:241], v71 offset:24960
    v_mfma_f32_16x16x32_bf16 v[132:135], v[244:247], v[200:203], v[132:135]
    ds_read_b64_tr_b16 v[242:243], v71 offset:25472
    buffer_load_dwordx4 v[188:191], v2, s[32:35], s16 offen offset:3072 sc1
    v_mfma_f32_16x16x32_bf16 v[136:139], v[248:251], v[196:199], v[136:139]
    ds_read_b64_tr_b16 v[244:245], v71 offset:24992
    v_mfma_f32_16x16x32_bf16 v[140:143], v[248:251], v[200:203], v[140:143]
    ds_read_b64_tr_b16 v[246:247], v71 offset:25504
    s_waitcnt lgkmcnt(8)
    v_mfma_f32_16x16x32_bf16 v[112:115], v[224:227], v[196:199], v[112:115]
    ds_read_b64_tr_b16 v[248:249], v70 offset:41600
    v_mfma_f32_16x16x32_bf16 v[116:119], v[224:227], v[200:203], v[116:119]
    ds_read_b64_tr_b16 v[250:251], v70 offset:42112
    v_mfma_f32_16x16x32_bf16 v[120:123], v[228:231], v[196:199], v[120:123]
    ds_read_b64_tr_b16 v[224:225], v70 offset:41632
    v_mfma_f32_16x16x32_bf16 v[124:127], v[228:231], v[200:203], v[124:127]
    ds_read_b64_tr_b16 v[226:227], v70 offset:42144
    s_add_u32 s96, s85, 14
    s_and_b32 s97, s96, 15
    s_lshl_b32 s98, s97, 14
    s_add_u32 s16, s98, s15
    buffer_load_dwordx4 v[192:195], v2, s[32:35], s16 offen sc1
    s_waitcnt lgkmcnt(8)
    v_mfma_f32_16x16x32_bf16 v[80:83], v[232:235], v[196:199], v[80:83]
    ds_read_b64_tr_b16 v[228:229], v71 offset:41600
    v_mfma_f32_16x16x32_bf16 v[84:87], v[232:235], v[200:203], v[84:87]
    ds_read_b64_tr_b16 v[230:231], v71 offset:42112
    v_mfma_f32_16x16x32_bf16 v[88:91], v[236:239], v[196:199], v[88:91]
    ds_read_b64_tr_b16 v[232:233], v71 offset:41632
    v_mfma_f32_16x16x32_bf16 v[92:95], v[236:239], v[200:203], v[92:95]
    ds_read_b64_tr_b16 v[234:235], v71 offset:42144
    s_waitcnt lgkmcnt(8)
    v_mfma_f32_16x16x32_bf16 v[96:99], v[240:243], v[196:199], v[96:99]
    ds_read_b64_tr_b16 v[236:237], v71 offset:37440
    v_mfma_f32_16x16x32_bf16 v[100:103], v[240:243], v[200:203], v[100:103]
    ds_read_b64_tr_b16 v[238:239], v71 offset:37952
    v_mfma_f32_16x16x32_bf16 v[104:107], v[244:247], v[196:199], v[104:107]
    ds_read_b64_tr_b16 v[240:241], v71 offset:37472
    v_mfma_f32_16x16x32_bf16 v[108:111], v[244:247], v[200:203], v[108:111]
    ds_read_b64_tr_b16 v[242:243], v71 offset:37984
    s_waitcnt lgkmcnt(8)
    v_mfma_f32_16x16x32_bf16 v[144:147], v[248:251], v[196:199], v[144:147]
    ds_read_b64_tr_b16 v[244:245], v70 offset:37440
    v_mfma_f32_16x16x32_bf16 v[148:151], v[248:251], v[200:203], v[148:151]
    ds_read_b64_tr_b16 v[246:247], v70 offset:37952
    v_mfma_f32_16x16x32_bf16 v[152:155], v[224:227], v[196:199], v[152:155]
    ds_read_b64_tr_b16 v[248:249], v70 offset:37472
    v_mfma_f32_16x16x32_bf16 v[156:159], v[224:227], v[200:203], v[156:159]
    ds_read_b64_tr_b16 v[250:251], v70 offset:37984
    s_waitcnt lgkmcnt(8)
    v_mfma_f32_16x16x32_bf16 v[160:163], v[228:231], v[196:199], v[160:163]
    ds_read_b64_tr_b16 v[224:225], v70 offset:29120
    v_mfma_f32_16x16x32_bf16 v[164:167], v[228:231], v[200:203], v[164:167]
    ds_read_b64_tr_b16 v[226:227], v70 offset:29632
    v_mfma_f32_16x16x32_bf16 v[168:171], v[232:235], v[196:199], v[168:171]
    ds_read_b64_tr_b16 v[228:229], v70 offset:29152
    v_mfma_f32_16x16x32_bf16 v[172:175], v[232:235], v[200:203], v[172:175]
    ds_read_b64_tr_b16 v[230:231], v70 offset:29664
    s_waitcnt lgkmcnt(8)
    s_waitcnt vmcnt(9)
    v_mfma_f32_16x16x32_bf16 v[128:131], v[236:239], v[204:207], v[128:131]
    ds_read_b64_tr_b16 v[232:233], v71 offset:29120
    v_mfma_f32_16x16x32_bf16 v[132:135], v[236:239], v[208:211], v[132:135]
    ds_read_b64_tr_b16 v[234:235], v71 offset:29632
    buffer_load_dwordx4 v[196:199], v2, s[32:35], s16 offen offset:1024 sc1
    v_mfma_f32_16x16x32_bf16 v[136:139], v[240:243], v[204:207], v[136:139]
    ds_read_b64_tr_b16 v[236:237], v71 offset:29152
    v_mfma_f32_16x16x32_bf16 v[140:143], v[240:243], v[208:211], v[140:143]
    ds_read_b64_tr_b16 v[238:239], v71 offset:29664
    s_waitcnt lgkmcnt(8)
    v_mfma_f32_16x16x32_bf16 v[112:115], v[244:247], v[204:207], v[112:115]
    ds_read_b64_tr_b16 v[240:241], v70 offset:45760
    v_mfma_f32_16x16x32_bf16 v[116:119], v[244:247], v[208:211], v[116:119]
    ds_read_b64_tr_b16 v[242:243], v70 offset:46272
    v_mfma_f32_16x16x32_bf16 v[120:123], v[248:251], v[204:207], v[120:123]
    ds_read_b64_tr_b16 v[244:245], v70 offset:45792
    v_mfma_f32_16x16x32_bf16 v[124:127], v[248:251], v[208:211], v[124:127]
    ds_read_b64_tr_b16 v[246:247], v70 offset:46304
    buffer_load_dwordx4 v[200:203], v2, s[32:35], s16 offen offset:2048 sc1
    s_waitcnt lgkmcnt(8)
    v_mfma_f32_16x16x32_bf16 v[80:83], v[224:227], v[204:207], v[80:83]
    ds_read_b64_tr_b16 v[248:249], v71 offset:45760
    v_mfma_f32_16x16x32_bf16 v[84:87], v[224:227], v[208:211], v[84:87]
    ds_read_b64_tr_b16 v[250:251], v71 offset:46272
    v_mfma_f32_16x16x32_bf16 v[88:91], v[228:231], v[204:207], v[88:91]
    ds_read_b64_tr_b16 v[224:225], v71 offset:45792
    v_mfma_f32_16x16x32_bf16 v[92:95], v[228:231], v[208:211], v[92:95]
    ds_read_b64_tr_b16 v[226:227], v71 offset:46304
    s_waitcnt lgkmcnt(8)
    v_mfma_f32_16x16x32_bf16 v[96:99], v[232:235], v[204:207], v[96:99]
    s_barrier
    ds_read_b64_tr_b16 v[228:229], v67 offset:8320
    v_mfma_f32_16x16x32_bf16 v[100:103], v[232:235], v[208:211], v[100:103]
    ds_read_b64_tr_b16 v[230:231], v67 offset:8832
    v_mfma_f32_16x16x32_bf16 v[104:107], v[236:239], v[204:207], v[104:107]
    ds_read_b64_tr_b16 v[232:233], v67 offset:8352
    v_mfma_f32_16x16x32_bf16 v[108:111], v[236:239], v[208:211], v[108:111]
    ds_read_b64_tr_b16 v[234:235], v67 offset:8864
    s_waitcnt lgkmcnt(8)
    v_mfma_f32_16x16x32_bf16 v[144:147], v[240:243], v[204:207], v[144:147]
    ds_read_b64_tr_b16 v[236:237], v66 offset:8320
    v_mfma_f32_16x16x32_bf16 v[148:151], v[240:243], v[208:211], v[148:151]
    ds_read_b64_tr_b16 v[238:239], v66 offset:8832
    v_mfma_f32_16x16x32_bf16 v[152:155], v[244:247], v[204:207], v[152:155]
    ds_read_b64_tr_b16 v[240:241], v66 offset:8352
    v_mfma_f32_16x16x32_bf16 v[156:159], v[244:247], v[208:211], v[156:159]
    ds_read_b64_tr_b16 v[242:243], v66 offset:8864
    s_waitcnt lgkmcnt(8)
    v_mfma_f32_16x16x32_bf16 v[160:163], v[248:251], v[204:207], v[160:163]
    ds_read_b64_tr_b16 v[244:245], v66
    v_mfma_f32_16x16x32_bf16 v[164:167], v[248:251], v[208:211], v[164:167]
    ds_read_b64_tr_b16 v[246:247], v66 offset:512
    v_mfma_f32_16x16x32_bf16 v[168:171], v[224:227], v[204:207], v[168:171]
    ds_read_b64_tr_b16 v[248:249], v66 offset:32
    v_mfma_f32_16x16x32_bf16 v[172:175], v[224:227], v[208:211], v[172:175]
    ds_read_b64_tr_b16 v[250:251], v66 offset:544
    s_waitcnt lgkmcnt(8)
    s_waitcnt vmcnt(9)
    v_mfma_f32_16x16x32_bf16 v[128:131], v[228:231], v[212:215], v[128:131]
    ds_read_b64_tr_b16 v[224:225], v67
    v_mfma_f32_16x16x32_bf16 v[132:135], v[228:231], v[216:219], v[132:135]
    ds_read_b64_tr_b16 v[226:227], v67 offset:512
    buffer_load_dwordx4 v[204:207], v2, s[32:35], s16 offen offset:3072 sc1
    v_mfma_f32_16x16x32_bf16 v[136:139], v[232:235], v[212:215], v[136:139]
    ds_read_b64_tr_b16 v[228:229], v67 offset:32
    v_mfma_f32_16x16x32_bf16 v[140:143], v[232:235], v[216:219], v[140:143]
    ds_read_b64_tr_b16 v[230:231], v67 offset:544
    s_waitcnt lgkmcnt(8)
    v_mfma_f32_16x16x32_bf16 v[112:115], v[236:239], v[212:215], v[112:115]
    ds_read_b64_tr_b16 v[232:233], v66 offset:16640
    v_mfma_f32_16x16x32_bf16 v[116:119], v[236:239], v[216:219], v[116:119]
    ds_read_b64_tr_b16 v[234:235], v66 offset:17152
    v_mfma_f32_16x16x32_bf16 v[120:123], v[240:243], v[212:215], v[120:123]
    ds_read_b64_tr_b16 v[236:237], v66 offset:16672
    v_mfma_f32_16x16x32_bf16 v[124:127], v[240:243], v[216:219], v[124:127]
    ds_read_b64_tr_b16 v[238:239], v66 offset:17184
    s_add_u32 s96, s85, 15
    s_and_b32 s97, s96, 15
    s_lshl_b32 s98, s97, 14
    s_add_u32 s16, s98, s15
    buffer_load_dwordx4 v[208:211], v2, s[32:35], s16 offen sc1
    s_waitcnt lgkmcnt(8)
    v_mfma_f32_16x16x32_bf16 v[80:83], v[244:247], v[212:215], v[80:83]
    ds_read_b64_tr_b16 v[240:241], v67 offset:16640
    v_mfma_f32_16x16x32_bf16 v[84:87], v[244:247], v[216:219], v[84:87]
    ds_read_b64_tr_b16 v[242:243], v67 offset:17152
    v_mfma_f32_16x16x32_bf16 v[88:91], v[248:251], v[212:215], v[88:91]
    ds_read_b64_tr_b16 v[244:245], v67 offset:16672
    v_mfma_f32_16x16x32_bf16 v[92:95], v[248:251], v[216:219], v[92:95]
    ds_read_b64_tr_b16 v[246:247], v67 offset:17184
    s_waitcnt lgkmcnt(8)
    v_mfma_f32_16x16x32_bf16 v[96:99], v[224:227], v[212:215], v[96:99]
    ds_read_b64_tr_b16 v[248:249], v67 offset:12480
    v_mfma_f32_16x16x32_bf16 v[100:103], v[224:227], v[216:219], v[100:103]
    ds_read_b64_tr_b16 v[250:251], v67 offset:12992
    v_mfma_f32_16x16x32_bf16 v[104:107], v[228:231], v[212:215], v[104:107]
    ds_read_b64_tr_b16 v[224:225], v67 offset:12512
    v_mfma_f32_16x16x32_bf16 v[108:111], v[228:231], v[216:219], v[108:111]
    ds_read_b64_tr_b16 v[226:227], v67 offset:13024
    s_waitcnt lgkmcnt(8)
    v_mfma_f32_16x16x32_bf16 v[144:147], v[232:235], v[212:215], v[144:147]
    ds_read_b64_tr_b16 v[228:229], v66 offset:12480
    v_mfma_f32_16x16x32_bf16 v[148:151], v[232:235], v[216:219], v[148:151]
    ds_read_b64_tr_b16 v[230:231], v66 offset:12992
    v_mfma_f32_16x16x32_bf16 v[152:155], v[236:239], v[212:215], v[152:155]
    ds_read_b64_tr_b16 v[232:233], v66 offset:12512
    v_mfma_f32_16x16x32_bf16 v[156:159], v[236:239], v[216:219], v[156:159]
    ds_read_b64_tr_b16 v[234:235], v66 offset:13024
    s_waitcnt lgkmcnt(8)
    v_mfma_f32_16x16x32_bf16 v[160:163], v[240:243], v[212:215], v[160:163]
    ds_read_b64_tr_b16 v[236:237], v66 offset:4160
    v_mfma_f32_16x16x32_bf16 v[164:167], v[240:243], v[216:219], v[164:167]
    ds_read_b64_tr_b16 v[238:239], v66 offset:4672
    v_mfma_f32_16x16x32_bf16 v[168:171], v[244:247], v[212:215], v[168:171]
    ds_read_b64_tr_b16 v[240:241], v66 offset:4192
    v_mfma_f32_16x16x32_bf16 v[172:175], v[244:247], v[216:219], v[172:175]
    ds_read_b64_tr_b16 v[242:243], v66 offset:4704
    s_waitcnt lgkmcnt(8)
    s_waitcnt vmcnt(9)
    v_mfma_f32_16x16x32_bf16 v[128:131], v[248:251], v[220:223], v[128:131]
    ds_read_b64_tr_b16 v[244:245], v67 offset:4160
    v_mfma_f32_16x16x32_bf16 v[132:135], v[248:251], v[36:39], v[132:135]
    ds_read_b64_tr_b16 v[246:247], v67 offset:4672
    buffer_load_dwordx4 v[212:215], v2, s[32:35], s16 offen offset:1024 sc1
    v_mfma_f32_16x16x32_bf16 v[136:139], v[224:227], v[220:223], v[136:139]
    ds_read_b64_tr_b16 v[248:249], v67 offset:4192
    v_mfma_f32_16x16x32_bf16 v[140:143], v[224:227], v[36:39], v[140:143]
    ds_read_b64_tr_b16 v[250:251], v67 offset:4704
    s_waitcnt lgkmcnt(8)
    v_mfma_f32_16x16x32_bf16 v[112:115], v[228:231], v[220:223], v[112:115]
    ds_read_b64_tr_b16 v[224:225], v66 offset:20800
    v_mfma_f32_16x16x32_bf16 v[116:119], v[228:231], v[36:39], v[116:119]
    ds_read_b64_tr_b16 v[226:227], v66 offset:21312
    v_mfma_f32_16x16x32_bf16 v[120:123], v[232:235], v[220:223], v[120:123]
    ds_read_b64_tr_b16 v[228:229], v66 offset:20832
    v_mfma_f32_16x16x32_bf16 v[124:127], v[232:235], v[36:39], v[124:127]
    ds_read_b64_tr_b16 v[230:231], v66 offset:21344
    buffer_load_dwordx4 v[216:219], v2, s[32:35], s16 offen offset:2048 sc1
    s_waitcnt lgkmcnt(8)
    v_mfma_f32_16x16x32_bf16 v[80:83], v[236:239], v[220:223], v[80:83]
    ds_read_b64_tr_b16 v[232:233], v67 offset:20800
    v_mfma_f32_16x16x32_bf16 v[84:87], v[236:239], v[36:39], v[84:87]
    ds_read_b64_tr_b16 v[234:235], v67 offset:21312
    v_mfma_f32_16x16x32_bf16 v[88:91], v[240:243], v[220:223], v[88:91]
    ds_read_b64_tr_b16 v[236:237], v67 offset:20832
    v_mfma_f32_16x16x32_bf16 v[92:95], v[240:243], v[36:39], v[92:95]
    ds_read_b64_tr_b16 v[238:239], v67 offset:21344
    s_waitcnt lgkmcnt(8)
    v_mfma_f32_16x16x32_bf16 v[96:99], v[244:247], v[220:223], v[96:99]
    s_barrier
    ds_read_b64_tr_b16 v[240:241], v67 offset:33280
    v_mfma_f32_16x16x32_bf16 v[100:103], v[244:247], v[36:39], v[100:103]
    ds_read_b64_tr_b16 v[242:243], v67 offset:33792
    v_mfma_f32_16x16x32_bf16 v[104:107], v[248:251], v[220:223], v[104:107]
    ds_read_b64_tr_b16 v[244:245], v67 offset:33312
    v_mfma_f32_16x16x32_bf16 v[108:111], v[248:251], v[36:39], v[108:111]
    ds_read_b64_tr_b16 v[246:247], v67 offset:33824
    s_waitcnt lgkmcnt(8)
    v_mfma_f32_16x16x32_bf16 v[144:147], v[224:227], v[220:223], v[144:147]
    ds_read_b64_tr_b16 v[248:249], v66 offset:33280
    v_mfma_f32_16x16x32_bf16 v[148:151], v[224:227], v[36:39], v[148:151]
    ds_read_b64_tr_b16 v[250:251], v66 offset:33792
    v_mfma_f32_16x16x32_bf16 v[152:155], v[228:231], v[220:223], v[152:155]
    ds_read_b64_tr_b16 v[224:225], v66 offset:33312
    v_mfma_f32_16x16x32_bf16 v[156:159], v[228:231], v[36:39], v[156:159]
    ds_read_b64_tr_b16 v[226:227], v66 offset:33824
    s_waitcnt lgkmcnt(8)
    v_mfma_f32_16x16x32_bf16 v[160:163], v[232:235], v[220:223], v[160:163]
    ds_read_b64_tr_b16 v[228:229], v66 offset:24960
    v_mfma_f32_16x16x32_bf16 v[164:167], v[232:235], v[36:39], v[164:167]
    ds_read_b64_tr_b16 v[230:231], v66 offset:25472
    v_mfma_f32_16x16x32_bf16 v[168:171], v[236:239], v[220:223], v[168:171]
    ds_read_b64_tr_b16 v[232:233], v66 offset:24992
    v_mfma_f32_16x16x32_bf16 v[172:175], v[236:239], v[36:39], v[172:175]
    ds_read_b64_tr_b16 v[234:235], v66 offset:25504
    s_waitcnt lgkmcnt(8)
    s_waitcnt vmcnt(9)
    v_mfma_f32_16x16x32_bf16 v[128:131], v[240:243], v[176:179], v[128:131]
    ds_read_b64_tr_b16 v[236:237], v67 offset:24960
    v_mfma_f32_16x16x32_bf16 v[132:135], v[240:243], v[180:183], v[132:135]
    ds_read_b64_tr_b16 v[238:239], v67 offset:25472
    buffer_load_dwordx4 v[220:223], v2, s[32:35], s16 offen offset:3072 sc1
    s_barrier
    v_mfma_f32_16x16x32_bf16 v[136:139], v[244:247], v[176:179], v[136:139]
    ds_read_b64_tr_b16 v[240:241], v67 offset:24992
    v_mfma_f32_16x16x32_bf16 v[140:143], v[244:247], v[180:183], v[140:143]
    ds_read_b64_tr_b16 v[242:243], v67 offset:25504
    s_waitcnt lgkmcnt(8)
    v_mfma_f32_16x16x32_bf16 v[112:115], v[248:251], v[176:179], v[112:115]
    ds_read_b64_tr_b16 v[244:245], v66 offset:41600
    v_mfma_f32_16x16x32_bf16 v[116:119], v[248:251], v[180:183], v[116:119]
    ds_read_b64_tr_b16 v[246:247], v66 offset:42112
    v_mfma_f32_16x16x32_bf16 v[120:123], v[224:227], v[176:179], v[120:123]
    ds_read_b64_tr_b16 v[248:249], v66 offset:41632
    v_mfma_f32_16x16x32_bf16 v[124:127], v[224:227], v[180:183], v[124:127]
    ds_read_b64_tr_b16 v[250:251], v66 offset:42144
    s_waitcnt lgkmcnt(8)
    v_mfma_f32_16x16x32_bf16 v[80:83], v[228:231], v[176:179], v[80:83]
    ds_read_b64_tr_b16 v[224:225], v67 offset:41600
    v_mfma_f32_16x16x32_bf16 v[84:87], v[228:231], v[180:183], v[84:87]
    ds_read_b64_tr_b16 v[226:227], v67 offset:42112
    v_mfma_f32_16x16x32_bf16 v[88:91], v[232:235], v[176:179], v[88:91]
    ds_read_b64_tr_b16 v[228:229], v67 offset:41632
    v_mfma_f32_16x16x32_bf16 v[92:95], v[232:235], v[180:183], v[92:95]
    ds_read_b64_tr_b16 v[230:231], v67 offset:42144
    s_waitcnt lgkmcnt(8)
    v_mfma_f32_16x16x32_bf16 v[96:99], v[236:239], v[176:179], v[96:99]
    ds_read_b64_tr_b16 v[232:233], v67 offset:37440
    v_mfma_f32_16x16x32_bf16 v[100:103], v[236:239], v[180:183], v[100:103]
    ds_read_b64_tr_b16 v[234:235], v67 offset:37952
    v_mfma_f32_16x16x32_bf16 v[104:107], v[240:243], v[176:179], v[104:107]
    ds_read_b64_tr_b16 v[236:237], v67 offset:37472
    v_mfma_f32_16x16x32_bf16 v[108:111], v[240:243], v[180:183], v[108:111]
    ds_read_b64_tr_b16 v[238:239], v67 offset:37984
    s_waitcnt lgkmcnt(8)
    v_mfma_f32_16x16x32_bf16 v[144:147], v[244:247], v[176:179], v[144:147]
    ds_read_b64_tr_b16 v[240:241], v66 offset:37440
    v_mfma_f32_16x16x32_bf16 v[148:151], v[244:247], v[180:183], v[148:151]
    ds_read_b64_tr_b16 v[242:243], v66 offset:37952
    v_mfma_f32_16x16x32_bf16 v[152:155], v[248:251], v[176:179], v[152:155]
    ds_read_b64_tr_b16 v[244:245], v66 offset:37472
    v_mfma_f32_16x16x32_bf16 v[156:159], v[248:251], v[180:183], v[156:159]
    ds_read_b64_tr_b16 v[246:247], v66 offset:37984
    s_waitcnt lgkmcnt(8)
    v_mfma_f32_16x16x32_bf16 v[160:163], v[224:227], v[176:179], v[160:163]
    ds_read_b64_tr_b16 v[248:249], v66 offset:29120
    v_mfma_f32_16x16x32_bf16 v[164:167], v[224:227], v[180:183], v[164:167]
    ds_read_b64_tr_b16 v[250:251], v66 offset:29632
    v_mfma_f32_16x16x32_bf16 v[168:171], v[228:231], v[176:179], v[168:171]
    ds_read_b64_tr_b16 v[224:225], v66 offset:29152
    v_mfma_f32_16x16x32_bf16 v[172:175], v[228:231], v[180:183], v[172:175]
    ds_read_b64_tr_b16 v[226:227], v66 offset:29664
    s_waitcnt lgkmcnt(8)
    s_waitcnt vmcnt(8)
    v_mfma_f32_16x16x32_bf16 v[128:131], v[232:235], v[184:187], v[128:131]
    ds_read_b64_tr_b16 v[228:229], v67 offset:29120
    v_mfma_f32_16x16x32_bf16 v[132:135], v[232:235], v[188:191], v[132:135]
    ds_read_b64_tr_b16 v[230:231], v67 offset:29632
    v_mfma_f32_16x16x32_bf16 v[136:139], v[236:239], v[184:187], v[136:139]
    ds_read_b64_tr_b16 v[232:233], v67 offset:29152
    v_mfma_f32_16x16x32_bf16 v[140:143], v[236:239], v[188:191], v[140:143]
    ds_read_b64_tr_b16 v[234:235], v67 offset:29664
    s_waitcnt lgkmcnt(8)
    v_mfma_f32_16x16x32_bf16 v[112:115], v[240:243], v[184:187], v[112:115]
    ds_read_b64_tr_b16 v[236:237], v66 offset:45760
    v_mfma_f32_16x16x32_bf16 v[116:119], v[240:243], v[188:191], v[116:119]
    ds_read_b64_tr_b16 v[238:239], v66 offset:46272
    v_mfma_f32_16x16x32_bf16 v[120:123], v[244:247], v[184:187], v[120:123]
    ds_read_b64_tr_b16 v[240:241], v66 offset:45792
    v_mfma_f32_16x16x32_bf16 v[124:127], v[244:247], v[188:191], v[124:127]
    ds_read_b64_tr_b16 v[242:243], v66 offset:46304
    s_waitcnt lgkmcnt(8)
    v_mfma_f32_16x16x32_bf16 v[80:83], v[248:251], v[184:187], v[80:83]
    ds_read_b64_tr_b16 v[244:245], v67 offset:45760
    v_mfma_f32_16x16x32_bf16 v[84:87], v[248:251], v[188:191], v[84:87]
    ds_read_b64_tr_b16 v[246:247], v67 offset:46272
    v_mfma_f32_16x16x32_bf16 v[88:91], v[224:227], v[184:187], v[88:91]
    ds_read_b64_tr_b16 v[248:249], v67 offset:45792
    v_mfma_f32_16x16x32_bf16 v[92:95], v[224:227], v[188:191], v[92:95]
    ds_read_b64_tr_b16 v[250:251], v67 offset:46304
    s_waitcnt lgkmcnt(8)
    v_mfma_f32_16x16x32_bf16 v[96:99], v[228:231], v[184:187], v[96:99]
    s_barrier
    ds_read_b64_tr_b16 v[224:225], v69 offset:8320
    v_mfma_f32_16x16x32_bf16 v[100:103], v[228:231], v[188:191], v[100:103]
    ds_read_b64_tr_b16 v[226:227], v69 offset:8832
    v_mfma_f32_16x16x32_bf16 v[104:107], v[232:235], v[184:187], v[104:107]
    ds_read_b64_tr_b16 v[228:229], v69 offset:8352
    v_mfma_f32_16x16x32_bf16 v[108:111], v[232:235], v[188:191], v[108:111]
    ds_read_b64_tr_b16 v[230:231], v69 offset:8864
    s_waitcnt lgkmcnt(8)
    v_mfma_f32_16x16x32_bf16 v[144:147], v[236:239], v[184:187], v[144:147]
    ds_read_b64_tr_b16 v[232:233], v68 offset:8320
    v_mfma_f32_16x16x32_bf16 v[148:151], v[236:239], v[188:191], v[148:151]
    ds_read_b64_tr_b16 v[234:235], v68 offset:8832
    v_mfma_f32_16x16x32_bf16 v[152:155], v[240:243], v[184:187], v[152:155]
    ds_read_b64_tr_b16 v[236:237], v68 offset:8352
    v_mfma_f32_16x16x32_bf16 v[156:159], v[240:243], v[188:191], v[156:159]
    ds_read_b64_tr_b16 v[238:239], v68 offset:8864
    s_waitcnt lgkmcnt(8)
    v_mfma_f32_16x16x32_bf16 v[160:163], v[244:247], v[184:187], v[160:163]
    ds_read_b64_tr_b16 v[240:241], v68
    v_mfma_f32_16x16x32_bf16 v[164:167], v[244:247], v[188:191], v[164:167]
    ds_read_b64_tr_b16 v[242:243], v68 offset:512
    v_mfma_f32_16x16x32_bf16 v[168:171], v[248:251], v[184:187], v[168:171]
    ds_read_b64_tr_b16 v[244:245], v68 offset:32
    v_mfma_f32_16x16x32_bf16 v[172:175], v[248:251], v[188:191], v[172:175]
    ds_read_b64_tr_b16 v[246:247], v68 offset:544
    s_waitcnt lgkmcnt(8)
    s_waitcnt vmcnt(6)
    v_mfma_f32_16x16x32_bf16 v[128:131], v[224:227], v[192:195], v[128:131]
    ds_read_b64_tr_b16 v[248:249], v69
    v_mfma_f32_16x16x32_bf16 v[132:135], v[224:227], v[196:199], v[132:135]
    ds_read_b64_tr_b16 v[250:251], v69 offset:512
    v_mfma_f32_16x16x32_bf16 v[136:139], v[228:231], v[192:195], v[136:139]
    ds_read_b64_tr_b16 v[224:225], v69 offset:32
    v_mfma_f32_16x16x32_bf16 v[140:143], v[228:231], v[196:199], v[140:143]
    ds_read_b64_tr_b16 v[226:227], v69 offset:544
    s_waitcnt lgkmcnt(8)
    v_mfma_f32_16x16x32_bf16 v[112:115], v[232:235], v[192:195], v[112:115]
    ds_read_b64_tr_b16 v[228:229], v68 offset:16640
    v_mfma_f32_16x16x32_bf16 v[116:119], v[232:235], v[196:199], v[116:119]
    ds_read_b64_tr_b16 v[230:231], v68 offset:17152
    v_mfma_f32_16x16x32_bf16 v[120:123], v[236:239], v[192:195], v[120:123]
    ds_read_b64_tr_b16 v[232:233], v68 offset:16672
    v_mfma_f32_16x16x32_bf16 v[124:127], v[236:239], v[196:199], v[124:127]
    ds_read_b64_tr_b16 v[234:235], v68 offset:17184
    s_waitcnt lgkmcnt(8)
    v_mfma_f32_16x16x32_bf16 v[80:83], v[240:243], v[192:195], v[80:83]
    ds_read_b64_tr_b16 v[236:237], v69 offset:16640
    v_mfma_f32_16x16x32_bf16 v[84:87], v[240:243], v[196:199], v[84:87]
    ds_read_b64_tr_b16 v[238:239], v69 offset:17152
    v_mfma_f32_16x16x32_bf16 v[88:91], v[244:247], v[192:195], v[88:91]
    ds_read_b64_tr_b16 v[240:241], v69 offset:16672
    v_mfma_f32_16x16x32_bf16 v[92:95], v[244:247], v[196:199], v[92:95]
    ds_read_b64_tr_b16 v[242:243], v69 offset:17184
    s_waitcnt lgkmcnt(8)
    v_mfma_f32_16x16x32_bf16 v[96:99], v[248:251], v[192:195], v[96:99]
    ds_read_b64_tr_b16 v[244:245], v69 offset:12480
    v_mfma_f32_16x16x32_bf16 v[100:103], v[248:251], v[196:199], v[100:103]
    ds_read_b64_tr_b16 v[246:247], v69 offset:12992
    v_mfma_f32_16x16x32_bf16 v[104:107], v[224:227], v[192:195], v[104:107]
    ds_read_b64_tr_b16 v[248:249], v69 offset:12512
    v_mfma_f32_16x16x32_bf16 v[108:111], v[224:227], v[196:199], v[108:111]
    ds_read_b64_tr_b16 v[250:251], v69 offset:13024
    s_waitcnt lgkmcnt(8)
    v_mfma_f32_16x16x32_bf16 v[144:147], v[228:231], v[192:195], v[144:147]
    ds_read_b64_tr_b16 v[224:225], v68 offset:12480
    v_mfma_f32_16x16x32_bf16 v[148:151], v[228:231], v[196:199], v[148:151]
    ds_read_b64_tr_b16 v[226:227], v68 offset:12992
    v_mfma_f32_16x16x32_bf16 v[152:155], v[232:235], v[192:195], v[152:155]
    ds_read_b64_tr_b16 v[228:229], v68 offset:12512
    v_mfma_f32_16x16x32_bf16 v[156:159], v[232:235], v[196:199], v[156:159]
    ds_read_b64_tr_b16 v[230:231], v68 offset:13024
    s_waitcnt lgkmcnt(8)
    v_mfma_f32_16x16x32_bf16 v[160:163], v[236:239], v[192:195], v[160:163]
    ds_read_b64_tr_b16 v[232:233], v68 offset:4160
    v_mfma_f32_16x16x32_bf16 v[164:167], v[236:239], v[196:199], v[164:167]
    ds_read_b64_tr_b16 v[234:235], v68 offset:4672
    v_mfma_f32_16x16x32_bf16 v[168:171], v[240:243], v[192:195], v[168:171]
    ds_read_b64_tr_b16 v[236:237], v68 offset:4192
    v_mfma_f32_16x16x32_bf16 v[172:175], v[240:243], v[196:199], v[172:175]
    ds_read_b64_tr_b16 v[238:239], v68 offset:4704
    s_waitcnt lgkmcnt(8)
    s_waitcnt vmcnt(4)
    v_mfma_f32_16x16x32_bf16 v[128:131], v[244:247], v[200:203], v[128:131]
    ds_read_b64_tr_b16 v[240:241], v69 offset:4160
    v_mfma_f32_16x16x32_bf16 v[132:135], v[244:247], v[204:207], v[132:135]
    ds_read_b64_tr_b16 v[242:243], v69 offset:4672
    v_mfma_f32_16x16x32_bf16 v[136:139], v[248:251], v[200:203], v[136:139]
    ds_read_b64_tr_b16 v[244:245], v69 offset:4192
    v_mfma_f32_16x16x32_bf16 v[140:143], v[248:251], v[204:207], v[140:143]
    ds_read_b64_tr_b16 v[246:247], v69 offset:4704
    s_waitcnt lgkmcnt(8)
    v_mfma_f32_16x16x32_bf16 v[112:115], v[224:227], v[200:203], v[112:115]
    ds_read_b64_tr_b16 v[248:249], v68 offset:20800
    v_mfma_f32_16x16x32_bf16 v[116:119], v[224:227], v[204:207], v[116:119]
    ds_read_b64_tr_b16 v[250:251], v68 offset:21312
    v_mfma_f32_16x16x32_bf16 v[120:123], v[228:231], v[200:203], v[120:123]
    ds_read_b64_tr_b16 v[224:225], v68 offset:20832
    v_mfma_f32_16x16x32_bf16 v[124:127], v[228:231], v[204:207], v[124:127]
    ds_read_b64_tr_b16 v[226:227], v68 offset:21344
    s_waitcnt lgkmcnt(8)
    v_mfma_f32_16x16x32_bf16 v[80:83], v[232:235], v[200:203], v[80:83]
    ds_read_b64_tr_b16 v[228:229], v69 offset:20800
    v_mfma_f32_16x16x32_bf16 v[84:87], v[232:235], v[204:207], v[84:87]
    ds_read_b64_tr_b16 v[230:231], v69 offset:21312
    v_mfma_f32_16x16x32_bf16 v[88:91], v[236:239], v[200:203], v[88:91]
    ds_read_b64_tr_b16 v[232:233], v69 offset:20832
    v_mfma_f32_16x16x32_bf16 v[92:95], v[236:239], v[204:207], v[92:95]
    ds_read_b64_tr_b16 v[234:235], v69 offset:21344
    s_waitcnt lgkmcnt(8)
    v_mfma_f32_16x16x32_bf16 v[96:99], v[240:243], v[200:203], v[96:99]
    ds_read_b64_tr_b16 v[236:237], v69 offset:33280
    v_mfma_f32_16x16x32_bf16 v[100:103], v[240:243], v[204:207], v[100:103]
    ds_read_b64_tr_b16 v[238:239], v69 offset:33792
    v_mfma_f32_16x16x32_bf16 v[104:107], v[244:247], v[200:203], v[104:107]
    ds_read_b64_tr_b16 v[240:241], v69 offset:33312
    v_mfma_f32_16x16x32_bf16 v[108:111], v[244:247], v[204:207], v[108:111]
    ds_read_b64_tr_b16 v[242:243], v69 offset:33824
    s_waitcnt lgkmcnt(8)
    v_mfma_f32_16x16x32_bf16 v[144:147], v[248:251], v[200:203], v[144:147]
    ds_read_b64_tr_b16 v[244:245], v68 offset:33280
    v_mfma_f32_16x16x32_bf16 v[148:151], v[248:251], v[204:207], v[148:151]
    ds_read_b64_tr_b16 v[246:247], v68 offset:33792
    v_mfma_f32_16x16x32_bf16 v[152:155], v[224:227], v[200:203], v[152:155]
    ds_read_b64_tr_b16 v[248:249], v68 offset:33312
    v_mfma_f32_16x16x32_bf16 v[156:159], v[224:227], v[204:207], v[156:159]
    ds_read_b64_tr_b16 v[250:251], v68 offset:33824
    s_waitcnt lgkmcnt(8)
    v_mfma_f32_16x16x32_bf16 v[160:163], v[228:231], v[200:203], v[160:163]
    ds_read_b64_tr_b16 v[224:225], v68 offset:24960
    v_mfma_f32_16x16x32_bf16 v[164:167], v[228:231], v[204:207], v[164:167]
    ds_read_b64_tr_b16 v[226:227], v68 offset:25472
    v_mfma_f32_16x16x32_bf16 v[168:171], v[232:235], v[200:203], v[168:171]
    ds_read_b64_tr_b16 v[228:229], v68 offset:24992
    v_mfma_f32_16x16x32_bf16 v[172:175], v[232:235], v[204:207], v[172:175]
    ds_read_b64_tr_b16 v[230:231], v68 offset:25504
    s_waitcnt lgkmcnt(8)
    s_waitcnt vmcnt(2)
    v_mfma_f32_16x16x32_bf16 v[128:131], v[236:239], v[208:211], v[128:131]
    ds_read_b64_tr_b16 v[232:233], v69 offset:24960
    v_mfma_f32_16x16x32_bf16 v[132:135], v[236:239], v[212:215], v[132:135]
    ds_read_b64_tr_b16 v[234:235], v69 offset:25472
    v_mfma_f32_16x16x32_bf16 v[136:139], v[240:243], v[208:211], v[136:139]
    ds_read_b64_tr_b16 v[236:237], v69 offset:24992
    v_mfma_f32_16x16x32_bf16 v[140:143], v[240:243], v[212:215], v[140:143]
    ds_read_b64_tr_b16 v[238:239], v69 offset:25504
    s_waitcnt lgkmcnt(8)
    v_mfma_f32_16x16x32_bf16 v[112:115], v[244:247], v[208:211], v[112:115]
    ds_read_b64_tr_b16 v[240:241], v68 offset:41600
    v_mfma_f32_16x16x32_bf16 v[116:119], v[244:247], v[212:215], v[116:119]
    ds_read_b64_tr_b16 v[242:243], v68 offset:42112
    v_mfma_f32_16x16x32_bf16 v[120:123], v[248:251], v[208:211], v[120:123]
    ds_read_b64_tr_b16 v[244:245], v68 offset:41632
    v_mfma_f32_16x16x32_bf16 v[124:127], v[248:251], v[212:215], v[124:127]
    ds_read_b64_tr_b16 v[246:247], v68 offset:42144
    s_waitcnt lgkmcnt(8)
    v_mfma_f32_16x16x32_bf16 v[80:83], v[224:227], v[208:211], v[80:83]
    ds_read_b64_tr_b16 v[248:249], v69 offset:41600
    v_mfma_f32_16x16x32_bf16 v[84:87], v[224:227], v[212:215], v[84:87]
    ds_read_b64_tr_b16 v[250:251], v69 offset:42112
    v_mfma_f32_16x16x32_bf16 v[88:91], v[228:231], v[208:211], v[88:91]
    ds_read_b64_tr_b16 v[224:225], v69 offset:41632
    v_mfma_f32_16x16x32_bf16 v[92:95], v[228:231], v[212:215], v[92:95]
    ds_read_b64_tr_b16 v[226:227], v69 offset:42144
    s_waitcnt lgkmcnt(8)
    v_mfma_f32_16x16x32_bf16 v[96:99], v[232:235], v[208:211], v[96:99]
    ds_read_b64_tr_b16 v[228:229], v69 offset:37440
    v_mfma_f32_16x16x32_bf16 v[100:103], v[232:235], v[212:215], v[100:103]
    ds_read_b64_tr_b16 v[230:231], v69 offset:37952
    v_mfma_f32_16x16x32_bf16 v[104:107], v[236:239], v[208:211], v[104:107]
    ds_read_b64_tr_b16 v[232:233], v69 offset:37472
    v_mfma_f32_16x16x32_bf16 v[108:111], v[236:239], v[212:215], v[108:111]
    ds_read_b64_tr_b16 v[234:235], v69 offset:37984
    s_waitcnt lgkmcnt(8)
    v_mfma_f32_16x16x32_bf16 v[144:147], v[240:243], v[208:211], v[144:147]
    ds_read_b64_tr_b16 v[236:237], v68 offset:37440
    v_mfma_f32_16x16x32_bf16 v[148:151], v[240:243], v[212:215], v[148:151]
    ds_read_b64_tr_b16 v[238:239], v68 offset:37952
    v_mfma_f32_16x16x32_bf16 v[152:155], v[244:247], v[208:211], v[152:155]
    ds_read_b64_tr_b16 v[240:241], v68 offset:37472
    v_mfma_f32_16x16x32_bf16 v[156:159], v[244:247], v[212:215], v[156:159]
    ds_read_b64_tr_b16 v[242:243], v68 offset:37984
    s_waitcnt lgkmcnt(8)
    v_mfma_f32_16x16x32_bf16 v[160:163], v[248:251], v[208:211], v[160:163]
    ds_read_b64_tr_b16 v[244:245], v68 offset:29120
    v_mfma_f32_16x16x32_bf16 v[164:167], v[248:251], v[212:215], v[164:167]
    ds_read_b64_tr_b16 v[246:247], v68 offset:29632
    v_mfma_f32_16x16x32_bf16 v[168:171], v[224:227], v[208:211], v[168:171]
    ds_read_b64_tr_b16 v[248:249], v68 offset:29152
    v_mfma_f32_16x16x32_bf16 v[172:175], v[224:227], v[212:215], v[172:175]
    ds_read_b64_tr_b16 v[250:251], v68 offset:29664
    s_waitcnt lgkmcnt(8)
    s_waitcnt vmcnt(0)
    v_mfma_f32_16x16x32_bf16 v[128:131], v[228:231], v[216:219], v[128:131]
    ds_read_b64_tr_b16 v[224:225], v69 offset:29120
    v_mfma_f32_16x16x32_bf16 v[132:135], v[228:231], v[220:223], v[132:135]
    ds_read_b64_tr_b16 v[226:227], v69 offset:29632
    v_mfma_f32_16x16x32_bf16 v[136:139], v[232:235], v[216:219], v[136:139]
    ds_read_b64_tr_b16 v[228:229], v69 offset:29152
    v_mfma_f32_16x16x32_bf16 v[140:143], v[232:235], v[220:223], v[140:143]
    ds_read_b64_tr_b16 v[230:231], v69 offset:29664
    s_waitcnt lgkmcnt(8)
    v_mfma_f32_16x16x32_bf16 v[112:115], v[236:239], v[216:219], v[112:115]
    ds_read_b64_tr_b16 v[232:233], v68 offset:45760
    v_mfma_f32_16x16x32_bf16 v[116:119], v[236:239], v[220:223], v[116:119]
    ds_read_b64_tr_b16 v[234:235], v68 offset:46272
    v_mfma_f32_16x16x32_bf16 v[120:123], v[240:243], v[216:219], v[120:123]
    ds_read_b64_tr_b16 v[236:237], v68 offset:45792
    v_mfma_f32_16x16x32_bf16 v[124:127], v[240:243], v[220:223], v[124:127]
    ds_read_b64_tr_b16 v[238:239], v68 offset:46304
    s_waitcnt lgkmcnt(8)
    v_mfma_f32_16x16x32_bf16 v[80:83], v[244:247], v[216:219], v[80:83]
    ds_read_b64_tr_b16 v[240:241], v69 offset:45760
    v_mfma_f32_16x16x32_bf16 v[84:87], v[244:247], v[220:223], v[84:87]
    ds_read_b64_tr_b16 v[242:243], v69 offset:46272
    v_mfma_f32_16x16x32_bf16 v[88:91], v[248:251], v[216:219], v[88:91]
    ds_read_b64_tr_b16 v[244:245], v69 offset:45792
    v_mfma_f32_16x16x32_bf16 v[92:95], v[248:251], v[220:223], v[92:95]
    ds_read_b64_tr_b16 v[246:247], v69 offset:46304
    s_waitcnt lgkmcnt(8)
    v_mfma_f32_16x16x32_bf16 v[96:99], v[224:227], v[216:219], v[96:99]
    v_mfma_f32_16x16x32_bf16 v[100:103], v[224:227], v[220:223], v[100:103]
    v_mfma_f32_16x16x32_bf16 v[104:107], v[228:231], v[216:219], v[104:107]
    v_mfma_f32_16x16x32_bf16 v[108:111], v[228:231], v[220:223], v[108:111]
    s_waitcnt lgkmcnt(4)
    v_mfma_f32_16x16x32_bf16 v[144:147], v[232:235], v[216:219], v[144:147]
    v_mfma_f32_16x16x32_bf16 v[148:151], v[232:235], v[220:223], v[148:151]
    v_mfma_f32_16x16x32_bf16 v[152:155], v[236:239], v[216:219], v[152:155]
    v_mfma_f32_16x16x32_bf16 v[156:159], v[236:239], v[220:223], v[156:159]
    s_waitcnt lgkmcnt(0)
    v_mfma_f32_16x16x32_bf16 v[160:163], v[240:243], v[216:219], v[160:163]
    v_mfma_f32_16x16x32_bf16 v[164:167], v[240:243], v[220:223], v[164:167]
    v_mfma_f32_16x16x32_bf16 v[168:171], v[244:247], v[216:219], v[168:171]
    v_mfma_f32_16x16x32_bf16 v[172:175], v[244:247], v[220:223], v[172:175]
    v_cvt_pk_bf16_f32 v52, v128, v129
    v_cvt_pk_bf16_f32 v53, v130, v131
    v_cvt_pk_bf16_f32 v54, v132, v133
    v_cvt_pk_bf16_f32 v55, v134, v135
    v_cvt_pk_bf16_f32 v56, v136, v137
    v_cvt_pk_bf16_f32 v57, v138, v139
    v_cvt_pk_bf16_f32 v58, v140, v141
    v_cvt_pk_bf16_f32 v59, v142, v143
    ds_write_b64 v77, v[52:53]
    ds_write_b64 v77, v[54:55] offset:256
    ds_write_b64 v77, v[56:57] offset:1024
    ds_write_b64 v77, v[58:59] offset:1280
    v_cvt_pk_bf16_f32 v36, v112, v113
    v_cvt_pk_bf16_f32 v37, v114, v115
    v_cvt_pk_bf16_f32 v38, v116, v117
    v_cvt_pk_bf16_f32 v39, v118, v119
    v_cvt_pk_bf16_f32 v40, v120, v121
    v_cvt_pk_bf16_f32 v41, v122, v123
    v_cvt_pk_bf16_f32 v42, v124, v125
    v_cvt_pk_bf16_f32 v43, v126, v127
    v_permlane16_swap_b32 v36, v38
    v_permlane16_swap_b32 v37, v39
    v_permlane16_swap_b32 v40, v42
    v_permlane16_swap_b32 v41, v43
    s_waitcnt lgkmcnt(0)
    s_barrier
    s_setprio 0
    v_mfma_f32_32x32x16_bf16 v[112:127], v[28:31], v[36:39], 0
    v_mfma_f32_32x32x16_bf16 v[112:127], v[32:35], v[40:43], v[112:127]
    v_cvt_pk_bf16_f32 v52, v144, v145
    v_cvt_pk_bf16_f32 v53, v146, v147
    v_cvt_pk_bf16_f32 v54, v148, v149
    v_cvt_pk_bf16_f32 v55, v150, v151
    v_cvt_pk_bf16_f32 v56, v152, v153
    v_cvt_pk_bf16_f32 v57, v154, v155
    v_cvt_pk_bf16_f32 v58, v156, v157
    v_cvt_pk_bf16_f32 v59, v158, v159
    ds_write_b64 v78, v[52:53]
    ds_write_b64 v78, v[54:55] offset:512
    ds_write_b64 v78, v[56:57] offset:4096
    ds_write_b64 v78, v[58:59] offset:4608
    v_cvt_pk_bf16_f32 v44, v160, v161
    v_cvt_pk_bf16_f32 v45, v162, v163
    v_cvt_pk_bf16_f32 v46, v164, v165
    v_cvt_pk_bf16_f32 v47, v166, v167
    v_cvt_pk_bf16_f32 v48, v168, v169
    v_cvt_pk_bf16_f32 v49, v170, v171
    v_cvt_pk_bf16_f32 v50, v172, v173
    v_cvt_pk_bf16_f32 v51, v174, v175
    ds_write_b64 v78, v[44:45] offset:8192
    ds_write_b64 v78, v[46:47] offset:8704
    ds_write_b64 v78, v[48:49] offset:12288
    ds_write_b64 v78, v[50:51] offset:12800
    v_cvt_pk_bf16_f32 v36, v96, v97
    v_cvt_pk_bf16_f32 v37, v98, v99
    v_cvt_pk_bf16_f32 v38, v100, v101
    v_cvt_pk_bf16_f32 v39, v102, v103
    v_cvt_pk_bf16_f32 v40, v104, v105
    v_cvt_pk_bf16_f32 v41, v106, v107
    v_cvt_pk_bf16_f32 v42, v108, v109
    v_cvt_pk_bf16_f32 v43, v110, v111
    ds_write_b64 v77, v[36:37] offset:2048
    ds_write_b64 v77, v[38:39] offset:2304
    ds_write_b64 v77, v[40:41] offset:3072
    ds_write_b64 v77, v[42:43] offset:3328
    v_cvt_pk_bf16_f32 v44, v80, v81
    v_cvt_pk_bf16_f32 v45, v82, v83
    v_cvt_pk_bf16_f32 v46, v84, v85
    v_cvt_pk_bf16_f32 v47, v86, v87
    v_cvt_pk_bf16_f32 v48, v88, v89
    v_cvt_pk_bf16_f32 v49, v90, v91
    v_cvt_pk_bf16_f32 v50, v92, v93
    v_cvt_pk_bf16_f32 v51, v94, v95
    v_permlane16_swap_b32 v44, v46
    v_permlane16_swap_b32 v45, v47
    v_permlane16_swap_b32 v48, v50
    v_permlane16_swap_b32 v49, v51
    s_branch L_JOIN
L_HELP:
    s_add_u32 s96, s85, 5
    s_and_b32 s97, s96, 15
    s_lshl3_add_u32 s98, s97, s3
    s_sub_u32 s99, s98, 4
    s_mul_i32 s96, s99, 49152
    s_lshl_b32 s97, s11, 7
    s_add_u32 s82, s96, s97
    s_sub_u32 s96, s3, 4
    s_lshr_b32 s97, s96, 1
    s_mul_i32 s98, s97, 2080
    s_sub_u32 s99, s3, 4
    s_and_b32 s96, s99, 1
    s_mul_i32 s97, s96, 1056
    s_add_u32 s99, s98, s97
    s_add_u32 s20, s99, 124800
    s_mov_b32 m0, s20
    s_nop 0
    buffer_load_dwordx4 v62, s[40:43], s82 offen lds
    s_add_u32 s82, s82, 2048
    s_add_u32 m0, s20, 8320
    s_nop 0
    buffer_load_dwordx4 v62, s[40:43], s82 offen lds
    s_add_u32 s82, s82, 2048
    s_add_u32 m0, s20, 16640
    s_nop 0
    buffer_load_dwordx4 v62, s[40:43], s82 offen lds
    s_add_u32 s96, s85, 5
    s_and_b32 s97, s96, 15
    s_lshl3_add_u32 s98, s97, s3
    s_mul_i32 s99, s98, 49152
    s_lshl_b32 s96, s11, 7
    s_add_u32 s82, s99, s96
    s_lshr_b32 s96, s3, 1
    s_mul_i32 s97, s96, 2080
    s_and_b32 s98, s3, 1
    s_mul_i32 s99, s98, 1056
    s_add_u32 s96, s97, s99
    s_add_u32 s20, s96, 124800
    s_mov_b32 m0, s20
    s_nop 0
    buffer_load_dwordx4 v62, s[40:43], s82 offen lds
    s_add_u32 s82, s82, 2048
    s_add_u32 m0, s20, 8320
    s_nop 0
    buffer_load_dwordx4 v62, s[40:43], s82 offen lds
    s_add_u32 s82, s82, 2048
    s_add_u32 m0, s20, 16640
    s_nop 0
    buffer_load_dwordx4 v62, s[40:43], s82 offen lds
    s_and_b32 s96, s9, 3
    s_lshl2_add_u32 s97, s96, s3
    s_sub_u32 s98, s97, 4
    s_lshl_b32 s13, s98, 7
    v_lshrrev_b32 v61, 3, v1
    v_lshl_add_u32 v61, v61, 4, s13
    v_lshrrev_b32 v60, 3, v1
    v_mul_u32_u24 v60, 98304, v60
    v_and_b32 v9, 7, v1
    v_lshl_add_u32 v60, v9, 4, v60
    s_mul_i32 s96, s13, 6144
    s_bfe_u32 s97, s9, 131074
    s_lshl_b32 s98, s8, 1
    s_lshl4_add_u32 s99, s97, s98
    s_lshr_b32 s97, s9, 4
    s_add_u32 s98, s99, s97
    s_lshl_b32 s99, s98, 7
    s_add_u32 s97, s96, s99
    s_add_u32 s17, s97, 4096
    global_load_dwordx4 v[120:123], v61, s[86:87]
    s_waitcnt vmcnt(13)
    s_barrier
    buffer_load_dwordx4 v[80:83], v60, s[48:51], s17 offen nt
    s_add_u32 s17, s17, 12288
    buffer_load_dwordx4 v[84:87], v60, s[48:51], s17 offen nt
    s_add_u32 s17, s17, 12288
    s_lshl_b32 s13, s12, 7
    v_and_b32 v4, 31, v1
    v_lshl_add_u32 v4, v4, 2, s13
    global_load_dword v152, v4, s[78:79]
    s_waitcnt lgkmcnt(0)
    s_load_dword s24, s[32:33], s92 offset:512 glc
    s_load_dword s25, s[32:33], s92 offset:256 glc
    s_load_dword s26, s[32:33], s92 offset:1024 glc
    s_load_dword s27, s[32:33], s92 offset:768 glc
    s_waitcnt vmcnt(13)
    s_barrier
    s_add_u32 s96, s85, 6
    s_and_b32 s97, s96, 15
    s_lshl3_add_u32 s98, s97, s3
    s_sub_u32 s99, s98, 4
    s_mul_i32 s96, s99, 49152
    s_lshl_b32 s97, s11, 7
    s_add_u32 s82, s96, s97
    s_sub_u32 s96, s3, 4
    s_lshr_b32 s97, s96, 1
    s_mul_i32 s98, s97, 2080
    s_sub_u32 s99, s3, 4
    s_and_b32 s96, s99, 1
    s_mul_i32 s97, s96, 1056
    s_add_u32 s20, s98, s97
    s_mov_b32 m0, s20
    s_nop 0
    buffer_load_dwordx4 v62, s[40:43], s82 offen lds
    s_add_u32 s82, s82, 2048
    s_add_u32 m0, s20, 8320
    s_nop 0
    buffer_load_dwordx4 v62, s[40:43], s82 offen lds
    s_add_u32 s82, s82, 2048
    s_add_u32 m0, s20, 16640
    s_nop 0
    buffer_load_dwordx4 v62, s[40:43], s82 offen lds
    s_add_u32 s96, s85, 6
    s_and_b32 s97, s96, 15
    s_lshl3_add_u32 s98, s97, s3
    s_mul_i32 s99, s98, 49152
    s_lshl_b32 s96, s11, 7
    s_add_u32 s82, s99, s96
    s_lshr_b32 s96, s3, 1
    s_mul_i32 s97, s96, 2080
    s_and_b32 s98, s3, 1
    s_mul_i32 s99, s98, 1056
    s_add_u32 s20, s97, s99
    s_mov_b32 m0, s20
    s_nop 0
    buffer_load_dwordx4 v62, s[40:43], s82 offen lds
    s_add_u32 s82, s82, 2048
    s_add_u32 m0, s20, 8320
    s_nop 0
    buffer_load_dwordx4 v62, s[40:43], s82 offen lds
    s_add_u32 s82, s82, 2048
    s_add_u32 m0, s20, 16640
    s_nop 0
    buffer_load_dwordx4 v62, s[40:43], s82 offen lds
    s_waitcnt vmcnt(9)
    v_lshlrev_b32 v112, 16, v120
    v_mul_f32 v4, s7, v112
    v_exp_f32 v4, -v4
    s_nop 0
    v_add_f32 v4, 1.0, v4
    v_rcp_f32 v4, v4
    s_nop 0
    v_mul_f32 v112, v112, v4
    v_cvt_pk_bf16_f32 v112, 0, v112
    v_and_b32 v113, s6, v120
    v_mul_f32 v5, s7, v113
    v_exp_f32 v5, -v5
    s_nop 0
    v_add_f32 v5, 1.0, v5
    v_rcp_f32 v5, v5
    s_nop 0
    v_mul_f32 v113, v113, v5
    v_cvt_pk_bf16_f32 v113, 0, v113
    v_lshlrev_b32 v114, 16, v121
    v_mul_f32 v4, s7, v114
    v_exp_f32 v4, -v4
    s_nop 0
    v_add_f32 v4, 1.0, v4
    v_rcp_f32 v4, v4
    s_nop 0
    v_mul_f32 v114, v114, v4
    v_cvt_pk_bf16_f32 v114, 0, v114
    v_and_b32 v115, s6, v121
    v_mul_f32 v5, s7, v115
    v_exp_f32 v5, -v5
    s_nop 0
    v_add_f32 v5, 1.0, v5
    v_rcp_f32 v5, v5
    s_nop 0
    v_mul_f32 v115, v115, v5
    v_cvt_pk_bf16_f32 v115, 0, v115
    s_barrier
    s_add_u32 s96, s85, 7
    s_and_b32 s97, s96, 15
    s_lshl3_add_u32 s98, s97, s3
    s_sub_u32 s99, s98, 4
    s_mul_i32 s96, s99, 49152
    s_lshl_b32 s97, s11, 7
    s_add_u32 s82, s96, s97
    s_sub_u32 s96, s3, 4
    s_lshr_b32 s97, s96, 1
    s_mul_i32 s98, s97, 2080
    s_sub_u32 s99, s3, 4
    s_and_b32 s96, s99, 1
    s_mul_i32 s97, s96, 1056
    s_add_u32 s99, s98, s97
    s_add_u32 s20, s99, 24960
    s_mov_b32 m0, s20
    s_nop 0
    buffer_load_dwordx4 v62, s[40:43], s82 offen lds
    s_add_u32 s82, s82, 2048
    s_add_u32 m0, s20, 8320
    s_nop 0
    buffer_load_dwordx4 v62, s[40:43], s82 offen lds
    s_add_u32 s82, s82, 2048
    s_add_u32 m0, s20, 16640
    s_nop 0
    buffer_load_dwordx4 v62, s[40:43], s82 offen lds
    buffer_load_dwordx4 v[88:91], v60, s[48:51], s17 offen nt
    s_add_u32 s17, s17, 12288
    buffer_load_dwordx4 v[92:95], v60, s[48:51], s17 offen nt
    s_add_u32 s17, s17, 12288
    v_lshlrev_b32 v116, 16, v122
    v_mul_f32 v4, s7, v116
    v_exp_f32 v4, -v4
    s_nop 0
    v_add_f32 v4, 1.0, v4
    v_rcp_f32 v4, v4
    s_nop 0
    v_mul_f32 v116, v116, v4
    v_cvt_pk_bf16_f32 v116, 0, v116
    v_and_b32 v117, s6, v122
    v_mul_f32 v5, s7, v117
    v_exp_f32 v5, -v5
    s_nop 0
    v_add_f32 v5, 1.0, v5
    v_rcp_f32 v5, v5
    s_nop 0
    v_mul_f32 v117, v117, v5
    v_cvt_pk_bf16_f32 v117, 0, v117
    v_lshlrev_b32 v118, 16, v123
    v_mul_f32 v4, s7, v118
    v_exp_f32 v4, -v4
    s_nop 0
    v_add_f32 v4, 1.0, v4
    v_rcp_f32 v4, v4
    s_nop 0
    v_mul_f32 v118, v118, v4
    v_cvt_pk_bf16_f32 v118, 0, v118
    v_and_b32 v119, s6, v123
    v_mul_f32 v5, s7, v119
    v_exp_f32 v5, -v5
    s_nop 0
    v_add_f32 v5, 1.0, v5
    v_rcp_f32 v5, v5
    s_nop 0
    v_mul_f32 v119, v119, v5
    v_cvt_pk_bf16_f32 v119, 0, v119
    s_barrier
    s_add_u32 s96, s85, 7
    s_and_b32 s97, s96, 15
    s_lshl3_add_u32 s98, s97, s3
    s_mul_i32 s99, s98, 49152
    s_lshl_b32 s96, s11, 7
    s_add_u32 s82, s99, s96
    s_lshr_b32 s96, s3, 1
    s_mul_i32 s97, s96, 2080
    s_and_b32 s98, s3, 1
    s_mul_i32 s99, s98, 1056
    s_add_u32 s96, s97, s99
    s_add_u32 s20, s96, 24960
    s_mov_b32 m0, s20
    s_nop 0
    buffer_load_dwordx4 v62, s[40:43], s82 offen lds
    s_add_u32 s82, s82, 2048
    s_add_u32 m0, s20, 8320
    s_nop 0
    buffer_load_dwordx4 v62, s[40:43], s82 offen lds
    s_add_u32 s82, s82, 2048
    s_add_u32 m0, s20, 16640
    s_nop 0
    buffer_load_dwordx4 v62, s[40:43], s82 offen lds
    s_add_u32 s96, s85, 8
    s_and_b32 s97, s96, 15
    s_lshl3_add_u32 s98, s97, s3
    s_sub_u32 s99, s98, 4
    s_mul_i32 s96, s99, 49152
    s_lshl_b32 s97, s11, 7
    s_add_u32 s82, s96, s97
    s_sub_u32 s96, s3, 4
    s_lshr_b32 s97, s96, 1
    s_mul_i32 s98, s97, 2080
    s_sub_u32 s99, s3, 4
    s_and_b32 s96, s99, 1
    s_mul_i32 s97, s96, 1056
    s_add_u32 s99, s98, s97
    s_add_u32 s20, s99, 49920
    s_mov_b32 m0, s20
    s_nop 0
    buffer_load_dwordx4 v62, s[40:43], s82 offen lds
    s_add_u32 s82, s82, 2048
    s_add_u32 m0, s20, 8320
    s_nop 0
    buffer_load_dwordx4 v62, s[40:43], s82 offen lds
    s_add_u32 s82, s82, 2048
    s_add_u32 m0, s20, 16640
    s_nop 0
    buffer_load_dwordx4 v62, s[40:43], s82 offen lds
    s_waitcnt lgkmcnt(0)
    s_load_dword s24, s[32:33], s92 offset:1536 glc
    s_load_dword s25, s[32:33], s92 offset:1280 glc
    s_load_dword s26, s[32:33], s92 offset:2048 glc
    s_load_dword s27, s[32:33], s92 offset:1792 glc
    s_waitcnt vmcnt(19)
    v_lshlrev_b32 v4, 16, v80
    v_and_b32 v5, s6, v80
    v_mul_f32 v20, v4, v112
    v_mul_f32 v21, v5, v112
    v_lshlrev_b32 v6, 16, v81
    v_and_b32 v7, s6, v81
    v_mul_f32 v22, v6, v112
    v_mul_f32 v23, v7, v112
    v_lshlrev_b32 v4, 16, v82
    v_and_b32 v5, s6, v82
    v_mul_f32 v24, v4, v112
    v_mul_f32 v25, v5, v112
    v_lshlrev_b32 v6, 16, v83
    v_and_b32 v7, s6, v83
    v_mul_f32 v26, v6, v112
    v_mul_f32 v27, v7, v112
    s_barrier
    s_add_u32 s96, s85, 8
    s_and_b32 s97, s96, 15
    s_lshl3_add_u32 s98, s97, s3
    s_mul_i32 s99, s98, 49152
    s_lshl_b32 s96, s11, 7
    s_add_u32 s82, s99, s96
    s_lshr_b32 s96, s3, 1
    s_mul_i32 s97, s96, 2080
    s_and_b32 s98, s3, 1
    s_mul_i32 s99, s98, 1056
    s_add_u32 s96, s97, s99
    s_add_u32 s20, s96, 49920
    s_mov_b32 m0, s20
    s_nop 0
    buffer_load_dwordx4 v62, s[40:43], s82 offen lds
    s_add_u32 s82, s82, 2048
    s_add_u32 m0, s20, 8320
    s_nop 0
    buffer_load_dwordx4 v62, s[40:43], s82 offen lds
    s_add_u32 s82, s82, 2048
    s_add_u32 m0, s20, 16640
    s_nop 0
    buffer_load_dwordx4 v62, s[40:43], s82 offen lds
    buffer_load_dwordx4 v[96:99], v60, s[48:51], s17 offen nt
    s_add_u32 s17, s17, 12288
    buffer_load_dwordx4 v[100:103], v60, s[48:51], s17 offen nt
    s_add_u32 s17, s17, 12288
    s_waitcnt vmcnt(23)
    v_lshlrev_b32 v4, 16, v84
    v_and_b32 v5, s6, v84
    v_fmac_f32 v20, v4, v113
    v_fmac_f32 v21, v5, v113
    v_lshlrev_b32 v6, 16, v85
    v_and_b32 v7, s6, v85
    v_fmac_f32 v22, v6, v113
    v_fmac_f32 v23, v7, v113
    v_lshlrev_b32 v4, 16, v86
    v_and_b32 v5, s6, v86
    v_fmac_f32 v24, v4, v113
    v_fmac_f32 v25, v5, v113
    v_lshlrev_b32 v6, 16, v87
    v_and_b32 v7, s6, v87
    v_fmac_f32 v26, v6, v113
    v_fmac_f32 v27, v7, v113
    s_waitcnt vmcnt(16)
    s_barrier
    s_add_u32 s96, s85, 9
    s_and_b32 s97, s96, 15
    s_lshl3_add_u32 s98, s97, s3
    s_sub_u32 s99, s98, 4
    s_mul_i32 s96, s99, 49152
    s_lshl_b32 s97, s11, 7
    s_add_u32 s82, s96, s97
    s_sub_u32 s96, s3, 4
    s_lshr_b32 s97, s96, 1
    s_mul_i32 s98, s97, 2080
    s_sub_u32 s99, s3, 4
    s_and_b32 s96, s99, 1
    s_mul_i32 s97, s96, 1056
    s_add_u32 s99, s98, s97
    s_add_u32 s20, s99, 74880
    s_mov_b32 m0, s20
    s_nop 0
    buffer_load_dwordx4 v62, s[40:43], s82 offen lds
    s_add_u32 s82, s82, 2048
    s_add_u32 m0, s20, 8320
    s_nop 0
    buffer_load_dwordx4 v62, s[40:43], s82 offen lds
    s_add_u32 s82, s82, 2048
    s_add_u32 m0, s20, 16640
    s_nop 0
    buffer_load_dwordx4 v62, s[40:43], s82 offen lds
    s_add_u32 s96, s85, 9
    s_and_b32 s97, s96, 15
    s_lshl3_add_u32 s98, s97, s3
    s_mul_i32 s99, s98, 49152
    s_lshl_b32 s96, s11, 7
    s_add_u32 s82, s99, s96
    s_lshr_b32 s96, s3, 1
    s_mul_i32 s97, s96, 2080
    s_and_b32 s98, s3, 1
    s_mul_i32 s99, s98, 1056
    s_add_u32 s96, s97, s99
    s_add_u32 s20, s96, 74880
    s_mov_b32 m0, s20
    s_nop 0
    buffer_load_dwordx4 v62, s[40:43], s82 offen lds
    s_add_u32 s82, s82, 2048
    s_add_u32 m0, s20, 8320
    s_nop 0
    buffer_load_dwordx4 v62, s[40:43], s82 offen lds
    s_add_u32 s82, s82, 2048
    s_add_u32 m0, s20, 16640
    s_nop 0
    buffer_load_dwordx4 v62, s[40:43], s82 offen lds
    s_waitcnt vmcnt(18)
    v_lshlrev_b32 v4, 16, v88
    v_and_b32 v5, s6, v88
    v_fmac_f32 v20, v4, v114
    v_fmac_f32 v21, v5, v114
    v_lshlrev_b32 v6, 16, v89
    v_and_b32 v7, s6, v89
    v_fmac_f32 v22, v6, v114
    v_fmac_f32 v23, v7, v114
    v_lshlrev_b32 v4, 16, v90
    v_and_b32 v5, s6, v90
    v_fmac_f32 v24, v4, v114
    v_fmac_f32 v25, v5, v114
    v_lshlrev_b32 v6, 16, v91
    v_and_b32 v7, s6, v91
    v_fmac_f32 v26, v6, v114
    v_fmac_f32 v27, v7, v114
    s_waitcnt vmcnt(14)
    s_barrier
    s_add_u32 s96, s85, 10
    s_and_b32 s97, s96, 15
    s_lshl3_add_u32 s98, s97, s3
    s_sub_u32 s99, s98, 4
    s_mul_i32 s96, s99, 49152
    s_lshl_b32 s97, s11, 7
    s_add_u32 s82, s96, s97
    s_sub_u32 s96, s3, 4
    s_lshr_b32 s97, s96, 1
    s_mul_i32 s98, s97, 2080
    s_sub_u32 s99, s3, 4
    s_and_b32 s96, s99, 1
    s_mul_i32 s97, s96, 1056
    s_add_u32 s99, s98, s97
    s_add_u32 s20, s99, 99840
    s_mov_b32 m0, s20
    s_nop 0
    buffer_load_dwordx4 v62, s[40:43], s82 offen lds
    s_add_u32 s82, s82, 2048
    s_add_u32 m0, s20, 8320
    s_nop 0
    buffer_load_dwordx4 v62, s[40:43], s82 offen lds
    s_add_u32 s82, s82, 2048
    s_add_u32 m0, s20, 16640
    s_nop 0
    buffer_load_dwordx4 v62, s[40:43], s82 offen lds
    buffer_load_dwordx4 v[104:107], v60, s[48:51], s17 offen nt
    s_add_u32 s17, s17, 12288
    buffer_load_dwordx4 v[108:111], v60, s[48:51], s17 offen nt
    s_lshl2_add_u32 s96, s74, s75
    s_lshl_b32 s97, s96, 11
    s_and_b32 s98, s3, 1
    s_lshl_b32 s99, s98, 10
    s_add_u32 s96, s97, s99
    s_add_u32 s13, s96, 20971520
    s_lshl4_add_u32 s96, s21, s12
    s_lshl_b32 s97, s96, 11
    s_and_b32 s98, s3, 1
    s_lshl_b32 s99, s98, 10
    s_add_u32 s96, s97, s99
    s_add_u32 s14, s96, 12582912
    buffer_load_dwordx4 v[124:127], v2, s[32:35], s13 offen
    v_lshlrev_b32 v4, 16, v92
    v_and_b32 v5, s6, v92
    v_fmac_f32 v20, v4, v115
    v_fmac_f32 v21, v5, v115
    v_lshlrev_b32 v6, 16, v93
    v_and_b32 v7, s6, v93
    v_fmac_f32 v22, v6, v115
    v_fmac_f32 v23, v7, v115
    v_lshlrev_b32 v4, 16, v94
    v_and_b32 v5, s6, v94
    v_fmac_f32 v24, v4, v115
    v_fmac_f32 v25, v5, v115
    v_lshlrev_b32 v6, 16, v95
    v_and_b32 v7, s6, v95
    v_fmac_f32 v26, v6, v115
    v_fmac_f32 v27, v7, v115
    s_waitcnt lgkmcnt(0)
    s_load_dword s24, s[32:33], s92 offset:2560 glc
    s_load_dword s25, s[32:33], s92 offset:2304 glc
    s_load_dword s26, s[32:33], s92 offset:3072 glc
    s_load_dword s27, s[32:33], s92 offset:2816 glc
    s_load_dword s28, s[32:33], s92 offset:3584 glc
    s_load_dword s29, s[32:33], s92 offset:3328 glc
    s_waitcnt vmcnt(14)
    s_barrier
    s_add_u32 s96, s85, 10
    s_and_b32 s97, s96, 15
    s_lshl3_add_u32 s98, s97, s3
    s_mul_i32 s99, s98, 49152
    s_lshl_b32 s96, s11, 7
    s_add_u32 s82, s99, s96
    s_lshr_b32 s96, s3, 1
    s_mul_i32 s97, s96, 2080
    s_and_b32 s98, s3, 1
    s_mul_i32 s99, s98, 1056
    s_add_u32 s96, s97, s99
    s_add_u32 s20, s96, 99840
    s_mov_b32 m0, s20
    s_nop 0
    buffer_load_dwordx4 v62, s[40:43], s82 offen lds
    s_add_u32 s82, s82, 2048
    s_add_u32 m0, s20, 8320
    s_nop 0
    buffer_load_dwordx4 v62, s[40:43], s82 offen lds
    s_add_u32 s82, s82, 2048
    s_add_u32 m0, s20, 16640
    s_nop 0
    buffer_load_dwordx4 v62, s[40:43], s82 offen lds
    s_add_u32 s96, s85, 11
    s_and_b32 s97, s96, 15
    s_lshl3_add_u32 s98, s97, s3
    s_sub_u32 s99, s98, 4
    s_mul_i32 s96, s99, 49152
    s_lshl_b32 s97, s11, 7
    s_add_u32 s82, s96, s97
    s_sub_u32 s96, s3, 4
    s_lshr_b32 s97, s96, 1
    s_mul_i32 s98, s97, 2080
    s_sub_u32 s99, s3, 4
    s_and_b32 s96, s99, 1
    s_mul_i32 s97, s96, 1056
    s_add_u32 s99, s98, s97
    s_add_u32 s20, s99, 124800
    s_mov_b32 m0, s20
    s_nop 0
    buffer_load_dwordx4 v62, s[40:43], s82 offen lds
    s_add_u32 s82, s82, 2048
    s_add_u32 m0, s20, 8320
    s_nop 0
    buffer_load_dwordx4 v62, s[40:43], s82 offen lds
    s_add_u32 s82, s82, 2048
    s_add_u32 m0, s20, 16640
    s_nop 0
    buffer_load_dwordx4 v62, s[40:43], s82 offen lds
    s_waitcnt vmcnt(19)
    v_lshlrev_b32 v4, 16, v96
    v_and_b32 v5, s6, v96
    v_fmac_f32 v20, v4, v116
    v_fmac_f32 v21, v5, v116
    v_lshlrev_b32 v6, 16, v97
    v_and_b32 v7, s6, v97
    v_fmac_f32 v22, v6, v116
    v_fmac_f32 v23, v7, v116
    v_lshlrev_b32 v4, 16, v98
    v_and_b32 v5, s6, v98
    v_fmac_f32 v24, v4, v116
    v_fmac_f32 v25, v5, v116
    v_lshlrev_b32 v6, 16, v99
    v_and_b32 v7, s6, v99
    v_fmac_f32 v26, v6, v116
    v_fmac_f32 v27, v7, v116
    s_waitcnt vmcnt(18)
    v_lshlrev_b32 v4, 16, v100
    v_and_b32 v5, s6, v100
    v_fmac_f32 v20, v4, v117
    v_fmac_f32 v21, v5, v117
    v_lshlrev_b32 v6, 16, v101
    v_and_b32 v7, s6, v101
    v_fmac_f32 v22, v6, v117
    v_fmac_f32 v23, v7, v117
    v_lshlrev_b32 v4, 16, v102
    v_and_b32 v5, s6, v102
    v_fmac_f32 v24, v4, v117
    v_fmac_f32 v25, v5, v117
    v_lshlrev_b32 v6, 16, v103
    v_and_b32 v7, s6, v103
    v_fmac_f32 v26, v6, v117
    v_fmac_f32 v27, v7, v117
    s_waitcnt vmcnt(12)
    s_barrier
    s_add_u32 s96, s85, 11
    s_and_b32 s97, s96, 15
    s_lshl3_add_u32 s98, s97, s3
    s_mul_i32 s99, s98, 49152
    s_lshl_b32 s96, s11, 7
    s_add_u32 s82, s99, s96
    s_lshr_b32 s96, s3, 1
    s_mul_i32 s97, s96, 2080
    s_and_b32 s98, s3, 1
    s_mul_i32 s99, s98, 1056
    s_add_u32 s96, s97, s99
    s_add_u32 s20, s96, 124800
    s_mov_b32 m0, s20
    s_nop 0
    buffer_load_dwordx4 v62, s[40:43], s82 offen lds
    s_add_u32 s82, s82, 2048
    s_add_u32 m0, s20, 8320
    s_nop 0
    buffer_load_dwordx4 v62, s[40:43], s82 offen lds
    s_add_u32 s82, s82, 2048
    s_add_u32 m0, s20, 16640
    s_nop 0
    buffer_load_dwordx4 v62, s[40:43], s82 offen lds
    s_add_u32 s96, s85, 12
    s_and_b32 s97, s96, 15
    s_lshl3_add_u32 s98, s97, s3
    s_sub_u32 s99, s98, 4
    s_mul_i32 s96, s99, 49152
    s_lshl_b32 s97, s11, 7
    s_add_u32 s82, s96, s97
    s_sub_u32 s96, s3, 4
    s_lshr_b32 s97, s96, 1
    s_mul_i32 s98, s97, 2080
    s_sub_u32 s99, s3, 4
    s_and_b32 s96, s99, 1
    s_mul_i32 s97, s96, 1056
    s_add_u32 s20, s98, s97
    s_mov_b32 m0, s20
    s_nop 0
    buffer_load_dwordx4 v62, s[40:43], s82 offen lds
    s_add_u32 s82, s82, 2048
    s_add_u32 m0, s20, 8320
    s_nop 0
    buffer_load_dwordx4 v62, s[40:43], s82 offen lds
    s_add_u32 s82, s82, 2048
    s_add_u32 m0, s20, 16640
    s_nop 0
    buffer_load_dwordx4 v62, s[40:43], s82 offen lds
    s_waitcnt vmcnt(14)
    v_lshlrev_b32 v4, 16, v104
    v_and_b32 v5, s6, v104
    v_fmac_f32 v20, v4, v118
    v_fmac_f32 v21, v5, v118
    v_lshlrev_b32 v6, 16, v105
    v_and_b32 v7, s6, v105
    v_fmac_f32 v22, v6, v118
    v_fmac_f32 v23, v7, v118
    v_lshlrev_b32 v4, 16, v106
    v_and_b32 v5, s6, v106
    v_fmac_f32 v24, v4, v118
    v_fmac_f32 v25, v5, v118
    v_lshlrev_b32 v6, 16, v107
    v_and_b32 v7, s6, v107
    v_fmac_f32 v26, v6, v118
    v_fmac_f32 v27, v7, v118
    s_waitcnt vmcnt(13)
    v_lshlrev_b32 v4, 16, v108
    v_and_b32 v5, s6, v108
    v_fmac_f32 v20, v4, v119
    v_fmac_f32 v21, v5, v119
    v_lshlrev_b32 v6, 16, v109
    v_and_b32 v7, s6, v109
    v_fmac_f32 v22, v6, v119
    v_fmac_f32 v23, v7, v119
    v_lshlrev_b32 v4, 16, v110
    v_and_b32 v5, s6, v110
    v_fmac_f32 v24, v4, v119
    v_fmac_f32 v25, v5, v119
    v_lshlrev_b32 v6, 16, v111
    v_and_b32 v7, s6, v111
    v_fmac_f32 v26, v6, v119
    v_fmac_f32 v27, v7, v119
    v_permlane32_swap_b32 v20, v24
    v_permlane32_swap_b32 v21, v25
    v_permlane32_swap_b32 v22, v26
    v_permlane32_swap_b32 v23, v27
    v_add_f32 v20, v20, v24
    v_add_f32 v21, v21, v25
    v_add_f32 v22, v22, v26
    v_add_f32 v23, v23, v27
    s_nop 0
    v_permlane16_swap_b32 v20, v22
    v_permlane16_swap_b32 v21, v23
    v_add_f32 v20, v20, v22
    v_add_f32 v21, v21, v23
    s_nop 0
    v_add_f32_dpp v20, v20, v20 row_ror:8 row_mask:0xf bank_mask:0xf
    v_add_f32_dpp v21, v21, v21 row_ror:8 row_mask:0xf bank_mask:0xf
    s_nop 1
    v_mov_b32_dpp v20, v21 quad_perm:[0,1,2,3] row_mask:0xf bank_mask:0xc
    ds_write_b32 v65, v20 offset:1024
    s_waitcnt lgkmcnt(0)
    s_waitcnt vmcnt(9)
    s_barrier
    s_add_u32 s96, s85, 12
    s_and_b32 s97, s96, 15
    s_lshl3_add_u32 s98, s97, s3
    s_mul_i32 s99, s98, 49152
    s_lshl_b32 s96, s11, 7
    s_add_u32 s82, s99, s96
    s_lshr_b32 s96, s3, 1
    s_mul_i32 s97, s96, 2080
    s_and_b32 s98, s3, 1
    s_mul_i32 s99, s98, 1056
    s_add_u32 s20, s97, s99
    s_mov_b32 m0, s20
    s_nop 0
    buffer_load_dwordx4 v62, s[40:43], s82 offen lds
    s_add_u32 s82, s82, 2048
    s_add_u32 m0, s20, 8320
    s_nop 0
    buffer_load_dwordx4 v62, s[40:43], s82 offen lds
    s_add_u32 s82, s82, 2048
    s_add_u32 m0, s20, 16640
    s_nop 0
    buffer_load_dwordx4 v62, s[40:43], s82 offen lds
    s_add_u32 s96, s85, 13
    s_and_b32 s97, s96, 15
    s_lshl3_add_u32 s98, s97, s3
    s_sub_u32 s99, s98, 4
    s_mul_i32 s96, s99, 49152
    s_lshl_b32 s97, s11, 7
    s_add_u32 s82, s96, s97
    s_sub_u32 s96, s3, 4
    s_lshr_b32 s97, s96, 1
    s_mul_i32 s98, s97, 2080
    s_sub_u32 s99, s3, 4
    s_and_b32 s96, s99, 1
    s_mul_i32 s97, s96, 1056
    s_add_u32 s99, s98, s97
    s_add_u32 s20, s99, 24960
    s_mov_b32 m0, s20
    s_nop 0
    buffer_load_dwordx4 v62, s[40:43], s82 offen lds
    s_add_u32 s82, s82, 2048
    s_add_u32 m0, s20, 8320
    s_nop 0
    buffer_load_dwordx4 v62, s[40:43], s82 offen lds
    s_add_u32 s82, s82, 2048
    s_add_u32 m0, s20, 16640
    s_nop 0
    buffer_load_dwordx4 v62, s[40:43], s82 offen lds
    s_cmp_lg_u32 s3, 4
    s_cbranch_scc1 L_M2F
    ds_read_b128 v[20:23], v64 offset:1024
    s_bfe_u32 s96, s9, 131074
    s_lshl_b32 s97, s8, 1
    s_lshl4_add_u32 s98, s96, s97
    s_lshr_b32 s99, s9, 4
    s_add_u32 s96, s98, s99
    s_and_b32 s97, s9, 3
    s_lshl2_add_u32 s98, s96, s97
    s_lshl_b32 s99, s98, 9
    s_add_u32 s13, s99, 131072
    s_waitcnt lgkmcnt(0)
    v_add_f32 v20, v20, v21
    v_add_f32 v22, v22, v23
    v_mov_b32 v21, s4
    v_add_f32 v20, v20, v22
    buffer_store_dwordx2 v[20:21], v63, s[32:35], s13 offen sc1
L_M2F:
    s_waitcnt vmcnt(9)
    s_barrier
    s_add_u32 s96, s85, 13
    s_and_b32 s97, s96, 15
    s_lshl3_add_u32 s98, s97, s3
    s_mul_i32 s99, s98, 49152
    s_lshl_b32 s96, s11, 7
    s_add_u32 s82, s99, s96
    s_lshr_b32 s96, s3, 1
    s_mul_i32 s97, s96, 2080
    s_and_b32 s98, s3, 1
    s_mul_i32 s99, s98, 1056
    s_add_u32 s96, s97, s99
    s_add_u32 s20, s96, 24960
    s_mov_b32 m0, s20
    s_nop 0
    buffer_load_dwordx4 v62, s[40:43], s82 offen lds
    s_add_u32 s82, s82, 2048
    s_add_u32 m0, s20, 8320
    s_nop 0
    buffer_load_dwordx4 v62, s[40:43], s82 offen lds
    s_add_u32 s82, s82, 2048
    s_add_u32 m0, s20, 16640
    s_nop 0
    buffer_load_dwordx4 v62, s[40:43], s82 offen lds
    s_add_u32 s96, s85, 14
    s_and_b32 s97, s96, 15
    s_lshl3_add_u32 s98, s97, s3
    s_sub_u32 s99, s98, 4
    s_mul_i32 s96, s99, 49152
    s_lshl_b32 s97, s11, 7
    s_add_u32 s82, s96, s97
    s_sub_u32 s96, s3, 4
    s_lshr_b32 s97, s96, 1
    s_mul_i32 s98, s97, 2080
    s_sub_u32 s99, s3, 4
    s_and_b32 s96, s99, 1
    s_mul_i32 s97, s96, 1056
    s_add_u32 s99, s98, s97
    s_add_u32 s20, s99, 49920
    s_mov_b32 m0, s20
    s_nop 0
    buffer_load_dwordx4 v62, s[40:43], s82 offen lds
    s_add_u32 s82, s82, 2048
    s_add_u32 m0, s20, 8320
    s_nop 0
    buffer_load_dwordx4 v62, s[40:43], s82 offen lds
    s_add_u32 s82, s82, 2048
    s_add_u32 m0, s20, 16640
    s_nop 0
    buffer_load_dwordx4 v62, s[40:43], s82 offen lds
    s_waitcnt vmcnt(9)
    s_barrier
    s_add_u32 s96, s85, 14
    s_and_b32 s97, s96, 15
    s_lshl3_add_u32 s98, s97, s3
    s_mul_i32 s99, s98, 49152
    s_lshl_b32 s96, s11, 7
    s_add_u32 s82, s99, s96
    s_lshr_b32 s96, s3, 1
    s_mul_i32 s97, s96, 2080
    s_and_b32 s98, s3, 1
    s_mul_i32 s99, s98, 1056
    s_add_u32 s96, s97, s99
    s_add_u32 s20, s96, 49920
    s_mov_b32 m0, s20
    s_nop 0
    buffer_load_dwordx4 v62, s[40:43], s82 offen lds
    s_add_u32 s82, s82, 2048
    s_add_u32 m0, s20, 8320
    s_nop 0
    buffer_load_dwordx4 v62, s[40:43], s82 offen lds
    s_add_u32 s82, s82, 2048
    s_add_u32 m0, s20, 16640
    s_nop 0
    buffer_load_dwordx4 v62, s[40:43], s82 offen lds
    s_add_u32 s96, s85, 15
    s_and_b32 s97, s96, 15
    s_lshl3_add_u32 s98, s97, s3
    s_sub_u32 s99, s98, 4
    s_mul_i32 s96, s99, 49152
    s_lshl_b32 s97, s11, 7
    s_add_u32 s82, s96, s97
    s_sub_u32 s96, s3, 4
    s_lshr_b32 s97, s96, 1
    s_mul_i32 s98, s97, 2080
    s_sub_u32 s99, s3, 4
    s_and_b32 s96, s99, 1
    s_mul_i32 s97, s96, 1056
    s_add_u32 s99, s98, s97
    s_add_u32 s20, s99, 74880
    s_mov_b32 m0, s20
    s_nop 0
    buffer_load_dwordx4 v62, s[40:43], s82 offen lds
    s_add_u32 s82, s82, 2048
    s_add_u32 m0, s20, 8320
    s_nop 0
    buffer_load_dwordx4 v62, s[40:43], s82 offen lds
    s_add_u32 s82, s82, 2048
    s_add_u32 m0, s20, 16640
    s_nop 0
    buffer_load_dwordx4 v62, s[40:43], s82 offen lds
    s_waitcnt vmcnt(9)
    s_barrier
    s_add_u32 s96, s85, 15
    s_and_b32 s97, s96, 15
    s_lshl3_add_u32 s98, s97, s3
    s_mul_i32 s99, s98, 49152
    s_lshl_b32 s96, s11, 7
    s_add_u32 s82, s99, s96
    s_lshr_b32 s96, s3, 1
    s_mul_i32 s97, s96, 2080
    s_and_b32 s98, s3, 1
    s_mul_i32 s99, s98, 1056
    s_add_u32 s96, s97, s99
    s_add_u32 s20, s96, 74880
    s_mov_b32 m0, s20
    s_nop 0
    buffer_load_dwordx4 v62, s[40:43], s82 offen lds
    s_add_u32 s82, s82, 2048
    s_add_u32 m0, s20, 8320
    s_nop 0
    buffer_load_dwordx4 v62, s[40:43], s82 offen lds
    s_add_u32 s82, s82, 2048
    s_add_u32 m0, s20, 16640
    s_nop 0
    buffer_load_dwordx4 v62, s[40:43], s82 offen lds
    v_and_b32 v153, 31, v1
    v_lshlrev_b32 v153, 4, v153
    v_lshrrev_b32 v9, 5, v1
    v_lshl_add_u32 v153, v9, 9, v153
    s_and_b32 s96, s3, 3
    s_lshl4_add_u32 s97, s96, s12
    s_lshl_b32 s98, s97, 11
    s_add_u32 s18, s98, 131072
    buffer_load_dwordx4 v[144:147], v153, s[32:35], s18 offen sc1
    buffer_load_dwordx4 v[148:151], v153, s[32:35], s18 offen offset:1024 sc1
    s_barrier
    s_waitcnt vmcnt(8)
    s_waitcnt vmcnt(2)
    s_barrier
    s_lshl4_add_u32 s96, s11, s10
    s_lshl_b32 s97, s96, 10
    s_and_b32 s98, s3, 3
    s_lshl_b32 s99, s98, 8
    s_add_u32 s96, s97, s99
    s_add_u32 s13, s96, 29360128
    s_lshl_b32 s96, s11, 7
    s_add_u32 s14, s96, 32768
    v_lshlrev_b32 v60, 7, v1
    s_mov_b64 exec, 3
    buffer_load_dword v60, v60, s[32:35], s13 offen
    buffer_load_dword v61, v3, s[32:35], s14 offen
    s_mov_b64 exec, -1
    s_add_u32 s96, s84, 1114112
    s_and_b32 s97, s96, 1048575
    s_lshl_b32 s98, s83, 16
    s_xor_b32 s99, s97, s98
    s_xor_b32 s96, s88, 1048576
    s_add_u32 s13, s99, s96
    s_add_u32 m0, s89, 102400
    s_nop 0
    buffer_load_dwordx4 v74, s[44:47], s13 offen lds
    s_add_u32 s96, s84, 1179648
    s_and_b32 s97, s96, 1048575
    s_lshl_b32 s98, s83, 16
    s_xor_b32 s99, s97, s98
    s_xor_b32 s96, s88, 1048576
    s_add_u32 s13, s99, s96
    s_add_u32 m0, s89, 106496
    s_nop 0
    buffer_load_dwordx4 v74, s[44:47], s13 offen lds
    s_add_u32 s96, s84, 1245184
    s_and_b32 s97, s96, 1048575
    s_lshl_b32 s98, s83, 16
    s_xor_b32 s99, s97, s98
    s_xor_b32 s96, s88, 1048576
    s_add_u32 s13, s99, s96
    s_add_u32 m0, s89, 110592
    s_nop 0
    buffer_load_dwordx4 v74, s[44:47], s13 offen lds
    s_add_u32 s96, s84, 1310720
    s_and_b32 s97, s96, 1048575
    s_lshl_b32 s98, s83, 16
    s_xor_b32 s99, s97, s98
    s_xor_b32 s96, s88, 1048576
    s_add_u32 s13, s99, s96
    s_add_u32 m0, s89, 114688
    s_nop 0
    buffer_load_dwordx4 v74, s[44:47], s13 offen lds
    s_add_u32 s96, s84, 1376256
    s_and_b32 s97, s96, 1048575
    s_lshl_b32 s98, s83, 16
    s_xor_b32 s99, s97, s98
    s_xor_b32 s96, s88, 1048576
    s_add_u32 s13, s99, s96
    s_add_u32 m0, s89, 118784
    s_nop 0
    buffer_load_dwordx4 v74, s[44:47], s13 offen lds
    s_add_u32 s96, s84, 1441792
    s_and_b32 s97, s96, 1048575
    s_lshl_b32 s98, s83, 16
    s_xor_b32 s99, s97, s98
    s_xor_b32 s96, s88, 1048576
    s_add_u32 s13, s99, s96
    s_add_u32 m0, s89, 122880
    s_nop 0
    buffer_load_dwordx4 v74, s[44:47], s13 offen lds
    s_add_u32 s96, s84, 1507328
    s_and_b32 s97, s96, 1048575
    s_lshl_b32 s98, s83, 16
    s_xor_b32 s99, s97, s98
    s_xor_b32 s96, s88, 1048576
    s_add_u32 s13, s99, s96
    s_add_u32 m0, s89, 126976
    s_nop 0
    buffer_load_dwordx4 v74, s[44:47], s13 offen lds
    s_add_u32 s96, s84, 1572864
    s_and_b32 s97, s96, 1048575
    s_lshl_b32 s98, s83, 16
    s_xor_b32 s99, s97, s98
    s_xor_b32 s96, s88, 1048576
    s_add_u32 s13, s99, s96
    s_add_u32 m0, s89, 131072
    s_nop 0
    buffer_load_dwordx4 v74, s[44:47], s13 offen lds
    s_mov_b32 s13, s80
    buffer_load_dwordx4 v[176:179], v72, s[52:55], s13 offen nt
    s_add_u32 s13, s80, 4294049792
    buffer_load_dwordx4 v[180:183], v72, s[52:55], s13 offen nt
    s_add_u32 s13, s80, 57344
    buffer_load_dwordx4 v[184:187], v72, s[52:55], s13 offen nt
    s_add_u32 s13, s80, 4294107136
    buffer_load_dwordx4 v[188:191], v72, s[52:55], s13 offen nt
    s_add_u32 s13, s80, 114688
    buffer_load_dwordx4 v[192:195], v72, s[52:55], s13 offen nt
    s_add_u32 s13, s80, 4294164480
    buffer_load_dwordx4 v[196:199], v72, s[52:55], s13 offen nt
    s_add_u32 s13, s80, 172032
    buffer_load_dwordx4 v[200:203], v72, s[52:55], s13 offen nt
    s_add_u32 s13, s80, 4294221824
    buffer_load_dwordx4 v[204:207], v72, s[52:55], s13 offen nt
    s_waitcnt vmcnt(18)
    v_bitop3_b32 v4, v145, v147, s4 bitop3:0x7e
    v_bitop3_b32 v4, v4, v149, s4 bitop3:0xf6
    v_bitop3_b32 v4, v4, v151, s4 bitop3:0xf6
    v_cmp_ne_u32 vcc, 0, v4
    s_cbranch_vccz TOK_14
POLL_15:
    buffer_load_dwordx4 v[144:147], v153, s[32:35], s18 offen sc1
    buffer_load_dwordx4 v[148:151], v153, s[32:35], s18 offen offset:1024 sc1
    s_waitcnt vmcnt(0)
    v_bitop3_b32 v4, v145, v147, s4 bitop3:0x7e
    v_bitop3_b32 v4, v4, v149, s4 bitop3:0xf6
    v_bitop3_b32 v4, v4, v151, s4 bitop3:0xf6
    v_cmp_ne_u32 vcc, 0, v4
    s_cbranch_vccz PDONE_16
    s_add_u32 s5, s5, 1
    s_cmp_lt_u32 s5, 300000
    s_cbranch_scc1 POLL_15
PDONE_16:
TOK_14:
    s_and_b32 s96, s3, 3
    s_lshl_b32 s97, s96, 7
    s_add_u32 s13, s97, 139264
    v_and_b32 v4, 31, v1
    v_lshl_add_u32 v4, v4, 2, s13
    s_and_b32 s14, s3, 3
    v_add_f32 v144, v144, v148
    v_add_f32 v145, v146, v150
    v_mov_b32 v146, v144
    v_mov_b32 v147, v145
    s_cmp_eq_u32 s14, 2
    s_cselect_b32 s15, 1.0, 0
    v_permlane32_swap_b32 v144, v146
    v_permlane32_swap_b32 v145, v147
    v_pk_add_f32 v[144:145], v[144:145], v[146:147]
    v_cvt_pk_bf16_f32 v144, 0, v144
    v_cvt_pk_bf16_f32 v145, 0, v145
    v_add_f32 v144, s15, v144
    v_add_f32 v145, s15, v145
    v_cvt_pk_bf16_f32 v146, v144, v145
    ds_write_b32 v4, v146
    s_cbranch_scc0 L_NOG
    v_lshlrev_b32 v144, 16, v146
    v_and_b32 v145, s6, v146
    v_lshlrev_b32 v148, 16, v152
    v_and_b32 v149, s6, v152
    v_pk_mul_f32 v[148:149], v[148:149], v[144:145]
    v_cvt_pk_bf16_f32 v150, v148, v149
    v_lshlrev_b32 v144, 16, v150
    v_and_b32 v145, s6, v150
    v_pk_add_f32 v[144:145], v[148:149], v[144:145] neg_lo:[0,1] neg_hi:[0,1]
    v_cvt_pk_bf16_f32 v151, v144, v145
    v_add_f32 v144, v148, v149
    ds_write2_b32 v4, v150, v151 offset0:64 offset1:96
    ds_write_b32 v4, v152 offset:512
    v_add_f32_dpp v144, v144, v144 quad_perm:[1,0,3,2] row_mask:0xf bank_mask:0xf
    s_nop 1
    v_add_f32_dpp v144, v144, v144 quad_perm:[2,3,0,1] row_mask:0xf bank_mask:0xf
    s_nop 1
    v_add_f32_dpp v144, v144, v144 row_half_mirror row_mask:0xf bank_mask:0xf
    s_nop 1
    v_add_f32_dpp v144, v144, v144 row_ror:8 row_mask:0xf bank_mask:0xf
    s_lshl4_add_u32 s96, s21, s12
    s_lshl3_add_u32 s13, s96, 65536
    v_mov_b32 v146, v144
    v_mov_b32 v145, s4
    s_nop 0
    v_permlane16_swap_b32 v144, v146
    v_add_f32 v144, v144, v146
    s_mov_b64 exec, 1
    buffer_store_dwordx2 v[144:145], v3, s[32:35], s13 offen sc1
    s_mov_b64 exec, -1
L_NOG:
    s_waitcnt lgkmcnt(0)
    s_barrier
    ds_read_b128 v[36:39], v76
    ds_read_b128 v[40:43], v76 offset:1024
    s_waitcnt lgkmcnt(0)
    v_mfma_f32_32x32x16_bf16 v[112:127], v[28:31], v[36:39], 0
    v_mfma_f32_32x32x16_bf16 v[112:127], v[32:35], v[40:43], v[112:127]
    s_mov_b32 s13, s80
    buffer_load_dwordx4 v[208:211], v72, s[56:59], s13 offen nt
    s_add_u32 s13, s80, 4294049792
    buffer_load_dwordx4 v[212:215], v72, s[56:59], s13 offen nt
    s_add_u32 s13, s80, 57344
    buffer_load_dwordx4 v[216:219], v72, s[56:59], s13 offen nt
    s_add_u32 s13, s80, 4294107136
    buffer_load_dwordx4 v[220:223], v72, s[56:59], s13 offen nt
L_JOIN:
    s_nop 3
    v_cvt_pk_bf16_f32 v112, 0, v112
    v_cvt_pk_bf16_f32 v113, 0, v113
    v_cvt_pk_bf16_f32 v114, 0, v114
    v_cvt_pk_bf16_f32 v115, 0, v115
    v_cvt_pk_bf16_f32 v116, 0, v116
    v_cvt_pk_bf16_f32 v117, 0, v117
    v_cvt_pk_bf16_f32 v118, 0, v118
    v_cvt_pk_bf16_f32 v119, 0, v119
    v_cvt_pk_bf16_f32 v120, 0, v120
    v_cvt_pk_bf16_f32 v121, 0, v121
    v_cvt_pk_bf16_f32 v122, 0, v122
    v_cvt_pk_bf16_f32 v123, 0, v123
    v_cvt_pk_bf16_f32 v124, 0, v124
    v_cvt_pk_bf16_f32 v125, 0, v125
    v_cvt_pk_bf16_f32 v126, 0, v126
    v_cvt_pk_bf16_f32 v127, 0, v127
    v_max3_f32 v4, v112, v113, v114
    v_min3_f32 v5, v112, v113, v114
    v_max3_f32 v4, v4, v115, v116
    v_min3_f32 v5, v5, v115, v116
    v_max3_f32 v4, v4, v117, v118
    v_min3_f32 v5, v5, v117, v118
    v_max3_f32 v4, v4, v119, v120
    v_min3_f32 v5, v5, v119, v120
    v_max3_f32 v4, v4, v121, v122
    v_min3_f32 v5, v5, v121, v122
    v_max3_f32 v4, v4, v123, v124
    v_min3_f32 v5, v5, v123, v124
    v_max3_f32 v4, v4, v125, v126
    v_min3_f32 v5, v5, v125, v126
    v_max_f32 v6, v4, v127
    v_min_f32 v7, v5, v127
    v_max_f32 v4, v4, v127
    v_min_f32 v5, v5, v127
    s_nop 0
    v_permlane32_swap_b32 v4, v6
    v_permlane32_swap_b32 v5, v7
    v_max_f32 v4, v4, v6
    v_min_f32 v5, v5, v7
    v_pk_mul_f32 v[4:5], v[4:5], s[6:7] op_sel:[0,1]
    v_pk_fma_f32 v[128:129], v[112:113], s[6:7], v[4:5] op_sel:[0,1,0] op_sel_hi:[1,1,0] neg_lo:[0,0,1] neg_hi:[0,0,1]
    v_pk_fma_f32 v[112:113], v[112:113], s[6:7], v[4:5] op_sel:[0,1,1] neg_lo:[1,0,0] neg_hi:[1,0,0]
    v_pk_fma_f32 v[130:131], v[114:115], s[6:7], v[4:5] op_sel:[0,1,0] op_sel_hi:[1,1,0] neg_lo:[0,0,1] neg_hi:[0,0,1]
    v_pk_fma_f32 v[114:115], v[114:115], s[6:7], v[4:5] op_sel:[0,1,1] neg_lo:[1,0,0] neg_hi:[1,0,0]
    v_pk_fma_f32 v[132:133], v[116:117], s[6:7], v[4:5] op_sel:[0,1,0] op_sel_hi:[1,1,0] neg_lo:[0,0,1] neg_hi:[0,0,1]
    v_pk_fma_f32 v[116:117], v[116:117], s[6:7], v[4:5] op_sel:[0,1,1] neg_lo:[1,0,0] neg_hi:[1,0,0]
    v_pk_fma_f32 v[134:135], v[118:119], s[6:7], v[4:5] op_sel:[0,1,0] op_sel_hi:[1,1,0] neg_lo:[0,0,1] neg_hi:[0,0,1]
    v_pk_fma_f32 v[118:119], v[118:119], s[6:7], v[4:5] op_sel:[0,1,1] neg_lo:[1,0,0] neg_hi:[1,0,0]
    v_pk_fma_f32 v[136:137], v[120:121], s[6:7], v[4:5] op_sel:[0,1,0] op_sel_hi:[1,1,0] neg_lo:[0,0,1] neg_hi:[0,0,1]
    v_pk_fma_f32 v[120:121], v[120:121], s[6:7], v[4:5] op_sel:[0,1,1] neg_lo:[1,0,0] neg_hi:[1,0,0]
    v_pk_fma_f32 v[138:139], v[122:123], s[6:7], v[4:5] op_sel:[0,1,0] op_sel_hi:[1,1,0] neg_lo:[0,0,1] neg_hi:[0,0,1]
    v_pk_fma_f32 v[122:123], v[122:123], s[6:7], v[4:5] op_sel:[0,1,1] neg_lo:[1,0,0] neg_hi:[1,0,0]
    v_pk_fma_f32 v[140:141], v[124:125], s[6:7], v[4:5] op_sel:[0,1,0] op_sel_hi:[1,1,0] neg_lo:[0,0,1] neg_hi:[0,0,1]
    v_pk_fma_f32 v[124:125], v[124:125], s[6:7], v[4:5] op_sel:[0,1,1] neg_lo:[1,0,0] neg_hi:[1,0,0]
    v_pk_fma_f32 v[142:143], v[126:127], s[6:7], v[4:5] op_sel:[0,1,0] op_sel_hi:[1,1,0] neg_lo:[0,0,1] neg_hi:[0,0,1]
    v_pk_fma_f32 v[126:127], v[126:127], s[6:7], v[4:5] op_sel:[0,1,1] neg_lo:[1,0,0] neg_hi:[1,0,0]
    v_exp_f32 v128, v128
    v_exp_f32 v112, v112
    v_exp_f32 v129, v129
    v_exp_f32 v113, v113
    v_exp_f32 v130, v130
    v_exp_f32 v114, v114
    v_exp_f32 v131, v131
    v_exp_f32 v115, v115
    v_exp_f32 v132, v132
    v_exp_f32 v116, v116
    v_exp_f32 v133, v133
    v_exp_f32 v117, v117
    v_exp_f32 v134, v134
    v_exp_f32 v118, v118
    v_exp_f32 v135, v135
    v_exp_f32 v119, v119
    v_exp_f32 v136, v136
    v_exp_f32 v120, v120
    v_exp_f32 v137, v137
    v_exp_f32 v121, v121
    v_exp_f32 v138, v138
    v_exp_f32 v122, v122
    v_exp_f32 v139, v139
    v_exp_f32 v123, v123
    v_exp_f32 v140, v140
    v_exp_f32 v124, v124
    v_exp_f32 v141, v141
    v_exp_f32 v125, v125
    v_exp_f32 v142, v142
    v_exp_f32 v126, v126
    v_exp_f32 v143, v143
    v_exp_f32 v127, v127
    v_pk_add_f32 v[8:9], v[128:129], v[130:131]
    v_pk_add_f32 v[10:11], v[112:113], v[114:115]
    v_pk_add_f32 v[8:9], v[8:9], v[132:133]
    v_pk_add_f32 v[10:11], v[10:11], v[116:117]
    v_pk_add_f32 v[8:9], v[8:9], v[134:135]
    v_pk_add_f32 v[10:11], v[10:11], v[118:119]
    v_pk_add_f32 v[8:9], v[8:9], v[136:137]
    v_pk_add_f32 v[10:11], v[10:11], v[120:121]
    v_pk_add_f32 v[8:9], v[8:9], v[138:139]
    v_pk_add_f32 v[10:11], v[10:11], v[122:123]
    v_pk_add_f32 v[8:9], v[8:9], v[140:141]
    v_pk_add_f32 v[10:11], v[10:11], v[124:125]
    v_pk_add_f32 v[8:9], v[8:9], v[142:143]
    v_pk_add_f32 v[10:11], v[10:11], v[126:127]
    v_add_f32 v6, v8, v9
    v_add_f32 v7, v10, v11
    v_add_f32 v4, v8, v9
    v_add_f32 v5, v10, v11
    s_nop 0
    v_permlane32_swap_b32 v4, v6
    v_permlane32_swap_b32 v5, v7
    v_pk_add_f32 v[4:5], v[4:5], v[6:7]
    v_rcp_f32 v4, v4
    v_rcp_f32 v5, v5
    s_nop 0
    v_pk_mul_f32 v[128:129], v[128:129], v[4:5] op_sel_hi:[1,0]
    v_pk_mul_f32 v[112:113], v[112:113], v[4:5] op_sel:[0,1]
    v_pk_mul_f32 v[130:131], v[130:131], v[4:5] op_sel_hi:[1,0]
    v_pk_mul_f32 v[114:115], v[114:115], v[4:5] op_sel:[0,1]
    v_pk_mul_f32 v[132:133], v[132:133], v[4:5] op_sel_hi:[1,0]
    v_pk_mul_f32 v[116:117], v[116:117], v[4:5] op_sel:[0,1]
    v_pk_mul_f32 v[134:135], v[134:135], v[4:5] op_sel_hi:[1,0]
    v_pk_mul_f32 v[118:119], v[118:119], v[4:5] op_sel:[0,1]
    v_pk_mul_f32 v[136:137], v[136:137], v[4:5] op_sel_hi:[1,0]
    v_pk_mul_f32 v[120:121], v[120:121], v[4:5] op_sel:[0,1]
    v_pk_mul_f32 v[138:139], v[138:139], v[4:5] op_sel_hi:[1,0]
    v_pk_mul_f32 v[122:123], v[122:123], v[4:5] op_sel:[0,1]
    v_pk_mul_f32 v[140:141], v[140:141], v[4:5] op_sel_hi:[1,0]
    v_pk_mul_f32 v[124:125], v[124:125], v[4:5] op_sel:[0,1]
    v_pk_mul_f32 v[142:143], v[142:143], v[4:5] op_sel_hi:[1,0]
    v_pk_mul_f32 v[126:127], v[126:127], v[4:5] op_sel:[0,1]
    v_cvt_pk_bf16_f32 v80, v128, v129
    v_cvt_pk_bf16_f32 v88, v112, v113
    v_cvt_pk_bf16_f32 v81, v130, v131
    v_cvt_pk_bf16_f32 v89, v114, v115
    v_cvt_pk_bf16_f32 v82, v132, v133
    v_cvt_pk_bf16_f32 v90, v116, v117
    v_cvt_pk_bf16_f32 v83, v134, v135
    v_cvt_pk_bf16_f32 v91, v118, v119
    v_cvt_pk_bf16_f32 v84, v136, v137
    v_cvt_pk_bf16_f32 v92, v120, v121
    v_cvt_pk_bf16_f32 v85, v138, v139
    v_cvt_pk_bf16_f32 v93, v122, v123
    v_cvt_pk_bf16_f32 v86, v140, v141
    v_cvt_pk_bf16_f32 v94, v124, v125
    v_cvt_pk_bf16_f32 v87, v142, v143
    v_cvt_pk_bf16_f32 v95, v126, v127
    ds_write_b128 v75, v[80:83]
    ds_write_b128 v75, v[84:87] offset:4096
    ds_write_b128 v75, v[88:91] offset:8192
    ds_write_b128 v75, v[92:95] offset:12288
    s_lshl_b32 s13, s3, 12
    v_add_u32 v20, s13, v63
    s_lshl_b32 s96, s76, 13
    s_add_u32 s13, s96, 32768
    v_add_u32 v21, s13, v63
    v_mov_b32 v36, 0x3f803f80
    v_mov_b32 v37, 0x3f803f80
    v_mov_b32 v38, 0x3f803f80
    v_mov_b32 v39, 0x3f803f80
    s_lshl3_add_u32 s96, s11, s3
    s_lshl_b32 s97, s96, 5
    s_add_u32 s98, s97, s10
    s_lshl_b32 s99, s98, 10
    s_add_u32 s13, s99, 25165824
    s_add_u32 s15, s13, 16384
    s_lshl3_add_u32 s96, s11, s3
    s_lshl_b32 s97, s96, 10
    s_add_u32 s16, s97, 21495808
    s_lshl_b32 s96, s10, 6
    s_add_u32 s14, s96, s16
    s_waitcnt lgkmcnt(0)
    s_barrier
    s_lshl_b32 s96, s76, 6
    s_add_u32 s18, s96, 139264
    v_and_b32 v67, 7, v1
    v_lshl_add_u32 v67, v67, 2, s18
    v_lshrrev_b32 v9, 5, v1
    v_lshl_add_u32 v67, v9, 5, v67
    ds_read_b32 v64, v67
    ds_read_b32 v65, v67 offset:512
    ds_read_b32 v66, v67 offset:640
    ds_read_b32 v68, v67 offset:128
    ds_read_b32 v69, v67 offset:256
    ds_read_b32 v70, v67 offset:384
    ds_read_b32 v71, v67 offset:768
    ds_read_b64_tr_b16 v[128:129], v20
    ds_read_b64_tr_b16 v[130:131], v20 offset:512
    ds_read_b64_tr_b16 v[144:145], v21
    ds_read_b64_tr_b16 v[146:147], v21 offset:512
    ds_read_b64_tr_b16 v[148:149], v21 offset:4096
    ds_read_b64_tr_b16 v[150:151], v21 offset:4608
    ds_read_b64_tr_b16 v[132:133], v20 offset:1024
    ds_read_b64_tr_b16 v[134:135], v20 offset:1536
    ds_read_b64_tr_b16 v[152:153], v21 offset:1024
    ds_read_b64_tr_b16 v[154:155], v21 offset:1536
    ds_read_b64_tr_b16 v[156:157], v21 offset:5120
    ds_read_b64_tr_b16 v[158:159], v21 offset:5632
    ds_read_b64_tr_b16 v[136:137], v20 offset:2048
    ds_read_b64_tr_b16 v[138:139], v20 offset:2560
    ds_read_b64_tr_b16 v[160:161], v21 offset:2048
    ds_read_b64_tr_b16 v[162:163], v21 offset:2560
    ds_read_b64_tr_b16 v[164:165], v21 offset:6144
    ds_read_b64_tr_b16 v[166:167], v21 offset:6656
    s_waitcnt lgkmcnt(12)
    v_mfma_f32_16x16x32_bf16 v[52:55], v[128:131], v[144:147], 0
    v_mfma_f32_16x16x32_bf16 v[56:59], v[128:131], v[148:151], 0
    v_mfma_f32_16x16x32_bf16 v[40:43], v[128:131], v[36:39], 0
    ds_read_b64_tr_b16 v[140:141], v20 offset:3072
    ds_read_b64_tr_b16 v[142:143], v20 offset:3584
    ds_read_b64_tr_b16 v[168:169], v21 offset:3072
    ds_read_b64_tr_b16 v[170:171], v21 offset:3584
    ds_read_b64_tr_b16 v[172:173], v21 offset:7168
    ds_read_b64_tr_b16 v[174:175], v21 offset:7680
    s_waitcnt lgkmcnt(12)
    v_mfma_f32_16x16x32_bf16 v[52:55], v[132:135], v[152:155], v[52:55]
    v_mfma_f32_16x16x32_bf16 v[56:59], v[132:135], v[156:159], v[56:59]
    v_mfma_f32_16x16x32_bf16 v[40:43], v[132:135], v[36:39], v[40:43]
    v_and_b32 v75, 15, v1
    v_lshlrev_b32 v75, 15, v75
    s_and_b32 s96, s10, 1
    s_and_b32 s97, s2, 135
    s_lshl_b32 s98, s97, 12
    s_lshr_b32 s99, s10, 1
    s_lshl_b32 s97, s99, 6
    s_add_u32 s99, s98, s97
    s_lshl2_add_u32 s98, s96, s99
    s_add_u32 s97, s98, 1048576
    s_add_u32 s17, s97, 512
    s_waitcnt lgkmcnt(6)
    v_mfma_f32_16x16x32_bf16 v[52:55], v[136:139], v[160:163], v[52:55]
    v_mfma_f32_16x16x32_bf16 v[56:59], v[136:139], v[164:167], v[56:59]
    v_mfma_f32_16x16x32_bf16 v[40:43], v[136:139], v[36:39], v[40:43]
    s_waitcnt lgkmcnt(0)
    v_mfma_f32_16x16x32_bf16 v[52:55], v[140:143], v[168:171], v[52:55]
    v_mfma_f32_16x16x32_bf16 v[56:59], v[140:143], v[172:175], v[56:59]
    v_mfma_f32_16x16x32_bf16 v[40:43], v[140:143], v[36:39], v[40:43]
    s_cmp_lt_u32 s3, 4
    s_cbranch_scc1 L_NOQX
    ds_read_b128 v[44:47], v76 offset:2048
    ds_read_b128 v[48:51], v76 offset:3072
L_NOQX:
    s_nop 3
    buffer_store_dwordx4 v[52:55], v2, s[32:35], s13 offen sc1
    buffer_store_dwordx4 v[56:59], v2, s[32:35], s15 offen sc1
    s_mov_b32 exec_lo, 0x00010001
    s_mov_b32 exec_hi, 0x00010001
    buffer_store_dwordx4 v[40:43], v1, s[32:35], s14 offen sc1
    s_mov_b64 exec, -1
    s_waitcnt lgkmcnt(0)
    v_mfma_f32_32x32x16_bf16 v[112:127], v[28:31], v[44:47], 0
    v_mfma_f32_32x32x16_bf16 v[112:127], v[32:35], v[48:51], v[112:127]
    v_lshrrev_b32 v22, 3, v1
    v_lshlrev_b32 v22, 10, v22
    v_and_b32 v9, 7, v1
    v_lshl_add_u32 v22, v9, 4, v22
    v_and_b32 v76, 7, v1
    v_lshlrev_b32 v76, 4, v76
    v_lshrrev_b32 v9, 5, v1
    v_lshl_add_u32 v76, v9, 3, v76
    s_nop 3
    v_cvt_pk_bf16_f32 v112, 0, v112
    v_cvt_pk_bf16_f32 v113, 0, v113
    v_cvt_pk_bf16_f32 v114, 0, v114
    v_cvt_pk_bf16_f32 v115, 0, v115
    v_cvt_pk_bf16_f32 v116, 0, v116
    v_cvt_pk_bf16_f32 v117, 0, v117
    v_cvt_pk_bf16_f32 v118, 0, v118
    v_cvt_pk_bf16_f32 v119, 0, v119
    v_cvt_pk_bf16_f32 v120, 0, v120
    v_cvt_pk_bf16_f32 v121, 0, v121
    v_cvt_pk_bf16_f32 v122, 0, v122
    v_cvt_pk_bf16_f32 v123, 0, v123
    v_cvt_pk_bf16_f32 v124, 0, v124
    v_cvt_pk_bf16_f32 v125, 0, v125
    v_cvt_pk_bf16_f32 v126, 0, v126
    v_cvt_pk_bf16_f32 v127, 0, v127
    v_max3_f32 v52, v112, v113, v114
    v_min3_f32 v53, v112, v113, v114
    v_max3_f32 v52, v52, v115, v116
    v_min3_f32 v53, v53, v115, v116
    v_max3_f32 v52, v52, v117, v118
    v_min3_f32 v53, v53, v117, v118
    v_max3_f32 v52, v52, v119, v120
    v_min3_f32 v53, v53, v119, v120
    v_max3_f32 v52, v52, v121, v122
    v_min3_f32 v53, v53, v121, v122
    v_max3_f32 v52, v52, v123, v124
    v_min3_f32 v53, v53, v123, v124
    v_max3_f32 v52, v52, v125, v126
    v_min3_f32 v53, v53, v125, v126
    v_max_f32 v54, v52, v127
    v_min_f32 v55, v53, v127
    v_max_f32 v52, v52, v127
    v_min_f32 v53, v53, v127
    s_nop 0
    v_permlane32_swap_b32 v52, v54
    v_permlane32_swap_b32 v53, v55
    v_max_f32 v52, v52, v54
    v_min_f32 v53, v53, v55
    v_pk_mul_f32 v[52:53], v[52:53], s[6:7] op_sel:[0,1]
    v_pk_fma_f32 v[128:129], v[112:113], s[6:7], v[52:53] op_sel:[0,1,0] op_sel_hi:[1,1,0] neg_lo:[0,0,1] neg_hi:[0,0,1]
    v_pk_fma_f32 v[112:113], v[112:113], s[6:7], v[52:53] op_sel:[0,1,1] neg_lo:[1,0,0] neg_hi:[1,0,0]
    v_pk_fma_f32 v[130:131], v[114:115], s[6:7], v[52:53] op_sel:[0,1,0] op_sel_hi:[1,1,0] neg_lo:[0,0,1] neg_hi:[0,0,1]
    v_pk_fma_f32 v[114:115], v[114:115], s[6:7], v[52:53] op_sel:[0,1,1] neg_lo:[1,0,0] neg_hi:[1,0,0]
    v_pk_fma_f32 v[132:133], v[116:117], s[6:7], v[52:53] op_sel:[0,1,0] op_sel_hi:[1,1,0] neg_lo:[0,0,1] neg_hi:[0,0,1]
    v_pk_fma_f32 v[116:117], v[116:117], s[6:7], v[52:53] op_sel:[0,1,1] neg_lo:[1,0,0] neg_hi:[1,0,0]
    v_pk_fma_f32 v[134:135], v[118:119], s[6:7], v[52:53] op_sel:[0,1,0] op_sel_hi:[1,1,0] neg_lo:[0,0,1] neg_hi:[0,0,1]
    v_pk_fma_f32 v[118:119], v[118:119], s[6:7], v[52:53] op_sel:[0,1,1] neg_lo:[1,0,0] neg_hi:[1,0,0]
    v_pk_fma_f32 v[136:137], v[120:121], s[6:7], v[52:53] op_sel:[0,1,0] op_sel_hi:[1,1,0] neg_lo:[0,0,1] neg_hi:[0,0,1]
    v_pk_fma_f32 v[120:121], v[120:121], s[6:7], v[52:53] op_sel:[0,1,1] neg_lo:[1,0,0] neg_hi:[1,0,0]
    v_pk_fma_f32 v[138:139], v[122:123], s[6:7], v[52:53] op_sel:[0,1,0] op_sel_hi:[1,1,0] neg_lo:[0,0,1] neg_hi:[0,0,1]
    v_pk_fma_f32 v[122:123], v[122:123], s[6:7], v[52:53] op_sel:[0,1,1] neg_lo:[1,0,0] neg_hi:[1,0,0]
    v_pk_fma_f32 v[140:141], v[124:125], s[6:7], v[52:53] op_sel:[0,1,0] op_sel_hi:[1,1,0] neg_lo:[0,0,1] neg_hi:[0,0,1]
    v_pk_fma_f32 v[124:125], v[124:125], s[6:7], v[52:53] op_sel:[0,1,1] neg_lo:[1,0,0] neg_hi:[1,0,0]
    v_pk_fma_f32 v[142:143], v[126:127], s[6:7], v[52:53] op_sel:[0,1,0] op_sel_hi:[1,1,0] neg_lo:[0,0,1] neg_hi:[0,0,1]
    v_pk_fma_f32 v[126:127], v[126:127], s[6:7], v[52:53] op_sel:[0,1,1] neg_lo:[1,0,0] neg_hi:[1,0,0]
    v_exp_f32 v128, v128
    v_exp_f32 v112, v112
    v_exp_f32 v129, v129
    s_lshl_b32 s96, s11, 7
    s_add_u32 s18, s96, 32768
    s_lshl3_add_u32 s14, s10, s18
    v_and_b32 v23, 15, v1
    v_lshlrev_b32 v23, 3, v23
    s_waitcnt vmcnt(0)
    s_barrier
    s_cmp_lg_u32 s3, 0
    s_cbranch_scc1 L_PC
    v_mov_b32 v21, s4
    s_mov_b32 exec_hi, 0
    s_mov_b32 exec_lo, 65535
    buffer_store_dword v21, v75, s[32:35], s17 offen sc1
    s_mov_b64 exec, -1
L_PC:
    buffer_load_dword v67, v3, s[32:35], 0 offen offset:256 sc1
    s_lshl4_add_u32 s96, s11, s10
    s_lshl_b32 s97, s96, 14
    s_lshl_b32 s98, s3, 7
    s_add_u32 s99, s97, s98
    s_add_u32 s13, s99, 25165824
    s_lshl4_add_u32 s96, s11, s10
    s_lshl_b32 s97, s96, 10
    s_lshl_b32 s98, s3, 7
    s_add_u32 s99, s97, s98
    s_add_u32 s15, s99, 29360128
    s_add_u32 s17, s17, 3072
    s_load_dwordx2 s[24:25], s[32:33], s92 offset:512 glc
    s_add_u32 s96, s84, 262144
    s_and_b32 s97, s96, 1048575
    s_lshl_b32 s98, s83, 16
    s_xor_b32 s99, s97, s98
    s_add_u32 s19, s99, s88
    s_add_u32 m0, s89, 49152
    s_nop 0
    buffer_load_dwordx4 v74, s[44:47], s19 offen lds
    v_exp_f32 v113, v113
    v_exp_f32 v130, v130
    v_exp_f32 v114, v114
    v_exp_f32 v131, v131
    v_exp_f32 v115, v115
    v_exp_f32 v132, v132
    v_exp_f32 v116, v116
    v_exp_f32 v133, v133
    v_exp_f32 v117, v117
    v_exp_f32 v134, v134
    s_add_u32 s96, s84, 393216
    s_and_b32 s97, s96, 1048575
    s_lshl_b32 s98, s83, 16
    s_xor_b32 s99, s97, s98
    s_add_u32 s19, s99, s88
    s_add_u32 m0, s89, 57344
    s_nop 0
    buffer_load_dwordx4 v74, s[44:47], s19 offen lds
    v_exp_f32 v118, v118
    v_exp_f32 v135, v135
    v_exp_f32 v119, v119
    v_exp_f32 v136, v136
    v_exp_f32 v120, v120
    v_exp_f32 v137, v137
    v_exp_f32 v121, v121
    v_exp_f32 v138, v138
    v_exp_f32 v122, v122
    s_add_u32 s96, s84, 524288
    s_and_b32 s97, s96, 1048575
    s_lshl_b32 s98, s83, 16
    s_xor_b32 s99, s97, s98
    s_add_u32 s19, s99, s88
    s_add_u32 m0, s89, 65536
    s_nop 0
    buffer_load_dwordx4 v74, s[44:47], s19 offen lds
    v_exp_f32 v139, v139
    v_exp_f32 v123, v123
    v_exp_f32 v140, v140
    v_exp_f32 v124, v124
    v_exp_f32 v141, v141
    v_exp_f32 v125, v125
    v_exp_f32 v142, v142
    v_exp_f32 v126, v126
    v_exp_f32 v143, v143
    v_exp_f32 v127, v127
    s_add_u32 s96, s84, 655360
    s_and_b32 s97, s96, 1048575
    s_lshl_b32 s98, s83, 16
    s_xor_b32 s99, s97, s98
    s_add_u32 s19, s99, s88
    s_add_u32 m0, s89, 73728
    s_nop 0
    buffer_load_dwordx4 v74, s[44:47], s19 offen lds
    v_pk_add_f32 v[56:57], v[128:129], v[130:131]
    v_pk_add_f32 v[58:59], v[112:113], v[114:115]
    v_pk_add_f32 v[56:57], v[56:57], v[132:133]
    v_pk_add_f32 v[58:59], v[58:59], v[116:117]
    v_pk_add_f32 v[56:57], v[56:57], v[134:135]
    v_pk_add_f32 v[58:59], v[58:59], v[118:119]
    v_pk_add_f32 v[56:57], v[56:57], v[136:137]
    v_pk_add_f32 v[58:59], v[58:59], v[120:121]
    v_pk_add_f32 v[56:57], v[56:57], v[138:139]
    s_add_u32 s96, s84, 786432
    s_and_b32 s97, s96, 1048575
    s_lshl_b32 s98, s83, 16
    s_xor_b32 s99, s97, s98
    s_add_u32 s19, s99, s88
    s_add_u32 m0, s89, 81920
    s_nop 0
    buffer_load_dwordx4 v74, s[44:47], s19 offen lds
    v_pk_add_f32 v[58:59], v[58:59], v[122:123]
    v_pk_add_f32 v[56:57], v[56:57], v[140:141]
    v_pk_add_f32 v[58:59], v[58:59], v[124:125]
    v_pk_add_f32 v[56:57], v[56:57], v[142:143]
    v_pk_add_f32 v[58:59], v[58:59], v[126:127]
    v_add_f32 v54, v56, v57
    v_add_f32 v55, v58, v59
    v_add_f32 v52, v56, v57
    v_add_f32 v53, v58, v59
    s_nop 0
    v_permlane32_swap_b32 v52, v54
    s_add_u32 s96, s84, 917504
    s_and_b32 s97, s96, 1048575
    s_lshl_b32 s98, s83, 16
    s_xor_b32 s99, s97, s98
    s_add_u32 s19, s99, s88
    s_add_u32 m0, s89, 90112
    s_nop 0
    buffer_load_dwordx4 v74, s[44:47], s19 offen lds
    v_permlane32_swap_b32 v53, v55
    v_pk_add_f32 v[52:53], v[52:53], v[54:55]
    v_rcp_f32 v52, v52
    v_rcp_f32 v53, v53
    s_nop 0
    v_pk_mul_f32 v[128:129], v[128:129], v[52:53] op_sel_hi:[1,0]
    v_pk_mul_f32 v[112:113], v[112:113], v[52:53] op_sel:[0,1]
    v_pk_mul_f32 v[130:131], v[130:131], v[52:53] op_sel_hi:[1,0]
    v_pk_mul_f32 v[114:115], v[114:115], v[52:53] op_sel:[0,1]
    v_pk_mul_f32 v[132:133], v[132:133], v[52:53] op_sel_hi:[1,0]
    s_branch SCHK_18
SPOLL_17:
    s_load_dwordx2 s[24:25], s[32:33], s92 offset:512 glc
SCHK_18:
    s_add_u32 s5, s5, 1
    s_cmp_ge_u32 s5, 300000
    s_waitcnt lgkmcnt(0)
    s_cbranch_scc1 SDONE_19
    s_cmp_lg_u32 s24, s4
    s_cbranch_scc1 SPOLL_17
    s_cmp_lg_u32 s25, s4
    s_cbranch_scc1 SPOLL_17
SDONE_19:
    s_barrier
    s_add_u32 s18, s13, 8192
    buffer_load_dwordx4 v[144:147], v22, s[32:35], s13 offen sc1
    buffer_load_dwordx4 v[148:151], v22, s[32:35], s18 offen sc1
    buffer_load_dwordx4 v[160:163], v2, s[32:35], s16 offen sc1
    s_lshl_b32 s96, s3, 5
    s_add_u32 s14, s96, 8192
    v_and_b32 v6, 3, v1
    v_lshl_add_u32 v6, v6, 3, s14
    v_lshrrev_b32 v9, 5, v1
    v_lshl_add_u32 v6, v9, 2, v6
    s_lshl_b32 s14, s3, 10
    v_and_b32 v5, 15, v1
    v_lshl_add_u32 v5, v5, 4, s14
    v_lshrrev_b32 v9, 5, v1
    v_lshl_add_u32 v5, v9, 9, v5
    v_bfe_u32 v9, v1, 4, 1
    v_lshl_add_u32 v5, v9, 3, v5
    s_lshl_b32 s96, s76, 7
    s_add_u32 s14, s96, 8192
    v_lshrrev_b32 v7, 5, v1
    v_lshl_add_u32 v7, v7, 4, s14
    s_lshl_b32 s14, s76, 12
    v_add_u32 v20, s14, v2
    v_pk_mul_f32 v[116:117], v[116:117], v[52:53] op_sel:[0,1]
    v_pk_mul_f32 v[134:135], v[134:135], v[52:53] op_sel_hi:[1,0]
    v_pk_mul_f32 v[118:119], v[118:119], v[52:53] op_sel:[0,1]
    v_pk_mul_f32 v[136:137], v[136:137], v[52:53] op_sel_hi:[1,0]
    v_pk_mul_f32 v[120:121], v[120:121], v[52:53] op_sel:[0,1]
    v_pk_mul_f32 v[138:139], v[138:139], v[52:53] op_sel_hi:[1,0]
    v_pk_mul_f32 v[122:123], v[122:123], v[52:53] op_sel:[0,1]
    v_pk_mul_f32 v[140:141], v[140:141], v[52:53] op_sel_hi:[1,0]
    v_pk_mul_f32 v[124:125], v[124:125], v[52:53] op_sel:[0,1]
    v_pk_mul_f32 v[142:143], v[142:143], v[52:53] op_sel_hi:[1,0]
    v_pk_mul_f32 v[126:127], v[126:127], v[52:53] op_sel:[0,1]
    v_cvt_pk_bf16_f32 v80, v128, v129
    v_cvt_pk_bf16_f32 v88, v112, v113
    v_cvt_pk_bf16_f32 v81, v130, v131
    v_cvt_pk_bf16_f32 v89, v114, v115
    v_cvt_pk_bf16_f32 v82, v132, v133
    v_cvt_pk_bf16_f32 v90, v116, v117
    v_cvt_pk_bf16_f32 v83, v134, v135
    v_cvt_pk_bf16_f32 v91, v118, v119
    v_cvt_pk_bf16_f32 v84, v136, v137
    v_cvt_pk_bf16_f32 v92, v120, v121
    v_cvt_pk_bf16_f32 v85, v138, v139
    v_cvt_pk_bf16_f32 v93, v122, v123
    v_cvt_pk_bf16_f32 v86, v140, v141
    v_cvt_pk_bf16_f32 v94, v124, v125
    v_cvt_pk_bf16_f32 v87, v142, v143
    v_cvt_pk_bf16_f32 v95, v126, v127
    s_waitcnt vmcnt(1)
    v_cmp_eq_u32 vcc, s4, v67
    s_nop 0
    s_cmp_eq_u32 vcc_lo, 0
    s_cselect_b32 s93, 1, 0
    v_pk_add_f32 v[144:145], v[144:145], v[148:149]
    v_pk_add_f32 v[146:147], v[146:147], v[150:151]
    s_nop 1
    v_permlane32_swap_b32 v144, v146
    v_permlane32_swap_b32 v145, v147
    v_pk_add_f32 v[144:145], v[144:145], v[146:147]
    s_nop 1
    v_add_f32_dpp v144, v144, v144 row_ror:8 row_mask:0xf bank_mask:0xf
    v_add_f32_dpp v145, v145, v145 row_ror:8 row_mask:0xf bank_mask:0xf
    v_mov_b32 v146, v144
    v_mov_b32 v147, v145
    s_nop 0
    v_permlane16_swap_b32 v144, v146
    v_permlane16_swap_b32 v145, v147
    v_pk_add_f32 v[144:145], v[144:145], v[146:147]
    v_cvt_pk_bf16_f32 v144, v144, v145
    v_mov_b32 v145, s4
    s_mov_b32 exec_lo, 0xff
    s_mov_b32 exec_hi, 0xff
    s_cmp_lg_u32 s93, 0
    s_cbranch_scc1 LOC_20
    buffer_store_dwordx2 v[144:145], v76, s[32:35], s15 offen sc1
    s_branch LOCD_21
LOC_20:
    buffer_store_dwordx2 v[144:145], v76, s[32:35], s15 offen
LOCD_21:
    s_mov_b64 exec, -1
    v_mov_b32 v224, v144
    v_mov_b32 v225, v145
    v_add_u32 v226, s15, v76
    s_cbranch_scc1 L_PC2
    s_barrier
    s_cmp_lg_u32 s3, 0
    s_cbranch_scc1 L_PC2
    v_mov_b32 v21, s4
    s_mov_b32 exec_hi, 0
    s_mov_b32 exec_lo, 65535
    buffer_store_dword v21, v75, s[32:35], s17 offen sc1
    s_mov_b64 exec, -1
L_PC2:
    s_lshl3_add_u32 s96, s11, s3
    s_lshl_b32 s97, s96, 11
    s_add_u32 s13, s97, 29360128
    s_waitcnt vmcnt(0)
    v_permlane32_swap_b32 v160, v162
    v_permlane32_swap_b32 v161, v163
    v_pk_add_f32 v[160:161], v[160:161], v[162:163]
    s_nop 1
    v_add_f32_dpp v160, v160, v160 row_ror:4 row_mask:0xf bank_mask:0xf
    v_add_f32_dpp v161, v161, v161 row_ror:4 row_mask:0xf bank_mask:0xf
    s_nop 0
    v_add_f32_dpp v160, v160, v160 row_ror:8 row_mask:0xf bank_mask:0xf
    v_add_f32_dpp v161, v161, v161 row_ror:8 row_mask:0xf bank_mask:0xf
    v_mov_b32 v162, v160
    v_mov_b32 v163, v161
    s_nop 0
    v_permlane16_swap_b32 v160, v162
    v_permlane16_swap_b32 v161, v163
    v_pk_add_f32 v[160:161], v[160:161], v[162:163]
    v_cvt_pk_bf16_f32 v160, v160, v161
    ds_write_b32 v6, v160
    s_cmp_lg_u32 s93, 0
    s_cbranch_scc1 L_C2L
SPOLL_22:
    s_load_dwordx2 s[24:25], s[32:33], s92 offset:3584 glc
SCHK_23:
    s_add_u32 s5, s5, 1
    s_cmp_ge_u32 s5, 300000
    s_waitcnt lgkmcnt(0)
    s_cbranch_scc1 SDONE_24
    s_cmp_lg_u32 s24, s4
    s_cbranch_scc1 SPOLL_22
    s_cmp_lg_u32 s25, s4
    s_cbranch_scc1 SPOLL_22
SDONE_24:
L_C2L:
    buffer_load_dwordx4 v[152:155], v2, s[32:35], s13 offen sc1
    buffer_load_dwordx4 v[156:159], v2, s[32:35], s13 offen offset:1024 sc1
    s_waitcnt vmcnt(0)
    v_bitop3_b32 v4, v153, v155, s4 bitop3:0x7e
    v_bitop3_b32 v4, v4, v157, s4 bitop3:0xf6
    v_bitop3_b32 v4, v4, v159, s4 bitop3:0xf6
    v_cmp_ne_u32 vcc, 0, v4
    s_cbranch_vccz TOK_26
POLL_27:
    buffer_load_dwordx4 v[152:155], v2, s[32:35], s13 offen sc1
    buffer_load_dwordx4 v[156:159], v2, s[32:35], s13 offen offset:1024 sc1
    s_waitcnt vmcnt(0)
    v_bitop3_b32 v4, v153, v155, s4 bitop3:0x7e
    v_bitop3_b32 v4, v4, v157, s4 bitop3:0xf6
    v_bitop3_b32 v4, v4, v159, s4 bitop3:0xf6
    v_cmp_ne_u32 vcc, 0, v4
    s_cbranch_vccz PDONE_28
    s_add_u32 s5, s5, 1
    s_cmp_lt_u32 s5, 300000
    s_cbranch_scc1 POLL_27
PDONE_28:
TOK_26:
    ds_write2_b32 v5, v152, v154 offset0:0 offset1:1
    ds_write2_b32 v5, v156, v158 offset0:64 offset1:65
    s_waitcnt lgkmcnt(0)
    s_barrier
    ds_read_b128 v[160:163], v7
    ds_read_b128 v[164:167], v7 offset:32
    ds_read_b128 v[168:171], v7 offset:64
    ds_read_b128 v[172:175], v7 offset:96
    ds_read_b128 v[144:147], v20
    ds_read_b128 v[148:151], v20 offset:1024
    ds_read_b128 v[152:155], v20 offset:2048
    ds_read_b128 v[156:159], v20 offset:3072
    s_add_u32 s96, s84, 1048576
    s_and_b32 s97, s96, 1048575
    s_lshl_b32 s98, s83, 16
    s_xor_b32 s99, s97, s98
    s_xor_b32 s96, s88, 1048576
    s_add_u32 s19, s99, s96
    s_add_u32 m0, s89, 98304
    s_nop 0
    buffer_load_dwordx4 v74, s[44:47], s19 offen lds
    s_add_u32 s96, s84, 1703936
    s_and_b32 s97, s96, 1048575
    s_lshl_b32 s98, s83, 16
    s_xor_b32 s99, s97, s98
    s_xor_b32 s96, s88, 1048576
    s_add_u32 s19, s99, s96
    s_add_u32 m0, s89, 139264
    s_nop 0
    buffer_load_dwordx4 v74, s[44:47], s19 offen lds
    s_add_u32 s96, s84, 1835008
    s_and_b32 s97, s96, 1048575
    s_lshl_b32 s98, s83, 16
    s_xor_b32 s99, s97, s98
    s_xor_b32 s96, s88, 1048576
    s_add_u32 s19, s99, s96
    s_add_u32 m0, s89, 147456
    s_nop 0
    buffer_load_dwordx4 v74, s[44:47], s19 offen lds
    s_and_b32 s96, s3, 3
    s_lshl2_add_u32 s97, s10, s96
    s_lshl4_add_u32 s98, s97, s11
    s_lshl1_add_u32 s99, s98, s76
    s_lshl_b32 s96, s99, 11
    s_add_u32 s13, s96, 8388608
    v_and_b32 v8, 15, v1
    v_lshlrev_b32 v8, 4, v8
    v_bfe_u32 v9, v1, 4, 1
    v_lshl_add_u32 v8, v9, 10, v8
    v_lshrrev_b32 v9, 5, v1
    v_lshl_add_u32 v8, v9, 8, v8
    s_waitcnt lgkmcnt(7)
    v_mfma_f32_32x32x16_bf16 v[128:143], v[160:163], v[80:83], 0
    s_waitcnt lgkmcnt(6)
    v_mfma_f32_32x32x16_bf16 v[128:143], v[164:167], v[84:87], v[128:143]
    s_waitcnt lgkmcnt(5)
    v_mfma_f32_32x32x16_bf16 v[128:143], v[168:171], v[88:91], v[128:143]
    s_waitcnt lgkmcnt(4)
    v_mfma_f32_32x32x16_bf16 v[128:143], v[172:175], v[92:95], v[128:143]
    s_waitcnt lgkmcnt(3)
    v_mfma_f32_32x32x16_bf16 v[112:127], v[144:147], v[80:83], 0
    s_waitcnt lgkmcnt(2)
    v_mfma_f32_32x32x16_bf16 v[112:127], v[148:151], v[84:87], v[112:127]
    s_waitcnt lgkmcnt(1)
    v_mfma_f32_32x32x16_bf16 v[112:127], v[152:155], v[88:91], v[112:127]
    s_waitcnt lgkmcnt(0)
    v_mfma_f32_32x32x16_bf16 v[112:127], v[156:159], v[92:95], v[112:127]
    s_nop 3
    v_cvt_pk_bf16_f32 v128, 0, v128
    v_add_f32 v128, 0x358637bd, v128
    v_cvt_pk_bf16_f32 v128, 0, v128
    v_rcp_f32 v128, v128
    s_nop 3
    v_cvt_pk_bf16_f32 v112, 0, v112
    v_cvt_pk_bf16_f32 v113, 0, v113
    v_cvt_pk_bf16_f32 v114, 0, v114
    v_cvt_pk_bf16_f32 v115, 0, v115
    v_cvt_pk_bf16_f32 v116, 0, v116
    v_cvt_pk_bf16_f32 v117, 0, v117
    v_cvt_pk_bf16_f32 v118, 0, v118
    v_cvt_pk_bf16_f32 v119, 0, v119
    v_pk_mul_f32 v[112:113], v[112:113], v[128:129] op_sel_hi:[1,0]
    v_pk_mul_f32 v[114:115], v[114:115], v[128:129] op_sel_hi:[1,0]
    v_pk_mul_f32 v[116:117], v[116:117], v[128:129] op_sel_hi:[1,0]
    v_pk_mul_f32 v[118:119], v[118:119], v[128:129] op_sel_hi:[1,0]
    v_cvt_pk_bf16_f32 v44, v112, v113
    v_cvt_pk_bf16_f32 v45, v114, v115
    v_cvt_pk_bf16_f32 v46, v116, v117
    v_cvt_pk_bf16_f32 v47, v118, v119
    buffer_store_dwordx4 v[44:47], v8, s[32:35], s13 offen sc1
    v_cvt_pk_bf16_f32 v120, 0, v120
    v_cvt_pk_bf16_f32 v121, 0, v121
    v_cvt_pk_bf16_f32 v122, 0, v122
    v_cvt_pk_bf16_f32 v123, 0, v123
    v_cvt_pk_bf16_f32 v124, 0, v124
    v_cvt_pk_bf16_f32 v125, 0, v125
    v_cvt_pk_bf16_f32 v126, 0, v126
    v_cvt_pk_bf16_f32 v127, 0, v127
    v_pk_mul_f32 v[120:121], v[120:121], v[128:129] op_sel_hi:[1,0]
    v_pk_mul_f32 v[122:123], v[122:123], v[128:129] op_sel_hi:[1,0]
    v_pk_mul_f32 v[124:125], v[124:125], v[128:129] op_sel_hi:[1,0]
    v_pk_mul_f32 v[126:127], v[126:127], v[128:129] op_sel_hi:[1,0]
    v_cvt_pk_bf16_f32 v48, v120, v121
    v_cvt_pk_bf16_f32 v49, v122, v123
    v_cvt_pk_bf16_f32 v50, v124, v125
    v_cvt_pk_bf16_f32 v51, v126, v127
    buffer_store_dwordx4 v[48:51], v8, s[32:35], s13 offen offset:512 sc1
    s_mul_i32 s96, s76, 65600
    s_add_u32 s17, s96, 32768
    v_lshrrev_b32 v20, 5, v1
    v_lshlrev_b32 v20, 11, v20
    v_bfe_u32 v9, v1, 4, 1
    v_lshl_add_u32 v20, v9, 9, v20
    v_bfe_u32 v9, v1, 2, 2
    v_lshl_add_u32 v20, v9, 7, v20
    v_bfe_u32 v9, v1, 3, 1
    v_lshl_add_u32 v20, v9, 6, v20
    v_bfe_u32 v9, v1, 1, 1
    v_lshl_add_u32 v20, v9, 5, v20
    v_bfe_u32 v9, v1, 4, 1
    v_lshl_add_u32 v20, v9, 4, v20
    v_and_b32 v9, 1, v1
    v_lshl_add_u32 v20, v9, 3, v20
    v_xor_b32 v20, s17, v20
    v_xor_b32 v21, 16, v20
    v_xor_b32 v22, 64, v20
    v_xor_b32 v23, 80, v20
    v_and_b32 v5, 7, v1
    v_lshlrev_b32 v5, 15, v5
    v_bfe_u32 v9, v1, 3, 1
    v_lshl_add_u32 v5, v9, 12, v5
    s_lshr_b32 s96, s11, 2
    s_xor_b32 s97, s96, 1
    s_and_b32 s98, s97, 1
    s_lshr_b32 s99, s10, 2
    s_and_b32 s96, s10, 3
    s_lshl_b32 s97, s96, 6
    s_lshl1_add_u32 s96, s99, s97
    s_lshl_b32 s99, s96, 12
    s_lshr_b32 s97, s11, 3
    s_and_b32 s96, s11, 3
    s_lshl2_add_u32 s97, s97, s96
    s_lshl_b32 s96, s97, 6
    s_add_u32 s97, s99, s96
    s_lshl2_add_u32 s99, s98, s97
    s_add_u32 s96, s99, 1048576
    s_add_u32 s15, s96, 1024
    v_mov_b32 v52, 0x10000
    v_mov_b32 v53, s6
    v_lshlrev_b32 v28, 16, v12
    v_and_b32 v29, s6, v12
    v_lshlrev_b32 v30, 16, v13
    v_and_b32 v31, s6, v13
    v_lshlrev_b32 v32, 16, v14
    v_and_b32 v33, s6, v14
    v_lshlrev_b32 v34, 16, v15
    v_and_b32 v35, s6, v15
    v_lshlrev_b32 v36, 16, v16
    v_and_b32 v37, s6, v16
    v_lshlrev_b32 v38, 16, v17
    v_and_b32 v39, s6, v17
    v_lshlrev_b32 v40, 16, v18
    v_and_b32 v41, s6, v18
    v_lshlrev_b32 v42, 16, v19
    v_and_b32 v43, s6, v19
    v_mul_u32_u24_dpp v76, v64, v52 row_newbcast:0 row_mask:0xf bank_mask:0xf
    v_and_b32_dpp v77, v64, v53 row_newbcast:0 row_mask:0xf bank_mask:0xf
    v_mul_u32_u24_dpp v78, v64, v52 row_newbcast:1 row_mask:0xf bank_mask:0xf
    v_and_b32_dpp v79, v64, v53 row_newbcast:1 row_mask:0xf bank_mask:0xf
    v_mul_u32_u24_dpp v80, v64, v52 row_newbcast:2 row_mask:0xf bank_mask:0xf
    v_and_b32_dpp v81, v64, v53 row_newbcast:2 row_mask:0xf bank_mask:0xf
    v_mul_u32_u24_dpp v82, v64, v52 row_newbcast:3 row_mask:0xf bank_mask:0xf
    v_and_b32_dpp v83, v64, v53 row_newbcast:3 row_mask:0xf bank_mask:0xf
    v_mul_u32_u24_dpp v84, v64, v52 row_newbcast:4 row_mask:0xf bank_mask:0xf
    v_and_b32_dpp v85, v64, v53 row_newbcast:4 row_mask:0xf bank_mask:0xf
    v_mul_u32_u24_dpp v86, v64, v52 row_newbcast:5 row_mask:0xf bank_mask:0xf
    v_and_b32_dpp v87, v64, v53 row_newbcast:5 row_mask:0xf bank_mask:0xf
    v_mul_u32_u24_dpp v88, v64, v52 row_newbcast:6 row_mask:0xf bank_mask:0xf
    v_and_b32_dpp v89, v64, v53 row_newbcast:6 row_mask:0xf bank_mask:0xf
    v_mul_u32_u24_dpp v90, v64, v52 row_newbcast:7 row_mask:0xf bank_mask:0xf
    v_and_b32_dpp v91, v64, v53 row_newbcast:7 row_mask:0xf bank_mask:0xf
    s_lshl1_add_u32 s96, s94, s77
    s_lshl_b32 s97, s96, 15
    s_add_u32 s19, s97, 8388608
    v_and_b32 v25, 15, v1
    v_lshlrev_b32 v25, 3, v25
    s_waitcnt vmcnt(0)
    s_waitcnt lgkmcnt(0)
    s_barrier
    s_cmp_lg_u32 s3, 0
    s_cbranch_scc1 L_PD
    v_mov_b32 v6, s4
    s_mov_b32 exec_hi, 0
    s_mov_b32 exec_lo, 65535
    buffer_store_dword v6, v5, s[32:35], s15 offen sc1
    s_mov_b64 exec, -1
L_PD:
    s_add_u32 s96, s84, 1966080
    s_and_b32 s97, s96, 1048575
    s_lshl_b32 s98, s83, 16
    s_xor_b32 s99, s97, s98
    s_xor_b32 s96, s88, 1048576
    s_add_u32 s13, s99, s96
    s_add_u32 m0, s89, 155648
    s_nop 0
    buffer_load_dwordx4 v74, s[44:47], s13 offen lds
    s_and_b32 s96, s84, 1048575
    s_lshl_b32 s97, s83, 16
    s_xor_b32 s98, s96, s97
    s_add_u32 s13, s98, s88
    s_add_u32 m0, s89, 32768
    s_nop 0
    buffer_load_dwordx4 v74, s[44:47], s13 offen lds
    s_add_u32 s96, s84, 131072
    s_and_b32 s97, s96, 1048575
    s_lshl_b32 s98, s83, 16
    s_xor_b32 s99, s97, s98
    s_add_u32 s13, s99, s88
    s_add_u32 m0, s89, 40960
    s_nop 0
    buffer_load_dwordx4 v74, s[44:47], s13 offen lds
    s_load_dwordx2 s[24:25], s[32:33], s92 offset:1024 glc
    v_mov_b32_dpp v92, v65 row_newbcast:0 row_mask:0xf bank_mask:0xf
    v_mov_b32_dpp v93, v65 row_newbcast:1 row_mask:0xf bank_mask:0xf
    v_mov_b32_dpp v94, v65 row_newbcast:2 row_mask:0xf bank_mask:0xf
    v_mov_b32_dpp v95, v65 row_newbcast:3 row_mask:0xf bank_mask:0xf
    v_mov_b32_dpp v96, v65 row_newbcast:4 row_mask:0xf bank_mask:0xf
    v_mov_b32_dpp v97, v65 row_newbcast:5 row_mask:0xf bank_mask:0xf
    v_mov_b32_dpp v98, v65 row_newbcast:6 row_mask:0xf bank_mask:0xf
    v_mov_b32_dpp v99, v65 row_newbcast:7 row_mask:0xf bank_mask:0xf
    v_mov_b32_dpp v100, v66 row_newbcast:0 row_mask:0xf bank_mask:0xf
    v_mov_b32_dpp v101, v66 row_newbcast:1 row_mask:0xf bank_mask:0xf
    v_mov_b32_dpp v102, v66 row_newbcast:2 row_mask:0xf bank_mask:0xf
    v_mov_b32_dpp v103, v66 row_newbcast:3 row_mask:0xf bank_mask:0xf
    v_mov_b32_dpp v104, v66 row_newbcast:4 row_mask:0xf bank_mask:0xf
    v_mov_b32_dpp v105, v66 row_newbcast:5 row_mask:0xf bank_mask:0xf
    v_mov_b32_dpp v106, v66 row_newbcast:6 row_mask:0xf bank_mask:0xf
    v_mov_b32_dpp v107, v66 row_newbcast:7 row_mask:0xf bank_mask:0xf
    v_and_b32 v4, 3, v1
    v_cmp_eq_u32 vcc, 1, v4
    v_cmp_eq_u32 s[22:23], 0, v4
    v_mov_b32 v5, 0x3f803f80
    v_cndmask_b32 v92, v100, v92, vcc
    v_cndmask_b32 v93, v101, v93, vcc
    v_cndmask_b32 v94, v102, v94, vcc
    v_cndmask_b32 v95, v103, v95, vcc
    v_cndmask_b32 v96, v104, v96, vcc
    v_cndmask_b32 v97, v105, v97, vcc
    v_cndmask_b32 v98, v106, v98, vcc
    v_cndmask_b32 v99, v107, v99, vcc
    v_cndmask_b32 v92, v92, v5, s[22:23]
    v_cndmask_b32 v93, v93, v5, s[22:23]
    v_cndmask_b32 v94, v94, v5, s[22:23]
    v_cndmask_b32 v95, v95, v5, s[22:23]
    v_cndmask_b32 v96, v96, v5, s[22:23]
    v_cndmask_b32 v97, v97, v5, s[22:23]
    v_cndmask_b32 v98, v98, v5, s[22:23]
    v_cndmask_b32 v99, v99, v5, s[22:23]
    s_waitcnt vmcnt(0)
    s_branch SCHK_30
SPOLL_29:
    s_load_dwordx2 s[24:25], s[32:33], s92 offset:1024 glc
SCHK_30:
    s_add_u32 s5, s5, 1
    s_cmp_ge_u32 s5, 300000
    s_waitcnt lgkmcnt(0)
    s_cbranch_scc1 SDONE_31
    s_cmp_lg_u32 s24, s4
    s_cbranch_scc1 SPOLL_29
SDONE_31:
    s_barrier
    s_cmp_lt_u32 s3, 4
    s_cbranch_scc1 L_P2
    s_setprio 1
L_P2:
    s_lshl_b32 s96, s21, 7
    s_add_u32 s18, s96, 65536
    s_lshl_b32 s96, s83, 11
    s_add_u32 s20, s96, s19
    buffer_load_dwordx4 v[140:143], v2, s[32:35], s20 offen sc1
    buffer_load_dwordx4 v[144:147], v2, s[32:35], s20 offen offset:1024 sc1
    ds_read_b64_tr_b16 v[228:229], v22
    ds_read_b64_tr_b16 v[230:231], v22 offset:1024
    ds_read_b64_tr_b16 v[232:233], v23
    ds_read_b64_tr_b16 v[234:235], v23 offset:1024
    ds_read_b64_tr_b16 v[236:237], v20
    ds_read_b64_tr_b16 v[238:239], v20 offset:1024
    ds_read_b64_tr_b16 v[240:241], v21
    ds_read_b64_tr_b16 v[242:243], v21 offset:1024
    s_xor_b32 s96, s83, 1
    s_lshl_b32 s97, s96, 11
    s_add_u32 s20, s97, s19
    buffer_load_dwordx4 v[148:151], v2, s[32:35], s20 offen sc1
    buffer_load_dwordx4 v[152:155], v2, s[32:35], s20 offen offset:1024 sc1
    s_xor_b32 s96, s83, 2
    s_lshl_b32 s97, s96, 11
    s_add_u32 s20, s97, s19
    buffer_load_dwordx4 v[156:159], v2, s[32:35], s20 offen sc1
    buffer_load_dwordx4 v[160:163], v2, s[32:35], s20 offen offset:1024 sc1
    s_waitcnt lgkmcnt(6)
    s_waitcnt vmcnt(5)
    v_mfma_f32_16x16x32_bf16 v[124:127], v[228:231], v[140:143], 0
    ds_read_b64_tr_b16 v[244:245], v22 offset:4096
    s_waitcnt vmcnt(4)
    v_mfma_f32_16x16x32_bf16 v[128:131], v[228:231], v[144:147], 0
    ds_read_b64_tr_b16 v[246:247], v22 offset:5120
    s_xor_b32 s96, s83, 3
    s_lshl_b32 s97, s96, 11
    s_add_u32 s20, s97, s19
    buffer_load_dwordx4 v[164:167], v2, s[32:35], s20 offen sc1
    s_waitcnt lgkmcnt(6)
    v_mfma_f32_16x16x32_bf16 v[132:135], v[232:235], v[140:143], 0
    ds_read_b64_tr_b16 v[228:229], v23 offset:4096
    v_mfma_f32_16x16x32_bf16 v[136:139], v[232:235], v[144:147], 0
    ds_read_b64_tr_b16 v[230:231], v23 offset:5120
    buffer_load_dwordx4 v[168:171], v2, s[32:35], s20 offen offset:1024 sc1
    s_waitcnt lgkmcnt(6)
    v_mfma_f32_16x16x32_bf16 v[108:111], v[236:239], v[140:143], 0
    ds_read_b64_tr_b16 v[232:233], v20 offset:4096
    v_mfma_f32_16x16x32_bf16 v[112:115], v[236:239], v[144:147], 0
    ds_read_b64_tr_b16 v[234:235], v20 offset:5120
    s_waitcnt lgkmcnt(6)
    v_mfma_f32_16x16x32_bf16 v[116:119], v[240:243], v[140:143], 0
    ds_read_b64_tr_b16 v[236:237], v21 offset:4096
    v_mfma_f32_16x16x32_bf16 v[120:123], v[240:243], v[144:147], 0
    ds_read_b64_tr_b16 v[238:239], v21 offset:5120
    s_waitcnt lgkmcnt(6)
    s_waitcnt vmcnt(4)
    v_mfma_f32_16x16x32_bf16 v[124:127], v[244:247], v[148:151], v[124:127]
    ds_read_b64_tr_b16 v[240:241], v22 offset:8192
    v_mfma_f32_16x16x32_bf16 v[128:131], v[244:247], v[152:155], v[128:131]
    ds_read_b64_tr_b16 v[242:243], v22 offset:9216
    s_xor_b32 s96, s83, 4
    s_lshl_b32 s97, s96, 11
    s_add_u32 s20, s97, s19
    buffer_load_dwordx4 v[140:143], v2, s[32:35], s20 offen sc1
    s_waitcnt lgkmcnt(6)
    v_mfma_f32_16x16x32_bf16 v[132:135], v[228:231], v[148:151], v[132:135]
    ds_read_b64_tr_b16 v[244:245], v23 offset:8192
    v_mfma_f32_16x16x32_bf16 v[136:139], v[228:231], v[152:155], v[136:139]
    ds_read_b64_tr_b16 v[246:247], v23 offset:9216
    buffer_load_dwordx4 v[144:147], v2, s[32:35], s20 offen offset:1024 sc1
    s_waitcnt lgkmcnt(6)
    v_mfma_f32_16x16x32_bf16 v[108:111], v[232:235], v[148:151], v[108:111]
    ds_read_b64_tr_b16 v[228:229], v20 offset:8192
    v_mfma_f32_16x16x32_bf16 v[112:115], v[232:235], v[152:155], v[112:115]
    ds_read_b64_tr_b16 v[230:231], v20 offset:9216
    s_waitcnt lgkmcnt(6)
    v_mfma_f32_16x16x32_bf16 v[116:119], v[236:239], v[148:151], v[116:119]
    ds_read_b64_tr_b16 v[232:233], v21 offset:8192
    v_mfma_f32_16x16x32_bf16 v[120:123], v[236:239], v[152:155], v[120:123]
    ds_read_b64_tr_b16 v[234:235], v21 offset:9216
    s_waitcnt lgkmcnt(6)
    s_waitcnt vmcnt(4)
    v_mfma_f32_16x16x32_bf16 v[124:127], v[240:243], v[156:159], v[124:127]
    ds_read_b64_tr_b16 v[236:237], v22 offset:12288
    v_mfma_f32_16x16x32_bf16 v[128:131], v[240:243], v[160:163], v[128:131]
    ds_read_b64_tr_b16 v[238:239], v22 offset:13312
    s_xor_b32 s96, s83, 5
    s_lshl_b32 s97, s96, 11
    s_add_u32 s20, s97, s19
    buffer_load_dwordx4 v[148:151], v2, s[32:35], s20 offen sc1
    s_waitcnt lgkmcnt(6)
    v_mfma_f32_16x16x32_bf16 v[132:135], v[244:247], v[156:159], v[132:135]
    ds_read_b64_tr_b16 v[240:241], v23 offset:12288
    v_mfma_f32_16x16x32_bf16 v[136:139], v[244:247], v[160:163], v[136:139]
    ds_read_b64_tr_b16 v[242:243], v23 offset:13312
    buffer_load_dwordx4 v[152:155], v2, s[32:35], s20 offen offset:1024 sc1
    s_waitcnt lgkmcnt(6)
    v_mfma_f32_16x16x32_bf16 v[108:111], v[228:231], v[156:159], v[108:111]
    ds_read_b64_tr_b16 v[244:245], v20 offset:12288
    v_mfma_f32_16x16x32_bf16 v[112:115], v[228:231], v[160:163], v[112:115]
    ds_read_b64_tr_b16 v[246:247], v20 offset:13312
    s_waitcnt lgkmcnt(6)
    v_mfma_f32_16x16x32_bf16 v[116:119], v[232:235], v[156:159], v[116:119]
    ds_read_b64_tr_b16 v[228:229], v21 offset:12288
    v_mfma_f32_16x16x32_bf16 v[120:123], v[232:235], v[160:163], v[120:123]
    ds_read_b64_tr_b16 v[230:231], v21 offset:13312
    s_waitcnt lgkmcnt(6)
    s_waitcnt vmcnt(4)
    v_mfma_f32_16x16x32_bf16 v[124:127], v[236:239], v[164:167], v[124:127]
    ds_read_b64_tr_b16 v[232:233], v22 offset:16384
    v_mfma_f32_16x16x32_bf16 v[128:131], v[236:239], v[168:171], v[128:131]
    ds_read_b64_tr_b16 v[234:235], v22 offset:17408
    s_xor_b32 s96, s83, 6
    s_lshl_b32 s97, s96, 11
    s_add_u32 s20, s97, s19
    buffer_load_dwordx4 v[156:159], v2, s[32:35], s20 offen sc1
    s_waitcnt lgkmcnt(6)
    v_mfma_f32_16x16x32_bf16 v[132:135], v[240:243], v[164:167], v[132:135]
    ds_read_b64_tr_b16 v[236:237], v23 offset:16384
    v_mfma_f32_16x16x32_bf16 v[136:139], v[240:243], v[168:171], v[136:139]
    ds_read_b64_tr_b16 v[238:239], v23 offset:17408
    buffer_load_dwordx4 v[160:163], v2, s[32:35], s20 offen offset:1024 sc1
    s_waitcnt lgkmcnt(6)
    v_mfma_f32_16x16x32_bf16 v[108:111], v[244:247], v[164:167], v[108:111]
    ds_read_b64_tr_b16 v[240:241], v20 offset:16384
    v_mfma_f32_16x16x32_bf16 v[112:115], v[244:247], v[168:171], v[112:115]
    ds_read_b64_tr_b16 v[242:243], v20 offset:17408
    s_waitcnt lgkmcnt(6)
    v_mfma_f32_16x16x32_bf16 v[116:119], v[228:231], v[164:167], v[116:119]
    ds_read_b64_tr_b16 v[244:245], v21 offset:16384
    v_mfma_f32_16x16x32_bf16 v[120:123], v[228:231], v[168:171], v[120:123]
    ds_read_b64_tr_b16 v[246:247], v21 offset:17408
    s_waitcnt lgkmcnt(6)
    s_waitcnt vmcnt(4)
    v_mfma_f32_16x16x32_bf16 v[124:127], v[232:235], v[140:143], v[124:127]
    ds_read_b64_tr_b16 v[228:229], v22 offset:20480
    v_mfma_f32_16x16x32_bf16 v[128:131], v[232:235], v[144:147], v[128:131]
    ds_read_b64_tr_b16 v[230:231], v22 offset:21504
    s_xor_b32 s96, s83, 7
    s_lshl_b32 s97, s96, 11
    s_add_u32 s20, s97, s19
    buffer_load_dwordx4 v[164:167], v2, s[32:35], s20 offen sc1
    s_waitcnt lgkmcnt(6)
    v_mfma_f32_16x16x32_bf16 v[132:135], v[236:239], v[140:143], v[132:135]
    ds_read_b64_tr_b16 v[232:233], v23 offset:20480
    v_mfma_f32_16x16x32_bf16 v[136:139], v[236:239], v[144:147], v[136:139]
    ds_read_b64_tr_b16 v[234:235], v23 offset:21504
    buffer_load_dwordx4 v[168:171], v2, s[32:35], s20 offen offset:1024 sc1
    s_waitcnt lgkmcnt(6)
    v_mfma_f32_16x16x32_bf16 v[108:111], v[240:243], v[140:143], v[108:111]
    ds_read_b64_tr_b16 v[236:237], v20 offset:20480
    v_mfma_f32_16x16x32_bf16 v[112:115], v[240:243], v[144:147], v[112:115]
    ds_read_b64_tr_b16 v[238:239], v20 offset:21504
    s_setprio 0
    s_waitcnt lgkmcnt(6)
    v_mfma_f32_16x16x32_bf16 v[116:119], v[244:247], v[140:143], v[116:119]
    ds_read_b64_tr_b16 v[240:241], v21 offset:20480
    v_mfma_f32_16x16x32_bf16 v[120:123], v[244:247], v[144:147], v[120:123]
    ds_read_b64_tr_b16 v[242:243], v21 offset:21504
    s_waitcnt lgkmcnt(6)
    s_waitcnt vmcnt(4)
    v_mfma_f32_16x16x32_bf16 v[124:127], v[228:231], v[148:151], v[124:127]
    ds_read_b64_tr_b16 v[244:245], v22 offset:24576
    v_mfma_f32_16x16x32_bf16 v[128:131], v[228:231], v[152:155], v[128:131]
    ds_read_b64_tr_b16 v[246:247], v22 offset:25600
    s_cmp_eq_u32 s25, s4
    s_cbranch_scc1 L_D2
SPOLL_32:
    s_load_dwordx2 s[24:25], s[32:33], s92 offset:1024 glc
SCHK_33:
    s_add_u32 s5, s5, 1
    s_cmp_ge_u32 s5, 300000
    s_waitcnt lgkmcnt(0)
    s_cbranch_scc1 SDONE_34
    s_cmp_lg_u32 s25, s4
    s_cbranch_scc1 SPOLL_32
SDONE_34:
L_D2:
    s_barrier
    s_xor_b32 s96, s83, 8
    s_lshl_b32 s97, s96, 11
    s_add_u32 s20, s97, s19
    buffer_load_dwordx4 v[140:143], v2, s[32:35], s20 offen sc1
    s_waitcnt lgkmcnt(6)
    v_mfma_f32_16x16x32_bf16 v[132:135], v[232:235], v[148:151], v[132:135]
    ds_read_b64_tr_b16 v[228:229], v23 offset:24576
    v_mfma_f32_16x16x32_bf16 v[136:139], v[232:235], v[152:155], v[136:139]
    ds_read_b64_tr_b16 v[230:231], v23 offset:25600
    buffer_load_dwordx4 v[144:147], v2, s[32:35], s20 offen offset:1024 sc1
    s_waitcnt lgkmcnt(6)
    v_mfma_f32_16x16x32_bf16 v[108:111], v[236:239], v[148:151], v[108:111]
    ds_read_b64_tr_b16 v[232:233], v20 offset:24576
    v_mfma_f32_16x16x32_bf16 v[112:115], v[236:239], v[152:155], v[112:115]
    ds_read_b64_tr_b16 v[234:235], v20 offset:25600
    s_waitcnt lgkmcnt(6)
    v_mfma_f32_16x16x32_bf16 v[116:119], v[240:243], v[148:151], v[116:119]
    ds_read_b64_tr_b16 v[236:237], v21 offset:24576
    v_mfma_f32_16x16x32_bf16 v[120:123], v[240:243], v[152:155], v[120:123]
    ds_read_b64_tr_b16 v[238:239], v21 offset:25600
    s_waitcnt lgkmcnt(6)
    s_waitcnt vmcnt(4)
    v_mfma_f32_16x16x32_bf16 v[124:127], v[244:247], v[156:159], v[124:127]
    ds_read_b64_tr_b16 v[240:241], v22 offset:28672
    v_mfma_f32_16x16x32_bf16 v[128:131], v[244:247], v[160:163], v[128:131]
    ds_read_b64_tr_b16 v[242:243], v22 offset:29696
    s_xor_b32 s96, s83, 9
    s_lshl_b32 s97, s96, 11
    s_add_u32 s20, s97, s19
    buffer_load_dwordx4 v[148:151], v2, s[32:35], s20 offen sc1
    s_waitcnt lgkmcnt(6)
    v_mfma_f32_16x16x32_bf16 v[132:135], v[228:231], v[156:159], v[132:135]
    ds_read_b64_tr_b16 v[244:245], v23 offset:28672
    v_mfma_f32_16x16x32_bf16 v[136:139], v[228:231], v[160:163], v[136:139]
    ds_read_b64_tr_b16 v[246:247], v23 offset:29696
    buffer_load_dwordx4 v[152:155], v2, s[32:35], s20 offen offset:1024 sc1
    s_waitcnt lgkmcnt(6)
    v_mfma_f32_16x16x32_bf16 v[108:111], v[232:235], v[156:159], v[108:111]
    ds_read_b64_tr_b16 v[228:229], v20 offset:28672
    v_mfma_f32_16x16x32_bf16 v[112:115], v[232:235], v[160:163], v[112:115]
    ds_read_b64_tr_b16 v[230:231], v20 offset:29696
    s_waitcnt lgkmcnt(6)
    v_mfma_f32_16x16x32_bf16 v[116:119], v[236:239], v[156:159], v[116:119]
    ds_read_b64_tr_b16 v[232:233], v21 offset:28672
    v_mfma_f32_16x16x32_bf16 v[120:123], v[236:239], v[160:163], v[120:123]
    ds_read_b64_tr_b16 v[234:235], v21 offset:29696
    s_waitcnt lgkmcnt(6)
    s_waitcnt vmcnt(4)
    v_mfma_f32_16x16x32_bf16 v[124:127], v[240:243], v[164:167], v[124:127]
    ds_read_b64_tr_b16 v[236:237], v22 offset:32768
    v_mfma_f32_16x16x32_bf16 v[128:131], v[240:243], v[168:171], v[128:131]
    ds_read_b64_tr_b16 v[238:239], v22 offset:33792
    s_xor_b32 s96, s83, 10
    s_lshl_b32 s97, s96, 11
    s_add_u32 s20, s97, s19
    buffer_load_dwordx4 v[156:159], v2, s[32:35], s20 offen sc1
    s_waitcnt lgkmcnt(6)
    v_mfma_f32_16x16x32_bf16 v[132:135], v[244:247], v[164:167], v[132:135]
    ds_read_b64_tr_b16 v[240:241], v23 offset:32768
    v_mfma_f32_16x16x32_bf16 v[136:139], v[244:247], v[168:171], v[136:139]
    ds_read_b64_tr_b16 v[242:243], v23 offset:33792
    buffer_load_dwordx4 v[160:163], v2, s[32:35], s20 offen offset:1024 sc1
    s_waitcnt lgkmcnt(6)
    v_mfma_f32_16x16x32_bf16 v[108:111], v[228:231], v[164:167], v[108:111]
    ds_read_b64_tr_b16 v[244:245], v20 offset:32768
    v_mfma_f32_16x16x32_bf16 v[112:115], v[228:231], v[168:171], v[112:115]
    ds_read_b64_tr_b16 v[246:247], v20 offset:33792
    s_waitcnt lgkmcnt(6)
    v_mfma_f32_16x16x32_bf16 v[116:119], v[232:235], v[164:167], v[116:119]
    ds_read_b64_tr_b16 v[228:229], v21 offset:32768
    v_mfma_f32_16x16x32_bf16 v[120:123], v[232:235], v[168:171], v[120:123]
    ds_read_b64_tr_b16 v[230:231], v21 offset:33792
    s_waitcnt lgkmcnt(6)
    s_waitcnt vmcnt(4)
    v_mfma_f32_16x16x32_bf16 v[124:127], v[236:239], v[140:143], v[124:127]
    ds_read_b64_tr_b16 v[232:233], v22 offset:36864
    v_mfma_f32_16x16x32_bf16 v[128:131], v[236:239], v[144:147], v[128:131]
    ds_read_b64_tr_b16 v[234:235], v22 offset:37888
    s_xor_b32 s96, s83, 11
    s_lshl_b32 s97, s96, 11
    s_add_u32 s20, s97, s19
    buffer_load_dwordx4 v[164:167], v2, s[32:35], s20 offen sc1
    s_waitcnt lgkmcnt(6)
    v_mfma_f32_16x16x32_bf16 v[132:135], v[240:243], v[140:143], v[132:135]
    ds_read_b64_tr_b16 v[236:237], v23 offset:36864
    v_mfma_f32_16x16x32_bf16 v[136:139], v[240:243], v[144:147], v[136:139]
    ds_read_b64_tr_b16 v[238:239], v23 offset:37888
    buffer_load_dwordx4 v[168:171], v2, s[32:35], s20 offen offset:1024 sc1
    s_waitcnt lgkmcnt(6)
    v_mfma_f32_16x16x32_bf16 v[108:111], v[244:247], v[140:143], v[108:111]
    ds_read_b64_tr_b16 v[240:241], v20 offset:36864
    v_mfma_f32_16x16x32_bf16 v[112:115], v[244:247], v[144:147], v[112:115]
    ds_read_b64_tr_b16 v[242:243], v20 offset:37888
    s_waitcnt lgkmcnt(6)
    v_mfma_f32_16x16x32_bf16 v[116:119], v[228:231], v[140:143], v[116:119]
    ds_read_b64_tr_b16 v[244:245], v21 offset:36864
    v_mfma_f32_16x16x32_bf16 v[120:123], v[228:231], v[144:147], v[120:123]
    ds_read_b64_tr_b16 v[246:247], v21 offset:37888
    s_waitcnt lgkmcnt(6)
    s_waitcnt vmcnt(4)
    v_mfma_f32_16x16x32_bf16 v[124:127], v[232:235], v[148:151], v[124:127]
    ds_read_b64_tr_b16 v[228:229], v22 offset:40960
    v_mfma_f32_16x16x32_bf16 v[128:131], v[232:235], v[152:155], v[128:131]
    ds_read_b64_tr_b16 v[230:231], v22 offset:41984
    s_xor_b32 s96, s83, 12
    s_lshl_b32 s97, s96, 11
    s_add_u32 s20, s97, s19
    buffer_load_dwordx4 v[140:143], v2, s[32:35], s20 offen sc1
    s_waitcnt lgkmcnt(6)
    v_mfma_f32_16x16x32_bf16 v[132:135], v[236:239], v[148:151], v[132:135]
    ds_read_b64_tr_b16 v[232:233], v23 offset:40960
    v_mfma_f32_16x16x32_bf16 v[136:139], v[236:239], v[152:155], v[136:139]
    ds_read_b64_tr_b16 v[234:235], v23 offset:41984
    buffer_load_dwordx4 v[144:147], v2, s[32:35], s20 offen offset:1024 sc1
    s_waitcnt lgkmcnt(6)
    v_mfma_f32_16x16x32_bf16 v[108:111], v[240:243], v[148:151], v[108:111]
    ds_read_b64_tr_b16 v[236:237], v20 offset:40960
    v_mfma_f32_16x16x32_bf16 v[112:115], v[240:243], v[152:155], v[112:115]
    ds_read_b64_tr_b16 v[238:239], v20 offset:41984
    s_waitcnt lgkmcnt(6)
    v_mfma_f32_16x16x32_bf16 v[116:119], v[244:247], v[148:151], v[116:119]
    ds_read_b64_tr_b16 v[240:241], v21 offset:40960
    v_mfma_f32_16x16x32_bf16 v[120:123], v[244:247], v[152:155], v[120:123]
    ds_read_b64_tr_b16 v[242:243], v21 offset:41984
    s_waitcnt lgkmcnt(6)
    s_waitcnt vmcnt(4)
    v_mfma_f32_16x16x32_bf16 v[124:127], v[228:231], v[156:159], v[124:127]
    ds_read_b64_tr_b16 v[244:245], v22 offset:45056
    v_mfma_f32_16x16x32_bf16 v[128:131], v[228:231], v[160:163], v[128:131]
    ds_read_b64_tr_b16 v[246:247], v22 offset:46080
    s_xor_b32 s96, s83, 13
    s_lshl_b32 s97, s96, 11
    s_add_u32 s20, s97, s19
    buffer_load_dwordx4 v[148:151], v2, s[32:35], s20 offen sc1
    s_waitcnt lgkmcnt(6)
    v_mfma_f32_16x16x32_bf16 v[132:135], v[232:235], v[156:159], v[132:135]
    ds_read_b64_tr_b16 v[228:229], v23 offset:45056
    v_mfma_f32_16x16x32_bf16 v[136:139], v[232:235], v[160:163], v[136:139]
    ds_read_b64_tr_b16 v[230:231], v23 offset:46080
    buffer_load_dwordx4 v[152:155], v2, s[32:35], s20 offen offset:1024 sc1
    s_waitcnt lgkmcnt(6)
    v_mfma_f32_16x16x32_bf16 v[108:111], v[236:239], v[156:159], v[108:111]
    ds_read_b64_tr_b16 v[232:233], v20 offset:45056
    v_mfma_f32_16x16x32_bf16 v[112:115], v[236:239], v[160:163], v[112:115]
    ds_read_b64_tr_b16 v[234:235], v20 offset:46080
    s_waitcnt lgkmcnt(6)
    v_mfma_f32_16x16x32_bf16 v[116:119], v[240:243], v[156:159], v[116:119]
    ds_read_b64_tr_b16 v[236:237], v21 offset:45056
    v_mfma_f32_16x16x32_bf16 v[120:123], v[240:243], v[160:163], v[120:123]
    ds_read_b64_tr_b16 v[238:239], v21 offset:46080
    s_waitcnt lgkmcnt(6)
    s_waitcnt vmcnt(4)
    v_mfma_f32_16x16x32_bf16 v[124:127], v[244:247], v[164:167], v[124:127]
    ds_read_b64_tr_b16 v[240:241], v22 offset:49152
    v_mfma_f32_16x16x32_bf16 v[128:131], v[244:247], v[168:171], v[128:131]
    ds_read_b64_tr_b16 v[242:243], v22 offset:50176
    s_xor_b32 s96, s83, 14
    s_lshl_b32 s97, s96, 11
    s_add_u32 s20, s97, s19
    buffer_load_dwordx4 v[156:159], v2, s[32:35], s20 offen sc1
    s_waitcnt lgkmcnt(6)
    v_mfma_f32_16x16x32_bf16 v[132:135], v[228:231], v[164:167], v[132:135]
    ds_read_b64_tr_b16 v[244:245], v23 offset:49152
    v_mfma_f32_16x16x32_bf16 v[136:139], v[228:231], v[168:171], v[136:139]
    ds_read_b64_tr_b16 v[246:247], v23 offset:50176
    buffer_load_dwordx4 v[160:163], v2, s[32:35], s20 offen offset:1024 sc1
    s_waitcnt lgkmcnt(6)
    v_mfma_f32_16x16x32_bf16 v[108:111], v[232:235], v[164:167], v[108:111]
    ds_read_b64_tr_b16 v[228:229], v20 offset:49152
    v_mfma_f32_16x16x32_bf16 v[112:115], v[232:235], v[168:171], v[112:115]
    ds_read_b64_tr_b16 v[230:231], v20 offset:50176
    s_waitcnt lgkmcnt(6)
    v_mfma_f32_16x16x32_bf16 v[116:119], v[236:239], v[164:167], v[116:119]
    ds_read_b64_tr_b16 v[232:233], v21 offset:49152
    v_mfma_f32_16x16x32_bf16 v[120:123], v[236:239], v[168:171], v[120:123]
    ds_read_b64_tr_b16 v[234:235], v21 offset:50176
    s_waitcnt lgkmcnt(6)
    s_waitcnt vmcnt(4)
    v_mfma_f32_16x16x32_bf16 v[124:127], v[240:243], v[140:143], v[124:127]
    ds_read_b64_tr_b16 v[236:237], v22 offset:53248
    v_mfma_f32_16x16x32_bf16 v[128:131], v[240:243], v[144:147], v[128:131]
    ds_read_b64_tr_b16 v[238:239], v22 offset:54272
    s_xor_b32 s96, s83, 15
    s_lshl_b32 s97, s96, 11
    s_add_u32 s20, s97, s19
    buffer_load_dwordx4 v[164:167], v2, s[32:35], s20 offen sc1
    s_waitcnt lgkmcnt(6)
    v_mfma_f32_16x16x32_bf16 v[132:135], v[244:247], v[140:143], v[132:135]
    ds_read_b64_tr_b16 v[240:241], v23 offset:53248
    v_mfma_f32_16x16x32_bf16 v[136:139], v[244:247], v[144:147], v[136:139]
    ds_read_b64_tr_b16 v[242:243], v23 offset:54272
    buffer_load_dwordx4 v[168:171], v2, s[32:35], s20 offen offset:1024 sc1
    buffer_load_dwordx2 v[26:27], v25, s[32:35], s18 offen sc1
    s_waitcnt lgkmcnt(6)
    v_mfma_f32_16x16x32_bf16 v[108:111], v[228:231], v[140:143], v[108:111]
    ds_read_b64_tr_b16 v[244:245], v20 offset:53248
    v_mfma_f32_16x16x32_bf16 v[112:115], v[228:231], v[144:147], v[112:115]
    ds_read_b64_tr_b16 v[246:247], v20 offset:54272
    s_waitcnt lgkmcnt(6)
    v_mfma_f32_16x16x32_bf16 v[116:119], v[232:235], v[140:143], v[116:119]
    ds_read_b64_tr_b16 v[228:229], v21 offset:53248
    v_mfma_f32_16x16x32_bf16 v[120:123], v[232:235], v[144:147], v[120:123]
    ds_read_b64_tr_b16 v[230:231], v21 offset:54272
    s_waitcnt lgkmcnt(6)
    s_waitcnt vmcnt(5)
    v_mfma_f32_16x16x32_bf16 v[124:127], v[236:239], v[148:151], v[124:127]
    ds_read_b64_tr_b16 v[232:233], v22 offset:57344
    v_mfma_f32_16x16x32_bf16 v[128:131], v[236:239], v[152:155], v[128:131]
    ds_read_b64_tr_b16 v[234:235], v22 offset:58368
    s_waitcnt lgkmcnt(6)
    v_mfma_f32_16x16x32_bf16 v[132:135], v[240:243], v[148:151], v[132:135]
    ds_read_b64_tr_b16 v[236:237], v23 offset:57344
    v_mfma_f32_16x16x32_bf16 v[136:139], v[240:243], v[152:155], v[136:139]
    ds_read_b64_tr_b16 v[238:239], v23 offset:58368
    s_waitcnt lgkmcnt(6)
    v_mfma_f32_16x16x32_bf16 v[108:111], v[244:247], v[148:151], v[108:111]
    ds_read_b64_tr_b16 v[240:241], v20 offset:57344
    v_mfma_f32_16x16x32_bf16 v[112:115], v[244:247], v[152:155], v[112:115]
    ds_read_b64_tr_b16 v[242:243], v20 offset:58368
    s_waitcnt lgkmcnt(6)
    v_mfma_f32_16x16x32_bf16 v[116:119], v[228:231], v[148:151], v[116:119]
    ds_read_b64_tr_b16 v[244:245], v21 offset:57344
    v_mfma_f32_16x16x32_bf16 v[120:123], v[228:231], v[152:155], v[120:123]
    ds_read_b64_tr_b16 v[246:247], v21 offset:58368
    s_waitcnt lgkmcnt(6)
    s_waitcnt vmcnt(3)
    v_mfma_f32_16x16x32_bf16 v[124:127], v[232:235], v[156:159], v[124:127]
    ds_read_b64_tr_b16 v[228:229], v22 offset:61440
    v_mfma_f32_16x16x32_bf16 v[128:131], v[232:235], v[160:163], v[128:131]
    ds_read_b64_tr_b16 v[230:231], v22 offset:62464
    s_waitcnt lgkmcnt(6)
    v_mfma_f32_16x16x32_bf16 v[132:135], v[236:239], v[156:159], v[132:135]
    ds_read_b64_tr_b16 v[232:233], v23 offset:61440
    v_mfma_f32_16x16x32_bf16 v[136:139], v[236:239], v[160:163], v[136:139]
    ds_read_b64_tr_b16 v[234:235], v23 offset:62464
    s_waitcnt lgkmcnt(6)
    v_mfma_f32_16x16x32_bf16 v[108:111], v[240:243], v[156:159], v[108:111]
    ds_read_b64_tr_b16 v[236:237], v20 offset:61440
    v_mfma_f32_16x16x32_bf16 v[112:115], v[240:243], v[160:163], v[112:115]
    ds_read_b64_tr_b16 v[238:239], v20 offset:62464
    s_waitcnt lgkmcnt(6)
    v_mfma_f32_16x16x32_bf16 v[116:119], v[244:247], v[156:159], v[116:119]
    ds_read_b64_tr_b16 v[240:241], v21 offset:61440
    v_mfma_f32_16x16x32_bf16 v[120:123], v[244:247], v[160:163], v[120:123]
    ds_read_b64_tr_b16 v[242:243], v21 offset:62464
    s_waitcnt lgkmcnt(6)
    s_waitcnt vmcnt(1)
    v_mfma_f32_16x16x32_bf16 v[124:127], v[228:231], v[164:167], v[124:127]
    v_mfma_f32_16x16x32_bf16 v[128:131], v[228:231], v[168:171], v[128:131]
    s_waitcnt lgkmcnt(4)
    v_mfma_f32_16x16x32_bf16 v[132:135], v[232:235], v[164:167], v[132:135]
    v_mfma_f32_16x16x32_bf16 v[136:139], v[232:235], v[168:171], v[136:139]
    s_waitcnt lgkmcnt(2)
    v_mfma_f32_16x16x32_bf16 v[108:111], v[236:239], v[164:167], v[108:111]
    v_mfma_f32_16x16x32_bf16 v[112:115], v[236:239], v[168:171], v[112:115]
    s_waitcnt lgkmcnt(0)
    v_mfma_f32_16x16x32_bf16 v[116:119], v[240:243], v[164:167], v[116:119]
    v_mfma_f32_16x16x32_bf16 v[120:123], v[240:243], v[168:171], v[120:123]
    s_setprio 0
    s_lshl_b32 s13, s3, 12
    v_add_u32 v4, s13, v2
    ds_write_b128 v4, v[124:127]
    ds_write_b128 v4, v[128:131] offset:1024
    ds_write_b128 v4, v[132:135] offset:2048
    ds_write_b128 v4, v[136:139] offset:3072
    v_permlane16_swap_b32 v108, v112
    v_permlane16_swap_b32 v109, v113
    v_permlane16_swap_b32 v110, v114
    v_permlane16_swap_b32 v111, v115
    v_permlane16_swap_b32 v116, v120
    v_permlane16_swap_b32 v117, v121
    v_permlane16_swap_b32 v118, v122
    v_permlane16_swap_b32 v119, v123
    s_xor_b32 s96, s3, 4
    s_lshl_b32 s13, s96, 12
    v_and_b32 v5, 15, v1
    v_lshl_add_u32 v5, v5, 4, s13
    v_bfe_u32 v9, v1, 4, 1
    v_lshl_add_u32 v5, v9, 10, v5
    v_lshrrev_b32 v9, 5, v1
    v_lshl_add_u32 v5, v9, 9, v5
    s_lshl_b32 s96, s76, 11
    s_and_b32 s97, s3, 3
    s_lshl_b32 s98, s97, 9
    s_add_u32 s99, s96, s98
    s_add_u32 s13, s99, 131072
    v_and_b32 v6, 31, v1
    v_lshl_add_u32 v6, v6, 4, s13
    v_lshrrev_b32 v9, 5, v1
    v_lshl_add_u32 v6, v9, 3, v6
    s_lshl_b32 s96, s76, 6
    s_add_u32 s13, s96, 139008
    v_and_b32 v7, 7, v1
    v_lshl_add_u32 v7, v7, 2, s13
    v_lshrrev_b32 v9, 5, v1
    v_lshl_add_u32 v7, v9, 5, v7
    s_lshl_b32 s96, s21, 15
    s_lshl_b32 s97, s3, 8
    s_add_u32 s98, s96, s97
    s_add_u32 s19, s98, 12582912
    v_and_b32 v44, 15, v1
    v_lshlrev_b32 v44, 4, v44
    v_lshrrev_b32 v9, 4, v1
    v_lshl_add_u32 v44, v9, 11, v44
    v_mov_b32 v232, 0x3f803f80
    s_waitcnt lgkmcnt(0)
    s_barrier
    ds_read_b128 v[124:127], v5
    ds_read_b128 v[128:131], v5 offset:256
    ds_read_b128 v[132:135], v5 offset:2048
    ds_read_b128 v[136:139], v5 offset:2304
    s_add_u32 s14, s80, 114688
    s_lshl2_add_u32 m0, s89, 67584
    s_nop 0
    buffer_load_dwordx4 v72, s[56:59], s14 offen nt lds
    s_add_u32 s14, s80, 172032
    s_lshl2_add_u32 m0, s89, 68608
    s_nop 0
    buffer_load_dwordx4 v72, s[56:59], s14 offen nt lds
    s_mov_b32 s14, s81
    s_lshl2_add_u32 m0, s89, 98304
    s_nop 0
    buffer_load_dwordx4 v73, s[60:63], s14 offen nt lds
    s_waitcnt lgkmcnt(3)
    v_pk_add_f32 v[108:109], v[108:109], v[124:125]
    v_pk_add_f32 v[110:111], v[110:111], v[126:127]
    s_waitcnt lgkmcnt(2)
    v_pk_add_f32 v[112:113], v[112:113], v[128:129]
    v_pk_add_f32 v[114:115], v[114:115], v[130:131]
    v_cvt_pk_bf16_f32 v108, 0, v108
    v_cvt_pk_bf16_f32 v109, 0, v109
    v_cvt_pk_bf16_f32 v110, 0, v110
    v_cvt_pk_bf16_f32 v111, 0, v111
    v_cvt_pk_bf16_f32 v112, 0, v112
    v_cvt_pk_bf16_f32 v113, 0, v113
    v_cvt_pk_bf16_f32 v114, 0, v114
    v_cvt_pk_bf16_f32 v115, 0, v115
    v_pk_mul_f32 v[108:109], v[108:109], v[76:77]
    v_pk_mul_f32 v[110:111], v[110:111], v[78:79]
    v_pk_mul_f32 v[112:113], v[112:113], v[80:81]
    v_pk_mul_f32 v[114:115], v[114:115], v[82:83]
    v_cvt_pk_bf16_f32 v108, 0, v108
    v_cvt_pk_bf16_f32 v109, 0, v109
    v_cvt_pk_bf16_f32 v110, 0, v110
    v_cvt_pk_bf16_f32 v111, 0, v111
    v_cvt_pk_bf16_f32 v112, 0, v112
    v_cvt_pk_bf16_f32 v113, 0, v113
    v_cvt_pk_bf16_f32 v114, 0, v114
    v_cvt_pk_bf16_f32 v115, 0, v115
    v_pk_add_f32 v[108:109], v[108:109], v[28:29]
    v_pk_add_f32 v[110:111], v[110:111], v[30:31]
    v_pk_add_f32 v[112:113], v[112:113], v[32:33]
    v_pk_add_f32 v[114:115], v[114:115], v[34:35]
    v_cvt_pk_bf16_f32 v12, v108, v109
    v_cvt_pk_bf16_f32 v13, v110, v111
    v_cvt_pk_bf16_f32 v14, v112, v113
    v_cvt_pk_bf16_f32 v15, v114, v115
    s_waitcnt lgkmcnt(1)
    v_pk_add_f32 v[116:117], v[116:117], v[132:133]
    v_pk_add_f32 v[118:119], v[118:119], v[134:135]
    s_waitcnt lgkmcnt(0)
    v_pk_add_f32 v[120:121], v[120:121], v[136:137]
    v_pk_add_f32 v[122:123], v[122:123], v[138:139]
    v_cvt_pk_bf16_f32 v116, 0, v116
    v_cvt_pk_bf16_f32 v117, 0, v117
    v_cvt_pk_bf16_f32 v118, 0, v118
    v_cvt_pk_bf16_f32 v119, 0, v119
    v_cvt_pk_bf16_f32 v120, 0, v120
    v_cvt_pk_bf16_f32 v121, 0, v121
    v_cvt_pk_bf16_f32 v122, 0, v122
    v_cvt_pk_bf16_f32 v123, 0, v123
    v_pk_mul_f32 v[116:117], v[116:117], v[84:85]
    v_pk_mul_f32 v[118:119], v[118:119], v[86:87]
    v_pk_mul_f32 v[120:121], v[120:121], v[88:89]
    v_pk_mul_f32 v[122:123], v[122:123], v[90:91]
    v_cvt_pk_bf16_f32 v116, 0, v116
    v_cvt_pk_bf16_f32 v117, 0, v117
    v_cvt_pk_bf16_f32 v118, 0, v118
    v_cvt_pk_bf16_f32 v119, 0, v119
    v_cvt_pk_bf16_f32 v120, 0, v120
    v_cvt_pk_bf16_f32 v121, 0, v121
    v_cvt_pk_bf16_f32 v122, 0, v122
    v_cvt_pk_bf16_f32 v123, 0, v123
    v_pk_add_f32 v[116:117], v[116:117], v[36:37]
    v_pk_add_f32 v[118:119], v[118:119], v[38:39]
    v_pk_add_f32 v[120:121], v[120:121], v[40:41]
    v_pk_add_f32 v[122:123], v[122:123], v[42:43]
    v_cvt_pk_bf16_f32 v16, v116, v117
    v_cvt_pk_bf16_f32 v17, v118, v119
    v_cvt_pk_bf16_f32 v18, v120, v121
    v_cvt_pk_bf16_f32 v19, v122, v123
    v_mfma_f32_32x32x16_bf16 v[124:139], v[92:95], v[12:15], 0
    s_nop 0
    v_mfma_f32_32x32x16_bf16 v[124:139], v[96:99], v[16:19], v[124:139]
    v_dot2_f32_bf16 v228, v12, v12, 0
    v_dot2_f32_bf16 v229, v13, v13, 0
    v_dot2_f32_bf16 v228, v14, v14, v228
    v_dot2_f32_bf16 v229, v15, v15, v229
    v_dot2_f32_bf16 v228, v16, v16, v228
    v_dot2_f32_bf16 v229, v17, v17, v229
    v_dot2_f32_bf16 v228, v18, v18, v228
    v_dot2_f32_bf16 v229, v19, v19, v229
    s_nop 2
    v_add_f32 v230, v228, v229
    v_add_f32 v228, v228, v229
    s_nop 1
    v_permlane32_swap_b32 v228, v230
    s_mov_b32 exec_lo, 0
    v_add_f32 v124, v228, v230
    v_mov_b32 v125, v126
    s_mov_b32 exec_lo, -1
    ds_write_b64 v6, v[124:125]
    ds_write_b32 v7, v68
    ds_write_b32 v7, v69 offset:128
    ds_write_b32 v7, v70 offset:256
    ds_write_b32 v7, v71 offset:384
    v_add_u32 v4, 131072, v2
    v_and_b32 v5, 7, v1
    v_lshlrev_b32 v5, 15, v5
    v_bfe_u32 v9, v1, 3, 1
    v_lshl_add_u32 v5, v9, 12, v5
    s_lshl4_add_u32 s96, s21, s12
    s_lshl_b32 s97, s96, 11
    s_add_u32 s13, s97, 12582912
    s_and_b32 s96, s12, 1
    s_lshr_b32 s97, s21, 2
    s_and_b32 s98, s21, 3
    s_lshl_b32 s99, s98, 6
    s_lshl1_add_u32 s98, s97, s99
    s_lshl_b32 s97, s98, 12
    s_lshr_b32 s99, s12, 1
    s_lshl_b32 s98, s99, 6
    s_add_u32 s99, s97, s98
    s_lshl2_add_u32 s97, s96, s99
    s_add_u32 s98, s97, 1048576
    s_add_u32 s16, s98, 1536
    s_waitcnt lgkmcnt(0)
    s_barrier
    s_cmp_lg_u32 s3, 0
    s_cbranch_scc1 L_PE
    s_setprio 3
    ds_read_b128 v[124:127], v4 offset:0
    ds_read_b128 v[128:131], v4 offset:2048
    ds_read_b128 v[132:135], v4 offset:1024
    ds_read_b128 v[136:139], v4 offset:3072
    s_waitcnt lgkmcnt(2)
    v_pk_add_f32 v[124:125], v[124:125], v[128:129]
    v_pk_add_f32 v[126:127], v[126:127], v[130:131]
    v_add_f32 v125, v125, v127
    v_mov_b32 v127, s4
    s_waitcnt lgkmcnt(0)
    v_pk_add_f32 v[132:133], v[132:133], v[136:137]
    v_pk_add_f32 v[134:135], v[134:135], v[138:139]
    v_add_f32 v133, v133, v135
    v_mov_b32 v135, s4
    buffer_store_dwordx4 v[124:127], v2, s[32:35], s13 offen sc1
    buffer_store_dwordx4 v[132:135], v2, s[32:35], s13 offen offset:1024 sc1
    s_mov_b64 exec, 0xffff
    buffer_store_dword v127, v5, s[32:35], s16 offen sc1
    s_setprio 0
    s_mov_b64 exec, -1
L_PE:
    s_load_dwordx2 s[24:25], s[32:33], s92 offset:1536 glc
    s_and_b32 s96, s3, 3
    s_mul_i32 s97, s96, 4608
    s_lshl_b32 s98, s76, 6
    s_add_u32 s16, s97, s98
    v_and_b32 v23, 31, v1
    v_mul_u32_u24 v23, 144, v23
    v_lshrrev_b32 v9, 5, v1
    v_lshl_add_u32 v23, v9, 5, v23
    v_add_u32 v23, s16, v23
    ds_write_b128 v23, v[12:15]
    ds_write_b128 v23, v[16:19] offset:16
    v_add_u32 v23, 139776, v23
    s_lshl3_add_u32 s96, s21, s3
    s_lshl_b32 s97, s96, 5
    s_sub_u32 s15, 4094, s97
    v_and_b32 v22, 15, v1
    v_lshlrev_b32 v22, 1, v22
    v_sub_u32 v22, s15, v22
    s_lshl_b32 s96, s3, 7
    s_add_u32 s15, s96, 135168
    v_and_b32 v8, 15, v1
    v_lshl_add_u32 v8, v8, 3, s15
    s_and_b32 s96, s3, 3
    s_lshl_b32 s97, s96, 8
    s_add_u32 s15, s97, 135168
    v_and_b32 v10, 31, v1
    v_lshl_add_u32 v10, v10, 3, s15
    v_and_b32 v11, 7, v1
    v_lshlrev_b32 v11, 3, v11
    v_add_u32 v11, 136192, v11
    s_waitcnt vmcnt(3)
    v_cmp_ne_u32 vcc, s4, v27
    s_cbranch_vccz TOK_38
POLL_39:
    buffer_load_dwordx2 v[26:27], v25, s[32:35], s18 offen sc1
    s_waitcnt vmcnt(0)
    v_cmp_ne_u32 vcc, s4, v27
    s_cbranch_vccz PDONE_40
    s_add_u32 s5, s5, 1
    s_cmp_lt_u32 s5, 300000
    s_cbranch_scc1 POLL_39
PDONE_40:
TOK_38:
    v_add_f32_dpp v26, v26, v26 quad_perm:[1,0,3,2] row_mask:0xf bank_mask:0xf
    s_nop 1
    v_add_f32_dpp v26, v26, v26 quad_perm:[2,3,0,1] row_mask:0xf bank_mask:0xf
    s_nop 1
    v_add_f32_dpp v26, v26, v26 row_half_mirror row_mask:0xf bank_mask:0xf
    s_nop 1
    v_add_f32_dpp v26, v26, v26 row_ror:8 row_mask:0xf bank_mask:0xf
    s_cmp_lg_u32 s3, 1
    s_cbranch_scc1 L_NOCT
    v_and_b32 v5, 15, v1
    v_lshlrev_b32 v5, 3, v5
    v_add_u32 v5, 139008, v5
    ds_read_b64 v[150:151], v5
    ds_read_b64 v[154:155], v5 offset:128
    ds_read_b64 v[156:157], v5 offset:384
    s_waitcnt lgkmcnt(0)
    v_lshlrev_b32 v148, 16, v150
    v_and_b32 v149, s6, v150
    v_lshlrev_b32 v150, 16, v151
    v_and_b32 v151, s6, v151
    v_lshlrev_b32 v152, 16, v154
    v_and_b32 v153, s6, v154
    v_lshlrev_b32 v154, 16, v155
    v_and_b32 v155, s6, v155
L_NOCT:
    s_cmp_lt_u32 s3, 4
    s_cbranch_scc1 L_NOST
    s_sub_u32 s96, s3, 4
    s_lshl_b32 s97, s96, 12
    s_add_u32 s13, s97, 32768
    v_add_u32 v4, s13, v2
    v_add_u32 v7, 65536, v4
    ds_write_b128 v4, v[176:179] offset:16384
    ds_write_b128 v4, v[180:183]
    ds_write_b128 v4, v[184:187] offset:17408
    ds_write_b128 v4, v[188:191] offset:1024
    ds_write_b128 v4, v[192:195] offset:18432
    ds_write_b128 v4, v[196:199] offset:2048
    ds_write_b128 v4, v[200:203] offset:19456
    ds_write_b128 v4, v[204:207] offset:3072
    ds_write_b128 v4, v[208:211] offset:49152
    ds_write_b128 v4, v[212:215] offset:32768
    ds_write_b128 v4, v[216:219] offset:50176
    ds_write_b128 v4, v[220:223] offset:33792
L_NOST:
    s_branch SCHK_36
SPOLL_35:
    s_load_dwordx2 s[24:25], s[32:33], s92 offset:1536 glc
SCHK_36:
    s_add_u32 s5, s5, 1
    s_cmp_ge_u32 s5, 300000
    s_waitcnt lgkmcnt(0)
    s_cbranch_scc1 SDONE_37
    s_cmp_lg_u32 s24, s4
    s_cbranch_scc1 SPOLL_35
    s_cmp_lg_u32 s25, s4
    s_cbranch_scc1 SPOLL_35
SDONE_37:
    s_barrier
    s_mov_b32 s13, s19
    buffer_load_dwordx4 v[124:127], v44, s[32:35], s13 offen sc1
    s_add_u32 s13, s19, 8192
    buffer_load_dwordx4 v[128:131], v44, s[32:35], s13 offen sc1
    s_add_u32 s13, s19, 16384
    buffer_load_dwordx4 v[132:135], v44, s[32:35], s13 offen sc1
    s_add_u32 s13, s19, 24576
    buffer_load_dwordx4 v[136:139], v44, s[32:35], s13 offen sc1
    v_lshlrev_b32 v28, 16, v12
    v_and_b32 v29, s6, v12
    v_lshlrev_b32 v30, 16, v13
    v_and_b32 v31, s6, v13
    v_lshlrev_b32 v32, 16, v14
    v_and_b32 v33, s6, v14
    v_lshlrev_b32 v34, 16, v15
    v_and_b32 v35, s6, v15
    v_lshlrev_b32 v36, 16, v16
    v_and_b32 v37, s6, v16
    v_lshlrev_b32 v38, 16, v17
    v_and_b32 v39, s6, v17
    v_lshlrev_b32 v40, 16, v18
    v_and_b32 v41, s6, v18
    v_lshlrev_b32 v42, 16, v19
    v_and_b32 v43, s6, v19
    v_mul_u32_u24_dpp v92, v68, v52 row_newbcast:0 row_mask:0xf bank_mask:0xf
    v_and_b32_dpp v93, v68, v53 row_newbcast:0 row_mask:0xf bank_mask:0xf
    v_mul_u32_u24_dpp v94, v68, v52 row_newbcast:1 row_mask:0xf bank_mask:0xf
    v_and_b32_dpp v95, v68, v53 row_newbcast:1 row_mask:0xf bank_mask:0xf
    v_mul_u32_u24_dpp v96, v68, v52 row_newbcast:2 row_mask:0xf bank_mask:0xf
    v_and_b32_dpp v97, v68, v53 row_newbcast:2 row_mask:0xf bank_mask:0xf
    v_mul_u32_u24_dpp v98, v68, v52 row_newbcast:3 row_mask:0xf bank_mask:0xf
    v_and_b32_dpp v99, v68, v53 row_newbcast:3 row_mask:0xf bank_mask:0xf
    v_mul_u32_u24_dpp v100, v68, v52 row_newbcast:4 row_mask:0xf bank_mask:0xf
    v_and_b32_dpp v101, v68, v53 row_newbcast:4 row_mask:0xf bank_mask:0xf
    v_mul_u32_u24_dpp v102, v68, v52 row_newbcast:5 row_mask:0xf bank_mask:0xf
    v_and_b32_dpp v103, v68, v53 row_newbcast:5 row_mask:0xf bank_mask:0xf
    v_mul_u32_u24_dpp v104, v68, v52 row_newbcast:6 row_mask:0xf bank_mask:0xf
    v_and_b32_dpp v105, v68, v53 row_newbcast:6 row_mask:0xf bank_mask:0xf
    v_mul_u32_u24_dpp v106, v68, v52 row_newbcast:7 row_mask:0xf bank_mask:0xf
    v_and_b32_dpp v107, v68, v53 row_newbcast:7 row_mask:0xf bank_mask:0xf
    v_mul_u32_u24_dpp v108, v69, v52 row_newbcast:0 row_mask:0xf bank_mask:0xf
    v_and_b32_dpp v109, v69, v53 row_newbcast:0 row_mask:0xf bank_mask:0xf
    v_mul_u32_u24_dpp v110, v69, v52 row_newbcast:1 row_mask:0xf bank_mask:0xf
    v_and_b32_dpp v111, v69, v53 row_newbcast:1 row_mask:0xf bank_mask:0xf
    v_mul_u32_u24_dpp v112, v69, v52 row_newbcast:2 row_mask:0xf bank_mask:0xf
    v_and_b32_dpp v113, v69, v53 row_newbcast:2 row_mask:0xf bank_mask:0xf
    v_mul_u32_u24_dpp v114, v69, v52 row_newbcast:3 row_mask:0xf bank_mask:0xf
    v_and_b32_dpp v115, v69, v53 row_newbcast:3 row_mask:0xf bank_mask:0xf
    v_mul_u32_u24_dpp v116, v69, v52 row_newbcast:4 row_mask:0xf bank_mask:0xf
    v_and_b32_dpp v117, v69, v53 row_newbcast:4 row_mask:0xf bank_mask:0xf
    v_mul_u32_u24_dpp v118, v69, v52 row_newbcast:5 row_mask:0xf bank_mask:0xf
    v_and_b32_dpp v119, v69, v53 row_newbcast:5 row_mask:0xf bank_mask:0xf
    v_mul_u32_u24_dpp v120, v69, v52 row_newbcast:6 row_mask:0xf bank_mask:0xf
    v_and_b32_dpp v121, v69, v53 row_newbcast:6 row_mask:0xf bank_mask:0xf
    v_mul_u32_u24_dpp v122, v69, v52 row_newbcast:7 row_mask:0xf bank_mask:0xf
    v_and_b32_dpp v123, v69, v53 row_newbcast:7 row_mask:0xf bank_mask:0xf
    s_waitcnt vmcnt(0)
    v_bitop3_b32 v4, v127, v131, s4 bitop3:0x7e
    v_bitop3_b32 v4, v4, v135, s4 bitop3:0xf6
    v_bitop3_b32 v4, v4, v139, s4 bitop3:0xf6
    v_cmp_ne_u32 vcc, 0, v4
    s_cbranch_vccz TOK_42
POLL_43:
    s_mov_b32 s13, s19
    buffer_load_dwordx4 v[124:127], v44, s[32:35], s13 offen sc1
    s_add_u32 s13, s19, 8192
    buffer_load_dwordx4 v[128:131], v44, s[32:35], s13 offen sc1
    s_add_u32 s13, s19, 16384
    buffer_load_dwordx4 v[132:135], v44, s[32:35], s13 offen sc1
    s_add_u32 s13, s19, 24576
    buffer_load_dwordx4 v[136:139], v44, s[32:35], s13 offen sc1
    s_waitcnt vmcnt(0)
    v_bitop3_b32 v4, v127, v131, s4 bitop3:0x7e
    v_bitop3_b32 v4, v4, v135, s4 bitop3:0xf6
    v_bitop3_b32 v4, v4, v139, s4 bitop3:0xf6
    v_cmp_ne_u32 vcc, 0, v4
    s_cbranch_vccz PDONE_44
    s_add_u32 s5, s5, 1
    s_cmp_lt_u32 s5, 300000
    s_cbranch_scc1 POLL_43
PDONE_44:
TOK_42:
    s_lshl2_add_u32 s96, s74, s75
    s_lshl_b32 s97, s96, 11
    s_lshl_b32 s98, s3, 8
    s_add_u32 s99, s97, s98
    s_add_u32 s15, s99, 20971520
    v_lshlrev_b32 v44, 7, v1
    s_mov_b64 exec, 3
    buffer_load_dword v44, v44, s[32:35], s15 offen
    s_mov_b64 exec, -1
    s_add_u32 s15, s81, 4096
    s_lshl2_add_u32 m0, s89, 99328
    s_nop 0
    buffer_load_dwordx4 v73, s[60:63], s15 offen nt lds
    v_pk_add_f32 v[124:125], v[124:125], v[128:129]
    v_pk_add_f32 v[132:133], v[132:133], v[136:137]
    v_add_f32 v126, v126, v130
    v_add_f32 v134, v134, v138
    v_pk_add_f32 v[124:125], v[124:125], v[132:133]
    v_add_f32 v126, v126, v134
    v_mov_b32 v127, v125
    s_nop 0
    v_permlane32_swap_b32 v124, v126
    v_permlane32_swap_b32 v125, v127
    v_add_f32 v124, v124, v126
    v_add_f32 v125, v125, v127
    s_nop 1
    v_permlane16_swap_b32 v124, v125
    v_add_f32 v127, v124, v125
    v_add_f32 v124, v124, v125
    s_nop 1
    v_permlane16_swap_b32 v124, v127
    v_mul_f32 v126, 0x3a800000, v124
    v_mul_f32 v124, 0x3a800000, v124
    s_nop 1
    v_permlane32_swap_b32 v124, v126
    v_fma_f32 v21, -v124, v124, v126
    v_cvt_pk_bf16_f32 v20, 0, v124
    v_max_f32 v21, 0, v21
    v_cvt_pk_bf16_f32 v21, 0, v21
    v_add_f32 v21, 0x3727c5ac, v21
    v_cvt_pk_bf16_f32 v21, 0, v21
    v_sqrt_f32 v21, v21
    s_nop 0
    v_cvt_pk_bf16_f32 v21, 0, v21
    s_lshl3_add_u32 s13, s3, 136192
    v_rcp_f32 v21, v21
    v_fma_f32 v127, -v20, v26, v127
    v_mov_b32 v5, s13
    v_mul_f32 v127, v127, v21
    ds_write_b64 v8, v[20:21]
    s_movk_i32 s13, 0xfff
    v_ashrrev_i32 v124, 31, v127
    v_or_b32 v124, 0x80000000, v124
    v_xor_b32 v124, v124, v127
    v_bfi_b32 v48, s13, v22, v124
    s_nop 1
    v_min_u32_dpp v49, v48, v48 row_ror:8 row_mask:0xf bank_mask:0xf
    v_max_u32_dpp v48, v48, v48 row_ror:8 row_mask:0xf bank_mask:0xf
    s_nop 1
    v_min_u32_dpp v50, v48, v48 row_ror:4 row_mask:0xf bank_mask:0xf
    v_max_u32_dpp v49, v49, v49 row_ror:4 row_mask:0xf bank_mask:0xf
    v_max_u32_dpp v48, v48, v48 row_ror:4 row_mask:0xf bank_mask:0xf
    v_max_u32 v49, v49, v50
    s_nop 0
    v_min_u32_dpp v50, v48, v48 row_ror:2 row_mask:0xf bank_mask:0xf
    v_max_u32_dpp v49, v49, v49 row_ror:2 row_mask:0xf bank_mask:0xf
    v_max_u32_dpp v48, v48, v48 row_ror:2 row_mask:0xf bank_mask:0xf
    v_max_u32 v49, v49, v50
    s_nop 0
    v_min_u32_dpp v50, v48, v48 row_ror:1 row_mask:0xf bank_mask:0xf
    v_max_u32_dpp v49, v49, v49 row_ror:1 row_mask:0xf bank_mask:0xf
    v_max_u32_dpp v48, v48, v48 row_ror:1 row_mask:0xf bank_mask:0xf
    v_max_u32 v49, v49, v50
    ds_write_b64 v5, v[48:49]
    v_and_b32 v6, 3, v1
    v_lshlrev_b32 v6, 18, v6
    v_bfe_u32 v9, v1, 2, 2
    v_lshl_add_u32 v6, v9, 13, v6
    s_and_b32 s96, s21, 1
    s_and_b32 s97, s12, 7
    s_lshr_b32 s98, s12, 3
    s_lshl3_add_u32 s99, s97, s98
    s_lshl_b32 s97, s99, 12
    s_lshr_b32 s98, s21, 1
    s_lshl_b32 s99, s98, 6
    s_add_u32 s98, s97, s99
    s_lshl4_add_u32 s97, s96, s98
    s_add_u32 s99, s97, 1048576
    s_add_u32 s14, s99, 2560
    s_waitcnt lgkmcnt(0)
    s_barrier
    s_cmp_ge_u32 s3, 2
    s_cbranch_scc1 L_PR1
    s_setprio 3
L_PR1:
    ds_read_b64 v[48:49], v11
    ds_read_b64 v[20:21], v10
    s_waitcnt lgkmcnt(1)
    v_min_u32_dpp v50, v48, v48 quad_perm:[1,0,3,2] row_mask:0xf bank_mask:0xf
    v_max_u32_dpp v49, v49, v49 quad_perm:[1,0,3,2] row_mask:0xf bank_mask:0xf
    v_max_u32_dpp v48, v48, v48 quad_perm:[1,0,3,2] row_mask:0xf bank_mask:0xf
    v_max_u32 v49, v49, v50
    s_nop 0
    v_min_u32_dpp v50, v48, v48 quad_perm:[2,3,0,1] row_mask:0xf bank_mask:0xf
    v_max_u32_dpp v49, v49, v49 quad_perm:[2,3,0,1] row_mask:0xf bank_mask:0xf
    v_max_u32_dpp v48, v48, v48 quad_perm:[2,3,0,1] row_mask:0xf bank_mask:0xf
    v_max_u32 v49, v49, v50
    s_nop 0
    v_min_u32_dpp v50, v48, v48 row_half_mirror row_mask:0xf bank_mask:0xf
    v_max_u32_dpp v49, v49, v49 row_half_mirror row_mask:0xf bank_mask:0xf
    v_max_u32_dpp v48, v48, v48 row_half_mirror row_mask:0xf bank_mask:0xf
    v_max_u32 v49, v49, v50
    v_or_b32 v50, 1, v49
    v_mov_b32 v49, s4
    v_mov_b32 v51, s4
    s_cmp_lg_u32 s3, 0
    s_cbranch_scc1 L_NOF
    s_mov_b64 exec, 0xffff
    buffer_store_dwordx4 v[48:51], v6, s[32:35], s14 offen sc1
    s_mov_b64 exec, -1
L_NOF:
    s_cmp_lg_u32 s3, 1
    s_cbranch_scc1 L_NOC
    v_and_b32 v4, 16, v1
    v_cmp_eq_u32 vcc, 0, v4
    s_nop 1
    v_cndmask_b32 v4, v50, v48, vcc
    v_not_b32 v4, v4
    v_bfe_u32 v4, v4, 1, 7
    v_lshlrev_b32 v6, 3, v4
    v_mul_u32_u24 v4, 144, v4
    v_add_u32 v6, 135168, v6
    v_and_b32 v5, 15, v1
    v_lshlrev_b32 v5, 3, v5
    v_add_u32 v4, v4, v5
    ds_read_b64 v[128:129], v6
    ds_read_b64 v[124:125], v4 offset:0
    v_and_b32 v6, 15, v1
    v_lshlrev_b32 v6, 4, v6
    v_bfe_u32 v9, v1, 4, 1
    v_lshl_add_u32 v6, v9, 14, v6
    v_lshrrev_b32 v9, 5, v1
    v_lshl_add_u32 v6, v9, 12, v6
    v_bfe_u32 v7, v1, 4, 1
    v_lshlrev_b32 v7, 14, v7
    s_lshl_b32 s96, s21, 15
    s_lshl_b32 s97, s12, 8
    s_add_u32 s98, s96, s97
    s_add_u32 s13, s98, 33554432
    s_lshl_b32 s96, s21, 15
    s_lshl3_add_u32 s97, s12, s96
    s_add_u32 s98, s97, 8192
    s_add_u32 s16, s98, 33554432
    v_mov_b32 v127, s4
    s_waitcnt lgkmcnt(0)
    v_lshlrev_b32 v132, 16, v124
    v_and_b32 v133, s6, v124
    v_lshlrev_b32 v134, 16, v125
    v_and_b32 v135, s6, v125
    v_pk_add_f32 v[132:133], v[132:133], v[128:129] op_sel_hi:[1,0] neg_lo:[0,1] neg_hi:[0,1]
    v_pk_add_f32 v[134:135], v[134:135], v[128:129] op_sel_hi:[1,0] neg_lo:[0,1] neg_hi:[0,1]
    v_cvt_pk_bf16_f32 v132, 0, v132
    v_cvt_pk_bf16_f32 v133, 0, v133
    v_cvt_pk_bf16_f32 v134, 0, v134
    v_cvt_pk_bf16_f32 v135, 0, v135
    v_pk_mul_f32 v[132:133], v[132:133], v[128:129] op_sel:[0,1]
    v_pk_mul_f32 v[134:135], v[134:135], v[128:129] op_sel:[0,1]
    v_cvt_pk_bf16_f32 v132, 0, v132
    v_cvt_pk_bf16_f32 v133, 0, v133
    v_cvt_pk_bf16_f32 v134, 0, v134
    v_cvt_pk_bf16_f32 v135, 0, v135
    v_pk_mul_f32 v[132:133], v[132:133], v[152:153]
    v_pk_mul_f32 v[134:135], v[134:135], v[154:155]
    v_cvt_pk_bf16_f32 v132, 0, v132
    v_cvt_pk_bf16_f32 v133, 0, v133
    v_cvt_pk_bf16_f32 v134, 0, v134
    v_cvt_pk_bf16_f32 v135, 0, v135
    v_pk_add_f32 v[132:133], v[132:133], v[148:149]
    v_pk_add_f32 v[134:135], v[134:135], v[150:151]
    v_mov_b32 v126, v125
    v_mov_b32 v125, s4
    s_mov_b32 exec_hi, 0
    v_cvt_pk_bf16_f32 v124, v132, v133
    v_cvt_pk_bf16_f32 v126, v134, v135
    s_mov_b32 exec_hi, -1
    v_dot2_f32_bf16 v128, v124, v156, 0
    v_mov_b32 v129, s4
    v_dot2_f32_bf16 v128, v126, v157, v128
    buffer_store_dwordx4 v[124:127], v6, s[32:35], s13 offen sc1
    s_nop 1
    v_add_f32_dpp v128, v128, v128 quad_perm:[1,0,3,2] row_mask:0xf bank_mask:0xf
    s_nop 1
    v_add_f32_dpp v128, v128, v128 quad_perm:[2,3,0,1] row_mask:0xf bank_mask:0xf
    s_nop 1
    v_add_f32_dpp v128, v128, v128 row_half_mirror row_mask:0xf bank_mask:0xf
    s_nop 1
    v_add_f32_dpp v128, v128, v128 row_ror:8 row_mask:0xf bank_mask:0xf
    s_mov_b64 exec, 0x10001
    buffer_store_dwordx2 v[128:129], v7, s[32:35], s16 offen sc1
    s_mov_b64 exec, -1
L_NOC:
    s_waitcnt lgkmcnt(0)
    s_setprio 0
    s_mov_b32 exec_lo, 0xff
    s_mov_b32 exec_hi, 0xff
    buffer_store_dwordx2 v[224:225], v226, s[32:35], 0 offen sc1
    s_mov_b64 exec, -1
    s_add_u32 s13, s81, 8192
    s_lshl2_add_u32 m0, s89, 100352
    s_nop 0
    buffer_load_dwordx4 v73, s[60:63], s13 offen nt lds
    s_load_dwordx8 s[24:31], s[32:33], s92 offset:2560 glc
    v_pk_add_f32 v[76:77], v[28:29], v[20:21] op_sel_hi:[1,0] neg_lo:[0,1] neg_hi:[0,1]
    v_pk_add_f32 v[78:79], v[30:31], v[20:21] op_sel_hi:[1,0] neg_lo:[0,1] neg_hi:[0,1]
    v_pk_add_f32 v[80:81], v[32:33], v[20:21] op_sel_hi:[1,0] neg_lo:[0,1] neg_hi:[0,1]
    v_pk_add_f32 v[82:83], v[34:35], v[20:21] op_sel_hi:[1,0] neg_lo:[0,1] neg_hi:[0,1]
    v_pk_add_f32 v[84:85], v[36:37], v[20:21] op_sel_hi:[1,0] neg_lo:[0,1] neg_hi:[0,1]
    v_pk_add_f32 v[86:87], v[38:39], v[20:21] op_sel_hi:[1,0] neg_lo:[0,1] neg_hi:[0,1]
    v_pk_add_f32 v[88:89], v[40:41], v[20:21] op_sel_hi:[1,0] neg_lo:[0,1] neg_hi:[0,1]
    v_pk_add_f32 v[90:91], v[42:43], v[20:21] op_sel_hi:[1,0] neg_lo:[0,1] neg_hi:[0,1]
    v_cvt_pk_bf16_f32 v76, 0, v76
    v_cvt_pk_bf16_f32 v77, 0, v77
    v_cvt_pk_bf16_f32 v78, 0, v78
    v_cvt_pk_bf16_f32 v79, 0, v79
    v_cvt_pk_bf16_f32 v80, 0, v80
    v_cvt_pk_bf16_f32 v81, 0, v81
    v_cvt_pk_bf16_f32 v82, 0, v82
    v_cvt_pk_bf16_f32 v83, 0, v83
    v_cvt_pk_bf16_f32 v84, 0, v84
    v_cvt_pk_bf16_f32 v85, 0, v85
    v_cvt_pk_bf16_f32 v86, 0, v86
    v_cvt_pk_bf16_f32 v87, 0, v87
    v_cvt_pk_bf16_f32 v88, 0, v88
    v_cvt_pk_bf16_f32 v89, 0, v89
    v_cvt_pk_bf16_f32 v90, 0, v90
    v_cvt_pk_bf16_f32 v91, 0, v91
    v_pk_mul_f32 v[76:77], v[76:77], v[20:21] op_sel:[0,1]
    v_pk_mul_f32 v[78:79], v[78:79], v[20:21] op_sel:[0,1]
    v_pk_mul_f32 v[80:81], v[80:81], v[20:21] op_sel:[0,1]
    v_pk_mul_f32 v[82:83], v[82:83], v[20:21] op_sel:[0,1]
    v_pk_mul_f32 v[84:85], v[84:85], v[20:21] op_sel:[0,1]
    v_pk_mul_f32 v[86:87], v[86:87], v[20:21] op_sel:[0,1]
    v_pk_mul_f32 v[88:89], v[88:89], v[20:21] op_sel:[0,1]
    v_pk_mul_f32 v[90:91], v[90:91], v[20:21] op_sel:[0,1]
    v_cvt_pk_bf16_f32 v76, 0, v76
    v_cvt_pk_bf16_f32 v77, 0, v77
    v_cvt_pk_bf16_f32 v78, 0, v78
    v_cvt_pk_bf16_f32 v79, 0, v79
    v_cvt_pk_bf16_f32 v80, 0, v80
    v_cvt_pk_bf16_f32 v81, 0, v81
    v_cvt_pk_bf16_f32 v82, 0, v82
    v_cvt_pk_bf16_f32 v83, 0, v83
    v_cvt_pk_bf16_f32 v84, 0, v84
    v_cvt_pk_bf16_f32 v85, 0, v85
    v_cvt_pk_bf16_f32 v86, 0, v86
    v_cvt_pk_bf16_f32 v87, 0, v87
    v_cvt_pk_bf16_f32 v88, 0, v88
    v_cvt_pk_bf16_f32 v89, 0, v89
    v_cvt_pk_bf16_f32 v90, 0, v90
    v_cvt_pk_bf16_f32 v91, 0, v91
    v_pk_mul_f32 v[76:77], v[76:77], v[108:109]
    v_pk_mul_f32 v[78:79], v[78:79], v[110:111]
    v_pk_mul_f32 v[80:81], v[80:81], v[112:113]
    v_pk_mul_f32 v[82:83], v[82:83], v[114:115]
    v_pk_mul_f32 v[84:85], v[84:85], v[116:117]
    v_pk_mul_f32 v[86:87], v[86:87], v[118:119]
    v_pk_mul_f32 v[88:89], v[88:89], v[120:121]
    v_pk_mul_f32 v[90:91], v[90:91], v[122:123]
    v_cvt_pk_bf16_f32 v76, 0, v76
    v_cvt_pk_bf16_f32 v77, 0, v77
    v_cvt_pk_bf16_f32 v78, 0, v78
    v_cvt_pk_bf16_f32 v79, 0, v79
    v_cvt_pk_bf16_f32 v80, 0, v80
    v_cvt_pk_bf16_f32 v81, 0, v81
    v_cvt_pk_bf16_f32 v82, 0, v82
    v_cvt_pk_bf16_f32 v83, 0, v83
    v_cvt_pk_bf16_f32 v84, 0, v84
    v_cvt_pk_bf16_f32 v85, 0, v85
    v_cvt_pk_bf16_f32 v86, 0, v86
    v_cvt_pk_bf16_f32 v87, 0, v87
    v_cvt_pk_bf16_f32 v88, 0, v88
    v_cvt_pk_bf16_f32 v89, 0, v89
    v_cvt_pk_bf16_f32 v90, 0, v90
    v_cvt_pk_bf16_f32 v91, 0, v91
    v_pk_add_f32 v[76:77], v[76:77], v[92:93]
    v_pk_add_f32 v[78:79], v[78:79], v[94:95]
    v_pk_add_f32 v[80:81], v[80:81], v[96:97]
    v_pk_add_f32 v[82:83], v[82:83], v[98:99]
    v_pk_add_f32 v[84:85], v[84:85], v[100:101]
    v_pk_add_f32 v[86:87], v[86:87], v[102:103]
    v_pk_add_f32 v[88:89], v[88:89], v[104:105]
    v_pk_add_f32 v[90:91], v[90:91], v[106:107]
    v_cvt_pk_bf16_f32 v76, 0, v76
    v_cvt_pk_bf16_f32 v77, 0, v77
    v_cvt_pk_bf16_f32 v78, 0, v78
    v_cvt_pk_bf16_f32 v79, 0, v79
    v_cvt_pk_bf16_f32 v80, 0, v80
    v_cvt_pk_bf16_f32 v81, 0, v81
    v_cvt_pk_bf16_f32 v82, 0, v82
    v_cvt_pk_bf16_f32 v83, 0, v83
    v_cvt_pk_bf16_f32 v84, 0, v84
    v_cvt_pk_bf16_f32 v85, 0, v85
    v_cvt_pk_bf16_f32 v86, 0, v86
    v_cvt_pk_bf16_f32 v87, 0, v87
    v_cvt_pk_bf16_f32 v88, 0, v88
    v_cvt_pk_bf16_f32 v89, 0, v89
    v_cvt_pk_bf16_f32 v90, 0, v90
    v_cvt_pk_bf16_f32 v91, 0, v91
    s_lshr_b32 s96, s3, 2
    s_lshl_b32 s97, s96, 15
    s_and_b32 s98, s3, 3
    s_lshl_b32 s99, s98, 5
    s_add_u32 s96, s97, s99
    s_add_u32 s13, s96, 32768
    v_lshrrev_b32 v24, 4, v1
    v_lshlrev_b32 v24, 13, v24
    v_bfe_u32 v9, v1, 2, 2
    v_lshl_add_u32 v24, v9, 7, v24
    v_bfe_u32 v9, v1, 3, 2
    v_lshl_add_u32 v24, v9, 5, v24
    v_and_b32 v9, 3, v1
    v_lshl_add_u32 v24, v9, 3, v24
    v_xor_b32 v24, s13, v24
    s_lshl_b32 s13, s3, 6
    v_bfe_u32 v45, v1, 2, 1
    v_lshlrev_b32 v45, 9, v45
    v_bfe_u32 v9, v1, 3, 1
    v_lshl_add_u32 v45, v9, 12, v45
    v_lshrrev_b32 v9, 5, v1
    v_lshl_add_u32 v45, v9, 11, v45
    v_bfe_u32 v9, v1, 2, 2
    v_lshl_add_u32 v45, v9, 6, v45
    v_bfe_u32 v9, v1, 4, 1
    v_lshl_add_u32 v45, v9, 5, v45
    v_and_b32 v9, 3, v1
    v_lshl_add_u32 v45, v9, 3, v45
    v_xor_b32 v45, s13, v45
    v_add_u32 v45, 98304, v45
    v_and_b32 v46, 7, v1
    v_lshlrev_b32 v46, 4, v46
    v_lshrrev_b32 v9, 4, v1
    v_lshl_add_u32 v46, v9, 7, v46
    v_add_u32 v46, 136704, v46
    s_lshl4_add_u32 s13, s3, 136256
    v_mov_b32 v4, s13
    v_and_b32 v5, 7, v1
    v_lshlrev_b32 v5, 4, v5
    v_add_u32 v5, 136256, v5
    v_and_b32 v8, 8, v1
    v_cmp_eq_u32 s[22:23], 0, v8
    s_branch SCHK_46
SPOLL_45:
    s_load_dwordx8 s[24:31], s[32:33], s92 offset:2560 glc
SCHK_46:
    s_add_u32 s5, s5, 1
    s_cmp_ge_u32 s5, 300000
    s_waitcnt lgkmcnt(0)
    s_cbranch_scc1 SDONE_47
    s_cmp_lg_u32 s25, s4
    s_cbranch_scc1 SPOLL_45
    s_cmp_lg_u32 s27, s4
    s_cbranch_scc1 SPOLL_45
    s_cmp_lg_u32 s29, s4
    s_cbranch_scc1 SPOLL_45
    s_cmp_lg_u32 s31, s4
    s_cbranch_scc1 SPOLL_45
SDONE_47:
    s_min_u32 s25, s24, s28
    s_max_u32 s24, s24, s28
    s_max_u32 s27, s26, s30
    s_min_u32 s26, s26, s30
    s_max_u32 s28, s25, s27
    s_min_u32 s25, s25, s27
    v_mov_b32 v148, s24
    v_mov_b32 v151, s26
    v_mov_b32 v149, s28
    v_mov_b32 v150, s25
    ds_write_b128 v4, v[148:151]
    s_waitcnt lgkmcnt(0)
    s_barrier
    s_cmp_lt_u32 s3, 4
    s_cbranch_scc1 L_CSEL
    ds_read_b64_tr_b16 v[164:165], v24
    ds_read_b64_tr_b16 v[166:167], v24 offset:512
    ds_read_b64_tr_b16 v[168:169], v24 offset:1024
    ds_read_b64_tr_b16 v[170:171], v24 offset:1536
    ds_read_b64_tr_b16 v[172:173], v24 offset:2048
    ds_read_b64_tr_b16 v[174:175], v24 offset:2560
    ds_read_b64_tr_b16 v[176:177], v24 offset:3072
    ds_read_b64_tr_b16 v[178:179], v24 offset:3584
    ds_read_b64_tr_b16 v[180:181], v24 offset:4096
    ds_read_b64_tr_b16 v[182:183], v24 offset:4608
    ds_read_b64_tr_b16 v[184:185], v24 offset:5120
    ds_read_b64_tr_b16 v[186:187], v24 offset:5632
    ds_read_b64_tr_b16 v[188:189], v24 offset:6144
    ds_read_b64_tr_b16 v[190:191], v24 offset:6656
    ds_read_b64_tr_b16 v[192:193], v24 offset:7168
    ds_read_b64_tr_b16 v[194:195], v24 offset:7680
    v_mul_u32_u24_dpp v92, v70, v52 row_newbcast:0 row_mask:0xf bank_mask:0xf
    v_and_b32_dpp v93, v70, v53 row_newbcast:0 row_mask:0xf bank_mask:0xf
    v_mul_u32_u24_dpp v94, v70, v52 row_newbcast:1 row_mask:0xf bank_mask:0xf
    v_and_b32_dpp v95, v70, v53 row_newbcast:1 row_mask:0xf bank_mask:0xf
    v_mul_u32_u24_dpp v96, v70, v52 row_newbcast:2 row_mask:0xf bank_mask:0xf
    v_and_b32_dpp v97, v70, v53 row_newbcast:2 row_mask:0xf bank_mask:0xf
    v_mul_u32_u24_dpp v98, v70, v52 row_newbcast:3 row_mask:0xf bank_mask:0xf
    v_and_b32_dpp v99, v70, v53 row_newbcast:3 row_mask:0xf bank_mask:0xf
    v_mul_u32_u24_dpp v100, v70, v52 row_newbcast:4 row_mask:0xf bank_mask:0xf
    v_and_b32_dpp v101, v70, v53 row_newbcast:4 row_mask:0xf bank_mask:0xf
    v_mul_u32_u24_dpp v102, v70, v52 row_newbcast:5 row_mask:0xf bank_mask:0xf
    v_and_b32_dpp v103, v70, v53 row_newbcast:5 row_mask:0xf bank_mask:0xf
    v_mul_u32_u24_dpp v104, v70, v52 row_newbcast:6 row_mask:0xf bank_mask:0xf
    v_and_b32_dpp v105, v70, v53 row_newbcast:6 row_mask:0xf bank_mask:0xf
    v_mul_u32_u24_dpp v106, v70, v52 row_newbcast:7 row_mask:0xf bank_mask:0xf
    v_and_b32_dpp v107, v70, v53 row_newbcast:7 row_mask:0xf bank_mask:0xf
    v_pk_mul_f32 v[76:77], v[76:77], v[92:93]
    v_pk_mul_f32 v[78:79], v[78:79], v[94:95]
    v_pk_mul_f32 v[80:81], v[80:81], v[96:97]
    v_pk_mul_f32 v[82:83], v[82:83], v[98:99]
    v_pk_mul_f32 v[84:85], v[84:85], v[100:101]
    v_pk_mul_f32 v[86:87], v[86:87], v[102:103]
    v_pk_mul_f32 v[88:89], v[88:89], v[104:105]
    v_pk_mul_f32 v[90:91], v[90:91], v[106:107]
    v_cvt_pk_bf16_f32 v76, 0, v76
    v_cvt_pk_bf16_f32 v77, 0, v77
    v_cvt_pk_bf16_f32 v78, 0, v78
    v_cvt_pk_bf16_f32 v79, 0, v79
    v_cvt_pk_bf16_f32 v80, 0, v80
    v_cvt_pk_bf16_f32 v81, 0, v81
    v_cvt_pk_bf16_f32 v82, 0, v82
    v_cvt_pk_bf16_f32 v83, 0, v83
    v_cvt_pk_bf16_f32 v84, 0, v84
    v_cvt_pk_bf16_f32 v85, 0, v85
    v_cvt_pk_bf16_f32 v86, 0, v86
    v_cvt_pk_bf16_f32 v87, 0, v87
    v_cvt_pk_bf16_f32 v88, 0, v88
    v_cvt_pk_bf16_f32 v89, 0, v89
    v_cvt_pk_bf16_f32 v90, 0, v90
    v_cvt_pk_bf16_f32 v91, 0, v91
    v_pk_add_f32 v[76:77], v[76:77], v[28:29]
    v_pk_add_f32 v[78:79], v[78:79], v[30:31]
    v_pk_add_f32 v[80:81], v[80:81], v[32:33]
    v_pk_add_f32 v[82:83], v[82:83], v[34:35]
    v_pk_add_f32 v[84:85], v[84:85], v[36:37]
    v_pk_add_f32 v[86:87], v[86:87], v[38:39]
    v_pk_add_f32 v[88:89], v[88:89], v[40:41]
    v_pk_add_f32 v[90:91], v[90:91], v[42:43]
    v_cvt_pk_bf16_f32 v140, v76, v77
    v_cvt_pk_bf16_f32 v141, v78, v79
    v_cvt_pk_bf16_f32 v142, v80, v81
    v_cvt_pk_bf16_f32 v143, v82, v83
    v_cvt_pk_bf16_f32 v144, v84, v85
    v_cvt_pk_bf16_f32 v145, v86, v87
    v_cvt_pk_bf16_f32 v146, v88, v89
    v_cvt_pk_bf16_f32 v147, v90, v91
    ds_write_b128 v23, v[140:143]
    ds_write_b128 v23, v[144:147] offset:16
    s_mul_i32 s96, s3, 2304
    s_add_u32 s16, s96, 139776
    v_lshrrev_b32 v23, 3, v1
    v_mul_u32_u24 v23, 144, v23
    v_and_b32 v9, 7, v1
    v_lshl_add_u32 v23, v9, 4, v23
    v_add_u32 v23, s16, v23
    s_add_u32 s13, s81, 12288
    s_lshl2_add_u32 m0, s89, 101376
    s_nop 0
    buffer_load_dwordx4 v73, s[60:63], s13 offen nt lds
    s_branch L_CSELD
L_CSEL:
    s_setprio 3
    ds_read_b128 v[148:151], v5
    s_lshl_b32 s96, s3, 9
    s_add_u32 s13, s96, 136704
    v_add_u32 v6, s13, v63
    s_lshl2_add_u32 s13, s3, 136384
    v_mov_b32 v7, s13
    s_waitcnt lgkmcnt(0)
    v_max_u32_dpp v152, v151, v148 quad_perm:[1,0,3,2] row_mask:0xf bank_mask:0xf
    v_max_u32_dpp v153, v150, v149 quad_perm:[1,0,3,2] row_mask:0xf bank_mask:0xf
    v_max_u32_dpp v154, v149, v150 quad_perm:[1,0,3,2] row_mask:0xf bank_mask:0xf
    v_max_u32_dpp v155, v148, v151 quad_perm:[1,0,3,2] row_mask:0xf bank_mask:0xf
    v_max_u32 v156, v152, v154
    v_max_u32 v157, v153, v155
    v_min_u32 v158, v152, v154
    v_min_u32 v159, v153, v155
    v_max_u32 v148, v156, v157
    v_min_u32 v149, v156, v157
    v_max_u32 v150, v158, v159
    v_min_u32 v151, v158, v159
    s_nop 1
    v_max_u32_dpp v152, v151, v148 quad_perm:[2,3,0,1] row_mask:0xf bank_mask:0xf
    v_max_u32_dpp v153, v150, v149 quad_perm:[2,3,0,1] row_mask:0xf bank_mask:0xf
    v_max_u32_dpp v154, v149, v150 quad_perm:[2,3,0,1] row_mask:0xf bank_mask:0xf
    v_max_u32_dpp v155, v148, v151 quad_perm:[2,3,0,1] row_mask:0xf bank_mask:0xf
    v_max_u32 v156, v152, v154
    v_max_u32 v157, v153, v155
    v_min_u32 v158, v152, v154
    v_min_u32 v159, v153, v155
    v_max_u32 v148, v156, v157
    v_min_u32 v149, v156, v157
    v_max_u32 v150, v158, v159
    v_min_u32 v151, v158, v159
    s_nop 1
    v_max_u32_dpp v152, v151, v148 row_half_mirror row_mask:0xf bank_mask:0xf
    v_max_u32_dpp v153, v150, v149 row_half_mirror row_mask:0xf bank_mask:0xf
    v_max_u32_dpp v154, v149, v150 row_half_mirror row_mask:0xf bank_mask:0xf
    v_max_u32_dpp v155, v148, v151 row_half_mirror row_mask:0xf bank_mask:0xf
    v_readfirstlane_b32 s24, v152
    v_readfirstlane_b32 s25, v153
    v_readfirstlane_b32 s26, v154
    v_readfirstlane_b32 s27, v155
    s_bitcmp1_b32 s3, 0
    s_cselect_b32 s24, s25, s24
    s_cselect_b32 s26, s27, s26
    s_bitcmp1_b32 s3, 1
    s_cselect_b32 s24, s26, s24
    s_and_b32 s15, s24, 4095
    s_lshr_b32 s96, s15, 8
    s_sub_u32 s97, 15, s96
    s_and_b32 s98, s15, 1
    s_lshl1_add_u32 s99, s97, s98
    s_lshl_b32 s96, s99, 14
    s_add_u32 s13, s96, 33554432
    s_lshl_b32 s96, s75, 10
    s_add_u32 s14, s96, s13
    s_add_u32 s13, s13, 8192
    v_and_b32 v10, 15, v1
    v_lshlrev_b32 v10, 3, v10
    buffer_load_dwordx2 v[152:153], v10, s[32:35], s13 offen sc1
    buffer_load_dwordx4 v[148:151], v2, s[32:35], s14 offen sc1
    s_setprio 0
    s_add_u32 s16, s81, 12288
    s_lshl2_add_u32 m0, s89, 101376
    s_nop 0
    buffer_load_dwordx4 v73, s[60:63], s16 offen nt lds
    ds_read_b64_tr_b16 v[164:165], v24
    ds_read_b64_tr_b16 v[166:167], v24 offset:512
    ds_read_b64_tr_b16 v[168:169], v24 offset:1024
    ds_read_b64_tr_b16 v[170:171], v24 offset:1536
    ds_read_b64_tr_b16 v[172:173], v24 offset:2048
    ds_read_b64_tr_b16 v[174:175], v24 offset:2560
    ds_read_b64_tr_b16 v[176:177], v24 offset:3072
    ds_read_b64_tr_b16 v[178:179], v24 offset:3584
    ds_read_b64_tr_b16 v[180:181], v24 offset:4096
    ds_read_b64_tr_b16 v[182:183], v24 offset:4608
    ds_read_b64_tr_b16 v[184:185], v24 offset:5120
    ds_read_b64_tr_b16 v[186:187], v24 offset:5632
    ds_read_b64_tr_b16 v[188:189], v24 offset:6144
    ds_read_b64_tr_b16 v[190:191], v24 offset:6656
    ds_read_b64_tr_b16 v[192:193], v24 offset:7168
    ds_read_b64_tr_b16 v[194:195], v24 offset:7680
    v_mul_u32_u24_dpp v92, v70, v52 row_newbcast:0 row_mask:0xf bank_mask:0xf
    v_and_b32_dpp v93, v70, v53 row_newbcast:0 row_mask:0xf bank_mask:0xf
    v_mul_u32_u24_dpp v94, v70, v52 row_newbcast:1 row_mask:0xf bank_mask:0xf
    v_and_b32_dpp v95, v70, v53 row_newbcast:1 row_mask:0xf bank_mask:0xf
    v_mul_u32_u24_dpp v96, v70, v52 row_newbcast:2 row_mask:0xf bank_mask:0xf
    v_and_b32_dpp v97, v70, v53 row_newbcast:2 row_mask:0xf bank_mask:0xf
    v_mul_u32_u24_dpp v98, v70, v52 row_newbcast:3 row_mask:0xf bank_mask:0xf
    v_and_b32_dpp v99, v70, v53 row_newbcast:3 row_mask:0xf bank_mask:0xf
    v_mul_u32_u24_dpp v100, v70, v52 row_newbcast:4 row_mask:0xf bank_mask:0xf
    v_and_b32_dpp v101, v70, v53 row_newbcast:4 row_mask:0xf bank_mask:0xf
    v_mul_u32_u24_dpp v102, v70, v52 row_newbcast:5 row_mask:0xf bank_mask:0xf
    v_and_b32_dpp v103, v70, v53 row_newbcast:5 row_mask:0xf bank_mask:0xf
    v_mul_u32_u24_dpp v104, v70, v52 row_newbcast:6 row_mask:0xf bank_mask:0xf
    v_and_b32_dpp v105, v70, v53 row_newbcast:6 row_mask:0xf bank_mask:0xf
    v_mul_u32_u24_dpp v106, v70, v52 row_newbcast:7 row_mask:0xf bank_mask:0xf
    v_and_b32_dpp v107, v70, v53 row_newbcast:7 row_mask:0xf bank_mask:0xf
    v_pk_mul_f32 v[76:77], v[76:77], v[92:93]
    v_pk_mul_f32 v[78:79], v[78:79], v[94:95]
    v_pk_mul_f32 v[80:81], v[80:81], v[96:97]
    v_pk_mul_f32 v[82:83], v[82:83], v[98:99]
    v_pk_mul_f32 v[84:85], v[84:85], v[100:101]
    v_pk_mul_f32 v[86:87], v[86:87], v[102:103]
    v_pk_mul_f32 v[88:89], v[88:89], v[104:105]
    v_pk_mul_f32 v[90:91], v[90:91], v[106:107]
    v_cvt_pk_bf16_f32 v76, 0, v76
    v_cvt_pk_bf16_f32 v77, 0, v77
    v_cvt_pk_bf16_f32 v78, 0, v78
    v_cvt_pk_bf16_f32 v79, 0, v79
    v_cvt_pk_bf16_f32 v80, 0, v80
    v_cvt_pk_bf16_f32 v81, 0, v81
    v_cvt_pk_bf16_f32 v82, 0, v82
    v_cvt_pk_bf16_f32 v83, 0, v83
    v_cvt_pk_bf16_f32 v84, 0, v84
    v_cvt_pk_bf16_f32 v85, 0, v85
    v_cvt_pk_bf16_f32 v86, 0, v86
    v_cvt_pk_bf16_f32 v87, 0, v87
    v_cvt_pk_bf16_f32 v88, 0, v88
    v_cvt_pk_bf16_f32 v89, 0, v89
    v_cvt_pk_bf16_f32 v90, 0, v90
    v_cvt_pk_bf16_f32 v91, 0, v91
    v_pk_add_f32 v[76:77], v[76:77], v[28:29]
    v_pk_add_f32 v[78:79], v[78:79], v[30:31]
    v_pk_add_f32 v[80:81], v[80:81], v[32:33]
    v_pk_add_f32 v[82:83], v[82:83], v[34:35]
    v_pk_add_f32 v[84:85], v[84:85], v[36:37]
    v_pk_add_f32 v[86:87], v[86:87], v[38:39]
    v_pk_add_f32 v[88:89], v[88:89], v[40:41]
    v_pk_add_f32 v[90:91], v[90:91], v[42:43]
    v_cvt_pk_bf16_f32 v140, v76, v77
    v_cvt_pk_bf16_f32 v141, v78, v79
    v_cvt_pk_bf16_f32 v142, v80, v81
    v_cvt_pk_bf16_f32 v143, v82, v83
    v_cvt_pk_bf16_f32 v144, v84, v85
    v_cvt_pk_bf16_f32 v145, v86, v87
    v_cvt_pk_bf16_f32 v146, v88, v89
    v_cvt_pk_bf16_f32 v147, v90, v91
    ds_write_b128 v23, v[140:143]
    ds_write_b128 v23, v[144:147] offset:16
    s_mul_i32 s96, s3, 2304
    s_add_u32 s16, s96, 139776
    v_lshrrev_b32 v23, 3, v1
    v_mul_u32_u24 v23, 144, v23
    v_and_b32 v9, 7, v1
    v_lshl_add_u32 v23, v9, 4, v23
    v_add_u32 v23, s16, v23
    s_lshl2_add_u32 s15, s15, s3
    s_waitcnt vmcnt(1)
    v_bitop3_b32 v8, v149, v151, s4 bitop3:0x7e
    v_bitop3_b32 v8, v8, v153, s4 bitop3:0xf6
    v_cmp_ne_u32 vcc, 0, v8
    s_cbranch_vccz TOK_49
POLL_50:
    buffer_load_dwordx2 v[152:153], v10, s[32:35], s13 offen sc1
    buffer_load_dwordx4 v[148:151], v2, s[32:35], s14 offen sc1
    s_waitcnt vmcnt(0)
    v_bitop3_b32 v8, v149, v151, s4 bitop3:0x7e
    v_bitop3_b32 v8, v8, v153, s4 bitop3:0xf6
    v_cmp_ne_u32 vcc, 0, v8
    s_cbranch_vccz PDONE_51
    s_add_u32 s5, s5, 1
    s_cmp_lt_u32 s5, 300000
    s_cbranch_scc1 POLL_50
PDONE_51:
TOK_49:
    s_setprio 3
    ds_write2_b32 v6, v148, v150 offset0:0 offset1:1
    v_add_f32_dpp v152, v152, v152 quad_perm:[1,0,3,2] row_mask:0xf bank_mask:0xf
    s_nop 1
    v_add_f32_dpp v152, v152, v152 quad_perm:[2,3,0,1] row_mask:0xf bank_mask:0xf
    s_nop 1
    v_add_f32_dpp v152, v152, v152 row_half_mirror row_mask:0xf bank_mask:0xf
    s_nop 1
    v_add_f32_dpp v152, v152, v152 row_ror:8 row_mask:0xf bank_mask:0xf
    v_cvt_pk_bf16_f32 v152, 0, v152
    v_ashrrev_i32 v153, 31, v152
    v_or_b32 v153, 0x80000000, v153
    v_xor_b32 v152, v152, v153
    v_and_b32 v152, s6, v152
    v_or_b32 v152, s15, v152
    ds_write_b32 v7, v152
    s_setprio 0
L_CSELD:
    v_mov_b32 v4, 136384
    v_and_b32 v8, 15, v1
    v_lshlrev_b32 v8, 4, v8
    v_lshrrev_b32 v9, 5, v1
    v_lshl_add_u32 v8, v9, 3, v8
    s_lshl_b32 s96, s74, 13
    s_add_u32 s14, s96, 20971520
    s_lshl3_add_u32 s96, s75, s3
    s_lshl_b32 s97, s96, 8
    s_add_u32 s20, s97, s14
    s_waitcnt lgkmcnt(0)
    s_barrier
    ds_read_b128 v[148:151], v4
    s_waitcnt lgkmcnt(0)
    v_max_u32 v152, v148, v149
    v_max_u32 v153, v150, v151
    v_min_u32 v154, v148, v149
    v_min_u32 v155, v150, v151
    v_min_u32 v149, v152, v153
    v_max_u32 v148, v152, v153
    v_max3_u32 v149, v149, v154, v155
    v_cndmask_b32 v4, v149, v148, s[22:23]
    v_readfirstlane_b32 s68, v148
    v_and_b32 v4, 3, v4
    v_readfirstlane_b32 s69, v149
    v_lshl_add_u32 v4, v4, 9, v46
    ds_read_b128 v[152:155], v4
    ds_read_b128 v[140:143], v23
    ds_read_b128 v[144:147], v23 offset:1152
    s_bfe_u32 s70, s68, 720899
    s_bfe_u32 s71, s69, 720899
    s_sub_u32 s70, 2047, s70
    s_sub_u32 s71, 2047, s71
    s_waitcnt lgkmcnt(2)
    v_mfma_f32_16x16x32_bf16 v[212:215], v[152:155], v[164:167], 0
    v_mfma_f32_16x16x32_bf16 v[216:219], v[152:155], v[168:171], 0
    v_mfma_f32_16x16x32_bf16 v[220:223], v[152:155], v[172:175], 0
    v_mfma_f32_16x16x32_bf16 v[224:227], v[152:155], v[176:179], 0
    v_mfma_f32_16x16x32_bf16 v[228:231], v[152:155], v[180:183], 0
    v_mfma_f32_16x16x32_bf16 v[232:235], v[152:155], v[184:187], 0
    v_mfma_f32_16x16x32_bf16 v[236:239], v[152:155], v[188:191], 0
    v_mfma_f32_16x16x32_bf16 v[240:243], v[152:155], v[192:195], 0
    s_nop 1
    v_add_f32 v148, v212, v217
    s_nop 0
    v_add_f32 v149, v222, v227
    s_nop 0
    v_add_f32 v150, v228, v233
    s_nop 0
    v_add_f32 v151, v238, v243
    v_add_f32 v148, v148, v149
    v_add_f32 v150, v150, v151
    v_mov_b32 v149, s4
    s_nop 0
    v_permlane16_swap_b32 v150, v151
    s_cmp_ge_u32 s9, 28
    s_cbranch_scc1 L_NOHP
    v_add_f32 v148, v148, v151
    s_mov_b32 exec_lo, 0xffff
    s_mov_b32 exec_hi, 0xffff
    s_cmp_lg_u32 s93, 0
    s_cbranch_scc1 LOC_52
    buffer_store_dwordx2 v[148:149], v8, s[32:35], s20 offen sc1
    s_branch LOCD_53
LOC_52:
    buffer_store_dwordx2 v[148:149], v8, s[32:35], s20 offen
LOCD_53:
    s_mov_b64 exec, -1
L_NOHP:
    v_mov_b32 v56, v148
    v_mov_b32 v57, v149
    v_add_u32 v58, s20, v8
    s_waitcnt lgkmcnt(0)
    s_bitcmp1_b32 s21, 2
    s_cselect_b32 s17, s71, s70
    s_cselect_b32 s18, s69, s68
    s_cmp_lg_u32 s3, 7
    s_cbranch_scc1 L_NOFZ
    s_cmp_lg_u32 s2, 0
    s_cbranch_scc1 L_NONON
    v_mov_b32 v6, s4
    s_mov_b64 exec, 1
    buffer_store_dword v6, v3, s[32:35], 0 offen sc1
    s_mov_b64 exec, -1
L_NONON:
    s_lshr_b32 s96, s21, 3
    s_and_b32 s97, s21, 1
    s_lshl1_add_u32 s19, s96, s97
    s_lshr_b32 s96, s21, 2
    s_lshl_b32 s97, s96, 1
    s_lshl3_add_u32 s98, s12, s97
    s_and_b32 s99, s21, 1
    s_add_u32 s96, s98, s99
    s_mul_i32 s97, s96, 7168
    s_add_u32 s20, s97, 22020096
    s_lshl_b32 s96, s17, 11
    s_lshl_b32 s97, s12, 7
    s_add_u32 s98, s96, s97
    s_lshl_b32 s99, s19, 5
    s_add_u32 s82, s98, s99
    v_and_b32 v10, 7, v1
    v_lshlrev_b32 v10, 2, v10
    s_lshl_b32 s96, s19, 5
    s_add_u32 s13, s96, 139264
    v_add_u32 v5, s13, v10
    ds_read_b32 v74, v5
    s_lshr_b32 s96, s17, 7
    s_bfe_u32 s97, s18, 65538
    s_lshl1_add_u32 s98, s96, s97
    s_lshl_b32 s99, s98, 14
    s_lshl_b32 s96, s12, 8
    s_add_u32 s97, s99, s96
    s_lshl_b32 s98, s19, 6
    s_add_u32 s99, s97, s98
    s_add_u32 s68, s99, 33554432
    s_add_u32 s69, s68, 4096
    v_and_b32 v11, 7, v1
    v_lshlrev_b32 v11, 3, v11
    buffer_load_dwordx2 v[20:21], v11, s[32:35], s68 offen sc1
    buffer_load_dwordx2 v[72:73], v11, s[32:35], s69 offen sc1
    s_and_b32 s13, s18, s6
    s_ashr_i32 s15, s13, 31
    s_andn2_b32 s15, 0x7fff0000, s15
    s_or_b32 s15, s15, 0x80000000
    s_xor_b32 s13, s13, s15
    v_mov_b32 v75, s13
    v_mul_f32 v75, s7, v75
    v_exp_f32 v75, -v75
    s_nop 0
    v_add_f32 v75, 1.0, v75
    v_rcp_f32 v75, v75
    s_nop 0
    v_cvt_pk_bf16_f32 v75, 0, v75
L_NOFZ:
    s_cmp_lt_u32 s9, 28
    s_cbranch_scc1 L_HSEC
    s_branch L_GSEC
L_HSEC:
    s_cmp_lt_u32 s3, 4
    s_cbranch_scc1 L_HW
    s_branch L_NOH
L_HW:
    s_lshl_b32 s96, s3, 8
    s_add_u32 s13, s96, s14
    v_lshrrev_b32 v4, 4, v1
    v_lshlrev_b32 v4, 11, v4
    v_and_b32 v9, 15, v1
    v_lshl_add_u32 v4, v9, 4, v4
    s_lshl_b32 s96, s3, 5
    s_add_u32 s15, s96, 138752
    v_lshrrev_b32 v5, 5, v1
    v_lshl_add_u32 v5, v5, 7, s15
    v_bfe_u32 v9, v1, 2, 1
    v_lshl_add_u32 v5, v9, 4, v5
    v_bfe_u32 v9, v1, 1, 1
    v_lshl_add_u32 v5, v9, 3, v5
    v_bfe_u32 v9, v1, 3, 1
    v_lshl_add_u32 v5, v9, 2, v5
    v_and_b32 v9, 1, v1
    v_lshl_add_u32 v5, v9, 1, v5
    s_cmp_lg_u32 s93, 0
    s_cbranch_scc1 L_HLOC
SPOLL_54:
    s_load_dword s24, s[32:33], s13 offset:1276 glc
    s_load_dword s25, s[32:33], s13 offset:3324 glc
    s_load_dword s26, s[32:33], s13 offset:5372 glc
    s_load_dword s27, s[32:33], s13 offset:7420 glc
SCHK_55:
    s_add_u32 s5, s5, 1
    s_cmp_ge_u32 s5, 300000
    s_waitcnt lgkmcnt(0)
    s_cbranch_scc1 SDONE_56
    s_cmp_lg_u32 s24, s4
    s_cbranch_scc1 SPOLL_54
    s_cmp_lg_u32 s25, s4
    s_cbranch_scc1 SPOLL_54
    s_cmp_lg_u32 s26, s4
    s_cbranch_scc1 SPOLL_54
    s_cmp_lg_u32 s27, s4
    s_cbranch_scc1 SPOLL_54
SDONE_56:
L_HLOC:
    buffer_load_dwordx4 v[212:215], v4, s[32:35], s13 offen sc1
    buffer_load_dwordx4 v[216:219], v4, s[32:35], s13 offen offset:1024 sc1
    s_waitcnt vmcnt(0)
    v_bitop3_b32 v6, v213, v215, s4 bitop3:0x7e
    v_bitop3_b32 v6, v6, v217, s4 bitop3:0xf6
    v_bitop3_b32 v6, v6, v219, s4 bitop3:0xf6
    v_cmp_ne_u32 vcc, 0, v6
    s_cbranch_vccz TOK_58
POLL_59:
    buffer_load_dwordx4 v[212:215], v4, s[32:35], s13 offen sc1
    buffer_load_dwordx4 v[216:219], v4, s[32:35], s13 offen offset:1024 sc1
    s_waitcnt vmcnt(0)
    v_bitop3_b32 v6, v213, v215, s4 bitop3:0x7e
    v_bitop3_b32 v6, v6, v217, s4 bitop3:0xf6
    v_bitop3_b32 v6, v6, v219, s4 bitop3:0xf6
    v_cmp_ne_u32 vcc, 0, v6
    s_cbranch_vccz PDONE_60
    s_add_u32 s5, s5, 1
    s_cmp_lt_u32 s5, 300000
    s_cbranch_scc1 POLL_59
PDONE_60:
TOK_58:
    v_permlane32_swap_b32 v212, v214
    v_permlane32_swap_b32 v216, v218
    v_add_f32 v212, v212, v214
    v_add_f32 v216, v216, v218
    v_mov_b32 v214, v212
    v_mov_b32 v218, v216
    s_nop 0
    v_permlane16_swap_b32 v212, v214
    v_permlane16_swap_b32 v216, v218
    v_add_f32 v212, v212, v214
    v_add_f32 v216, v216, v218
    v_cvt_pk_bf16_f32 v212, 0, v212
    v_cvt_pk_bf16_f32 v216, 0, v216
    v_mul_f32 v6, s7, v212
    v_exp_f32 v6, -v6
    s_nop 0
    v_add_f32 v6, 1.0, v6
    v_rcp_f32 v6, v6
    s_nop 0
    v_mul_f32 v212, v212, v6
    v_cvt_pk_bf16_f32 v212, 0, v212
    v_mul_f32 v212, v212, v216
    v_cvt_pk_bf16_f32 v212, v212, v212
    ds_write_b16 v5, v212
L_NOH:
    v_bfe_u32 v4, v1, 2, 1
    v_lshlrev_b32 v4, 7, v4
    v_lshrrev_b32 v9, 5, v1
    v_lshl_add_u32 v4, v9, 4, v4
    v_add_u32 v4, 138752, v4
    v_lshrrev_b32 v5, 4, v1
    v_mul_u32_u24 v5, 7168, v5
    v_and_b32 v9, 15, v1
    v_lshl_add_u32 v5, v9, 3, v5
    v_and_b32 v6, 1, v1
    v_lshlrev_b32 v6, 18, v6
    v_bfe_u32 v9, v1, 1, 1
    v_lshl_add_u32 v6, v9, 13, v6
    s_lshl3_add_u32 s96, s75, s3
    s_mul_i32 s97, s96, 28672
    s_lshl_b32 s98, s74, 7
    s_add_u32 s99, s97, s98
    s_add_u32 s13, s99, 22020096
    s_lshr_b32 s96, s9, 2
    s_and_b32 s97, s75, 1
    s_lshr_b32 s98, s3, 1
    s_lshl2_add_u32 s99, s97, s98
    s_and_b32 s97, s3, 1
    s_lshl_b32 s98, s97, 2
    s_lshl3_add_u32 s97, s99, s98
    s_lshr_b32 s99, s75, 1
    s_add_u32 s98, s97, s99
    s_lshl_b32 s97, s98, 12
    s_lshl_b32 s99, s8, 6
    s_add_u32 s98, s97, s99
    s_lshl2_add_u32 s97, s96, s98
    s_add_u32 s99, s97, 1048576
    s_add_u32 s14, s99, 3072
    s_waitcnt vmcnt(0)
    s_waitcnt lgkmcnt(0)
    s_barrier
    ds_read_b128 v[212:215], v4
    ds_read_b64_tr_b16 v[196:197], v45
    ds_read_b64_tr_b16 v[198:199], v45 offset:1024
    ds_read_b128 v[216:219], v4 offset:32
    ds_read_b64_tr_b16 v[200:201], v45 offset:8192
    ds_read_b64_tr_b16 v[202:203], v45 offset:9216
    ds_read_b128 v[220:223], v4 offset:64
    ds_read_b64_tr_b16 v[204:205], v45 offset:16384
    ds_read_b64_tr_b16 v[206:207], v45 offset:17408
    ds_read_b128 v[224:227], v4 offset:96
    ds_read_b64_tr_b16 v[208:209], v45 offset:24576
    ds_read_b64_tr_b16 v[210:211], v45 offset:25600
    s_waitcnt lgkmcnt(9)
    v_mfma_f32_32x32x16_bf16 v[228:243], v[212:215], v[196:199], 0
    s_waitcnt lgkmcnt(6)
    v_mfma_f32_32x32x16_bf16 v[228:243], v[216:219], v[200:203], v[228:243]
    s_waitcnt lgkmcnt(3)
    v_mfma_f32_32x32x16_bf16 v[228:243], v[220:223], v[204:207], v[228:243]
    s_waitcnt lgkmcnt(0)
    v_mfma_f32_32x32x16_bf16 v[228:243], v[224:227], v[208:211], v[228:243]
    s_nop 11
    v_mov_b32 v229, s4
    buffer_store_dwordx2 v[228:229], v5, s[32:35], s13 offen sc1
    s_mov_b64 exec, 15
    buffer_store_dword v229, v6, s[32:35], s14 offen sc1
    s_mov_b64 exec, -1
    s_waitcnt lgkmcnt(0)
L_GSEC:
    s_lshl_b32 s96, s21, 7
    s_lshl4_add_u32 s13, s3, s96
    v_lshrrev_b32 v22, 3, v1
    v_lshl_add_u32 v22, v22, 0, s13
    s_lshl_b32 s96, s13, 11
    s_lshl_b32 s97, s12, 7
    s_add_u32 s15, s96, s97
    s_add_u32 s16, s15, 16384
    v_lshrrev_b32 v25, 3, v1
    v_lshlrev_b32 v25, 11, v25
    v_and_b32 v9, 7, v1
    v_lshl_add_u32 v25, v9, 4, v25
    v_cmp_ne_u32 vcc, s70, v22
    v_cmp_ne_u32 s[22:23], s71, v22
    s_nop 0
    s_and_b64 exec, vcc, s[22:23]
    buffer_store_dwordx4 v[140:143], v25, s[64:67], s15 offen sc1
    s_mov_b64 exec, -1
    v_add_u32 v22, 8, v22
    v_cmp_ne_u32 vcc, s70, v22
    v_cmp_ne_u32 s[22:23], s71, v22
    s_nop 0
    s_and_b64 exec, vcc, s[22:23]
    buffer_store_dwordx4 v[144:147], v25, s[64:67], s16 offen sc1
    s_mov_b64 exec, -1
    s_cmp_lt_u32 s9, 16
    s_cbranch_scc1 L_GF
    s_cmp_ge_u32 s9, 28
    s_cbranch_scc1 L_FIN
    s_waitcnt vmcnt(0)
    s_mov_b32 exec_lo, 0xffff
    s_mov_b32 exec_hi, 0xffff
    buffer_store_dwordx2 v[56:57], v58, s[32:35], 0 offen sc1
    s_mov_b64 exec, -1
    s_branch L_FIN
L_GF:
SPOLL_61:
    s_load_dwordx8 s[24:31], s[32:33], s92 offset:3072 glc
SCHK_62:
    s_add_u32 s5, s5, 1
    s_cmp_ge_u32 s5, 300000
    s_waitcnt lgkmcnt(0)
    s_cbranch_scc1 SDONE_63
    s_cmp_lg_u32 s24, s4
    s_cbranch_scc1 SPOLL_61
    s_cmp_lg_u32 s25, s4
    s_cbranch_scc1 SPOLL_61
    s_cmp_lg_u32 s26, s4
    s_cbranch_scc1 SPOLL_61
    s_cmp_lg_u32 s27, s4
    s_cbranch_scc1 SPOLL_61
    s_cmp_lg_u32 s28, s4
    s_cbranch_scc1 SPOLL_61
    s_cmp_lg_u32 s29, s4
    s_cbranch_scc1 SPOLL_61
    s_cmp_lg_u32 s30, s4
    s_cbranch_scc1 SPOLL_61
SDONE_63:
    s_barrier
    s_cmp_eq_u32 s3, 7
    s_cbranch_scc1 L_G7
    s_barrier
    s_mov_b32 exec_lo, 0xffff
    s_mov_b32 exec_hi, 0xffff
    buffer_store_dwordx2 v[56:57], v58, s[32:35], 0 offen sc1
    s_mov_b64 exec, -1
    s_branch L_FIN
L_G7:
    s_cmp_lg_u32 s3, 7
    s_cbranch_scc1 L_FIN
    s_add_u32 s13, s20, 4096
POLL_64:
    buffer_load_dwordx4 v[212:215], v2, s[32:35], s20 offen sc1
    buffer_load_dwordx4 v[216:219], v2, s[32:35], s20 offen offset:1024 sc1
    buffer_load_dwordx4 v[220:223], v2, s[32:35], s20 offen offset:2048 sc1
    buffer_load_dwordx4 v[224:227], v2, s[32:35], s20 offen offset:3072 sc1
    buffer_load_dwordx4 v[148:151], v2, s[32:35], s13 offen sc1
    buffer_load_dwordx4 v[152:155], v2, s[32:35], s13 offen offset:1024 sc1
    buffer_load_dwordx4 v[156:159], v2, s[32:35], s13 offen offset:2048 sc1
    s_waitcnt vmcnt(0)
    v_bitop3_b32 v4, v213, v215, s4 bitop3:0x7e
    v_bitop3_b32 v4, v4, v217, s4 bitop3:0xf6
    v_bitop3_b32 v4, v4, v219, s4 bitop3:0xf6
    v_bitop3_b32 v4, v4, v221, s4 bitop3:0xf6
    v_bitop3_b32 v4, v4, v223, s4 bitop3:0xf6
    v_bitop3_b32 v4, v4, v225, s4 bitop3:0xf6
    v_bitop3_b32 v4, v4, v227, s4 bitop3:0xf6
    v_bitop3_b32 v4, v4, v149, s4 bitop3:0xf6
    v_bitop3_b32 v4, v4, v151, s4 bitop3:0xf6
    v_bitop3_b32 v4, v4, v153, s4 bitop3:0xf6
    v_bitop3_b32 v4, v4, v155, s4 bitop3:0xf6
    v_bitop3_b32 v4, v4, v157, s4 bitop3:0xf6
    v_bitop3_b32 v4, v4, v159, s4 bitop3:0xf6
    v_cmp_ne_u32 vcc, 0, v4
    s_cbranch_vccz PDONE_65
    s_add_u32 s5, s5, 1
    s_cmp_lt_u32 s5, 300000
    s_cbranch_scc1 POLL_64
PDONE_65:
    v_bitop3_b32 v4, v21, v73, s4 bitop3:0x7e
    v_cmp_ne_u32 vcc, 0, v4
    s_cbranch_vccz TOK_66
POLL_67:
    buffer_load_dwordx2 v[20:21], v11, s[32:35], s68 offen sc1
    buffer_load_dwordx2 v[72:73], v11, s[32:35], s69 offen sc1
    s_waitcnt vmcnt(0)
    v_bitop3_b32 v4, v21, v73, s4 bitop3:0x7e
    v_cmp_ne_u32 vcc, 0, v4
    s_cbranch_vccz PDONE_68
    s_add_u32 s5, s5, 1
    s_cmp_lt_u32 s5, 300000
    s_cbranch_scc1 POLL_67
PDONE_68:
TOK_66:
    s_barrier
    v_add_f32 v212, v212, v216
    v_add_f32 v214, v214, v218
    v_add_f32 v220, v220, v224
    v_add_f32 v222, v222, v226
    v_add_f32 v148, v148, v152
    v_add_f32 v150, v150, v154
    v_add_f32 v212, v212, v220
    v_add_f32 v214, v214, v222
    v_add_f32 v148, v148, v156
    v_add_f32 v150, v150, v158
    v_add_f32 v212, v212, v148
    v_add_f32 v214, v214, v150
    v_mov_b32 v213, v214
    v_add_f32_dpp v212, v212, v212 row_ror:8 row_mask:0xf bank_mask:0xf
    s_nop 0
    v_add_f32_dpp v213, v213, v213 row_ror:8 row_mask:0xf bank_mask:0xf
    v_mov_b32 v214, v212
    v_mov_b32 v215, v213
    s_nop 0
    v_permlane16_swap_b32 v212, v214
    v_permlane16_swap_b32 v213, v215
    v_pk_add_f32 v[212:213], v[212:213], v[214:215]
    v_mov_b32 v214, v212
    v_mov_b32 v215, v213
    s_nop 0
    v_permlane32_swap_b32 v212, v214
    v_permlane32_swap_b32 v213, v215
    v_pk_add_f32 v[212:213], v[212:213], v[214:215]
    v_cvt_pk_bf16_f32 v212, 0, v212
    v_cvt_pk_bf16_f32 v213, 0, v213
    v_pk_mul_f32 v[212:213], v[212:213], v[74:75] op_sel:[0,1]
    v_lshlrev_b32 v4, 16, v20
    v_and_b32 v5, s6, v20
    v_cvt_pk_bf16_f32 v212, 0, v212
    v_cvt_pk_bf16_f32 v213, 0, v213
    v_pk_add_f32 v[212:213], v[212:213], v[4:5]
    v_lshlrev_b32 v4, 16, v74
    v_and_b32 v5, s6, v74
    v_cvt_pk_bf16_f32 v212, 0, v212
    v_cvt_pk_bf16_f32 v213, 0, v213
    v_pk_mul_f32 v[212:213], v[212:213], v[4:5]
    v_lshlrev_b32 v4, 16, v72
    v_and_b32 v5, s6, v72
    v_cvt_pk_bf16_f32 v212, 0, v212
    v_cvt_pk_bf16_f32 v213, 0, v213
    v_pk_add_f32 v[212:213], v[212:213], v[4:5]
    v_cvt_pk_bf16_f32 v212, v212, v213
    s_mov_b64 exec, 0xff
    buffer_store_dword v212, v10, s[64:67], s82 offen sc1
    s_mov_b64 exec, -1
    s_mov_b32 exec_lo, 0xffff
    s_mov_b32 exec_hi, 0xffff
    buffer_store_dwordx2 v[56:57], v58, s[32:35], 0 offen sc1
    s_mov_b64 exec, -1
L_FIN:
L_END:
    s_endpgm
.p2align 10
.fill 768, 4, 0xbf800000
.section .rodata,"a"
.p2align 6
.amdhsa_kernel adaLN_cond__linear_kernel_hedgehog__moe_arch_mod__prompt_kernel
  .amdhsa_next_free_vgpr 256
  .amdhsa_next_free_sgpr 102
  .amdhsa_accum_offset 256
  .amdhsa_group_segment_fixed_size 0
  .amdhsa_kernarg_size 112
  .amdhsa_user_sgpr_count 2
  .amdhsa_user_sgpr_kernarg_segment_ptr 1
  .amdhsa_system_sgpr_workgroup_id_x 1
  .amdhsa_float_denorm_mode_32 3
  .amdhsa_float_denorm_mode_16_64 3
.end_amdhsa_kernel
```

```asm
; @launch grid=(256,1,1) block=(512,1,1) lds=163840
.amdgcn_target "amdgcn-amd-amdhsa--gfx950"
.text
.globl adaLN_cond__linear_kernel_hedgehog__moe_arch_mod__prompt_kernel
.p2align 8
.type adaLN_cond__linear_kernel_hedgehog__moe_arch_mod__prompt_kernel,@function
adaLN_cond__linear_kernel_hedgehog__moe_arch_mod__prompt_kernel:
    s_load_dwordx16 s[68:83], s[0:1], 0
    s_load_dwordx8 s[84:91], s[0:1], 64
    s_load_dwordx2 s[32:33], s[0:1], 104
    s_load_dwordx2 s[30:31], s[0:1], 96
    s_cmp_ge_u32 s2, 256
    s_cbranch_scc1 L_END
    v_lshrrev_b32 v4, 6, v0
    v_and_b32 v1, 63, v0
    v_mov_b32 v3, 0
    v_readfirstlane_b32 s3, v4
    v_lshlrev_b32 v2, 4, v1
    s_and_b32 s8, s2, 7
    s_lshr_b32 s9, s2, 3
    s_lshl2_add_u32 s96, s8, s3
    s_lshl_b32 s15, s96, 6
    s_mul_i32 s96, s15, 6144
    s_xor_b32 s97, s9, 1
    s_lshl_b32 s98, s97, 7
    s_add_u32 s13, s96, s98
    v_lshrrev_b32 v60, 3, v1
    v_mul_u32_u24 v60, 49152, v60
    v_and_b32 v9, 7, v1
    v_lshl_add_u32 v60, v9, 4, v60
    v_lshrrev_b32 v61, 3, v1
    v_lshl_add_u32 v61, v61, 3, s15
    s_lshl_b32 s96, s8, 5
    s_add_u32 s97, s96, s9
    s_lshl2_add_u32 s98, s97, s3
    s_sub_u32 s99, s98, 4
    s_lshl_b32 s16, s99, 12
    s_mov_b32 s50, 12582912
    s_mov_b32 s51, 0x20000
    s_mov_b32 s38, 4194304
    s_mov_b32 s39, 0x20000
    s_mov_b32 s34, 268435456
    s_mov_b32 s35, 0x20000
    s_getreg_b32 s94, hwreg(HW_REG_XCC_ID, 0, 3)
    s_getpc_b64 s[22:23]
    s_mul_i32 s96, s9, 7
    s_add_u32 s97, s96, s3
    s_lshl_b32 s19, s97, 7
    v_lshrrev_b32 v10, 5, v1
    v_mul_u32_u24 v10, 28672, v10
    v_add_u32 v10, s19, v10
    v_min_u32 v10, 44032, v10
    s_cmp_ge_u32 s3, 4
    s_waitcnt lgkmcnt(0)
    s_mov_b64 s[48:49], s[88:89]
    s_mov_b64 s[36:37], s[68:69]
    s_load_dword s4, s[32:33], 0
    s_cbranch_scc1 L_FS
    global_load_dwordx2 v[96:97], v61, s[86:87]
    buffer_load_dwordx4 v[80:83], v60, s[48:51], s13 offen nt
    s_add_u32 s13, s13, 12288
    buffer_load_dwordx4 v[84:87], v60, s[48:51], s13 offen nt
    s_add_u32 s13, s13, 12288
    buffer_load_dwordx4 v[88:91], v60, s[48:51], s13 offen nt
    s_add_u32 s13, s13, 12288
    buffer_load_dwordx4 v[92:95], v60, s[48:51], s13 offen nt
    s_barrier
    s_barrier
    s_and_b32 s22, s22, 0xfffffc00
    global_load_dword v78, v10, s[22:23]
    s_mov_b32 s42, 6291456
    s_mov_b32 s43, 0x20000
    s_mov_b32 s46, 2097152
    s_mov_b32 s47, 0x20000
    s_mov_b32 s54, 7340032
    s_mov_b32 s55, 0x20000
    s_mov_b32 s58, 7340032
    s_mov_b32 s59, 0x20000
    s_mov_b32 s62, 7340032
    s_mov_b32 s63, 0x20000
    s_mov_b32 s66, 4194304
    s_mov_b32 s67, 0x20000
    s_mov_b64 s[40:41], s[70:71]
    s_mov_b64 s[44:45], s[74:75]
    s_mov_b64 s[52:53], s[80:81]
    s_mov_b64 s[56:57], s[82:83]
    s_mov_b64 s[60:61], s[84:85]
    s_mov_b64 s[64:65], s[90:91]
    s_mov_b32 s5, 0
    s_mov_b32 s6, 0xffff0000
    s_mov_b32 s7, 0x3fb8aa3b
    s_lshr_b32 s76, s3, 2
    v_bfe_u32 v6, v1, 4, 1
    v_lshlrev_b32 v6, 6, v6
    v_and_b32 v62, 7, v1
    v_lshlrev_b32 v62, 4, v62
    v_xor_b32 v62, v62, v6
    v_lshrrev_b32 v6, 3, v1
    v_mul_u32_u24 v6, 6144, v6
    v_add_u32 v62, v62, v6
    v_lshlrev_b32 v63, 3, v1
    v_add_u32 v64, 149760, v2
    s_and_b32 s96, s3, 3
    s_lshl2_add_u32 s13, s96, 149760
    v_lshrrev_b32 v65, 4, v1
    v_lshl_add_u32 v65, v65, 5, s13
    v_and_b32 v9, 7, v1
    v_lshl_add_u32 v65, v9, 7, v65
    v_bfe_u32 v9, v1, 3, 1
    v_lshl_add_u32 v65, v9, 4, v65
    s_and_b32 s96, s8, 6
    s_and_b32 s97, s8, 1
    s_lshr_b32 s98, s9, 4
    s_lshl1_add_u32 s99, s97, s98
    s_lshl_b32 s97, s99, 6
    s_add_u32 s98, s96, s97
    s_lshl3_add_u32 s99, s3, s98
    s_lshl_b32 s96, s99, 10
    s_and_b32 s97, s9, 15
    s_lshl_b32 s98, s97, 6
    s_add_u32 s99, s96, s98
    s_add_u32 s14, s99, 262144
    s_xor_b32 s96, s9, 1
    s_and_b32 s97, s96, 15
    s_lshl4_add_u32 s98, s3, s97
    s_lshr_b32 s99, s9, 4
    s_lshl1_add_u32 s96, s98, s99
    s_lshl3_add_u32 s97, s96, s8
    s_lshl_b32 s98, s97, 9
    s_add_u32 s13, s98, 524288
    s_lshr_b32 s96, s9, 4
    s_xor_b32 s97, s9, 1
    s_and_b32 s98, s97, 7
    s_lshl_b32 s99, s3, 1
    s_lshl3_add_u32 s97, s98, s99
    s_bfe_u32 s98, s9, 65539
    s_add_u32 s99, s97, s98
    s_lshl_b32 s97, s99, 9
    s_lshl_b32 s98, s8, 6
    s_add_u32 s99, s97, s98
    s_lshl2_add_u32 s97, s96, s99
    s_add_u32 s15, s97, 2097152
    v_and_b32 v10, 3, v1
    v_lshlrev_b32 v10, 15, v10
    s_waitcnt vmcnt(5)
    v_lshlrev_b32 v98, 16, v97
    v_and_b32 v99, s6, v97
    v_and_b32 v97, s6, v96
    v_lshlrev_b32 v96, 16, v96
    v_mul_f32 v4, s7, v96
    v_exp_f32 v4, -v4
    s_nop 0
    v_add_f32 v4, 1.0, v4
    v_rcp_f32 v4, v4
    s_nop 0
    v_mul_f32 v96, v96, v4
    v_cvt_pk_bf16_f32 v96, 0, v96
    v_mul_f32 v5, s7, v97
    v_exp_f32 v5, -v5
    s_nop 0
    v_add_f32 v5, 1.0, v5
    v_rcp_f32 v5, v5
    s_nop 0
    v_mul_f32 v97, v97, v5
    v_cvt_pk_bf16_f32 v97, 0, v97
    v_mul_f32 v4, s7, v98
    v_exp_f32 v4, -v4
    s_nop 0
    v_add_f32 v4, 1.0, v4
    v_rcp_f32 v4, v4
    s_nop 0
    v_mul_f32 v98, v98, v4
    v_cvt_pk_bf16_f32 v98, 0, v98
    v_mul_f32 v5, s7, v99
    v_exp_f32 v5, -v5
    s_nop 0
    v_add_f32 v5, 1.0, v5
    v_rcp_f32 v5, v5
    s_nop 0
    v_mul_f32 v99, v99, v5
    v_cvt_pk_bf16_f32 v99, 0, v99
    s_waitcnt vmcnt(4)
    v_lshlrev_b32 v4, 16, v80
    v_and_b32 v5, s6, v80
    v_pk_mul_f32 v[20:21], v[4:5], v[96:97] op_sel:[0,0] op_sel_hi:[1,0]
    v_lshlrev_b32 v6, 16, v81
    v_and_b32 v7, s6, v81
    v_pk_mul_f32 v[22:23], v[6:7], v[96:97] op_sel:[0,0] op_sel_hi:[1,0]
    v_lshlrev_b32 v4, 16, v82
    v_and_b32 v5, s6, v82
    v_pk_mul_f32 v[24:25], v[4:5], v[96:97] op_sel:[0,0] op_sel_hi:[1,0]
    v_lshlrev_b32 v6, 16, v83
    v_and_b32 v7, s6, v83
    v_pk_mul_f32 v[26:27], v[6:7], v[96:97] op_sel:[0,0] op_sel_hi:[1,0]
    s_waitcnt vmcnt(3)
    v_lshlrev_b32 v4, 16, v84
    v_and_b32 v5, s6, v84
    v_pk_fma_f32 v[20:21], v[4:5], v[96:97], v[20:21] op_sel:[0,1,0] op_sel_hi:[1,1,1]
    v_lshlrev_b32 v6, 16, v85
    v_and_b32 v7, s6, v85
    v_pk_fma_f32 v[22:23], v[6:7], v[96:97], v[22:23] op_sel:[0,1,0] op_sel_hi:[1,1,1]
    v_lshlrev_b32 v4, 16, v86
    v_and_b32 v5, s6, v86
    v_pk_fma_f32 v[24:25], v[4:5], v[96:97], v[24:25] op_sel:[0,1,0] op_sel_hi:[1,1,1]
    v_lshlrev_b32 v6, 16, v87
    v_and_b32 v7, s6, v87
    v_pk_fma_f32 v[26:27], v[6:7], v[96:97], v[26:27] op_sel:[0,1,0] op_sel_hi:[1,1,1]
    s_waitcnt vmcnt(2)
    v_lshlrev_b32 v4, 16, v88
    v_and_b32 v5, s6, v88
    v_pk_fma_f32 v[20:21], v[4:5], v[98:99], v[20:21] op_sel:[0,0,0] op_sel_hi:[1,0,1]
    v_lshlrev_b32 v6, 16, v89
    v_and_b32 v7, s6, v89
    v_pk_fma_f32 v[22:23], v[6:7], v[98:99], v[22:23] op_sel:[0,0,0] op_sel_hi:[1,0,1]
    v_lshlrev_b32 v4, 16, v90
    v_and_b32 v5, s6, v90
    v_pk_fma_f32 v[24:25], v[4:5], v[98:99], v[24:25] op_sel:[0,0,0] op_sel_hi:[1,0,1]
    v_lshlrev_b32 v6, 16, v91
    v_and_b32 v7, s6, v91
    v_pk_fma_f32 v[26:27], v[6:7], v[98:99], v[26:27] op_sel:[0,0,0] op_sel_hi:[1,0,1]
    s_waitcnt vmcnt(1)
    v_lshlrev_b32 v4, 16, v92
    v_and_b32 v5, s6, v92
    v_pk_fma_f32 v[20:21], v[4:5], v[98:99], v[20:21] op_sel:[0,1,0] op_sel_hi:[1,1,1]
    v_lshlrev_b32 v6, 16, v93
    v_and_b32 v7, s6, v93
    v_pk_fma_f32 v[22:23], v[6:7], v[98:99], v[22:23] op_sel:[0,1,0] op_sel_hi:[1,1,1]
    v_lshlrev_b32 v4, 16, v94
    v_and_b32 v5, s6, v94
    v_pk_fma_f32 v[24:25], v[4:5], v[98:99], v[24:25] op_sel:[0,1,0] op_sel_hi:[1,1,1]
    v_lshlrev_b32 v6, 16, v95
    v_and_b32 v7, s6, v95
    v_pk_fma_f32 v[26:27], v[6:7], v[98:99], v[26:27] op_sel:[0,1,0] op_sel_hi:[1,1,1]
    v_permlane32_swap_b32 v20, v24
    v_permlane32_swap_b32 v21, v25
    v_permlane32_swap_b32 v22, v26
    v_permlane32_swap_b32 v23, v27
    v_add_f32 v20, v20, v24
    v_add_f32 v21, v21, v25
    v_add_f32 v22, v22, v26
    v_add_f32 v23, v23, v27
    s_nop 0
    v_permlane16_swap_b32 v20, v22
    v_permlane16_swap_b32 v21, v23
    v_add_f32 v20, v20, v22
    v_add_f32 v21, v21, v23
    s_nop 0
    v_add_f32_dpp v20, v20, v20 row_ror:8 row_mask:0xf bank_mask:0xf
    v_add_f32_dpp v21, v21, v21 row_ror:8 row_mask:0xf bank_mask:0xf
    s_nop 1
    v_mov_b32_dpp v20, v21 quad_perm:[0,1,2,3] row_mask:0xf bank_mask:0xc
    ds_write_b32 v65, v20
    s_waitcnt lgkmcnt(0)
    s_barrier
    ds_read_b128 v[20:23], v64 offset:0
    s_mul_i32 s4, s4, 0x9e3779b1
    s_add_u32 s4, s4, 0x7f4a7c15
    s_waitcnt lgkmcnt(0)
    v_pk_add_f32 v[20:21], v[20:21], v[22:23]
    v_add_f32 v20, v20, v21
    v_mov_b32 v21, s4
    buffer_store_dwordx2 v[20:21], v63, s[32:35], s13 offen sc1
    s_mov_b64 exec, 15
    buffer_store_dword v21, v10, s[32:35], s15 offen sc1
    s_mov_b64 exec, -1
    s_branch L_FJ
L_FS:
    s_barrier
    buffer_load_dwordx4 v[80:83], v2, s[36:39], s16 offen
    buffer_load_dwordx4 v[84:87], v2, s[36:39], s16 offen offset:1024
    buffer_load_dwordx4 v[88:91], v2, s[36:39], s16 offen offset:2048
    buffer_load_dwordx4 v[92:95], v2, s[36:39], s16 offen offset:3072
    s_lshl2_add_u32 s96, s2, s3
    s_sub_u32 s97, s96, 4
    s_lshl_b32 s98, s97, 7
    s_add_u32 s17, s98, 2097152
    s_load_dword s24, s[32:33], s17 offset:0 glc
    s_load_dword s25, s[32:33], s17 offset:64 glc
    s_lshl_b32 s96, s2, 5
    s_add_u32 s97, s96, s3
    s_sub_u32 s98, s97, 4
    s_lshl_b32 s99, s98, 7
    s_add_u32 s17, s99, 1048576
    s_load_dword s24, s[32:33], s17 offset:0 glc
    s_load_dword s25, s[32:33], s17 offset:64 glc
    s_lshl_b32 s19, s94, 5
    v_mov_b32 v78, 1
    v_mov_b32 v79, s19
    s_barrier
    s_cmp_lg_u32 s3, 7
    s_cbranch_scc1 L_NOTK
    s_mov_b64 exec, 1
    global_atomic_add v78, v79, v78, s[30:31] sc0 sc1
    s_mov_b64 exec, -1
    s_branch L_TK0
L_NOTK:
    s_and_b32 s22, s22, 0xfffffc00
    global_load_dword v78, v10, s[22:23]
L_TK0:
    s_mov_b32 s42, 6291456
    s_mov_b32 s43, 0x20000
    s_mov_b32 s46, 2097152
    s_mov_b32 s47, 0x20000
    s_mov_b32 s54, 7340032
    s_mov_b32 s55, 0x20000
    s_mov_b32 s58, 7340032
    s_mov_b32 s59, 0x20000
    s_mov_b32 s62, 7340032
    s_mov_b32 s63, 0x20000
    s_mov_b32 s66, 4194304
    s_mov_b32 s67, 0x20000
    s_mov_b64 s[40:41], s[70:71]
    s_mov_b64 s[44:45], s[74:75]
    s_mov_b64 s[52:53], s[80:81]
    s_mov_b64 s[56:57], s[82:83]
    s_mov_b64 s[60:61], s[84:85]
    s_mov_b64 s[64:65], s[90:91]
    s_mov_b32 s5, 0
    s_mov_b32 s6, 0xffff0000
    s_mov_b32 s7, 0x3fb8aa3b
    s_lshr_b32 s76, s3, 2
    v_bfe_u32 v6, v1, 4, 1
    v_lshlrev_b32 v6, 6, v6
    v_and_b32 v62, 7, v1
    v_lshlrev_b32 v62, 4, v62
    v_xor_b32 v62, v62, v6
    v_lshrrev_b32 v6, 3, v1
    v_mul_u32_u24 v6, 6144, v6
    v_add_u32 v62, v62, v6
    v_lshlrev_b32 v63, 3, v1
    v_add_u32 v64, 149760, v2
    s_and_b32 s96, s3, 3
    s_lshl2_add_u32 s13, s96, 149760
    v_lshrrev_b32 v65, 4, v1
    v_lshl_add_u32 v65, v65, 5, s13
    v_and_b32 v9, 7, v1
    v_lshl_add_u32 v65, v9, 7, v65
    v_bfe_u32 v9, v1, 3, 1
    v_lshl_add_u32 v65, v9, 4, v65
    s_and_b32 s96, s8, 6
    s_and_b32 s97, s8, 1
    s_lshr_b32 s98, s9, 4
    s_lshl1_add_u32 s99, s97, s98
    s_lshl_b32 s97, s99, 6
    s_add_u32 s98, s96, s97
    s_lshl3_add_u32 s99, s3, s98
    s_lshl_b32 s96, s99, 10
    s_and_b32 s97, s9, 15
    s_lshl_b32 s98, s97, 6
    s_add_u32 s99, s96, s98
    s_add_u32 s14, s99, 262144
    s_sub_u32 s96, s3, 4
    s_lshl4_add_u32 s13, s96, 151808
    v_lshrrev_b32 v10, 5, v1
    v_lshl_add_u32 v10, v10, 3, s13
    s_barrier
    s_waitcnt vmcnt(1)
    s_waitcnt lgkmcnt(0)
    s_mul_i32 s4, s4, 0x9e3779b1
    s_add_u32 s4, s4, 0x7f4a7c15
    v_mov_b32 v104, 0x3f803f80
    v_dot2_f32_bf16 v100, v80, v104, 0
    v_dot2_f32_bf16 v102, v80, v80, 0
    v_dot2_f32_bf16 v101, v88, v104, 0
    v_dot2_f32_bf16 v103, v88, v88, 0
    v_dot2_f32_bf16 v100, v81, v104, v100
    v_dot2_f32_bf16 v102, v81, v81, v102
    v_dot2_f32_bf16 v101, v89, v104, v101
    v_dot2_f32_bf16 v103, v89, v89, v103
    v_dot2_f32_bf16 v100, v82, v104, v100
    v_dot2_f32_bf16 v102, v82, v82, v102
    v_dot2_f32_bf16 v101, v90, v104, v101
    v_dot2_f32_bf16 v103, v90, v90, v103
    v_dot2_f32_bf16 v100, v83, v104, v100
    v_dot2_f32_bf16 v102, v83, v83, v102
    v_dot2_f32_bf16 v101, v91, v104, v101
    v_dot2_f32_bf16 v103, v91, v91, v103
    v_dot2_f32_bf16 v100, v84, v104, v100
    v_dot2_f32_bf16 v102, v84, v84, v102
    v_dot2_f32_bf16 v101, v92, v104, v101
    v_dot2_f32_bf16 v103, v92, v92, v103
    v_dot2_f32_bf16 v100, v85, v104, v100
    v_dot2_f32_bf16 v102, v85, v85, v102
    v_dot2_f32_bf16 v101, v93, v104, v101
    v_dot2_f32_bf16 v103, v93, v93, v103
    v_dot2_f32_bf16 v100, v86, v104, v100
    v_dot2_f32_bf16 v102, v86, v86, v102
    v_dot2_f32_bf16 v101, v94, v104, v101
    v_dot2_f32_bf16 v103, v94, v94, v103
    v_dot2_f32_bf16 v100, v87, v104, v100
    v_dot2_f32_bf16 v102, v87, v87, v102
    v_dot2_f32_bf16 v101, v95, v104, v101
    v_dot2_f32_bf16 v103, v95, v95, v103
    s_nop 1
    v_permlane32_swap_b32 v100, v101
    v_permlane32_swap_b32 v102, v103
    v_add_f32 v100, v100, v101
    v_add_f32 v102, v102, v103
    s_nop 1
    v_permlane16_swap_b32 v100, v102
    v_add_f32 v100, v100, v102
    s_nop 1
    v_add_f32_dpp v100, v100, v100 quad_perm:[1,0,3,2] row_mask:0xf bank_mask:0xf
    s_nop 1
    v_add_f32_dpp v100, v100, v100 quad_perm:[2,3,0,1] row_mask:0xf bank_mask:0xf
    s_nop 1
    v_add_f32_dpp v100, v100, v100 row_half_mirror row_mask:0xf bank_mask:0xf
    s_nop 1
    v_add_f32_dpp v100, v100, v100 row_ror:8 row_mask:0xf bank_mask:0xf
    v_mul_f32 v102, 0x3a800000, v100
    v_mul_f32 v100, 0x3a800000, v100
    s_nop 1
    v_permlane16_swap_b32 v100, v102
    v_fma_f32 v117, -v100, v100, v102
    v_cvt_pk_bf16_f32 v116, 0, v100
    v_max_f32 v117, 0, v117
    v_cvt_pk_bf16_f32 v117, 0, v117
    v_add_f32 v117, 0x3727c5ac, v117
    v_cvt_pk_bf16_f32 v117, 0, v117
    v_sqrt_f32 v117, v117
    s_nop 0
    v_cvt_pk_bf16_f32 v117, 0, v117
    v_lshrrev_b32 v116, 16, v116
    v_or_b32 v116, v116, v117
    v_mov_b32 v117, s4
    ds_write_b64 v10, v[116:117]
L_FJ:
    v_and_b32 v5, 3, v1
    v_lshlrev_b32 v5, 4, v5
    v_add_u32 v5, 151808, v5
    v_and_b32 v4, 3, v1
    v_lshlrev_b32 v4, 4, v4
    v_bfe_u32 v9, v1, 2, 1
    v_lshl_add_u32 v4, v9, 10, v4
    v_and_b32 v10, 31, v1
    v_lshlrev_b32 v10, 11, v10
    v_lshrrev_b32 v9, 5, v1
    v_lshl_add_u32 v10, v9, 5, v10
    v_and_b32 v6, 1, v1
    v_lshlrev_b32 v6, 9, v6
    v_bfe_u32 v9, v1, 1, 1
    v_lshl_add_u32 v6, v9, 8, v6
    s_and_b32 s96, s9, 3
    s_and_b32 s97, s8, 6
    s_and_b32 s98, s8, 1
    s_lshr_b32 s99, s9, 4
    s_lshl1_add_u32 s98, s98, s99
    s_lshl_b32 s99, s98, 6
    s_add_u32 s98, s97, s99
    s_lshl3_add_u32 s97, s3, s98
    s_lshl_b32 s99, s97, 9
    s_bfe_u32 s98, s9, 131074
    s_lshl_b32 s97, s98, 6
    s_add_u32 s98, s99, s97
    s_lshl2_add_u32 s99, s96, s98
    s_add_u32 s97, s99, 16
    s_add_u32 s15, s97, 2097152
    s_waitcnt lgkmcnt(0)
    s_barrier
    ds_read_b128 v[116:119], v5
    s_waitcnt lgkmcnt(0)
    s_mov_b64 exec, 0xff
    buffer_store_dwordx4 v[116:119], v4, s[32:35], s14 offen sc1
    s_mov_b64 exec, 15
    buffer_store_dword v117, v6, s[32:35], s15 offen sc1
    s_mov_b64 exec, -1
    s_cmp_lg_u32 s3, 7
    s_cbranch_scc1 L_NOTK2
    s_mov_b32 s13, 0
    s_waitcnt vmcnt(2)
L_TK:
    v_readfirstlane_b32 s15, v78
    s_nop 0
    s_cmp_lt_u32 s15, 32
    s_cbranch_scc1 L_TKOK
    v_mov_b32 v78, s4
    s_mov_b64 exec, 1
    buffer_store_dword v78, v3, s[32:35], 0 offen offset:256 sc1
    s_mov_b64 exec, -1
    s_add_u32 s13, s13, 1
    s_cmp_lt_u32 s13, 8
    s_cbranch_scc0 L_TKNO
    s_add_u32 s94, s94, 1
    s_and_b32 s94, s94, 7
    s_lshl_b32 s19, s94, 5
    v_mov_b32 v78, 1
    v_mov_b32 v79, s19
    s_mov_b64 exec, 1
    global_atomic_add v78, v79, v78, s[30:31] sc0 sc1
    s_mov_b64 exec, -1
    s_waitcnt vmcnt(0)
    s_branch L_TK
L_TKNO:
    s_and_b32 s94, s2, 7
    s_lshr_b32 s15, s2, 3
L_TKOK:
    s_lshl3_add_u32 s15, s15, s94
    v_mov_b32 v78, s15
    ds_write_b32 v5, v78 offset:64
L_NOTK2:
    s_waitcnt lgkmcnt(0)
    s_barrier
    ds_read_b32 v120, v5 offset:64
    s_waitcnt lgkmcnt(0)
    v_readfirstlane_b32 s2, v120
    s_nop 0
    s_and_b32 s8, s2, 7
    s_lshr_b32 s9, s2, 3
    s_and_b32 s96, s8, 1
    s_and_b32 s97, s9, 7
    s_lshl3_add_u32 s12, s96, s97
    s_lshr_b32 s96, s8, 1
    s_lshr_b32 s97, s9, 3
    s_lshl2_add_u32 s21, s96, s97
    s_and_b32 s96, s3, 3
    s_lshl2_add_u32 s94, s21, s96
    s_lshl1_add_u32 s95, s12, s76
    s_lshl_b32 s96, s94, 16
    s_lshl_b32 s97, s95, 6
    s_add_u32 s18, s96, s97
    buffer_load_dwordx4 v[12:15], v10, s[36:39], s18 offen
    buffer_load_dwordx4 v[16:19], v10, s[36:39], s18 offen offset:16
    s_lshr_b32 s96, s8, 1
    s_lshl4_add_u32 s97, s96, s12
    s_lshl4_add_u32 s98, s97, s3
    s_lshl_b32 s99, s98, 9
    s_add_u32 s13, s99, 524288
    s_lshl3_add_u32 s96, s2, s3
    s_lshl_b32 s97, s96, 6
    s_add_u32 s15, s97, 2097152
    s_and_b32 s96, s3, 3
    s_lshl2_add_u32 s97, s2, s96
    s_lshl_b32 s98, s97, 8
    s_add_u32 s14, s98, 262144
    s_load_dwordx8 s[24:31], s[32:33], s15 offset:0 glc
    s_and_b32 s10, s9, 15
    s_lshr_b32 s96, s8, 2
    s_and_b32 s97, s8, 1
    s_lshl1_add_u32 s98, s96, s97
    s_and_b32 s99, s8, 2
    s_lshl2_add_u32 s96, s98, s99
    s_lshr_b32 s97, s9, 4
    s_add_u32 s11, s96, s97
    s_and_b32 s85, s9, 12
    s_lshl_b32 s96, s2, 6
    s_add_u32 s97, s96, s3
    s_lshl_b32 s98, s97, 6
    s_add_u32 s92, s98, 1048576
    s_lshr_b32 s96, s9, 4
    s_xor_b32 s77, s76, s96
    s_lshr_b32 s96, s9, 3
    s_xor_b32 s97, s96, s9
    s_and_b32 s98, s97, 1
    s_lshl2_add_u32 s83, s98, 8
    s_mul_i32 s96, s8, 7
    s_lshr_b32 s97, s9, 2
    s_add_u32 s74, s96, s97
    s_and_b32 s75, s9, 3
    v_and_b32 v8, 31, v1
    v_lshlrev_b32 v8, 3, v8
    v_and_b32 v4, 31, v1
    v_lshlrev_b32 v4, 4, v4
    v_lshrrev_b32 v9, 5, v1
    v_lshl_add_u32 v4, v9, 12, v4
    s_lshl2_add_u32 s16, s3, 152320
    v_lshl_add_u32 v5, v1, 6, s16
    s_lshl_b32 s96, s76, 10
    s_add_u32 s16, s96, 152320
    v_and_b32 v6, 15, v1
    v_lshl_add_u32 v6, v6, 5, s16
    v_lshrrev_b32 v9, 5, v1
    v_lshl_add_u32 v6, v9, 9, v6
    s_branch SCHK_2
SPOLL_1:
    s_load_dwordx8 s[24:31], s[32:33], s15 offset:0 glc
SCHK_2:
    s_add_u32 s5, s5, 1
    s_cmp_ge_u32 s5, 300000
    s_waitcnt lgkmcnt(0)
    s_cbranch_scc1 SDONE_3
    s_cmp_lg_u32 s24, s4
    s_cbranch_scc1 SPOLL_1
    s_cmp_lg_u32 s25, s4
    s_cbranch_scc1 SPOLL_1
    s_cmp_lg_u32 s28, s4
    s_cbranch_scc1 SPOLL_1
    s_cmp_lg_u32 s29, s4
    s_cbranch_scc1 SPOLL_1
    s_cmp_lg_u32 s30, s4
    s_cbranch_scc1 SPOLL_1
    s_cmp_lg_u32 s31, s4
    s_cbranch_scc1 SPOLL_1
SDONE_3:
    buffer_load_dwordx4 v[120:123], v4, s[32:35], s13 offen sc1
    buffer_load_dwordx2 v[116:117], v8, s[32:35], s14 offen sc1
    s_barrier
    s_lshl_b32 s96, s11, 12
    s_lshl_b32 s97, s3, 9
    s_add_u32 s16, s96, s97
    v_add_u32 v10, s16, v2
    s_lshl_b32 s96, s3, 9
    s_add_u32 m0, s96, 156416
    s_mov_b32 exec_hi, 0
    global_load_lds_dwordx4 v10, s[72:73]
    s_mov_b32 exec_hi, -1
    s_and_b32 s20, s9, 3
    s_add_u32 s96, s20, s85
    s_and_b32 s97, s96, 15
    s_lshl3_add_u32 s98, s97, s3
    s_mul_i32 s99, s98, 49152
    s_lshl_b32 s96, s11, 7
    s_add_u32 s82, s99, s96
    s_mul_i32 s96, s20, 24960
    s_lshr_b32 s97, s3, 1
    s_mul_i32 s98, s97, 2080
    s_add_u32 s99, s96, s98
    s_and_b32 s97, s3, 1
    s_mul_i32 s96, s97, 1056
    s_add_u32 s20, s99, s96
    s_mov_b32 m0, s20
    s_nop 0
    buffer_load_dwordx4 v62, s[40:43], s82 offen lds
    s_add_u32 s82, s82, 2048
    s_add_u32 m0, s20, 8320
    s_nop 0
    buffer_load_dwordx4 v62, s[40:43], s82 offen lds
    s_add_u32 s82, s82, 2048
    s_add_u32 m0, s20, 16640
    s_nop 0
    buffer_load_dwordx4 v62, s[40:43], s82 offen lds
    s_waitcnt vmcnt(5)
    v_bitop3_b32 v7, v121, v123, s4 bitop3:0x7e
    v_cmp_ne_u32 vcc, 0, v7
    s_cbranch_vccz TOK_5
POLL_6:
    buffer_load_dwordx4 v[120:123], v4, s[32:35], s13 offen sc1
    s_waitcnt vmcnt(0)
    v_bitop3_b32 v7, v121, v123, s4 bitop3:0x7e
    v_cmp_ne_u32 vcc, 0, v7
    s_cbranch_vccz PDONE_7
    s_add_u32 s5, s5, 1
    s_cmp_lt_u32 s5, 300000
    s_cbranch_scc1 POLL_6
PDONE_7:
TOK_5:
    ds_write2_b32 v5, v120, v122 offset0:0 offset1:8
    v_lshlrev_b32 v100, 16, v12
    v_and_b32 v101, s6, v12
    v_lshlrev_b32 v102, 16, v13
    v_and_b32 v103, s6, v13
    v_lshlrev_b32 v104, 16, v14
    v_and_b32 v105, s6, v14
    v_lshlrev_b32 v106, 16, v15
    v_and_b32 v107, s6, v15
    v_lshlrev_b32 v108, 16, v16
    v_and_b32 v109, s6, v16
    v_lshlrev_b32 v110, 16, v17
    v_and_b32 v111, s6, v17
    v_lshlrev_b32 v112, 16, v18
    v_and_b32 v113, s6, v18
    v_lshlrev_b32 v114, 16, v19
    v_and_b32 v115, s6, v19
    s_waitcnt lgkmcnt(0)
    s_barrier
    ds_read_b128 v[88:91], v6 offset:2048
    ds_read_b128 v[92:95], v6 offset:2064
    ds_read_b128 v[80:83], v6
    ds_read_b128 v[84:87], v6 offset:16
    s_waitcnt vmcnt(4)
    v_cmp_ne_u32 vcc, s4, v117
    s_cbranch_vccz TOK_8
POLL_9:
    buffer_load_dwordx2 v[116:117], v8, s[32:35], s14 offen sc1
    s_waitcnt vmcnt(0)
    v_cmp_ne_u32 vcc, s4, v117
    s_cbranch_vccz PDONE_10
    s_add_u32 s5, s5, 1
    s_cmp_lt_u32 s5, 300000
    s_cbranch_scc1 POLL_9
PDONE_10:
TOK_8:
    v_lshlrev_b32 v117, 16, v116
    v_and_b32 v116, s6, v116
    v_rcp_f32 v116, v116
    s_nop 0
    v_pk_add_f32 v[100:101], v[100:101], v[116:117] op_sel:[0,1] neg_lo:[0,1] neg_hi:[0,1]
    v_pk_add_f32 v[102:103], v[102:103], v[116:117] op_sel:[0,1] neg_lo:[0,1] neg_hi:[0,1]
    v_pk_add_f32 v[104:105], v[104:105], v[116:117] op_sel:[0,1] neg_lo:[0,1] neg_hi:[0,1]
    v_pk_add_f32 v[106:107], v[106:107], v[116:117] op_sel:[0,1] neg_lo:[0,1] neg_hi:[0,1]
    v_pk_add_f32 v[108:109], v[108:109], v[116:117] op_sel:[0,1] neg_lo:[0,1] neg_hi:[0,1]
    v_pk_add_f32 v[110:111], v[110:111], v[116:117] op_sel:[0,1] neg_lo:[0,1] neg_hi:[0,1]
    v_pk_add_f32 v[112:113], v[112:113], v[116:117] op_sel:[0,1] neg_lo:[0,1] neg_hi:[0,1]
    v_pk_add_f32 v[114:115], v[114:115], v[116:117] op_sel:[0,1] neg_lo:[0,1] neg_hi:[0,1]
    s_lshl4_add_u32 s96, s21, s12
    s_and_b32 s97, s3, 3
    s_lshl2_add_u32 s98, s96, s97
    s_lshl1_add_u32 s99, s98, s76
    s_lshl_b32 s96, s99, 11
    s_add_u32 s13, s96, 4194304
    v_and_b32 v8, 15, v1
    v_lshlrev_b32 v8, 4, v8
    v_bfe_u32 v9, v1, 4, 1
    v_lshl_add_u32 v8, v9, 10, v8
    v_lshrrev_b32 v9, 5, v1
    v_lshl_add_u32 v8, v9, 9, v8
    s_waitcnt lgkmcnt(2)
    v_pk_add_f32 v[88:89], v[88:89], v[90:91]
    v_pk_add_f32 v[92:93], v[92:93], v[94:95]
    v_pk_add_f32 v[88:89], v[88:89], v[92:93]
    v_add_f32 v88, v88, v89
    v_cvt_pk_bf16_f32 v88, 0, v88
    s_waitcnt lgkmcnt(0)
    v_pk_add_f32 v[80:81], v[80:81], v[82:83]
    v_pk_add_f32 v[84:85], v[84:85], v[86:87]
    v_pk_add_f32 v[80:81], v[80:81], v[84:85]
    v_add_f32 v80, v80, v81
    v_add_f32 v88, 1.0, v88
    v_cvt_pk_bf16_f32 v88, 0, v88
    v_cvt_pk_bf16_f32 v80, 0, v80
    s_lshl_b32 s96, s3, 8
    s_add_u32 s16, s96, 160512
    v_and_b32 v4, 15, v1
    v_lshl_add_u32 v4, v4, 2, s16
    v_lshrrev_b32 v9, 5, v1
    v_lshl_add_u32 v4, v9, 6, v4
    v_lshrrev_b32 v5, 5, v1
    v_lshl_add_u32 v5, v5, 6, s16
    ds_write2_b32 v4, v88, v80 offset0:0 offset1:32
    ds_read_b128 v[132:135], v5
    ds_read_b128 v[136:139], v5 offset:16
    ds_read_b128 v[140:143], v5 offset:32
    ds_read_b128 v[144:147], v5 offset:48
    ds_read_b128 v[148:151], v5 offset:128
    ds_read_b128 v[152:155], v5 offset:144
    ds_read_b128 v[156:159], v5 offset:160
    ds_read_b128 v[160:163], v5 offset:176
    v_cvt_pk_bf16_f32 v100, 0, v100
    v_cvt_pk_bf16_f32 v101, 0, v101
    v_cvt_pk_bf16_f32 v102, 0, v102
    v_cvt_pk_bf16_f32 v103, 0, v103
    v_cvt_pk_bf16_f32 v104, 0, v104
    v_cvt_pk_bf16_f32 v105, 0, v105
    v_cvt_pk_bf16_f32 v106, 0, v106
    v_cvt_pk_bf16_f32 v107, 0, v107
    v_pk_mul_f32 v[100:101], v[100:101], v[116:117] op_sel_hi:[1,0]
    v_pk_mul_f32 v[102:103], v[102:103], v[116:117] op_sel_hi:[1,0]
    v_pk_mul_f32 v[104:105], v[104:105], v[116:117] op_sel_hi:[1,0]
    v_pk_mul_f32 v[106:107], v[106:107], v[116:117] op_sel_hi:[1,0]
    v_cvt_pk_bf16_f32 v100, 0, v100
    v_cvt_pk_bf16_f32 v101, 0, v101
    v_cvt_pk_bf16_f32 v102, 0, v102
    v_cvt_pk_bf16_f32 v103, 0, v103
    v_cvt_pk_bf16_f32 v104, 0, v104
    v_cvt_pk_bf16_f32 v105, 0, v105
    v_cvt_pk_bf16_f32 v106, 0, v106
    v_cvt_pk_bf16_f32 v107, 0, v107
    v_cvt_pk_bf16_f32 v108, 0, v108
    v_cvt_pk_bf16_f32 v109, 0, v109
    v_cvt_pk_bf16_f32 v110, 0, v110
    v_cvt_pk_bf16_f32 v111, 0, v111
    v_cvt_pk_bf16_f32 v112, 0, v112
    v_cvt_pk_bf16_f32 v113, 0, v113
    v_cvt_pk_bf16_f32 v114, 0, v114
    v_cvt_pk_bf16_f32 v115, 0, v115
    v_pk_mul_f32 v[108:109], v[108:109], v[116:117] op_sel_hi:[1,0]
    v_pk_mul_f32 v[110:111], v[110:111], v[116:117] op_sel_hi:[1,0]
    v_pk_mul_f32 v[112:113], v[112:113], v[116:117] op_sel_hi:[1,0]
    v_pk_mul_f32 v[114:115], v[114:115], v[116:117] op_sel_hi:[1,0]
    v_cvt_pk_bf16_f32 v108, 0, v108
    v_cvt_pk_bf16_f32 v109, 0, v109
    v_cvt_pk_bf16_f32 v110, 0, v110
    v_cvt_pk_bf16_f32 v111, 0, v111
    v_cvt_pk_bf16_f32 v112, 0, v112
    v_cvt_pk_bf16_f32 v113, 0, v113
    v_cvt_pk_bf16_f32 v114, 0, v114
    v_cvt_pk_bf16_f32 v115, 0, v115
    s_waitcnt lgkmcnt(6)
    v_pk_mul_f32 v[100:101], v[100:101], v[132:133]
    v_pk_mul_f32 v[102:103], v[102:103], v[134:135]
    v_pk_mul_f32 v[104:105], v[104:105], v[136:137]
    v_pk_mul_f32 v[106:107], v[106:107], v[138:139]
    v_cvt_pk_bf16_f32 v100, 0, v100
    v_cvt_pk_bf16_f32 v101, 0, v101
    v_cvt_pk_bf16_f32 v102, 0, v102
    v_cvt_pk_bf16_f32 v103, 0, v103
    v_cvt_pk_bf16_f32 v104, 0, v104
    v_cvt_pk_bf16_f32 v105, 0, v105
    v_cvt_pk_bf16_f32 v106, 0, v106
    v_cvt_pk_bf16_f32 v107, 0, v107
    s_waitcnt lgkmcnt(2)
    v_pk_add_f32 v[100:101], v[100:101], v[148:149]
    v_pk_add_f32 v[102:103], v[102:103], v[150:151]
    v_pk_add_f32 v[104:105], v[104:105], v[152:153]
    v_pk_add_f32 v[106:107], v[106:107], v[154:155]
    v_cvt_pk_bf16_f32 v124, v100, v101
    v_cvt_pk_bf16_f32 v125, v102, v103
    v_cvt_pk_bf16_f32 v126, v104, v105
    v_cvt_pk_bf16_f32 v127, v106, v107
    buffer_store_dwordx4 v[124:127], v8, s[32:35], s13 offen sc1
    v_pk_mul_f32 v[108:109], v[108:109], v[140:141]
    v_pk_mul_f32 v[110:111], v[110:111], v[142:143]
    v_pk_mul_f32 v[112:113], v[112:113], v[144:145]
    v_pk_mul_f32 v[114:115], v[114:115], v[146:147]
    v_cvt_pk_bf16_f32 v108, 0, v108
    v_cvt_pk_bf16_f32 v109, 0, v109
    v_cvt_pk_bf16_f32 v110, 0, v110
    v_cvt_pk_bf16_f32 v111, 0, v111
    v_cvt_pk_bf16_f32 v112, 0, v112
    v_cvt_pk_bf16_f32 v113, 0, v113
    v_cvt_pk_bf16_f32 v114, 0, v114
    v_cvt_pk_bf16_f32 v115, 0, v115
    s_waitcnt lgkmcnt(0)
    v_pk_add_f32 v[108:109], v[108:109], v[156:157]
    v_pk_add_f32 v[110:111], v[110:111], v[158:159]
    v_pk_add_f32 v[112:113], v[112:113], v[160:161]
    v_pk_add_f32 v[114:115], v[114:115], v[162:163]
    v_cvt_pk_bf16_f32 v128, v108, v109
    v_cvt_pk_bf16_f32 v129, v110, v111
    v_cvt_pk_bf16_f32 v130, v112, v113
    v_cvt_pk_bf16_f32 v131, v114, v115
    buffer_store_dwordx4 v[128:131], v8, s[32:35], s13 offen offset:256 sc1
    v_lshrrev_b32 v66, 5, v1
    v_mul_u32_u24 v66, 2080, v66
    v_bfe_u32 v9, v1, 2, 2
    v_lshl_add_u32 v66, v9, 7, v66
    v_bfe_u32 v9, v1, 3, 1
    v_lshl_add_u32 v66, v9, 6, v66
    v_and_b32 v9, 3, v1
    v_lshl_add_u32 v66, v9, 3, v66
    v_bfe_u32 v67, v1, 4, 1
    v_mul_u32_u24 v67, 1056, v67
    v_bfe_u32 v68, v1, 3, 1
    v_lshlrev_b32 v68, 7, v68
    v_add_u32 v66, v66, v67
    v_sub_u32 v67, v66, v68
    v_add_u32 v67, 64, v67
    v_add_u32 v68, 49920, v66
    v_add_u32 v69, 49920, v67
    v_add_u32 v70, 99840, v66
    v_add_u32 v71, 99840, v67
    s_lshl_b32 s96, s76, 11
    s_add_u32 s14, s96, 156416
    v_bfe_u32 v4, v1, 2, 2
    v_lshl_add_u32 v4, v4, 6, s14
    v_bfe_u32 v9, v1, 4, 1
    v_lshl_add_u32 v4, v9, 5, v4
    v_and_b32 v9, 3, v1
    v_lshl_add_u32 v4, v9, 3, v4
    v_lshrrev_b32 v9, 5, v1
    v_lshl_add_u32 v4, v9, 9, v4
    v_and_b32 v5, 7, v1
    v_lshlrev_b32 v5, 12, v5
    v_bfe_u32 v9, v1, 3, 1
    v_lshl_add_u32 v5, v9, 19, v5
    s_and_b32 s96, s12, 1
    s_lshl_b32 s97, s21, 15
    s_lshr_b32 s98, s12, 1
    s_lshl_b32 s99, s98, 6
    s_add_u32 s98, s97, s99
    s_lshl2_add_u32 s97, s96, s98
    s_add_u32 s13, s97, 1048576
    v_bfe_u32 v6, v1, 4, 1
    v_lshlrev_b32 v6, 6, v6
    v_lshrrev_b32 v9, 5, v1
    v_lshl_add_u32 v6, v9, 4, v6
    v_and_b32 v74, 7, v1
    v_lshlrev_b32 v74, 4, v74
    v_xor_b32 v74, v74, v6
    v_lshrrev_b32 v6, 3, v1
    v_lshlrev_b32 v6, 11, v6
    v_add_u32 v74, v74, v6
    s_and_b32 s96, s3, 2
    s_lshl_b32 s14, s96, 5
    v_bfe_u32 v6, v1, 4, 1
    v_lshl_add_u32 v6, v6, 5, s14
    v_and_b32 v72, 7, v1
    v_lshlrev_b32 v72, 4, v72
    v_xor_b32 v72, v72, v6
    v_lshrrev_b32 v6, 3, v1
    v_mul_u32_u24 v6, 7168, v6
    v_add_u32 v72, v72, v6
    s_and_b32 s96, s3, 1
    s_lshl_b32 s14, s96, 7
    v_lshrrev_b32 v6, 5, v1
    v_lshl_add_u32 v6, v6, 6, s14
    v_and_b32 v73, 31, v1
    v_lshlrev_b32 v73, 4, v73
    v_lshrrev_b32 v9, 5, v1
    v_lshl_add_u32 v73, v9, 11, v73
    v_xor_b32 v73, v73, v6
    s_lshl3_add_u32 s96, s75, s3
    s_mul_i32 s97, s96, 229376
    s_lshl_b32 s98, s74, 7
    s_add_u32 s80, s97, s98
    s_lshl3_add_u32 s96, s74, s3
    s_lshl_b32 s97, s96, 14
    s_lshl_b32 s98, s75, 9
    s_add_u32 s81, s97, s98
    s_lshr_b32 s96, s9, 2
    s_add_u32 s90, s96, 1
    s_cmp_ge_u32 s90, 7
    s_cselect_b32 s90, 4294967290, 1
    s_cmp_ge_u32 s9, 28
    s_cselect_b32 s54, 0, s54
    s_cselect_b32 s58, 0, s58
    s_cselect_b32 s62, 0, s62
    s_waitcnt vmcnt(0)
    s_barrier
    s_cmp_lg_u32 s3, 0
    s_cbranch_scc1 L_PB
    v_mov_b32 v6, s4
    s_mov_b32 exec_hi, 0
    s_mov_b32 exec_lo, 65535
    buffer_store_dword v6, v5, s[32:35], s13 offen sc1
    s_mov_b64 exec, -1
L_PB:
    s_and_b32 s20, s9, 3
    s_cmp_le_u32 s20, 0
    s_cselect_b32 s20, 1, 0
    s_add_u32 s96, s20, s85
    s_and_b32 s97, s96, 15
    s_lshl3_add_u32 s98, s97, s3
    s_mul_i32 s99, s98, 49152
    s_lshl_b32 s96, s11, 7
    s_add_u32 s82, s99, s96
    s_mul_i32 s96, s20, 24960
    s_lshr_b32 s97, s3, 1
    s_mul_i32 s98, s97, 2080
    s_add_u32 s99, s96, s98
    s_and_b32 s97, s3, 1
    s_mul_i32 s96, s97, 1056
    s_add_u32 s20, s99, s96
    s_mov_b32 m0, s20
    s_nop 0
    buffer_load_dwordx4 v62, s[40:43], s82 offen lds
    s_add_u32 s82, s82, 2048
    s_add_u32 m0, s20, 8320
    s_nop 0
    buffer_load_dwordx4 v62, s[40:43], s82 offen lds
    s_add_u32 s82, s82, 2048
    s_add_u32 m0, s20, 16640
    s_nop 0
    buffer_load_dwordx4 v62, s[40:43], s82 offen lds
    s_and_b32 s20, s9, 3
    s_cmp_le_u32 s20, 1
    s_cselect_b32 s20, 2, 1
    s_add_u32 s96, s20, s85
    s_and_b32 s97, s96, 15
    s_lshl3_add_u32 s98, s97, s3
    s_mul_i32 s99, s98, 49152
    s_lshl_b32 s96, s11, 7
    s_add_u32 s82, s99, s96
    s_mul_i32 s96, s20, 24960
    s_lshr_b32 s97, s3, 1
    s_mul_i32 s98, s97, 2080
    s_add_u32 s99, s96, s98
    s_and_b32 s97, s3, 1
    s_mul_i32 s96, s97, 1056
    s_add_u32 s20, s99, s96
    s_mov_b32 m0, s20
    s_nop 0
    buffer_load_dwordx4 v62, s[40:43], s82 offen lds
    s_add_u32 s82, s82, 2048
    s_add_u32 m0, s20, 8320
    s_nop 0
    buffer_load_dwordx4 v62, s[40:43], s82 offen lds
    s_add_u32 s82, s82, 2048
    s_add_u32 m0, s20, 16640
    s_nop 0
    buffer_load_dwordx4 v62, s[40:43], s82 offen lds
    ds_read_b64_tr_b16 v[28:29], v4
    ds_read_b64_tr_b16 v[30:31], v4 offset:256
    ds_read_b64_tr_b16 v[32:33], v4 offset:1024
    ds_read_b64_tr_b16 v[34:35], v4 offset:1280
    s_lshl_b32 s96, s10, 6
    s_add_u32 s97, s96, s3
    s_lshl_b32 s98, s97, 12
    s_add_u32 s15, s98, 4194304
    s_and_b32 s96, s3, 3
    s_lshl_b32 s97, s96, 12
    s_add_u32 s13, s97, 147456
    v_add_u32 v76, s13, v2
    v_and_b32 v77, 15, v1
    v_lshl_add_u32 v77, v77, 4, s13
    v_lshrrev_b32 v9, 5, v1
    v_lshl_add_u32 v77, v9, 9, v77
    v_bfe_u32 v9, v1, 4, 1
    v_lshl_add_u32 v77, v9, 3, v77
    s_and_b32 s96, s3, 3
    s_lshl_b32 s97, s96, 10
    s_add_u32 s13, s97, 32768
    v_and_b32 v78, 15, v1
    v_lshl_add_u32 v78, v78, 5, s13
    v_lshrrev_b32 v9, 4, v1
    v_lshl_add_u32 v78, v9, 3, v78
    s_and_b32 s96, s3, 3
    s_lshl_b32 s97, s96, 10
    s_lshl_b32 s98, s76, 14
    s_add_u32 s13, s97, s98
    v_and_b32 v75, 31, v1
    v_lshl_add_u32 v75, v75, 5, s13
    v_lshrrev_b32 v9, 5, v1
    v_lshl_add_u32 v75, v9, 4, v75
    s_lshl_b32 s84, s3, 14
    s_lshr_b32 s96, s9, 4
    s_lshl_b32 s97, s96, 20
    s_lshl_b32 s98, s12, 7
    s_add_u32 s88, s97, s98
    s_lshl_b32 s89, s3, 10
    s_load_dwordx2 s[24:25], s[32:33], s92 offset:0 glc
    s_and_b32 s20, s9, 3
    s_cmp_le_u32 s20, 2
    s_cselect_b32 s20, 3, 2
    s_add_u32 s96, s20, s85
    s_and_b32 s97, s96, 15
    s_lshl3_add_u32 s98, s97, s3
    s_mul_i32 s99, s98, 49152
    s_lshl_b32 s96, s11, 7
    s_add_u32 s82, s99, s96
    s_mul_i32 s96, s20, 24960
    s_lshr_b32 s97, s3, 1
    s_mul_i32 s98, s97, 2080
    s_add_u32 s99, s96, s98
    s_and_b32 s97, s3, 1
    s_mul_i32 s96, s97, 1056
    s_add_u32 s20, s99, s96
    s_mov_b32 m0, s20
    s_nop 0
    buffer_load_dwordx4 v62, s[40:43], s82 offen lds
    s_add_u32 s82, s82, 2048
    s_add_u32 m0, s20, 8320
    s_nop 0
    buffer_load_dwordx4 v62, s[40:43], s82 offen lds
    s_add_u32 s82, s82, 2048
    s_add_u32 m0, s20, 16640
    s_nop 0
    buffer_load_dwordx4 v62, s[40:43], s82 offen lds
    s_add_u32 s96, s85, 4
    s_and_b32 s97, s96, 15
    s_lshl3_add_u32 s98, s97, s3
    s_mul_i32 s99, s98, 49152
    s_lshl_b32 s96, s11, 7
    s_add_u32 s82, s99, s96
    s_lshr_b32 s96, s3, 1
    s_mul_i32 s97, s96, 2080
    s_and_b32 s98, s3, 1
    s_mul_i32 s99, s98, 1056
    s_add_u32 s96, s97, s99
    s_add_u32 s20, s96, 99840
    s_mov_b32 m0, s20
    s_nop 0
    buffer_load_dwordx4 v62, s[40:43], s82 offen lds
    s_add_u32 s82, s82, 2048
    s_add_u32 m0, s20, 8320
    s_nop 0
    buffer_load_dwordx4 v62, s[40:43], s82 offen lds
    s_add_u32 s82, s82, 2048
    s_add_u32 m0, s20, 16640
    s_nop 0
    buffer_load_dwordx4 v62, s[40:43], s82 offen lds
    s_branch SCHK_12
SPOLL_11:
    s_load_dwordx2 s[24:25], s[32:33], s92 offset:0 glc
SCHK_12:
    s_add_u32 s5, s5, 1
    s_cmp_ge_u32 s5, 300000
    s_waitcnt lgkmcnt(0)
    s_cbranch_scc1 SDONE_13
    s_cmp_lg_u32 s24, s4
    s_cbranch_scc1 SPOLL_11
    s_cmp_lg_u32 s25, s4
    s_cbranch_scc1 SPOLL_11
SDONE_13:
    s_waitcnt vmcnt(9)
    s_barrier
    s_cmp_ge_u32 s3, 4
    s_cbranch_scc1 L_HELP
    s_setprio 2
    s_and_b32 s96, s85, 15
    s_lshl_b32 s97, s96, 14
    s_add_u32 s16, s97, s15
    buffer_load_dwordx4 v[176:179], v2, s[32:35], s16 offen sc1
    buffer_load_dwordx4 v[180:183], v2, s[32:35], s16 offen offset:1024 sc1
    ds_read_b64_tr_b16 v[224:225], v67 offset:8320
    ds_read_b64_tr_b16 v[226:227], v67 offset:8832
    ds_read_b64_tr_b16 v[228:229], v67 offset:8352
    ds_read_b64_tr_b16 v[230:231], v67 offset:8864
    ds_read_b64_tr_b16 v[232:233], v66 offset:8320
    ds_read_b64_tr_b16 v[234:235], v66 offset:8832
    ds_read_b64_tr_b16 v[236:237], v66 offset:8352
    ds_read_b64_tr_b16 v[238:239], v66 offset:8864
    ds_read_b64_tr_b16 v[240:241], v66
    ds_read_b64_tr_b16 v[242:243], v66 offset:512
    ds_read_b64_tr_b16 v[244:245], v66 offset:32
    ds_read_b64_tr_b16 v[246:247], v66 offset:544
    buffer_load_dwordx4 v[184:187], v2, s[32:35], s16 offen offset:2048 sc1
    buffer_load_dwordx4 v[188:191], v2, s[32:35], s16 offen offset:3072 sc1
    s_waitcnt lgkmcnt(8)
    s_waitcnt vmcnt(3)
    v_mfma_f32_16x16x32_bf16 v[128:131], v[224:227], v[176:179], 0
    ds_read_b64_tr_b16 v[248:249], v67
    s_waitcnt vmcnt(2)
    v_mfma_f32_16x16x32_bf16 v[132:135], v[224:227], v[180:183], 0
    ds_read_b64_tr_b16 v[250:251], v67 offset:512
    s_add_u32 s96, s85, 1
    s_and_b32 s97, s96, 15
    s_lshl_b32 s98, s97, 14
    s_add_u32 s16, s98, s15
    buffer_load_dwordx4 v[192:195], v2, s[32:35], s16 offen sc1
    v_mfma_f32_16x16x32_bf16 v[136:139], v[228:231], v[176:179], 0
    ds_read_b64_tr_b16 v[224:225], v67 offset:32
    v_mfma_f32_16x16x32_bf16 v[140:143], v[228:231], v[180:183], 0
    ds_read_b64_tr_b16 v[226:227], v67 offset:544
    s_waitcnt lgkmcnt(8)
    v_mfma_f32_16x16x32_bf16 v[112:115], v[232:235], v[176:179], 0
    ds_read_b64_tr_b16 v[228:229], v66 offset:16640
    v_mfma_f32_16x16x32_bf16 v[116:119], v[232:235], v[180:183], 0
    ds_read_b64_tr_b16 v[230:231], v66 offset:17152
    v_mfma_f32_16x16x32_bf16 v[120:123], v[236:239], v[176:179], 0
    ds_read_b64_tr_b16 v[232:233], v66 offset:16672
    v_mfma_f32_16x16x32_bf16 v[124:127], v[236:239], v[180:183], 0
    ds_read_b64_tr_b16 v[234:235], v66 offset:17184
    buffer_load_dwordx4 v[196:199], v2, s[32:35], s16 offen offset:1024 sc1
    s_waitcnt lgkmcnt(8)
    v_mfma_f32_16x16x32_bf16 v[80:83], v[240:243], v[176:179], 0
    ds_read_b64_tr_b16 v[236:237], v67 offset:16640
    v_mfma_f32_16x16x32_bf16 v[84:87], v[240:243], v[180:183], 0
    ds_read_b64_tr_b16 v[238:239], v67 offset:17152
    v_mfma_f32_16x16x32_bf16 v[88:91], v[244:247], v[176:179], 0
    ds_read_b64_tr_b16 v[240:241], v67 offset:16672
    v_mfma_f32_16x16x32_bf16 v[92:95], v[244:247], v[180:183], 0
    ds_read_b64_tr_b16 v[242:243], v67 offset:17184
    s_waitcnt lgkmcnt(8)
    v_mfma_f32_16x16x32_bf16 v[96:99], v[248:251], v[176:179], 0
    ds_read_b64_tr_b16 v[244:245], v67 offset:12480
    v_mfma_f32_16x16x32_bf16 v[100:103], v[248:251], v[180:183], 0
    ds_read_b64_tr_b16 v[246:247], v67 offset:12992
    buffer_load_dwordx4 v[200:203], v2, s[32:35], s16 offen offset:2048 sc1
    v_mfma_f32_16x16x32_bf16 v[104:107], v[224:227], v[176:179], 0
    ds_read_b64_tr_b16 v[248:249], v67 offset:12512
    v_mfma_f32_16x16x32_bf16 v[108:111], v[224:227], v[180:183], 0
    ds_read_b64_tr_b16 v[250:251], v67 offset:13024
    s_waitcnt lgkmcnt(8)
    v_mfma_f32_16x16x32_bf16 v[144:147], v[228:231], v[176:179], 0
    ds_read_b64_tr_b16 v[224:225], v66 offset:12480
    v_mfma_f32_16x16x32_bf16 v[148:151], v[228:231], v[180:183], 0
    ds_read_b64_tr_b16 v[226:227], v66 offset:12992
    v_mfma_f32_16x16x32_bf16 v[152:155], v[232:235], v[176:179], 0
    ds_read_b64_tr_b16 v[228:229], v66 offset:12512
    v_mfma_f32_16x16x32_bf16 v[156:159], v[232:235], v[180:183], 0
    ds_read_b64_tr_b16 v[230:231], v66 offset:13024
    buffer_load_dwordx4 v[204:207], v2, s[32:35], s16 offen offset:3072 sc1
    s_waitcnt lgkmcnt(8)
    v_mfma_f32_16x16x32_bf16 v[160:163], v[236:239], v[176:179], 0
    ds_read_b64_tr_b16 v[232:233], v66 offset:4160
    v_mfma_f32_16x16x32_bf16 v[164:167], v[236:239], v[180:183], 0
    ds_read_b64_tr_b16 v[234:235], v66 offset:4672
    v_mfma_f32_16x16x32_bf16 v[168:171], v[240:243], v[176:179], 0
    ds_read_b64_tr_b16 v[236:237], v66 offset:4192
    v_mfma_f32_16x16x32_bf16 v[172:175], v[240:243], v[180:183], 0
    ds_read_b64_tr_b16 v[238:239], v66 offset:4704
    s_waitcnt lgkmcnt(8)
    s_waitcnt vmcnt(5)
    v_mfma_f32_16x16x32_bf16 v[128:131], v[244:247], v[184:187], v[128:131]
    ds_read_b64_tr_b16 v[240:241], v67 offset:4160
    s_waitcnt vmcnt(4)
    v_mfma_f32_16x16x32_bf16 v[132:135], v[244:247], v[188:191], v[132:135]
    ds_read_b64_tr_b16 v[242:243], v67 offset:4672
    s_add_u32 s96, s85, 2
    s_and_b32 s97, s96, 15
    s_lshl_b32 s98, s97, 14
    s_add_u32 s16, s98, s15
    buffer_load_dwordx4 v[208:211], v2, s[32:35], s16 offen sc1
    v_mfma_f32_16x16x32_bf16 v[136:139], v[248:251], v[184:187], v[136:139]
    ds_read_b64_tr_b16 v[244:245], v67 offset:4192
    v_mfma_f32_16x16x32_bf16 v[140:143], v[248:251], v[188:191], v[140:143]
    ds_read_b64_tr_b16 v[246:247], v67 offset:4704
    s_waitcnt lgkmcnt(8)
    v_mfma_f32_16x16x32_bf16 v[112:115], v[224:227], v[184:187], v[112:115]
    ds_read_b64_tr_b16 v[248:249], v66 offset:20800
    v_mfma_f32_16x16x32_bf16 v[116:119], v[224:227], v[188:191], v[116:119]
    ds_read_b64_tr_b16 v[250:251], v66 offset:21312
    v_mfma_f32_16x16x32_bf16 v[120:123], v[228:231], v[184:187], v[120:123]
    ds_read_b64_tr_b16 v[224:225], v66 offset:20832
    v_mfma_f32_16x16x32_bf16 v[124:127], v[228:231], v[188:191], v[124:127]
    ds_read_b64_tr_b16 v[226:227], v66 offset:21344
    buffer_load_dwordx4 v[212:215], v2, s[32:35], s16 offen offset:1024 sc1
    s_waitcnt lgkmcnt(8)
    v_mfma_f32_16x16x32_bf16 v[80:83], v[232:235], v[184:187], v[80:83]
    ds_read_b64_tr_b16 v[228:229], v67 offset:20800
    v_mfma_f32_16x16x32_bf16 v[84:87], v[232:235], v[188:191], v[84:87]
    ds_read_b64_tr_b16 v[230:231], v67 offset:21312
    v_mfma_f32_16x16x32_bf16 v[88:91], v[236:239], v[184:187], v[88:91]
    ds_read_b64_tr_b16 v[232:233], v67 offset:20832
    v_mfma_f32_16x16x32_bf16 v[92:95], v[236:239], v[188:191], v[92:95]
    ds_read_b64_tr_b16 v[234:235], v67 offset:21344
    s_waitcnt lgkmcnt(8)
    v_mfma_f32_16x16x32_bf16 v[96:99], v[240:243], v[184:187], v[96:99]
    s_barrier
    ds_read_b64_tr_b16 v[236:237], v67 offset:33280
    v_mfma_f32_16x16x32_bf16 v[100:103], v[240:243], v[188:191], v[100:103]
    ds_read_b64_tr_b16 v[238:239], v67 offset:33792
    buffer_load_dwordx4 v[216:219], v2, s[32:35], s16 offen offset:2048 sc1
    v_mfma_f32_16x16x32_bf16 v[104:107], v[244:247], v[184:187], v[104:107]
    ds_read_b64_tr_b16 v[240:241], v67 offset:33312
    v_mfma_f32_16x16x32_bf16 v[108:111], v[244:247], v[188:191], v[108:111]
    ds_read_b64_tr_b16 v[242:243], v67 offset:33824
    s_waitcnt lgkmcnt(8)
    v_mfma_f32_16x16x32_bf16 v[144:147], v[248:251], v[184:187], v[144:147]
    ds_read_b64_tr_b16 v[244:245], v66 offset:33280
    v_mfma_f32_16x16x32_bf16 v[148:151], v[248:251], v[188:191], v[148:151]
    ds_read_b64_tr_b16 v[246:247], v66 offset:33792
    v_mfma_f32_16x16x32_bf16 v[152:155], v[224:227], v[184:187], v[152:155]
    ds_read_b64_tr_b16 v[248:249], v66 offset:33312
    v_mfma_f32_16x16x32_bf16 v[156:159], v[224:227], v[188:191], v[156:159]
    ds_read_b64_tr_b16 v[250:251], v66 offset:33824
    buffer_load_dwordx4 v[220:223], v2, s[32:35], s16 offen offset:3072 sc1
    s_waitcnt lgkmcnt(8)
    v_mfma_f32_16x16x32_bf16 v[160:163], v[228:231], v[184:187], v[160:163]
    ds_read_b64_tr_b16 v[224:225], v66 offset:24960
    v_mfma_f32_16x16x32_bf16 v[164:167], v[228:231], v[188:191], v[164:167]
    ds_read_b64_tr_b16 v[226:227], v66 offset:25472
    v_mfma_f32_16x16x32_bf16 v[168:171], v[232:235], v[184:187], v[168:171]
    ds_read_b64_tr_b16 v[228:229], v66 offset:24992
    v_mfma_f32_16x16x32_bf16 v[172:175], v[232:235], v[188:191], v[172:175]
    ds_read_b64_tr_b16 v[230:231], v66 offset:25504
    s_waitcnt lgkmcnt(8)
    s_waitcnt vmcnt(6)
    v_mfma_f32_16x16x32_bf16 v[128:131], v[236:239], v[192:195], v[128:131]
    ds_read_b64_tr_b16 v[232:233], v67 offset:24960
    v_mfma_f32_16x16x32_bf16 v[132:135], v[236:239], v[196:199], v[132:135]
    ds_read_b64_tr_b16 v[234:235], v67 offset:25472
    s_add_u32 s96, s85, 3
    s_and_b32 s97, s96, 15
    s_lshl_b32 s98, s97, 14
    s_add_u32 s16, s98, s15
    buffer_load_dwordx4 v[36:39], v2, s[32:35], s16 offen sc1
    v_mfma_f32_16x16x32_bf16 v[136:139], v[240:243], v[192:195], v[136:139]
    ds_read_b64_tr_b16 v[236:237], v67 offset:24992
    v_mfma_f32_16x16x32_bf16 v[140:143], v[240:243], v[196:199], v[140:143]
    ds_read_b64_tr_b16 v[238:239], v67 offset:25504
    s_waitcnt lgkmcnt(8)
    v_mfma_f32_16x16x32_bf16 v[112:115], v[244:247], v[192:195], v[112:115]
    ds_read_b64_tr_b16 v[240:241], v66 offset:41600
    v_mfma_f32_16x16x32_bf16 v[116:119], v[244:247], v[196:199], v[116:119]
    ds_read_b64_tr_b16 v[242:243], v66 offset:42112
    v_mfma_f32_16x16x32_bf16 v[120:123], v[248:251], v[192:195], v[120:123]
    ds_read_b64_tr_b16 v[244:245], v66 offset:41632
    v_mfma_f32_16x16x32_bf16 v[124:127], v[248:251], v[196:199], v[124:127]
    ds_read_b64_tr_b16 v[246:247], v66 offset:42144
    buffer_load_dwordx4 v[176:179], v2, s[32:35], s16 offen offset:1024 sc1
    s_waitcnt lgkmcnt(8)
    v_mfma_f32_16x16x32_bf16 v[80:83], v[224:227], v[192:195], v[80:83]
    ds_read_b64_tr_b16 v[248:249], v67 offset:41600
    v_mfma_f32_16x16x32_bf16 v[84:87], v[224:227], v[196:199], v[84:87]
    ds_read_b64_tr_b16 v[250:251], v67 offset:42112
    v_mfma_f32_16x16x32_bf16 v[88:91], v[228:231], v[192:195], v[88:91]
    ds_read_b64_tr_b16 v[224:225], v67 offset:41632
    v_mfma_f32_16x16x32_bf16 v[92:95], v[228:231], v[196:199], v[92:95]
    ds_read_b64_tr_b16 v[226:227], v67 offset:42144
    s_waitcnt lgkmcnt(8)
    v_mfma_f32_16x16x32_bf16 v[96:99], v[232:235], v[192:195], v[96:99]
    ds_read_b64_tr_b16 v[228:229], v67 offset:37440
    v_mfma_f32_16x16x32_bf16 v[100:103], v[232:235], v[196:199], v[100:103]
    ds_read_b64_tr_b16 v[230:231], v67 offset:37952
    buffer_load_dwordx4 v[180:183], v2, s[32:35], s16 offen offset:2048 sc1
    v_mfma_f32_16x16x32_bf16 v[104:107], v[236:239], v[192:195], v[104:107]
    ds_read_b64_tr_b16 v[232:233], v67 offset:37472
    v_mfma_f32_16x16x32_bf16 v[108:111], v[236:239], v[196:199], v[108:111]
    ds_read_b64_tr_b16 v[234:235], v67 offset:37984
    s_waitcnt lgkmcnt(8)
    v_mfma_f32_16x16x32_bf16 v[144:147], v[240:243], v[192:195], v[144:147]
    ds_read_b64_tr_b16 v[236:237], v66 offset:37440
    v_mfma_f32_16x16x32_bf16 v[148:151], v[240:243], v[196:199], v[148:151]
    ds_read_b64_tr_b16 v[238:239], v66 offset:37952
    v_mfma_f32_16x16x32_bf16 v[152:155], v[244:247], v[192:195], v[152:155]
    ds_read_b64_tr_b16 v[240:241], v66 offset:37472
    v_mfma_f32_16x16x32_bf16 v[156:159], v[244:247], v[196:199], v[156:159]
    ds_read_b64_tr_b16 v[242:243], v66 offset:37984
    buffer_load_dwordx4 v[184:187], v2, s[32:35], s16 offen offset:3072 sc1
    s_waitcnt lgkmcnt(8)
    v_mfma_f32_16x16x32_bf16 v[160:163], v[248:251], v[192:195], v[160:163]
    ds_read_b64_tr_b16 v[244:245], v66 offset:29120
    v_mfma_f32_16x16x32_bf16 v[164:167], v[248:251], v[196:199], v[164:167]
    ds_read_b64_tr_b16 v[246:247], v66 offset:29632
    v_mfma_f32_16x16x32_bf16 v[168:171], v[224:227], v[192:195], v[168:171]
    ds_read_b64_tr_b16 v[248:249], v66 offset:29152
    v_mfma_f32_16x16x32_bf16 v[172:175], v[224:227], v[196:199], v[172:175]
    ds_read_b64_tr_b16 v[250:251], v66 offset:29664
    s_waitcnt lgkmcnt(8)
    s_waitcnt vmcnt(8)
    v_mfma_f32_16x16x32_bf16 v[128:131], v[228:231], v[200:203], v[128:131]
    ds_read_b64_tr_b16 v[224:225], v67 offset:29120
    v_mfma_f32_16x16x32_bf16 v[132:135], v[228:231], v[204:207], v[132:135]
    ds_read_b64_tr_b16 v[226:227], v67 offset:29632
    s_add_u32 s96, s85, 4
    s_and_b32 s97, s96, 15
    s_lshl_b32 s98, s97, 14
    s_add_u32 s16, s98, s15
    buffer_load_dwordx4 v[188:191], v2, s[32:35], s16 offen sc1
    v_mfma_f32_16x16x32_bf16 v[136:139], v[232:235], v[200:203], v[136:139]
    ds_read_b64_tr_b16 v[228:229], v67 offset:29152
    v_mfma_f32_16x16x32_bf16 v[140:143], v[232:235], v[204:207], v[140:143]
    ds_read_b64_tr_b16 v[230:231], v67 offset:29664
    s_waitcnt lgkmcnt(8)
    v_mfma_f32_16x16x32_bf16 v[112:115], v[236:239], v[200:203], v[112:115]
    ds_read_b64_tr_b16 v[232:233], v66 offset:45760
    v_mfma_f32_16x16x32_bf16 v[116:119], v[236:239], v[204:207], v[116:119]
    ds_read_b64_tr_b16 v[234:235], v66 offset:46272
    v_mfma_f32_16x16x32_bf16 v[120:123], v[240:243], v[200:203], v[120:123]
    ds_read_b64_tr_b16 v[236:237], v66 offset:45792
    v_mfma_f32_16x16x32_bf16 v[124:127], v[240:243], v[204:207], v[124:127]
    ds_read_b64_tr_b16 v[238:239], v66 offset:46304
    buffer_load_dwordx4 v[192:195], v2, s[32:35], s16 offen offset:1024 sc1
    s_waitcnt lgkmcnt(8)
    v_mfma_f32_16x16x32_bf16 v[80:83], v[244:247], v[200:203], v[80:83]
    ds_read_b64_tr_b16 v[240:241], v67 offset:45760
    v_mfma_f32_16x16x32_bf16 v[84:87], v[244:247], v[204:207], v[84:87]
    ds_read_b64_tr_b16 v[242:243], v67 offset:46272
    v_mfma_f32_16x16x32_bf16 v[88:91], v[248:251], v[200:203], v[88:91]
    ds_read_b64_tr_b16 v[244:245], v67 offset:45792
    v_mfma_f32_16x16x32_bf16 v[92:95], v[248:251], v[204:207], v[92:95]
    ds_read_b64_tr_b16 v[246:247], v67 offset:46304
    s_waitcnt lgkmcnt(8)
    v_mfma_f32_16x16x32_bf16 v[96:99], v[224:227], v[200:203], v[96:99]
    s_barrier
    ds_read_b64_tr_b16 v[248:249], v69 offset:8320
    v_mfma_f32_16x16x32_bf16 v[100:103], v[224:227], v[204:207], v[100:103]
    ds_read_b64_tr_b16 v[250:251], v69 offset:8832
    buffer_load_dwordx4 v[196:199], v2, s[32:35], s16 offen offset:2048 sc1
    v_mfma_f32_16x16x32_bf16 v[104:107], v[228:231], v[200:203], v[104:107]
    ds_read_b64_tr_b16 v[224:225], v69 offset:8352
    v_mfma_f32_16x16x32_bf16 v[108:111], v[228:231], v[204:207], v[108:111]
    ds_read_b64_tr_b16 v[226:227], v69 offset:8864
    s_waitcnt lgkmcnt(8)
    v_mfma_f32_16x16x32_bf16 v[144:147], v[232:235], v[200:203], v[144:147]
    ds_read_b64_tr_b16 v[228:229], v68 offset:8320
    v_mfma_f32_16x16x32_bf16 v[148:151], v[232:235], v[204:207], v[148:151]
    ds_read_b64_tr_b16 v[230:231], v68 offset:8832
    v_mfma_f32_16x16x32_bf16 v[152:155], v[236:239], v[200:203], v[152:155]
    ds_read_b64_tr_b16 v[232:233], v68 offset:8352
    v_mfma_f32_16x16x32_bf16 v[156:159], v[236:239], v[204:207], v[156:159]
    ds_read_b64_tr_b16 v[234:235], v68 offset:8864
    s_waitcnt lgkmcnt(8)
    v_mfma_f32_16x16x32_bf16 v[160:163], v[240:243], v[200:203], v[160:163]
    ds_read_b64_tr_b16 v[236:237], v68
    v_mfma_f32_16x16x32_bf16 v[164:167], v[240:243], v[204:207], v[164:167]
    ds_read_b64_tr_b16 v[238:239], v68 offset:512
    v_mfma_f32_16x16x32_bf16 v[168:171], v[244:247], v[200:203], v[168:171]
    ds_read_b64_tr_b16 v[240:241], v68 offset:32
    v_mfma_f32_16x16x32_bf16 v[172:175], v[244:247], v[204:207], v[172:175]
    ds_read_b64_tr_b16 v[242:243], v68 offset:544
    s_waitcnt lgkmcnt(8)
    s_waitcnt vmcnt(9)
    v_mfma_f32_16x16x32_bf16 v[128:131], v[248:251], v[208:211], v[128:131]
    ds_read_b64_tr_b16 v[244:245], v69
    v_mfma_f32_16x16x32_bf16 v[132:135], v[248:251], v[212:215], v[132:135]
    ds_read_b64_tr_b16 v[246:247], v69 offset:512
    buffer_load_dwordx4 v[200:203], v2, s[32:35], s16 offen offset:3072 sc1
    v_mfma_f32_16x16x32_bf16 v[136:139], v[224:227], v[208:211], v[136:139]
    ds_read_b64_tr_b16 v[248:249], v69 offset:32
    v_mfma_f32_16x16x32_bf16 v[140:143], v[224:227], v[212:215], v[140:143]
    ds_read_b64_tr_b16 v[250:251], v69 offset:544
    s_waitcnt lgkmcnt(8)
    v_mfma_f32_16x16x32_bf16 v[112:115], v[228:231], v[208:211], v[112:115]
    ds_read_b64_tr_b16 v[224:225], v68 offset:16640
    v_mfma_f32_16x16x32_bf16 v[116:119], v[228:231], v[212:215], v[116:119]
    ds_read_b64_tr_b16 v[226:227], v68 offset:17152
    v_mfma_f32_16x16x32_bf16 v[120:123], v[232:235], v[208:211], v[120:123]
    ds_read_b64_tr_b16 v[228:229], v68 offset:16672
    v_mfma_f32_16x16x32_bf16 v[124:127], v[232:235], v[212:215], v[124:127]
    ds_read_b64_tr_b16 v[230:231], v68 offset:17184
    s_add_u32 s96, s85, 5
    s_and_b32 s97, s96, 15
    s_lshl_b32 s98, s97, 14
    s_add_u32 s16, s98, s15
    buffer_load_dwordx4 v[204:207], v2, s[32:35], s16 offen sc1
    s_waitcnt lgkmcnt(8)
    v_mfma_f32_16x16x32_bf16 v[80:83], v[236:239], v[208:211], v[80:83]
    ds_read_b64_tr_b16 v[232:233], v69 offset:16640
    v_mfma_f32_16x16x32_bf16 v[84:87], v[236:239], v[212:215], v[84:87]
    ds_read_b64_tr_b16 v[234:235], v69 offset:17152
    v_mfma_f32_16x16x32_bf16 v[88:91], v[240:243], v[208:211], v[88:91]
    ds_read_b64_tr_b16 v[236:237], v69 offset:16672
    v_mfma_f32_16x16x32_bf16 v[92:95], v[240:243], v[212:215], v[92:95]
    ds_read_b64_tr_b16 v[238:239], v69 offset:17184
    s_waitcnt lgkmcnt(8)
    v_mfma_f32_16x16x32_bf16 v[96:99], v[244:247], v[208:211], v[96:99]
    ds_read_b64_tr_b16 v[240:241], v69 offset:12480
    v_mfma_f32_16x16x32_bf16 v[100:103], v[244:247], v[212:215], v[100:103]
    ds_read_b64_tr_b16 v[242:243], v69 offset:12992
    v_mfma_f32_16x16x32_bf16 v[104:107], v[248:251], v[208:211], v[104:107]
    ds_read_b64_tr_b16 v[244:245], v69 offset:12512
    v_mfma_f32_16x16x32_bf16 v[108:111], v[248:251], v[212:215], v[108:111]
    ds_read_b64_tr_b16 v[246:247], v69 offset:13024
    s_waitcnt lgkmcnt(8)
    v_mfma_f32_16x16x32_bf16 v[144:147], v[224:227], v[208:211], v[144:147]
    ds_read_b64_tr_b16 v[248:249], v68 offset:12480
    v_mfma_f32_16x16x32_bf16 v[148:151], v[224:227], v[212:215], v[148:151]
    ds_read_b64_tr_b16 v[250:251], v68 offset:12992
    v_mfma_f32_16x16x32_bf16 v[152:155], v[228:231], v[208:211], v[152:155]
    ds_read_b64_tr_b16 v[224:225], v68 offset:12512
    v_mfma_f32_16x16x32_bf16 v[156:159], v[228:231], v[212:215], v[156:159]
    ds_read_b64_tr_b16 v[226:227], v68 offset:13024
    s_waitcnt lgkmcnt(8)
    v_mfma_f32_16x16x32_bf16 v[160:163], v[232:235], v[208:211], v[160:163]
    ds_read_b64_tr_b16 v[228:229], v68 offset:4160
    v_mfma_f32_16x16x32_bf16 v[164:167], v[232:235], v[212:215], v[164:167]
    ds_read_b64_tr_b16 v[230:231], v68 offset:4672
    v_mfma_f32_16x16x32_bf16 v[168:171], v[236:239], v[208:211], v[168:171]
    ds_read_b64_tr_b16 v[232:233], v68 offset:4192
    v_mfma_f32_16x16x32_bf16 v[172:175], v[236:239], v[212:215], v[172:175]
    ds_read_b64_tr_b16 v[234:235], v68 offset:4704
    s_waitcnt lgkmcnt(8)
    s_waitcnt vmcnt(9)
    v_mfma_f32_16x16x32_bf16 v[128:131], v[240:243], v[216:219], v[128:131]
    ds_read_b64_tr_b16 v[236:237], v69 offset:4160
    v_mfma_f32_16x16x32_bf16 v[132:135], v[240:243], v[220:223], v[132:135]
    ds_read_b64_tr_b16 v[238:239], v69 offset:4672
    buffer_load_dwordx4 v[208:211], v2, s[32:35], s16 offen offset:1024 sc1
    v_mfma_f32_16x16x32_bf16 v[136:139], v[244:247], v[216:219], v[136:139]
    ds_read_b64_tr_b16 v[240:241], v69 offset:4192
    v_mfma_f32_16x16x32_bf16 v[140:143], v[244:247], v[220:223], v[140:143]
    ds_read_b64_tr_b16 v[242:243], v69 offset:4704
    s_waitcnt lgkmcnt(8)
    v_mfma_f32_16x16x32_bf16 v[112:115], v[248:251], v[216:219], v[112:115]
    ds_read_b64_tr_b16 v[244:245], v68 offset:20800
    v_mfma_f32_16x16x32_bf16 v[116:119], v[248:251], v[220:223], v[116:119]
    ds_read_b64_tr_b16 v[246:247], v68 offset:21312
    v_mfma_f32_16x16x32_bf16 v[120:123], v[224:227], v[216:219], v[120:123]
    ds_read_b64_tr_b16 v[248:249], v68 offset:20832
    v_mfma_f32_16x16x32_bf16 v[124:127], v[224:227], v[220:223], v[124:127]
    ds_read_b64_tr_b16 v[250:251], v68 offset:21344
    buffer_load_dwordx4 v[212:215], v2, s[32:35], s16 offen offset:2048 sc1
    s_waitcnt lgkmcnt(8)
    v_mfma_f32_16x16x32_bf16 v[80:83], v[228:231], v[216:219], v[80:83]
    ds_read_b64_tr_b16 v[224:225], v69 offset:20800
    v_mfma_f32_16x16x32_bf16 v[84:87], v[228:231], v[220:223], v[84:87]
    ds_read_b64_tr_b16 v[226:227], v69 offset:21312
    v_mfma_f32_16x16x32_bf16 v[88:91], v[232:235], v[216:219], v[88:91]
    ds_read_b64_tr_b16 v[228:229], v69 offset:20832
    v_mfma_f32_16x16x32_bf16 v[92:95], v[232:235], v[220:223], v[92:95]
    ds_read_b64_tr_b16 v[230:231], v69 offset:21344
    s_waitcnt lgkmcnt(8)
    v_mfma_f32_16x16x32_bf16 v[96:99], v[236:239], v[216:219], v[96:99]
    s_barrier
    ds_read_b64_tr_b16 v[232:233], v69 offset:33280
    v_mfma_f32_16x16x32_bf16 v[100:103], v[236:239], v[220:223], v[100:103]
    ds_read_b64_tr_b16 v[234:235], v69 offset:33792
    v_mfma_f32_16x16x32_bf16 v[104:107], v[240:243], v[216:219], v[104:107]
    ds_read_b64_tr_b16 v[236:237], v69 offset:33312
    v_mfma_f32_16x16x32_bf16 v[108:111], v[240:243], v[220:223], v[108:111]
    ds_read_b64_tr_b16 v[238:239], v69 offset:33824
    s_waitcnt lgkmcnt(8)
    v_mfma_f32_16x16x32_bf16 v[144:147], v[244:247], v[216:219], v[144:147]
    ds_read_b64_tr_b16 v[240:241], v68 offset:33280
    v_mfma_f32_16x16x32_bf16 v[148:151], v[244:247], v[220:223], v[148:151]
    ds_read_b64_tr_b16 v[242:243], v68 offset:33792
    v_mfma_f32_16x16x32_bf16 v[152:155], v[248:251], v[216:219], v[152:155]
    ds_read_b64_tr_b16 v[244:245], v68 offset:33312
    v_mfma_f32_16x16x32_bf16 v[156:159], v[248:251], v[220:223], v[156:159]
    ds_read_b64_tr_b16 v[246:247], v68 offset:33824
    s_waitcnt lgkmcnt(8)
    v_mfma_f32_16x16x32_bf16 v[160:163], v[224:227], v[216:219], v[160:163]
    ds_read_b64_tr_b16 v[248:249], v68 offset:24960
    v_mfma_f32_16x16x32_bf16 v[164:167], v[224:227], v[220:223], v[164:167]
    ds_read_b64_tr_b16 v[250:251], v68 offset:25472
    v_mfma_f32_16x16x32_bf16 v[168:171], v[228:231], v[216:219], v[168:171]
    ds_read_b64_tr_b16 v[224:225], v68 offset:24992
    v_mfma_f32_16x16x32_bf16 v[172:175], v[228:231], v[220:223], v[172:175]
    ds_read_b64_tr_b16 v[226:227], v68 offset:25504
    s_waitcnt lgkmcnt(8)
    s_waitcnt vmcnt(9)
    v_mfma_f32_16x16x32_bf16 v[128:131], v[232:235], v[36:39], v[128:131]
    ds_read_b64_tr_b16 v[228:229], v69 offset:24960
    v_mfma_f32_16x16x32_bf16 v[132:135], v[232:235], v[176:179], v[132:135]
    ds_read_b64_tr_b16 v[230:231], v69 offset:25472
    buffer_load_dwordx4 v[216:219], v2, s[32:35], s16 offen offset:3072 sc1
    v_mfma_f32_16x16x32_bf16 v[136:139], v[236:239], v[36:39], v[136:139]
    ds_read_b64_tr_b16 v[232:233], v69 offset:24992
    v_mfma_f32_16x16x32_bf16 v[140:143], v[236:239], v[176:179], v[140:143]
    ds_read_b64_tr_b16 v[234:235], v69 offset:25504
    s_waitcnt lgkmcnt(8)
    v_mfma_f32_16x16x32_bf16 v[112:115], v[240:243], v[36:39], v[112:115]
    ds_read_b64_tr_b16 v[236:237], v68 offset:41600
    v_mfma_f32_16x16x32_bf16 v[116:119], v[240:243], v[176:179], v[116:119]
    ds_read_b64_tr_b16 v[238:239], v68 offset:42112
    v_mfma_f32_16x16x32_bf16 v[120:123], v[244:247], v[36:39], v[120:123]
    ds_read_b64_tr_b16 v[240:241], v68 offset:41632
    v_mfma_f32_16x16x32_bf16 v[124:127], v[244:247], v[176:179], v[124:127]
    ds_read_b64_tr_b16 v[242:243], v68 offset:42144
    s_add_u32 s96, s85, 6
    s_and_b32 s97, s96, 15
    s_lshl_b32 s98, s97, 14
    s_add_u32 s16, s98, s15
    buffer_load_dwordx4 v[220:223], v2, s[32:35], s16 offen sc1
    s_waitcnt lgkmcnt(8)
    v_mfma_f32_16x16x32_bf16 v[80:83], v[248:251], v[36:39], v[80:83]
    ds_read_b64_tr_b16 v[244:245], v69 offset:41600
    v_mfma_f32_16x16x32_bf16 v[84:87], v[248:251], v[176:179], v[84:87]
    ds_read_b64_tr_b16 v[246:247], v69 offset:42112
    v_mfma_f32_16x16x32_bf16 v[88:91], v[224:227], v[36:39], v[88:91]
    ds_read_b64_tr_b16 v[248:249], v69 offset:41632
    v_mfma_f32_16x16x32_bf16 v[92:95], v[224:227], v[176:179], v[92:95]
    ds_read_b64_tr_b16 v[250:251], v69 offset:42144
    s_waitcnt lgkmcnt(8)
    v_mfma_f32_16x16x32_bf16 v[96:99], v[228:231], v[36:39], v[96:99]
    ds_read_b64_tr_b16 v[224:225], v69 offset:37440
    v_mfma_f32_16x16x32_bf16 v[100:103], v[228:231], v[176:179], v[100:103]
    ds_read_b64_tr_b16 v[226:227], v69 offset:37952
    v_mfma_f32_16x16x32_bf16 v[104:107], v[232:235], v[36:39], v[104:107]
    ds_read_b64_tr_b16 v[228:229], v69 offset:37472
    v_mfma_f32_16x16x32_bf16 v[108:111], v[232:235], v[176:179], v[108:111]
    ds_read_b64_tr_b16 v[230:231], v69 offset:37984
    s_waitcnt lgkmcnt(8)
    v_mfma_f32_16x16x32_bf16 v[144:147], v[236:239], v[36:39], v[144:147]
    ds_read_b64_tr_b16 v[232:233], v68 offset:37440
    v_mfma_f32_16x16x32_bf16 v[148:151], v[236:239], v[176:179], v[148:151]
    ds_read_b64_tr_b16 v[234:235], v68 offset:37952
    v_mfma_f32_16x16x32_bf16 v[152:155], v[240:243], v[36:39], v[152:155]
    ds_read_b64_tr_b16 v[236:237], v68 offset:37472
    v_mfma_f32_16x16x32_bf16 v[156:159], v[240:243], v[176:179], v[156:159]
    ds_read_b64_tr_b16 v[238:239], v68 offset:37984
    s_waitcnt lgkmcnt(8)
    v_mfma_f32_16x16x32_bf16 v[160:163], v[244:247], v[36:39], v[160:163]
    ds_read_b64_tr_b16 v[240:241], v68 offset:29120
    v_mfma_f32_16x16x32_bf16 v[164:167], v[244:247], v[176:179], v[164:167]
    ds_read_b64_tr_b16 v[242:243], v68 offset:29632
    v_mfma_f32_16x16x32_bf16 v[168:171], v[248:251], v[36:39], v[168:171]
    ds_read_b64_tr_b16 v[244:245], v68 offset:29152
    v_mfma_f32_16x16x32_bf16 v[172:175], v[248:251], v[176:179], v[172:175]
    ds_read_b64_tr_b16 v[246:247], v68 offset:29664
    s_waitcnt lgkmcnt(8)
    s_waitcnt vmcnt(9)
    v_mfma_f32_16x16x32_bf16 v[128:131], v[224:227], v[180:183], v[128:131]
    ds_read_b64_tr_b16 v[248:249], v69 offset:29120
    v_mfma_f32_16x16x32_bf16 v[132:135], v[224:227], v[184:187], v[132:135]
    ds_read_b64_tr_b16 v[250:251], v69 offset:29632
    buffer_load_dwordx4 v[36:39], v2, s[32:35], s16 offen offset:1024 sc1
    v_mfma_f32_16x16x32_bf16 v[136:139], v[228:231], v[180:183], v[136:139]
    ds_read_b64_tr_b16 v[224:225], v69 offset:29152
    v_mfma_f32_16x16x32_bf16 v[140:143], v[228:231], v[184:187], v[140:143]
    ds_read_b64_tr_b16 v[226:227], v69 offset:29664
    s_waitcnt lgkmcnt(8)
    v_mfma_f32_16x16x32_bf16 v[112:115], v[232:235], v[180:183], v[112:115]
    ds_read_b64_tr_b16 v[228:229], v68 offset:45760
    v_mfma_f32_16x16x32_bf16 v[116:119], v[232:235], v[184:187], v[116:119]
    ds_read_b64_tr_b16 v[230:231], v68 offset:46272
    v_mfma_f32_16x16x32_bf16 v[120:123], v[236:239], v[180:183], v[120:123]
    ds_read_b64_tr_b16 v[232:233], v68 offset:45792
    v_mfma_f32_16x16x32_bf16 v[124:127], v[236:239], v[184:187], v[124:127]
    ds_read_b64_tr_b16 v[234:235], v68 offset:46304
    buffer_load_dwordx4 v[176:179], v2, s[32:35], s16 offen offset:2048 sc1
    s_waitcnt lgkmcnt(8)
    v_mfma_f32_16x16x32_bf16 v[80:83], v[240:243], v[180:183], v[80:83]
    ds_read_b64_tr_b16 v[236:237], v69 offset:45760
    v_mfma_f32_16x16x32_bf16 v[84:87], v[240:243], v[184:187], v[84:87]
    ds_read_b64_tr_b16 v[238:239], v69 offset:46272
    v_mfma_f32_16x16x32_bf16 v[88:91], v[244:247], v[180:183], v[88:91]
    ds_read_b64_tr_b16 v[240:241], v69 offset:45792
    v_mfma_f32_16x16x32_bf16 v[92:95], v[244:247], v[184:187], v[92:95]
    ds_read_b64_tr_b16 v[242:243], v69 offset:46304
    s_waitcnt lgkmcnt(8)
    v_mfma_f32_16x16x32_bf16 v[96:99], v[248:251], v[180:183], v[96:99]
    s_barrier
    ds_read_b64_tr_b16 v[244:245], v71 offset:8320
    v_mfma_f32_16x16x32_bf16 v[100:103], v[248:251], v[184:187], v[100:103]
    ds_read_b64_tr_b16 v[246:247], v71 offset:8832
    v_mfma_f32_16x16x32_bf16 v[104:107], v[224:227], v[180:183], v[104:107]
    ds_read_b64_tr_b16 v[248:249], v71 offset:8352
    v_mfma_f32_16x16x32_bf16 v[108:111], v[224:227], v[184:187], v[108:111]
    ds_read_b64_tr_b16 v[250:251], v71 offset:8864
    s_waitcnt lgkmcnt(8)
    v_mfma_f32_16x16x32_bf16 v[144:147], v[228:231], v[180:183], v[144:147]
    ds_read_b64_tr_b16 v[224:225], v70 offset:8320
    v_mfma_f32_16x16x32_bf16 v[148:151], v[228:231], v[184:187], v[148:151]
    ds_read_b64_tr_b16 v[226:227], v70 offset:8832
    v_mfma_f32_16x16x32_bf16 v[152:155], v[232:235], v[180:183], v[152:155]
    ds_read_b64_tr_b16 v[228:229], v70 offset:8352
    v_mfma_f32_16x16x32_bf16 v[156:159], v[232:235], v[184:187], v[156:159]
    ds_read_b64_tr_b16 v[230:231], v70 offset:8864
    s_waitcnt lgkmcnt(8)
    v_mfma_f32_16x16x32_bf16 v[160:163], v[236:239], v[180:183], v[160:163]
    ds_read_b64_tr_b16 v[232:233], v70
    v_mfma_f32_16x16x32_bf16 v[164:167], v[236:239], v[184:187], v[164:167]
    ds_read_b64_tr_b16 v[234:235], v70 offset:512
    v_mfma_f32_16x16x32_bf16 v[168:171], v[240:243], v[180:183], v[168:171]
    ds_read_b64_tr_b16 v[236:237], v70 offset:32
    v_mfma_f32_16x16x32_bf16 v[172:175], v[240:243], v[184:187], v[172:175]
    ds_read_b64_tr_b16 v[238:239], v70 offset:544
    s_waitcnt lgkmcnt(8)
    s_waitcnt vmcnt(9)
    v_mfma_f32_16x16x32_bf16 v[128:131], v[244:247], v[188:191], v[128:131]
    ds_read_b64_tr_b16 v[240:241], v71
    v_mfma_f32_16x16x32_bf16 v[132:135], v[244:247], v[192:195], v[132:135]
    ds_read_b64_tr_b16 v[242:243], v71 offset:512
    buffer_load_dwordx4 v[180:183], v2, s[32:35], s16 offen offset:3072 sc1
    v_mfma_f32_16x16x32_bf16 v[136:139], v[248:251], v[188:191], v[136:139]
    ds_read_b64_tr_b16 v[244:245], v71 offset:32
    v_mfma_f32_16x16x32_bf16 v[140:143], v[248:251], v[192:195], v[140:143]
    ds_read_b64_tr_b16 v[246:247], v71 offset:544
    s_waitcnt lgkmcnt(8)
    v_mfma_f32_16x16x32_bf16 v[112:115], v[224:227], v[188:191], v[112:115]
    ds_read_b64_tr_b16 v[248:249], v70 offset:16640
    v_mfma_f32_16x16x32_bf16 v[116:119], v[224:227], v[192:195], v[116:119]
    ds_read_b64_tr_b16 v[250:251], v70 offset:17152
    v_mfma_f32_16x16x32_bf16 v[120:123], v[228:231], v[188:191], v[120:123]
    ds_read_b64_tr_b16 v[224:225], v70 offset:16672
    v_mfma_f32_16x16x32_bf16 v[124:127], v[228:231], v[192:195], v[124:127]
    ds_read_b64_tr_b16 v[226:227], v70 offset:17184
    s_add_u32 s96, s85, 7
    s_and_b32 s97, s96, 15
    s_lshl_b32 s98, s97, 14
    s_add_u32 s16, s98, s15
    buffer_load_dwordx4 v[184:187], v2, s[32:35], s16 offen sc1
    s_waitcnt lgkmcnt(8)
    v_mfma_f32_16x16x32_bf16 v[80:83], v[232:235], v[188:191], v[80:83]
    ds_read_b64_tr_b16 v[228:229], v71 offset:16640
    v_mfma_f32_16x16x32_bf16 v[84:87], v[232:235], v[192:195], v[84:87]
    ds_read_b64_tr_b16 v[230:231], v71 offset:17152
    v_mfma_f32_16x16x32_bf16 v[88:91], v[236:239], v[188:191], v[88:91]
    ds_read_b64_tr_b16 v[232:233], v71 offset:16672
    v_mfma_f32_16x16x32_bf16 v[92:95], v[236:239], v[192:195], v[92:95]
    ds_read_b64_tr_b16 v[234:235], v71 offset:17184
    s_waitcnt lgkmcnt(8)
    v_mfma_f32_16x16x32_bf16 v[96:99], v[240:243], v[188:191], v[96:99]
    ds_read_b64_tr_b16 v[236:237], v71 offset:12480
    v_mfma_f32_16x16x32_bf16 v[100:103], v[240:243], v[192:195], v[100:103]
    ds_read_b64_tr_b16 v[238:239], v71 offset:12992
    v_mfma_f32_16x16x32_bf16 v[104:107], v[244:247], v[188:191], v[104:107]
    ds_read_b64_tr_b16 v[240:241], v71 offset:12512
    v_mfma_f32_16x16x32_bf16 v[108:111], v[244:247], v[192:195], v[108:111]
    ds_read_b64_tr_b16 v[242:243], v71 offset:13024
    s_waitcnt lgkmcnt(8)
    v_mfma_f32_16x16x32_bf16 v[144:147], v[248:251], v[188:191], v[144:147]
    ds_read_b64_tr_b16 v[244:245], v70 offset:12480
    v_mfma_f32_16x16x32_bf16 v[148:151], v[248:251], v[192:195], v[148:151]
    ds_read_b64_tr_b16 v[246:247], v70 offset:12992
    v_mfma_f32_16x16x32_bf16 v[152:155], v[224:227], v[188:191], v[152:155]
    ds_read_b64_tr_b16 v[248:249], v70 offset:12512
    v_mfma_f32_16x16x32_bf16 v[156:159], v[224:227], v[192:195], v[156:159]
    ds_read_b64_tr_b16 v[250:251], v70 offset:13024
    s_waitcnt lgkmcnt(8)
    v_mfma_f32_16x16x32_bf16 v[160:163], v[228:231], v[188:191], v[160:163]
    ds_read_b64_tr_b16 v[224:225], v70 offset:4160
    v_mfma_f32_16x16x32_bf16 v[164:167], v[228:231], v[192:195], v[164:167]
    ds_read_b64_tr_b16 v[226:227], v70 offset:4672
    v_mfma_f32_16x16x32_bf16 v[168:171], v[232:235], v[188:191], v[168:171]
    ds_read_b64_tr_b16 v[228:229], v70 offset:4192
    v_mfma_f32_16x16x32_bf16 v[172:175], v[232:235], v[192:195], v[172:175]
    ds_read_b64_tr_b16 v[230:231], v70 offset:4704
    s_waitcnt lgkmcnt(8)
    s_waitcnt vmcnt(9)
    v_mfma_f32_16x16x32_bf16 v[128:131], v[236:239], v[196:199], v[128:131]
    ds_read_b64_tr_b16 v[232:233], v71 offset:4160
    v_mfma_f32_16x16x32_bf16 v[132:135], v[236:239], v[200:203], v[132:135]
    ds_read_b64_tr_b16 v[234:235], v71 offset:4672
    buffer_load_dwordx4 v[188:191], v2, s[32:35], s16 offen offset:1024 sc1
    v_mfma_f32_16x16x32_bf16 v[136:139], v[240:243], v[196:199], v[136:139]
    ds_read_b64_tr_b16 v[236:237], v71 offset:4192
    v_mfma_f32_16x16x32_bf16 v[140:143], v[240:243], v[200:203], v[140:143]
    ds_read_b64_tr_b16 v[238:239], v71 offset:4704
    s_waitcnt lgkmcnt(8)
    v_mfma_f32_16x16x32_bf16 v[112:115], v[244:247], v[196:199], v[112:115]
    ds_read_b64_tr_b16 v[240:241], v70 offset:20800
    v_mfma_f32_16x16x32_bf16 v[116:119], v[244:247], v[200:203], v[116:119]
    ds_read_b64_tr_b16 v[242:243], v70 offset:21312
    v_mfma_f32_16x16x32_bf16 v[120:123], v[248:251], v[196:199], v[120:123]
    ds_read_b64_tr_b16 v[244:245], v70 offset:20832
    v_mfma_f32_16x16x32_bf16 v[124:127], v[248:251], v[200:203], v[124:127]
    ds_read_b64_tr_b16 v[246:247], v70 offset:21344
    buffer_load_dwordx4 v[192:195], v2, s[32:35], s16 offen offset:2048 sc1
    s_waitcnt lgkmcnt(8)
    v_mfma_f32_16x16x32_bf16 v[80:83], v[224:227], v[196:199], v[80:83]
    ds_read_b64_tr_b16 v[248:249], v71 offset:20800
    v_mfma_f32_16x16x32_bf16 v[84:87], v[224:227], v[200:203], v[84:87]
    ds_read_b64_tr_b16 v[250:251], v71 offset:21312
    v_mfma_f32_16x16x32_bf16 v[88:91], v[228:231], v[196:199], v[88:91]
    ds_read_b64_tr_b16 v[224:225], v71 offset:20832
    v_mfma_f32_16x16x32_bf16 v[92:95], v[228:231], v[200:203], v[92:95]
    ds_read_b64_tr_b16 v[226:227], v71 offset:21344
    s_waitcnt lgkmcnt(8)
    v_mfma_f32_16x16x32_bf16 v[96:99], v[232:235], v[196:199], v[96:99]
    s_barrier
    ds_read_b64_tr_b16 v[228:229], v71 offset:33280
    v_mfma_f32_16x16x32_bf16 v[100:103], v[232:235], v[200:203], v[100:103]
    ds_read_b64_tr_b16 v[230:231], v71 offset:33792
    v_mfma_f32_16x16x32_bf16 v[104:107], v[236:239], v[196:199], v[104:107]
    ds_read_b64_tr_b16 v[232:233], v71 offset:33312
    v_mfma_f32_16x16x32_bf16 v[108:111], v[236:239], v[200:203], v[108:111]
    ds_read_b64_tr_b16 v[234:235], v71 offset:33824
    s_waitcnt lgkmcnt(8)
    v_mfma_f32_16x16x32_bf16 v[144:147], v[240:243], v[196:199], v[144:147]
    ds_read_b64_tr_b16 v[236:237], v70 offset:33280
    v_mfma_f32_16x16x32_bf16 v[148:151], v[240:243], v[200:203], v[148:151]
    ds_read_b64_tr_b16 v[238:239], v70 offset:33792
    v_mfma_f32_16x16x32_bf16 v[152:155], v[244:247], v[196:199], v[152:155]
    ds_read_b64_tr_b16 v[240:241], v70 offset:33312
    v_mfma_f32_16x16x32_bf16 v[156:159], v[244:247], v[200:203], v[156:159]
    ds_read_b64_tr_b16 v[242:243], v70 offset:33824
    s_waitcnt lgkmcnt(8)
    v_mfma_f32_16x16x32_bf16 v[160:163], v[248:251], v[196:199], v[160:163]
    ds_read_b64_tr_b16 v[244:245], v70 offset:24960
    v_mfma_f32_16x16x32_bf16 v[164:167], v[248:251], v[200:203], v[164:167]
    ds_read_b64_tr_b16 v[246:247], v70 offset:25472
    v_mfma_f32_16x16x32_bf16 v[168:171], v[224:227], v[196:199], v[168:171]
    ds_read_b64_tr_b16 v[248:249], v70 offset:24992
    v_mfma_f32_16x16x32_bf16 v[172:175], v[224:227], v[200:203], v[172:175]
    ds_read_b64_tr_b16 v[250:251], v70 offset:25504
    s_waitcnt lgkmcnt(8)
    s_waitcnt vmcnt(9)
    v_mfma_f32_16x16x32_bf16 v[128:131], v[228:231], v[204:207], v[128:131]
    ds_read_b64_tr_b16 v[224:225], v71 offset:24960
    v_mfma_f32_16x16x32_bf16 v[132:135], v[228:231], v[208:211], v[132:135]
    ds_read_b64_tr_b16 v[226:227], v71 offset:25472
    buffer_load_dwordx4 v[196:199], v2, s[32:35], s16 offen offset:3072 sc1
    v_mfma_f32_16x16x32_bf16 v[136:139], v[232:235], v[204:207], v[136:139]
    ds_read_b64_tr_b16 v[228:229], v71 offset:24992
    v_mfma_f32_16x16x32_bf16 v[140:143], v[232:235], v[208:211], v[140:143]
    ds_read_b64_tr_b16 v[230:231], v71 offset:25504
    s_waitcnt lgkmcnt(8)
    v_mfma_f32_16x16x32_bf16 v[112:115], v[236:239], v[204:207], v[112:115]
    ds_read_b64_tr_b16 v[232:233], v70 offset:41600
    v_mfma_f32_16x16x32_bf16 v[116:119], v[236:239], v[208:211], v[116:119]
    ds_read_b64_tr_b16 v[234:235], v70 offset:42112
    v_mfma_f32_16x16x32_bf16 v[120:123], v[240:243], v[204:207], v[120:123]
    ds_read_b64_tr_b16 v[236:237], v70 offset:41632
    v_mfma_f32_16x16x32_bf16 v[124:127], v[240:243], v[208:211], v[124:127]
    ds_read_b64_tr_b16 v[238:239], v70 offset:42144
    s_add_u32 s96, s85, 8
    s_and_b32 s97, s96, 15
    s_lshl_b32 s98, s97, 14
    s_add_u32 s16, s98, s15
    buffer_load_dwordx4 v[200:203], v2, s[32:35], s16 offen sc1
    s_waitcnt lgkmcnt(8)
    v_mfma_f32_16x16x32_bf16 v[80:83], v[244:247], v[204:207], v[80:83]
    ds_read_b64_tr_b16 v[240:241], v71 offset:41600
    v_mfma_f32_16x16x32_bf16 v[84:87], v[244:247], v[208:211], v[84:87]
    ds_read_b64_tr_b16 v[242:243], v71 offset:42112
    v_mfma_f32_16x16x32_bf16 v[88:91], v[248:251], v[204:207], v[88:91]
    ds_read_b64_tr_b16 v[244:245], v71 offset:41632
    v_mfma_f32_16x16x32_bf16 v[92:95], v[248:251], v[208:211], v[92:95]
    ds_read_b64_tr_b16 v[246:247], v71 offset:42144
    s_waitcnt lgkmcnt(8)
    v_mfma_f32_16x16x32_bf16 v[96:99], v[224:227], v[204:207], v[96:99]
    ds_read_b64_tr_b16 v[248:249], v71 offset:37440
    v_mfma_f32_16x16x32_bf16 v[100:103], v[224:227], v[208:211], v[100:103]
    ds_read_b64_tr_b16 v[250:251], v71 offset:37952
    v_mfma_f32_16x16x32_bf16 v[104:107], v[228:231], v[204:207], v[104:107]
    ds_read_b64_tr_b16 v[224:225], v71 offset:37472
    v_mfma_f32_16x16x32_bf16 v[108:111], v[228:231], v[208:211], v[108:111]
    ds_read_b64_tr_b16 v[226:227], v71 offset:37984
    s_waitcnt lgkmcnt(8)
    v_mfma_f32_16x16x32_bf16 v[144:147], v[232:235], v[204:207], v[144:147]
    ds_read_b64_tr_b16 v[228:229], v70 offset:37440
    v_mfma_f32_16x16x32_bf16 v[148:151], v[232:235], v[208:211], v[148:151]
    ds_read_b64_tr_b16 v[230:231], v70 offset:37952
    v_mfma_f32_16x16x32_bf16 v[152:155], v[236:239], v[204:207], v[152:155]
    ds_read_b64_tr_b16 v[232:233], v70 offset:37472
    v_mfma_f32_16x16x32_bf16 v[156:159], v[236:239], v[208:211], v[156:159]
    ds_read_b64_tr_b16 v[234:235], v70 offset:37984
    s_waitcnt lgkmcnt(8)
    v_mfma_f32_16x16x32_bf16 v[160:163], v[240:243], v[204:207], v[160:163]
    ds_read_b64_tr_b16 v[236:237], v70 offset:29120
    v_mfma_f32_16x16x32_bf16 v[164:167], v[240:243], v[208:211], v[164:167]
    ds_read_b64_tr_b16 v[238:239], v70 offset:29632
    v_mfma_f32_16x16x32_bf16 v[168:171], v[244:247], v[204:207], v[168:171]
    ds_read_b64_tr_b16 v[240:241], v70 offset:29152
    v_mfma_f32_16x16x32_bf16 v[172:175], v[244:247], v[208:211], v[172:175]
    ds_read_b64_tr_b16 v[242:243], v70 offset:29664
    s_waitcnt lgkmcnt(8)
    s_waitcnt vmcnt(9)
    v_mfma_f32_16x16x32_bf16 v[128:131], v[248:251], v[212:215], v[128:131]
    ds_read_b64_tr_b16 v[244:245], v71 offset:29120
    v_mfma_f32_16x16x32_bf16 v[132:135], v[248:251], v[216:219], v[132:135]
    ds_read_b64_tr_b16 v[246:247], v71 offset:29632
    buffer_load_dwordx4 v[204:207], v2, s[32:35], s16 offen offset:1024 sc1
    v_mfma_f32_16x16x32_bf16 v[136:139], v[224:227], v[212:215], v[136:139]
    ds_read_b64_tr_b16 v[248:249], v71 offset:29152
    v_mfma_f32_16x16x32_bf16 v[140:143], v[224:227], v[216:219], v[140:143]
    ds_read_b64_tr_b16 v[250:251], v71 offset:29664
    s_waitcnt lgkmcnt(8)
    v_mfma_f32_16x16x32_bf16 v[112:115], v[228:231], v[212:215], v[112:115]
    ds_read_b64_tr_b16 v[224:225], v70 offset:45760
    v_mfma_f32_16x16x32_bf16 v[116:119], v[228:231], v[216:219], v[116:119]
    ds_read_b64_tr_b16 v[226:227], v70 offset:46272
    v_mfma_f32_16x16x32_bf16 v[120:123], v[232:235], v[212:215], v[120:123]
    ds_read_b64_tr_b16 v[228:229], v70 offset:45792
    v_mfma_f32_16x16x32_bf16 v[124:127], v[232:235], v[216:219], v[124:127]
    ds_read_b64_tr_b16 v[230:231], v70 offset:46304
    buffer_load_dwordx4 v[208:211], v2, s[32:35], s16 offen offset:2048 sc1
    s_waitcnt lgkmcnt(8)
    v_mfma_f32_16x16x32_bf16 v[80:83], v[236:239], v[212:215], v[80:83]
    ds_read_b64_tr_b16 v[232:233], v71 offset:45760
    v_mfma_f32_16x16x32_bf16 v[84:87], v[236:239], v[216:219], v[84:87]
    ds_read_b64_tr_b16 v[234:235], v71 offset:46272
    v_mfma_f32_16x16x32_bf16 v[88:91], v[240:243], v[212:215], v[88:91]
    ds_read_b64_tr_b16 v[236:237], v71 offset:45792
    v_mfma_f32_16x16x32_bf16 v[92:95], v[240:243], v[216:219], v[92:95]
    ds_read_b64_tr_b16 v[238:239], v71 offset:46304
    s_waitcnt lgkmcnt(8)
    v_mfma_f32_16x16x32_bf16 v[96:99], v[244:247], v[212:215], v[96:99]
    s_barrier
    ds_read_b64_tr_b16 v[240:241], v67 offset:8320
    v_mfma_f32_16x16x32_bf16 v[100:103], v[244:247], v[216:219], v[100:103]
    ds_read_b64_tr_b16 v[242:243], v67 offset:8832
    v_mfma_f32_16x16x32_bf16 v[104:107], v[248:251], v[212:215], v[104:107]
    ds_read_b64_tr_b16 v[244:245], v67 offset:8352
    v_mfma_f32_16x16x32_bf16 v[108:111], v[248:251], v[216:219], v[108:111]
    ds_read_b64_tr_b16 v[246:247], v67 offset:8864
    s_waitcnt lgkmcnt(8)
    v_mfma_f32_16x16x32_bf16 v[144:147], v[224:227], v[212:215], v[144:147]
    ds_read_b64_tr_b16 v[248:249], v66 offset:8320
    v_mfma_f32_16x16x32_bf16 v[148:151], v[224:227], v[216:219], v[148:151]
    ds_read_b64_tr_b16 v[250:251], v66 offset:8832
    v_mfma_f32_16x16x32_bf16 v[152:155], v[228:231], v[212:215], v[152:155]
    ds_read_b64_tr_b16 v[224:225], v66 offset:8352
    v_mfma_f32_16x16x32_bf16 v[156:159], v[228:231], v[216:219], v[156:159]
    ds_read_b64_tr_b16 v[226:227], v66 offset:8864
    s_waitcnt lgkmcnt(8)
    v_mfma_f32_16x16x32_bf16 v[160:163], v[232:235], v[212:215], v[160:163]
    ds_read_b64_tr_b16 v[228:229], v66
    v_mfma_f32_16x16x32_bf16 v[164:167], v[232:235], v[216:219], v[164:167]
    ds_read_b64_tr_b16 v[230:231], v66 offset:512
    v_mfma_f32_16x16x32_bf16 v[168:171], v[236:239], v[212:215], v[168:171]
    ds_read_b64_tr_b16 v[232:233], v66 offset:32
    v_mfma_f32_16x16x32_bf16 v[172:175], v[236:239], v[216:219], v[172:175]
    ds_read_b64_tr_b16 v[234:235], v66 offset:544
    s_waitcnt lgkmcnt(8)
    s_waitcnt vmcnt(9)
    v_mfma_f32_16x16x32_bf16 v[128:131], v[240:243], v[220:223], v[128:131]
    ds_read_b64_tr_b16 v[236:237], v67
    v_mfma_f32_16x16x32_bf16 v[132:135], v[240:243], v[36:39], v[132:135]
    ds_read_b64_tr_b16 v[238:239], v67 offset:512
    buffer_load_dwordx4 v[212:215], v2, s[32:35], s16 offen offset:3072 sc1
    v_mfma_f32_16x16x32_bf16 v[136:139], v[244:247], v[220:223], v[136:139]
    ds_read_b64_tr_b16 v[240:241], v67 offset:32
    v_mfma_f32_16x16x32_bf16 v[140:143], v[244:247], v[36:39], v[140:143]
    ds_read_b64_tr_b16 v[242:243], v67 offset:544
    s_waitcnt lgkmcnt(8)
    v_mfma_f32_16x16x32_bf16 v[112:115], v[248:251], v[220:223], v[112:115]
    ds_read_b64_tr_b16 v[244:245], v66 offset:16640
    v_mfma_f32_16x16x32_bf16 v[116:119], v[248:251], v[36:39], v[116:119]
    ds_read_b64_tr_b16 v[246:247], v66 offset:17152
    v_mfma_f32_16x16x32_bf16 v[120:123], v[224:227], v[220:223], v[120:123]
    ds_read_b64_tr_b16 v[248:249], v66 offset:16672
    v_mfma_f32_16x16x32_bf16 v[124:127], v[224:227], v[36:39], v[124:127]
    ds_read_b64_tr_b16 v[250:251], v66 offset:17184
    s_add_u32 s96, s85, 9
    s_and_b32 s97, s96, 15
    s_lshl_b32 s98, s97, 14
    s_add_u32 s16, s98, s15
    buffer_load_dwordx4 v[216:219], v2, s[32:35], s16 offen sc1
    s_waitcnt lgkmcnt(8)
    v_mfma_f32_16x16x32_bf16 v[80:83], v[228:231], v[220:223], v[80:83]
    ds_read_b64_tr_b16 v[224:225], v67 offset:16640
    v_mfma_f32_16x16x32_bf16 v[84:87], v[228:231], v[36:39], v[84:87]
    ds_read_b64_tr_b16 v[226:227], v67 offset:17152
    v_mfma_f32_16x16x32_bf16 v[88:91], v[232:235], v[220:223], v[88:91]
    ds_read_b64_tr_b16 v[228:229], v67 offset:16672
    v_mfma_f32_16x16x32_bf16 v[92:95], v[232:235], v[36:39], v[92:95]
    ds_read_b64_tr_b16 v[230:231], v67 offset:17184
    s_waitcnt lgkmcnt(8)
    v_mfma_f32_16x16x32_bf16 v[96:99], v[236:239], v[220:223], v[96:99]
    ds_read_b64_tr_b16 v[232:233], v67 offset:12480
    v_mfma_f32_16x16x32_bf16 v[100:103], v[236:239], v[36:39], v[100:103]
    ds_read_b64_tr_b16 v[234:235], v67 offset:12992
    v_mfma_f32_16x16x32_bf16 v[104:107], v[240:243], v[220:223], v[104:107]
    ds_read_b64_tr_b16 v[236:237], v67 offset:12512
    v_mfma_f32_16x16x32_bf16 v[108:111], v[240:243], v[36:39], v[108:111]
    ds_read_b64_tr_b16 v[238:239], v67 offset:13024
    s_waitcnt lgkmcnt(8)
    v_mfma_f32_16x16x32_bf16 v[144:147], v[244:247], v[220:223], v[144:147]
    ds_read_b64_tr_b16 v[240:241], v66 offset:12480
    v_mfma_f32_16x16x32_bf16 v[148:151], v[244:247], v[36:39], v[148:151]
    ds_read_b64_tr_b16 v[242:243], v66 offset:12992
    v_mfma_f32_16x16x32_bf16 v[152:155], v[248:251], v[220:223], v[152:155]
    ds_read_b64_tr_b16 v[244:245], v66 offset:12512
    v_mfma_f32_16x16x32_bf16 v[156:159], v[248:251], v[36:39], v[156:159]
    ds_read_b64_tr_b16 v[246:247], v66 offset:13024
    s_waitcnt lgkmcnt(8)
    v_mfma_f32_16x16x32_bf16 v[160:163], v[224:227], v[220:223], v[160:163]
    ds_read_b64_tr_b16 v[248:249], v66 offset:4160
    v_mfma_f32_16x16x32_bf16 v[164:167], v[224:227], v[36:39], v[164:167]
    ds_read_b64_tr_b16 v[250:251], v66 offset:4672
    v_mfma_f32_16x16x32_bf16 v[168:171], v[228:231], v[220:223], v[168:171]
    ds_read_b64_tr_b16 v[224:225], v66 offset:4192
    v_mfma_f32_16x16x32_bf16 v[172:175], v[228:231], v[36:39], v[172:175]
    ds_read_b64_tr_b16 v[226:227], v66 offset:4704
    s_waitcnt lgkmcnt(8)
    s_waitcnt vmcnt(9)
    v_mfma_f32_16x16x32_bf16 v[128:131], v[232:235], v[176:179], v[128:131]
    ds_read_b64_tr_b16 v[228:229], v67 offset:4160
    v_mfma_f32_16x16x32_bf16 v[132:135], v[232:235], v[180:183], v[132:135]
    ds_read_b64_tr_b16 v[230:231], v67 offset:4672
    buffer_load_dwordx4 v[220:223], v2, s[32:35], s16 offen offset:1024 sc1
    v_mfma_f32_16x16x32_bf16 v[136:139], v[236:239], v[176:179], v[136:139]
    ds_read_b64_tr_b16 v[232:233], v67 offset:4192
    v_mfma_f32_16x16x32_bf16 v[140:143], v[236:239], v[180:183], v[140:143]
    ds_read_b64_tr_b16 v[234:235], v67 offset:4704
    s_waitcnt lgkmcnt(8)
    v_mfma_f32_16x16x32_bf16 v[112:115], v[240:243], v[176:179], v[112:115]
    ds_read_b64_tr_b16 v[236:237], v66 offset:20800
    v_mfma_f32_16x16x32_bf16 v[116:119], v[240:243], v[180:183], v[116:119]
    ds_read_b64_tr_b16 v[238:239], v66 offset:21312
    v_mfma_f32_16x16x32_bf16 v[120:123], v[244:247], v[176:179], v[120:123]
    ds_read_b64_tr_b16 v[240:241], v66 offset:20832
    v_mfma_f32_16x16x32_bf16 v[124:127], v[244:247], v[180:183], v[124:127]
    ds_read_b64_tr_b16 v[242:243], v66 offset:21344
    buffer_load_dwordx4 v[36:39], v2, s[32:35], s16 offen offset:2048 sc1
    s_waitcnt lgkmcnt(8)
    v_mfma_f32_16x16x32_bf16 v[80:83], v[248:251], v[176:179], v[80:83]
    ds_read_b64_tr_b16 v[244:245], v67 offset:20800
    v_mfma_f32_16x16x32_bf16 v[84:87], v[248:251], v[180:183], v[84:87]
    ds_read_b64_tr_b16 v[246:247], v67 offset:21312
    v_mfma_f32_16x16x32_bf16 v[88:91], v[224:227], v[176:179], v[88:91]
    ds_read_b64_tr_b16 v[248:249], v67 offset:20832
    v_mfma_f32_16x16x32_bf16 v[92:95], v[224:227], v[180:183], v[92:95]
    ds_read_b64_tr_b16 v[250:251], v67 offset:21344
    s_waitcnt lgkmcnt(8)
    v_mfma_f32_16x16x32_bf16 v[96:99], v[228:231], v[176:179], v[96:99]
    s_barrier
    ds_read_b64_tr_b16 v[224:225], v67 offset:33280
    v_mfma_f32_16x16x32_bf16 v[100:103], v[228:231], v[180:183], v[100:103]
    ds_read_b64_tr_b16 v[226:227], v67 offset:33792
    v_mfma_f32_16x16x32_bf16 v[104:107], v[232:235], v[176:179], v[104:107]
    ds_read_b64_tr_b16 v[228:229], v67 offset:33312
    v_mfma_f32_16x16x32_bf16 v[108:111], v[232:235], v[180:183], v[108:111]
    ds_read_b64_tr_b16 v[230:231], v67 offset:33824
    s_waitcnt lgkmcnt(8)
    v_mfma_f32_16x16x32_bf16 v[144:147], v[236:239], v[176:179], v[144:147]
    ds_read_b64_tr_b16 v[232:233], v66 offset:33280
    v_mfma_f32_16x16x32_bf16 v[148:151], v[236:239], v[180:183], v[148:151]
    ds_read_b64_tr_b16 v[234:235], v66 offset:33792
    v_mfma_f32_16x16x32_bf16 v[152:155], v[240:243], v[176:179], v[152:155]
    ds_read_b64_tr_b16 v[236:237], v66 offset:33312
    v_mfma_f32_16x16x32_bf16 v[156:159], v[240:243], v[180:183], v[156:159]
    ds_read_b64_tr_b16 v[238:239], v66 offset:33824
    s_waitcnt lgkmcnt(8)
    v_mfma_f32_16x16x32_bf16 v[160:163], v[244:247], v[176:179], v[160:163]
    ds_read_b64_tr_b16 v[240:241], v66 offset:24960
    v_mfma_f32_16x16x32_bf16 v[164:167], v[244:247], v[180:183], v[164:167]
    ds_read_b64_tr_b16 v[242:243], v66 offset:25472
    v_mfma_f32_16x16x32_bf16 v[168:171], v[248:251], v[176:179], v[168:171]
    ds_read_b64_tr_b16 v[244:245], v66 offset:24992
    v_mfma_f32_16x16x32_bf16 v[172:175], v[248:251], v[180:183], v[172:175]
    ds_read_b64_tr_b16 v[246:247], v66 offset:25504
    s_waitcnt lgkmcnt(8)
    s_waitcnt vmcnt(9)
    v_mfma_f32_16x16x32_bf16 v[128:131], v[224:227], v[184:187], v[128:131]
    ds_read_b64_tr_b16 v[248:249], v67 offset:24960
    v_mfma_f32_16x16x32_bf16 v[132:135], v[224:227], v[188:191], v[132:135]
    ds_read_b64_tr_b16 v[250:251], v67 offset:25472
    buffer_load_dwordx4 v[176:179], v2, s[32:35], s16 offen offset:3072 sc1
    v_mfma_f32_16x16x32_bf16 v[136:139], v[228:231], v[184:187], v[136:139]
    ds_read_b64_tr_b16 v[224:225], v67 offset:24992
    v_mfma_f32_16x16x32_bf16 v[140:143], v[228:231], v[188:191], v[140:143]
    ds_read_b64_tr_b16 v[226:227], v67 offset:25504
    s_waitcnt lgkmcnt(8)
    v_mfma_f32_16x16x32_bf16 v[112:115], v[232:235], v[184:187], v[112:115]
    ds_read_b64_tr_b16 v[228:229], v66 offset:41600
    v_mfma_f32_16x16x32_bf16 v[116:119], v[232:235], v[188:191], v[116:119]
    ds_read_b64_tr_b16 v[230:231], v66 offset:42112
    v_mfma_f32_16x16x32_bf16 v[120:123], v[236:239], v[184:187], v[120:123]
    ds_read_b64_tr_b16 v[232:233], v66 offset:41632
    v_mfma_f32_16x16x32_bf16 v[124:127], v[236:239], v[188:191], v[124:127]
    ds_read_b64_tr_b16 v[234:235], v66 offset:42144
    s_add_u32 s96, s85, 10
    s_and_b32 s97, s96, 15
    s_lshl_b32 s98, s97, 14
    s_add_u32 s16, s98, s15
    buffer_load_dwordx4 v[180:183], v2, s[32:35], s16 offen sc1
    s_waitcnt lgkmcnt(8)
    v_mfma_f32_16x16x32_bf16 v[80:83], v[240:243], v[184:187], v[80:83]
    ds_read_b64_tr_b16 v[236:237], v67 offset:41600
    v_mfma_f32_16x16x32_bf16 v[84:87], v[240:243], v[188:191], v[84:87]
    ds_read_b64_tr_b16 v[238:239], v67 offset:42112
    v_mfma_f32_16x16x32_bf16 v[88:91], v[244:247], v[184:187], v[88:91]
    ds_read_b64_tr_b16 v[240:241], v67 offset:41632
    v_mfma_f32_16x16x32_bf16 v[92:95], v[244:247], v[188:191], v[92:95]
    ds_read_b64_tr_b16 v[242:243], v67 offset:42144
    s_waitcnt lgkmcnt(8)
    v_mfma_f32_16x16x32_bf16 v[96:99], v[248:251], v[184:187], v[96:99]
    ds_read_b64_tr_b16 v[244:245], v67 offset:37440
    v_mfma_f32_16x16x32_bf16 v[100:103], v[248:251], v[188:191], v[100:103]
    ds_read_b64_tr_b16 v[246:247], v67 offset:37952
    v_mfma_f32_16x16x32_bf16 v[104:107], v[224:227], v[184:187], v[104:107]
    ds_read_b64_tr_b16 v[248:249], v67 offset:37472
    v_mfma_f32_16x16x32_bf16 v[108:111], v[224:227], v[188:191], v[108:111]
    ds_read_b64_tr_b16 v[250:251], v67 offset:37984
    s_waitcnt lgkmcnt(8)
    v_mfma_f32_16x16x32_bf16 v[144:147], v[228:231], v[184:187], v[144:147]
    ds_read_b64_tr_b16 v[224:225], v66 offset:37440
    v_mfma_f32_16x16x32_bf16 v[148:151], v[228:231], v[188:191], v[148:151]
    ds_read_b64_tr_b16 v[226:227], v66 offset:37952
    v_mfma_f32_16x16x32_bf16 v[152:155], v[232:235], v[184:187], v[152:155]
    ds_read_b64_tr_b16 v[228:229], v66 offset:37472
    v_mfma_f32_16x16x32_bf16 v[156:159], v[232:235], v[188:191], v[156:159]
    ds_read_b64_tr_b16 v[230:231], v66 offset:37984
    s_waitcnt lgkmcnt(8)
    v_mfma_f32_16x16x32_bf16 v[160:163], v[236:239], v[184:187], v[160:163]
    ds_read_b64_tr_b16 v[232:233], v66 offset:29120
    v_mfma_f32_16x16x32_bf16 v[164:167], v[236:239], v[188:191], v[164:167]
    ds_read_b64_tr_b16 v[234:235], v66 offset:29632
    v_mfma_f32_16x16x32_bf16 v[168:171], v[240:243], v[184:187], v[168:171]
    ds_read_b64_tr_b16 v[236:237], v66 offset:29152
    v_mfma_f32_16x16x32_bf16 v[172:175], v[240:243], v[188:191], v[172:175]
    ds_read_b64_tr_b16 v[238:239], v66 offset:29664
    s_waitcnt lgkmcnt(8)
    s_waitcnt vmcnt(9)
    v_mfma_f32_16x16x32_bf16 v[128:131], v[244:247], v[192:195], v[128:131]
    ds_read_b64_tr_b16 v[240:241], v67 offset:29120
    v_mfma_f32_16x16x32_bf16 v[132:135], v[244:247], v[196:199], v[132:135]
    ds_read_b64_tr_b16 v[242:243], v67 offset:29632
    buffer_load_dwordx4 v[184:187], v2, s[32:35], s16 offen offset:1024 sc1
    v_mfma_f32_16x16x32_bf16 v[136:139], v[248:251], v[192:195], v[136:139]
    ds_read_b64_tr_b16 v[244:245], v67 offset:29152
    v_mfma_f32_16x16x32_bf16 v[140:143], v[248:251], v[196:199], v[140:143]
    ds_read_b64_tr_b16 v[246:247], v67 offset:29664
    s_waitcnt lgkmcnt(8)
    v_mfma_f32_16x16x32_bf16 v[112:115], v[224:227], v[192:195], v[112:115]
    ds_read_b64_tr_b16 v[248:249], v66 offset:45760
    v_mfma_f32_16x16x32_bf16 v[116:119], v[224:227], v[196:199], v[116:119]
    ds_read_b64_tr_b16 v[250:251], v66 offset:46272
    v_mfma_f32_16x16x32_bf16 v[120:123], v[228:231], v[192:195], v[120:123]
    ds_read_b64_tr_b16 v[224:225], v66 offset:45792
    v_mfma_f32_16x16x32_bf16 v[124:127], v[228:231], v[196:199], v[124:127]
    ds_read_b64_tr_b16 v[226:227], v66 offset:46304
    buffer_load_dwordx4 v[188:191], v2, s[32:35], s16 offen offset:2048 sc1
    s_waitcnt lgkmcnt(8)
    v_mfma_f32_16x16x32_bf16 v[80:83], v[232:235], v[192:195], v[80:83]
    ds_read_b64_tr_b16 v[228:229], v67 offset:45760
    v_mfma_f32_16x16x32_bf16 v[84:87], v[232:235], v[196:199], v[84:87]
    ds_read_b64_tr_b16 v[230:231], v67 offset:46272
    v_mfma_f32_16x16x32_bf16 v[88:91], v[236:239], v[192:195], v[88:91]
    ds_read_b64_tr_b16 v[232:233], v67 offset:45792
    v_mfma_f32_16x16x32_bf16 v[92:95], v[236:239], v[196:199], v[92:95]
    ds_read_b64_tr_b16 v[234:235], v67 offset:46304
    s_waitcnt lgkmcnt(8)
    v_mfma_f32_16x16x32_bf16 v[96:99], v[240:243], v[192:195], v[96:99]
    s_barrier
    ds_read_b64_tr_b16 v[236:237], v69 offset:8320
    v_mfma_f32_16x16x32_bf16 v[100:103], v[240:243], v[196:199], v[100:103]
    ds_read_b64_tr_b16 v[238:239], v69 offset:8832
    v_mfma_f32_16x16x32_bf16 v[104:107], v[244:247], v[192:195], v[104:107]
    ds_read_b64_tr_b16 v[240:241], v69 offset:8352
    v_mfma_f32_16x16x32_bf16 v[108:111], v[244:247], v[196:199], v[108:111]
    ds_read_b64_tr_b16 v[242:243], v69 offset:8864
    s_waitcnt lgkmcnt(8)
    v_mfma_f32_16x16x32_bf16 v[144:147], v[248:251], v[192:195], v[144:147]
    ds_read_b64_tr_b16 v[244:245], v68 offset:8320
    v_mfma_f32_16x16x32_bf16 v[148:151], v[248:251], v[196:199], v[148:151]
    ds_read_b64_tr_b16 v[246:247], v68 offset:8832
    v_mfma_f32_16x16x32_bf16 v[152:155], v[224:227], v[192:195], v[152:155]
    ds_read_b64_tr_b16 v[248:249], v68 offset:8352
    v_mfma_f32_16x16x32_bf16 v[156:159], v[224:227], v[196:199], v[156:159]
    ds_read_b64_tr_b16 v[250:251], v68 offset:8864
    s_waitcnt lgkmcnt(8)
    v_mfma_f32_16x16x32_bf16 v[160:163], v[228:231], v[192:195], v[160:163]
    ds_read_b64_tr_b16 v[224:225], v68
    v_mfma_f32_16x16x32_bf16 v[164:167], v[228:231], v[196:199], v[164:167]
    ds_read_b64_tr_b16 v[226:227], v68 offset:512
    v_mfma_f32_16x16x32_bf16 v[168:171], v[232:235], v[192:195], v[168:171]
    ds_read_b64_tr_b16 v[228:229], v68 offset:32
    v_mfma_f32_16x16x32_bf16 v[172:175], v[232:235], v[196:199], v[172:175]
    ds_read_b64_tr_b16 v[230:231], v68 offset:544
    s_waitcnt lgkmcnt(8)
    s_waitcnt vmcnt(9)
    v_mfma_f32_16x16x32_bf16 v[128:131], v[236:239], v[200:203], v[128:131]
    ds_read_b64_tr_b16 v[232:233], v69
    v_mfma_f32_16x16x32_bf16 v[132:135], v[236:239], v[204:207], v[132:135]
    ds_read_b64_tr_b16 v[234:235], v69 offset:512
    buffer_load_dwordx4 v[192:195], v2, s[32:35], s16 offen offset:3072 sc1
    v_mfma_f32_16x16x32_bf16 v[136:139], v[240:243], v[200:203], v[136:139]
    ds_read_b64_tr_b16 v[236:237], v69 offset:32
    v_mfma_f32_16x16x32_bf16 v[140:143], v[240:243], v[204:207], v[140:143]
    ds_read_b64_tr_b16 v[238:239], v69 offset:544
    s_waitcnt lgkmcnt(8)
    v_mfma_f32_16x16x32_bf16 v[112:115], v[244:247], v[200:203], v[112:115]
    ds_read_b64_tr_b16 v[240:241], v68 offset:16640
    v_mfma_f32_16x16x32_bf16 v[116:119], v[244:247], v[204:207], v[116:119]
    ds_read_b64_tr_b16 v[242:243], v68 offset:17152
    v_mfma_f32_16x16x32_bf16 v[120:123], v[248:251], v[200:203], v[120:123]
    ds_read_b64_tr_b16 v[244:245], v68 offset:16672
    v_mfma_f32_16x16x32_bf16 v[124:127], v[248:251], v[204:207], v[124:127]
    ds_read_b64_tr_b16 v[246:247], v68 offset:17184
    s_add_u32 s96, s85, 11
    s_and_b32 s97, s96, 15
    s_lshl_b32 s98, s97, 14
    s_add_u32 s16, s98, s15
    buffer_load_dwordx4 v[196:199], v2, s[32:35], s16 offen sc1
    s_waitcnt lgkmcnt(8)
    v_mfma_f32_16x16x32_bf16 v[80:83], v[224:227], v[200:203], v[80:83]
    ds_read_b64_tr_b16 v[248:249], v69 offset:16640
    v_mfma_f32_16x16x32_bf16 v[84:87], v[224:227], v[204:207], v[84:87]
    ds_read_b64_tr_b16 v[250:251], v69 offset:17152
    v_mfma_f32_16x16x32_bf16 v[88:91], v[228:231], v[200:203], v[88:91]
    ds_read_b64_tr_b16 v[224:225], v69 offset:16672
    v_mfma_f32_16x16x32_bf16 v[92:95], v[228:231], v[204:207], v[92:95]
    ds_read_b64_tr_b16 v[226:227], v69 offset:17184
    s_waitcnt lgkmcnt(8)
    v_mfma_f32_16x16x32_bf16 v[96:99], v[232:235], v[200:203], v[96:99]
    ds_read_b64_tr_b16 v[228:229], v69 offset:12480
    v_mfma_f32_16x16x32_bf16 v[100:103], v[232:235], v[204:207], v[100:103]
    ds_read_b64_tr_b16 v[230:231], v69 offset:12992
    v_mfma_f32_16x16x32_bf16 v[104:107], v[236:239], v[200:203], v[104:107]
    ds_read_b64_tr_b16 v[232:233], v69 offset:12512
    v_mfma_f32_16x16x32_bf16 v[108:111], v[236:239], v[204:207], v[108:111]
    ds_read_b64_tr_b16 v[234:235], v69 offset:13024
    s_waitcnt lgkmcnt(8)
    v_mfma_f32_16x16x32_bf16 v[144:147], v[240:243], v[200:203], v[144:147]
    ds_read_b64_tr_b16 v[236:237], v68 offset:12480
    v_mfma_f32_16x16x32_bf16 v[148:151], v[240:243], v[204:207], v[148:151]
    ds_read_b64_tr_b16 v[238:239], v68 offset:12992
    v_mfma_f32_16x16x32_bf16 v[152:155], v[244:247], v[200:203], v[152:155]
    ds_read_b64_tr_b16 v[240:241], v68 offset:12512
    v_mfma_f32_16x16x32_bf16 v[156:159], v[244:247], v[204:207], v[156:159]
    ds_read_b64_tr_b16 v[242:243], v68 offset:13024
    s_waitcnt lgkmcnt(8)
    v_mfma_f32_16x16x32_bf16 v[160:163], v[248:251], v[200:203], v[160:163]
    ds_read_b64_tr_b16 v[244:245], v68 offset:4160
    v_mfma_f32_16x16x32_bf16 v[164:167], v[248:251], v[204:207], v[164:167]
    ds_read_b64_tr_b16 v[246:247], v68 offset:4672
    v_mfma_f32_16x16x32_bf16 v[168:171], v[224:227], v[200:203], v[168:171]
    ds_read_b64_tr_b16 v[248:249], v68 offset:4192
    v_mfma_f32_16x16x32_bf16 v[172:175], v[224:227], v[204:207], v[172:175]
    ds_read_b64_tr_b16 v[250:251], v68 offset:4704
    s_waitcnt lgkmcnt(8)
    s_waitcnt vmcnt(9)
    v_mfma_f32_16x16x32_bf16 v[128:131], v[228:231], v[208:211], v[128:131]
    ds_read_b64_tr_b16 v[224:225], v69 offset:4160
    v_mfma_f32_16x16x32_bf16 v[132:135], v[228:231], v[212:215], v[132:135]
    ds_read_b64_tr_b16 v[226:227], v69 offset:4672
    buffer_load_dwordx4 v[200:203], v2, s[32:35], s16 offen offset:1024 sc1
    v_mfma_f32_16x16x32_bf16 v[136:139], v[232:235], v[208:211], v[136:139]
    ds_read_b64_tr_b16 v[228:229], v69 offset:4192
    v_mfma_f32_16x16x32_bf16 v[140:143], v[232:235], v[212:215], v[140:143]
    ds_read_b64_tr_b16 v[230:231], v69 offset:4704
    s_waitcnt lgkmcnt(8)
    v_mfma_f32_16x16x32_bf16 v[112:115], v[236:239], v[208:211], v[112:115]
    ds_read_b64_tr_b16 v[232:233], v68 offset:20800
    v_mfma_f32_16x16x32_bf16 v[116:119], v[236:239], v[212:215], v[116:119]
    ds_read_b64_tr_b16 v[234:235], v68 offset:21312
    v_mfma_f32_16x16x32_bf16 v[120:123], v[240:243], v[208:211], v[120:123]
    ds_read_b64_tr_b16 v[236:237], v68 offset:20832
    v_mfma_f32_16x16x32_bf16 v[124:127], v[240:243], v[212:215], v[124:127]
    ds_read_b64_tr_b16 v[238:239], v68 offset:21344
    buffer_load_dwordx4 v[204:207], v2, s[32:35], s16 offen offset:2048 sc1
    s_waitcnt lgkmcnt(8)
    v_mfma_f32_16x16x32_bf16 v[80:83], v[244:247], v[208:211], v[80:83]
    ds_read_b64_tr_b16 v[240:241], v69 offset:20800
    v_mfma_f32_16x16x32_bf16 v[84:87], v[244:247], v[212:215], v[84:87]
    ds_read_b64_tr_b16 v[242:243], v69 offset:21312
    v_mfma_f32_16x16x32_bf16 v[88:91], v[248:251], v[208:211], v[88:91]
    ds_read_b64_tr_b16 v[244:245], v69 offset:20832
    v_mfma_f32_16x16x32_bf16 v[92:95], v[248:251], v[212:215], v[92:95]
    ds_read_b64_tr_b16 v[246:247], v69 offset:21344
    s_waitcnt lgkmcnt(8)
    v_mfma_f32_16x16x32_bf16 v[96:99], v[224:227], v[208:211], v[96:99]
    s_barrier
    ds_read_b64_tr_b16 v[248:249], v69 offset:33280
    v_mfma_f32_16x16x32_bf16 v[100:103], v[224:227], v[212:215], v[100:103]
    ds_read_b64_tr_b16 v[250:251], v69 offset:33792
    v_mfma_f32_16x16x32_bf16 v[104:107], v[228:231], v[208:211], v[104:107]
    ds_read_b64_tr_b16 v[224:225], v69 offset:33312
    v_mfma_f32_16x16x32_bf16 v[108:111], v[228:231], v[212:215], v[108:111]
    ds_read_b64_tr_b16 v[226:227], v69 offset:33824
    s_waitcnt lgkmcnt(8)
    v_mfma_f32_16x16x32_bf16 v[144:147], v[232:235], v[208:211], v[144:147]
    ds_read_b64_tr_b16 v[228:229], v68 offset:33280
    v_mfma_f32_16x16x32_bf16 v[148:151], v[232:235], v[212:215], v[148:151]
    ds_read_b64_tr_b16 v[230:231], v68 offset:33792
    v_mfma_f32_16x16x32_bf16 v[152:155], v[236:239], v[208:211], v[152:155]
    ds_read_b64_tr_b16 v[232:233], v68 offset:33312
    v_mfma_f32_16x16x32_bf16 v[156:159], v[236:239], v[212:215], v[156:159]
    ds_read_b64_tr_b16 v[234:235], v68 offset:33824
    s_waitcnt lgkmcnt(8)
    v_mfma_f32_16x16x32_bf16 v[160:163], v[240:243], v[208:211], v[160:163]
    ds_read_b64_tr_b16 v[236:237], v68 offset:24960
    v_mfma_f32_16x16x32_bf16 v[164:167], v[240:243], v[212:215], v[164:167]
    ds_read_b64_tr_b16 v[238:239], v68 offset:25472
    v_mfma_f32_16x16x32_bf16 v[168:171], v[244:247], v[208:211], v[168:171]
    ds_read_b64_tr_b16 v[240:241], v68 offset:24992
    v_mfma_f32_16x16x32_bf16 v[172:175], v[244:247], v[212:215], v[172:175]
    ds_read_b64_tr_b16 v[242:243], v68 offset:25504
    s_waitcnt lgkmcnt(8)
    s_waitcnt vmcnt(9)
    v_mfma_f32_16x16x32_bf16 v[128:131], v[248:251], v[216:219], v[128:131]
    ds_read_b64_tr_b16 v[244:245], v69 offset:24960
    v_mfma_f32_16x16x32_bf16 v[132:135], v[248:251], v[220:223], v[132:135]
    ds_read_b64_tr_b16 v[246:247], v69 offset:25472
    buffer_load_dwordx4 v[208:211], v2, s[32:35], s16 offen offset:3072 sc1
    v_mfma_f32_16x16x32_bf16 v[136:139], v[224:227], v[216:219], v[136:139]
    ds_read_b64_tr_b16 v[248:249], v69 offset:24992
    v_mfma_f32_16x16x32_bf16 v[140:143], v[224:227], v[220:223], v[140:143]
    ds_read_b64_tr_b16 v[250:251], v69 offset:25504
    s_waitcnt lgkmcnt(8)
    v_mfma_f32_16x16x32_bf16 v[112:115], v[228:231], v[216:219], v[112:115]
    ds_read_b64_tr_b16 v[224:225], v68 offset:41600
    v_mfma_f32_16x16x32_bf16 v[116:119], v[228:231], v[220:223], v[116:119]
    ds_read_b64_tr_b16 v[226:227], v68 offset:42112
    v_mfma_f32_16x16x32_bf16 v[120:123], v[232:235], v[216:219], v[120:123]
    ds_read_b64_tr_b16 v[228:229], v68 offset:41632
    v_mfma_f32_16x16x32_bf16 v[124:127], v[232:235], v[220:223], v[124:127]
    ds_read_b64_tr_b16 v[230:231], v68 offset:42144
    s_add_u32 s96, s85, 12
    s_and_b32 s97, s96, 15
    s_lshl_b32 s98, s97, 14
    s_add_u32 s16, s98, s15
    buffer_load_dwordx4 v[212:215], v2, s[32:35], s16 offen sc1
    s_waitcnt lgkmcnt(8)
    v_mfma_f32_16x16x32_bf16 v[80:83], v[236:239], v[216:219], v[80:83]
    ds_read_b64_tr_b16 v[232:233], v69 offset:41600
    v_mfma_f32_16x16x32_bf16 v[84:87], v[236:239], v[220:223], v[84:87]
    ds_read_b64_tr_b16 v[234:235], v69 offset:42112
    v_mfma_f32_16x16x32_bf16 v[88:91], v[240:243], v[216:219], v[88:91]
    ds_read_b64_tr_b16 v[236:237], v69 offset:41632
    v_mfma_f32_16x16x32_bf16 v[92:95], v[240:243], v[220:223], v[92:95]
    ds_read_b64_tr_b16 v[238:239], v69 offset:42144
    s_waitcnt lgkmcnt(8)
    v_mfma_f32_16x16x32_bf16 v[96:99], v[244:247], v[216:219], v[96:99]
    ds_read_b64_tr_b16 v[240:241], v69 offset:37440
    v_mfma_f32_16x16x32_bf16 v[100:103], v[244:247], v[220:223], v[100:103]
    ds_read_b64_tr_b16 v[242:243], v69 offset:37952
    v_mfma_f32_16x16x32_bf16 v[104:107], v[248:251], v[216:219], v[104:107]
    ds_read_b64_tr_b16 v[244:245], v69 offset:37472
    v_mfma_f32_16x16x32_bf16 v[108:111], v[248:251], v[220:223], v[108:111]
    ds_read_b64_tr_b16 v[246:247], v69 offset:37984
    s_waitcnt lgkmcnt(8)
    v_mfma_f32_16x16x32_bf16 v[144:147], v[224:227], v[216:219], v[144:147]
    ds_read_b64_tr_b16 v[248:249], v68 offset:37440
    v_mfma_f32_16x16x32_bf16 v[148:151], v[224:227], v[220:223], v[148:151]
    ds_read_b64_tr_b16 v[250:251], v68 offset:37952
    v_mfma_f32_16x16x32_bf16 v[152:155], v[228:231], v[216:219], v[152:155]
    ds_read_b64_tr_b16 v[224:225], v68 offset:37472
    v_mfma_f32_16x16x32_bf16 v[156:159], v[228:231], v[220:223], v[156:159]
    ds_read_b64_tr_b16 v[226:227], v68 offset:37984
    s_waitcnt lgkmcnt(8)
    v_mfma_f32_16x16x32_bf16 v[160:163], v[232:235], v[216:219], v[160:163]
    ds_read_b64_tr_b16 v[228:229], v68 offset:29120
    v_mfma_f32_16x16x32_bf16 v[164:167], v[232:235], v[220:223], v[164:167]
    ds_read_b64_tr_b16 v[230:231], v68 offset:29632
    v_mfma_f32_16x16x32_bf16 v[168:171], v[236:239], v[216:219], v[168:171]
    ds_read_b64_tr_b16 v[232:233], v68 offset:29152
    v_mfma_f32_16x16x32_bf16 v[172:175], v[236:239], v[220:223], v[172:175]
    ds_read_b64_tr_b16 v[234:235], v68 offset:29664
    s_waitcnt lgkmcnt(8)
    s_waitcnt vmcnt(9)
    v_mfma_f32_16x16x32_bf16 v[128:131], v[240:243], v[36:39], v[128:131]
    ds_read_b64_tr_b16 v[236:237], v69 offset:29120
    v_mfma_f32_16x16x32_bf16 v[132:135], v[240:243], v[176:179], v[132:135]
    ds_read_b64_tr_b16 v[238:239], v69 offset:29632
    buffer_load_dwordx4 v[216:219], v2, s[32:35], s16 offen offset:1024 sc1
    v_mfma_f32_16x16x32_bf16 v[136:139], v[244:247], v[36:39], v[136:139]
    ds_read_b64_tr_b16 v[240:241], v69 offset:29152
    v_mfma_f32_16x16x32_bf16 v[140:143], v[244:247], v[176:179], v[140:143]
    ds_read_b64_tr_b16 v[242:243], v69 offset:29664
    s_waitcnt lgkmcnt(8)
    v_mfma_f32_16x16x32_bf16 v[112:115], v[248:251], v[36:39], v[112:115]
    ds_read_b64_tr_b16 v[244:245], v68 offset:45760
    v_mfma_f32_16x16x32_bf16 v[116:119], v[248:251], v[176:179], v[116:119]
    ds_read_b64_tr_b16 v[246:247], v68 offset:46272
    v_mfma_f32_16x16x32_bf16 v[120:123], v[224:227], v[36:39], v[120:123]
    ds_read_b64_tr_b16 v[248:249], v68 offset:45792
    v_mfma_f32_16x16x32_bf16 v[124:127], v[224:227], v[176:179], v[124:127]
    ds_read_b64_tr_b16 v[250:251], v68 offset:46304
    buffer_load_dwordx4 v[220:223], v2, s[32:35], s16 offen offset:2048 sc1
    s_waitcnt lgkmcnt(8)
    v_mfma_f32_16x16x32_bf16 v[80:83], v[228:231], v[36:39], v[80:83]
    ds_read_b64_tr_b16 v[224:225], v69 offset:45760
    v_mfma_f32_16x16x32_bf16 v[84:87], v[228:231], v[176:179], v[84:87]
    ds_read_b64_tr_b16 v[226:227], v69 offset:46272
    v_mfma_f32_16x16x32_bf16 v[88:91], v[232:235], v[36:39], v[88:91]
    ds_read_b64_tr_b16 v[228:229], v69 offset:45792
    v_mfma_f32_16x16x32_bf16 v[92:95], v[232:235], v[176:179], v[92:95]
    ds_read_b64_tr_b16 v[230:231], v69 offset:46304
    s_waitcnt lgkmcnt(8)
    v_mfma_f32_16x16x32_bf16 v[96:99], v[236:239], v[36:39], v[96:99]
    s_barrier
    ds_read_b64_tr_b16 v[232:233], v71 offset:8320
    v_mfma_f32_16x16x32_bf16 v[100:103], v[236:239], v[176:179], v[100:103]
    ds_read_b64_tr_b16 v[234:235], v71 offset:8832
    v_mfma_f32_16x16x32_bf16 v[104:107], v[240:243], v[36:39], v[104:107]
    ds_read_b64_tr_b16 v[236:237], v71 offset:8352
    v_mfma_f32_16x16x32_bf16 v[108:111], v[240:243], v[176:179], v[108:111]
    ds_read_b64_tr_b16 v[238:239], v71 offset:8864
    s_waitcnt lgkmcnt(8)
    v_mfma_f32_16x16x32_bf16 v[144:147], v[244:247], v[36:39], v[144:147]
    ds_read_b64_tr_b16 v[240:241], v70 offset:8320
    v_mfma_f32_16x16x32_bf16 v[148:151], v[244:247], v[176:179], v[148:151]
    ds_read_b64_tr_b16 v[242:243], v70 offset:8832
    v_mfma_f32_16x16x32_bf16 v[152:155], v[248:251], v[36:39], v[152:155]
    ds_read_b64_tr_b16 v[244:245], v70 offset:8352
    v_mfma_f32_16x16x32_bf16 v[156:159], v[248:251], v[176:179], v[156:159]
    ds_read_b64_tr_b16 v[246:247], v70 offset:8864
    s_waitcnt lgkmcnt(8)
    v_mfma_f32_16x16x32_bf16 v[160:163], v[224:227], v[36:39], v[160:163]
    ds_read_b64_tr_b16 v[248:249], v70
    v_mfma_f32_16x16x32_bf16 v[164:167], v[224:227], v[176:179], v[164:167]
    ds_read_b64_tr_b16 v[250:251], v70 offset:512
    v_mfma_f32_16x16x32_bf16 v[168:171], v[228:231], v[36:39], v[168:171]
    ds_read_b64_tr_b16 v[224:225], v70 offset:32
    v_mfma_f32_16x16x32_bf16 v[172:175], v[228:231], v[176:179], v[172:175]
    ds_read_b64_tr_b16 v[226:227], v70 offset:544
    s_waitcnt lgkmcnt(8)
    s_waitcnt vmcnt(9)
    v_mfma_f32_16x16x32_bf16 v[128:131], v[232:235], v[180:183], v[128:131]
    ds_read_b64_tr_b16 v[228:229], v71
    v_mfma_f32_16x16x32_bf16 v[132:135], v[232:235], v[184:187], v[132:135]
    ds_read_b64_tr_b16 v[230:231], v71 offset:512
    buffer_load_dwordx4 v[36:39], v2, s[32:35], s16 offen offset:3072 sc1
    v_mfma_f32_16x16x32_bf16 v[136:139], v[236:239], v[180:183], v[136:139]
    ds_read_b64_tr_b16 v[232:233], v71 offset:32
    v_mfma_f32_16x16x32_bf16 v[140:143], v[236:239], v[184:187], v[140:143]
    ds_read_b64_tr_b16 v[234:235], v71 offset:544
    s_waitcnt lgkmcnt(8)
    v_mfma_f32_16x16x32_bf16 v[112:115], v[240:243], v[180:183], v[112:115]
    ds_read_b64_tr_b16 v[236:237], v70 offset:16640
    v_mfma_f32_16x16x32_bf16 v[116:119], v[240:243], v[184:187], v[116:119]
    ds_read_b64_tr_b16 v[238:239], v70 offset:17152
    v_mfma_f32_16x16x32_bf16 v[120:123], v[244:247], v[180:183], v[120:123]
    ds_read_b64_tr_b16 v[240:241], v70 offset:16672
    v_mfma_f32_16x16x32_bf16 v[124:127], v[244:247], v[184:187], v[124:127]
    ds_read_b64_tr_b16 v[242:243], v70 offset:17184
    s_add_u32 s96, s85, 13
    s_and_b32 s97, s96, 15
    s_lshl_b32 s98, s97, 14
    s_add_u32 s16, s98, s15
    buffer_load_dwordx4 v[176:179], v2, s[32:35], s16 offen sc1
    s_waitcnt lgkmcnt(8)
    v_mfma_f32_16x16x32_bf16 v[80:83], v[248:251], v[180:183], v[80:83]
    ds_read_b64_tr_b16 v[244:245], v71 offset:16640
    v_mfma_f32_16x16x32_bf16 v[84:87], v[248:251], v[184:187], v[84:87]
    ds_read_b64_tr_b16 v[246:247], v71 offset:17152
    v_mfma_f32_16x16x32_bf16 v[88:91], v[224:227], v[180:183], v[88:91]
    ds_read_b64_tr_b16 v[248:249], v71 offset:16672
    v_mfma_f32_16x16x32_bf16 v[92:95], v[224:227], v[184:187], v[92:95]
    ds_read_b64_tr_b16 v[250:251], v71 offset:17184
    s_waitcnt lgkmcnt(8)
    v_mfma_f32_16x16x32_bf16 v[96:99], v[228:231], v[180:183], v[96:99]
    ds_read_b64_tr_b16 v[224:225], v71 offset:12480
    v_mfma_f32_16x16x32_bf16 v[100:103], v[228:231], v[184:187], v[100:103]
    ds_read_b64_tr_b16 v[226:227], v71 offset:12992
    v_mfma_f32_16x16x32_bf16 v[104:107], v[232:235], v[180:183], v[104:107]
    ds_read_b64_tr_b16 v[228:229], v71 offset:12512
    v_mfma_f32_16x16x32_bf16 v[108:111], v[232:235], v[184:187], v[108:111]
    ds_read_b64_tr_b16 v[230:231], v71 offset:13024
    s_waitcnt lgkmcnt(8)
    v_mfma_f32_16x16x32_bf16 v[144:147], v[236:239], v[180:183], v[144:147]
    ds_read_b64_tr_b16 v[232:233], v70 offset:12480
    v_mfma_f32_16x16x32_bf16 v[148:151], v[236:239], v[184:187], v[148:151]
    ds_read_b64_tr_b16 v[234:235], v70 offset:12992
    v_mfma_f32_16x16x32_bf16 v[152:155], v[240:243], v[180:183], v[152:155]
    ds_read_b64_tr_b16 v[236:237], v70 offset:12512
    v_mfma_f32_16x16x32_bf16 v[156:159], v[240:243], v[184:187], v[156:159]
    ds_read_b64_tr_b16 v[238:239], v70 offset:13024
    s_waitcnt lgkmcnt(8)
    v_mfma_f32_16x16x32_bf16 v[160:163], v[244:247], v[180:183], v[160:163]
    ds_read_b64_tr_b16 v[240:241], v70 offset:4160
    v_mfma_f32_16x16x32_bf16 v[164:167], v[244:247], v[184:187], v[164:167]
    ds_read_b64_tr_b16 v[242:243], v70 offset:4672
    v_mfma_f32_16x16x32_bf16 v[168:171], v[248:251], v[180:183], v[168:171]
    ds_read_b64_tr_b16 v[244:245], v70 offset:4192
    v_mfma_f32_16x16x32_bf16 v[172:175], v[248:251], v[184:187], v[172:175]
    ds_read_b64_tr_b16 v[246:247], v70 offset:4704
    s_waitcnt lgkmcnt(8)
    s_waitcnt vmcnt(9)
    v_mfma_f32_16x16x32_bf16 v[128:131], v[224:227], v[188:191], v[128:131]
    ds_read_b64_tr_b16 v[248:249], v71 offset:4160
    v_mfma_f32_16x16x32_bf16 v[132:135], v[224:227], v[192:195], v[132:135]
    ds_read_b64_tr_b16 v[250:251], v71 offset:4672
    buffer_load_dwordx4 v[180:183], v2, s[32:35], s16 offen offset:1024 sc1
    v_mfma_f32_16x16x32_bf16 v[136:139], v[228:231], v[188:191], v[136:139]
    ds_read_b64_tr_b16 v[224:225], v71 offset:4192
    v_mfma_f32_16x16x32_bf16 v[140:143], v[228:231], v[192:195], v[140:143]
    ds_read_b64_tr_b16 v[226:227], v71 offset:4704
    s_waitcnt lgkmcnt(8)
    v_mfma_f32_16x16x32_bf16 v[112:115], v[232:235], v[188:191], v[112:115]
    ds_read_b64_tr_b16 v[228:229], v70 offset:20800
    v_mfma_f32_16x16x32_bf16 v[116:119], v[232:235], v[192:195], v[116:119]
    ds_read_b64_tr_b16 v[230:231], v70 offset:21312
    v_mfma_f32_16x16x32_bf16 v[120:123], v[236:239], v[188:191], v[120:123]
    ds_read_b64_tr_b16 v[232:233], v70 offset:20832
    v_mfma_f32_16x16x32_bf16 v[124:127], v[236:239], v[192:195], v[124:127]
    ds_read_b64_tr_b16 v[234:235], v70 offset:21344
    buffer_load_dwordx4 v[184:187], v2, s[32:35], s16 offen offset:2048 sc1
    s_waitcnt lgkmcnt(8)
    v_mfma_f32_16x16x32_bf16 v[80:83], v[240:243], v[188:191], v[80:83]
    ds_read_b64_tr_b16 v[236:237], v71 offset:20800
    v_mfma_f32_16x16x32_bf16 v[84:87], v[240:243], v[192:195], v[84:87]
    ds_read_b64_tr_b16 v[238:239], v71 offset:21312
    v_mfma_f32_16x16x32_bf16 v[88:91], v[244:247], v[188:191], v[88:91]
    ds_read_b64_tr_b16 v[240:241], v71 offset:20832
    v_mfma_f32_16x16x32_bf16 v[92:95], v[244:247], v[192:195], v[92:95]
    ds_read_b64_tr_b16 v[242:243], v71 offset:21344
    s_waitcnt lgkmcnt(8)
    v_mfma_f32_16x16x32_bf16 v[96:99], v[248:251], v[188:191], v[96:99]
    s_barrier
    ds_read_b64_tr_b16 v[244:245], v71 offset:33280
    v_mfma_f32_16x16x32_bf16 v[100:103], v[248:251], v[192:195], v[100:103]
    ds_read_b64_tr_b16 v[246:247], v71 offset:33792
    v_mfma_f32_16x16x32_bf16 v[104:107], v[224:227], v[188:191], v[104:107]
    ds_read_b64_tr_b16 v[248:249], v71 offset:33312
    v_mfma_f32_16x16x32_bf16 v[108:111], v[224:227], v[192:195], v[108:111]
    ds_read_b64_tr_b16 v[250:251], v71 offset:33824
    s_waitcnt lgkmcnt(8)
    v_mfma_f32_16x16x32_bf16 v[144:147], v[228:231], v[188:191], v[144:147]
    ds_read_b64_tr_b16 v[224:225], v70 offset:33280
    v_mfma_f32_16x16x32_bf16 v[148:151], v[228:231], v[192:195], v[148:151]
    ds_read_b64_tr_b16 v[226:227], v70 offset:33792
    v_mfma_f32_16x16x32_bf16 v[152:155], v[232:235], v[188:191], v[152:155]
    ds_read_b64_tr_b16 v[228:229], v70 offset:33312
    v_mfma_f32_16x16x32_bf16 v[156:159], v[232:235], v[192:195], v[156:159]
    ds_read_b64_tr_b16 v[230:231], v70 offset:33824
    s_waitcnt lgkmcnt(8)
    v_mfma_f32_16x16x32_bf16 v[160:163], v[236:239], v[188:191], v[160:163]
    ds_read_b64_tr_b16 v[232:233], v70 offset:24960
    v_mfma_f32_16x16x32_bf16 v[164:167], v[236:239], v[192:195], v[164:167]
    ds_read_b64_tr_b16 v[234:235], v70 offset:25472
    v_mfma_f32_16x16x32_bf16 v[168:171], v[240:243], v[188:191], v[168:171]
    ds_read_b64_tr_b16 v[236:237], v70 offset:24992
    v_mfma_f32_16x16x32_bf16 v[172:175], v[240:243], v[192:195], v[172:175]
    ds_read_b64_tr_b16 v[238:239], v70 offset:25504
    s_waitcnt lgkmcnt(8)
    s_waitcnt vmcnt(9)
    v_mfma_f32_16x16x32_bf16 v[128:131], v[244:247], v[196:199], v[128:131]
    ds_read_b64_tr_b16 v[240:241], v71 offset:24960
    v_mfma_f32_16x16x32_bf16 v[132:135], v[244:247], v[200:203], v[132:135]
    ds_read_b64_tr_b16 v[242:243], v71 offset:25472
    buffer_load_dwordx4 v[188:191], v2, s[32:35], s16 offen offset:3072 sc1
    v_mfma_f32_16x16x32_bf16 v[136:139], v[248:251], v[196:199], v[136:139]
    ds_read_b64_tr_b16 v[244:245], v71 offset:24992
    v_mfma_f32_16x16x32_bf16 v[140:143], v[248:251], v[200:203], v[140:143]
    ds_read_b64_tr_b16 v[246:247], v71 offset:25504
    s_waitcnt lgkmcnt(8)
    v_mfma_f32_16x16x32_bf16 v[112:115], v[224:227], v[196:199], v[112:115]
    ds_read_b64_tr_b16 v[248:249], v70 offset:41600
    v_mfma_f32_16x16x32_bf16 v[116:119], v[224:227], v[200:203], v[116:119]
    ds_read_b64_tr_b16 v[250:251], v70 offset:42112
    v_mfma_f32_16x16x32_bf16 v[120:123], v[228:231], v[196:199], v[120:123]
    ds_read_b64_tr_b16 v[224:225], v70 offset:41632
    v_mfma_f32_16x16x32_bf16 v[124:127], v[228:231], v[200:203], v[124:127]
    ds_read_b64_tr_b16 v[226:227], v70 offset:42144
    s_add_u32 s96, s85, 14
    s_and_b32 s97, s96, 15
    s_lshl_b32 s98, s97, 14
    s_add_u32 s16, s98, s15
    buffer_load_dwordx4 v[192:195], v2, s[32:35], s16 offen sc1
    s_waitcnt lgkmcnt(8)
    v_mfma_f32_16x16x32_bf16 v[80:83], v[232:235], v[196:199], v[80:83]
    ds_read_b64_tr_b16 v[228:229], v71 offset:41600
    v_mfma_f32_16x16x32_bf16 v[84:87], v[232:235], v[200:203], v[84:87]
    ds_read_b64_tr_b16 v[230:231], v71 offset:42112
    v_mfma_f32_16x16x32_bf16 v[88:91], v[236:239], v[196:199], v[88:91]
    ds_read_b64_tr_b16 v[232:233], v71 offset:41632
    v_mfma_f32_16x16x32_bf16 v[92:95], v[236:239], v[200:203], v[92:95]
    ds_read_b64_tr_b16 v[234:235], v71 offset:42144
    s_waitcnt lgkmcnt(8)
    v_mfma_f32_16x16x32_bf16 v[96:99], v[240:243], v[196:199], v[96:99]
    ds_read_b64_tr_b16 v[236:237], v71 offset:37440
    v_mfma_f32_16x16x32_bf16 v[100:103], v[240:243], v[200:203], v[100:103]
    ds_read_b64_tr_b16 v[238:239], v71 offset:37952
    v_mfma_f32_16x16x32_bf16 v[104:107], v[244:247], v[196:199], v[104:107]
    ds_read_b64_tr_b16 v[240:241], v71 offset:37472
    v_mfma_f32_16x16x32_bf16 v[108:111], v[244:247], v[200:203], v[108:111]
    ds_read_b64_tr_b16 v[242:243], v71 offset:37984
    s_waitcnt lgkmcnt(8)
    v_mfma_f32_16x16x32_bf16 v[144:147], v[248:251], v[196:199], v[144:147]
    ds_read_b64_tr_b16 v[244:245], v70 offset:37440
    v_mfma_f32_16x16x32_bf16 v[148:151], v[248:251], v[200:203], v[148:151]
    ds_read_b64_tr_b16 v[246:247], v70 offset:37952
    v_mfma_f32_16x16x32_bf16 v[152:155], v[224:227], v[196:199], v[152:155]
    ds_read_b64_tr_b16 v[248:249], v70 offset:37472
    v_mfma_f32_16x16x32_bf16 v[156:159], v[224:227], v[200:203], v[156:159]
    ds_read_b64_tr_b16 v[250:251], v70 offset:37984
    s_waitcnt lgkmcnt(8)
    v_mfma_f32_16x16x32_bf16 v[160:163], v[228:231], v[196:199], v[160:163]
    ds_read_b64_tr_b16 v[224:225], v70 offset:29120
    v_mfma_f32_16x16x32_bf16 v[164:167], v[228:231], v[200:203], v[164:167]
    ds_read_b64_tr_b16 v[226:227], v70 offset:29632
    v_mfma_f32_16x16x32_bf16 v[168:171], v[232:235], v[196:199], v[168:171]
    ds_read_b64_tr_b16 v[228:229], v70 offset:29152
    v_mfma_f32_16x16x32_bf16 v[172:175], v[232:235], v[200:203], v[172:175]
    ds_read_b64_tr_b16 v[230:231], v70 offset:29664
    s_waitcnt lgkmcnt(8)
    s_waitcnt vmcnt(9)
    v_mfma_f32_16x16x32_bf16 v[128:131], v[236:239], v[204:207], v[128:131]
    ds_read_b64_tr_b16 v[232:233], v71 offset:29120
    v_mfma_f32_16x16x32_bf16 v[132:135], v[236:239], v[208:211], v[132:135]
    ds_read_b64_tr_b16 v[234:235], v71 offset:29632
    buffer_load_dwordx4 v[196:199], v2, s[32:35], s16 offen offset:1024 sc1
    v_mfma_f32_16x16x32_bf16 v[136:139], v[240:243], v[204:207], v[136:139]
    ds_read_b64_tr_b16 v[236:237], v71 offset:29152
    v_mfma_f32_16x16x32_bf16 v[140:143], v[240:243], v[208:211], v[140:143]
    ds_read_b64_tr_b16 v[238:239], v71 offset:29664
    s_waitcnt lgkmcnt(8)
    v_mfma_f32_16x16x32_bf16 v[112:115], v[244:247], v[204:207], v[112:115]
    ds_read_b64_tr_b16 v[240:241], v70 offset:45760
    v_mfma_f32_16x16x32_bf16 v[116:119], v[244:247], v[208:211], v[116:119]
    ds_read_b64_tr_b16 v[242:243], v70 offset:46272
    v_mfma_f32_16x16x32_bf16 v[120:123], v[248:251], v[204:207], v[120:123]
    ds_read_b64_tr_b16 v[244:245], v70 offset:45792
    v_mfma_f32_16x16x32_bf16 v[124:127], v[248:251], v[208:211], v[124:127]
    ds_read_b64_tr_b16 v[246:247], v70 offset:46304
    buffer_load_dwordx4 v[200:203], v2, s[32:35], s16 offen offset:2048 sc1
    s_waitcnt lgkmcnt(8)
    v_mfma_f32_16x16x32_bf16 v[80:83], v[224:227], v[204:207], v[80:83]
    ds_read_b64_tr_b16 v[248:249], v71 offset:45760
    v_mfma_f32_16x16x32_bf16 v[84:87], v[224:227], v[208:211], v[84:87]
    ds_read_b64_tr_b16 v[250:251], v71 offset:46272
    v_mfma_f32_16x16x32_bf16 v[88:91], v[228:231], v[204:207], v[88:91]
    ds_read_b64_tr_b16 v[224:225], v71 offset:45792
    v_mfma_f32_16x16x32_bf16 v[92:95], v[228:231], v[208:211], v[92:95]
    ds_read_b64_tr_b16 v[226:227], v71 offset:46304
    s_waitcnt lgkmcnt(8)
    v_mfma_f32_16x16x32_bf16 v[96:99], v[232:235], v[204:207], v[96:99]
    s_barrier
    ds_read_b64_tr_b16 v[228:229], v67 offset:8320
    v_mfma_f32_16x16x32_bf16 v[100:103], v[232:235], v[208:211], v[100:103]
    ds_read_b64_tr_b16 v[230:231], v67 offset:8832
    v_mfma_f32_16x16x32_bf16 v[104:107], v[236:239], v[204:207], v[104:107]
    ds_read_b64_tr_b16 v[232:233], v67 offset:8352
    v_mfma_f32_16x16x32_bf16 v[108:111], v[236:239], v[208:211], v[108:111]
    ds_read_b64_tr_b16 v[234:235], v67 offset:8864
    s_waitcnt lgkmcnt(8)
    v_mfma_f32_16x16x32_bf16 v[144:147], v[240:243], v[204:207], v[144:147]
    ds_read_b64_tr_b16 v[236:237], v66 offset:8320
    v_mfma_f32_16x16x32_bf16 v[148:151], v[240:243], v[208:211], v[148:151]
    ds_read_b64_tr_b16 v[238:239], v66 offset:8832
    v_mfma_f32_16x16x32_bf16 v[152:155], v[244:247], v[204:207], v[152:155]
    ds_read_b64_tr_b16 v[240:241], v66 offset:8352
    v_mfma_f32_16x16x32_bf16 v[156:159], v[244:247], v[208:211], v[156:159]
    ds_read_b64_tr_b16 v[242:243], v66 offset:8864
    s_waitcnt lgkmcnt(8)
    v_mfma_f32_16x16x32_bf16 v[160:163], v[248:251], v[204:207], v[160:163]
    ds_read_b64_tr_b16 v[244:245], v66
    v_mfma_f32_16x16x32_bf16 v[164:167], v[248:251], v[208:211], v[164:167]
    ds_read_b64_tr_b16 v[246:247], v66 offset:512
    v_mfma_f32_16x16x32_bf16 v[168:171], v[224:227], v[204:207], v[168:171]
    ds_read_b64_tr_b16 v[248:249], v66 offset:32
    v_mfma_f32_16x16x32_bf16 v[172:175], v[224:227], v[208:211], v[172:175]
    ds_read_b64_tr_b16 v[250:251], v66 offset:544
    s_waitcnt lgkmcnt(8)
    s_waitcnt vmcnt(9)
    v_mfma_f32_16x16x32_bf16 v[128:131], v[228:231], v[212:215], v[128:131]
    ds_read_b64_tr_b16 v[224:225], v67
    v_mfma_f32_16x16x32_bf16 v[132:135], v[228:231], v[216:219], v[132:135]
    ds_read_b64_tr_b16 v[226:227], v67 offset:512
    buffer_load_dwordx4 v[204:207], v2, s[32:35], s16 offen offset:3072 sc1
    v_mfma_f32_16x16x32_bf16 v[136:139], v[232:235], v[212:215], v[136:139]
    ds_read_b64_tr_b16 v[228:229], v67 offset:32
    v_mfma_f32_16x16x32_bf16 v[140:143], v[232:235], v[216:219], v[140:143]
    ds_read_b64_tr_b16 v[230:231], v67 offset:544
    s_waitcnt lgkmcnt(8)
    v_mfma_f32_16x16x32_bf16 v[112:115], v[236:239], v[212:215], v[112:115]
    ds_read_b64_tr_b16 v[232:233], v66 offset:16640
    v_mfma_f32_16x16x32_bf16 v[116:119], v[236:239], v[216:219], v[116:119]
    ds_read_b64_tr_b16 v[234:235], v66 offset:17152
    v_mfma_f32_16x16x32_bf16 v[120:123], v[240:243], v[212:215], v[120:123]
    ds_read_b64_tr_b16 v[236:237], v66 offset:16672
    v_mfma_f32_16x16x32_bf16 v[124:127], v[240:243], v[216:219], v[124:127]
    ds_read_b64_tr_b16 v[238:239], v66 offset:17184
    s_add_u32 s96, s85, 15
    s_and_b32 s97, s96, 15
    s_lshl_b32 s98, s97, 14
    s_add_u32 s16, s98, s15
    buffer_load_dwordx4 v[208:211], v2, s[32:35], s16 offen sc1
    s_waitcnt lgkmcnt(8)
    v_mfma_f32_16x16x32_bf16 v[80:83], v[244:247], v[212:215], v[80:83]
    ds_read_b64_tr_b16 v[240:241], v67 offset:16640
    v_mfma_f32_16x16x32_bf16 v[84:87], v[244:247], v[216:219], v[84:87]
    ds_read_b64_tr_b16 v[242:243], v67 offset:17152
    v_mfma_f32_16x16x32_bf16 v[88:91], v[248:251], v[212:215], v[88:91]
    ds_read_b64_tr_b16 v[244:245], v67 offset:16672
    v_mfma_f32_16x16x32_bf16 v[92:95], v[248:251], v[216:219], v[92:95]
    ds_read_b64_tr_b16 v[246:247], v67 offset:17184
    s_waitcnt lgkmcnt(8)
    v_mfma_f32_16x16x32_bf16 v[96:99], v[224:227], v[212:215], v[96:99]
    ds_read_b64_tr_b16 v[248:249], v67 offset:12480
    v_mfma_f32_16x16x32_bf16 v[100:103], v[224:227], v[216:219], v[100:103]
    ds_read_b64_tr_b16 v[250:251], v67 offset:12992
    v_mfma_f32_16x16x32_bf16 v[104:107], v[228:231], v[212:215], v[104:107]
    ds_read_b64_tr_b16 v[224:225], v67 offset:12512
    v_mfma_f32_16x16x32_bf16 v[108:111], v[228:231], v[216:219], v[108:111]
    ds_read_b64_tr_b16 v[226:227], v67 offset:13024
    s_waitcnt lgkmcnt(8)
    v_mfma_f32_16x16x32_bf16 v[144:147], v[232:235], v[212:215], v[144:147]
    ds_read_b64_tr_b16 v[228:229], v66 offset:12480
    v_mfma_f32_16x16x32_bf16 v[148:151], v[232:235], v[216:219], v[148:151]
    ds_read_b64_tr_b16 v[230:231], v66 offset:12992
    v_mfma_f32_16x16x32_bf16 v[152:155], v[236:239], v[212:215], v[152:155]
    ds_read_b64_tr_b16 v[232:233], v66 offset:12512
    v_mfma_f32_16x16x32_bf16 v[156:159], v[236:239], v[216:219], v[156:159]
    ds_read_b64_tr_b16 v[234:235], v66 offset:13024
    s_waitcnt lgkmcnt(8)
    v_mfma_f32_16x16x32_bf16 v[160:163], v[240:243], v[212:215], v[160:163]
    ds_read_b64_tr_b16 v[236:237], v66 offset:4160
    v_mfma_f32_16x16x32_bf16 v[164:167], v[240:243], v[216:219], v[164:167]
    ds_read_b64_tr_b16 v[238:239], v66 offset:4672
    v_mfma_f32_16x16x32_bf16 v[168:171], v[244:247], v[212:215], v[168:171]
    ds_read_b64_tr_b16 v[240:241], v66 offset:4192
    v_mfma_f32_16x16x32_bf16 v[172:175], v[244:247], v[216:219], v[172:175]
    ds_read_b64_tr_b16 v[242:243], v66 offset:4704
    s_waitcnt lgkmcnt(8)
    s_waitcnt vmcnt(9)
    v_mfma_f32_16x16x32_bf16 v[128:131], v[248:251], v[220:223], v[128:131]
    ds_read_b64_tr_b16 v[244:245], v67 offset:4160
    v_mfma_f32_16x16x32_bf16 v[132:135], v[248:251], v[36:39], v[132:135]
    ds_read_b64_tr_b16 v[246:247], v67 offset:4672
    buffer_load_dwordx4 v[212:215], v2, s[32:35], s16 offen offset:1024 sc1
    v_mfma_f32_16x16x32_bf16 v[136:139], v[224:227], v[220:223], v[136:139]
    ds_read_b64_tr_b16 v[248:249], v67 offset:4192
    v_mfma_f32_16x16x32_bf16 v[140:143], v[224:227], v[36:39], v[140:143]
    ds_read_b64_tr_b16 v[250:251], v67 offset:4704
    s_waitcnt lgkmcnt(8)
    v_mfma_f32_16x16x32_bf16 v[112:115], v[228:231], v[220:223], v[112:115]
    ds_read_b64_tr_b16 v[224:225], v66 offset:20800
    v_mfma_f32_16x16x32_bf16 v[116:119], v[228:231], v[36:39], v[116:119]
    ds_read_b64_tr_b16 v[226:227], v66 offset:21312
    v_mfma_f32_16x16x32_bf16 v[120:123], v[232:235], v[220:223], v[120:123]
    ds_read_b64_tr_b16 v[228:229], v66 offset:20832
    v_mfma_f32_16x16x32_bf16 v[124:127], v[232:235], v[36:39], v[124:127]
    ds_read_b64_tr_b16 v[230:231], v66 offset:21344
    buffer_load_dwordx4 v[216:219], v2, s[32:35], s16 offen offset:2048 sc1
    s_waitcnt lgkmcnt(8)
    v_mfma_f32_16x16x32_bf16 v[80:83], v[236:239], v[220:223], v[80:83]
    ds_read_b64_tr_b16 v[232:233], v67 offset:20800
    v_mfma_f32_16x16x32_bf16 v[84:87], v[236:239], v[36:39], v[84:87]
    ds_read_b64_tr_b16 v[234:235], v67 offset:21312
    v_mfma_f32_16x16x32_bf16 v[88:91], v[240:243], v[220:223], v[88:91]
    ds_read_b64_tr_b16 v[236:237], v67 offset:20832
    v_mfma_f32_16x16x32_bf16 v[92:95], v[240:243], v[36:39], v[92:95]
    ds_read_b64_tr_b16 v[238:239], v67 offset:21344
    s_waitcnt lgkmcnt(8)
    v_mfma_f32_16x16x32_bf16 v[96:99], v[244:247], v[220:223], v[96:99]
    s_barrier
    ds_read_b64_tr_b16 v[240:241], v67 offset:33280
    v_mfma_f32_16x16x32_bf16 v[100:103], v[244:247], v[36:39], v[100:103]
    ds_read_b64_tr_b16 v[242:243], v67 offset:33792
    v_mfma_f32_16x16x32_bf16 v[104:107], v[248:251], v[220:223], v[104:107]
    ds_read_b64_tr_b16 v[244:245], v67 offset:33312
    v_mfma_f32_16x16x32_bf16 v[108:111], v[248:251], v[36:39], v[108:111]
    ds_read_b64_tr_b16 v[246:247], v67 offset:33824
    s_waitcnt lgkmcnt(8)
    v_mfma_f32_16x16x32_bf16 v[144:147], v[224:227], v[220:223], v[144:147]
    ds_read_b64_tr_b16 v[248:249], v66 offset:33280
    v_mfma_f32_16x16x32_bf16 v[148:151], v[224:227], v[36:39], v[148:151]
    ds_read_b64_tr_b16 v[250:251], v66 offset:33792
    v_mfma_f32_16x16x32_bf16 v[152:155], v[228:231], v[220:223], v[152:155]
    ds_read_b64_tr_b16 v[224:225], v66 offset:33312
    v_mfma_f32_16x16x32_bf16 v[156:159], v[228:231], v[36:39], v[156:159]
    ds_read_b64_tr_b16 v[226:227], v66 offset:33824
    s_waitcnt lgkmcnt(8)
    v_mfma_f32_16x16x32_bf16 v[160:163], v[232:235], v[220:223], v[160:163]
    ds_read_b64_tr_b16 v[228:229], v66 offset:24960
    v_mfma_f32_16x16x32_bf16 v[164:167], v[232:235], v[36:39], v[164:167]
    ds_read_b64_tr_b16 v[230:231], v66 offset:25472
    v_mfma_f32_16x16x32_bf16 v[168:171], v[236:239], v[220:223], v[168:171]
    ds_read_b64_tr_b16 v[232:233], v66 offset:24992
    v_mfma_f32_16x16x32_bf16 v[172:175], v[236:239], v[36:39], v[172:175]
    ds_read_b64_tr_b16 v[234:235], v66 offset:25504
    s_waitcnt lgkmcnt(8)
    s_waitcnt vmcnt(9)
    v_mfma_f32_16x16x32_bf16 v[128:131], v[240:243], v[176:179], v[128:131]
    ds_read_b64_tr_b16 v[236:237], v67 offset:24960
    v_mfma_f32_16x16x32_bf16 v[132:135], v[240:243], v[180:183], v[132:135]
    ds_read_b64_tr_b16 v[238:239], v67 offset:25472
    buffer_load_dwordx4 v[220:223], v2, s[32:35], s16 offen offset:3072 sc1
    s_barrier
    v_mfma_f32_16x16x32_bf16 v[136:139], v[244:247], v[176:179], v[136:139]
    ds_read_b64_tr_b16 v[240:241], v67 offset:24992
    v_mfma_f32_16x16x32_bf16 v[140:143], v[244:247], v[180:183], v[140:143]
    ds_read_b64_tr_b16 v[242:243], v67 offset:25504
    s_waitcnt lgkmcnt(8)
    v_mfma_f32_16x16x32_bf16 v[112:115], v[248:251], v[176:179], v[112:115]
    ds_read_b64_tr_b16 v[244:245], v66 offset:41600
    v_mfma_f32_16x16x32_bf16 v[116:119], v[248:251], v[180:183], v[116:119]
    ds_read_b64_tr_b16 v[246:247], v66 offset:42112
    v_mfma_f32_16x16x32_bf16 v[120:123], v[224:227], v[176:179], v[120:123]
    ds_read_b64_tr_b16 v[248:249], v66 offset:41632
    v_mfma_f32_16x16x32_bf16 v[124:127], v[224:227], v[180:183], v[124:127]
    ds_read_b64_tr_b16 v[250:251], v66 offset:42144
    s_waitcnt lgkmcnt(8)
    v_mfma_f32_16x16x32_bf16 v[80:83], v[228:231], v[176:179], v[80:83]
    ds_read_b64_tr_b16 v[224:225], v67 offset:41600
    v_mfma_f32_16x16x32_bf16 v[84:87], v[228:231], v[180:183], v[84:87]
    ds_read_b64_tr_b16 v[226:227], v67 offset:42112
    v_mfma_f32_16x16x32_bf16 v[88:91], v[232:235], v[176:179], v[88:91]
    ds_read_b64_tr_b16 v[228:229], v67 offset:41632
    v_mfma_f32_16x16x32_bf16 v[92:95], v[232:235], v[180:183], v[92:95]
    ds_read_b64_tr_b16 v[230:231], v67 offset:42144
    s_waitcnt lgkmcnt(8)
    v_mfma_f32_16x16x32_bf16 v[96:99], v[236:239], v[176:179], v[96:99]
    ds_read_b64_tr_b16 v[232:233], v67 offset:37440
    v_mfma_f32_16x16x32_bf16 v[100:103], v[236:239], v[180:183], v[100:103]
    ds_read_b64_tr_b16 v[234:235], v67 offset:37952
    v_mfma_f32_16x16x32_bf16 v[104:107], v[240:243], v[176:179], v[104:107]
    ds_read_b64_tr_b16 v[236:237], v67 offset:37472
    v_mfma_f32_16x16x32_bf16 v[108:111], v[240:243], v[180:183], v[108:111]
    ds_read_b64_tr_b16 v[238:239], v67 offset:37984
    s_waitcnt lgkmcnt(8)
    v_mfma_f32_16x16x32_bf16 v[144:147], v[244:247], v[176:179], v[144:147]
    ds_read_b64_tr_b16 v[240:241], v66 offset:37440
    v_mfma_f32_16x16x32_bf16 v[148:151], v[244:247], v[180:183], v[148:151]
    ds_read_b64_tr_b16 v[242:243], v66 offset:37952
    v_mfma_f32_16x16x32_bf16 v[152:155], v[248:251], v[176:179], v[152:155]
    ds_read_b64_tr_b16 v[244:245], v66 offset:37472
    v_mfma_f32_16x16x32_bf16 v[156:159], v[248:251], v[180:183], v[156:159]
    ds_read_b64_tr_b16 v[246:247], v66 offset:37984
    s_waitcnt lgkmcnt(8)
    v_mfma_f32_16x16x32_bf16 v[160:163], v[224:227], v[176:179], v[160:163]
    ds_read_b64_tr_b16 v[248:249], v66 offset:29120
    v_mfma_f32_16x16x32_bf16 v[164:167], v[224:227], v[180:183], v[164:167]
    ds_read_b64_tr_b16 v[250:251], v66 offset:29632
    v_mfma_f32_16x16x32_bf16 v[168:171], v[228:231], v[176:179], v[168:171]
    ds_read_b64_tr_b16 v[224:225], v66 offset:29152
    v_mfma_f32_16x16x32_bf16 v[172:175], v[228:231], v[180:183], v[172:175]
    ds_read_b64_tr_b16 v[226:227], v66 offset:29664
    s_waitcnt lgkmcnt(8)
    s_waitcnt vmcnt(8)
    v_mfma_f32_16x16x32_bf16 v[128:131], v[232:235], v[184:187], v[128:131]
    ds_read_b64_tr_b16 v[228:229], v67 offset:29120
    v_mfma_f32_16x16x32_bf16 v[132:135], v[232:235], v[188:191], v[132:135]
    ds_read_b64_tr_b16 v[230:231], v67 offset:29632
    v_mfma_f32_16x16x32_bf16 v[136:139], v[236:239], v[184:187], v[136:139]
    ds_read_b64_tr_b16 v[232:233], v67 offset:29152
    v_mfma_f32_16x16x32_bf16 v[140:143], v[236:239], v[188:191], v[140:143]
    ds_read_b64_tr_b16 v[234:235], v67 offset:29664
    s_waitcnt lgkmcnt(8)
    v_mfma_f32_16x16x32_bf16 v[112:115], v[240:243], v[184:187], v[112:115]
    ds_read_b64_tr_b16 v[236:237], v66 offset:45760
    v_mfma_f32_16x16x32_bf16 v[116:119], v[240:243], v[188:191], v[116:119]
    ds_read_b64_tr_b16 v[238:239], v66 offset:46272
    v_mfma_f32_16x16x32_bf16 v[120:123], v[244:247], v[184:187], v[120:123]
    ds_read_b64_tr_b16 v[240:241], v66 offset:45792
    v_mfma_f32_16x16x32_bf16 v[124:127], v[244:247], v[188:191], v[124:127]
    ds_read_b64_tr_b16 v[242:243], v66 offset:46304
    s_waitcnt lgkmcnt(8)
    v_mfma_f32_16x16x32_bf16 v[80:83], v[248:251], v[184:187], v[80:83]
    ds_read_b64_tr_b16 v[244:245], v67 offset:45760
    v_mfma_f32_16x16x32_bf16 v[84:87], v[248:251], v[188:191], v[84:87]
    ds_read_b64_tr_b16 v[246:247], v67 offset:46272
    v_mfma_f32_16x16x32_bf16 v[88:91], v[224:227], v[184:187], v[88:91]
    ds_read_b64_tr_b16 v[248:249], v67 offset:45792
    v_mfma_f32_16x16x32_bf16 v[92:95], v[224:227], v[188:191], v[92:95]
    ds_read_b64_tr_b16 v[250:251], v67 offset:46304
    s_waitcnt lgkmcnt(8)
    v_mfma_f32_16x16x32_bf16 v[96:99], v[228:231], v[184:187], v[96:99]
    s_barrier
    ds_read_b64_tr_b16 v[224:225], v69 offset:8320
    v_mfma_f32_16x16x32_bf16 v[100:103], v[228:231], v[188:191], v[100:103]
    ds_read_b64_tr_b16 v[226:227], v69 offset:8832
    v_mfma_f32_16x16x32_bf16 v[104:107], v[232:235], v[184:187], v[104:107]
    ds_read_b64_tr_b16 v[228:229], v69 offset:8352
    v_mfma_f32_16x16x32_bf16 v[108:111], v[232:235], v[188:191], v[108:111]
    ds_read_b64_tr_b16 v[230:231], v69 offset:8864
    s_waitcnt lgkmcnt(8)
    v_mfma_f32_16x16x32_bf16 v[144:147], v[236:239], v[184:187], v[144:147]
    ds_read_b64_tr_b16 v[232:233], v68 offset:8320
    v_mfma_f32_16x16x32_bf16 v[148:151], v[236:239], v[188:191], v[148:151]
    ds_read_b64_tr_b16 v[234:235], v68 offset:8832
    v_mfma_f32_16x16x32_bf16 v[152:155], v[240:243], v[184:187], v[152:155]
    ds_read_b64_tr_b16 v[236:237], v68 offset:8352
    v_mfma_f32_16x16x32_bf16 v[156:159], v[240:243], v[188:191], v[156:159]
    ds_read_b64_tr_b16 v[238:239], v68 offset:8864
    s_waitcnt lgkmcnt(8)
    v_mfma_f32_16x16x32_bf16 v[160:163], v[244:247], v[184:187], v[160:163]
    ds_read_b64_tr_b16 v[240:241], v68
    v_mfma_f32_16x16x32_bf16 v[164:167], v[244:247], v[188:191], v[164:167]
    ds_read_b64_tr_b16 v[242:243], v68 offset:512
    v_mfma_f32_16x16x32_bf16 v[168:171], v[248:251], v[184:187], v[168:171]
    ds_read_b64_tr_b16 v[244:245], v68 offset:32
    v_mfma_f32_16x16x32_bf16 v[172:175], v[248:251], v[188:191], v[172:175]
    ds_read_b64_tr_b16 v[246:247], v68 offset:544
    s_waitcnt lgkmcnt(8)
    s_waitcnt vmcnt(6)
    v_mfma_f32_16x16x32_bf16 v[128:131], v[224:227], v[192:195], v[128:131]
    ds_read_b64_tr_b16 v[248:249], v69
    v_mfma_f32_16x16x32_bf16 v[132:135], v[224:227], v[196:199], v[132:135]
    ds_read_b64_tr_b16 v[250:251], v69 offset:512
    v_mfma_f32_16x16x32_bf16 v[136:139], v[228:231], v[192:195], v[136:139]
    ds_read_b64_tr_b16 v[224:225], v69 offset:32
    v_mfma_f32_16x16x32_bf16 v[140:143], v[228:231], v[196:199], v[140:143]
    ds_read_b64_tr_b16 v[226:227], v69 offset:544
    s_waitcnt lgkmcnt(8)
    v_mfma_f32_16x16x32_bf16 v[112:115], v[232:235], v[192:195], v[112:115]
    ds_read_b64_tr_b16 v[228:229], v68 offset:16640
    v_mfma_f32_16x16x32_bf16 v[116:119], v[232:235], v[196:199], v[116:119]
    ds_read_b64_tr_b16 v[230:231], v68 offset:17152
    v_mfma_f32_16x16x32_bf16 v[120:123], v[236:239], v[192:195], v[120:123]
    ds_read_b64_tr_b16 v[232:233], v68 offset:16672
    v_mfma_f32_16x16x32_bf16 v[124:127], v[236:239], v[196:199], v[124:127]
    ds_read_b64_tr_b16 v[234:235], v68 offset:17184
    s_waitcnt lgkmcnt(8)
    v_mfma_f32_16x16x32_bf16 v[80:83], v[240:243], v[192:195], v[80:83]
    ds_read_b64_tr_b16 v[236:237], v69 offset:16640
    v_mfma_f32_16x16x32_bf16 v[84:87], v[240:243], v[196:199], v[84:87]
    ds_read_b64_tr_b16 v[238:239], v69 offset:17152
    v_mfma_f32_16x16x32_bf16 v[88:91], v[244:247], v[192:195], v[88:91]
    ds_read_b64_tr_b16 v[240:241], v69 offset:16672
    v_mfma_f32_16x16x32_bf16 v[92:95], v[244:247], v[196:199], v[92:95]
    ds_read_b64_tr_b16 v[242:243], v69 offset:17184
    s_waitcnt lgkmcnt(8)
    v_mfma_f32_16x16x32_bf16 v[96:99], v[248:251], v[192:195], v[96:99]
    ds_read_b64_tr_b16 v[244:245], v69 offset:12480
    v_mfma_f32_16x16x32_bf16 v[100:103], v[248:251], v[196:199], v[100:103]
    ds_read_b64_tr_b16 v[246:247], v69 offset:12992
    v_mfma_f32_16x16x32_bf16 v[104:107], v[224:227], v[192:195], v[104:107]
    ds_read_b64_tr_b16 v[248:249], v69 offset:12512
    v_mfma_f32_16x16x32_bf16 v[108:111], v[224:227], v[196:199], v[108:111]
    ds_read_b64_tr_b16 v[250:251], v69 offset:13024
    s_waitcnt lgkmcnt(8)
    v_mfma_f32_16x16x32_bf16 v[144:147], v[228:231], v[192:195], v[144:147]
    ds_read_b64_tr_b16 v[224:225], v68 offset:12480
    v_mfma_f32_16x16x32_bf16 v[148:151], v[228:231], v[196:199], v[148:151]
    ds_read_b64_tr_b16 v[226:227], v68 offset:12992
    v_mfma_f32_16x16x32_bf16 v[152:155], v[232:235], v[192:195], v[152:155]
    ds_read_b64_tr_b16 v[228:229], v68 offset:12512
    v_mfma_f32_16x16x32_bf16 v[156:159], v[232:235], v[196:199], v[156:159]
    ds_read_b64_tr_b16 v[230:231], v68 offset:13024
    s_waitcnt lgkmcnt(8)
    v_mfma_f32_16x16x32_bf16 v[160:163], v[236:239], v[192:195], v[160:163]
    ds_read_b64_tr_b16 v[232:233], v68 offset:4160
    v_mfma_f32_16x16x32_bf16 v[164:167], v[236:239], v[196:199], v[164:167]
    ds_read_b64_tr_b16 v[234:235], v68 offset:4672
    v_mfma_f32_16x16x32_bf16 v[168:171], v[240:243], v[192:195], v[168:171]
    ds_read_b64_tr_b16 v[236:237], v68 offset:4192
    v_mfma_f32_16x16x32_bf16 v[172:175], v[240:243], v[196:199], v[172:175]
    ds_read_b64_tr_b16 v[238:239], v68 offset:4704
    s_waitcnt lgkmcnt(8)
    s_waitcnt vmcnt(4)
    v_mfma_f32_16x16x32_bf16 v[128:131], v[244:247], v[200:203], v[128:131]
    ds_read_b64_tr_b16 v[240:241], v69 offset:4160
    v_mfma_f32_16x16x32_bf16 v[132:135], v[244:247], v[204:207], v[132:135]
    ds_read_b64_tr_b16 v[242:243], v69 offset:4672
    v_mfma_f32_16x16x32_bf16 v[136:139], v[248:251], v[200:203], v[136:139]
    ds_read_b64_tr_b16 v[244:245], v69 offset:4192
    v_mfma_f32_16x16x32_bf16 v[140:143], v[248:251], v[204:207], v[140:143]
    ds_read_b64_tr_b16 v[246:247], v69 offset:4704
    s_waitcnt lgkmcnt(8)
    v_mfma_f32_16x16x32_bf16 v[112:115], v[224:227], v[200:203], v[112:115]
    ds_read_b64_tr_b16 v[248:249], v68 offset:20800
    v_mfma_f32_16x16x32_bf16 v[116:119], v[224:227], v[204:207], v[116:119]
    ds_read_b64_tr_b16 v[250:251], v68 offset:21312
    v_mfma_f32_16x16x32_bf16 v[120:123], v[228:231], v[200:203], v[120:123]
    ds_read_b64_tr_b16 v[224:225], v68 offset:20832
    v_mfma_f32_16x16x32_bf16 v[124:127], v[228:231], v[204:207], v[124:127]
    ds_read_b64_tr_b16 v[226:227], v68 offset:21344
    s_waitcnt lgkmcnt(8)
    v_mfma_f32_16x16x32_bf16 v[80:83], v[232:235], v[200:203], v[80:83]
    ds_read_b64_tr_b16 v[228:229], v69 offset:20800
    v_mfma_f32_16x16x32_bf16 v[84:87], v[232:235], v[204:207], v[84:87]
    ds_read_b64_tr_b16 v[230:231], v69 offset:21312
    v_mfma_f32_16x16x32_bf16 v[88:91], v[236:239], v[200:203], v[88:91]
    ds_read_b64_tr_b16 v[232:233], v69 offset:20832
    v_mfma_f32_16x16x32_bf16 v[92:95], v[236:239], v[204:207], v[92:95]
    ds_read_b64_tr_b16 v[234:235], v69 offset:21344
    s_waitcnt lgkmcnt(8)
    v_mfma_f32_16x16x32_bf16 v[96:99], v[240:243], v[200:203], v[96:99]
    ds_read_b64_tr_b16 v[236:237], v69 offset:33280
    v_mfma_f32_16x16x32_bf16 v[100:103], v[240:243], v[204:207], v[100:103]
    ds_read_b64_tr_b16 v[238:239], v69 offset:33792
    v_mfma_f32_16x16x32_bf16 v[104:107], v[244:247], v[200:203], v[104:107]
    ds_read_b64_tr_b16 v[240:241], v69 offset:33312
    v_mfma_f32_16x16x32_bf16 v[108:111], v[244:247], v[204:207], v[108:111]
    ds_read_b64_tr_b16 v[242:243], v69 offset:33824
    s_waitcnt lgkmcnt(8)
    v_mfma_f32_16x16x32_bf16 v[144:147], v[248:251], v[200:203], v[144:147]
    ds_read_b64_tr_b16 v[244:245], v68 offset:33280
    v_mfma_f32_16x16x32_bf16 v[148:151], v[248:251], v[204:207], v[148:151]
    ds_read_b64_tr_b16 v[246:247], v68 offset:33792
    v_mfma_f32_16x16x32_bf16 v[152:155], v[224:227], v[200:203], v[152:155]
    ds_read_b64_tr_b16 v[248:249], v68 offset:33312
    v_mfma_f32_16x16x32_bf16 v[156:159], v[224:227], v[204:207], v[156:159]
    ds_read_b64_tr_b16 v[250:251], v68 offset:33824
    s_waitcnt lgkmcnt(8)
    v_mfma_f32_16x16x32_bf16 v[160:163], v[228:231], v[200:203], v[160:163]
    ds_read_b64_tr_b16 v[224:225], v68 offset:24960
    v_mfma_f32_16x16x32_bf16 v[164:167], v[228:231], v[204:207], v[164:167]
    ds_read_b64_tr_b16 v[226:227], v68 offset:25472
    v_mfma_f32_16x16x32_bf16 v[168:171], v[232:235], v[200:203], v[168:171]
    ds_read_b64_tr_b16 v[228:229], v68 offset:24992
    v_mfma_f32_16x16x32_bf16 v[172:175], v[232:235], v[204:207], v[172:175]
    ds_read_b64_tr_b16 v[230:231], v68 offset:25504
    s_waitcnt lgkmcnt(8)
    s_waitcnt vmcnt(2)
    v_mfma_f32_16x16x32_bf16 v[128:131], v[236:239], v[208:211], v[128:131]
    ds_read_b64_tr_b16 v[232:233], v69 offset:24960
    v_mfma_f32_16x16x32_bf16 v[132:135], v[236:239], v[212:215], v[132:135]
    ds_read_b64_tr_b16 v[234:235], v69 offset:25472
    v_mfma_f32_16x16x32_bf16 v[136:139], v[240:243], v[208:211], v[136:139]
    ds_read_b64_tr_b16 v[236:237], v69 offset:24992
    v_mfma_f32_16x16x32_bf16 v[140:143], v[240:243], v[212:215], v[140:143]
    ds_read_b64_tr_b16 v[238:239], v69 offset:25504
    s_waitcnt lgkmcnt(8)
    v_mfma_f32_16x16x32_bf16 v[112:115], v[244:247], v[208:211], v[112:115]
    ds_read_b64_tr_b16 v[240:241], v68 offset:41600
    v_mfma_f32_16x16x32_bf16 v[116:119], v[244:247], v[212:215], v[116:119]
    ds_read_b64_tr_b16 v[242:243], v68 offset:42112
    v_mfma_f32_16x16x32_bf16 v[120:123], v[248:251], v[208:211], v[120:123]
    ds_read_b64_tr_b16 v[244:245], v68 offset:41632
    v_mfma_f32_16x16x32_bf16 v[124:127], v[248:251], v[212:215], v[124:127]
    ds_read_b64_tr_b16 v[246:247], v68 offset:42144
    s_waitcnt lgkmcnt(8)
    v_mfma_f32_16x16x32_bf16 v[80:83], v[224:227], v[208:211], v[80:83]
    ds_read_b64_tr_b16 v[248:249], v69 offset:41600
    v_mfma_f32_16x16x32_bf16 v[84:87], v[224:227], v[212:215], v[84:87]
    ds_read_b64_tr_b16 v[250:251], v69 offset:42112
    v_mfma_f32_16x16x32_bf16 v[88:91], v[228:231], v[208:211], v[88:91]
    ds_read_b64_tr_b16 v[224:225], v69 offset:41632
    v_mfma_f32_16x16x32_bf16 v[92:95], v[228:231], v[212:215], v[92:95]
    ds_read_b64_tr_b16 v[226:227], v69 offset:42144
    s_waitcnt lgkmcnt(8)
    v_mfma_f32_16x16x32_bf16 v[96:99], v[232:235], v[208:211], v[96:99]
    ds_read_b64_tr_b16 v[228:229], v69 offset:37440
    v_mfma_f32_16x16x32_bf16 v[100:103], v[232:235], v[212:215], v[100:103]
    ds_read_b64_tr_b16 v[230:231], v69 offset:37952
    v_mfma_f32_16x16x32_bf16 v[104:107], v[236:239], v[208:211], v[104:107]
    ds_read_b64_tr_b16 v[232:233], v69 offset:37472
    v_mfma_f32_16x16x32_bf16 v[108:111], v[236:239], v[212:215], v[108:111]
    ds_read_b64_tr_b16 v[234:235], v69 offset:37984
    s_waitcnt lgkmcnt(8)
    v_mfma_f32_16x16x32_bf16 v[144:147], v[240:243], v[208:211], v[144:147]
    ds_read_b64_tr_b16 v[236:237], v68 offset:37440
    v_mfma_f32_16x16x32_bf16 v[148:151], v[240:243], v[212:215], v[148:151]
    ds_read_b64_tr_b16 v[238:239], v68 offset:37952
    v_mfma_f32_16x16x32_bf16 v[152:155], v[244:247], v[208:211], v[152:155]
    ds_read_b64_tr_b16 v[240:241], v68 offset:37472
    v_mfma_f32_16x16x32_bf16 v[156:159], v[244:247], v[212:215], v[156:159]
    ds_read_b64_tr_b16 v[242:243], v68 offset:37984
    s_waitcnt lgkmcnt(8)
    v_mfma_f32_16x16x32_bf16 v[160:163], v[248:251], v[208:211], v[160:163]
    ds_read_b64_tr_b16 v[244:245], v68 offset:29120
    v_mfma_f32_16x16x32_bf16 v[164:167], v[248:251], v[212:215], v[164:167]
    ds_read_b64_tr_b16 v[246:247], v68 offset:29632
    v_mfma_f32_16x16x32_bf16 v[168:171], v[224:227], v[208:211], v[168:171]
    ds_read_b64_tr_b16 v[248:249], v68 offset:29152
    v_mfma_f32_16x16x32_bf16 v[172:175], v[224:227], v[212:215], v[172:175]
    ds_read_b64_tr_b16 v[250:251], v68 offset:29664
    s_waitcnt lgkmcnt(8)
    s_waitcnt vmcnt(0)
    v_mfma_f32_16x16x32_bf16 v[128:131], v[228:231], v[216:219], v[128:131]
    ds_read_b64_tr_b16 v[224:225], v69 offset:29120
    v_mfma_f32_16x16x32_bf16 v[132:135], v[228:231], v[220:223], v[132:135]
    ds_read_b64_tr_b16 v[226:227], v69 offset:29632
    v_mfma_f32_16x16x32_bf16 v[136:139], v[232:235], v[216:219], v[136:139]
    ds_read_b64_tr_b16 v[228:229], v69 offset:29152
    v_mfma_f32_16x16x32_bf16 v[140:143], v[232:235], v[220:223], v[140:143]
    ds_read_b64_tr_b16 v[230:231], v69 offset:29664
    s_waitcnt lgkmcnt(8)
    v_mfma_f32_16x16x32_bf16 v[112:115], v[236:239], v[216:219], v[112:115]
    ds_read_b64_tr_b16 v[232:233], v68 offset:45760
    v_mfma_f32_16x16x32_bf16 v[116:119], v[236:239], v[220:223], v[116:119]
    ds_read_b64_tr_b16 v[234:235], v68 offset:46272
    v_mfma_f32_16x16x32_bf16 v[120:123], v[240:243], v[216:219], v[120:123]
    ds_read_b64_tr_b16 v[236:237], v68 offset:45792
    v_mfma_f32_16x16x32_bf16 v[124:127], v[240:243], v[220:223], v[124:127]
    ds_read_b64_tr_b16 v[238:239], v68 offset:46304
    s_waitcnt lgkmcnt(8)
    v_mfma_f32_16x16x32_bf16 v[80:83], v[244:247], v[216:219], v[80:83]
    ds_read_b64_tr_b16 v[240:241], v69 offset:45760
    v_mfma_f32_16x16x32_bf16 v[84:87], v[244:247], v[220:223], v[84:87]
    ds_read_b64_tr_b16 v[242:243], v69 offset:46272
    v_mfma_f32_16x16x32_bf16 v[88:91], v[248:251], v[216:219], v[88:91]
    ds_read_b64_tr_b16 v[244:245], v69 offset:45792
    v_mfma_f32_16x16x32_bf16 v[92:95], v[248:251], v[220:223], v[92:95]
    ds_read_b64_tr_b16 v[246:247], v69 offset:46304
    s_waitcnt lgkmcnt(8)
    v_mfma_f32_16x16x32_bf16 v[96:99], v[224:227], v[216:219], v[96:99]
    v_mfma_f32_16x16x32_bf16 v[100:103], v[224:227], v[220:223], v[100:103]
    v_mfma_f32_16x16x32_bf16 v[104:107], v[228:231], v[216:219], v[104:107]
    v_mfma_f32_16x16x32_bf16 v[108:111], v[228:231], v[220:223], v[108:111]
    s_waitcnt lgkmcnt(4)
    v_mfma_f32_16x16x32_bf16 v[144:147], v[232:235], v[216:219], v[144:147]
    v_mfma_f32_16x16x32_bf16 v[148:151], v[232:235], v[220:223], v[148:151]
    v_mfma_f32_16x16x32_bf16 v[152:155], v[236:239], v[216:219], v[152:155]
    v_mfma_f32_16x16x32_bf16 v[156:159], v[236:239], v[220:223], v[156:159]
    s_waitcnt lgkmcnt(0)
    v_mfma_f32_16x16x32_bf16 v[160:163], v[240:243], v[216:219], v[160:163]
    v_mfma_f32_16x16x32_bf16 v[164:167], v[240:243], v[220:223], v[164:167]
    v_mfma_f32_16x16x32_bf16 v[168:171], v[244:247], v[216:219], v[168:171]
    v_mfma_f32_16x16x32_bf16 v[172:175], v[244:247], v[220:223], v[172:175]
    v_cvt_pk_bf16_f32 v52, v128, v129
    v_cvt_pk_bf16_f32 v53, v130, v131
    v_cvt_pk_bf16_f32 v54, v132, v133
    v_cvt_pk_bf16_f32 v55, v134, v135
    v_cvt_pk_bf16_f32 v56, v136, v137
    v_cvt_pk_bf16_f32 v57, v138, v139
    v_cvt_pk_bf16_f32 v58, v140, v141
    v_cvt_pk_bf16_f32 v59, v142, v143
    ds_write_b64 v77, v[52:53]
    ds_write_b64 v77, v[54:55] offset:256
    ds_write_b64 v77, v[56:57] offset:1024
    ds_write_b64 v77, v[58:59] offset:1280
    v_cvt_pk_bf16_f32 v36, v112, v113
    v_cvt_pk_bf16_f32 v37, v114, v115
    v_cvt_pk_bf16_f32 v38, v116, v117
    v_cvt_pk_bf16_f32 v39, v118, v119
    v_cvt_pk_bf16_f32 v40, v120, v121
    v_cvt_pk_bf16_f32 v41, v122, v123
    v_cvt_pk_bf16_f32 v42, v124, v125
    v_cvt_pk_bf16_f32 v43, v126, v127
    v_permlane16_swap_b32 v36, v38
    v_permlane16_swap_b32 v37, v39
    v_permlane16_swap_b32 v40, v42
    v_permlane16_swap_b32 v41, v43
    s_waitcnt lgkmcnt(0)
    s_barrier
    s_setprio 0
    v_mfma_f32_32x32x16_bf16 v[112:127], v[28:31], v[36:39], 0
    v_mfma_f32_32x32x16_bf16 v[112:127], v[32:35], v[40:43], v[112:127]
    v_cvt_pk_bf16_f32 v52, v144, v145
    v_cvt_pk_bf16_f32 v53, v146, v147
    v_cvt_pk_bf16_f32 v54, v148, v149
    v_cvt_pk_bf16_f32 v55, v150, v151
    v_cvt_pk_bf16_f32 v56, v152, v153
    v_cvt_pk_bf16_f32 v57, v154, v155
    v_cvt_pk_bf16_f32 v58, v156, v157
    v_cvt_pk_bf16_f32 v59, v158, v159
    ds_write_b64 v78, v[52:53]
    ds_write_b64 v78, v[54:55] offset:512
    ds_write_b64 v78, v[56:57] offset:4096
    ds_write_b64 v78, v[58:59] offset:4608
    v_cvt_pk_bf16_f32 v44, v160, v161
    v_cvt_pk_bf16_f32 v45, v162, v163
    v_cvt_pk_bf16_f32 v46, v164, v165
    v_cvt_pk_bf16_f32 v47, v166, v167
    v_cvt_pk_bf16_f32 v48, v168, v169
    v_cvt_pk_bf16_f32 v49, v170, v171
    v_cvt_pk_bf16_f32 v50, v172, v173
    v_cvt_pk_bf16_f32 v51, v174, v175
    ds_write_b64 v78, v[44:45] offset:8192
    ds_write_b64 v78, v[46:47] offset:8704
    ds_write_b64 v78, v[48:49] offset:12288
    ds_write_b64 v78, v[50:51] offset:12800
    v_cvt_pk_bf16_f32 v36, v96, v97
    v_cvt_pk_bf16_f32 v37, v98, v99
    v_cvt_pk_bf16_f32 v38, v100, v101
    v_cvt_pk_bf16_f32 v39, v102, v103
    v_cvt_pk_bf16_f32 v40, v104, v105
    v_cvt_pk_bf16_f32 v41, v106, v107
    v_cvt_pk_bf16_f32 v42, v108, v109
    v_cvt_pk_bf16_f32 v43, v110, v111
    ds_write_b64 v77, v[36:37] offset:2048
    ds_write_b64 v77, v[38:39] offset:2304
    ds_write_b64 v77, v[40:41] offset:3072
    ds_write_b64 v77, v[42:43] offset:3328
    v_cvt_pk_bf16_f32 v44, v80, v81
    v_cvt_pk_bf16_f32 v45, v82, v83
    v_cvt_pk_bf16_f32 v46, v84, v85
    v_cvt_pk_bf16_f32 v47, v86, v87
    v_cvt_pk_bf16_f32 v48, v88, v89
    v_cvt_pk_bf16_f32 v49, v90, v91
    v_cvt_pk_bf16_f32 v50, v92, v93
    v_cvt_pk_bf16_f32 v51, v94, v95
    v_permlane16_swap_b32 v44, v46
    v_permlane16_swap_b32 v45, v47
    v_permlane16_swap_b32 v48, v50
    v_permlane16_swap_b32 v49, v51
    s_branch L_JOIN
L_HELP:
    s_add_u32 s96, s85, 5
    s_and_b32 s97, s96, 15
    s_lshl3_add_u32 s98, s97, s3
    s_sub_u32 s99, s98, 4
    s_mul_i32 s96, s99, 49152
    s_lshl_b32 s97, s11, 7
    s_add_u32 s82, s96, s97
    s_sub_u32 s96, s3, 4
    s_lshr_b32 s97, s96, 1
    s_mul_i32 s98, s97, 2080
    s_sub_u32 s99, s3, 4
    s_and_b32 s96, s99, 1
    s_mul_i32 s97, s96, 1056
    s_add_u32 s99, s98, s97
    s_add_u32 s20, s99, 124800
    s_mov_b32 m0, s20
    s_nop 0
    buffer_load_dwordx4 v62, s[40:43], s82 offen lds
    s_add_u32 s82, s82, 2048
    s_add_u32 m0, s20, 8320
    s_nop 0
    buffer_load_dwordx4 v62, s[40:43], s82 offen lds
    s_add_u32 s82, s82, 2048
    s_add_u32 m0, s20, 16640
    s_nop 0
    buffer_load_dwordx4 v62, s[40:43], s82 offen lds
    s_add_u32 s96, s85, 5
    s_and_b32 s97, s96, 15
    s_lshl3_add_u32 s98, s97, s3
    s_mul_i32 s99, s98, 49152
    s_lshl_b32 s96, s11, 7
    s_add_u32 s82, s99, s96
    s_lshr_b32 s96, s3, 1
    s_mul_i32 s97, s96, 2080
    s_and_b32 s98, s3, 1
    s_mul_i32 s99, s98, 1056
    s_add_u32 s96, s97, s99
    s_add_u32 s20, s96, 124800
    s_mov_b32 m0, s20
    s_nop 0
    buffer_load_dwordx4 v62, s[40:43], s82 offen lds
    s_add_u32 s82, s82, 2048
    s_add_u32 m0, s20, 8320
    s_nop 0
    buffer_load_dwordx4 v62, s[40:43], s82 offen lds
    s_add_u32 s82, s82, 2048
    s_add_u32 m0, s20, 16640
    s_nop 0
    buffer_load_dwordx4 v62, s[40:43], s82 offen lds
    s_and_b32 s96, s9, 3
    s_lshl2_add_u32 s97, s96, s3
    s_sub_u32 s98, s97, 4
    s_lshl_b32 s13, s98, 7
    v_lshrrev_b32 v61, 3, v1
    v_lshl_add_u32 v61, v61, 4, s13
    v_lshrrev_b32 v60, 3, v1
    v_mul_u32_u24 v60, 98304, v60
    v_and_b32 v9, 7, v1
    v_lshl_add_u32 v60, v9, 4, v60
    s_mul_i32 s96, s13, 6144
    s_bfe_u32 s97, s9, 131074
    s_lshl_b32 s98, s8, 1
    s_lshl4_add_u32 s99, s97, s98
    s_lshr_b32 s97, s9, 4
    s_add_u32 s98, s99, s97
    s_lshl_b32 s99, s98, 7
    s_add_u32 s97, s96, s99
    s_add_u32 s17, s97, 4096
    global_load_dwordx4 v[120:123], v61, s[86:87]
    s_waitcnt vmcnt(13)
    s_barrier
    buffer_load_dwordx4 v[80:83], v60, s[48:51], s17 offen nt
    s_add_u32 s17, s17, 12288
    buffer_load_dwordx4 v[84:87], v60, s[48:51], s17 offen nt
    s_add_u32 s17, s17, 12288
    s_waitcnt lgkmcnt(0)
    s_load_dword s24, s[32:33], s92 offset:512 glc
    s_load_dword s25, s[32:33], s92 offset:256 glc
    s_load_dword s26, s[32:33], s92 offset:1024 glc
    s_load_dword s27, s[32:33], s92 offset:768 glc
    s_waitcnt vmcnt(12)
    s_barrier
    s_add_u32 s96, s85, 6
    s_and_b32 s97, s96, 15
    s_lshl3_add_u32 s98, s97, s3
    s_sub_u32 s99, s98, 4
    s_mul_i32 s96, s99, 49152
    s_lshl_b32 s97, s11, 7
    s_add_u32 s82, s96, s97
    s_sub_u32 s96, s3, 4
    s_lshr_b32 s97, s96, 1
    s_mul_i32 s98, s97, 2080
    s_sub_u32 s99, s3, 4
    s_and_b32 s96, s99, 1
    s_mul_i32 s97, s96, 1056
    s_add_u32 s20, s98, s97
    s_mov_b32 m0, s20
    s_nop 0
    buffer_load_dwordx4 v62, s[40:43], s82 offen lds
    s_add_u32 s82, s82, 2048
    s_add_u32 m0, s20, 8320
    s_nop 0
    buffer_load_dwordx4 v62, s[40:43], s82 offen lds
    s_add_u32 s82, s82, 2048
    s_add_u32 m0, s20, 16640
    s_nop 0
    buffer_load_dwordx4 v62, s[40:43], s82 offen lds
    s_add_u32 s96, s85, 6
    s_and_b32 s97, s96, 15
    s_lshl3_add_u32 s98, s97, s3
    s_mul_i32 s99, s98, 49152
    s_lshl_b32 s96, s11, 7
    s_add_u32 s82, s99, s96
    s_lshr_b32 s96, s3, 1
    s_mul_i32 s97, s96, 2080
    s_and_b32 s98, s3, 1
    s_mul_i32 s99, s98, 1056
    s_add_u32 s20, s97, s99
    s_mov_b32 m0, s20
    s_nop 0
    buffer_load_dwordx4 v62, s[40:43], s82 offen lds
    s_add_u32 s82, s82, 2048
    s_add_u32 m0, s20, 8320
    s_nop 0
    buffer_load_dwordx4 v62, s[40:43], s82 offen lds
    s_add_u32 s82, s82, 2048
    s_add_u32 m0, s20, 16640
    s_nop 0
    buffer_load_dwordx4 v62, s[40:43], s82 offen lds
    s_waitcnt vmcnt(8)
    v_lshlrev_b32 v112, 16, v120
    v_mul_f32 v4, s7, v112
    v_exp_f32 v4, -v4
    s_nop 0
    v_add_f32 v4, 1.0, v4
    v_rcp_f32 v4, v4
    s_nop 0
    v_mul_f32 v112, v112, v4
    v_cvt_pk_bf16_f32 v112, 0, v112
    v_and_b32 v113, s6, v120
    v_mul_f32 v5, s7, v113
    v_exp_f32 v5, -v5
    s_nop 0
    v_add_f32 v5, 1.0, v5
    v_rcp_f32 v5, v5
    s_nop 0
    v_mul_f32 v113, v113, v5
    v_cvt_pk_bf16_f32 v113, 0, v113
    v_lshlrev_b32 v114, 16, v121
    v_mul_f32 v4, s7, v114
    v_exp_f32 v4, -v4
    s_nop 0
    v_add_f32 v4, 1.0, v4
    v_rcp_f32 v4, v4
    s_nop 0
    v_mul_f32 v114, v114, v4
    v_cvt_pk_bf16_f32 v114, 0, v114
    v_and_b32 v115, s6, v121
    v_mul_f32 v5, s7, v115
    v_exp_f32 v5, -v5
    s_nop 0
    v_add_f32 v5, 1.0, v5
    v_rcp_f32 v5, v5
    s_nop 0
    v_mul_f32 v115, v115, v5
    v_cvt_pk_bf16_f32 v115, 0, v115
    s_barrier
    s_add_u32 s96, s85, 7
    s_and_b32 s97, s96, 15
    s_lshl3_add_u32 s98, s97, s3
    s_sub_u32 s99, s98, 4
    s_mul_i32 s96, s99, 49152
    s_lshl_b32 s97, s11, 7
    s_add_u32 s82, s96, s97
    s_sub_u32 s96, s3, 4
    s_lshr_b32 s97, s96, 1
    s_mul_i32 s98, s97, 2080
    s_sub_u32 s99, s3, 4
    s_and_b32 s96, s99, 1
    s_mul_i32 s97, s96, 1056
    s_add_u32 s99, s98, s97
    s_add_u32 s20, s99, 24960
    s_mov_b32 m0, s20
    s_nop 0
    buffer_load_dwordx4 v62, s[40:43], s82 offen lds
    s_add_u32 s82, s82, 2048
    s_add_u32 m0, s20, 8320
    s_nop 0
    buffer_load_dwordx4 v62, s[40:43], s82 offen lds
    s_add_u32 s82, s82, 2048
    s_add_u32 m0, s20, 16640
    s_nop 0
    buffer_load_dwordx4 v62, s[40:43], s82 offen lds
    buffer_load_dwordx4 v[88:91], v60, s[48:51], s17 offen nt
    s_add_u32 s17, s17, 12288
    buffer_load_dwordx4 v[92:95], v60, s[48:51], s17 offen nt
    s_add_u32 s17, s17, 12288
    s_barrier
    s_add_u32 s96, s85, 7
    s_and_b32 s97, s96, 15
    s_lshl3_add_u32 s98, s97, s3
    s_mul_i32 s99, s98, 49152
    s_lshl_b32 s96, s11, 7
    s_add_u32 s82, s99, s96
    s_lshr_b32 s96, s3, 1
    s_mul_i32 s97, s96, 2080
    s_and_b32 s98, s3, 1
    s_mul_i32 s99, s98, 1056
    s_add_u32 s96, s97, s99
    s_add_u32 s20, s96, 24960
    s_mov_b32 m0, s20
    s_nop 0
    buffer_load_dwordx4 v62, s[40:43], s82 offen lds
    s_add_u32 s82, s82, 2048
    s_add_u32 m0, s20, 8320
    s_nop 0
    buffer_load_dwordx4 v62, s[40:43], s82 offen lds
    s_add_u32 s82, s82, 2048
    s_add_u32 m0, s20, 16640
    s_nop 0
    buffer_load_dwordx4 v62, s[40:43], s82 offen lds
    s_add_u32 s96, s85, 8
    s_and_b32 s97, s96, 15
    s_lshl3_add_u32 s98, s97, s3
    s_sub_u32 s99, s98, 4
    s_mul_i32 s96, s99, 49152
    s_lshl_b32 s97, s11, 7
    s_add_u32 s82, s96, s97
    s_sub_u32 s96, s3, 4
    s_lshr_b32 s97, s96, 1
    s_mul_i32 s98, s97, 2080
    s_sub_u32 s99, s3, 4
    s_and_b32 s96, s99, 1
    s_mul_i32 s97, s96, 1056
    s_add_u32 s99, s98, s97
    s_add_u32 s20, s99, 49920
    s_mov_b32 m0, s20
    s_nop 0
    buffer_load_dwordx4 v62, s[40:43], s82 offen lds
    s_add_u32 s82, s82, 2048
    s_add_u32 m0, s20, 8320
    s_nop 0
    buffer_load_dwordx4 v62, s[40:43], s82 offen lds
    s_add_u32 s82, s82, 2048
    s_add_u32 m0, s20, 16640
    s_nop 0
    buffer_load_dwordx4 v62, s[40:43], s82 offen lds
    v_lshlrev_b32 v116, 16, v122
    v_mul_f32 v4, s7, v116
    v_exp_f32 v4, -v4
    s_nop 0
    v_add_f32 v4, 1.0, v4
    v_rcp_f32 v4, v4
    s_nop 0
    v_mul_f32 v116, v116, v4
    v_cvt_pk_bf16_f32 v116, 0, v116
    v_and_b32 v117, s6, v122
    v_mul_f32 v5, s7, v117
    v_exp_f32 v5, -v5
    s_nop 0
    v_add_f32 v5, 1.0, v5
    v_rcp_f32 v5, v5
    s_nop 0
    v_mul_f32 v117, v117, v5
    v_cvt_pk_bf16_f32 v117, 0, v117
    v_lshlrev_b32 v118, 16, v123
    v_mul_f32 v4, s7, v118
    v_exp_f32 v4, -v4
    s_nop 0
    v_add_f32 v4, 1.0, v4
    v_rcp_f32 v4, v4
    s_nop 0
    v_mul_f32 v118, v118, v4
    v_cvt_pk_bf16_f32 v118, 0, v118
    v_and_b32 v119, s6, v123
    v_mul_f32 v5, s7, v119
    v_exp_f32 v5, -v5
    s_nop 0
    v_add_f32 v5, 1.0, v5
    v_rcp_f32 v5, v5
    s_nop 0
    v_mul_f32 v119, v119, v5
    v_cvt_pk_bf16_f32 v119, 0, v119
    s_waitcnt lgkmcnt(0)
    s_load_dword s24, s[32:33], s92 offset:1536 glc
    s_load_dword s25, s[32:33], s92 offset:1280 glc
    s_load_dword s26, s[32:33], s92 offset:2048 glc
    s_load_dword s27, s[32:33], s92 offset:1792 glc
    s_barrier
    s_add_u32 s96, s85, 8
    s_and_b32 s97, s96, 15
    s_lshl3_add_u32 s98, s97, s3
    s_mul_i32 s99, s98, 49152
    s_lshl_b32 s96, s11, 7
    s_add_u32 s82, s99, s96
    s_lshr_b32 s96, s3, 1
    s_mul_i32 s97, s96, 2080
    s_and_b32 s98, s3, 1
    s_mul_i32 s99, s98, 1056
    s_add_u32 s96, s97, s99
    s_add_u32 s20, s96, 49920
    s_mov_b32 m0, s20
    s_nop 0
    buffer_load_dwordx4 v62, s[40:43], s82 offen lds
    s_add_u32 s82, s82, 2048
    s_add_u32 m0, s20, 8320
    s_nop 0
    buffer_load_dwordx4 v62, s[40:43], s82 offen lds
    s_add_u32 s82, s82, 2048
    s_add_u32 m0, s20, 16640
    s_nop 0
    buffer_load_dwordx4 v62, s[40:43], s82 offen lds
    buffer_load_dwordx4 v[96:99], v60, s[48:51], s17 offen nt
    s_add_u32 s17, s17, 12288
    buffer_load_dwordx4 v[100:103], v60, s[48:51], s17 offen nt
    s_add_u32 s17, s17, 12288
    s_waitcnt vmcnt(16)
    s_barrier
    s_add_u32 s96, s85, 9
    s_and_b32 s97, s96, 15
    s_lshl3_add_u32 s98, s97, s3
    s_sub_u32 s99, s98, 4
    s_mul_i32 s96, s99, 49152
    s_lshl_b32 s97, s11, 7
    s_add_u32 s82, s96, s97
    s_sub_u32 s96, s3, 4
    s_lshr_b32 s97, s96, 1
    s_mul_i32 s98, s97, 2080
    s_sub_u32 s99, s3, 4
    s_and_b32 s96, s99, 1
    s_mul_i32 s97, s96, 1056
    s_add_u32 s99, s98, s97
    s_add_u32 s20, s99, 74880
    s_mov_b32 m0, s20
    s_nop 0
    buffer_load_dwordx4 v62, s[40:43], s82 offen lds
    s_add_u32 s82, s82, 2048
    s_add_u32 m0, s20, 8320
    s_nop 0
    buffer_load_dwordx4 v62, s[40:43], s82 offen lds
    s_add_u32 s82, s82, 2048
    s_add_u32 m0, s20, 16640
    s_nop 0
    buffer_load_dwordx4 v62, s[40:43], s82 offen lds
    s_add_u32 s96, s85, 9
    s_and_b32 s97, s96, 15
    s_lshl3_add_u32 s98, s97, s3
    s_mul_i32 s99, s98, 49152
    s_lshl_b32 s96, s11, 7
    s_add_u32 s82, s99, s96
    s_lshr_b32 s96, s3, 1
    s_mul_i32 s97, s96, 2080
    s_and_b32 s98, s3, 1
    s_mul_i32 s99, s98, 1056
    s_add_u32 s96, s97, s99
    s_add_u32 s20, s96, 74880
    s_mov_b32 m0, s20
    s_nop 0
    buffer_load_dwordx4 v62, s[40:43], s82 offen lds
    s_add_u32 s82, s82, 2048
    s_add_u32 m0, s20, 8320
    s_nop 0
    buffer_load_dwordx4 v62, s[40:43], s82 offen lds
    s_add_u32 s82, s82, 2048
    s_add_u32 m0, s20, 16640
    s_nop 0
    buffer_load_dwordx4 v62, s[40:43], s82 offen lds
    v_lshlrev_b32 v4, 16, v80
    v_and_b32 v5, s6, v80
    v_mul_f32 v20, v4, v112
    v_mul_f32 v21, v5, v112
    v_lshlrev_b32 v6, 16, v81
    v_and_b32 v7, s6, v81
    v_mul_f32 v22, v6, v112
    v_mul_f32 v23, v7, v112
    v_lshlrev_b32 v4, 16, v82
    v_and_b32 v5, s6, v82
    v_mul_f32 v24, v4, v112
    v_mul_f32 v25, v5, v112
    v_lshlrev_b32 v6, 16, v83
    v_and_b32 v7, s6, v83
    v_mul_f32 v26, v6, v112
    v_mul_f32 v27, v7, v112
    s_waitcnt vmcnt(14)
    s_barrier
    s_add_u32 s96, s85, 10
    s_and_b32 s97, s96, 15
    s_lshl3_add_u32 s98, s97, s3
    s_sub_u32 s99, s98, 4
    s_mul_i32 s96, s99, 49152
    s_lshl_b32 s97, s11, 7
    s_add_u32 s82, s96, s97
    s_sub_u32 s96, s3, 4
    s_lshr_b32 s97, s96, 1
    s_mul_i32 s98, s97, 2080
    s_sub_u32 s99, s3, 4
    s_and_b32 s96, s99, 1
    s_mul_i32 s97, s96, 1056
    s_add_u32 s99, s98, s97
    s_add_u32 s20, s99, 99840
    s_mov_b32 m0, s20
    s_nop 0
    buffer_load_dwordx4 v62, s[40:43], s82 offen lds
    s_add_u32 s82, s82, 2048
    s_add_u32 m0, s20, 8320
    s_nop 0
    buffer_load_dwordx4 v62, s[40:43], s82 offen lds
    s_add_u32 s82, s82, 2048
    s_add_u32 m0, s20, 16640
    s_nop 0
    buffer_load_dwordx4 v62, s[40:43], s82 offen lds
    buffer_load_dwordx4 v[104:107], v60, s[48:51], s17 offen nt
    s_add_u32 s17, s17, 12288
    buffer_load_dwordx4 v[108:111], v60, s[48:51], s17 offen nt
    s_lshl2_add_u32 s96, s74, s75
    s_lshl_b32 s97, s96, 11
    s_and_b32 s98, s3, 1
    s_lshl_b32 s99, s98, 10
    s_add_u32 s96, s97, s99
    s_add_u32 s13, s96, 20971520
    s_lshl4_add_u32 s96, s21, s12
    s_lshl_b32 s97, s96, 11
    s_and_b32 s98, s3, 1
    s_lshl_b32 s99, s98, 10
    s_add_u32 s96, s97, s99
    s_add_u32 s14, s96, 12582912
    buffer_load_dwordx4 v[124:127], v2, s[32:35], s13 offen
    s_waitcnt lgkmcnt(0)
    s_load_dword s24, s[32:33], s92 offset:2560 glc
    s_load_dword s25, s[32:33], s92 offset:2304 glc
    s_load_dword s26, s[32:33], s92 offset:3072 glc
    s_load_dword s27, s[32:33], s92 offset:2816 glc
    s_load_dword s28, s[32:33], s92 offset:3584 glc
    s_load_dword s29, s[32:33], s92 offset:3328 glc
    s_waitcnt vmcnt(14)
    s_barrier
    s_add_u32 s96, s85, 10
    s_and_b32 s97, s96, 15
    s_lshl3_add_u32 s98, s97, s3
    s_mul_i32 s99, s98, 49152
    s_lshl_b32 s96, s11, 7
    s_add_u32 s82, s99, s96
    s_lshr_b32 s96, s3, 1
    s_mul_i32 s97, s96, 2080
    s_and_b32 s98, s3, 1
    s_mul_i32 s99, s98, 1056
    s_add_u32 s96, s97, s99
    s_add_u32 s20, s96, 99840
    s_mov_b32 m0, s20
    s_nop 0
    buffer_load_dwordx4 v62, s[40:43], s82 offen lds
    s_add_u32 s82, s82, 2048
    s_add_u32 m0, s20, 8320
    s_nop 0
    buffer_load_dwordx4 v62, s[40:43], s82 offen lds
    s_add_u32 s82, s82, 2048
    s_add_u32 m0, s20, 16640
    s_nop 0
    buffer_load_dwordx4 v62, s[40:43], s82 offen lds
    s_add_u32 s96, s85, 11
    s_and_b32 s97, s96, 15
    s_lshl3_add_u32 s98, s97, s3
    s_sub_u32 s99, s98, 4
    s_mul_i32 s96, s99, 49152
    s_lshl_b32 s97, s11, 7
    s_add_u32 s82, s96, s97
    s_sub_u32 s96, s3, 4
    s_lshr_b32 s97, s96, 1
    s_mul_i32 s98, s97, 2080
    s_sub_u32 s99, s3, 4
    s_and_b32 s96, s99, 1
    s_mul_i32 s97, s96, 1056
    s_add_u32 s99, s98, s97
    s_add_u32 s20, s99, 124800
    s_mov_b32 m0, s20
    s_nop 0
    buffer_load_dwordx4 v62, s[40:43], s82 offen lds
    s_add_u32 s82, s82, 2048
    s_add_u32 m0, s20, 8320
    s_nop 0
    buffer_load_dwordx4 v62, s[40:43], s82 offen lds
    s_add_u32 s82, s82, 2048
    s_add_u32 m0, s20, 16640
    s_nop 0
    buffer_load_dwordx4 v62, s[40:43], s82 offen lds
    v_lshlrev_b32 v4, 16, v84
    v_and_b32 v5, s6, v84
    v_fmac_f32 v20, v4, v113
    v_fmac_f32 v21, v5, v113
    v_lshlrev_b32 v6, 16, v85
    v_and_b32 v7, s6, v85
    v_fmac_f32 v22, v6, v113
    v_fmac_f32 v23, v7, v113
    v_lshlrev_b32 v4, 16, v86
    v_and_b32 v5, s6, v86
    v_fmac_f32 v24, v4, v113
    v_fmac_f32 v25, v5, v113
    v_lshlrev_b32 v6, 16, v87
    v_and_b32 v7, s6, v87
    v_fmac_f32 v26, v6, v113
    v_fmac_f32 v27, v7, v113
    s_waitcnt vmcnt(12)
    s_barrier
    s_add_u32 s96, s85, 11
    s_and_b32 s97, s96, 15
    s_lshl3_add_u32 s98, s97, s3
    s_mul_i32 s99, s98, 49152
    s_lshl_b32 s96, s11, 7
    s_add_u32 s82, s99, s96
    s_lshr_b32 s96, s3, 1
    s_mul_i32 s97, s96, 2080
    s_and_b32 s98, s3, 1
    s_mul_i32 s99, s98, 1056
    s_add_u32 s96, s97, s99
    s_add_u32 s20, s96, 124800
    s_mov_b32 m0, s20
    s_nop 0
    buffer_load_dwordx4 v62, s[40:43], s82 offen lds
    s_add_u32 s82, s82, 2048
    s_add_u32 m0, s20, 8320
    s_nop 0
    buffer_load_dwordx4 v62, s[40:43], s82 offen lds
    s_add_u32 s82, s82, 2048
    s_add_u32 m0, s20, 16640
    s_nop 0
    buffer_load_dwordx4 v62, s[40:43], s82 offen lds
    s_add_u32 s96, s85, 12
    s_and_b32 s97, s96, 15
    s_lshl3_add_u32 s98, s97, s3
    s_sub_u32 s99, s98, 4
    s_mul_i32 s96, s99, 49152
    s_lshl_b32 s97, s11, 7
    s_add_u32 s82, s96, s97
    s_sub_u32 s96, s3, 4
    s_lshr_b32 s97, s96, 1
    s_mul_i32 s98, s97, 2080
    s_sub_u32 s99, s3, 4
    s_and_b32 s96, s99, 1
    s_mul_i32 s97, s96, 1056
    s_add_u32 s20, s98, s97
    s_mov_b32 m0, s20
    s_nop 0
    buffer_load_dwordx4 v62, s[40:43], s82 offen lds
    s_add_u32 s82, s82, 2048
    s_add_u32 m0, s20, 8320
    s_nop 0
    buffer_load_dwordx4 v62, s[40:43], s82 offen lds
    s_add_u32 s82, s82, 2048
    s_add_u32 m0, s20, 16640
    s_nop 0
    buffer_load_dwordx4 v62, s[40:43], s82 offen lds
    v_lshlrev_b32 v4, 16, v88
    v_and_b32 v5, s6, v88
    v_fmac_f32 v20, v4, v114
    v_fmac_f32 v21, v5, v114
    v_lshlrev_b32 v6, 16, v89
    v_and_b32 v7, s6, v89
    v_fmac_f32 v22, v6, v114
    v_fmac_f32 v23, v7, v114
    v_lshlrev_b32 v4, 16, v90
    v_and_b32 v5, s6, v90
    v_fmac_f32 v24, v4, v114
    v_fmac_f32 v25, v5, v114
    v_lshlrev_b32 v6, 16, v91
    v_and_b32 v7, s6, v91
    v_fmac_f32 v26, v6, v114
    v_fmac_f32 v27, v7, v114
    s_waitcnt vmcnt(9)
    s_barrier
    s_add_u32 s96, s85, 12
    s_and_b32 s97, s96, 15
    s_lshl3_add_u32 s98, s97, s3
    s_mul_i32 s99, s98, 49152
    s_lshl_b32 s96, s11, 7
    s_add_u32 s82, s99, s96
    s_lshr_b32 s96, s3, 1
    s_mul_i32 s97, s96, 2080
    s_and_b32 s98, s3, 1
    s_mul_i32 s99, s98, 1056
    s_add_u32 s20, s97, s99
    s_mov_b32 m0, s20
    s_nop 0
    buffer_load_dwordx4 v62, s[40:43], s82 offen lds
    s_add_u32 s82, s82, 2048
    s_add_u32 m0, s20, 8320
    s_nop 0
    buffer_load_dwordx4 v62, s[40:43], s82 offen lds
    s_add_u32 s82, s82, 2048
    s_add_u32 m0, s20, 16640
    s_nop 0
    buffer_load_dwordx4 v62, s[40:43], s82 offen lds
    s_add_u32 s96, s85, 13
    s_and_b32 s97, s96, 15
    s_lshl3_add_u32 s98, s97, s3
    s_sub_u32 s99, s98, 4
    s_mul_i32 s96, s99, 49152
    s_lshl_b32 s97, s11, 7
    s_add_u32 s82, s96, s97
    s_sub_u32 s96, s3, 4
    s_lshr_b32 s97, s96, 1
    s_mul_i32 s98, s97, 2080
    s_sub_u32 s99, s3, 4
    s_and_b32 s96, s99, 1
    s_mul_i32 s97, s96, 1056
    s_add_u32 s99, s98, s97
    s_add_u32 s20, s99, 24960
    s_mov_b32 m0, s20
    s_nop 0
    buffer_load_dwordx4 v62, s[40:43], s82 offen lds
    s_add_u32 s82, s82, 2048
    s_add_u32 m0, s20, 8320
    s_nop 0
    buffer_load_dwordx4 v62, s[40:43], s82 offen lds
    s_add_u32 s82, s82, 2048
    s_add_u32 m0, s20, 16640
    s_nop 0
    buffer_load_dwordx4 v62, s[40:43], s82 offen lds
    v_lshlrev_b32 v4, 16, v92
    v_and_b32 v5, s6, v92
    v_fmac_f32 v20, v4, v115
    v_fmac_f32 v21, v5, v115
    v_lshlrev_b32 v6, 16, v93
    v_and_b32 v7, s6, v93
    v_fmac_f32 v22, v6, v115
    v_fmac_f32 v23, v7, v115
    v_lshlrev_b32 v4, 16, v94
    v_and_b32 v5, s6, v94
    v_fmac_f32 v24, v4, v115
    v_fmac_f32 v25, v5, v115
    v_lshlrev_b32 v6, 16, v95
    v_and_b32 v7, s6, v95
    v_fmac_f32 v26, v6, v115
    v_fmac_f32 v27, v7, v115
    s_waitcnt vmcnt(9)
    s_barrier
    s_add_u32 s96, s85, 13
    s_and_b32 s97, s96, 15
    s_lshl3_add_u32 s98, s97, s3
    s_mul_i32 s99, s98, 49152
    s_lshl_b32 s96, s11, 7
    s_add_u32 s82, s99, s96
    s_lshr_b32 s96, s3, 1
    s_mul_i32 s97, s96, 2080
    s_and_b32 s98, s3, 1
    s_mul_i32 s99, s98, 1056
    s_add_u32 s96, s97, s99
    s_add_u32 s20, s96, 24960
    s_mov_b32 m0, s20
    s_nop 0
    buffer_load_dwordx4 v62, s[40:43], s82 offen lds
    s_add_u32 s82, s82, 2048
    s_add_u32 m0, s20, 8320
    s_nop 0
    buffer_load_dwordx4 v62, s[40:43], s82 offen lds
    s_add_u32 s82, s82, 2048
    s_add_u32 m0, s20, 16640
    s_nop 0
    buffer_load_dwordx4 v62, s[40:43], s82 offen lds
    s_add_u32 s96, s85, 14
    s_and_b32 s97, s96, 15
    s_lshl3_add_u32 s98, s97, s3
    s_sub_u32 s99, s98, 4
    s_mul_i32 s96, s99, 49152
    s_lshl_b32 s97, s11, 7
    s_add_u32 s82, s96, s97
    s_sub_u32 s96, s3, 4
    s_lshr_b32 s97, s96, 1
    s_mul_i32 s98, s97, 2080
    s_sub_u32 s99, s3, 4
    s_and_b32 s96, s99, 1
    s_mul_i32 s97, s96, 1056
    s_add_u32 s99, s98, s97
    s_add_u32 s20, s99, 49920
    s_mov_b32 m0, s20
    s_nop 0
    buffer_load_dwordx4 v62, s[40:43], s82 offen lds
    s_add_u32 s82, s82, 2048
    s_add_u32 m0, s20, 8320
    s_nop 0
    buffer_load_dwordx4 v62, s[40:43], s82 offen lds
    s_add_u32 s82, s82, 2048
    s_add_u32 m0, s20, 16640
    s_nop 0
    buffer_load_dwordx4 v62, s[40:43], s82 offen lds
    v_lshlrev_b32 v4, 16, v96
    v_and_b32 v5, s6, v96
    v_fmac_f32 v20, v4, v116
    v_fmac_f32 v21, v5, v116
    v_lshlrev_b32 v6, 16, v97
    v_and_b32 v7, s6, v97
    v_fmac_f32 v22, v6, v116
    v_fmac_f32 v23, v7, v116
    v_lshlrev_b32 v4, 16, v98
    v_and_b32 v5, s6, v98
    v_fmac_f32 v24, v4, v116
    v_fmac_f32 v25, v5, v116
    v_lshlrev_b32 v6, 16, v99
    v_and_b32 v7, s6, v99
    v_fmac_f32 v26, v6, v116
    v_fmac_f32 v27, v7, v116
    v_lshlrev_b32 v4, 16, v100
    v_and_b32 v5, s6, v100
    v_fmac_f32 v20, v4, v117
    v_fmac_f32 v21, v5, v117
    v_lshlrev_b32 v6, 16, v101
    v_and_b32 v7, s6, v101
    v_fmac_f32 v22, v6, v117
    v_fmac_f32 v23, v7, v117
    v_lshlrev_b32 v4, 16, v102
    v_and_b32 v5, s6, v102
    v_fmac_f32 v24, v4, v117
    v_fmac_f32 v25, v5, v117
    v_lshlrev_b32 v6, 16, v103
    v_and_b32 v7, s6, v103
    v_fmac_f32 v26, v6, v117
    v_fmac_f32 v27, v7, v117
    s_waitcnt vmcnt(9)
    s_barrier
    s_add_u32 s96, s85, 14
    s_and_b32 s97, s96, 15
    s_lshl3_add_u32 s98, s97, s3
    s_mul_i32 s99, s98, 49152
    s_lshl_b32 s96, s11, 7
    s_add_u32 s82, s99, s96
    s_lshr_b32 s96, s3, 1
    s_mul_i32 s97, s96, 2080
    s_and_b32 s98, s3, 1
    s_mul_i32 s99, s98, 1056
    s_add_u32 s96, s97, s99
    s_add_u32 s20, s96, 49920
    s_mov_b32 m0, s20
    s_nop 0
    buffer_load_dwordx4 v62, s[40:43], s82 offen lds
    s_add_u32 s82, s82, 2048
    s_add_u32 m0, s20, 8320
    s_nop 0
    buffer_load_dwordx4 v62, s[40:43], s82 offen lds
    s_add_u32 s82, s82, 2048
    s_add_u32 m0, s20, 16640
    s_nop 0
    buffer_load_dwordx4 v62, s[40:43], s82 offen lds
    s_add_u32 s96, s85, 15
    s_and_b32 s97, s96, 15
    s_lshl3_add_u32 s98, s97, s3
    s_sub_u32 s99, s98, 4
    s_mul_i32 s96, s99, 49152
    s_lshl_b32 s97, s11, 7
    s_add_u32 s82, s96, s97
    s_sub_u32 s96, s3, 4
    s_lshr_b32 s97, s96, 1
    s_mul_i32 s98, s97, 2080
    s_sub_u32 s99, s3, 4
    s_and_b32 s96, s99, 1
    s_mul_i32 s97, s96, 1056
    s_add_u32 s99, s98, s97
    s_add_u32 s20, s99, 74880
    s_mov_b32 m0, s20
    s_nop 0
    buffer_load_dwordx4 v62, s[40:43], s82 offen lds
    s_add_u32 s82, s82, 2048
    s_add_u32 m0, s20, 8320
    s_nop 0
    buffer_load_dwordx4 v62, s[40:43], s82 offen lds
    s_add_u32 s82, s82, 2048
    s_add_u32 m0, s20, 16640
    s_nop 0
    buffer_load_dwordx4 v62, s[40:43], s82 offen lds
    v_lshlrev_b32 v4, 16, v104
    v_and_b32 v5, s6, v104
    v_fmac_f32 v20, v4, v118
    v_fmac_f32 v21, v5, v118
    v_lshlrev_b32 v6, 16, v105
    v_and_b32 v7, s6, v105
    v_fmac_f32 v22, v6, v118
    v_fmac_f32 v23, v7, v118
    v_lshlrev_b32 v4, 16, v106
    v_and_b32 v5, s6, v106
    v_fmac_f32 v24, v4, v118
    v_fmac_f32 v25, v5, v118
    v_lshlrev_b32 v6, 16, v107
    v_and_b32 v7, s6, v107
    v_fmac_f32 v26, v6, v118
    v_fmac_f32 v27, v7, v118
    v_lshlrev_b32 v4, 16, v108
    v_and_b32 v5, s6, v108
    v_fmac_f32 v20, v4, v119
    v_fmac_f32 v21, v5, v119
    v_lshlrev_b32 v6, 16, v109
    v_and_b32 v7, s6, v109
    v_fmac_f32 v22, v6, v119
    v_fmac_f32 v23, v7, v119
    v_lshlrev_b32 v4, 16, v110
    v_and_b32 v5, s6, v110
    v_fmac_f32 v24, v4, v119
    v_fmac_f32 v25, v5, v119
    v_lshlrev_b32 v6, 16, v111
    v_and_b32 v7, s6, v111
    v_fmac_f32 v26, v6, v119
    v_fmac_f32 v27, v7, v119
    s_waitcnt vmcnt(9)
    s_barrier
    s_add_u32 s96, s85, 15
    s_and_b32 s97, s96, 15
    s_lshl3_add_u32 s98, s97, s3
    s_mul_i32 s99, s98, 49152
    s_lshl_b32 s96, s11, 7
    s_add_u32 s82, s99, s96
    s_lshr_b32 s96, s3, 1
    s_mul_i32 s97, s96, 2080
    s_and_b32 s98, s3, 1
    s_mul_i32 s99, s98, 1056
    s_add_u32 s96, s97, s99
    s_add_u32 s20, s96, 74880
    s_mov_b32 m0, s20
    s_nop 0
    buffer_load_dwordx4 v62, s[40:43], s82 offen lds
    s_add_u32 s82, s82, 2048
    s_add_u32 m0, s20, 8320
    s_nop 0
    buffer_load_dwordx4 v62, s[40:43], s82 offen lds
    s_add_u32 s82, s82, 2048
    s_add_u32 m0, s20, 16640
    s_nop 0
    buffer_load_dwordx4 v62, s[40:43], s82 offen lds
    s_lshl_b32 s13, s12, 7
    v_and_b32 v4, 31, v1
    v_lshl_add_u32 v4, v4, 2, s13
    global_load_dword v104, v4, s[78:79]
    v_permlane32_swap_b32 v20, v24
    v_permlane32_swap_b32 v21, v25
    v_permlane32_swap_b32 v22, v26
    v_permlane32_swap_b32 v23, v27
    v_add_f32 v20, v20, v24
    v_add_f32 v21, v21, v25
    v_add_f32 v22, v22, v26
    v_add_f32 v23, v23, v27
    s_nop 0
    v_permlane16_swap_b32 v20, v22
    v_permlane16_swap_b32 v21, v23
    v_add_f32 v20, v20, v22
    v_add_f32 v21, v21, v23
    s_nop 0
    v_add_f32_dpp v20, v20, v20 row_ror:8 row_mask:0xf bank_mask:0xf
    v_add_f32_dpp v21, v21, v21 row_ror:8 row_mask:0xf bank_mask:0xf
    s_nop 1
    v_mov_b32_dpp v20, v21 quad_perm:[0,1,2,3] row_mask:0xf bank_mask:0xc
    ds_write_b32 v65, v20 offset:1024
    s_waitcnt lgkmcnt(0)
    s_barrier
    s_waitcnt vmcnt(7)
    s_waitcnt vmcnt(1)
    s_barrier
    s_cmp_lg_u32 s3, 4
    s_cbranch_scc1 L_M2F
    ds_read_b128 v[20:23], v64 offset:1024
    s_bfe_u32 s96, s9, 131074
    s_lshl_b32 s97, s8, 1
    s_lshl4_add_u32 s98, s96, s97
    s_lshr_b32 s99, s9, 4
    s_add_u32 s96, s98, s99
    s_and_b32 s97, s9, 3
    s_lshl2_add_u32 s98, s96, s97
    s_lshl_b32 s99, s98, 9
    s_add_u32 s13, s99, 131072
    s_waitcnt lgkmcnt(0)
    v_add_f32 v20, v20, v21
    v_add_f32 v22, v22, v23
    v_mov_b32 v21, s4
    v_add_f32 v20, v20, v22
    buffer_store_dwordx2 v[20:21], v63, s[32:35], s13 offen sc1
L_M2F:
    s_lshl4_add_u32 s96, s11, s10
    s_lshl_b32 s97, s96, 10
    s_and_b32 s98, s3, 3
    s_lshl_b32 s99, s98, 8
    s_add_u32 s96, s97, s99
    s_add_u32 s13, s96, 29360128
    s_lshl_b32 s96, s11, 7
    s_add_u32 s14, s96, 32768
    v_lshlrev_b32 v60, 7, v1
    s_mov_b64 exec, 3
    buffer_load_dword v60, v60, s[32:35], s13 offen
    buffer_load_dword v61, v3, s[32:35], s14 offen
    s_mov_b64 exec, -1
    s_add_u32 s96, s84, 1114112
    s_and_b32 s97, s96, 1048575
    s_lshl_b32 s98, s83, 16
    s_xor_b32 s99, s97, s98
    s_xor_b32 s96, s88, 1048576
    s_add_u32 s13, s99, s96
    s_add_u32 m0, s89, 102400
    s_nop 0
    buffer_load_dwordx4 v74, s[44:47], s13 offen lds
    s_add_u32 s96, s84, 1179648
    s_and_b32 s97, s96, 1048575
    s_lshl_b32 s98, s83, 16
    s_xor_b32 s99, s97, s98
    s_xor_b32 s96, s88, 1048576
    s_add_u32 s13, s99, s96
    s_add_u32 m0, s89, 106496
    s_nop 0
    buffer_load_dwordx4 v74, s[44:47], s13 offen lds
    s_add_u32 s96, s84, 1245184
    s_and_b32 s97, s96, 1048575
    s_lshl_b32 s98, s83, 16
    s_xor_b32 s99, s97, s98
    s_xor_b32 s96, s88, 1048576
    s_add_u32 s13, s99, s96
    s_add_u32 m0, s89, 110592
    s_nop 0
    buffer_load_dwordx4 v74, s[44:47], s13 offen lds
    s_add_u32 s96, s84, 1310720
    s_and_b32 s97, s96, 1048575
    s_lshl_b32 s98, s83, 16
    s_xor_b32 s99, s97, s98
    s_xor_b32 s96, s88, 1048576
    s_add_u32 s13, s99, s96
    s_add_u32 m0, s89, 114688
    s_nop 0
    buffer_load_dwordx4 v74, s[44:47], s13 offen lds
    s_add_u32 s96, s84, 1376256
    s_and_b32 s97, s96, 1048575
    s_lshl_b32 s98, s83, 16
    s_xor_b32 s99, s97, s98
    s_xor_b32 s96, s88, 1048576
    s_add_u32 s13, s99, s96
    s_add_u32 m0, s89, 118784
    s_nop 0
    buffer_load_dwordx4 v74, s[44:47], s13 offen lds
    s_add_u32 s96, s84, 1441792
    s_and_b32 s97, s96, 1048575
    s_lshl_b32 s98, s83, 16
    s_xor_b32 s99, s97, s98
    s_xor_b32 s96, s88, 1048576
    s_add_u32 s13, s99, s96
    s_add_u32 m0, s89, 122880
    s_nop 0
    buffer_load_dwordx4 v74, s[44:47], s13 offen lds
    s_add_u32 s96, s84, 1507328
    s_and_b32 s97, s96, 1048575
    s_lshl_b32 s98, s83, 16
    s_xor_b32 s99, s97, s98
    s_xor_b32 s96, s88, 1048576
    s_add_u32 s13, s99, s96
    s_add_u32 m0, s89, 126976
    s_nop 0
    buffer_load_dwordx4 v74, s[44:47], s13 offen lds
    s_add_u32 s96, s84, 1572864
    s_and_b32 s97, s96, 1048575
    s_lshl_b32 s98, s83, 16
    s_xor_b32 s99, s97, s98
    s_xor_b32 s96, s88, 1048576
    s_add_u32 s13, s99, s96
    s_add_u32 m0, s89, 131072
    s_nop 0
    buffer_load_dwordx4 v74, s[44:47], s13 offen lds
    s_mov_b32 s13, s80
    buffer_load_dwordx4 v[176:179], v72, s[52:55], s13 offen nt
    s_add_u32 s13, s80, 4294049792
    buffer_load_dwordx4 v[180:183], v72, s[52:55], s13 offen nt
    s_lshl_b32 s96, s90, 7
    s_add_u32 s13, s96, s80
    buffer_load_dwordx4 v[184:187], v72, s[56:59], s13 offen nt
    s_lshl_b32 s96, s90, 7
    s_add_u32 s97, s96, s80
    s_add_u32 s13, s97, 4294049792
    buffer_load_dwordx4 v[188:191], v72, s[56:59], s13 offen nt
    s_add_u32 s13, s80, 57344
    buffer_load_dwordx4 v[192:195], v72, s[52:55], s13 offen nt
    s_add_u32 s13, s80, 4294107136
    buffer_load_dwordx4 v[196:199], v72, s[52:55], s13 offen nt
    s_lshl_b32 s96, s90, 7
    s_add_u32 s97, s96, s80
    s_add_u32 s13, s97, 57344
    buffer_load_dwordx4 v[200:203], v72, s[56:59], s13 offen nt
    s_lshl_b32 s96, s90, 7
    s_add_u32 s97, s96, s80
    s_add_u32 s13, s97, 4294107136
    buffer_load_dwordx4 v[204:207], v72, s[56:59], s13 offen nt
    s_waitcnt lgkmcnt(0)
    s_barrier
    ds_read_b128 v[36:39], v76
    ds_read_b128 v[40:43], v76 offset:1024
    s_waitcnt lgkmcnt(0)
    v_mfma_f32_32x32x16_bf16 v[112:127], v[28:31], v[36:39], 0
    v_mfma_f32_32x32x16_bf16 v[112:127], v[32:35], v[40:43], v[112:127]
    s_add_u32 s13, s80, 114688
    buffer_load_dwordx4 v[208:211], v72, s[52:55], s13 offen nt
    s_add_u32 s13, s80, 4294164480
    buffer_load_dwordx4 v[212:215], v72, s[52:55], s13 offen nt
    s_lshl_b32 s96, s90, 7
    s_add_u32 s97, s96, s80
    s_add_u32 s13, s97, 114688
    buffer_load_dwordx4 v[216:219], v72, s[56:59], s13 offen nt
    s_lshl_b32 s96, s90, 7
    s_add_u32 s97, s96, s80
    s_add_u32 s13, s97, 4294164480
    buffer_load_dwordx4 v[220:223], v72, s[56:59], s13 offen nt
L_JOIN:
    v_cvt_pk_bf16_f32 v112, 0, v112
    v_cvt_pk_bf16_f32 v113, 0, v113
    v_cvt_pk_bf16_f32 v114, 0, v114
    v_cvt_pk_bf16_f32 v115, 0, v115
    v_cvt_pk_bf16_f32 v116, 0, v116
    v_cvt_pk_bf16_f32 v117, 0, v117
    v_cvt_pk_bf16_f32 v118, 0, v118
    v_cvt_pk_bf16_f32 v119, 0, v119
    v_cvt_pk_bf16_f32 v120, 0, v120
    v_cvt_pk_bf16_f32 v121, 0, v121
    v_cvt_pk_bf16_f32 v122, 0, v122
    v_cvt_pk_bf16_f32 v123, 0, v123
    v_cvt_pk_bf16_f32 v124, 0, v124
    v_cvt_pk_bf16_f32 v125, 0, v125
    v_cvt_pk_bf16_f32 v126, 0, v126
    v_cvt_pk_bf16_f32 v127, 0, v127
    v_max3_f32 v4, v112, v113, v114
    v_min3_f32 v5, v112, v113, v114
    v_max3_f32 v4, v4, v115, v116
    v_min3_f32 v5, v5, v115, v116
    v_max3_f32 v4, v4, v117, v118
    v_min3_f32 v5, v5, v117, v118
    v_max3_f32 v4, v4, v119, v120
    v_min3_f32 v5, v5, v119, v120
    v_max3_f32 v4, v4, v121, v122
    v_min3_f32 v5, v5, v121, v122
    v_max3_f32 v4, v4, v123, v124
    v_min3_f32 v5, v5, v123, v124
    v_max3_f32 v4, v4, v125, v126
    v_min3_f32 v5, v5, v125, v126
    v_max_f32 v6, v4, v127
    v_min_f32 v7, v5, v127
    v_max_f32 v4, v4, v127
    v_min_f32 v5, v5, v127
    s_nop 0
    v_permlane32_swap_b32 v4, v6
    v_permlane32_swap_b32 v5, v7
    v_max_f32 v4, v4, v6
    v_min_f32 v5, v5, v7
    v_pk_mul_f32 v[4:5], v[4:5], s[6:7] op_sel:[0,1]
    v_pk_fma_f32 v[128:129], v[112:113], s[6:7], v[4:5] op_sel:[0,1,0] op_sel_hi:[1,1,0] neg_lo:[0,0,1] neg_hi:[0,0,1]
    v_pk_fma_f32 v[112:113], v[112:113], s[6:7], v[4:5] op_sel:[0,1,1] neg_lo:[1,0,0] neg_hi:[1,0,0]
    v_pk_fma_f32 v[130:131], v[114:115], s[6:7], v[4:5] op_sel:[0,1,0] op_sel_hi:[1,1,0] neg_lo:[0,0,1] neg_hi:[0,0,1]
    v_pk_fma_f32 v[114:115], v[114:115], s[6:7], v[4:5] op_sel:[0,1,1] neg_lo:[1,0,0] neg_hi:[1,0,0]
    v_pk_fma_f32 v[132:133], v[116:117], s[6:7], v[4:5] op_sel:[0,1,0] op_sel_hi:[1,1,0] neg_lo:[0,0,1] neg_hi:[0,0,1]
    v_pk_fma_f32 v[116:117], v[116:117], s[6:7], v[4:5] op_sel:[0,1,1] neg_lo:[1,0,0] neg_hi:[1,0,0]
    v_pk_fma_f32 v[134:135], v[118:119], s[6:7], v[4:5] op_sel:[0,1,0] op_sel_hi:[1,1,0] neg_lo:[0,0,1] neg_hi:[0,0,1]
    v_pk_fma_f32 v[118:119], v[118:119], s[6:7], v[4:5] op_sel:[0,1,1] neg_lo:[1,0,0] neg_hi:[1,0,0]
    v_pk_fma_f32 v[136:137], v[120:121], s[6:7], v[4:5] op_sel:[0,1,0] op_sel_hi:[1,1,0] neg_lo:[0,0,1] neg_hi:[0,0,1]
    v_pk_fma_f32 v[120:121], v[120:121], s[6:7], v[4:5] op_sel:[0,1,1] neg_lo:[1,0,0] neg_hi:[1,0,0]
    v_pk_fma_f32 v[138:139], v[122:123], s[6:7], v[4:5] op_sel:[0,1,0] op_sel_hi:[1,1,0] neg_lo:[0,0,1] neg_hi:[0,0,1]
    v_pk_fma_f32 v[122:123], v[122:123], s[6:7], v[4:5] op_sel:[0,1,1] neg_lo:[1,0,0] neg_hi:[1,0,0]
    v_pk_fma_f32 v[140:141], v[124:125], s[6:7], v[4:5] op_sel:[0,1,0] op_sel_hi:[1,1,0] neg_lo:[0,0,1] neg_hi:[0,0,1]
    v_pk_fma_f32 v[124:125], v[124:125], s[6:7], v[4:5] op_sel:[0,1,1] neg_lo:[1,0,0] neg_hi:[1,0,0]
    v_pk_fma_f32 v[142:143], v[126:127], s[6:7], v[4:5] op_sel:[0,1,0] op_sel_hi:[1,1,0] neg_lo:[0,0,1] neg_hi:[0,0,1]
    v_pk_fma_f32 v[126:127], v[126:127], s[6:7], v[4:5] op_sel:[0,1,1] neg_lo:[1,0,0] neg_hi:[1,0,0]
    v_exp_f32 v128, v128
    v_exp_f32 v112, v112
    v_exp_f32 v129, v129
    v_exp_f32 v113, v113
    v_exp_f32 v130, v130
    v_exp_f32 v114, v114
    v_exp_f32 v131, v131
    v_exp_f32 v115, v115
    v_exp_f32 v132, v132
    v_exp_f32 v116, v116
    v_exp_f32 v133, v133
    v_exp_f32 v117, v117
    v_exp_f32 v134, v134
    v_exp_f32 v118, v118
    v_exp_f32 v135, v135
    v_exp_f32 v119, v119
    v_exp_f32 v136, v136
    v_exp_f32 v120, v120
    v_exp_f32 v137, v137
    v_exp_f32 v121, v121
    v_exp_f32 v138, v138
    v_exp_f32 v122, v122
    v_exp_f32 v139, v139
    v_exp_f32 v123, v123
    v_exp_f32 v140, v140
    v_exp_f32 v124, v124
    v_exp_f32 v141, v141
    v_exp_f32 v125, v125
    v_exp_f32 v142, v142
    v_exp_f32 v126, v126
    v_exp_f32 v143, v143
    v_exp_f32 v127, v127
    v_pk_add_f32 v[8:9], v[128:129], v[130:131]
    v_pk_add_f32 v[10:11], v[112:113], v[114:115]
    v_pk_add_f32 v[8:9], v[8:9], v[132:133]
    v_pk_add_f32 v[10:11], v[10:11], v[116:117]
    v_pk_add_f32 v[8:9], v[8:9], v[134:135]
    v_pk_add_f32 v[10:11], v[10:11], v[118:119]
    v_pk_add_f32 v[8:9], v[8:9], v[136:137]
    v_pk_add_f32 v[10:11], v[10:11], v[120:121]
    v_pk_add_f32 v[8:9], v[8:9], v[138:139]
    v_pk_add_f32 v[10:11], v[10:11], v[122:123]
    v_pk_add_f32 v[8:9], v[8:9], v[140:141]
    v_pk_add_f32 v[10:11], v[10:11], v[124:125]
    v_pk_add_f32 v[8:9], v[8:9], v[142:143]
    v_pk_add_f32 v[10:11], v[10:11], v[126:127]
    v_add_f32 v6, v8, v9
    v_add_f32 v7, v10, v11
    v_add_f32 v4, v8, v9
    v_add_f32 v5, v10, v11
    s_nop 0
    v_permlane32_swap_b32 v4, v6
    v_permlane32_swap_b32 v5, v7
    v_pk_add_f32 v[4:5], v[4:5], v[6:7]
    v_rcp_f32 v4, v4
    v_rcp_f32 v5, v5
    s_nop 0
    v_pk_mul_f32 v[128:129], v[128:129], v[4:5] op_sel_hi:[1,0]
    v_pk_mul_f32 v[112:113], v[112:113], v[4:5] op_sel:[0,1]
    v_pk_mul_f32 v[130:131], v[130:131], v[4:5] op_sel_hi:[1,0]
    v_pk_mul_f32 v[114:115], v[114:115], v[4:5] op_sel:[0,1]
    v_pk_mul_f32 v[132:133], v[132:133], v[4:5] op_sel_hi:[1,0]
    v_pk_mul_f32 v[116:117], v[116:117], v[4:5] op_sel:[0,1]
    v_pk_mul_f32 v[134:135], v[134:135], v[4:5] op_sel_hi:[1,0]
    v_pk_mul_f32 v[118:119], v[118:119], v[4:5] op_sel:[0,1]
    v_pk_mul_f32 v[136:137], v[136:137], v[4:5] op_sel_hi:[1,0]
    v_pk_mul_f32 v[120:121], v[120:121], v[4:5] op_sel:[0,1]
    v_pk_mul_f32 v[138:139], v[138:139], v[4:5] op_sel_hi:[1,0]
    v_pk_mul_f32 v[122:123], v[122:123], v[4:5] op_sel:[0,1]
    v_pk_mul_f32 v[140:141], v[140:141], v[4:5] op_sel_hi:[1,0]
    v_pk_mul_f32 v[124:125], v[124:125], v[4:5] op_sel:[0,1]
    v_pk_mul_f32 v[142:143], v[142:143], v[4:5] op_sel_hi:[1,0]
    v_pk_mul_f32 v[126:127], v[126:127], v[4:5] op_sel:[0,1]
    v_cvt_pk_bf16_f32 v80, v128, v129
    v_cvt_pk_bf16_f32 v88, v112, v113
    v_cvt_pk_bf16_f32 v81, v130, v131
    v_cvt_pk_bf16_f32 v89, v114, v115
    v_cvt_pk_bf16_f32 v82, v132, v133
    v_cvt_pk_bf16_f32 v90, v116, v117
    v_cvt_pk_bf16_f32 v83, v134, v135
    v_cvt_pk_bf16_f32 v91, v118, v119
    v_cvt_pk_bf16_f32 v84, v136, v137
    v_cvt_pk_bf16_f32 v92, v120, v121
    v_cvt_pk_bf16_f32 v85, v138, v139
    v_cvt_pk_bf16_f32 v93, v122, v123
    v_cvt_pk_bf16_f32 v86, v140, v141
    v_cvt_pk_bf16_f32 v94, v124, v125
    v_cvt_pk_bf16_f32 v87, v142, v143
    v_cvt_pk_bf16_f32 v95, v126, v127
    ds_write_b128 v75, v[80:83]
    ds_write_b128 v75, v[84:87] offset:4096
    ds_write_b128 v75, v[88:91] offset:8192
    ds_write_b128 v75, v[92:95] offset:12288
    s_lshl_b32 s13, s3, 12
    v_add_u32 v20, s13, v63
    s_lshl_b32 s96, s76, 13
    s_add_u32 s13, s96, 32768
    v_add_u32 v21, s13, v63
    v_mov_b32 v36, 0x3f803f80
    v_mov_b32 v37, 0x3f803f80
    v_mov_b32 v38, 0x3f803f80
    v_mov_b32 v39, 0x3f803f80
    s_lshl3_add_u32 s96, s11, s3
    s_lshl_b32 s97, s96, 5
    s_add_u32 s98, s97, s10
    s_lshl_b32 s99, s98, 10
    s_add_u32 s13, s99, 25165824
    s_add_u32 s15, s13, 16384
    s_lshl3_add_u32 s96, s11, s3
    s_lshl_b32 s97, s96, 10
    s_add_u32 s16, s97, 21495808
    s_lshl_b32 s96, s10, 6
    s_add_u32 s14, s96, s16
    s_waitcnt lgkmcnt(0)
    s_barrier
    ds_read_b64_tr_b16 v[128:129], v20
    ds_read_b64_tr_b16 v[130:131], v20 offset:512
    ds_read_b64_tr_b16 v[144:145], v21
    ds_read_b64_tr_b16 v[146:147], v21 offset:512
    ds_read_b64_tr_b16 v[148:149], v21 offset:4096
    ds_read_b64_tr_b16 v[150:151], v21 offset:4608
    ds_read_b64_tr_b16 v[132:133], v20 offset:1024
    ds_read_b64_tr_b16 v[134:135], v20 offset:1536
    ds_read_b64_tr_b16 v[152:153], v21 offset:1024
    ds_read_b64_tr_b16 v[154:155], v21 offset:1536
    ds_read_b64_tr_b16 v[156:157], v21 offset:5120
    ds_read_b64_tr_b16 v[158:159], v21 offset:5632
    ds_read_b64_tr_b16 v[136:137], v20 offset:2048
    ds_read_b64_tr_b16 v[138:139], v20 offset:2560
    ds_read_b64_tr_b16 v[160:161], v21 offset:2048
    ds_read_b64_tr_b16 v[162:163], v21 offset:2560
    ds_read_b64_tr_b16 v[164:165], v21 offset:6144
    ds_read_b64_tr_b16 v[166:167], v21 offset:6656
    s_waitcnt lgkmcnt(12)
    v_mfma_f32_16x16x32_bf16 v[52:55], v[128:131], v[144:147], 0
    v_mfma_f32_16x16x32_bf16 v[56:59], v[128:131], v[148:151], 0
    v_mfma_f32_16x16x32_bf16 v[40:43], v[128:131], v[36:39], 0
    ds_read_b64_tr_b16 v[140:141], v20 offset:3072
    ds_read_b64_tr_b16 v[142:143], v20 offset:3584
    ds_read_b64_tr_b16 v[168:169], v21 offset:3072
    ds_read_b64_tr_b16 v[170:171], v21 offset:3584
    ds_read_b64_tr_b16 v[172:173], v21 offset:7168
    ds_read_b64_tr_b16 v[174:175], v21 offset:7680
    s_waitcnt lgkmcnt(12)
    v_mfma_f32_16x16x32_bf16 v[52:55], v[132:135], v[152:155], v[52:55]
    v_mfma_f32_16x16x32_bf16 v[56:59], v[132:135], v[156:159], v[56:59]
    v_mfma_f32_16x16x32_bf16 v[40:43], v[132:135], v[36:39], v[40:43]
    v_and_b32 v75, 15, v1
    v_lshlrev_b32 v75, 15, v75
    s_and_b32 s96, s10, 1
    s_and_b32 s97, s2, 135
    s_lshl_b32 s98, s97, 12
    s_lshr_b32 s99, s10, 1
    s_lshl_b32 s97, s99, 6
    s_add_u32 s99, s98, s97
    s_lshl2_add_u32 s98, s96, s99
    s_add_u32 s97, s98, 1048576
    s_add_u32 s17, s97, 512
    s_waitcnt lgkmcnt(6)
    v_mfma_f32_16x16x32_bf16 v[52:55], v[136:139], v[160:163], v[52:55]
    v_mfma_f32_16x16x32_bf16 v[56:59], v[136:139], v[164:167], v[56:59]
    v_mfma_f32_16x16x32_bf16 v[40:43], v[136:139], v[36:39], v[40:43]
    s_waitcnt lgkmcnt(0)
    v_mfma_f32_16x16x32_bf16 v[52:55], v[140:143], v[168:171], v[52:55]
    v_mfma_f32_16x16x32_bf16 v[56:59], v[140:143], v[172:175], v[56:59]
    v_mfma_f32_16x16x32_bf16 v[40:43], v[140:143], v[36:39], v[40:43]
    s_cmp_lt_u32 s3, 4
    s_cbranch_scc1 L_NOQX
    ds_read_b128 v[44:47], v76 offset:2048
    ds_read_b128 v[48:51], v76 offset:3072
L_NOQX:
    s_nop 3
    buffer_store_dwordx4 v[52:55], v2, s[32:35], s13 offen sc1
    buffer_store_dwordx4 v[56:59], v2, s[32:35], s15 offen sc1
    s_mov_b32 exec_lo, 0x00010001
    s_mov_b32 exec_hi, 0x00010001
    buffer_store_dwordx4 v[40:43], v1, s[32:35], s14 offen sc1
    s_mov_b64 exec, -1
    s_waitcnt lgkmcnt(0)
    v_mfma_f32_32x32x16_bf16 v[112:127], v[28:31], v[44:47], 0
    v_mfma_f32_32x32x16_bf16 v[112:127], v[32:35], v[48:51], v[112:127]
    v_lshrrev_b32 v22, 3, v1
    v_lshlrev_b32 v22, 10, v22
    v_and_b32 v9, 7, v1
    v_lshl_add_u32 v22, v9, 4, v22
    v_and_b32 v76, 7, v1
    v_lshlrev_b32 v76, 4, v76
    v_lshrrev_b32 v9, 5, v1
    v_lshl_add_u32 v76, v9, 3, v76
    s_nop 3
    v_cvt_pk_bf16_f32 v112, 0, v112
    v_cvt_pk_bf16_f32 v113, 0, v113
    v_cvt_pk_bf16_f32 v114, 0, v114
    v_cvt_pk_bf16_f32 v115, 0, v115
    v_cvt_pk_bf16_f32 v116, 0, v116
    v_cvt_pk_bf16_f32 v117, 0, v117
    v_cvt_pk_bf16_f32 v118, 0, v118
    v_cvt_pk_bf16_f32 v119, 0, v119
    v_cvt_pk_bf16_f32 v120, 0, v120
    v_cvt_pk_bf16_f32 v121, 0, v121
    v_cvt_pk_bf16_f32 v122, 0, v122
    v_cvt_pk_bf16_f32 v123, 0, v123
    v_cvt_pk_bf16_f32 v124, 0, v124
    v_cvt_pk_bf16_f32 v125, 0, v125
    v_cvt_pk_bf16_f32 v126, 0, v126
    v_cvt_pk_bf16_f32 v127, 0, v127
    v_max3_f32 v52, v112, v113, v114
    v_min3_f32 v53, v112, v113, v114
    v_max3_f32 v52, v52, v115, v116
    v_min3_f32 v53, v53, v115, v116
    v_max3_f32 v52, v52, v117, v118
    v_min3_f32 v53, v53, v117, v118
    v_max3_f32 v52, v52, v119, v120
    v_min3_f32 v53, v53, v119, v120
    v_max3_f32 v52, v52, v121, v122
    v_min3_f32 v53, v53, v121, v122
    v_max3_f32 v52, v52, v123, v124
    v_min3_f32 v53, v53, v123, v124
    v_max3_f32 v52, v52, v125, v126
    v_min3_f32 v53, v53, v125, v126
    v_max_f32 v54, v52, v127
    v_min_f32 v55, v53, v127
    v_max_f32 v52, v52, v127
    v_min_f32 v53, v53, v127
    s_nop 0
    v_permlane32_swap_b32 v52, v54
    v_permlane32_swap_b32 v53, v55
    v_max_f32 v52, v52, v54
    v_min_f32 v53, v53, v55
    v_pk_mul_f32 v[52:53], v[52:53], s[6:7] op_sel:[0,1]
    v_pk_fma_f32 v[128:129], v[112:113], s[6:7], v[52:53] op_sel:[0,1,0] op_sel_hi:[1,1,0] neg_lo:[0,0,1] neg_hi:[0,0,1]
    v_pk_fma_f32 v[112:113], v[112:113], s[6:7], v[52:53] op_sel:[0,1,1] neg_lo:[1,0,0] neg_hi:[1,0,0]
    v_pk_fma_f32 v[130:131], v[114:115], s[6:7], v[52:53] op_sel:[0,1,0] op_sel_hi:[1,1,0] neg_lo:[0,0,1] neg_hi:[0,0,1]
    v_pk_fma_f32 v[114:115], v[114:115], s[6:7], v[52:53] op_sel:[0,1,1] neg_lo:[1,0,0] neg_hi:[1,0,0]
    v_pk_fma_f32 v[132:133], v[116:117], s[6:7], v[52:53] op_sel:[0,1,0] op_sel_hi:[1,1,0] neg_lo:[0,0,1] neg_hi:[0,0,1]
    v_pk_fma_f32 v[116:117], v[116:117], s[6:7], v[52:53] op_sel:[0,1,1] neg_lo:[1,0,0] neg_hi:[1,0,0]
    v_pk_fma_f32 v[134:135], v[118:119], s[6:7], v[52:53] op_sel:[0,1,0] op_sel_hi:[1,1,0] neg_lo:[0,0,1] neg_hi:[0,0,1]
    v_pk_fma_f32 v[118:119], v[118:119], s[6:7], v[52:53] op_sel:[0,1,1] neg_lo:[1,0,0] neg_hi:[1,0,0]
    v_pk_fma_f32 v[136:137], v[120:121], s[6:7], v[52:53] op_sel:[0,1,0] op_sel_hi:[1,1,0] neg_lo:[0,0,1] neg_hi:[0,0,1]
    v_pk_fma_f32 v[120:121], v[120:121], s[6:7], v[52:53] op_sel:[0,1,1] neg_lo:[1,0,0] neg_hi:[1,0,0]
    v_pk_fma_f32 v[138:139], v[122:123], s[6:7], v[52:53] op_sel:[0,1,0] op_sel_hi:[1,1,0] neg_lo:[0,0,1] neg_hi:[0,0,1]
    v_pk_fma_f32 v[122:123], v[122:123], s[6:7], v[52:53] op_sel:[0,1,1] neg_lo:[1,0,0] neg_hi:[1,0,0]
    v_pk_fma_f32 v[140:141], v[124:125], s[6:7], v[52:53] op_sel:[0,1,0] op_sel_hi:[1,1,0] neg_lo:[0,0,1] neg_hi:[0,0,1]
    v_pk_fma_f32 v[124:125], v[124:125], s[6:7], v[52:53] op_sel:[0,1,1] neg_lo:[1,0,0] neg_hi:[1,0,0]
    v_pk_fma_f32 v[142:143], v[126:127], s[6:7], v[52:53] op_sel:[0,1,0] op_sel_hi:[1,1,0] neg_lo:[0,0,1] neg_hi:[0,0,1]
    v_pk_fma_f32 v[126:127], v[126:127], s[6:7], v[52:53] op_sel:[0,1,1] neg_lo:[1,0,0] neg_hi:[1,0,0]
    v_exp_f32 v128, v128
    v_exp_f32 v112, v112
    v_exp_f32 v129, v129
    s_lshl_b32 s96, s11, 7
    s_add_u32 s18, s96, 32768
    s_lshl3_add_u32 s14, s10, s18
    v_and_b32 v23, 15, v1
    v_lshlrev_b32 v23, 3, v23
    s_waitcnt vmcnt(0)
    s_barrier
    s_cmp_lg_u32 s3, 0
    s_cbranch_scc1 L_PC
    v_mov_b32 v21, s4
    s_mov_b32 exec_hi, 0
    s_mov_b32 exec_lo, 65535
    buffer_store_dword v21, v75, s[32:35], s17 offen sc1
    s_mov_b64 exec, -1
L_PC:
    s_cmp_lt_u32 s3, 4
    s_cbranch_scc1 L_NOM
    v_and_b32 v105, 31, v1
    v_lshlrev_b32 v105, 4, v105
    v_lshrrev_b32 v9, 5, v1
    v_lshl_add_u32 v105, v9, 9, v105
    s_and_b32 s96, s3, 3
    s_lshl4_add_u32 s97, s96, s12
    s_lshl_b32 s98, s97, 11
    s_add_u32 s20, s98, 131072
    buffer_load_dwordx4 v[96:99], v105, s[32:35], s20 offen sc1
    buffer_load_dwordx4 v[100:103], v105, s[32:35], s20 offen offset:1024 sc1
L_NOM:
    s_lshl4_add_u32 s96, s11, s10
    s_lshl_b32 s97, s96, 14
    s_lshl_b32 s98, s3, 7
    s_add_u32 s99, s97, s98
    s_add_u32 s13, s99, 25165824
    s_lshl4_add_u32 s96, s11, s10
    s_lshl_b32 s97, s96, 10
    s_lshl_b32 s98, s3, 7
    s_add_u32 s99, s97, s98
    s_add_u32 s15, s99, 29360128
    s_add_u32 s17, s17, 3072
    s_load_dwordx2 s[24:25], s[32:33], s92 offset:512 glc
    s_add_u32 s96, s84, 262144
    s_and_b32 s97, s96, 1048575
    s_lshl_b32 s98, s83, 16
    s_xor_b32 s99, s97, s98
    s_add_u32 s19, s99, s88
    s_add_u32 m0, s89, 49152
    s_nop 0
    buffer_load_dwordx4 v74, s[44:47], s19 offen lds
    v_exp_f32 v113, v113
    v_exp_f32 v130, v130
    v_exp_f32 v114, v114
    v_exp_f32 v131, v131
    v_exp_f32 v115, v115
    v_exp_f32 v132, v132
    v_exp_f32 v116, v116
    v_exp_f32 v133, v133
    v_exp_f32 v117, v117
    v_exp_f32 v134, v134
    s_add_u32 s96, s84, 393216
    s_and_b32 s97, s96, 1048575
    s_lshl_b32 s98, s83, 16
    s_xor_b32 s99, s97, s98
    s_add_u32 s19, s99, s88
    s_add_u32 m0, s89, 57344
    s_nop 0
    buffer_load_dwordx4 v74, s[44:47], s19 offen lds
    v_exp_f32 v118, v118
    v_exp_f32 v135, v135
    v_exp_f32 v119, v119
    v_exp_f32 v136, v136
    v_exp_f32 v120, v120
    v_exp_f32 v137, v137
    v_exp_f32 v121, v121
    v_exp_f32 v138, v138
    v_exp_f32 v122, v122
    s_add_u32 s96, s84, 524288
    s_and_b32 s97, s96, 1048575
    s_lshl_b32 s98, s83, 16
    s_xor_b32 s99, s97, s98
    s_add_u32 s19, s99, s88
    s_add_u32 m0, s89, 65536
    s_nop 0
    buffer_load_dwordx4 v74, s[44:47], s19 offen lds
    v_exp_f32 v139, v139
    v_exp_f32 v123, v123
    v_exp_f32 v140, v140
    v_exp_f32 v124, v124
    v_exp_f32 v141, v141
    v_exp_f32 v125, v125
    v_exp_f32 v142, v142
    v_exp_f32 v126, v126
    v_exp_f32 v143, v143
    v_exp_f32 v127, v127
    s_add_u32 s96, s84, 655360
    s_and_b32 s97, s96, 1048575
    s_lshl_b32 s98, s83, 16
    s_xor_b32 s99, s97, s98
    s_add_u32 s19, s99, s88
    s_add_u32 m0, s89, 73728
    s_nop 0
    buffer_load_dwordx4 v74, s[44:47], s19 offen lds
    v_pk_add_f32 v[56:57], v[128:129], v[130:131]
    v_pk_add_f32 v[58:59], v[112:113], v[114:115]
    v_pk_add_f32 v[56:57], v[56:57], v[132:133]
    v_pk_add_f32 v[58:59], v[58:59], v[116:117]
    v_pk_add_f32 v[56:57], v[56:57], v[134:135]
    v_pk_add_f32 v[58:59], v[58:59], v[118:119]
    v_pk_add_f32 v[56:57], v[56:57], v[136:137]
    v_pk_add_f32 v[58:59], v[58:59], v[120:121]
    v_pk_add_f32 v[56:57], v[56:57], v[138:139]
    s_add_u32 s96, s84, 786432
    s_and_b32 s97, s96, 1048575
    s_lshl_b32 s98, s83, 16
    s_xor_b32 s99, s97, s98
    s_add_u32 s19, s99, s88
    s_add_u32 m0, s89, 81920
    s_nop 0
    buffer_load_dwordx4 v74, s[44:47], s19 offen lds
    v_pk_add_f32 v[58:59], v[58:59], v[122:123]
    v_pk_add_f32 v[56:57], v[56:57], v[140:141]
    v_pk_add_f32 v[58:59], v[58:59], v[124:125]
    v_pk_add_f32 v[56:57], v[56:57], v[142:143]
    v_pk_add_f32 v[58:59], v[58:59], v[126:127]
    v_add_f32 v54, v56, v57
    v_add_f32 v55, v58, v59
    v_add_f32 v52, v56, v57
    v_add_f32 v53, v58, v59
    s_nop 0
    v_permlane32_swap_b32 v52, v54
    s_add_u32 s96, s84, 917504
    s_and_b32 s97, s96, 1048575
    s_lshl_b32 s98, s83, 16
    s_xor_b32 s99, s97, s98
    s_add_u32 s19, s99, s88
    s_add_u32 m0, s89, 90112
    s_nop 0
    buffer_load_dwordx4 v74, s[44:47], s19 offen lds
    v_permlane32_swap_b32 v53, v55
    v_pk_add_f32 v[52:53], v[52:53], v[54:55]
    v_rcp_f32 v52, v52
    v_rcp_f32 v53, v53
    s_nop 0
    v_pk_mul_f32 v[128:129], v[128:129], v[52:53] op_sel_hi:[1,0]
    v_pk_mul_f32 v[112:113], v[112:113], v[52:53] op_sel:[0,1]
    v_pk_mul_f32 v[130:131], v[130:131], v[52:53] op_sel_hi:[1,0]
    v_pk_mul_f32 v[114:115], v[114:115], v[52:53] op_sel:[0,1]
    v_pk_mul_f32 v[132:133], v[132:133], v[52:53] op_sel_hi:[1,0]
    s_cmp_lt_u32 s3, 4
    s_cbranch_scc1 L_NOG
    s_waitcnt vmcnt(6)
    v_bitop3_b32 v4, v97, v99, s4 bitop3:0x7e
    v_bitop3_b32 v4, v4, v101, s4 bitop3:0xf6
    v_bitop3_b32 v4, v4, v103, s4 bitop3:0xf6
    v_cmp_ne_u32 vcc, 0, v4
    s_cbranch_vccz TOK_17
POLL_18:
    buffer_load_dwordx4 v[96:99], v105, s[32:35], s20 offen sc1
    buffer_load_dwordx4 v[100:103], v105, s[32:35], s20 offen offset:1024 sc1
    s_waitcnt vmcnt(0)
    v_bitop3_b32 v4, v97, v99, s4 bitop3:0x7e
    v_bitop3_b32 v4, v4, v101, s4 bitop3:0xf6
    v_bitop3_b32 v4, v4, v103, s4 bitop3:0xf6
    v_cmp_ne_u32 vcc, 0, v4
    s_cbranch_vccz PDONE_19
    s_add_u32 s5, s5, 1
    s_cmp_lt_u32 s5, 300000
    s_cbranch_scc1 POLL_18
PDONE_19:
TOK_17:
    s_and_b32 s96, s3, 3
    s_lshl_b32 s97, s96, 7
    s_add_u32 s14, s97, 12288
    v_and_b32 v4, 31, v1
    v_lshl_add_u32 v4, v4, 2, s14
    s_and_b32 s82, s3, 3
    v_add_f32 v96, v96, v100
    v_add_f32 v97, v98, v102
    v_mov_b32 v98, v96
    v_mov_b32 v99, v97
    s_cmp_eq_u32 s82, 2
    s_cselect_b32 s91, 1.0, 0
    v_permlane32_swap_b32 v96, v98
    v_permlane32_swap_b32 v97, v99
    v_pk_add_f32 v[96:97], v[96:97], v[98:99]
    v_cvt_pk_bf16_f32 v96, 0, v96
    v_cvt_pk_bf16_f32 v97, 0, v97
    v_add_f32 v96, s91, v96
    v_add_f32 v97, s91, v97
    v_cvt_pk_bf16_f32 v98, v96, v97
    ds_write_b32 v4, v98
    s_cbranch_scc0 L_NOG
    v_lshlrev_b32 v96, 16, v98
    v_and_b32 v97, s6, v98
    v_lshlrev_b32 v100, 16, v104
    v_and_b32 v101, s6, v104
    v_pk_mul_f32 v[100:101], v[100:101], v[96:97]
    v_cvt_pk_bf16_f32 v102, v100, v101
    v_lshlrev_b32 v96, 16, v102
    v_and_b32 v97, s6, v102
    v_pk_add_f32 v[96:97], v[100:101], v[96:97] neg_lo:[0,1] neg_hi:[0,1]
    v_cvt_pk_bf16_f32 v103, v96, v97
    v_add_f32 v96, v100, v101
    ds_write2_b32 v4, v102, v103 offset0:64 offset1:96
    ds_write_b32 v4, v104 offset:512
    v_add_f32_dpp v96, v96, v96 quad_perm:[1,0,3,2] row_mask:0xf bank_mask:0xf
    s_nop 1
    v_add_f32_dpp v96, v96, v96 quad_perm:[2,3,0,1] row_mask:0xf bank_mask:0xf
    s_nop 1
    v_add_f32_dpp v96, v96, v96 row_half_mirror row_mask:0xf bank_mask:0xf
    s_nop 1
    v_add_f32_dpp v96, v96, v96 row_ror:8 row_mask:0xf bank_mask:0xf
    s_lshl4_add_u32 s96, s21, s12
    s_lshl3_add_u32 s14, s96, 65536
    v_mov_b32 v98, v96
    v_mov_b32 v97, s4
    s_nop 0
    v_permlane16_swap_b32 v96, v98
    v_add_f32 v96, v96, v98
    s_mov_b64 exec, 1
    buffer_store_dwordx2 v[96:97], v3, s[32:35], s14 offen sc1
    s_mov_b64 exec, -1
L_NOG:
    s_branch SCHK_15
SPOLL_14:
    s_load_dwordx2 s[24:25], s[32:33], s92 offset:512 glc
SCHK_15:
    s_add_u32 s5, s5, 1
    s_cmp_ge_u32 s5, 300000
    s_waitcnt lgkmcnt(0)
    s_cbranch_scc1 SDONE_16
    s_cmp_lg_u32 s24, s4
    s_cbranch_scc1 SPOLL_14
    s_cmp_lg_u32 s25, s4
    s_cbranch_scc1 SPOLL_14
SDONE_16:
    s_barrier
    s_add_u32 s18, s13, 8192
    buffer_load_dword v24, v3, s[32:35], 0 offen offset:256 sc1
    buffer_load_dwordx4 v[144:147], v22, s[32:35], s13 offen sc1
    buffer_load_dwordx4 v[148:151], v22, s[32:35], s18 offen sc1
    buffer_load_dwordx4 v[160:163], v2, s[32:35], s16 offen sc1
    s_lshl_b32 s96, s3, 5
    s_add_u32 s14, s96, 8192
    v_and_b32 v6, 3, v1
    v_lshl_add_u32 v6, v6, 3, s14
    v_lshrrev_b32 v9, 5, v1
    v_lshl_add_u32 v6, v9, 2, v6
    s_lshl_b32 s14, s3, 10
    v_and_b32 v5, 15, v1
    v_lshl_add_u32 v5, v5, 4, s14
    v_lshrrev_b32 v9, 5, v1
    v_lshl_add_u32 v5, v9, 9, v5
    v_bfe_u32 v9, v1, 4, 1
    v_lshl_add_u32 v5, v9, 3, v5
    s_lshl_b32 s96, s76, 7
    s_add_u32 s14, s96, 8192
    v_lshrrev_b32 v7, 5, v1
    v_lshl_add_u32 v7, v7, 4, s14
    s_lshl_b32 s14, s76, 12
    v_add_u32 v20, s14, v2
    v_pk_mul_f32 v[116:117], v[116:117], v[52:53] op_sel:[0,1]
    v_pk_mul_f32 v[134:135], v[134:135], v[52:53] op_sel_hi:[1,0]
    v_pk_mul_f32 v[118:119], v[118:119], v[52:53] op_sel:[0,1]
    v_pk_mul_f32 v[136:137], v[136:137], v[52:53] op_sel_hi:[1,0]
    v_pk_mul_f32 v[120:121], v[120:121], v[52:53] op_sel:[0,1]
    v_pk_mul_f32 v[138:139], v[138:139], v[52:53] op_sel_hi:[1,0]
    v_pk_mul_f32 v[122:123], v[122:123], v[52:53] op_sel:[0,1]
    v_pk_mul_f32 v[140:141], v[140:141], v[52:53] op_sel_hi:[1,0]
    v_pk_mul_f32 v[124:125], v[124:125], v[52:53] op_sel:[0,1]
    v_pk_mul_f32 v[142:143], v[142:143], v[52:53] op_sel_hi:[1,0]
    v_pk_mul_f32 v[126:127], v[126:127], v[52:53] op_sel:[0,1]
    v_cvt_pk_bf16_f32 v80, v128, v129
    v_cvt_pk_bf16_f32 v88, v112, v113
    v_cvt_pk_bf16_f32 v81, v130, v131
    v_cvt_pk_bf16_f32 v89, v114, v115
    v_cvt_pk_bf16_f32 v82, v132, v133
    v_cvt_pk_bf16_f32 v90, v116, v117
    v_cvt_pk_bf16_f32 v83, v134, v135
    v_cvt_pk_bf16_f32 v91, v118, v119
    v_cvt_pk_bf16_f32 v84, v136, v137
    v_cvt_pk_bf16_f32 v92, v120, v121
    v_cvt_pk_bf16_f32 v85, v138, v139
    v_cvt_pk_bf16_f32 v93, v122, v123
    v_cvt_pk_bf16_f32 v86, v140, v141
    v_cvt_pk_bf16_f32 v94, v124, v125
    v_cvt_pk_bf16_f32 v87, v142, v143
    v_cvt_pk_bf16_f32 v95, v126, v127
    s_waitcnt vmcnt(1)
    v_cmp_eq_u32 vcc, s4, v24
    s_nop 0
    s_cmp_eq_u32 vcc_lo, 0
    s_cselect_b32 s93, 1, 0
    v_pk_add_f32 v[144:145], v[144:145], v[148:149]
    v_pk_add_f32 v[146:147], v[146:147], v[150:151]
    s_nop 1
    v_permlane32_swap_b32 v144, v146
    v_permlane32_swap_b32 v145, v147
    v_pk_add_f32 v[144:145], v[144:145], v[146:147]
    s_nop 1
    v_add_f32_dpp v144, v144, v144 row_ror:8 row_mask:0xf bank_mask:0xf
    v_add_f32_dpp v145, v145, v145 row_ror:8 row_mask:0xf bank_mask:0xf
    v_mov_b32 v146, v144
    v_mov_b32 v147, v145
    s_nop 0
    v_permlane16_swap_b32 v144, v146
    v_permlane16_swap_b32 v145, v147
    v_pk_add_f32 v[144:145], v[144:145], v[146:147]
    v_cvt_pk_bf16_f32 v144, v144, v145
    v_mov_b32 v145, s4
    s_mov_b32 exec_lo, 0xff
    s_mov_b32 exec_hi, 0xff
    s_cmp_lg_u32 s93, 0
    s_cbranch_scc1 LOC_20
    buffer_store_dwordx2 v[144:145], v76, s[32:35], s15 offen sc1
    s_branch LOCD_21
LOC_20:
    buffer_store_dwordx2 v[144:145], v76, s[32:35], s15 offen
LOCD_21:
    s_mov_b64 exec, -1
    v_mov_b32 v224, v144
    v_mov_b32 v225, v145
    v_add_u32 v226, s15, v76
    s_cbranch_scc1 L_PC2
    s_barrier
    s_cmp_lg_u32 s3, 0
    s_cbranch_scc1 L_PC2
    v_mov_b32 v21, s4
    s_mov_b32 exec_hi, 0
    s_mov_b32 exec_lo, 65535
    buffer_store_dword v21, v75, s[32:35], s17 offen sc1
    s_mov_b64 exec, -1
L_PC2:
    s_lshl3_add_u32 s96, s11, s3
    s_lshl_b32 s97, s96, 11
    s_add_u32 s13, s97, 29360128
    s_waitcnt vmcnt(0)
    v_permlane32_swap_b32 v160, v162
    v_permlane32_swap_b32 v161, v163
    v_pk_add_f32 v[160:161], v[160:161], v[162:163]
    s_nop 1
    v_add_f32_dpp v160, v160, v160 row_ror:4 row_mask:0xf bank_mask:0xf
    v_add_f32_dpp v161, v161, v161 row_ror:4 row_mask:0xf bank_mask:0xf
    s_nop 0
    v_add_f32_dpp v160, v160, v160 row_ror:8 row_mask:0xf bank_mask:0xf
    v_add_f32_dpp v161, v161, v161 row_ror:8 row_mask:0xf bank_mask:0xf
    v_mov_b32 v162, v160
    v_mov_b32 v163, v161
    s_nop 0
    v_permlane16_swap_b32 v160, v162
    v_permlane16_swap_b32 v161, v163
    v_pk_add_f32 v[160:161], v[160:161], v[162:163]
    v_cvt_pk_bf16_f32 v160, v160, v161
    ds_write_b32 v6, v160
    s_cmp_lg_u32 s93, 0
    s_cbranch_scc1 L_C2L
SPOLL_22:
    s_load_dwordx2 s[24:25], s[32:33], s92 offset:3584 glc
SCHK_23:
    s_add_u32 s5, s5, 1
    s_cmp_ge_u32 s5, 300000
    s_waitcnt lgkmcnt(0)
    s_cbranch_scc1 SDONE_24
    s_cmp_lg_u32 s24, s4
    s_cbranch_scc1 SPOLL_22
    s_cmp_lg_u32 s25, s4
    s_cbranch_scc1 SPOLL_22
SDONE_24:
L_C2L:
    buffer_load_dwordx4 v[152:155], v2, s[32:35], s13 offen sc1
    buffer_load_dwordx4 v[156:159], v2, s[32:35], s13 offen offset:1024 sc1
    s_waitcnt vmcnt(0)
    v_bitop3_b32 v4, v153, v155, s4 bitop3:0x7e
    v_bitop3_b32 v4, v4, v157, s4 bitop3:0xf6
    v_bitop3_b32 v4, v4, v159, s4 bitop3:0xf6
    v_cmp_ne_u32 vcc, 0, v4
    s_cbranch_vccz TOK_26
POLL_27:
    buffer_load_dwordx4 v[152:155], v2, s[32:35], s13 offen sc1
    buffer_load_dwordx4 v[156:159], v2, s[32:35], s13 offen offset:1024 sc1
    s_waitcnt vmcnt(0)
    v_bitop3_b32 v4, v153, v155, s4 bitop3:0x7e
    v_bitop3_b32 v4, v4, v157, s4 bitop3:0xf6
    v_bitop3_b32 v4, v4, v159, s4 bitop3:0xf6
    v_cmp_ne_u32 vcc, 0, v4
    s_cbranch_vccz PDONE_28
    s_add_u32 s5, s5, 1
    s_cmp_lt_u32 s5, 300000
    s_cbranch_scc1 POLL_27
PDONE_28:
TOK_26:
    ds_write2_b32 v5, v152, v154 offset0:0 offset1:1
    ds_write2_b32 v5, v156, v158 offset0:64 offset1:65
    s_waitcnt lgkmcnt(0)
    s_barrier
    ds_read_b128 v[160:163], v7
    ds_read_b128 v[164:167], v7 offset:32
    ds_read_b128 v[168:171], v7 offset:64
    ds_read_b128 v[172:175], v7 offset:96
    ds_read_b128 v[144:147], v20
    ds_read_b128 v[148:151], v20 offset:1024
    ds_read_b128 v[152:155], v20 offset:2048
    ds_read_b128 v[156:159], v20 offset:3072
    s_lshl_b32 s96, s76, 6
    s_add_u32 s18, s96, 12288
    v_and_b32 v67, 7, v1
    v_lshl_add_u32 v67, v67, 2, s18
    v_lshrrev_b32 v9, 5, v1
    v_lshl_add_u32 v67, v9, 5, v67
    ds_read_b32 v64, v67
    ds_read_b32 v65, v67 offset:512
    ds_read_b32 v66, v67 offset:640
    ds_read_b32 v68, v67 offset:128
    ds_read_b32 v69, v67 offset:256
    ds_read_b32 v70, v67 offset:384
    ds_read_b32 v71, v67 offset:768
    s_add_u32 s96, s84, 1048576
    s_and_b32 s97, s96, 1048575
    s_lshl_b32 s98, s83, 16
    s_xor_b32 s99, s97, s98
    s_xor_b32 s96, s88, 1048576
    s_add_u32 s19, s99, s96
    s_add_u32 m0, s89, 98304
    s_nop 0
    buffer_load_dwordx4 v74, s[44:47], s19 offen lds
    s_add_u32 s96, s84, 1703936
    s_and_b32 s97, s96, 1048575
    s_lshl_b32 s98, s83, 16
    s_xor_b32 s99, s97, s98
    s_xor_b32 s96, s88, 1048576
    s_add_u32 s19, s99, s96
    s_add_u32 m0, s89, 139264
    s_nop 0
    buffer_load_dwordx4 v74, s[44:47], s19 offen lds
    s_add_u32 s96, s84, 1835008
    s_and_b32 s97, s96, 1048575
    s_lshl_b32 s98, s83, 16
    s_xor_b32 s99, s97, s98
    s_xor_b32 s96, s88, 1048576
    s_add_u32 s19, s99, s96
    s_add_u32 m0, s89, 147456
    s_nop 0
    buffer_load_dwordx4 v74, s[44:47], s19 offen lds
    s_and_b32 s96, s3, 3
    s_lshl2_add_u32 s97, s10, s96
    s_lshl4_add_u32 s98, s97, s11
    s_lshl1_add_u32 s99, s98, s76
    s_lshl_b32 s96, s99, 11
    s_add_u32 s13, s96, 8388608
    v_and_b32 v8, 15, v1
    v_lshlrev_b32 v8, 4, v8
    v_bfe_u32 v9, v1, 4, 1
    v_lshl_add_u32 v8, v9, 10, v8
    v_lshrrev_b32 v9, 5, v1
    v_lshl_add_u32 v8, v9, 8, v8
    s_waitcnt lgkmcnt(14)
    v_mfma_f32_32x32x16_bf16 v[128:143], v[160:163], v[80:83], 0
    s_waitcnt lgkmcnt(13)
    v_mfma_f32_32x32x16_bf16 v[128:143], v[164:167], v[84:87], v[128:143]
    s_waitcnt lgkmcnt(12)
    v_mfma_f32_32x32x16_bf16 v[128:143], v[168:171], v[88:91], v[128:143]
    s_waitcnt lgkmcnt(11)
    v_mfma_f32_32x32x16_bf16 v[128:143], v[172:175], v[92:95], v[128:143]
    s_waitcnt lgkmcnt(10)
    v_mfma_f32_32x32x16_bf16 v[112:127], v[144:147], v[80:83], 0
    s_waitcnt lgkmcnt(9)
    v_mfma_f32_32x32x16_bf16 v[112:127], v[148:151], v[84:87], v[112:127]
    s_waitcnt lgkmcnt(8)
    v_mfma_f32_32x32x16_bf16 v[112:127], v[152:155], v[88:91], v[112:127]
    s_waitcnt lgkmcnt(7)
    v_mfma_f32_32x32x16_bf16 v[112:127], v[156:159], v[92:95], v[112:127]
    s_nop 3
    v_cvt_pk_bf16_f32 v128, 0, v128
    v_add_f32 v128, 0x358637bd, v128
    v_cvt_pk_bf16_f32 v128, 0, v128
    v_rcp_f32 v128, v128
    s_nop 3
    v_cvt_pk_bf16_f32 v112, 0, v112
    v_cvt_pk_bf16_f32 v113, 0, v113
    v_cvt_pk_bf16_f32 v114, 0, v114
    v_cvt_pk_bf16_f32 v115, 0, v115
    v_cvt_pk_bf16_f32 v116, 0, v116
    v_cvt_pk_bf16_f32 v117, 0, v117
    v_cvt_pk_bf16_f32 v118, 0, v118
    v_cvt_pk_bf16_f32 v119, 0, v119
    v_pk_mul_f32 v[112:113], v[112:113], v[128:129] op_sel_hi:[1,0]
    v_pk_mul_f32 v[114:115], v[114:115], v[128:129] op_sel_hi:[1,0]
    v_pk_mul_f32 v[116:117], v[116:117], v[128:129] op_sel_hi:[1,0]
    v_pk_mul_f32 v[118:119], v[118:119], v[128:129] op_sel_hi:[1,0]
    v_cvt_pk_bf16_f32 v44, v112, v113
    v_cvt_pk_bf16_f32 v45, v114, v115
    v_cvt_pk_bf16_f32 v46, v116, v117
    v_cvt_pk_bf16_f32 v47, v118, v119
    buffer_store_dwordx4 v[44:47], v8, s[32:35], s13 offen sc1
    v_cvt_pk_bf16_f32 v120, 0, v120
    v_cvt_pk_bf16_f32 v121, 0, v121
    v_cvt_pk_bf16_f32 v122, 0, v122
    v_cvt_pk_bf16_f32 v123, 0, v123
    v_cvt_pk_bf16_f32 v124, 0, v124
    v_cvt_pk_bf16_f32 v125, 0, v125
    v_cvt_pk_bf16_f32 v126, 0, v126
    v_cvt_pk_bf16_f32 v127, 0, v127
    v_pk_mul_f32 v[120:121], v[120:121], v[128:129] op_sel_hi:[1,0]
    v_pk_mul_f32 v[122:123], v[122:123], v[128:129] op_sel_hi:[1,0]
    v_pk_mul_f32 v[124:125], v[124:125], v[128:129] op_sel_hi:[1,0]
    v_pk_mul_f32 v[126:127], v[126:127], v[128:129] op_sel_hi:[1,0]
    v_cvt_pk_bf16_f32 v48, v120, v121
    v_cvt_pk_bf16_f32 v49, v122, v123
    v_cvt_pk_bf16_f32 v50, v124, v125
    v_cvt_pk_bf16_f32 v51, v126, v127
    buffer_store_dwordx4 v[48:51], v8, s[32:35], s13 offen offset:512 sc1
    s_mul_i32 s96, s76, 65600
    s_add_u32 s17, s96, 32768
    v_lshrrev_b32 v20, 5, v1
    v_lshlrev_b32 v20, 11, v20
    v_bfe_u32 v9, v1, 4, 1
    v_lshl_add_u32 v20, v9, 9, v20
    v_bfe_u32 v9, v1, 2, 2
    v_lshl_add_u32 v20, v9, 7, v20
    v_bfe_u32 v9, v1, 3, 1
    v_lshl_add_u32 v20, v9, 6, v20
    v_bfe_u32 v9, v1, 1, 1
    v_lshl_add_u32 v20, v9, 5, v20
    v_bfe_u32 v9, v1, 4, 1
    v_lshl_add_u32 v20, v9, 4, v20
    v_and_b32 v9, 1, v1
    v_lshl_add_u32 v20, v9, 3, v20
    v_xor_b32 v20, s17, v20
    v_xor_b32 v21, 16, v20
    v_xor_b32 v22, 64, v20
    v_xor_b32 v23, 80, v20
    v_and_b32 v5, 7, v1
    v_lshlrev_b32 v5, 15, v5
    v_bfe_u32 v9, v1, 3, 1
    v_lshl_add_u32 v5, v9, 12, v5
    s_lshr_b32 s96, s11, 2
    s_xor_b32 s97, s96, 1
    s_and_b32 s98, s97, 1
    s_lshr_b32 s99, s10, 2
    s_and_b32 s96, s10, 3
    s_lshl_b32 s97, s96, 6
    s_lshl1_add_u32 s96, s99, s97
    s_lshl_b32 s99, s96, 12
    s_lshr_b32 s97, s11, 3
    s_and_b32 s96, s11, 3
    s_lshl2_add_u32 s97, s97, s96
    s_lshl_b32 s96, s97, 6
    s_add_u32 s97, s99, s96
    s_lshl2_add_u32 s99, s98, s97
    s_add_u32 s96, s99, 1048576
    s_add_u32 s15, s96, 1024
    v_mov_b32 v52, 0x10000
    v_mov_b32 v53, s6
    v_lshlrev_b32 v28, 16, v12
    v_and_b32 v29, s6, v12
    v_lshlrev_b32 v30, 16, v13
    v_and_b32 v31, s6, v13
    v_lshlrev_b32 v32, 16, v14
    v_and_b32 v33, s6, v14
    v_lshlrev_b32 v34, 16, v15
    v_and_b32 v35, s6, v15
    v_lshlrev_b32 v36, 16, v16
    v_and_b32 v37, s6, v16
    v_lshlrev_b32 v38, 16, v17
    v_and_b32 v39, s6, v17
    v_lshlrev_b32 v40, 16, v18
    v_and_b32 v41, s6, v18
    v_lshlrev_b32 v42, 16, v19
    v_and_b32 v43, s6, v19
    s_waitcnt lgkmcnt(0)
    v_mul_u32_u24_dpp v76, v64, v52 row_newbcast:0 row_mask:0xf bank_mask:0xf
    v_and_b32_dpp v77, v64, v53 row_newbcast:0 row_mask:0xf bank_mask:0xf
    v_mul_u32_u24_dpp v78, v64, v52 row_newbcast:1 row_mask:0xf bank_mask:0xf
    v_and_b32_dpp v79, v64, v53 row_newbcast:1 row_mask:0xf bank_mask:0xf
    v_mul_u32_u24_dpp v80, v64, v52 row_newbcast:2 row_mask:0xf bank_mask:0xf
    v_and_b32_dpp v81, v64, v53 row_newbcast:2 row_mask:0xf bank_mask:0xf
    v_mul_u32_u24_dpp v82, v64, v52 row_newbcast:3 row_mask:0xf bank_mask:0xf
    v_and_b32_dpp v83, v64, v53 row_newbcast:3 row_mask:0xf bank_mask:0xf
    v_mul_u32_u24_dpp v84, v64, v52 row_newbcast:4 row_mask:0xf bank_mask:0xf
    v_and_b32_dpp v85, v64, v53 row_newbcast:4 row_mask:0xf bank_mask:0xf
    v_mul_u32_u24_dpp v86, v64, v52 row_newbcast:5 row_mask:0xf bank_mask:0xf
    v_and_b32_dpp v87, v64, v53 row_newbcast:5 row_mask:0xf bank_mask:0xf
    v_mul_u32_u24_dpp v88, v64, v52 row_newbcast:6 row_mask:0xf bank_mask:0xf
    v_and_b32_dpp v89, v64, v53 row_newbcast:6 row_mask:0xf bank_mask:0xf
    v_mul_u32_u24_dpp v90, v64, v52 row_newbcast:7 row_mask:0xf bank_mask:0xf
    v_and_b32_dpp v91, v64, v53 row_newbcast:7 row_mask:0xf bank_mask:0xf
    s_lshl1_add_u32 s96, s94, s77
    s_lshl_b32 s97, s96, 15
    s_add_u32 s19, s97, 8388608
    v_and_b32 v25, 15, v1
    v_lshlrev_b32 v25, 3, v25
    s_waitcnt vmcnt(0)
    s_waitcnt lgkmcnt(0)
    s_barrier
    s_cmp_lg_u32 s3, 0
    s_cbranch_scc1 L_PD
    v_mov_b32 v6, s4
    s_mov_b32 exec_hi, 0
    s_mov_b32 exec_lo, 65535
    buffer_store_dword v6, v5, s[32:35], s15 offen sc1
    s_mov_b64 exec, -1
L_PD:
    s_add_u32 s96, s84, 1966080
    s_and_b32 s97, s96, 1048575
    s_lshl_b32 s98, s83, 16
    s_xor_b32 s99, s97, s98
    s_xor_b32 s96, s88, 1048576
    s_add_u32 s13, s99, s96
    s_add_u32 m0, s89, 155648
    s_nop 0
    buffer_load_dwordx4 v74, s[44:47], s13 offen lds
    s_and_b32 s96, s84, 1048575
    s_lshl_b32 s97, s83, 16
    s_xor_b32 s98, s96, s97
    s_add_u32 s13, s98, s88
    s_add_u32 m0, s89, 32768
    s_nop 0
    buffer_load_dwordx4 v74, s[44:47], s13 offen lds
    s_add_u32 s96, s84, 131072
    s_and_b32 s97, s96, 1048575
    s_lshl_b32 s98, s83, 16
    s_xor_b32 s99, s97, s98
    s_add_u32 s13, s99, s88
    s_add_u32 m0, s89, 40960
    s_nop 0
    buffer_load_dwordx4 v74, s[44:47], s13 offen lds
    s_load_dwordx2 s[24:25], s[32:33], s92 offset:1024 glc
    v_mov_b32_dpp v92, v65 row_newbcast:0 row_mask:0xf bank_mask:0xf
    v_mov_b32_dpp v93, v65 row_newbcast:1 row_mask:0xf bank_mask:0xf
    v_mov_b32_dpp v94, v65 row_newbcast:2 row_mask:0xf bank_mask:0xf
    v_mov_b32_dpp v95, v65 row_newbcast:3 row_mask:0xf bank_mask:0xf
    v_mov_b32_dpp v96, v65 row_newbcast:4 row_mask:0xf bank_mask:0xf
    v_mov_b32_dpp v97, v65 row_newbcast:5 row_mask:0xf bank_mask:0xf
    v_mov_b32_dpp v98, v65 row_newbcast:6 row_mask:0xf bank_mask:0xf
    v_mov_b32_dpp v99, v65 row_newbcast:7 row_mask:0xf bank_mask:0xf
    v_mov_b32_dpp v100, v66 row_newbcast:0 row_mask:0xf bank_mask:0xf
    v_mov_b32_dpp v101, v66 row_newbcast:1 row_mask:0xf bank_mask:0xf
    v_mov_b32_dpp v102, v66 row_newbcast:2 row_mask:0xf bank_mask:0xf
    v_mov_b32_dpp v103, v66 row_newbcast:3 row_mask:0xf bank_mask:0xf
    v_mov_b32_dpp v104, v66 row_newbcast:4 row_mask:0xf bank_mask:0xf
    v_mov_b32_dpp v105, v66 row_newbcast:5 row_mask:0xf bank_mask:0xf
    v_mov_b32_dpp v106, v66 row_newbcast:6 row_mask:0xf bank_mask:0xf
    v_mov_b32_dpp v107, v66 row_newbcast:7 row_mask:0xf bank_mask:0xf
    v_and_b32 v4, 3, v1
    v_cmp_eq_u32 vcc, 1, v4
    v_cmp_eq_u32 s[22:23], 0, v4
    v_mov_b32 v5, 0x3f803f80
    v_cndmask_b32 v92, v100, v92, vcc
    v_cndmask_b32 v93, v101, v93, vcc
    v_cndmask_b32 v94, v102, v94, vcc
    v_cndmask_b32 v95, v103, v95, vcc
    v_cndmask_b32 v96, v104, v96, vcc
    v_cndmask_b32 v97, v105, v97, vcc
    v_cndmask_b32 v98, v106, v98, vcc
    v_cndmask_b32 v99, v107, v99, vcc
    v_cndmask_b32 v92, v92, v5, s[22:23]
    v_cndmask_b32 v93, v93, v5, s[22:23]
    v_cndmask_b32 v94, v94, v5, s[22:23]
    v_cndmask_b32 v95, v95, v5, s[22:23]
    v_cndmask_b32 v96, v96, v5, s[22:23]
    v_cndmask_b32 v97, v97, v5, s[22:23]
    v_cndmask_b32 v98, v98, v5, s[22:23]
    v_cndmask_b32 v99, v99, v5, s[22:23]
    s_waitcnt vmcnt(0)
    s_branch SCHK_30
SPOLL_29:
    s_load_dwordx2 s[24:25], s[32:33], s92 offset:1024 glc
SCHK_30:
    s_add_u32 s5, s5, 1
    s_cmp_ge_u32 s5, 300000
    s_waitcnt lgkmcnt(0)
    s_cbranch_scc1 SDONE_31
    s_cmp_lg_u32 s24, s4
    s_cbranch_scc1 SPOLL_29
SDONE_31:
    s_barrier
    s_cmp_lt_u32 s3, 4
    s_cbranch_scc1 L_P2
    s_setprio 1
L_P2:
    s_lshl_b32 s96, s21, 7
    s_add_u32 s18, s96, 65536
    s_lshl_b32 s96, s83, 11
    s_add_u32 s20, s96, s19
    buffer_load_dwordx4 v[140:143], v2, s[32:35], s20 offen sc1
    buffer_load_dwordx4 v[144:147], v2, s[32:35], s20 offen offset:1024 sc1
    ds_read_b64_tr_b16 v[228:229], v22
    ds_read_b64_tr_b16 v[230:231], v22 offset:1024
    ds_read_b64_tr_b16 v[232:233], v23
    ds_read_b64_tr_b16 v[234:235], v23 offset:1024
    ds_read_b64_tr_b16 v[236:237], v20
    ds_read_b64_tr_b16 v[238:239], v20 offset:1024
    ds_read_b64_tr_b16 v[240:241], v21
    ds_read_b64_tr_b16 v[242:243], v21 offset:1024
    s_xor_b32 s96, s83, 1
    s_lshl_b32 s97, s96, 11
    s_add_u32 s20, s97, s19
    buffer_load_dwordx4 v[148:151], v2, s[32:35], s20 offen sc1
    buffer_load_dwordx4 v[152:155], v2, s[32:35], s20 offen offset:1024 sc1
    s_xor_b32 s96, s83, 2
    s_lshl_b32 s97, s96, 11
    s_add_u32 s20, s97, s19
    buffer_load_dwordx4 v[156:159], v2, s[32:35], s20 offen sc1
    buffer_load_dwordx4 v[160:163], v2, s[32:35], s20 offen offset:1024 sc1
    s_waitcnt lgkmcnt(6)
    s_waitcnt vmcnt(5)
    v_mfma_f32_16x16x32_bf16 v[124:127], v[228:231], v[140:143], 0
    ds_read_b64_tr_b16 v[244:245], v22 offset:4096
    s_waitcnt vmcnt(4)
    v_mfma_f32_16x16x32_bf16 v[128:131], v[228:231], v[144:147], 0
    ds_read_b64_tr_b16 v[246:247], v22 offset:5120
    s_xor_b32 s96, s83, 3
    s_lshl_b32 s97, s96, 11
    s_add_u32 s20, s97, s19
    buffer_load_dwordx4 v[164:167], v2, s[32:35], s20 offen sc1
    s_waitcnt lgkmcnt(6)
    v_mfma_f32_16x16x32_bf16 v[132:135], v[232:235], v[140:143], 0
    ds_read_b64_tr_b16 v[228:229], v23 offset:4096
    v_mfma_f32_16x16x32_bf16 v[136:139], v[232:235], v[144:147], 0
    ds_read_b64_tr_b16 v[230:231], v23 offset:5120
    buffer_load_dwordx4 v[168:171], v2, s[32:35], s20 offen offset:1024 sc1
    s_waitcnt lgkmcnt(6)
    v_mfma_f32_16x16x32_bf16 v[108:111], v[236:239], v[140:143], 0
    ds_read_b64_tr_b16 v[232:233], v20 offset:4096
    v_mfma_f32_16x16x32_bf16 v[112:115], v[236:239], v[144:147], 0
    ds_read_b64_tr_b16 v[234:235], v20 offset:5120
    s_waitcnt lgkmcnt(6)
    v_mfma_f32_16x16x32_bf16 v[116:119], v[240:243], v[140:143], 0
    ds_read_b64_tr_b16 v[236:237], v21 offset:4096
    v_mfma_f32_16x16x32_bf16 v[120:123], v[240:243], v[144:147], 0
    ds_read_b64_tr_b16 v[238:239], v21 offset:5120
    s_waitcnt lgkmcnt(6)
    s_waitcnt vmcnt(4)
    v_mfma_f32_16x16x32_bf16 v[124:127], v[244:247], v[148:151], v[124:127]
    ds_read_b64_tr_b16 v[240:241], v22 offset:8192
    v_mfma_f32_16x16x32_bf16 v[128:131], v[244:247], v[152:155], v[128:131]
    ds_read_b64_tr_b16 v[242:243], v22 offset:9216
    s_xor_b32 s96, s83, 4
    s_lshl_b32 s97, s96, 11
    s_add_u32 s20, s97, s19
    buffer_load_dwordx4 v[140:143], v2, s[32:35], s20 offen sc1
    s_waitcnt lgkmcnt(6)
    v_mfma_f32_16x16x32_bf16 v[132:135], v[228:231], v[148:151], v[132:135]
    ds_read_b64_tr_b16 v[244:245], v23 offset:8192
    v_mfma_f32_16x16x32_bf16 v[136:139], v[228:231], v[152:155], v[136:139]
    ds_read_b64_tr_b16 v[246:247], v23 offset:9216
    buffer_load_dwordx4 v[144:147], v2, s[32:35], s20 offen offset:1024 sc1
    s_waitcnt lgkmcnt(6)
    v_mfma_f32_16x16x32_bf16 v[108:111], v[232:235], v[148:151], v[108:111]
    ds_read_b64_tr_b16 v[228:229], v20 offset:8192
    v_mfma_f32_16x16x32_bf16 v[112:115], v[232:235], v[152:155], v[112:115]
    ds_read_b64_tr_b16 v[230:231], v20 offset:9216
    s_waitcnt lgkmcnt(6)
    v_mfma_f32_16x16x32_bf16 v[116:119], v[236:239], v[148:151], v[116:119]
    ds_read_b64_tr_b16 v[232:233], v21 offset:8192
    v_mfma_f32_16x16x32_bf16 v[120:123], v[236:239], v[152:155], v[120:123]
    ds_read_b64_tr_b16 v[234:235], v21 offset:9216
    s_waitcnt lgkmcnt(6)
    s_waitcnt vmcnt(4)
    v_mfma_f32_16x16x32_bf16 v[124:127], v[240:243], v[156:159], v[124:127]
    ds_read_b64_tr_b16 v[236:237], v22 offset:12288
    v_mfma_f32_16x16x32_bf16 v[128:131], v[240:243], v[160:163], v[128:131]
    ds_read_b64_tr_b16 v[238:239], v22 offset:13312
    s_xor_b32 s96, s83, 5
    s_lshl_b32 s97, s96, 11
    s_add_u32 s20, s97, s19
    buffer_load_dwordx4 v[148:151], v2, s[32:35], s20 offen sc1
    s_waitcnt lgkmcnt(6)
    v_mfma_f32_16x16x32_bf16 v[132:135], v[244:247], v[156:159], v[132:135]
    ds_read_b64_tr_b16 v[240:241], v23 offset:12288
    v_mfma_f32_16x16x32_bf16 v[136:139], v[244:247], v[160:163], v[136:139]
    ds_read_b64_tr_b16 v[242:243], v23 offset:13312
    buffer_load_dwordx4 v[152:155], v2, s[32:35], s20 offen offset:1024 sc1
    s_waitcnt lgkmcnt(6)
    v_mfma_f32_16x16x32_bf16 v[108:111], v[228:231], v[156:159], v[108:111]
    ds_read_b64_tr_b16 v[244:245], v20 offset:12288
    v_mfma_f32_16x16x32_bf16 v[112:115], v[228:231], v[160:163], v[112:115]
    ds_read_b64_tr_b16 v[246:247], v20 offset:13312
    s_waitcnt lgkmcnt(6)
    v_mfma_f32_16x16x32_bf16 v[116:119], v[232:235], v[156:159], v[116:119]
    ds_read_b64_tr_b16 v[228:229], v21 offset:12288
    v_mfma_f32_16x16x32_bf16 v[120:123], v[232:235], v[160:163], v[120:123]
    ds_read_b64_tr_b16 v[230:231], v21 offset:13312
    s_waitcnt lgkmcnt(6)
    s_waitcnt vmcnt(4)
    v_mfma_f32_16x16x32_bf16 v[124:127], v[236:239], v[164:167], v[124:127]
    ds_read_b64_tr_b16 v[232:233], v22 offset:16384
    v_mfma_f32_16x16x32_bf16 v[128:131], v[236:239], v[168:171], v[128:131]
    ds_read_b64_tr_b16 v[234:235], v22 offset:17408
    s_xor_b32 s96, s83, 6
    s_lshl_b32 s97, s96, 11
    s_add_u32 s20, s97, s19
    buffer_load_dwordx4 v[156:159], v2, s[32:35], s20 offen sc1
    s_waitcnt lgkmcnt(6)
    v_mfma_f32_16x16x32_bf16 v[132:135], v[240:243], v[164:167], v[132:135]
    ds_read_b64_tr_b16 v[236:237], v23 offset:16384
    v_mfma_f32_16x16x32_bf16 v[136:139], v[240:243], v[168:171], v[136:139]
    ds_read_b64_tr_b16 v[238:239], v23 offset:17408
    buffer_load_dwordx4 v[160:163], v2, s[32:35], s20 offen offset:1024 sc1
    s_waitcnt lgkmcnt(6)
    v_mfma_f32_16x16x32_bf16 v[108:111], v[244:247], v[164:167], v[108:111]
    ds_read_b64_tr_b16 v[240:241], v20 offset:16384
    v_mfma_f32_16x16x32_bf16 v[112:115], v[244:247], v[168:171], v[112:115]
    ds_read_b64_tr_b16 v[242:243], v20 offset:17408
    s_waitcnt lgkmcnt(6)
    v_mfma_f32_16x16x32_bf16 v[116:119], v[228:231], v[164:167], v[116:119]
    ds_read_b64_tr_b16 v[244:245], v21 offset:16384
    v_mfma_f32_16x16x32_bf16 v[120:123], v[228:231], v[168:171], v[120:123]
    ds_read_b64_tr_b16 v[246:247], v21 offset:17408
    s_waitcnt lgkmcnt(6)
    s_waitcnt vmcnt(4)
    v_mfma_f32_16x16x32_bf16 v[124:127], v[232:235], v[140:143], v[124:127]
    ds_read_b64_tr_b16 v[228:229], v22 offset:20480
    v_mfma_f32_16x16x32_bf16 v[128:131], v[232:235], v[144:147], v[128:131]
    ds_read_b64_tr_b16 v[230:231], v22 offset:21504
    s_xor_b32 s96, s83, 7
    s_lshl_b32 s97, s96, 11
    s_add_u32 s20, s97, s19
    buffer_load_dwordx4 v[164:167], v2, s[32:35], s20 offen sc1
    s_waitcnt lgkmcnt(6)
    v_mfma_f32_16x16x32_bf16 v[132:135], v[236:239], v[140:143], v[132:135]
    ds_read_b64_tr_b16 v[232:233], v23 offset:20480
    v_mfma_f32_16x16x32_bf16 v[136:139], v[236:239], v[144:147], v[136:139]
    ds_read_b64_tr_b16 v[234:235], v23 offset:21504
    buffer_load_dwordx4 v[168:171], v2, s[32:35], s20 offen offset:1024 sc1
    s_waitcnt lgkmcnt(6)
    v_mfma_f32_16x16x32_bf16 v[108:111], v[240:243], v[140:143], v[108:111]
    ds_read_b64_tr_b16 v[236:237], v20 offset:20480
    v_mfma_f32_16x16x32_bf16 v[112:115], v[240:243], v[144:147], v[112:115]
    ds_read_b64_tr_b16 v[238:239], v20 offset:21504
    s_setprio 0
    s_waitcnt lgkmcnt(6)
    v_mfma_f32_16x16x32_bf16 v[116:119], v[244:247], v[140:143], v[116:119]
    ds_read_b64_tr_b16 v[240:241], v21 offset:20480
    v_mfma_f32_16x16x32_bf16 v[120:123], v[244:247], v[144:147], v[120:123]
    ds_read_b64_tr_b16 v[242:243], v21 offset:21504
    s_waitcnt lgkmcnt(6)
    s_waitcnt vmcnt(4)
    v_mfma_f32_16x16x32_bf16 v[124:127], v[228:231], v[148:151], v[124:127]
    ds_read_b64_tr_b16 v[244:245], v22 offset:24576
    v_mfma_f32_16x16x32_bf16 v[128:131], v[228:231], v[152:155], v[128:131]
    ds_read_b64_tr_b16 v[246:247], v22 offset:25600
    s_cmp_eq_u32 s25, s4
    s_cbranch_scc1 L_D2
SPOLL_32:
    s_load_dwordx2 s[24:25], s[32:33], s92 offset:1024 glc
SCHK_33:
    s_add_u32 s5, s5, 1
    s_cmp_ge_u32 s5, 300000
    s_waitcnt lgkmcnt(0)
    s_cbranch_scc1 SDONE_34
    s_cmp_lg_u32 s25, s4
    s_cbranch_scc1 SPOLL_32
SDONE_34:
L_D2:
    s_barrier
    s_xor_b32 s96, s83, 8
    s_lshl_b32 s97, s96, 11
    s_add_u32 s20, s97, s19
    buffer_load_dwordx4 v[140:143], v2, s[32:35], s20 offen sc1
    s_waitcnt lgkmcnt(6)
    v_mfma_f32_16x16x32_bf16 v[132:135], v[232:235], v[148:151], v[132:135]
    ds_read_b64_tr_b16 v[228:229], v23 offset:24576
    v_mfma_f32_16x16x32_bf16 v[136:139], v[232:235], v[152:155], v[136:139]
    ds_read_b64_tr_b16 v[230:231], v23 offset:25600
    buffer_load_dwordx4 v[144:147], v2, s[32:35], s20 offen offset:1024 sc1
    s_waitcnt lgkmcnt(6)
    v_mfma_f32_16x16x32_bf16 v[108:111], v[236:239], v[148:151], v[108:111]
    ds_read_b64_tr_b16 v[232:233], v20 offset:24576
    v_mfma_f32_16x16x32_bf16 v[112:115], v[236:239], v[152:155], v[112:115]
    ds_read_b64_tr_b16 v[234:235], v20 offset:25600
    s_waitcnt lgkmcnt(6)
    v_mfma_f32_16x16x32_bf16 v[116:119], v[240:243], v[148:151], v[116:119]
    ds_read_b64_tr_b16 v[236:237], v21 offset:24576
    v_mfma_f32_16x16x32_bf16 v[120:123], v[240:243], v[152:155], v[120:123]
    ds_read_b64_tr_b16 v[238:239], v21 offset:25600
    s_waitcnt lgkmcnt(6)
    s_waitcnt vmcnt(4)
    v_mfma_f32_16x16x32_bf16 v[124:127], v[244:247], v[156:159], v[124:127]
    ds_read_b64_tr_b16 v[240:241], v22 offset:28672
    v_mfma_f32_16x16x32_bf16 v[128:131], v[244:247], v[160:163], v[128:131]
    ds_read_b64_tr_b16 v[242:243], v22 offset:29696
    s_xor_b32 s96, s83, 9
    s_lshl_b32 s97, s96, 11
    s_add_u32 s20, s97, s19
    buffer_load_dwordx4 v[148:151], v2, s[32:35], s20 offen sc1
    s_waitcnt lgkmcnt(6)
    v_mfma_f32_16x16x32_bf16 v[132:135], v[228:231], v[156:159], v[132:135]
    ds_read_b64_tr_b16 v[244:245], v23 offset:28672
    v_mfma_f32_16x16x32_bf16 v[136:139], v[228:231], v[160:163], v[136:139]
    ds_read_b64_tr_b16 v[246:247], v23 offset:29696
    buffer_load_dwordx4 v[152:155], v2, s[32:35], s20 offen offset:1024 sc1
    s_waitcnt lgkmcnt(6)
    v_mfma_f32_16x16x32_bf16 v[108:111], v[232:235], v[156:159], v[108:111]
    ds_read_b64_tr_b16 v[228:229], v20 offset:28672
    v_mfma_f32_16x16x32_bf16 v[112:115], v[232:235], v[160:163], v[112:115]
    ds_read_b64_tr_b16 v[230:231], v20 offset:29696
    s_waitcnt lgkmcnt(6)
    v_mfma_f32_16x16x32_bf16 v[116:119], v[236:239], v[156:159], v[116:119]
    ds_read_b64_tr_b16 v[232:233], v21 offset:28672
    v_mfma_f32_16x16x32_bf16 v[120:123], v[236:239], v[160:163], v[120:123]
    ds_read_b64_tr_b16 v[234:235], v21 offset:29696
    s_waitcnt lgkmcnt(6)
    s_waitcnt vmcnt(4)
    v_mfma_f32_16x16x32_bf16 v[124:127], v[240:243], v[164:167], v[124:127]
    ds_read_b64_tr_b16 v[236:237], v22 offset:32768
    v_mfma_f32_16x16x32_bf16 v[128:131], v[240:243], v[168:171], v[128:131]
    ds_read_b64_tr_b16 v[238:239], v22 offset:33792
    s_xor_b32 s96, s83, 10
    s_lshl_b32 s97, s96, 11
    s_add_u32 s20, s97, s19
    buffer_load_dwordx4 v[156:159], v2, s[32:35], s20 offen sc1
    s_waitcnt lgkmcnt(6)
    v_mfma_f32_16x16x32_bf16 v[132:135], v[244:247], v[164:167], v[132:135]
    ds_read_b64_tr_b16 v[240:241], v23 offset:32768
    v_mfma_f32_16x16x32_bf16 v[136:139], v[244:247], v[168:171], v[136:139]
    ds_read_b64_tr_b16 v[242:243], v23 offset:33792
    buffer_load_dwordx4 v[160:163], v2, s[32:35], s20 offen offset:1024 sc1
    s_waitcnt lgkmcnt(6)
    v_mfma_f32_16x16x32_bf16 v[108:111], v[228:231], v[164:167], v[108:111]
    ds_read_b64_tr_b16 v[244:245], v20 offset:32768
    v_mfma_f32_16x16x32_bf16 v[112:115], v[228:231], v[168:171], v[112:115]
    ds_read_b64_tr_b16 v[246:247], v20 offset:33792
    s_waitcnt lgkmcnt(6)
    v_mfma_f32_16x16x32_bf16 v[116:119], v[232:235], v[164:167], v[116:119]
    ds_read_b64_tr_b16 v[228:229], v21 offset:32768
    v_mfma_f32_16x16x32_bf16 v[120:123], v[232:235], v[168:171], v[120:123]
    ds_read_b64_tr_b16 v[230:231], v21 offset:33792
    s_waitcnt lgkmcnt(6)
    s_waitcnt vmcnt(4)
    v_mfma_f32_16x16x32_bf16 v[124:127], v[236:239], v[140:143], v[124:127]
    ds_read_b64_tr_b16 v[232:233], v22 offset:36864
    v_mfma_f32_16x16x32_bf16 v[128:131], v[236:239], v[144:147], v[128:131]
    ds_read_b64_tr_b16 v[234:235], v22 offset:37888
    s_xor_b32 s96, s83, 11
    s_lshl_b32 s97, s96, 11
    s_add_u32 s20, s97, s19
    buffer_load_dwordx4 v[164:167], v2, s[32:35], s20 offen sc1
    s_waitcnt lgkmcnt(6)
    v_mfma_f32_16x16x32_bf16 v[132:135], v[240:243], v[140:143], v[132:135]
    ds_read_b64_tr_b16 v[236:237], v23 offset:36864
    v_mfma_f32_16x16x32_bf16 v[136:139], v[240:243], v[144:147], v[136:139]
    ds_read_b64_tr_b16 v[238:239], v23 offset:37888
    buffer_load_dwordx4 v[168:171], v2, s[32:35], s20 offen offset:1024 sc1
    s_waitcnt lgkmcnt(6)
    v_mfma_f32_16x16x32_bf16 v[108:111], v[244:247], v[140:143], v[108:111]
    ds_read_b64_tr_b16 v[240:241], v20 offset:36864
    v_mfma_f32_16x16x32_bf16 v[112:115], v[244:247], v[144:147], v[112:115]
    ds_read_b64_tr_b16 v[242:243], v20 offset:37888
    s_waitcnt lgkmcnt(6)
    v_mfma_f32_16x16x32_bf16 v[116:119], v[228:231], v[140:143], v[116:119]
    ds_read_b64_tr_b16 v[244:245], v21 offset:36864
    v_mfma_f32_16x16x32_bf16 v[120:123], v[228:231], v[144:147], v[120:123]
    ds_read_b64_tr_b16 v[246:247], v21 offset:37888
    s_waitcnt lgkmcnt(6)
    s_waitcnt vmcnt(4)
    v_mfma_f32_16x16x32_bf16 v[124:127], v[232:235], v[148:151], v[124:127]
    ds_read_b64_tr_b16 v[228:229], v22 offset:40960
    v_mfma_f32_16x16x32_bf16 v[128:131], v[232:235], v[152:155], v[128:131]
    ds_read_b64_tr_b16 v[230:231], v22 offset:41984
    s_xor_b32 s96, s83, 12
    s_lshl_b32 s97, s96, 11
    s_add_u32 s20, s97, s19
    buffer_load_dwordx4 v[140:143], v2, s[32:35], s20 offen sc1
    s_waitcnt lgkmcnt(6)
    v_mfma_f32_16x16x32_bf16 v[132:135], v[236:239], v[148:151], v[132:135]
    ds_read_b64_tr_b16 v[232:233], v23 offset:40960
    v_mfma_f32_16x16x32_bf16 v[136:139], v[236:239], v[152:155], v[136:139]
    ds_read_b64_tr_b16 v[234:235], v23 offset:41984
    buffer_load_dwordx4 v[144:147], v2, s[32:35], s20 offen offset:1024 sc1
    s_waitcnt lgkmcnt(6)
    v_mfma_f32_16x16x32_bf16 v[108:111], v[240:243], v[148:151], v[108:111]
    ds_read_b64_tr_b16 v[236:237], v20 offset:40960
    v_mfma_f32_16x16x32_bf16 v[112:115], v[240:243], v[152:155], v[112:115]
    ds_read_b64_tr_b16 v[238:239], v20 offset:41984
    s_waitcnt lgkmcnt(6)
    v_mfma_f32_16x16x32_bf16 v[116:119], v[244:247], v[148:151], v[116:119]
    ds_read_b64_tr_b16 v[240:241], v21 offset:40960
    v_mfma_f32_16x16x32_bf16 v[120:123], v[244:247], v[152:155], v[120:123]
    ds_read_b64_tr_b16 v[242:243], v21 offset:41984
    s_waitcnt lgkmcnt(6)
    s_waitcnt vmcnt(4)
    v_mfma_f32_16x16x32_bf16 v[124:127], v[228:231], v[156:159], v[124:127]
    ds_read_b64_tr_b16 v[244:245], v22 offset:45056
    v_mfma_f32_16x16x32_bf16 v[128:131], v[228:231], v[160:163], v[128:131]
    ds_read_b64_tr_b16 v[246:247], v22 offset:46080
    s_xor_b32 s96, s83, 13
    s_lshl_b32 s97, s96, 11
    s_add_u32 s20, s97, s19
    buffer_load_dwordx4 v[148:151], v2, s[32:35], s20 offen sc1
    s_waitcnt lgkmcnt(6)
    v_mfma_f32_16x16x32_bf16 v[132:135], v[232:235], v[156:159], v[132:135]
    ds_read_b64_tr_b16 v[228:229], v23 offset:45056
    v_mfma_f32_16x16x32_bf16 v[136:139], v[232:235], v[160:163], v[136:139]
    ds_read_b64_tr_b16 v[230:231], v23 offset:46080
    buffer_load_dwordx4 v[152:155], v2, s[32:35], s20 offen offset:1024 sc1
    s_waitcnt lgkmcnt(6)
    v_mfma_f32_16x16x32_bf16 v[108:111], v[236:239], v[156:159], v[108:111]
    ds_read_b64_tr_b16 v[232:233], v20 offset:45056
    v_mfma_f32_16x16x32_bf16 v[112:115], v[236:239], v[160:163], v[112:115]
    ds_read_b64_tr_b16 v[234:235], v20 offset:46080
    s_waitcnt lgkmcnt(6)
    v_mfma_f32_16x16x32_bf16 v[116:119], v[240:243], v[156:159], v[116:119]
    ds_read_b64_tr_b16 v[236:237], v21 offset:45056
    v_mfma_f32_16x16x32_bf16 v[120:123], v[240:243], v[160:163], v[120:123]
    ds_read_b64_tr_b16 v[238:239], v21 offset:46080
    s_waitcnt lgkmcnt(6)
    s_waitcnt vmcnt(4)
    v_mfma_f32_16x16x32_bf16 v[124:127], v[244:247], v[164:167], v[124:127]
    ds_read_b64_tr_b16 v[240:241], v22 offset:49152
    v_mfma_f32_16x16x32_bf16 v[128:131], v[244:247], v[168:171], v[128:131]
    ds_read_b64_tr_b16 v[242:243], v22 offset:50176
    s_xor_b32 s96, s83, 14
    s_lshl_b32 s97, s96, 11
    s_add_u32 s20, s97, s19
    buffer_load_dwordx4 v[156:159], v2, s[32:35], s20 offen sc1
    s_waitcnt lgkmcnt(6)
    v_mfma_f32_16x16x32_bf16 v[132:135], v[228:231], v[164:167], v[132:135]
    ds_read_b64_tr_b16 v[244:245], v23 offset:49152
    v_mfma_f32_16x16x32_bf16 v[136:139], v[228:231], v[168:171], v[136:139]
    ds_read_b64_tr_b16 v[246:247], v23 offset:50176
    buffer_load_dwordx4 v[160:163], v2, s[32:35], s20 offen offset:1024 sc1
    s_waitcnt lgkmcnt(6)
    v_mfma_f32_16x16x32_bf16 v[108:111], v[232:235], v[164:167], v[108:111]
    ds_read_b64_tr_b16 v[228:229], v20 offset:49152
    v_mfma_f32_16x16x32_bf16 v[112:115], v[232:235], v[168:171], v[112:115]
    ds_read_b64_tr_b16 v[230:231], v20 offset:50176
    s_waitcnt lgkmcnt(6)
    v_mfma_f32_16x16x32_bf16 v[116:119], v[236:239], v[164:167], v[116:119]
    ds_read_b64_tr_b16 v[232:233], v21 offset:49152
    v_mfma_f32_16x16x32_bf16 v[120:123], v[236:239], v[168:171], v[120:123]
    ds_read_b64_tr_b16 v[234:235], v21 offset:50176
    s_waitcnt lgkmcnt(6)
    s_waitcnt vmcnt(4)
    v_mfma_f32_16x16x32_bf16 v[124:127], v[240:243], v[140:143], v[124:127]
    ds_read_b64_tr_b16 v[236:237], v22 offset:53248
    v_mfma_f32_16x16x32_bf16 v[128:131], v[240:243], v[144:147], v[128:131]
    ds_read_b64_tr_b16 v[238:239], v22 offset:54272
    s_xor_b32 s96, s83, 15
    s_lshl_b32 s97, s96, 11
    s_add_u32 s20, s97, s19
    buffer_load_dwordx4 v[164:167], v2, s[32:35], s20 offen sc1
    s_waitcnt lgkmcnt(6)
    v_mfma_f32_16x16x32_bf16 v[132:135], v[244:247], v[140:143], v[132:135]
    ds_read_b64_tr_b16 v[240:241], v23 offset:53248
    v_mfma_f32_16x16x32_bf16 v[136:139], v[244:247], v[144:147], v[136:139]
    ds_read_b64_tr_b16 v[242:243], v23 offset:54272
    buffer_load_dwordx4 v[168:171], v2, s[32:35], s20 offen offset:1024 sc1
    buffer_load_dwordx2 v[26:27], v25, s[32:35], s18 offen sc1
    s_waitcnt lgkmcnt(6)
    v_mfma_f32_16x16x32_bf16 v[108:111], v[228:231], v[140:143], v[108:111]
    ds_read_b64_tr_b16 v[244:245], v20 offset:53248
    v_mfma_f32_16x16x32_bf16 v[112:115], v[228:231], v[144:147], v[112:115]
    ds_read_b64_tr_b16 v[246:247], v20 offset:54272
    s_waitcnt lgkmcnt(6)
    v_mfma_f32_16x16x32_bf16 v[116:119], v[232:235], v[140:143], v[116:119]
    ds_read_b64_tr_b16 v[228:229], v21 offset:53248
    v_mfma_f32_16x16x32_bf16 v[120:123], v[232:235], v[144:147], v[120:123]
    ds_read_b64_tr_b16 v[230:231], v21 offset:54272
    s_waitcnt lgkmcnt(6)
    s_waitcnt vmcnt(5)
    v_mfma_f32_16x16x32_bf16 v[124:127], v[236:239], v[148:151], v[124:127]
    ds_read_b64_tr_b16 v[232:233], v22 offset:57344
    v_mfma_f32_16x16x32_bf16 v[128:131], v[236:239], v[152:155], v[128:131]
    ds_read_b64_tr_b16 v[234:235], v22 offset:58368
    s_waitcnt lgkmcnt(6)
    v_mfma_f32_16x16x32_bf16 v[132:135], v[240:243], v[148:151], v[132:135]
    ds_read_b64_tr_b16 v[236:237], v23 offset:57344
    v_mfma_f32_16x16x32_bf16 v[136:139], v[240:243], v[152:155], v[136:139]
    ds_read_b64_tr_b16 v[238:239], v23 offset:58368
    s_waitcnt lgkmcnt(6)
    v_mfma_f32_16x16x32_bf16 v[108:111], v[244:247], v[148:151], v[108:111]
    ds_read_b64_tr_b16 v[240:241], v20 offset:57344
    v_mfma_f32_16x16x32_bf16 v[112:115], v[244:247], v[152:155], v[112:115]
    ds_read_b64_tr_b16 v[242:243], v20 offset:58368
    s_waitcnt lgkmcnt(6)
    v_mfma_f32_16x16x32_bf16 v[116:119], v[228:231], v[148:151], v[116:119]
    ds_read_b64_tr_b16 v[244:245], v21 offset:57344
    v_mfma_f32_16x16x32_bf16 v[120:123], v[228:231], v[152:155], v[120:123]
    ds_read_b64_tr_b16 v[246:247], v21 offset:58368
    s_waitcnt lgkmcnt(6)
    s_waitcnt vmcnt(3)
    v_mfma_f32_16x16x32_bf16 v[124:127], v[232:235], v[156:159], v[124:127]
    ds_read_b64_tr_b16 v[228:229], v22 offset:61440
    v_mfma_f32_16x16x32_bf16 v[128:131], v[232:235], v[160:163], v[128:131]
    ds_read_b64_tr_b16 v[230:231], v22 offset:62464
    s_waitcnt lgkmcnt(6)
    v_mfma_f32_16x16x32_bf16 v[132:135], v[236:239], v[156:159], v[132:135]
    ds_read_b64_tr_b16 v[232:233], v23 offset:61440
    v_mfma_f32_16x16x32_bf16 v[136:139], v[236:239], v[160:163], v[136:139]
    ds_read_b64_tr_b16 v[234:235], v23 offset:62464
    s_waitcnt lgkmcnt(6)
    v_mfma_f32_16x16x32_bf16 v[108:111], v[240:243], v[156:159], v[108:111]
    ds_read_b64_tr_b16 v[236:237], v20 offset:61440
    v_mfma_f32_16x16x32_bf16 v[112:115], v[240:243], v[160:163], v[112:115]
    ds_read_b64_tr_b16 v[238:239], v20 offset:62464
    s_waitcnt lgkmcnt(6)
    v_mfma_f32_16x16x32_bf16 v[116:119], v[244:247], v[156:159], v[116:119]
    ds_read_b64_tr_b16 v[240:241], v21 offset:61440
    v_mfma_f32_16x16x32_bf16 v[120:123], v[244:247], v[160:163], v[120:123]
    ds_read_b64_tr_b16 v[242:243], v21 offset:62464
    s_waitcnt lgkmcnt(6)
    s_waitcnt vmcnt(1)
    v_mfma_f32_16x16x32_bf16 v[124:127], v[228:231], v[164:167], v[124:127]
    v_mfma_f32_16x16x32_bf16 v[128:131], v[228:231], v[168:171], v[128:131]
    s_waitcnt lgkmcnt(4)
    v_mfma_f32_16x16x32_bf16 v[132:135], v[232:235], v[164:167], v[132:135]
    v_mfma_f32_16x16x32_bf16 v[136:139], v[232:235], v[168:171], v[136:139]
    s_waitcnt lgkmcnt(2)
    v_mfma_f32_16x16x32_bf16 v[108:111], v[236:239], v[164:167], v[108:111]
    v_mfma_f32_16x16x32_bf16 v[112:115], v[236:239], v[168:171], v[112:115]
    s_waitcnt lgkmcnt(0)
    v_mfma_f32_16x16x32_bf16 v[116:119], v[240:243], v[164:167], v[116:119]
    v_mfma_f32_16x16x32_bf16 v[120:123], v[240:243], v[168:171], v[120:123]
    s_setprio 0
    s_lshl_b32 s13, s3, 12
    v_add_u32 v4, s13, v2
    ds_write_b128 v4, v[124:127]
    ds_write_b128 v4, v[128:131] offset:1024
    ds_write_b128 v4, v[132:135] offset:2048
    ds_write_b128 v4, v[136:139] offset:3072
    v_permlane16_swap_b32 v108, v112
    v_permlane16_swap_b32 v109, v113
    v_permlane16_swap_b32 v110, v114
    v_permlane16_swap_b32 v111, v115
    v_permlane16_swap_b32 v116, v120
    v_permlane16_swap_b32 v117, v121
    v_permlane16_swap_b32 v118, v122
    v_permlane16_swap_b32 v119, v123
    s_xor_b32 s96, s3, 4
    s_lshl_b32 s13, s96, 12
    v_and_b32 v5, 15, v1
    v_lshl_add_u32 v5, v5, 4, s13
    v_bfe_u32 v9, v1, 4, 1
    v_lshl_add_u32 v5, v9, 10, v5
    v_lshrrev_b32 v9, 5, v1
    v_lshl_add_u32 v5, v9, 9, v5
    s_lshl_b32 s96, s76, 11
    s_and_b32 s97, s3, 3
    s_lshl_b32 s98, s97, 9
    s_add_u32 s99, s96, s98
    s_add_u32 s13, s99, 131072
    v_and_b32 v6, 31, v1
    v_lshl_add_u32 v6, v6, 4, s13
    v_lshrrev_b32 v9, 5, v1
    v_lshl_add_u32 v6, v9, 3, v6
    s_lshl_b32 s96, s76, 6
    s_add_u32 s13, s96, 139008
    v_and_b32 v7, 7, v1
    v_lshl_add_u32 v7, v7, 2, s13
    v_lshrrev_b32 v9, 5, v1
    v_lshl_add_u32 v7, v9, 5, v7
    s_lshl_b32 s96, s21, 15
    s_lshl_b32 s97, s3, 8
    s_add_u32 s98, s96, s97
    s_add_u32 s19, s98, 12582912
    v_and_b32 v44, 15, v1
    v_lshlrev_b32 v44, 4, v44
    v_lshrrev_b32 v9, 4, v1
    v_lshl_add_u32 v44, v9, 11, v44
    v_mov_b32 v232, 0x3f803f80
    s_waitcnt lgkmcnt(0)
    s_barrier
    ds_read_b128 v[124:127], v5
    ds_read_b128 v[128:131], v5 offset:256
    ds_read_b128 v[132:135], v5 offset:2048
    ds_read_b128 v[136:139], v5 offset:2304
    s_add_u32 s14, s80, 172032
    s_lshl2_add_u32 m0, s89, 35840
    s_nop 0
    buffer_load_dwordx4 v72, s[52:55], s14 offen nt lds
    s_lshl_b32 s96, s90, 7
    s_add_u32 s97, s96, s80
    s_add_u32 s14, s97, 172032
    s_lshl2_add_u32 m0, s89, 68608
    s_nop 0
    buffer_load_dwordx4 v72, s[56:59], s14 offen nt lds
    s_mov_b32 s14, s81
    s_lshl2_add_u32 m0, s89, 98304
    s_nop 0
    buffer_load_dwordx4 v73, s[60:63], s14 offen nt lds
    s_waitcnt lgkmcnt(3)
    v_pk_add_f32 v[108:109], v[108:109], v[124:125]
    v_pk_add_f32 v[110:111], v[110:111], v[126:127]
    s_waitcnt lgkmcnt(2)
    v_pk_add_f32 v[112:113], v[112:113], v[128:129]
    v_pk_add_f32 v[114:115], v[114:115], v[130:131]
    v_cvt_pk_bf16_f32 v108, 0, v108
    v_cvt_pk_bf16_f32 v109, 0, v109
    v_cvt_pk_bf16_f32 v110, 0, v110
    v_cvt_pk_bf16_f32 v111, 0, v111
    v_cvt_pk_bf16_f32 v112, 0, v112
    v_cvt_pk_bf16_f32 v113, 0, v113
    v_cvt_pk_bf16_f32 v114, 0, v114
    v_cvt_pk_bf16_f32 v115, 0, v115
    v_pk_mul_f32 v[108:109], v[108:109], v[76:77]
    v_pk_mul_f32 v[110:111], v[110:111], v[78:79]
    v_pk_mul_f32 v[112:113], v[112:113], v[80:81]
    v_pk_mul_f32 v[114:115], v[114:115], v[82:83]
    v_cvt_pk_bf16_f32 v108, 0, v108
    v_cvt_pk_bf16_f32 v109, 0, v109
    v_cvt_pk_bf16_f32 v110, 0, v110
    v_cvt_pk_bf16_f32 v111, 0, v111
    v_cvt_pk_bf16_f32 v112, 0, v112
    v_cvt_pk_bf16_f32 v113, 0, v113
    v_cvt_pk_bf16_f32 v114, 0, v114
    v_cvt_pk_bf16_f32 v115, 0, v115
    v_pk_add_f32 v[108:109], v[108:109], v[28:29]
    v_pk_add_f32 v[110:111], v[110:111], v[30:31]
    v_pk_add_f32 v[112:113], v[112:113], v[32:33]
    v_pk_add_f32 v[114:115], v[114:115], v[34:35]
    v_cvt_pk_bf16_f32 v12, v108, v109
    v_cvt_pk_bf16_f32 v13, v110, v111
    v_cvt_pk_bf16_f32 v14, v112, v113
    v_cvt_pk_bf16_f32 v15, v114, v115
    s_waitcnt lgkmcnt(1)
    v_pk_add_f32 v[116:117], v[116:117], v[132:133]
    v_pk_add_f32 v[118:119], v[118:119], v[134:135]
    s_waitcnt lgkmcnt(0)
    v_pk_add_f32 v[120:121], v[120:121], v[136:137]
    v_pk_add_f32 v[122:123], v[122:123], v[138:139]
    v_cvt_pk_bf16_f32 v116, 0, v116
    v_cvt_pk_bf16_f32 v117, 0, v117
    v_cvt_pk_bf16_f32 v118, 0, v118
    v_cvt_pk_bf16_f32 v119, 0, v119
    v_cvt_pk_bf16_f32 v120, 0, v120
    v_cvt_pk_bf16_f32 v121, 0, v121
    v_cvt_pk_bf16_f32 v122, 0, v122
    v_cvt_pk_bf16_f32 v123, 0, v123
    v_pk_mul_f32 v[116:117], v[116:117], v[84:85]
    v_pk_mul_f32 v[118:119], v[118:119], v[86:87]
    v_pk_mul_f32 v[120:121], v[120:121], v[88:89]
    v_pk_mul_f32 v[122:123], v[122:123], v[90:91]
    v_cvt_pk_bf16_f32 v116, 0, v116
    v_cvt_pk_bf16_f32 v117, 0, v117
    v_cvt_pk_bf16_f32 v118, 0, v118
    v_cvt_pk_bf16_f32 v119, 0, v119
    v_cvt_pk_bf16_f32 v120, 0, v120
    v_cvt_pk_bf16_f32 v121, 0, v121
    v_cvt_pk_bf16_f32 v122, 0, v122
    v_cvt_pk_bf16_f32 v123, 0, v123
    v_pk_add_f32 v[116:117], v[116:117], v[36:37]
    v_pk_add_f32 v[118:119], v[118:119], v[38:39]
    v_pk_add_f32 v[120:121], v[120:121], v[40:41]
    v_pk_add_f32 v[122:123], v[122:123], v[42:43]
    v_cvt_pk_bf16_f32 v16, v116, v117
    v_cvt_pk_bf16_f32 v17, v118, v119
    v_cvt_pk_bf16_f32 v18, v120, v121
    v_cvt_pk_bf16_f32 v19, v122, v123
    v_mfma_f32_32x32x16_bf16 v[124:139], v[92:95], v[12:15], 0
    s_nop 0
    v_mfma_f32_32x32x16_bf16 v[124:139], v[96:99], v[16:19], v[124:139]
    v_dot2_f32_bf16 v228, v12, v12, 0
    v_dot2_f32_bf16 v229, v13, v13, 0
    v_dot2_f32_bf16 v228, v14, v14, v228
    v_dot2_f32_bf16 v229, v15, v15, v229
    v_dot2_f32_bf16 v228, v16, v16, v228
    v_dot2_f32_bf16 v229, v17, v17, v229
    v_dot2_f32_bf16 v228, v18, v18, v228
    v_dot2_f32_bf16 v229, v19, v19, v229
    s_nop 2
    v_add_f32 v230, v228, v229
    v_add_f32 v228, v228, v229
    s_nop 1
    v_permlane32_swap_b32 v228, v230
    s_mov_b32 exec_lo, 0
    v_add_f32 v124, v228, v230
    v_mov_b32 v125, v126
    s_mov_b32 exec_lo, -1
    ds_write_b64 v6, v[124:125]
    ds_write_b32 v7, v68
    ds_write_b32 v7, v69 offset:128
    ds_write_b32 v7, v70 offset:256
    ds_write_b32 v7, v71 offset:384
    v_add_u32 v4, 131072, v2
    v_and_b32 v5, 7, v1
    v_lshlrev_b32 v5, 15, v5
    v_bfe_u32 v9, v1, 3, 1
    v_lshl_add_u32 v5, v9, 12, v5
    s_lshl4_add_u32 s96, s21, s12
    s_lshl_b32 s97, s96, 11
    s_add_u32 s13, s97, 12582912
    s_and_b32 s96, s12, 1
    s_lshr_b32 s97, s21, 2
    s_and_b32 s98, s21, 3
    s_lshl_b32 s99, s98, 6
    s_lshl1_add_u32 s98, s97, s99
    s_lshl_b32 s97, s98, 12
    s_lshr_b32 s99, s12, 1
    s_lshl_b32 s98, s99, 6
    s_add_u32 s99, s97, s98
    s_lshl2_add_u32 s97, s96, s99
    s_add_u32 s98, s97, 1048576
    s_add_u32 s16, s98, 1536
    s_waitcnt lgkmcnt(0)
    s_barrier
    s_cmp_lg_u32 s3, 0
    s_cbranch_scc1 L_PE
    s_setprio 3
    ds_read_b128 v[124:127], v4 offset:0
    ds_read_b128 v[128:131], v4 offset:2048
    ds_read_b128 v[132:135], v4 offset:1024
    ds_read_b128 v[136:139], v4 offset:3072
    s_waitcnt lgkmcnt(2)
    v_pk_add_f32 v[124:125], v[124:125], v[128:129]
    v_pk_add_f32 v[126:127], v[126:127], v[130:131]
    v_add_f32 v125, v125, v127
    v_mov_b32 v127, s4
    s_waitcnt lgkmcnt(0)
    v_pk_add_f32 v[132:133], v[132:133], v[136:137]
    v_pk_add_f32 v[134:135], v[134:135], v[138:139]
    v_add_f32 v133, v133, v135
    v_mov_b32 v135, s4
    buffer_store_dwordx4 v[124:127], v2, s[32:35], s13 offen sc1
    buffer_store_dwordx4 v[132:135], v2, s[32:35], s13 offen offset:1024 sc1
    s_mov_b64 exec, 0xffff
    buffer_store_dword v127, v5, s[32:35], s16 offen sc1
    s_setprio 0
    s_mov_b64 exec, -1
L_PE:
    s_load_dwordx2 s[24:25], s[32:33], s92 offset:1536 glc
    s_and_b32 s96, s3, 3
    s_mul_i32 s97, s96, 4608
    s_lshl_b32 s98, s76, 6
    s_add_u32 s16, s97, s98
    v_and_b32 v23, 31, v1
    v_mul_u32_u24 v23, 144, v23
    v_lshrrev_b32 v9, 5, v1
    v_lshl_add_u32 v23, v9, 5, v23
    v_add_u32 v23, s16, v23
    ds_write_b128 v23, v[12:15]
    ds_write_b128 v23, v[16:19] offset:16
    v_add_u32 v23, 139776, v23
    s_lshl3_add_u32 s96, s21, s3
    s_lshl_b32 s97, s96, 5
    s_sub_u32 s15, 4094, s97
    v_and_b32 v22, 15, v1
    v_lshlrev_b32 v22, 1, v22
    v_sub_u32 v22, s15, v22
    s_lshl_b32 s96, s3, 7
    s_add_u32 s15, s96, 135168
    v_and_b32 v8, 15, v1
    v_lshl_add_u32 v8, v8, 3, s15
    s_and_b32 s96, s3, 3
    s_lshl_b32 s97, s96, 8
    s_add_u32 s15, s97, 135168
    v_and_b32 v10, 31, v1
    v_lshl_add_u32 v10, v10, 3, s15
    v_and_b32 v11, 7, v1
    v_lshlrev_b32 v11, 3, v11
    v_add_u32 v11, 136192, v11
    s_waitcnt vmcnt(3)
    v_cmp_ne_u32 vcc, s4, v27
    s_cbranch_vccz TOK_38
POLL_39:
    buffer_load_dwordx2 v[26:27], v25, s[32:35], s18 offen sc1
    s_waitcnt vmcnt(0)
    v_cmp_ne_u32 vcc, s4, v27
    s_cbranch_vccz PDONE_40
    s_add_u32 s5, s5, 1
    s_cmp_lt_u32 s5, 300000
    s_cbranch_scc1 POLL_39
PDONE_40:
TOK_38:
    v_add_f32_dpp v26, v26, v26 quad_perm:[1,0,3,2] row_mask:0xf bank_mask:0xf
    s_nop 1
    v_add_f32_dpp v26, v26, v26 quad_perm:[2,3,0,1] row_mask:0xf bank_mask:0xf
    s_nop 1
    v_add_f32_dpp v26, v26, v26 row_half_mirror row_mask:0xf bank_mask:0xf
    s_nop 1
    v_add_f32_dpp v26, v26, v26 row_ror:8 row_mask:0xf bank_mask:0xf
    s_cmp_lg_u32 s3, 1
    s_cbranch_scc1 L_NOCT
    v_and_b32 v5, 15, v1
    v_lshlrev_b32 v5, 3, v5
    v_add_u32 v5, 139008, v5
    ds_read_b64 v[150:151], v5
    ds_read_b64 v[154:155], v5 offset:128
    ds_read_b64 v[156:157], v5 offset:384
    s_waitcnt lgkmcnt(0)
    v_lshlrev_b32 v148, 16, v150
    v_and_b32 v149, s6, v150
    v_lshlrev_b32 v150, 16, v151
    v_and_b32 v151, s6, v151
    v_lshlrev_b32 v152, 16, v154
    v_and_b32 v153, s6, v154
    v_lshlrev_b32 v154, 16, v155
    v_and_b32 v155, s6, v155
L_NOCT:
    s_cmp_lt_u32 s3, 4
    s_cbranch_scc1 L_NOST
    s_sub_u32 s96, s3, 4
    s_lshl_b32 s97, s96, 12
    s_add_u32 s13, s97, 32768
    v_add_u32 v4, s13, v2
    v_add_u32 v7, 65536, v4
    ds_write_b128 v4, v[176:179] offset:16384
    ds_write_b128 v4, v[180:183]
    ds_write_b128 v4, v[184:187] offset:49152
    ds_write_b128 v4, v[188:191] offset:32768
    ds_write_b128 v4, v[192:195] offset:17408
    ds_write_b128 v4, v[196:199] offset:1024
    ds_write_b128 v4, v[200:203] offset:50176
    ds_write_b128 v4, v[204:207] offset:33792
    ds_write_b128 v4, v[208:211] offset:18432
    ds_write_b128 v4, v[212:215] offset:2048
    ds_write_b128 v4, v[216:219] offset:51200
    ds_write_b128 v4, v[220:223] offset:34816
L_NOST:
    s_branch SCHK_36
SPOLL_35:
    s_load_dwordx2 s[24:25], s[32:33], s92 offset:1536 glc
SCHK_36:
    s_add_u32 s5, s5, 1
    s_cmp_ge_u32 s5, 300000
    s_waitcnt lgkmcnt(0)
    s_cbranch_scc1 SDONE_37
    s_cmp_lg_u32 s24, s4
    s_cbranch_scc1 SPOLL_35
    s_cmp_lg_u32 s25, s4
    s_cbranch_scc1 SPOLL_35
SDONE_37:
    s_barrier
    s_mov_b32 s13, s19
    buffer_load_dwordx4 v[124:127], v44, s[32:35], s13 offen sc1
    s_add_u32 s13, s19, 8192
    buffer_load_dwordx4 v[128:131], v44, s[32:35], s13 offen sc1
    s_add_u32 s13, s19, 16384
    buffer_load_dwordx4 v[132:135], v44, s[32:35], s13 offen sc1
    s_add_u32 s13, s19, 24576
    buffer_load_dwordx4 v[136:139], v44, s[32:35], s13 offen sc1
    v_lshlrev_b32 v28, 16, v12
    v_and_b32 v29, s6, v12
    v_lshlrev_b32 v30, 16, v13
    v_and_b32 v31, s6, v13
    v_lshlrev_b32 v32, 16, v14
    v_and_b32 v33, s6, v14
    v_lshlrev_b32 v34, 16, v15
    v_and_b32 v35, s6, v15
    v_lshlrev_b32 v36, 16, v16
    v_and_b32 v37, s6, v16
    v_lshlrev_b32 v38, 16, v17
    v_and_b32 v39, s6, v17
    v_lshlrev_b32 v40, 16, v18
    v_and_b32 v41, s6, v18
    v_lshlrev_b32 v42, 16, v19
    v_and_b32 v43, s6, v19
    v_mul_u32_u24_dpp v92, v68, v52 row_newbcast:0 row_mask:0xf bank_mask:0xf
    v_and_b32_dpp v93, v68, v53 row_newbcast:0 row_mask:0xf bank_mask:0xf
    v_mul_u32_u24_dpp v94, v68, v52 row_newbcast:1 row_mask:0xf bank_mask:0xf
    v_and_b32_dpp v95, v68, v53 row_newbcast:1 row_mask:0xf bank_mask:0xf
    v_mul_u32_u24_dpp v96, v68, v52 row_newbcast:2 row_mask:0xf bank_mask:0xf
    v_and_b32_dpp v97, v68, v53 row_newbcast:2 row_mask:0xf bank_mask:0xf
    v_mul_u32_u24_dpp v98, v68, v52 row_newbcast:3 row_mask:0xf bank_mask:0xf
    v_and_b32_dpp v99, v68, v53 row_newbcast:3 row_mask:0xf bank_mask:0xf
    v_mul_u32_u24_dpp v100, v68, v52 row_newbcast:4 row_mask:0xf bank_mask:0xf
    v_and_b32_dpp v101, v68, v53 row_newbcast:4 row_mask:0xf bank_mask:0xf
    v_mul_u32_u24_dpp v102, v68, v52 row_newbcast:5 row_mask:0xf bank_mask:0xf
    v_and_b32_dpp v103, v68, v53 row_newbcast:5 row_mask:0xf bank_mask:0xf
    v_mul_u32_u24_dpp v104, v68, v52 row_newbcast:6 row_mask:0xf bank_mask:0xf
    v_and_b32_dpp v105, v68, v53 row_newbcast:6 row_mask:0xf bank_mask:0xf
    v_mul_u32_u24_dpp v106, v68, v52 row_newbcast:7 row_mask:0xf bank_mask:0xf
    v_and_b32_dpp v107, v68, v53 row_newbcast:7 row_mask:0xf bank_mask:0xf
    v_mul_u32_u24_dpp v108, v69, v52 row_newbcast:0 row_mask:0xf bank_mask:0xf
    v_and_b32_dpp v109, v69, v53 row_newbcast:0 row_mask:0xf bank_mask:0xf
    v_mul_u32_u24_dpp v110, v69, v52 row_newbcast:1 row_mask:0xf bank_mask:0xf
    v_and_b32_dpp v111, v69, v53 row_newbcast:1 row_mask:0xf bank_mask:0xf
    v_mul_u32_u24_dpp v112, v69, v52 row_newbcast:2 row_mask:0xf bank_mask:0xf
    v_and_b32_dpp v113, v69, v53 row_newbcast:2 row_mask:0xf bank_mask:0xf
    v_mul_u32_u24_dpp v114, v69, v52 row_newbcast:3 row_mask:0xf bank_mask:0xf
    v_and_b32_dpp v115, v69, v53 row_newbcast:3 row_mask:0xf bank_mask:0xf
    v_mul_u32_u24_dpp v116, v69, v52 row_newbcast:4 row_mask:0xf bank_mask:0xf
    v_and_b32_dpp v117, v69, v53 row_newbcast:4 row_mask:0xf bank_mask:0xf
    v_mul_u32_u24_dpp v118, v69, v52 row_newbcast:5 row_mask:0xf bank_mask:0xf
    v_and_b32_dpp v119, v69, v53 row_newbcast:5 row_mask:0xf bank_mask:0xf
    v_mul_u32_u24_dpp v120, v69, v52 row_newbcast:6 row_mask:0xf bank_mask:0xf
    v_and_b32_dpp v121, v69, v53 row_newbcast:6 row_mask:0xf bank_mask:0xf
    v_mul_u32_u24_dpp v122, v69, v52 row_newbcast:7 row_mask:0xf bank_mask:0xf
    v_and_b32_dpp v123, v69, v53 row_newbcast:7 row_mask:0xf bank_mask:0xf
    s_waitcnt vmcnt(0)
    v_bitop3_b32 v4, v127, v131, s4 bitop3:0x7e
    v_bitop3_b32 v4, v4, v135, s4 bitop3:0xf6
    v_bitop3_b32 v4, v4, v139, s4 bitop3:0xf6
    v_cmp_ne_u32 vcc, 0, v4
    s_cbranch_vccz TOK_42
POLL_43:
    s_mov_b32 s13, s19
    buffer_load_dwordx4 v[124:127], v44, s[32:35], s13 offen sc1
    s_add_u32 s13, s19, 8192
    buffer_load_dwordx4 v[128:131], v44, s[32:35], s13 offen sc1
    s_add_u32 s13, s19, 16384
    buffer_load_dwordx4 v[132:135], v44, s[32:35], s13 offen sc1
    s_add_u32 s13, s19, 24576
    buffer_load_dwordx4 v[136:139], v44, s[32:35], s13 offen sc1
    s_waitcnt vmcnt(0)
    v_bitop3_b32 v4, v127, v131, s4 bitop3:0x7e
    v_bitop3_b32 v4, v4, v135, s4 bitop3:0xf6
    v_bitop3_b32 v4, v4, v139, s4 bitop3:0xf6
    v_cmp_ne_u32 vcc, 0, v4
    s_cbranch_vccz PDONE_44
    s_add_u32 s5, s5, 1
    s_cmp_lt_u32 s5, 300000
    s_cbranch_scc1 POLL_43
PDONE_44:
TOK_42:
    s_lshl2_add_u32 s96, s74, s75
    s_lshl_b32 s97, s96, 11
    s_lshl_b32 s98, s3, 8
    s_add_u32 s99, s97, s98
    s_add_u32 s15, s99, 20971520
    v_lshlrev_b32 v44, 7, v1
    s_mov_b64 exec, 3
    buffer_load_dword v44, v44, s[32:35], s15 offen
    s_mov_b64 exec, -1
    s_add_u32 s15, s81, 4096
    s_lshl2_add_u32 m0, s89, 99328
    s_nop 0
    buffer_load_dwordx4 v73, s[60:63], s15 offen nt lds
    v_pk_add_f32 v[124:125], v[124:125], v[128:129]
    v_pk_add_f32 v[132:133], v[132:133], v[136:137]
    v_add_f32 v126, v126, v130
    v_add_f32 v134, v134, v138
    v_pk_add_f32 v[124:125], v[124:125], v[132:133]
    v_add_f32 v126, v126, v134
    v_mov_b32 v127, v125
    s_nop 0
    v_permlane32_swap_b32 v124, v126
    v_permlane32_swap_b32 v125, v127
    v_add_f32 v124, v124, v126
    v_add_f32 v125, v125, v127
    s_nop 1
    v_permlane16_swap_b32 v124, v125
    v_add_f32 v127, v124, v125
    v_add_f32 v124, v124, v125
    s_nop 1
    v_permlane16_swap_b32 v124, v127
    v_mul_f32 v126, 0x3a800000, v124
    v_mul_f32 v124, 0x3a800000, v124
    s_nop 1
    v_permlane32_swap_b32 v124, v126
    v_fma_f32 v21, -v124, v124, v126
    v_cvt_pk_bf16_f32 v20, 0, v124
    v_max_f32 v21, 0, v21
    v_cvt_pk_bf16_f32 v21, 0, v21
    v_add_f32 v21, 0x3727c5ac, v21
    v_cvt_pk_bf16_f32 v21, 0, v21
    v_sqrt_f32 v21, v21
    s_nop 0
    v_cvt_pk_bf16_f32 v21, 0, v21
    s_lshl3_add_u32 s13, s3, 136192
    v_rcp_f32 v21, v21
    v_fma_f32 v127, -v20, v26, v127
    v_mov_b32 v5, s13
    v_mul_f32 v127, v127, v21
    ds_write_b64 v8, v[20:21]
    s_movk_i32 s13, 0xfff
    v_ashrrev_i32 v124, 31, v127
    v_or_b32 v124, 0x80000000, v124
    v_xor_b32 v124, v124, v127
    v_bfi_b32 v48, s13, v22, v124
    s_nop 1
    v_min_u32_dpp v49, v48, v48 row_ror:8 row_mask:0xf bank_mask:0xf
    v_max_u32_dpp v48, v48, v48 row_ror:8 row_mask:0xf bank_mask:0xf
    s_nop 1
    v_min_u32_dpp v50, v48, v48 row_ror:4 row_mask:0xf bank_mask:0xf
    v_max_u32_dpp v49, v49, v49 row_ror:4 row_mask:0xf bank_mask:0xf
    v_max_u32_dpp v48, v48, v48 row_ror:4 row_mask:0xf bank_mask:0xf
    v_max_u32 v49, v49, v50
    s_nop 0
    v_min_u32_dpp v50, v48, v48 row_ror:2 row_mask:0xf bank_mask:0xf
    v_max_u32_dpp v49, v49, v49 row_ror:2 row_mask:0xf bank_mask:0xf
    v_max_u32_dpp v48, v48, v48 row_ror:2 row_mask:0xf bank_mask:0xf
    v_max_u32 v49, v49, v50
    s_nop 0
    v_min_u32_dpp v50, v48, v48 row_ror:1 row_mask:0xf bank_mask:0xf
    v_max_u32_dpp v49, v49, v49 row_ror:1 row_mask:0xf bank_mask:0xf
    v_max_u32_dpp v48, v48, v48 row_ror:1 row_mask:0xf bank_mask:0xf
    v_max_u32 v49, v49, v50
    ds_write_b64 v5, v[48:49]
    v_and_b32 v6, 3, v1
    v_lshlrev_b32 v6, 18, v6
    v_bfe_u32 v9, v1, 2, 2
    v_lshl_add_u32 v6, v9, 13, v6
    s_and_b32 s96, s21, 1
    s_and_b32 s97, s12, 7
    s_lshr_b32 s98, s12, 3
    s_lshl3_add_u32 s99, s97, s98
    s_lshl_b32 s97, s99, 12
    s_lshr_b32 s98, s21, 1
    s_lshl_b32 s99, s98, 6
    s_add_u32 s98, s97, s99
    s_lshl4_add_u32 s97, s96, s98
    s_add_u32 s99, s97, 1048576
    s_add_u32 s14, s99, 2560
    s_waitcnt lgkmcnt(0)
    s_barrier
    s_cmp_ge_u32 s3, 2
    s_cbranch_scc1 L_PR1
    s_setprio 3
L_PR1:
    ds_read_b64 v[48:49], v11
    ds_read_b64 v[20:21], v10
    s_waitcnt lgkmcnt(1)
    v_min_u32_dpp v50, v48, v48 quad_perm:[1,0,3,2] row_mask:0xf bank_mask:0xf
    v_max_u32_dpp v49, v49, v49 quad_perm:[1,0,3,2] row_mask:0xf bank_mask:0xf
    v_max_u32_dpp v48, v48, v48 quad_perm:[1,0,3,2] row_mask:0xf bank_mask:0xf
    v_max_u32 v49, v49, v50
    s_nop 0
    v_min_u32_dpp v50, v48, v48 quad_perm:[2,3,0,1] row_mask:0xf bank_mask:0xf
    v_max_u32_dpp v49, v49, v49 quad_perm:[2,3,0,1] row_mask:0xf bank_mask:0xf
    v_max_u32_dpp v48, v48, v48 quad_perm:[2,3,0,1] row_mask:0xf bank_mask:0xf
    v_max_u32 v49, v49, v50
    s_nop 0
    v_min_u32_dpp v50, v48, v48 row_half_mirror row_mask:0xf bank_mask:0xf
    v_max_u32_dpp v49, v49, v49 row_half_mirror row_mask:0xf bank_mask:0xf
    v_max_u32_dpp v48, v48, v48 row_half_mirror row_mask:0xf bank_mask:0xf
    v_max_u32 v49, v49, v50
    v_or_b32 v50, 1, v49
    v_mov_b32 v49, s4
    v_mov_b32 v51, s4
    s_cmp_lg_u32 s3, 0
    s_cbranch_scc1 L_NOF
    s_mov_b64 exec, 0xffff
    buffer_store_dwordx4 v[48:51], v6, s[32:35], s14 offen sc1
    s_mov_b64 exec, -1
L_NOF:
    s_cmp_lg_u32 s3, 1
    s_cbranch_scc1 L_NOC
    v_and_b32 v4, 16, v1
    v_cmp_eq_u32 vcc, 0, v4
    s_nop 1
    v_cndmask_b32 v4, v50, v48, vcc
    v_not_b32 v4, v4
    v_bfe_u32 v4, v4, 1, 7
    v_lshlrev_b32 v6, 3, v4
    v_mul_u32_u24 v4, 144, v4
    v_add_u32 v6, 135168, v6
    v_and_b32 v5, 15, v1
    v_lshlrev_b32 v5, 3, v5
    v_add_u32 v4, v4, v5
    ds_read_b64 v[128:129], v6
    ds_read_b64 v[124:125], v4 offset:0
    v_and_b32 v6, 15, v1
    v_lshlrev_b32 v6, 4, v6
    v_bfe_u32 v9, v1, 4, 1
    v_lshl_add_u32 v6, v9, 14, v6
    v_lshrrev_b32 v9, 5, v1
    v_lshl_add_u32 v6, v9, 12, v6
    v_bfe_u32 v7, v1, 4, 1
    v_lshlrev_b32 v7, 14, v7
    s_lshl_b32 s96, s21, 15
    s_lshl_b32 s97, s12, 8
    s_add_u32 s98, s96, s97
    s_add_u32 s13, s98, 33554432
    s_lshl_b32 s96, s21, 15
    s_lshl3_add_u32 s97, s12, s96
    s_add_u32 s98, s97, 8192
    s_add_u32 s16, s98, 33554432
    v_mov_b32 v127, s4
    s_waitcnt lgkmcnt(0)
    v_lshlrev_b32 v132, 16, v124
    v_and_b32 v133, s6, v124
    v_lshlrev_b32 v134, 16, v125
    v_and_b32 v135, s6, v125
    v_pk_add_f32 v[132:133], v[132:133], v[128:129] op_sel_hi:[1,0] neg_lo:[0,1] neg_hi:[0,1]
    v_pk_add_f32 v[134:135], v[134:135], v[128:129] op_sel_hi:[1,0] neg_lo:[0,1] neg_hi:[0,1]
    v_cvt_pk_bf16_f32 v132, 0, v132
    v_cvt_pk_bf16_f32 v133, 0, v133
    v_cvt_pk_bf16_f32 v134, 0, v134
    v_cvt_pk_bf16_f32 v135, 0, v135
    v_pk_mul_f32 v[132:133], v[132:133], v[128:129] op_sel:[0,1]
    v_pk_mul_f32 v[134:135], v[134:135], v[128:129] op_sel:[0,1]
    v_cvt_pk_bf16_f32 v132, 0, v132
    v_cvt_pk_bf16_f32 v133, 0, v133
    v_cvt_pk_bf16_f32 v134, 0, v134
    v_cvt_pk_bf16_f32 v135, 0, v135
    v_pk_mul_f32 v[132:133], v[132:133], v[152:153]
    v_pk_mul_f32 v[134:135], v[134:135], v[154:155]
    v_cvt_pk_bf16_f32 v132, 0, v132
    v_cvt_pk_bf16_f32 v133, 0, v133
    v_cvt_pk_bf16_f32 v134, 0, v134
    v_cvt_pk_bf16_f32 v135, 0, v135
    v_pk_add_f32 v[132:133], v[132:133], v[148:149]
    v_pk_add_f32 v[134:135], v[134:135], v[150:151]
    v_mov_b32 v126, v125
    v_mov_b32 v125, s4
    s_mov_b32 exec_hi, 0
    v_cvt_pk_bf16_f32 v124, v132, v133
    v_cvt_pk_bf16_f32 v126, v134, v135
    s_mov_b32 exec_hi, -1
    v_dot2_f32_bf16 v128, v124, v156, 0
    v_mov_b32 v129, s4
    v_dot2_f32_bf16 v128, v126, v157, v128
    buffer_store_dwordx4 v[124:127], v6, s[32:35], s13 offen sc1
    s_nop 1
    v_add_f32_dpp v128, v128, v128 quad_perm:[1,0,3,2] row_mask:0xf bank_mask:0xf
    s_nop 1
    v_add_f32_dpp v128, v128, v128 quad_perm:[2,3,0,1] row_mask:0xf bank_mask:0xf
    s_nop 1
    v_add_f32_dpp v128, v128, v128 row_half_mirror row_mask:0xf bank_mask:0xf
    s_nop 1
    v_add_f32_dpp v128, v128, v128 row_ror:8 row_mask:0xf bank_mask:0xf
    s_mov_b64 exec, 0x10001
    buffer_store_dwordx2 v[128:129], v7, s[32:35], s16 offen sc1
    s_mov_b64 exec, -1
L_NOC:
    s_waitcnt lgkmcnt(0)
    s_setprio 0
    s_mov_b32 exec_lo, 0xff
    s_mov_b32 exec_hi, 0xff
    buffer_store_dwordx2 v[224:225], v226, s[32:35], 0 offen sc1
    s_mov_b64 exec, -1
    s_add_u32 s13, s81, 8192
    s_lshl2_add_u32 m0, s89, 100352
    s_nop 0
    buffer_load_dwordx4 v73, s[60:63], s13 offen nt lds
    s_load_dwordx8 s[24:31], s[32:33], s92 offset:2560 glc
    v_pk_add_f32 v[76:77], v[28:29], v[20:21] op_sel_hi:[1,0] neg_lo:[0,1] neg_hi:[0,1]
    v_pk_add_f32 v[78:79], v[30:31], v[20:21] op_sel_hi:[1,0] neg_lo:[0,1] neg_hi:[0,1]
    v_pk_add_f32 v[80:81], v[32:33], v[20:21] op_sel_hi:[1,0] neg_lo:[0,1] neg_hi:[0,1]
    v_pk_add_f32 v[82:83], v[34:35], v[20:21] op_sel_hi:[1,0] neg_lo:[0,1] neg_hi:[0,1]
    v_pk_add_f32 v[84:85], v[36:37], v[20:21] op_sel_hi:[1,0] neg_lo:[0,1] neg_hi:[0,1]
    v_pk_add_f32 v[86:87], v[38:39], v[20:21] op_sel_hi:[1,0] neg_lo:[0,1] neg_hi:[0,1]
    v_pk_add_f32 v[88:89], v[40:41], v[20:21] op_sel_hi:[1,0] neg_lo:[0,1] neg_hi:[0,1]
    v_pk_add_f32 v[90:91], v[42:43], v[20:21] op_sel_hi:[1,0] neg_lo:[0,1] neg_hi:[0,1]
    v_cvt_pk_bf16_f32 v76, 0, v76
    v_cvt_pk_bf16_f32 v77, 0, v77
    v_cvt_pk_bf16_f32 v78, 0, v78
    v_cvt_pk_bf16_f32 v79, 0, v79
    v_cvt_pk_bf16_f32 v80, 0, v80
    v_cvt_pk_bf16_f32 v81, 0, v81
    v_cvt_pk_bf16_f32 v82, 0, v82
    v_cvt_pk_bf16_f32 v83, 0, v83
    v_cvt_pk_bf16_f32 v84, 0, v84
    v_cvt_pk_bf16_f32 v85, 0, v85
    v_cvt_pk_bf16_f32 v86, 0, v86
    v_cvt_pk_bf16_f32 v87, 0, v87
    v_cvt_pk_bf16_f32 v88, 0, v88
    v_cvt_pk_bf16_f32 v89, 0, v89
    v_cvt_pk_bf16_f32 v90, 0, v90
    v_cvt_pk_bf16_f32 v91, 0, v91
    v_pk_mul_f32 v[76:77], v[76:77], v[20:21] op_sel:[0,1]
    v_pk_mul_f32 v[78:79], v[78:79], v[20:21] op_sel:[0,1]
    v_pk_mul_f32 v[80:81], v[80:81], v[20:21] op_sel:[0,1]
    v_pk_mul_f32 v[82:83], v[82:83], v[20:21] op_sel:[0,1]
    v_pk_mul_f32 v[84:85], v[84:85], v[20:21] op_sel:[0,1]
    v_pk_mul_f32 v[86:87], v[86:87], v[20:21] op_sel:[0,1]
    v_pk_mul_f32 v[88:89], v[88:89], v[20:21] op_sel:[0,1]
    v_pk_mul_f32 v[90:91], v[90:91], v[20:21] op_sel:[0,1]
    v_cvt_pk_bf16_f32 v76, 0, v76
    v_cvt_pk_bf16_f32 v77, 0, v77
    v_cvt_pk_bf16_f32 v78, 0, v78
    v_cvt_pk_bf16_f32 v79, 0, v79
    v_cvt_pk_bf16_f32 v80, 0, v80
    v_cvt_pk_bf16_f32 v81, 0, v81
    v_cvt_pk_bf16_f32 v82, 0, v82
    v_cvt_pk_bf16_f32 v83, 0, v83
    v_cvt_pk_bf16_f32 v84, 0, v84
    v_cvt_pk_bf16_f32 v85, 0, v85
    v_cvt_pk_bf16_f32 v86, 0, v86
    v_cvt_pk_bf16_f32 v87, 0, v87
    v_cvt_pk_bf16_f32 v88, 0, v88
    v_cvt_pk_bf16_f32 v89, 0, v89
    v_cvt_pk_bf16_f32 v90, 0, v90
    v_cvt_pk_bf16_f32 v91, 0, v91
    v_pk_mul_f32 v[76:77], v[76:77], v[108:109]
    v_pk_mul_f32 v[78:79], v[78:79], v[110:111]
    v_pk_mul_f32 v[80:81], v[80:81], v[112:113]
    v_pk_mul_f32 v[82:83], v[82:83], v[114:115]
    v_pk_mul_f32 v[84:85], v[84:85], v[116:117]
    v_pk_mul_f32 v[86:87], v[86:87], v[118:119]
    v_pk_mul_f32 v[88:89], v[88:89], v[120:121]
    v_pk_mul_f32 v[90:91], v[90:91], v[122:123]
    v_cvt_pk_bf16_f32 v76, 0, v76
    v_cvt_pk_bf16_f32 v77, 0, v77
    v_cvt_pk_bf16_f32 v78, 0, v78
    v_cvt_pk_bf16_f32 v79, 0, v79
    v_cvt_pk_bf16_f32 v80, 0, v80
    v_cvt_pk_bf16_f32 v81, 0, v81
    v_cvt_pk_bf16_f32 v82, 0, v82
    v_cvt_pk_bf16_f32 v83, 0, v83
    v_cvt_pk_bf16_f32 v84, 0, v84
    v_cvt_pk_bf16_f32 v85, 0, v85
    v_cvt_pk_bf16_f32 v86, 0, v86
    v_cvt_pk_bf16_f32 v87, 0, v87
    v_cvt_pk_bf16_f32 v88, 0, v88
    v_cvt_pk_bf16_f32 v89, 0, v89
    v_cvt_pk_bf16_f32 v90, 0, v90
    v_cvt_pk_bf16_f32 v91, 0, v91
    v_pk_add_f32 v[76:77], v[76:77], v[92:93]
    v_pk_add_f32 v[78:79], v[78:79], v[94:95]
    v_pk_add_f32 v[80:81], v[80:81], v[96:97]
    v_pk_add_f32 v[82:83], v[82:83], v[98:99]
    v_pk_add_f32 v[84:85], v[84:85], v[100:101]
    v_pk_add_f32 v[86:87], v[86:87], v[102:103]
    v_pk_add_f32 v[88:89], v[88:89], v[104:105]
    v_pk_add_f32 v[90:91], v[90:91], v[106:107]
    v_cvt_pk_bf16_f32 v76, 0, v76
    v_cvt_pk_bf16_f32 v77, 0, v77
    v_cvt_pk_bf16_f32 v78, 0, v78
    v_cvt_pk_bf16_f32 v79, 0, v79
    v_cvt_pk_bf16_f32 v80, 0, v80
    v_cvt_pk_bf16_f32 v81, 0, v81
    v_cvt_pk_bf16_f32 v82, 0, v82
    v_cvt_pk_bf16_f32 v83, 0, v83
    v_cvt_pk_bf16_f32 v84, 0, v84
    v_cvt_pk_bf16_f32 v85, 0, v85
    v_cvt_pk_bf16_f32 v86, 0, v86
    v_cvt_pk_bf16_f32 v87, 0, v87
    v_cvt_pk_bf16_f32 v88, 0, v88
    v_cvt_pk_bf16_f32 v89, 0, v89
    v_cvt_pk_bf16_f32 v90, 0, v90
    v_cvt_pk_bf16_f32 v91, 0, v91
    s_lshr_b32 s96, s3, 2
    s_lshl_b32 s97, s96, 15
    s_and_b32 s98, s3, 3
    s_lshl_b32 s99, s98, 5
    s_add_u32 s96, s97, s99
    s_add_u32 s13, s96, 32768
    v_lshrrev_b32 v24, 4, v1
    v_lshlrev_b32 v24, 13, v24
    v_bfe_u32 v9, v1, 2, 2
    v_lshl_add_u32 v24, v9, 7, v24
    v_bfe_u32 v9, v1, 3, 2
    v_lshl_add_u32 v24, v9, 5, v24
    v_and_b32 v9, 3, v1
    v_lshl_add_u32 v24, v9, 3, v24
    v_xor_b32 v24, s13, v24
    s_lshl_b32 s13, s3, 6
    v_bfe_u32 v45, v1, 2, 1
    v_lshlrev_b32 v45, 9, v45
    v_bfe_u32 v9, v1, 3, 1
    v_lshl_add_u32 v45, v9, 12, v45
    v_lshrrev_b32 v9, 5, v1
    v_lshl_add_u32 v45, v9, 11, v45
    v_bfe_u32 v9, v1, 2, 2
    v_lshl_add_u32 v45, v9, 6, v45
    v_bfe_u32 v9, v1, 4, 1
    v_lshl_add_u32 v45, v9, 5, v45
    v_and_b32 v9, 3, v1
    v_lshl_add_u32 v45, v9, 3, v45
    v_xor_b32 v45, s13, v45
    v_add_u32 v45, 98304, v45
    v_and_b32 v46, 7, v1
    v_lshlrev_b32 v46, 4, v46
    v_lshrrev_b32 v9, 4, v1
    v_lshl_add_u32 v46, v9, 7, v46
    v_add_u32 v46, 136704, v46
    s_lshl4_add_u32 s13, s3, 136256
    v_mov_b32 v4, s13
    v_and_b32 v5, 7, v1
    v_lshlrev_b32 v5, 4, v5
    v_add_u32 v5, 136256, v5
    v_and_b32 v8, 8, v1
    v_cmp_eq_u32 s[22:23], 0, v8
    s_branch SCHK_46
SPOLL_45:
    s_load_dwordx8 s[24:31], s[32:33], s92 offset:2560 glc
SCHK_46:
    s_add_u32 s5, s5, 1
    s_cmp_ge_u32 s5, 300000
    s_waitcnt lgkmcnt(0)
    s_cbranch_scc1 SDONE_47
    s_cmp_lg_u32 s25, s4
    s_cbranch_scc1 SPOLL_45
    s_cmp_lg_u32 s27, s4
    s_cbranch_scc1 SPOLL_45
    s_cmp_lg_u32 s29, s4
    s_cbranch_scc1 SPOLL_45
    s_cmp_lg_u32 s31, s4
    s_cbranch_scc1 SPOLL_45
SDONE_47:
    s_min_u32 s25, s24, s28
    s_max_u32 s24, s24, s28
    s_max_u32 s27, s26, s30
    s_min_u32 s26, s26, s30
    s_max_u32 s28, s25, s27
    s_min_u32 s25, s25, s27
    v_mov_b32 v148, s24
    v_mov_b32 v151, s26
    v_mov_b32 v149, s28
    v_mov_b32 v150, s25
    ds_write_b128 v4, v[148:151]
    s_waitcnt lgkmcnt(0)
    s_barrier
    s_cmp_lt_u32 s3, 4
    s_cbranch_scc1 L_CSEL
    ds_read_b64_tr_b16 v[164:165], v24
    ds_read_b64_tr_b16 v[166:167], v24 offset:512
    ds_read_b64_tr_b16 v[168:169], v24 offset:1024
    ds_read_b64_tr_b16 v[170:171], v24 offset:1536
    ds_read_b64_tr_b16 v[172:173], v24 offset:2048
    ds_read_b64_tr_b16 v[174:175], v24 offset:2560
    ds_read_b64_tr_b16 v[176:177], v24 offset:3072
    ds_read_b64_tr_b16 v[178:179], v24 offset:3584
    ds_read_b64_tr_b16 v[180:181], v24 offset:4096
    ds_read_b64_tr_b16 v[182:183], v24 offset:4608
    ds_read_b64_tr_b16 v[184:185], v24 offset:5120
    ds_read_b64_tr_b16 v[186:187], v24 offset:5632
    ds_read_b64_tr_b16 v[188:189], v24 offset:6144
    ds_read_b64_tr_b16 v[190:191], v24 offset:6656
    ds_read_b64_tr_b16 v[192:193], v24 offset:7168
    ds_read_b64_tr_b16 v[194:195], v24 offset:7680
    v_mul_u32_u24_dpp v92, v70, v52 row_newbcast:0 row_mask:0xf bank_mask:0xf
    v_and_b32_dpp v93, v70, v53 row_newbcast:0 row_mask:0xf bank_mask:0xf
    v_mul_u32_u24_dpp v94, v70, v52 row_newbcast:1 row_mask:0xf bank_mask:0xf
    v_and_b32_dpp v95, v70, v53 row_newbcast:1 row_mask:0xf bank_mask:0xf
    v_mul_u32_u24_dpp v96, v70, v52 row_newbcast:2 row_mask:0xf bank_mask:0xf
    v_and_b32_dpp v97, v70, v53 row_newbcast:2 row_mask:0xf bank_mask:0xf
    v_mul_u32_u24_dpp v98, v70, v52 row_newbcast:3 row_mask:0xf bank_mask:0xf
    v_and_b32_dpp v99, v70, v53 row_newbcast:3 row_mask:0xf bank_mask:0xf
    v_mul_u32_u24_dpp v100, v70, v52 row_newbcast:4 row_mask:0xf bank_mask:0xf
    v_and_b32_dpp v101, v70, v53 row_newbcast:4 row_mask:0xf bank_mask:0xf
    v_mul_u32_u24_dpp v102, v70, v52 row_newbcast:5 row_mask:0xf bank_mask:0xf
    v_and_b32_dpp v103, v70, v53 row_newbcast:5 row_mask:0xf bank_mask:0xf
    v_mul_u32_u24_dpp v104, v70, v52 row_newbcast:6 row_mask:0xf bank_mask:0xf
    v_and_b32_dpp v105, v70, v53 row_newbcast:6 row_mask:0xf bank_mask:0xf
    v_mul_u32_u24_dpp v106, v70, v52 row_newbcast:7 row_mask:0xf bank_mask:0xf
    v_and_b32_dpp v107, v70, v53 row_newbcast:7 row_mask:0xf bank_mask:0xf
    v_pk_mul_f32 v[76:77], v[76:77], v[92:93]
    v_pk_mul_f32 v[78:79], v[78:79], v[94:95]
    v_pk_mul_f32 v[80:81], v[80:81], v[96:97]
    v_pk_mul_f32 v[82:83], v[82:83], v[98:99]
    v_pk_mul_f32 v[84:85], v[84:85], v[100:101]
    v_pk_mul_f32 v[86:87], v[86:87], v[102:103]
    v_pk_mul_f32 v[88:89], v[88:89], v[104:105]
    v_pk_mul_f32 v[90:91], v[90:91], v[106:107]
    v_cvt_pk_bf16_f32 v76, 0, v76
    v_cvt_pk_bf16_f32 v77, 0, v77
    v_cvt_pk_bf16_f32 v78, 0, v78
    v_cvt_pk_bf16_f32 v79, 0, v79
    v_cvt_pk_bf16_f32 v80, 0, v80
    v_cvt_pk_bf16_f32 v81, 0, v81
    v_cvt_pk_bf16_f32 v82, 0, v82
    v_cvt_pk_bf16_f32 v83, 0, v83
    v_cvt_pk_bf16_f32 v84, 0, v84
    v_cvt_pk_bf16_f32 v85, 0, v85
    v_cvt_pk_bf16_f32 v86, 0, v86
    v_cvt_pk_bf16_f32 v87, 0, v87
    v_cvt_pk_bf16_f32 v88, 0, v88
    v_cvt_pk_bf16_f32 v89, 0, v89
    v_cvt_pk_bf16_f32 v90, 0, v90
    v_cvt_pk_bf16_f32 v91, 0, v91
    v_pk_add_f32 v[76:77], v[76:77], v[28:29]
    v_pk_add_f32 v[78:79], v[78:79], v[30:31]
    v_pk_add_f32 v[80:81], v[80:81], v[32:33]
    v_pk_add_f32 v[82:83], v[82:83], v[34:35]
    v_pk_add_f32 v[84:85], v[84:85], v[36:37]
    v_pk_add_f32 v[86:87], v[86:87], v[38:39]
    v_pk_add_f32 v[88:89], v[88:89], v[40:41]
    v_pk_add_f32 v[90:91], v[90:91], v[42:43]
    v_cvt_pk_bf16_f32 v140, v76, v77
    v_cvt_pk_bf16_f32 v141, v78, v79
    v_cvt_pk_bf16_f32 v142, v80, v81
    v_cvt_pk_bf16_f32 v143, v82, v83
    v_cvt_pk_bf16_f32 v144, v84, v85
    v_cvt_pk_bf16_f32 v145, v86, v87
    v_cvt_pk_bf16_f32 v146, v88, v89
    v_cvt_pk_bf16_f32 v147, v90, v91
    ds_write_b128 v23, v[140:143]
    ds_write_b128 v23, v[144:147] offset:16
    s_mul_i32 s96, s3, 2304
    s_add_u32 s16, s96, 139776
    v_lshrrev_b32 v23, 3, v1
    v_mul_u32_u24 v23, 144, v23
    v_and_b32 v9, 7, v1
    v_lshl_add_u32 v23, v9, 4, v23
    v_add_u32 v23, s16, v23
    s_add_u32 s13, s81, 12288
    s_lshl2_add_u32 m0, s89, 101376
    s_nop 0
    buffer_load_dwordx4 v73, s[60:63], s13 offen nt lds
    s_branch L_CSELD
L_CSEL:
    s_setprio 3
    ds_read_b128 v[148:151], v5
    s_lshl_b32 s96, s3, 9
    s_add_u32 s13, s96, 136704
    v_add_u32 v6, s13, v63
    s_lshl2_add_u32 s13, s3, 136384
    v_mov_b32 v7, s13
    s_waitcnt lgkmcnt(0)
    v_max_u32_dpp v152, v151, v148 quad_perm:[1,0,3,2] row_mask:0xf bank_mask:0xf
    v_max_u32_dpp v153, v150, v149 quad_perm:[1,0,3,2] row_mask:0xf bank_mask:0xf
    v_max_u32_dpp v154, v149, v150 quad_perm:[1,0,3,2] row_mask:0xf bank_mask:0xf
    v_max_u32_dpp v155, v148, v151 quad_perm:[1,0,3,2] row_mask:0xf bank_mask:0xf
    v_max_u32 v156, v152, v154
    v_max_u32 v157, v153, v155
    v_min_u32 v158, v152, v154
    v_min_u32 v159, v153, v155
    v_max_u32 v148, v156, v157
    v_min_u32 v149, v156, v157
    v_max_u32 v150, v158, v159
    v_min_u32 v151, v158, v159
    s_nop 1
    v_max_u32_dpp v152, v151, v148 quad_perm:[2,3,0,1] row_mask:0xf bank_mask:0xf
    v_max_u32_dpp v153, v150, v149 quad_perm:[2,3,0,1] row_mask:0xf bank_mask:0xf
    v_max_u32_dpp v154, v149, v150 quad_perm:[2,3,0,1] row_mask:0xf bank_mask:0xf
    v_max_u32_dpp v155, v148, v151 quad_perm:[2,3,0,1] row_mask:0xf bank_mask:0xf
    v_max_u32 v156, v152, v154
    v_max_u32 v157, v153, v155
    v_min_u32 v158, v152, v154
    v_min_u32 v159, v153, v155
    v_max_u32 v148, v156, v157
    v_min_u32 v149, v156, v157
    v_max_u32 v150, v158, v159
    v_min_u32 v151, v158, v159
    s_nop 1
    v_max_u32_dpp v152, v151, v148 row_half_mirror row_mask:0xf bank_mask:0xf
    v_max_u32_dpp v153, v150, v149 row_half_mirror row_mask:0xf bank_mask:0xf
    v_max_u32_dpp v154, v149, v150 row_half_mirror row_mask:0xf bank_mask:0xf
    v_max_u32_dpp v155, v148, v151 row_half_mirror row_mask:0xf bank_mask:0xf
    v_readfirstlane_b32 s24, v152
    v_readfirstlane_b32 s25, v153
    v_readfirstlane_b32 s26, v154
    v_readfirstlane_b32 s27, v155
    s_bitcmp1_b32 s3, 0
    s_cselect_b32 s24, s25, s24
    s_cselect_b32 s26, s27, s26
    s_bitcmp1_b32 s3, 1
    s_cselect_b32 s24, s26, s24
    s_and_b32 s15, s24, 4095
    s_lshr_b32 s96, s15, 8
    s_sub_u32 s97, 15, s96
    s_and_b32 s98, s15, 1
    s_lshl1_add_u32 s99, s97, s98
    s_lshl_b32 s96, s99, 14
    s_add_u32 s13, s96, 33554432
    s_lshl_b32 s96, s75, 10
    s_add_u32 s14, s96, s13
    s_add_u32 s13, s13, 8192
    v_and_b32 v10, 15, v1
    v_lshlrev_b32 v10, 3, v10
    buffer_load_dwordx2 v[152:153], v10, s[32:35], s13 offen sc1
    buffer_load_dwordx4 v[148:151], v2, s[32:35], s14 offen sc1
    s_setprio 0
    s_add_u32 s16, s81, 12288
    s_lshl2_add_u32 m0, s89, 101376
    s_nop 0
    buffer_load_dwordx4 v73, s[60:63], s16 offen nt lds
    ds_read_b64_tr_b16 v[164:165], v24
    ds_read_b64_tr_b16 v[166:167], v24 offset:512
    ds_read_b64_tr_b16 v[168:169], v24 offset:1024
    ds_read_b64_tr_b16 v[170:171], v24 offset:1536
    ds_read_b64_tr_b16 v[172:173], v24 offset:2048
    ds_read_b64_tr_b16 v[174:175], v24 offset:2560
    ds_read_b64_tr_b16 v[176:177], v24 offset:3072
    ds_read_b64_tr_b16 v[178:179], v24 offset:3584
    ds_read_b64_tr_b16 v[180:181], v24 offset:4096
    ds_read_b64_tr_b16 v[182:183], v24 offset:4608
    ds_read_b64_tr_b16 v[184:185], v24 offset:5120
    ds_read_b64_tr_b16 v[186:187], v24 offset:5632
    ds_read_b64_tr_b16 v[188:189], v24 offset:6144
    ds_read_b64_tr_b16 v[190:191], v24 offset:6656
    ds_read_b64_tr_b16 v[192:193], v24 offset:7168
    ds_read_b64_tr_b16 v[194:195], v24 offset:7680
    v_mul_u32_u24_dpp v92, v70, v52 row_newbcast:0 row_mask:0xf bank_mask:0xf
    v_and_b32_dpp v93, v70, v53 row_newbcast:0 row_mask:0xf bank_mask:0xf
    v_mul_u32_u24_dpp v94, v70, v52 row_newbcast:1 row_mask:0xf bank_mask:0xf
    v_and_b32_dpp v95, v70, v53 row_newbcast:1 row_mask:0xf bank_mask:0xf
    v_mul_u32_u24_dpp v96, v70, v52 row_newbcast:2 row_mask:0xf bank_mask:0xf
    v_and_b32_dpp v97, v70, v53 row_newbcast:2 row_mask:0xf bank_mask:0xf
    v_mul_u32_u24_dpp v98, v70, v52 row_newbcast:3 row_mask:0xf bank_mask:0xf
    v_and_b32_dpp v99, v70, v53 row_newbcast:3 row_mask:0xf bank_mask:0xf
    v_mul_u32_u24_dpp v100, v70, v52 row_newbcast:4 row_mask:0xf bank_mask:0xf
    v_and_b32_dpp v101, v70, v53 row_newbcast:4 row_mask:0xf bank_mask:0xf
    v_mul_u32_u24_dpp v102, v70, v52 row_newbcast:5 row_mask:0xf bank_mask:0xf
    v_and_b32_dpp v103, v70, v53 row_newbcast:5 row_mask:0xf bank_mask:0xf
    v_mul_u32_u24_dpp v104, v70, v52 row_newbcast:6 row_mask:0xf bank_mask:0xf
    v_and_b32_dpp v105, v70, v53 row_newbcast:6 row_mask:0xf bank_mask:0xf
    v_mul_u32_u24_dpp v106, v70, v52 row_newbcast:7 row_mask:0xf bank_mask:0xf
    v_and_b32_dpp v107, v70, v53 row_newbcast:7 row_mask:0xf bank_mask:0xf
    v_pk_mul_f32 v[76:77], v[76:77], v[92:93]
    v_pk_mul_f32 v[78:79], v[78:79], v[94:95]
    v_pk_mul_f32 v[80:81], v[80:81], v[96:97]
    v_pk_mul_f32 v[82:83], v[82:83], v[98:99]
    v_pk_mul_f32 v[84:85], v[84:85], v[100:101]
    v_pk_mul_f32 v[86:87], v[86:87], v[102:103]
    v_pk_mul_f32 v[88:89], v[88:89], v[104:105]
    v_pk_mul_f32 v[90:91], v[90:91], v[106:107]
    v_cvt_pk_bf16_f32 v76, 0, v76
    v_cvt_pk_bf16_f32 v77, 0, v77
    v_cvt_pk_bf16_f32 v78, 0, v78
    v_cvt_pk_bf16_f32 v79, 0, v79
    v_cvt_pk_bf16_f32 v80, 0, v80
    v_cvt_pk_bf16_f32 v81, 0, v81
    v_cvt_pk_bf16_f32 v82, 0, v82
    v_cvt_pk_bf16_f32 v83, 0, v83
    v_cvt_pk_bf16_f32 v84, 0, v84
    v_cvt_pk_bf16_f32 v85, 0, v85
    v_cvt_pk_bf16_f32 v86, 0, v86
    v_cvt_pk_bf16_f32 v87, 0, v87
    v_cvt_pk_bf16_f32 v88, 0, v88
    v_cvt_pk_bf16_f32 v89, 0, v89
    v_cvt_pk_bf16_f32 v90, 0, v90
    v_cvt_pk_bf16_f32 v91, 0, v91
    v_pk_add_f32 v[76:77], v[76:77], v[28:29]
    v_pk_add_f32 v[78:79], v[78:79], v[30:31]
    v_pk_add_f32 v[80:81], v[80:81], v[32:33]
    v_pk_add_f32 v[82:83], v[82:83], v[34:35]
    v_pk_add_f32 v[84:85], v[84:85], v[36:37]
    v_pk_add_f32 v[86:87], v[86:87], v[38:39]
    v_pk_add_f32 v[88:89], v[88:89], v[40:41]
    v_pk_add_f32 v[90:91], v[90:91], v[42:43]
    v_cvt_pk_bf16_f32 v140, v76, v77
    v_cvt_pk_bf16_f32 v141, v78, v79
    v_cvt_pk_bf16_f32 v142, v80, v81
    v_cvt_pk_bf16_f32 v143, v82, v83
    v_cvt_pk_bf16_f32 v144, v84, v85
    v_cvt_pk_bf16_f32 v145, v86, v87
    v_cvt_pk_bf16_f32 v146, v88, v89
    v_cvt_pk_bf16_f32 v147, v90, v91
    ds_write_b128 v23, v[140:143]
    ds_write_b128 v23, v[144:147] offset:16
    s_mul_i32 s96, s3, 2304
    s_add_u32 s16, s96, 139776
    v_lshrrev_b32 v23, 3, v1
    v_mul_u32_u24 v23, 144, v23
    v_and_b32 v9, 7, v1
    v_lshl_add_u32 v23, v9, 4, v23
    v_add_u32 v23, s16, v23
    s_lshl2_add_u32 s15, s15, s3
    s_waitcnt vmcnt(1)
    v_bitop3_b32 v8, v149, v151, s4 bitop3:0x7e
    v_bitop3_b32 v8, v8, v153, s4 bitop3:0xf6
    v_cmp_ne_u32 vcc, 0, v8
    s_cbranch_vccz TOK_49
POLL_50:
    buffer_load_dwordx2 v[152:153], v10, s[32:35], s13 offen sc1
    buffer_load_dwordx4 v[148:151], v2, s[32:35], s14 offen sc1
    s_waitcnt vmcnt(0)
    v_bitop3_b32 v8, v149, v151, s4 bitop3:0x7e
    v_bitop3_b32 v8, v8, v153, s4 bitop3:0xf6
    v_cmp_ne_u32 vcc, 0, v8
    s_cbranch_vccz PDONE_51
    s_add_u32 s5, s5, 1
    s_cmp_lt_u32 s5, 300000
    s_cbranch_scc1 POLL_50
PDONE_51:
TOK_49:
    s_setprio 3
    ds_write2_b32 v6, v148, v150 offset0:0 offset1:1
    v_add_f32_dpp v152, v152, v152 quad_perm:[1,0,3,2] row_mask:0xf bank_mask:0xf
    s_nop 1
    v_add_f32_dpp v152, v152, v152 quad_perm:[2,3,0,1] row_mask:0xf bank_mask:0xf
    s_nop 1
    v_add_f32_dpp v152, v152, v152 row_half_mirror row_mask:0xf bank_mask:0xf
    s_nop 1
    v_add_f32_dpp v152, v152, v152 row_ror:8 row_mask:0xf bank_mask:0xf
    v_cvt_pk_bf16_f32 v152, 0, v152
    v_ashrrev_i32 v153, 31, v152
    v_or_b32 v153, 0x80000000, v153
    v_xor_b32 v152, v152, v153
    v_and_b32 v152, s6, v152
    v_or_b32 v152, s15, v152
    ds_write_b32 v7, v152
    s_setprio 0
L_CSELD:
    v_mov_b32 v4, 136384
    v_and_b32 v8, 15, v1
    v_lshlrev_b32 v8, 4, v8
    v_lshrrev_b32 v9, 5, v1
    v_lshl_add_u32 v8, v9, 3, v8
    s_lshl_b32 s96, s74, 13
    s_add_u32 s14, s96, 20971520
    s_mul_i32 s96, s90, s76
    s_lshl_b32 s97, s96, 13
    s_lshl3_add_u32 s98, s75, s3
    s_lshl_b32 s99, s98, 8
    s_add_u32 s96, s97, s99
    s_add_u32 s20, s96, s14
    s_waitcnt lgkmcnt(0)
    s_barrier
    ds_read_b128 v[148:151], v4
    s_waitcnt lgkmcnt(0)
    v_max_u32 v152, v148, v149
    v_max_u32 v153, v150, v151
    v_min_u32 v154, v148, v149
    v_min_u32 v155, v150, v151
    v_min_u32 v149, v152, v153
    v_max_u32 v148, v152, v153
    v_max3_u32 v149, v149, v154, v155
    v_cndmask_b32 v4, v149, v148, s[22:23]
    v_readfirstlane_b32 s68, v148
    v_and_b32 v4, 3, v4
    v_readfirstlane_b32 s69, v149
    v_lshl_add_u32 v4, v4, 9, v46
    ds_read_b128 v[152:155], v4
    ds_read_b128 v[140:143], v23
    ds_read_b128 v[144:147], v23 offset:1152
    s_bfe_u32 s70, s68, 720899
    s_bfe_u32 s71, s69, 720899
    s_sub_u32 s70, 2047, s70
    s_sub_u32 s71, 2047, s71
    s_waitcnt lgkmcnt(2)
    v_mfma_f32_16x16x32_bf16 v[212:215], v[152:155], v[164:167], 0
    v_mfma_f32_16x16x32_bf16 v[216:219], v[152:155], v[168:171], 0
    v_mfma_f32_16x16x32_bf16 v[220:223], v[152:155], v[172:175], 0
    v_mfma_f32_16x16x32_bf16 v[224:227], v[152:155], v[176:179], 0
    v_mfma_f32_16x16x32_bf16 v[228:231], v[152:155], v[180:183], 0
    v_mfma_f32_16x16x32_bf16 v[232:235], v[152:155], v[184:187], 0
    v_mfma_f32_16x16x32_bf16 v[236:239], v[152:155], v[188:191], 0
    v_mfma_f32_16x16x32_bf16 v[240:243], v[152:155], v[192:195], 0
    s_nop 1
    v_add_f32 v148, v212, v217
    s_nop 0
    v_add_f32 v149, v222, v227
    s_nop 0
    v_add_f32 v150, v228, v233
    s_nop 0
    v_add_f32 v151, v238, v243
    v_add_f32 v148, v148, v149
    v_add_f32 v150, v150, v151
    v_mov_b32 v149, s4
    s_nop 0
    v_permlane16_swap_b32 v150, v151
    s_cmp_ge_u32 s9, 28
    s_cbranch_scc1 L_NOHP
    v_add_f32 v148, v148, v151
    s_mov_b32 exec_lo, 0xffff
    s_mov_b32 exec_hi, 0xffff
    s_cmp_lg_u32 s93, 0
    s_cbranch_scc1 LOC_52
    buffer_store_dwordx2 v[148:149], v8, s[32:35], s20 offen sc1
    s_branch LOCD_53
LOC_52:
    buffer_store_dwordx2 v[148:149], v8, s[32:35], s20 offen
LOCD_53:
    s_mov_b64 exec, -1
L_NOHP:
    v_mov_b32 v56, v148
    v_mov_b32 v57, v149
    v_add_u32 v58, s20, v8
    s_waitcnt lgkmcnt(0)
    s_bitcmp1_b32 s21, 2
    s_cselect_b32 s17, s71, s70
    s_cselect_b32 s18, s69, s68
    s_cmp_lg_u32 s3, 7
    s_cbranch_scc1 L_NOFZ
    s_cmp_lg_u32 s2, 0
    s_cbranch_scc1 L_NONON
    v_mov_b32 v6, s4
    s_mov_b64 exec, 1
    buffer_store_dword v6, v3, s[32:35], 0 offen sc1
    s_mov_b64 exec, -1
L_NONON:
    s_lshr_b32 s96, s21, 3
    s_and_b32 s97, s21, 1
    s_lshl1_add_u32 s19, s96, s97
    s_lshr_b32 s96, s21, 2
    s_lshl_b32 s97, s96, 1
    s_lshl3_add_u32 s98, s12, s97
    s_and_b32 s99, s21, 1
    s_add_u32 s96, s98, s99
    s_mul_i32 s97, s96, 7168
    s_add_u32 s20, s97, 22020096
    s_lshl_b32 s96, s17, 11
    s_lshl_b32 s97, s12, 7
    s_add_u32 s98, s96, s97
    s_lshl_b32 s99, s19, 5
    s_add_u32 s82, s98, s99
    v_and_b32 v10, 7, v1
    v_lshlrev_b32 v10, 2, v10
    s_lshl_b32 s96, s19, 5
    s_add_u32 s13, s96, 139264
    v_add_u32 v5, s13, v10
    ds_read_b32 v74, v5
    s_lshr_b32 s96, s17, 7
    s_bfe_u32 s97, s18, 65538
    s_lshl1_add_u32 s98, s96, s97
    s_lshl_b32 s99, s98, 14
    s_lshl_b32 s96, s12, 8
    s_add_u32 s97, s99, s96
    s_lshl_b32 s98, s19, 6
    s_add_u32 s99, s97, s98
    s_add_u32 s68, s99, 33554432
    s_add_u32 s69, s68, 4096
    v_and_b32 v11, 7, v1
    v_lshlrev_b32 v11, 3, v11
    buffer_load_dwordx2 v[20:21], v11, s[32:35], s68 offen sc1
    buffer_load_dwordx2 v[72:73], v11, s[32:35], s69 offen sc1
    s_and_b32 s13, s18, s6
    s_ashr_i32 s15, s13, 31
    s_andn2_b32 s15, 0x7fff0000, s15
    s_or_b32 s15, s15, 0x80000000
    s_xor_b32 s13, s13, s15
    v_mov_b32 v75, s13
    v_mul_f32 v75, s7, v75
    v_exp_f32 v75, -v75
    s_nop 0
    v_add_f32 v75, 1.0, v75
    v_rcp_f32 v75, v75
    s_nop 0
    v_cvt_pk_bf16_f32 v75, 0, v75
L_NOFZ:
    s_cmp_lt_u32 s9, 28
    s_cbranch_scc1 L_HSEC
    s_branch L_GSEC
L_HSEC:
    s_cmp_lt_u32 s3, 4
    s_cbranch_scc1 L_HW
    s_branch L_NOH
L_HW:
    s_lshl_b32 s96, s3, 8
    s_add_u32 s13, s96, s14
    v_lshrrev_b32 v4, 4, v1
    v_lshlrev_b32 v4, 11, v4
    v_and_b32 v9, 15, v1
    v_lshl_add_u32 v4, v9, 4, v4
    s_lshl_b32 s96, s3, 5
    s_add_u32 s15, s96, 138752
    v_lshrrev_b32 v5, 5, v1
    v_lshl_add_u32 v5, v5, 7, s15
    v_bfe_u32 v9, v1, 2, 1
    v_lshl_add_u32 v5, v9, 4, v5
    v_bfe_u32 v9, v1, 1, 1
    v_lshl_add_u32 v5, v9, 3, v5
    v_bfe_u32 v9, v1, 3, 1
    v_lshl_add_u32 v5, v9, 2, v5
    v_and_b32 v9, 1, v1
    v_lshl_add_u32 v5, v9, 1, v5
    s_cmp_lg_u32 s93, 0
    s_cbranch_scc1 L_HLOC
SPOLL_54:
    s_load_dword s24, s[32:33], s13 offset:1276 glc
    s_load_dword s25, s[32:33], s13 offset:3324 glc
    s_load_dword s26, s[32:33], s13 offset:5372 glc
    s_load_dword s27, s[32:33], s13 offset:7420 glc
SCHK_55:
    s_add_u32 s5, s5, 1
    s_cmp_ge_u32 s5, 300000
    s_waitcnt lgkmcnt(0)
    s_cbranch_scc1 SDONE_56
    s_cmp_lg_u32 s24, s4
    s_cbranch_scc1 SPOLL_54
    s_cmp_lg_u32 s25, s4
    s_cbranch_scc1 SPOLL_54
    s_cmp_lg_u32 s26, s4
    s_cbranch_scc1 SPOLL_54
    s_cmp_lg_u32 s27, s4
    s_cbranch_scc1 SPOLL_54
SDONE_56:
L_HLOC:
    buffer_load_dwordx4 v[212:215], v4, s[32:35], s13 offen sc1
    buffer_load_dwordx4 v[216:219], v4, s[32:35], s13 offen offset:1024 sc1
    s_waitcnt vmcnt(0)
    v_bitop3_b32 v6, v213, v215, s4 bitop3:0x7e
    v_bitop3_b32 v6, v6, v217, s4 bitop3:0xf6
    v_bitop3_b32 v6, v6, v219, s4 bitop3:0xf6
    v_cmp_ne_u32 vcc, 0, v6
    s_cbranch_vccz TOK_58
POLL_59:
    buffer_load_dwordx4 v[212:215], v4, s[32:35], s13 offen sc1
    buffer_load_dwordx4 v[216:219], v4, s[32:35], s13 offen offset:1024 sc1
    s_waitcnt vmcnt(0)
    v_bitop3_b32 v6, v213, v215, s4 bitop3:0x7e
    v_bitop3_b32 v6, v6, v217, s4 bitop3:0xf6
    v_bitop3_b32 v6, v6, v219, s4 bitop3:0xf6
    v_cmp_ne_u32 vcc, 0, v6
    s_cbranch_vccz PDONE_60
    s_add_u32 s5, s5, 1
    s_cmp_lt_u32 s5, 300000
    s_cbranch_scc1 POLL_59
PDONE_60:
TOK_58:
    v_permlane32_swap_b32 v212, v214
    v_permlane32_swap_b32 v216, v218
    v_add_f32 v212, v212, v214
    v_add_f32 v216, v216, v218
    v_mov_b32 v214, v212
    v_mov_b32 v218, v216
    s_nop 0
    v_permlane16_swap_b32 v212, v214
    v_permlane16_swap_b32 v216, v218
    v_add_f32 v212, v212, v214
    v_add_f32 v216, v216, v218
    v_cvt_pk_bf16_f32 v212, 0, v212
    v_cvt_pk_bf16_f32 v216, 0, v216
    v_mul_f32 v6, s7, v212
    v_exp_f32 v6, -v6
    s_nop 0
    v_add_f32 v6, 1.0, v6
    v_rcp_f32 v6, v6
    s_nop 0
    v_mul_f32 v212, v212, v6
    v_cvt_pk_bf16_f32 v212, 0, v212
    v_mul_f32 v212, v212, v216
    v_cvt_pk_bf16_f32 v212, v212, v212
    ds_write_b16 v5, v212
L_NOH:
    v_bfe_u32 v4, v1, 2, 1
    v_lshlrev_b32 v4, 7, v4
    v_lshrrev_b32 v9, 5, v1
    v_lshl_add_u32 v4, v9, 4, v4
    v_add_u32 v4, 138752, v4
    v_lshrrev_b32 v5, 4, v1
    v_mul_u32_u24 v5, 7168, v5
    v_and_b32 v9, 15, v1
    v_lshl_add_u32 v5, v9, 3, v5
    v_and_b32 v6, 1, v1
    v_lshlrev_b32 v6, 18, v6
    v_bfe_u32 v9, v1, 1, 1
    v_lshl_add_u32 v6, v9, 13, v6
    s_lshl3_add_u32 s96, s75, s3
    s_mul_i32 s97, s96, 28672
    s_lshl_b32 s98, s74, 7
    s_add_u32 s99, s97, s98
    s_add_u32 s13, s99, 22020096
    s_lshr_b32 s96, s9, 2
    s_and_b32 s97, s75, 1
    s_lshr_b32 s98, s3, 1
    s_lshl2_add_u32 s99, s97, s98
    s_and_b32 s97, s3, 1
    s_lshl_b32 s98, s97, 2
    s_lshl3_add_u32 s97, s99, s98
    s_lshr_b32 s99, s75, 1
    s_add_u32 s98, s97, s99
    s_lshl_b32 s97, s98, 12
    s_lshl_b32 s99, s8, 6
    s_add_u32 s98, s97, s99
    s_lshl2_add_u32 s97, s96, s98
    s_add_u32 s99, s97, 1048576
    s_add_u32 s14, s99, 3072
    s_waitcnt vmcnt(0)
    s_waitcnt lgkmcnt(0)
    s_barrier
    ds_read_b128 v[212:215], v4
    ds_read_b64_tr_b16 v[196:197], v45
    ds_read_b64_tr_b16 v[198:199], v45 offset:1024
    ds_read_b128 v[216:219], v4 offset:32
    ds_read_b64_tr_b16 v[200:201], v45 offset:8192
    ds_read_b64_tr_b16 v[202:203], v45 offset:9216
    ds_read_b128 v[220:223], v4 offset:64
    ds_read_b64_tr_b16 v[204:205], v45 offset:16384
    ds_read_b64_tr_b16 v[206:207], v45 offset:17408
    ds_read_b128 v[224:227], v4 offset:96
    ds_read_b64_tr_b16 v[208:209], v45 offset:24576
    ds_read_b64_tr_b16 v[210:211], v45 offset:25600
    s_waitcnt lgkmcnt(9)
    v_mfma_f32_32x32x16_bf16 v[228:243], v[212:215], v[196:199], 0
    s_waitcnt lgkmcnt(6)
    v_mfma_f32_32x32x16_bf16 v[228:243], v[216:219], v[200:203], v[228:243]
    s_waitcnt lgkmcnt(3)
    v_mfma_f32_32x32x16_bf16 v[228:243], v[220:223], v[204:207], v[228:243]
    s_waitcnt lgkmcnt(0)
    v_mfma_f32_32x32x16_bf16 v[228:243], v[224:227], v[208:211], v[228:243]
    s_nop 11
    v_mov_b32 v229, s4
    buffer_store_dwordx2 v[228:229], v5, s[32:35], s13 offen sc1
    s_mov_b64 exec, 15
    buffer_store_dword v229, v6, s[32:35], s14 offen sc1
    s_mov_b64 exec, -1
    s_waitcnt lgkmcnt(0)
L_GSEC:
    s_lshl_b32 s96, s21, 7
    s_lshl4_add_u32 s13, s3, s96
    v_lshrrev_b32 v22, 3, v1
    v_lshl_add_u32 v22, v22, 0, s13
    s_lshl_b32 s96, s13, 11
    s_lshl_b32 s97, s12, 7
    s_add_u32 s15, s96, s97
    s_add_u32 s16, s15, 16384
    v_lshrrev_b32 v25, 3, v1
    v_lshlrev_b32 v25, 11, v25
    v_and_b32 v9, 7, v1
    v_lshl_add_u32 v25, v9, 4, v25
    v_cmp_ne_u32 vcc, s70, v22
    v_cmp_ne_u32 s[22:23], s71, v22
    s_nop 0
    s_and_b64 exec, vcc, s[22:23]
    buffer_store_dwordx4 v[140:143], v25, s[64:67], s15 offen sc1
    s_mov_b64 exec, -1
    v_add_u32 v22, 8, v22
    v_cmp_ne_u32 vcc, s70, v22
    v_cmp_ne_u32 s[22:23], s71, v22
    s_nop 0
    s_and_b64 exec, vcc, s[22:23]
    buffer_store_dwordx4 v[144:147], v25, s[64:67], s16 offen sc1
    s_mov_b64 exec, -1
    s_cmp_lt_u32 s9, 16
    s_cbranch_scc1 L_GF
    s_cmp_ge_u32 s9, 28
    s_cbranch_scc1 L_FIN
    s_waitcnt vmcnt(0)
    s_mov_b32 exec_lo, 0xffff
    s_mov_b32 exec_hi, 0xffff
    buffer_store_dwordx2 v[56:57], v58, s[32:35], 0 offen sc1
    s_mov_b64 exec, -1
    s_branch L_FIN
L_GF:
SPOLL_61:
    s_load_dwordx8 s[24:31], s[32:33], s92 offset:3072 glc
SCHK_62:
    s_add_u32 s5, s5, 1
    s_cmp_ge_u32 s5, 300000
    s_waitcnt lgkmcnt(0)
    s_cbranch_scc1 SDONE_63
    s_cmp_lg_u32 s24, s4
    s_cbranch_scc1 SPOLL_61
    s_cmp_lg_u32 s25, s4
    s_cbranch_scc1 SPOLL_61
    s_cmp_lg_u32 s26, s4
    s_cbranch_scc1 SPOLL_61
    s_cmp_lg_u32 s27, s4
    s_cbranch_scc1 SPOLL_61
    s_cmp_lg_u32 s28, s4
    s_cbranch_scc1 SPOLL_61
    s_cmp_lg_u32 s29, s4
    s_cbranch_scc1 SPOLL_61
    s_cmp_lg_u32 s30, s4
    s_cbranch_scc1 SPOLL_61
SDONE_63:
    s_barrier
    s_cmp_eq_u32 s3, 7
    s_cbranch_scc1 L_G7
    s_barrier
    s_mov_b32 exec_lo, 0xffff
    s_mov_b32 exec_hi, 0xffff
    buffer_store_dwordx2 v[56:57], v58, s[32:35], 0 offen sc1
    s_mov_b64 exec, -1
    s_branch L_FIN
L_G7:
    s_cmp_lg_u32 s3, 7
    s_cbranch_scc1 L_FIN
    s_add_u32 s13, s20, 4096
POLL_64:
    buffer_load_dwordx4 v[212:215], v2, s[32:35], s20 offen sc1
    buffer_load_dwordx4 v[216:219], v2, s[32:35], s20 offen offset:1024 sc1
    buffer_load_dwordx4 v[220:223], v2, s[32:35], s20 offen offset:2048 sc1
    buffer_load_dwordx4 v[224:227], v2, s[32:35], s20 offen offset:3072 sc1
    buffer_load_dwordx4 v[148:151], v2, s[32:35], s13 offen sc1
    buffer_load_dwordx4 v[152:155], v2, s[32:35], s13 offen offset:1024 sc1
    buffer_load_dwordx4 v[156:159], v2, s[32:35], s13 offen offset:2048 sc1
    s_waitcnt vmcnt(0)
    v_bitop3_b32 v4, v213, v215, s4 bitop3:0x7e
    v_bitop3_b32 v4, v4, v217, s4 bitop3:0xf6
    v_bitop3_b32 v4, v4, v219, s4 bitop3:0xf6
    v_bitop3_b32 v4, v4, v221, s4 bitop3:0xf6
    v_bitop3_b32 v4, v4, v223, s4 bitop3:0xf6
    v_bitop3_b32 v4, v4, v225, s4 bitop3:0xf6
    v_bitop3_b32 v4, v4, v227, s4 bitop3:0xf6
    v_bitop3_b32 v4, v4, v149, s4 bitop3:0xf6
    v_bitop3_b32 v4, v4, v151, s4 bitop3:0xf6
    v_bitop3_b32 v4, v4, v153, s4 bitop3:0xf6
    v_bitop3_b32 v4, v4, v155, s4 bitop3:0xf6
    v_bitop3_b32 v4, v4, v157, s4 bitop3:0xf6
    v_bitop3_b32 v4, v4, v159, s4 bitop3:0xf6
    v_cmp_ne_u32 vcc, 0, v4
    s_cbranch_vccz PDONE_65
    s_add_u32 s5, s5, 1
    s_cmp_lt_u32 s5, 300000
    s_cbranch_scc1 POLL_64
PDONE_65:
    v_bitop3_b32 v4, v21, v73, s4 bitop3:0x7e
    v_cmp_ne_u32 vcc, 0, v4
    s_cbranch_vccz TOK_66
POLL_67:
    buffer_load_dwordx2 v[20:21], v11, s[32:35], s68 offen sc1
    buffer_load_dwordx2 v[72:73], v11, s[32:35], s69 offen sc1
    s_waitcnt vmcnt(0)
    v_bitop3_b32 v4, v21, v73, s4 bitop3:0x7e
    v_cmp_ne_u32 vcc, 0, v4
    s_cbranch_vccz PDONE_68
    s_add_u32 s5, s5, 1
    s_cmp_lt_u32 s5, 300000
    s_cbranch_scc1 POLL_67
PDONE_68:
TOK_66:
    s_barrier
    v_add_f32 v212, v212, v216
    v_add_f32 v214, v214, v218
    v_add_f32 v220, v220, v224
    v_add_f32 v222, v222, v226
    v_add_f32 v148, v148, v152
    v_add_f32 v150, v150, v154
    v_add_f32 v212, v212, v220
    v_add_f32 v214, v214, v222
    v_add_f32 v148, v148, v156
    v_add_f32 v150, v150, v158
    v_add_f32 v212, v212, v148
    v_add_f32 v214, v214, v150
    v_mov_b32 v213, v214
    v_add_f32_dpp v212, v212, v212 row_ror:8 row_mask:0xf bank_mask:0xf
    s_nop 0
    v_add_f32_dpp v213, v213, v213 row_ror:8 row_mask:0xf bank_mask:0xf
    v_mov_b32 v214, v212
    v_mov_b32 v215, v213
    s_nop 0
    v_permlane16_swap_b32 v212, v214
    v_permlane16_swap_b32 v213, v215
    v_pk_add_f32 v[212:213], v[212:213], v[214:215]
    v_mov_b32 v214, v212
    v_mov_b32 v215, v213
    s_nop 0
    v_permlane32_swap_b32 v212, v214
    v_permlane32_swap_b32 v213, v215
    v_pk_add_f32 v[212:213], v[212:213], v[214:215]
    v_cvt_pk_bf16_f32 v212, 0, v212
    v_cvt_pk_bf16_f32 v213, 0, v213
    v_pk_mul_f32 v[212:213], v[212:213], v[74:75] op_sel:[0,1]
    v_lshlrev_b32 v4, 16, v20
    v_and_b32 v5, s6, v20
    v_cvt_pk_bf16_f32 v212, 0, v212
    v_cvt_pk_bf16_f32 v213, 0, v213
    v_pk_add_f32 v[212:213], v[212:213], v[4:5]
    v_lshlrev_b32 v4, 16, v74
    v_and_b32 v5, s6, v74
    v_cvt_pk_bf16_f32 v212, 0, v212
    v_cvt_pk_bf16_f32 v213, 0, v213
    v_pk_mul_f32 v[212:213], v[212:213], v[4:5]
    v_lshlrev_b32 v4, 16, v72
    v_and_b32 v5, s6, v72
    v_cvt_pk_bf16_f32 v212, 0, v212
    v_cvt_pk_bf16_f32 v213, 0, v213
    v_pk_add_f32 v[212:213], v[212:213], v[4:5]
    v_cvt_pk_bf16_f32 v212, v212, v213
    s_mov_b64 exec, 0xff
    buffer_store_dword v212, v10, s[64:67], s82 offen sc1
    s_mov_b64 exec, -1
    s_mov_b32 exec_lo, 0xffff
    s_mov_b32 exec_hi, 0xffff
    buffer_store_dwordx2 v[56:57], v58, s[32:35], 0 offen sc1
    s_mov_b64 exec, -1
L_FIN:
L_END:
    s_endpgm
.p2align 10
.fill 768, 4, 0xbf800000
.section .rodata,"a"
.p2align 6
.amdhsa_kernel adaLN_cond__linear_kernel_hedgehog__moe_arch_mod__prompt_kernel
  .amdhsa_next_free_vgpr 256
  .amdhsa_next_free_sgpr 102
  .amdhsa_accum_offset 256
  .amdhsa_group_segment_fixed_size 0
  .amdhsa_kernarg_size 112
  .amdhsa_user_sgpr_count 2
  .amdhsa_user_sgpr_kernarg_segment_ptr 1
  .amdhsa_system_sgpr_workgroup_id_x 1
  .amdhsa_float_denorm_mode_32 3
  .amdhsa_float_denorm_mode_16_64 3
.end_amdhsa_kernel
```

```asm
; @launch grid=(256,1,1) block=(512,1,1) lds=163840
.amdgcn_target "amdgcn-amd-amdhsa--gfx950"
.text
.globl adaLN_cond__linear_kernel_hedgehog__moe_arch_mod__prompt_kernel
.p2align 8
.type adaLN_cond__linear_kernel_hedgehog__moe_arch_mod__prompt_kernel,@function
adaLN_cond__linear_kernel_hedgehog__moe_arch_mod__prompt_kernel:
    s_load_dwordx16 s[68:83], s[0:1], 0
    s_load_dwordx8 s[84:91], s[0:1], 64
    s_load_dwordx2 s[32:33], s[0:1], 104
    s_load_dwordx2 s[30:31], s[0:1], 96
    s_cmp_ge_u32 s2, 256
    s_cbranch_scc1 L_END
    v_lshrrev_b32 v4, 6, v0
    v_and_b32 v1, 63, v0
    v_mov_b32 v3, 0
    v_readfirstlane_b32 s3, v4
    v_lshlrev_b32 v2, 4, v1
    s_and_b32 s8, s2, 7
    s_lshr_b32 s9, s2, 3
    s_lshl2_add_u32 s96, s8, s3
    s_lshl_b32 s15, s96, 6
    s_mul_i32 s96, s15, 6144
    s_xor_b32 s97, s9, 1
    s_lshl_b32 s98, s97, 7
    s_add_u32 s13, s96, s98
    v_lshrrev_b32 v60, 3, v1
    v_mul_u32_u24 v60, 49152, v60
    v_and_b32 v9, 7, v1
    v_lshl_add_u32 v60, v9, 4, v60
    v_lshrrev_b32 v61, 3, v1
    v_lshl_add_u32 v61, v61, 3, s15
    s_lshl_b32 s96, s8, 5
    s_add_u32 s97, s96, s9
    s_lshl2_add_u32 s98, s97, s3
    s_sub_u32 s99, s98, 4
    s_lshl_b32 s16, s99, 12
    s_mov_b32 s50, 12582912
    s_mov_b32 s51, 0x20000
    s_mov_b32 s38, 4194304
    s_mov_b32 s39, 0x20000
    s_mov_b32 s34, 268435456
    s_mov_b32 s35, 0x20000
    s_getreg_b32 s94, hwreg(HW_REG_XCC_ID, 0, 3)
    s_getpc_b64 s[22:23]
    s_mul_i32 s96, s9, 7
    s_add_u32 s97, s96, s3
    s_lshl_b32 s19, s97, 7
    v_lshrrev_b32 v10, 5, v1
    v_mul_u32_u24 v10, 28672, v10
    v_add_u32 v10, s19, v10
    v_min_u32 v10, 44032, v10
    s_cmp_ge_u32 s3, 4
    s_waitcnt lgkmcnt(0)
    s_mov_b64 s[48:49], s[88:89]
    s_mov_b64 s[36:37], s[68:69]
    s_load_dword s4, s[32:33], 0
    s_cbranch_scc1 L_FS
    global_load_dwordx2 v[96:97], v61, s[86:87]
    buffer_load_dwordx4 v[80:83], v60, s[48:51], s13 offen nt
    s_add_u32 s13, s13, 12288
    buffer_load_dwordx4 v[84:87], v60, s[48:51], s13 offen nt
    s_add_u32 s13, s13, 12288
    buffer_load_dwordx4 v[88:91], v60, s[48:51], s13 offen nt
    s_add_u32 s13, s13, 12288
    buffer_load_dwordx4 v[92:95], v60, s[48:51], s13 offen nt
    s_barrier
    s_barrier
    s_and_b32 s22, s22, 0xfffffc00
    global_load_dword v78, v10, s[22:23]
    s_mov_b32 s42, 6291456
    s_mov_b32 s43, 0x20000
    s_mov_b32 s46, 2097152
    s_mov_b32 s47, 0x20000
    s_mov_b32 s54, 7340032
    s_mov_b32 s55, 0x20000
    s_mov_b32 s58, 7340032
    s_mov_b32 s59, 0x20000
    s_mov_b32 s62, 7340032
    s_mov_b32 s63, 0x20000
    s_mov_b32 s66, 4194304
    s_mov_b32 s67, 0x20000
    s_mov_b64 s[40:41], s[70:71]
    s_mov_b64 s[44:45], s[74:75]
    s_mov_b64 s[52:53], s[80:81]
    s_mov_b64 s[56:57], s[82:83]
    s_mov_b64 s[60:61], s[84:85]
    s_mov_b64 s[64:65], s[90:91]
    s_mov_b32 s5, 0
    s_mov_b32 s6, 0xffff0000
    s_mov_b32 s7, 0x3fb8aa3b
    s_lshr_b32 s76, s3, 2
    v_bfe_u32 v6, v1, 4, 1
    v_lshlrev_b32 v6, 6, v6
    v_and_b32 v62, 7, v1
    v_lshlrev_b32 v62, 4, v62
    v_xor_b32 v62, v62, v6
    v_lshrrev_b32 v6, 3, v1
    v_mul_u32_u24 v6, 6144, v6
    v_add_u32 v62, v62, v6
    v_lshlrev_b32 v63, 3, v1
    v_add_u32 v64, 149760, v2
    s_and_b32 s96, s3, 3
    s_lshl2_add_u32 s13, s96, 149760
    v_lshrrev_b32 v65, 4, v1
    v_lshl_add_u32 v65, v65, 5, s13
    v_and_b32 v9, 7, v1
    v_lshl_add_u32 v65, v9, 7, v65
    v_bfe_u32 v9, v1, 3, 1
    v_lshl_add_u32 v65, v9, 4, v65
    s_and_b32 s96, s8, 6
    s_and_b32 s97, s8, 1
    s_lshr_b32 s98, s9, 4
    s_lshl1_add_u32 s99, s97, s98
    s_lshl_b32 s97, s99, 6
    s_add_u32 s98, s96, s97
    s_lshl3_add_u32 s99, s3, s98
    s_lshl_b32 s96, s99, 10
    s_and_b32 s97, s9, 15
    s_lshl_b32 s98, s97, 6
    s_add_u32 s99, s96, s98
    s_add_u32 s14, s99, 262144
    s_xor_b32 s96, s9, 1
    s_and_b32 s97, s96, 15
    s_lshl4_add_u32 s98, s3, s97
    s_lshr_b32 s99, s9, 4
    s_lshl1_add_u32 s96, s98, s99
    s_lshl3_add_u32 s97, s96, s8
    s_lshl_b32 s98, s97, 9
    s_add_u32 s13, s98, 524288
    s_lshr_b32 s96, s9, 4
    s_xor_b32 s97, s9, 1
    s_and_b32 s98, s97, 7
    s_lshl_b32 s99, s3, 1
    s_lshl3_add_u32 s97, s98, s99
    s_bfe_u32 s98, s9, 65539
    s_add_u32 s99, s97, s98
    s_lshl_b32 s97, s99, 9
    s_lshl_b32 s98, s8, 6
    s_add_u32 s99, s97, s98
    s_lshl2_add_u32 s97, s96, s99
    s_add_u32 s15, s97, 2097152
    v_and_b32 v10, 3, v1
    v_lshlrev_b32 v10, 15, v10
    s_waitcnt vmcnt(5)
    v_lshlrev_b32 v98, 16, v97
    v_and_b32 v99, s6, v97
    v_and_b32 v97, s6, v96
    v_lshlrev_b32 v96, 16, v96
    v_mul_f32 v4, s7, v96
    v_exp_f32 v4, -v4
    s_nop 0
    v_add_f32 v4, 1.0, v4
    v_rcp_f32 v4, v4
    s_nop 0
    v_mul_f32 v96, v96, v4
    v_cvt_pk_bf16_f32 v96, 0, v96
    v_mul_f32 v5, s7, v97
    v_exp_f32 v5, -v5
    s_nop 0
    v_add_f32 v5, 1.0, v5
    v_rcp_f32 v5, v5
    s_nop 0
    v_mul_f32 v97, v97, v5
    v_cvt_pk_bf16_f32 v97, 0, v97
    v_mul_f32 v4, s7, v98
    v_exp_f32 v4, -v4
    s_nop 0
    v_add_f32 v4, 1.0, v4
    v_rcp_f32 v4, v4
    s_nop 0
    v_mul_f32 v98, v98, v4
    v_cvt_pk_bf16_f32 v98, 0, v98
    v_mul_f32 v5, s7, v99
    v_exp_f32 v5, -v5
    s_nop 0
    v_add_f32 v5, 1.0, v5
    v_rcp_f32 v5, v5
    s_nop 0
    v_mul_f32 v99, v99, v5
    v_cvt_pk_bf16_f32 v99, 0, v99
    s_waitcnt vmcnt(4)
    v_lshlrev_b32 v4, 16, v80
    v_and_b32 v5, s6, v80
    v_pk_mul_f32 v[20:21], v[4:5], v[96:97] op_sel:[0,0] op_sel_hi:[1,0]
    v_lshlrev_b32 v6, 16, v81
    v_and_b32 v7, s6, v81
    v_pk_mul_f32 v[22:23], v[6:7], v[96:97] op_sel:[0,0] op_sel_hi:[1,0]
    v_lshlrev_b32 v4, 16, v82
    v_and_b32 v5, s6, v82
    v_pk_mul_f32 v[24:25], v[4:5], v[96:97] op_sel:[0,0] op_sel_hi:[1,0]
    v_lshlrev_b32 v6, 16, v83
    v_and_b32 v7, s6, v83
    v_pk_mul_f32 v[26:27], v[6:7], v[96:97] op_sel:[0,0] op_sel_hi:[1,0]
    s_waitcnt vmcnt(3)
    v_lshlrev_b32 v4, 16, v84
    v_and_b32 v5, s6, v84
    v_pk_fma_f32 v[20:21], v[4:5], v[96:97], v[20:21] op_sel:[0,1,0] op_sel_hi:[1,1,1]
    v_lshlrev_b32 v6, 16, v85
    v_and_b32 v7, s6, v85
    v_pk_fma_f32 v[22:23], v[6:7], v[96:97], v[22:23] op_sel:[0,1,0] op_sel_hi:[1,1,1]
    v_lshlrev_b32 v4, 16, v86
    v_and_b32 v5, s6, v86
    v_pk_fma_f32 v[24:25], v[4:5], v[96:97], v[24:25] op_sel:[0,1,0] op_sel_hi:[1,1,1]
    v_lshlrev_b32 v6, 16, v87
    v_and_b32 v7, s6, v87
    v_pk_fma_f32 v[26:27], v[6:7], v[96:97], v[26:27] op_sel:[0,1,0] op_sel_hi:[1,1,1]
    s_waitcnt vmcnt(2)
    v_lshlrev_b32 v4, 16, v88
    v_and_b32 v5, s6, v88
    v_pk_fma_f32 v[20:21], v[4:5], v[98:99], v[20:21] op_sel:[0,0,0] op_sel_hi:[1,0,1]
    v_lshlrev_b32 v6, 16, v89
    v_and_b32 v7, s6, v89
    v_pk_fma_f32 v[22:23], v[6:7], v[98:99], v[22:23] op_sel:[0,0,0] op_sel_hi:[1,0,1]
    v_lshlrev_b32 v4, 16, v90
    v_and_b32 v5, s6, v90
    v_pk_fma_f32 v[24:25], v[4:5], v[98:99], v[24:25] op_sel:[0,0,0] op_sel_hi:[1,0,1]
    v_lshlrev_b32 v6, 16, v91
    v_and_b32 v7, s6, v91
    v_pk_fma_f32 v[26:27], v[6:7], v[98:99], v[26:27] op_sel:[0,0,0] op_sel_hi:[1,0,1]
    s_waitcnt vmcnt(1)
    v_lshlrev_b32 v4, 16, v92
    v_and_b32 v5, s6, v92
    v_pk_fma_f32 v[20:21], v[4:5], v[98:99], v[20:21] op_sel:[0,1,0] op_sel_hi:[1,1,1]
    v_lshlrev_b32 v6, 16, v93
    v_and_b32 v7, s6, v93
    v_pk_fma_f32 v[22:23], v[6:7], v[98:99], v[22:23] op_sel:[0,1,0] op_sel_hi:[1,1,1]
    v_lshlrev_b32 v4, 16, v94
    v_and_b32 v5, s6, v94
    v_pk_fma_f32 v[24:25], v[4:5], v[98:99], v[24:25] op_sel:[0,1,0] op_sel_hi:[1,1,1]
    v_lshlrev_b32 v6, 16, v95
    v_and_b32 v7, s6, v95
    v_pk_fma_f32 v[26:27], v[6:7], v[98:99], v[26:27] op_sel:[0,1,0] op_sel_hi:[1,1,1]
    v_permlane32_swap_b32 v20, v24
    v_permlane32_swap_b32 v21, v25
    v_permlane32_swap_b32 v22, v26
    v_permlane32_swap_b32 v23, v27
    v_add_f32 v20, v20, v24
    v_add_f32 v21, v21, v25
    v_add_f32 v22, v22, v26
    v_add_f32 v23, v23, v27
    s_nop 0
    v_permlane16_swap_b32 v20, v22
    v_permlane16_swap_b32 v21, v23
    v_add_f32 v20, v20, v22
    v_add_f32 v21, v21, v23
    s_nop 0
    v_add_f32_dpp v20, v20, v20 row_ror:8 row_mask:0xf bank_mask:0xf
    v_add_f32_dpp v21, v21, v21 row_ror:8 row_mask:0xf bank_mask:0xf
    s_nop 1
    v_mov_b32_dpp v20, v21 quad_perm:[0,1,2,3] row_mask:0xf bank_mask:0xc
    ds_write_b32 v65, v20
    s_waitcnt lgkmcnt(0)
    s_barrier
    ds_read_b128 v[20:23], v64 offset:0
    s_mul_i32 s4, s4, 0x9e3779b1
    s_add_u32 s4, s4, 0x7f4a7c15
    s_waitcnt lgkmcnt(0)
    v_pk_add_f32 v[20:21], v[20:21], v[22:23]
    v_add_f32 v20, v20, v21
    v_mov_b32 v21, s4
    buffer_store_dwordx2 v[20:21], v63, s[32:35], s13 offen sc1
    s_mov_b64 exec, 15
    buffer_store_dword v21, v10, s[32:35], s15 offen sc1
    s_mov_b64 exec, -1
    s_branch L_FJ
L_FS:
    s_barrier
    buffer_load_dwordx4 v[80:83], v2, s[36:39], s16 offen
    buffer_load_dwordx4 v[84:87], v2, s[36:39], s16 offen offset:1024
    buffer_load_dwordx4 v[88:91], v2, s[36:39], s16 offen offset:2048
    buffer_load_dwordx4 v[92:95], v2, s[36:39], s16 offen offset:3072
    s_lshl2_add_u32 s96, s2, s3
    s_sub_u32 s97, s96, 4
    s_lshl_b32 s98, s97, 7
    s_add_u32 s17, s98, 2097152
    s_load_dword s24, s[32:33], s17 offset:0 glc
    s_load_dword s25, s[32:33], s17 offset:64 glc
    s_lshl_b32 s96, s2, 5
    s_add_u32 s97, s96, s3
    s_sub_u32 s98, s97, 4
    s_lshl_b32 s99, s98, 7
    s_add_u32 s17, s99, 1048576
    s_load_dword s24, s[32:33], s17 offset:0 glc
    s_load_dword s25, s[32:33], s17 offset:64 glc
    s_lshl_b32 s19, s94, 5
    v_mov_b32 v78, 1
    v_mov_b32 v79, s19
    s_barrier
    s_cmp_lg_u32 s3, 7
    s_cbranch_scc1 L_NOTK
    s_mov_b64 exec, 1
    global_atomic_add v78, v79, v78, s[30:31] sc0 sc1
    s_mov_b64 exec, -1
    s_branch L_TK0
L_NOTK:
    s_and_b32 s22, s22, 0xfffffc00
    global_load_dword v78, v10, s[22:23]
L_TK0:
    s_mov_b32 s42, 6291456
    s_mov_b32 s43, 0x20000
    s_mov_b32 s46, 2097152
    s_mov_b32 s47, 0x20000
    s_mov_b32 s54, 7340032
    s_mov_b32 s55, 0x20000
    s_mov_b32 s58, 7340032
    s_mov_b32 s59, 0x20000
    s_mov_b32 s62, 7340032
    s_mov_b32 s63, 0x20000
    s_mov_b32 s66, 4194304
    s_mov_b32 s67, 0x20000
    s_mov_b64 s[40:41], s[70:71]
    s_mov_b64 s[44:45], s[74:75]
    s_mov_b64 s[52:53], s[80:81]
    s_mov_b64 s[56:57], s[82:83]
    s_mov_b64 s[60:61], s[84:85]
    s_mov_b64 s[64:65], s[90:91]
    s_mov_b32 s5, 0
    s_mov_b32 s6, 0xffff0000
    s_mov_b32 s7, 0x3fb8aa3b
    s_lshr_b32 s76, s3, 2
    v_bfe_u32 v6, v1, 4, 1
    v_lshlrev_b32 v6, 6, v6
    v_and_b32 v62, 7, v1
    v_lshlrev_b32 v62, 4, v62
    v_xor_b32 v62, v62, v6
    v_lshrrev_b32 v6, 3, v1
    v_mul_u32_u24 v6, 6144, v6
    v_add_u32 v62, v62, v6
    v_lshlrev_b32 v63, 3, v1
    v_add_u32 v64, 149760, v2
    s_and_b32 s96, s3, 3
    s_lshl2_add_u32 s13, s96, 149760
    v_lshrrev_b32 v65, 4, v1
    v_lshl_add_u32 v65, v65, 5, s13
    v_and_b32 v9, 7, v1
    v_lshl_add_u32 v65, v9, 7, v65
    v_bfe_u32 v9, v1, 3, 1
    v_lshl_add_u32 v65, v9, 4, v65
    s_and_b32 s96, s8, 6
    s_and_b32 s97, s8, 1
    s_lshr_b32 s98, s9, 4
    s_lshl1_add_u32 s99, s97, s98
    s_lshl_b32 s97, s99, 6
    s_add_u32 s98, s96, s97
    s_lshl3_add_u32 s99, s3, s98
    s_lshl_b32 s96, s99, 10
    s_and_b32 s97, s9, 15
    s_lshl_b32 s98, s97, 6
    s_add_u32 s99, s96, s98
    s_add_u32 s14, s99, 262144
    s_sub_u32 s96, s3, 4
    s_lshl4_add_u32 s13, s96, 151808
    v_lshrrev_b32 v10, 5, v1
    v_lshl_add_u32 v10, v10, 3, s13
    s_barrier
    s_waitcnt vmcnt(1)
    s_waitcnt lgkmcnt(0)
    s_mul_i32 s4, s4, 0x9e3779b1
    s_add_u32 s4, s4, 0x7f4a7c15
    v_mov_b32 v104, 0x3f803f80
    v_dot2_f32_bf16 v100, v80, v104, 0
    v_dot2_f32_bf16 v102, v80, v80, 0
    v_dot2_f32_bf16 v101, v88, v104, 0
    v_dot2_f32_bf16 v103, v88, v88, 0
    v_dot2_f32_bf16 v100, v81, v104, v100
    v_dot2_f32_bf16 v102, v81, v81, v102
    v_dot2_f32_bf16 v101, v89, v104, v101
    v_dot2_f32_bf16 v103, v89, v89, v103
    v_dot2_f32_bf16 v100, v82, v104, v100
    v_dot2_f32_bf16 v102, v82, v82, v102
    v_dot2_f32_bf16 v101, v90, v104, v101
    v_dot2_f32_bf16 v103, v90, v90, v103
    v_dot2_f32_bf16 v100, v83, v104, v100
    v_dot2_f32_bf16 v102, v83, v83, v102
    v_dot2_f32_bf16 v101, v91, v104, v101
    v_dot2_f32_bf16 v103, v91, v91, v103
    v_dot2_f32_bf16 v100, v84, v104, v100
    v_dot2_f32_bf16 v102, v84, v84, v102
    v_dot2_f32_bf16 v101, v92, v104, v101
    v_dot2_f32_bf16 v103, v92, v92, v103
    v_dot2_f32_bf16 v100, v85, v104, v100
    v_dot2_f32_bf16 v102, v85, v85, v102
    v_dot2_f32_bf16 v101, v93, v104, v101
    v_dot2_f32_bf16 v103, v93, v93, v103
    v_dot2_f32_bf16 v100, v86, v104, v100
    v_dot2_f32_bf16 v102, v86, v86, v102
    v_dot2_f32_bf16 v101, v94, v104, v101
    v_dot2_f32_bf16 v103, v94, v94, v103
    v_dot2_f32_bf16 v100, v87, v104, v100
    v_dot2_f32_bf16 v102, v87, v87, v102
    v_dot2_f32_bf16 v101, v95, v104, v101
    v_dot2_f32_bf16 v103, v95, v95, v103
    s_nop 1
    v_permlane32_swap_b32 v100, v101
    v_permlane32_swap_b32 v102, v103
    v_add_f32 v100, v100, v101
    v_add_f32 v102, v102, v103
    s_nop 1
    v_permlane16_swap_b32 v100, v102
    v_add_f32 v100, v100, v102
    s_nop 1
    v_add_f32_dpp v100, v100, v100 quad_perm:[1,0,3,2] row_mask:0xf bank_mask:0xf
    s_nop 1
    v_add_f32_dpp v100, v100, v100 quad_perm:[2,3,0,1] row_mask:0xf bank_mask:0xf
    s_nop 1
    v_add_f32_dpp v100, v100, v100 row_half_mirror row_mask:0xf bank_mask:0xf
    s_nop 1
    v_add_f32_dpp v100, v100, v100 row_ror:8 row_mask:0xf bank_mask:0xf
    v_mul_f32 v102, 0x3a800000, v100
    v_mul_f32 v100, 0x3a800000, v100
    s_nop 1
    v_permlane16_swap_b32 v100, v102
    v_fma_f32 v117, -v100, v100, v102
    v_cvt_pk_bf16_f32 v116, 0, v100
    v_max_f32 v117, 0, v117
    v_cvt_pk_bf16_f32 v117, 0, v117
    v_add_f32 v117, 0x3727c5ac, v117
    v_cvt_pk_bf16_f32 v117, 0, v117
    v_sqrt_f32 v117, v117
    s_nop 0
    v_cvt_pk_bf16_f32 v117, 0, v117
    v_lshrrev_b32 v116, 16, v116
    v_or_b32 v116, v116, v117
    v_mov_b32 v117, s4
    ds_write_b64 v10, v[116:117]
L_FJ:
    v_and_b32 v5, 3, v1
    v_lshlrev_b32 v5, 4, v5
    v_add_u32 v5, 151808, v5
    v_and_b32 v4, 3, v1
    v_lshlrev_b32 v4, 4, v4
    v_bfe_u32 v9, v1, 2, 1
    v_lshl_add_u32 v4, v9, 10, v4
    v_and_b32 v10, 31, v1
    v_lshlrev_b32 v10, 11, v10
    v_lshrrev_b32 v9, 5, v1
    v_lshl_add_u32 v10, v9, 5, v10
    v_and_b32 v6, 1, v1
    v_lshlrev_b32 v6, 9, v6
    v_bfe_u32 v9, v1, 1, 1
    v_lshl_add_u32 v6, v9, 8, v6
    s_and_b32 s96, s9, 3
    s_and_b32 s97, s8, 6
    s_and_b32 s98, s8, 1
    s_lshr_b32 s99, s9, 4
    s_lshl1_add_u32 s98, s98, s99
    s_lshl_b32 s99, s98, 6
    s_add_u32 s98, s97, s99
    s_lshl3_add_u32 s97, s3, s98
    s_lshl_b32 s99, s97, 9
    s_bfe_u32 s98, s9, 131074
    s_lshl_b32 s97, s98, 6
    s_add_u32 s98, s99, s97
    s_lshl2_add_u32 s99, s96, s98
    s_add_u32 s97, s99, 16
    s_add_u32 s15, s97, 2097152
    s_waitcnt lgkmcnt(0)
    s_barrier
    ds_read_b128 v[116:119], v5
    s_waitcnt lgkmcnt(0)
    s_mov_b64 exec, 0xff
    buffer_store_dwordx4 v[116:119], v4, s[32:35], s14 offen sc1
    s_mov_b64 exec, 15
    buffer_store_dword v117, v6, s[32:35], s15 offen sc1
    s_mov_b64 exec, -1
    s_cmp_lg_u32 s3, 7
    s_cbranch_scc1 L_NOTK2
    s_mov_b32 s13, 0
    s_waitcnt vmcnt(2)
L_TK:
    v_readfirstlane_b32 s15, v78
    s_nop 0
    s_cmp_lt_u32 s15, 32
    s_cbranch_scc1 L_TKOK
    v_mov_b32 v78, s4
    s_mov_b64 exec, 1
    buffer_store_dword v78, v3, s[32:35], 0 offen offset:256 sc1
    s_mov_b64 exec, -1
    s_add_u32 s13, s13, 1
    s_cmp_lt_u32 s13, 8
    s_cbranch_scc0 L_TKNO
    s_add_u32 s94, s94, 1
    s_and_b32 s94, s94, 7
    s_lshl_b32 s19, s94, 5
    v_mov_b32 v78, 1
    v_mov_b32 v79, s19
    s_mov_b64 exec, 1
    global_atomic_add v78, v79, v78, s[30:31] sc0 sc1
    s_mov_b64 exec, -1
    s_waitcnt vmcnt(0)
    s_branch L_TK
L_TKNO:
    s_and_b32 s94, s2, 7
    s_lshr_b32 s15, s2, 3
L_TKOK:
    s_lshl3_add_u32 s15, s15, s94
    v_mov_b32 v78, s15
    ds_write_b32 v5, v78 offset:64
L_NOTK2:
    s_waitcnt lgkmcnt(0)
    s_barrier
    ds_read_b32 v120, v5 offset:64
    s_waitcnt lgkmcnt(0)
    v_readfirstlane_b32 s2, v120
    s_nop 0
    s_and_b32 s8, s2, 7
    s_lshr_b32 s9, s2, 3
    s_and_b32 s96, s8, 1
    s_and_b32 s97, s9, 7
    s_lshl3_add_u32 s12, s96, s97
    s_lshr_b32 s96, s8, 1
    s_lshr_b32 s97, s9, 3
    s_lshl2_add_u32 s21, s96, s97
    s_and_b32 s96, s3, 3
    s_lshl2_add_u32 s94, s21, s96
    s_lshl1_add_u32 s95, s12, s76
    s_lshl_b32 s96, s94, 16
    s_lshl_b32 s97, s95, 6
    s_add_u32 s18, s96, s97
    buffer_load_dwordx4 v[12:15], v10, s[36:39], s18 offen
    buffer_load_dwordx4 v[16:19], v10, s[36:39], s18 offen offset:16
    s_lshr_b32 s96, s8, 1
    s_lshl4_add_u32 s97, s96, s12
    s_lshl4_add_u32 s98, s97, s3
    s_lshl_b32 s99, s98, 9
    s_add_u32 s13, s99, 524288
    s_lshl3_add_u32 s96, s2, s3
    s_lshl_b32 s97, s96, 6
    s_add_u32 s15, s97, 2097152
    s_and_b32 s96, s3, 3
    s_lshl2_add_u32 s97, s2, s96
    s_lshl_b32 s98, s97, 8
    s_add_u32 s14, s98, 262144
    s_load_dwordx8 s[24:31], s[32:33], s15 offset:0 glc
    s_and_b32 s10, s9, 15
    s_lshr_b32 s96, s8, 2
    s_and_b32 s97, s8, 1
    s_lshl1_add_u32 s98, s96, s97
    s_and_b32 s99, s8, 2
    s_lshl2_add_u32 s96, s98, s99
    s_lshr_b32 s97, s9, 4
    s_add_u32 s11, s96, s97
    s_and_b32 s85, s9, 12
    s_lshl_b32 s96, s2, 6
    s_add_u32 s97, s96, s3
    s_lshl_b32 s98, s97, 6
    s_add_u32 s92, s98, 1048576
    s_lshr_b32 s96, s9, 4
    s_xor_b32 s77, s76, s96
    s_lshr_b32 s96, s9, 3
    s_xor_b32 s97, s96, s9
    s_and_b32 s98, s97, 1
    s_lshl2_add_u32 s83, s98, 8
    s_mul_i32 s96, s8, 7
    s_lshr_b32 s97, s9, 2
    s_add_u32 s74, s96, s97
    s_and_b32 s75, s9, 3
    v_and_b32 v8, 31, v1
    v_lshlrev_b32 v8, 3, v8
    v_and_b32 v4, 31, v1
    v_lshlrev_b32 v4, 4, v4
    v_lshrrev_b32 v9, 5, v1
    v_lshl_add_u32 v4, v9, 12, v4
    s_lshl2_add_u32 s16, s3, 152320
    v_lshl_add_u32 v5, v1, 6, s16
    s_lshl_b32 s96, s76, 10
    s_add_u32 s16, s96, 152320
    v_and_b32 v6, 15, v1
    v_lshl_add_u32 v6, v6, 5, s16
    v_lshrrev_b32 v9, 5, v1
    v_lshl_add_u32 v6, v9, 9, v6
    s_branch SCHK_2
SPOLL_1:
    s_load_dwordx8 s[24:31], s[32:33], s15 offset:0 glc
SCHK_2:
    s_add_u32 s5, s5, 1
    s_cmp_ge_u32 s5, 300000
    s_waitcnt lgkmcnt(0)
    s_cbranch_scc1 SDONE_3
    s_cmp_lg_u32 s24, s4
    s_cbranch_scc1 SPOLL_1
    s_cmp_lg_u32 s25, s4
    s_cbranch_scc1 SPOLL_1
    s_cmp_lg_u32 s28, s4
    s_cbranch_scc1 SPOLL_1
    s_cmp_lg_u32 s29, s4
    s_cbranch_scc1 SPOLL_1
    s_cmp_lg_u32 s30, s4
    s_cbranch_scc1 SPOLL_1
    s_cmp_lg_u32 s31, s4
    s_cbranch_scc1 SPOLL_1
SDONE_3:
    buffer_load_dwordx4 v[120:123], v4, s[32:35], s13 offen sc1
    buffer_load_dwordx2 v[116:117], v8, s[32:35], s14 offen sc1
    s_barrier
    s_lshl_b32 s96, s11, 12
    s_lshl_b32 s97, s3, 9
    s_add_u32 s16, s96, s97
    v_add_u32 v10, s16, v2
    s_lshl_b32 s96, s3, 9
    s_add_u32 m0, s96, 156416
    s_mov_b32 exec_hi, 0
    global_load_lds_dwordx4 v10, s[72:73]
    s_mov_b32 exec_hi, -1
    s_and_b32 s20, s9, 3
    s_add_u32 s96, s20, s85
    s_and_b32 s97, s96, 15
    s_lshl3_add_u32 s98, s97, s3
    s_mul_i32 s99, s98, 49152
    s_lshl_b32 s96, s11, 7
    s_add_u32 s82, s99, s96
    s_mul_i32 s96, s20, 24960
    s_lshr_b32 s97, s3, 1
    s_mul_i32 s98, s97, 2080
    s_add_u32 s99, s96, s98
    s_and_b32 s97, s3, 1
    s_mul_i32 s96, s97, 1056
    s_add_u32 s20, s99, s96
    s_mov_b32 m0, s20
    s_nop 0
    buffer_load_dwordx4 v62, s[40:43], s82 offen lds
    s_add_u32 s82, s82, 2048
    s_add_u32 m0, s20, 8320
    s_nop 0
    buffer_load_dwordx4 v62, s[40:43], s82 offen lds
    s_add_u32 s82, s82, 2048
    s_add_u32 m0, s20, 16640
    s_nop 0
    buffer_load_dwordx4 v62, s[40:43], s82 offen lds
    s_waitcnt vmcnt(5)
    v_bitop3_b32 v7, v121, v123, s4 bitop3:0x7e
    v_cmp_ne_u32 vcc, 0, v7
    s_cbranch_vccz TOK_5
POLL_6:
    buffer_load_dwordx4 v[120:123], v4, s[32:35], s13 offen sc1
    s_waitcnt vmcnt(0)
    v_bitop3_b32 v7, v121, v123, s4 bitop3:0x7e
    v_cmp_ne_u32 vcc, 0, v7
    s_cbranch_vccz PDONE_7
    s_add_u32 s5, s5, 1
    s_cmp_lt_u32 s5, 300000
    s_cbranch_scc1 POLL_6
PDONE_7:
TOK_5:
    ds_write2_b32 v5, v120, v122 offset0:0 offset1:8
    v_lshlrev_b32 v100, 16, v12
    v_and_b32 v101, s6, v12
    v_lshlrev_b32 v102, 16, v13
    v_and_b32 v103, s6, v13
    v_lshlrev_b32 v104, 16, v14
    v_and_b32 v105, s6, v14
    v_lshlrev_b32 v106, 16, v15
    v_and_b32 v107, s6, v15
    v_lshlrev_b32 v108, 16, v16
    v_and_b32 v109, s6, v16
    v_lshlrev_b32 v110, 16, v17
    v_and_b32 v111, s6, v17
    v_lshlrev_b32 v112, 16, v18
    v_and_b32 v113, s6, v18
    v_lshlrev_b32 v114, 16, v19
    v_and_b32 v115, s6, v19
    s_waitcnt lgkmcnt(0)
    s_barrier
    ds_read_b128 v[88:91], v6 offset:2048
    ds_read_b128 v[92:95], v6 offset:2064
    ds_read_b128 v[80:83], v6
    ds_read_b128 v[84:87], v6 offset:16
    s_waitcnt vmcnt(4)
    v_cmp_ne_u32 vcc, s4, v117
    s_cbranch_vccz TOK_8
POLL_9:
    buffer_load_dwordx2 v[116:117], v8, s[32:35], s14 offen sc1
    s_waitcnt vmcnt(0)
    v_cmp_ne_u32 vcc, s4, v117
    s_cbranch_vccz PDONE_10
    s_add_u32 s5, s5, 1
    s_cmp_lt_u32 s5, 300000
    s_cbranch_scc1 POLL_9
PDONE_10:
TOK_8:
    v_lshlrev_b32 v117, 16, v116
    v_and_b32 v116, s6, v116
    v_rcp_f32 v116, v116
    s_nop 0
    v_pk_add_f32 v[100:101], v[100:101], v[116:117] op_sel:[0,1] neg_lo:[0,1] neg_hi:[0,1]
    v_pk_add_f32 v[102:103], v[102:103], v[116:117] op_sel:[0,1] neg_lo:[0,1] neg_hi:[0,1]
    v_pk_add_f32 v[104:105], v[104:105], v[116:117] op_sel:[0,1] neg_lo:[0,1] neg_hi:[0,1]
    v_pk_add_f32 v[106:107], v[106:107], v[116:117] op_sel:[0,1] neg_lo:[0,1] neg_hi:[0,1]
    v_pk_add_f32 v[108:109], v[108:109], v[116:117] op_sel:[0,1] neg_lo:[0,1] neg_hi:[0,1]
    v_pk_add_f32 v[110:111], v[110:111], v[116:117] op_sel:[0,1] neg_lo:[0,1] neg_hi:[0,1]
    v_pk_add_f32 v[112:113], v[112:113], v[116:117] op_sel:[0,1] neg_lo:[0,1] neg_hi:[0,1]
    v_pk_add_f32 v[114:115], v[114:115], v[116:117] op_sel:[0,1] neg_lo:[0,1] neg_hi:[0,1]
    s_lshl4_add_u32 s96, s21, s12
    s_and_b32 s97, s3, 3
    s_lshl2_add_u32 s98, s96, s97
    s_lshl1_add_u32 s99, s98, s76
    s_lshl_b32 s96, s99, 11
    s_add_u32 s13, s96, 4194304
    v_and_b32 v8, 15, v1
    v_lshlrev_b32 v8, 4, v8
    v_bfe_u32 v9, v1, 4, 1
    v_lshl_add_u32 v8, v9, 10, v8
    v_lshrrev_b32 v9, 5, v1
    v_lshl_add_u32 v8, v9, 9, v8
    s_waitcnt lgkmcnt(2)
    v_pk_add_f32 v[88:89], v[88:89], v[90:91]
    v_pk_add_f32 v[92:93], v[92:93], v[94:95]
    v_pk_add_f32 v[88:89], v[88:89], v[92:93]
    v_add_f32 v88, v88, v89
    v_cvt_pk_bf16_f32 v88, 0, v88
    s_waitcnt lgkmcnt(0)
    v_pk_add_f32 v[80:81], v[80:81], v[82:83]
    v_pk_add_f32 v[84:85], v[84:85], v[86:87]
    v_pk_add_f32 v[80:81], v[80:81], v[84:85]
    v_add_f32 v80, v80, v81
    v_add_f32 v88, 1.0, v88
    v_cvt_pk_bf16_f32 v88, 0, v88
    v_cvt_pk_bf16_f32 v80, 0, v80
    s_lshl_b32 s96, s3, 8
    s_add_u32 s16, s96, 160512
    v_and_b32 v4, 15, v1
    v_lshl_add_u32 v4, v4, 2, s16
    v_lshrrev_b32 v9, 5, v1
    v_lshl_add_u32 v4, v9, 6, v4
    v_lshrrev_b32 v5, 5, v1
    v_lshl_add_u32 v5, v5, 6, s16
    ds_write2_b32 v4, v88, v80 offset0:0 offset1:32
    ds_read_b128 v[132:135], v5
    ds_read_b128 v[136:139], v5 offset:16
    ds_read_b128 v[140:143], v5 offset:32
    ds_read_b128 v[144:147], v5 offset:48
    ds_read_b128 v[148:151], v5 offset:128
    ds_read_b128 v[152:155], v5 offset:144
    ds_read_b128 v[156:159], v5 offset:160
    ds_read_b128 v[160:163], v5 offset:176
    v_cvt_pk_bf16_f32 v100, 0, v100
    v_cvt_pk_bf16_f32 v101, 0, v101
    v_cvt_pk_bf16_f32 v102, 0, v102
    v_cvt_pk_bf16_f32 v103, 0, v103
    v_cvt_pk_bf16_f32 v104, 0, v104
    v_cvt_pk_bf16_f32 v105, 0, v105
    v_cvt_pk_bf16_f32 v106, 0, v106
    v_cvt_pk_bf16_f32 v107, 0, v107
    v_pk_mul_f32 v[100:101], v[100:101], v[116:117] op_sel_hi:[1,0]
    v_pk_mul_f32 v[102:103], v[102:103], v[116:117] op_sel_hi:[1,0]
    v_pk_mul_f32 v[104:105], v[104:105], v[116:117] op_sel_hi:[1,0]
    v_pk_mul_f32 v[106:107], v[106:107], v[116:117] op_sel_hi:[1,0]
    v_cvt_pk_bf16_f32 v100, 0, v100
    v_cvt_pk_bf16_f32 v101, 0, v101
    v_cvt_pk_bf16_f32 v102, 0, v102
    v_cvt_pk_bf16_f32 v103, 0, v103
    v_cvt_pk_bf16_f32 v104, 0, v104
    v_cvt_pk_bf16_f32 v105, 0, v105
    v_cvt_pk_bf16_f32 v106, 0, v106
    v_cvt_pk_bf16_f32 v107, 0, v107
    v_cvt_pk_bf16_f32 v108, 0, v108
    v_cvt_pk_bf16_f32 v109, 0, v109
    v_cvt_pk_bf16_f32 v110, 0, v110
    v_cvt_pk_bf16_f32 v111, 0, v111
    v_cvt_pk_bf16_f32 v112, 0, v112
    v_cvt_pk_bf16_f32 v113, 0, v113
    v_cvt_pk_bf16_f32 v114, 0, v114
    v_cvt_pk_bf16_f32 v115, 0, v115
    v_pk_mul_f32 v[108:109], v[108:109], v[116:117] op_sel_hi:[1,0]
    v_pk_mul_f32 v[110:111], v[110:111], v[116:117] op_sel_hi:[1,0]
    v_pk_mul_f32 v[112:113], v[112:113], v[116:117] op_sel_hi:[1,0]
    v_pk_mul_f32 v[114:115], v[114:115], v[116:117] op_sel_hi:[1,0]
    v_cvt_pk_bf16_f32 v108, 0, v108
    v_cvt_pk_bf16_f32 v109, 0, v109
    v_cvt_pk_bf16_f32 v110, 0, v110
    v_cvt_pk_bf16_f32 v111, 0, v111
    v_cvt_pk_bf16_f32 v112, 0, v112
    v_cvt_pk_bf16_f32 v113, 0, v113
    v_cvt_pk_bf16_f32 v114, 0, v114
    v_cvt_pk_bf16_f32 v115, 0, v115
    s_waitcnt lgkmcnt(6)
    v_pk_mul_f32 v[100:101], v[100:101], v[132:133]
    v_pk_mul_f32 v[102:103], v[102:103], v[134:135]
    v_pk_mul_f32 v[104:105], v[104:105], v[136:137]
    v_pk_mul_f32 v[106:107], v[106:107], v[138:139]
    v_cvt_pk_bf16_f32 v100, 0, v100
    v_cvt_pk_bf16_f32 v101, 0, v101
    v_cvt_pk_bf16_f32 v102, 0, v102
    v_cvt_pk_bf16_f32 v103, 0, v103
    v_cvt_pk_bf16_f32 v104, 0, v104
    v_cvt_pk_bf16_f32 v105, 0, v105
    v_cvt_pk_bf16_f32 v106, 0, v106
    v_cvt_pk_bf16_f32 v107, 0, v107
    s_waitcnt lgkmcnt(2)
    v_pk_add_f32 v[100:101], v[100:101], v[148:149]
    v_pk_add_f32 v[102:103], v[102:103], v[150:151]
    v_pk_add_f32 v[104:105], v[104:105], v[152:153]
    v_pk_add_f32 v[106:107], v[106:107], v[154:155]
    v_cvt_pk_bf16_f32 v124, v100, v101
    v_cvt_pk_bf16_f32 v125, v102, v103
    v_cvt_pk_bf16_f32 v126, v104, v105
    v_cvt_pk_bf16_f32 v127, v106, v107
    buffer_store_dwordx4 v[124:127], v8, s[32:35], s13 offen sc1
    v_pk_mul_f32 v[108:109], v[108:109], v[140:141]
    v_pk_mul_f32 v[110:111], v[110:111], v[142:143]
    v_pk_mul_f32 v[112:113], v[112:113], v[144:145]
    v_pk_mul_f32 v[114:115], v[114:115], v[146:147]
    v_cvt_pk_bf16_f32 v108, 0, v108
    v_cvt_pk_bf16_f32 v109, 0, v109
    v_cvt_pk_bf16_f32 v110, 0, v110
    v_cvt_pk_bf16_f32 v111, 0, v111
    v_cvt_pk_bf16_f32 v112, 0, v112
    v_cvt_pk_bf16_f32 v113, 0, v113
    v_cvt_pk_bf16_f32 v114, 0, v114
    v_cvt_pk_bf16_f32 v115, 0, v115
    s_waitcnt lgkmcnt(0)
    v_pk_add_f32 v[108:109], v[108:109], v[156:157]
    v_pk_add_f32 v[110:111], v[110:111], v[158:159]
    v_pk_add_f32 v[112:113], v[112:113], v[160:161]
    v_pk_add_f32 v[114:115], v[114:115], v[162:163]
    v_cvt_pk_bf16_f32 v128, v108, v109
    v_cvt_pk_bf16_f32 v129, v110, v111
    v_cvt_pk_bf16_f32 v130, v112, v113
    v_cvt_pk_bf16_f32 v131, v114, v115
    buffer_store_dwordx4 v[128:131], v8, s[32:35], s13 offen offset:256 sc1
    v_lshrrev_b32 v66, 5, v1
    v_mul_u32_u24 v66, 2080, v66
    v_bfe_u32 v9, v1, 2, 2
    v_lshl_add_u32 v66, v9, 7, v66
    v_bfe_u32 v9, v1, 3, 1
    v_lshl_add_u32 v66, v9, 6, v66
    v_and_b32 v9, 3, v1
    v_lshl_add_u32 v66, v9, 3, v66
    v_bfe_u32 v67, v1, 4, 1
    v_mul_u32_u24 v67, 1056, v67
    v_bfe_u32 v68, v1, 3, 1
    v_lshlrev_b32 v68, 7, v68
    v_add_u32 v66, v66, v67
    v_sub_u32 v67, v66, v68
    v_add_u32 v67, 64, v67
    v_add_u32 v68, 49920, v66
    v_add_u32 v69, 49920, v67
    v_add_u32 v70, 99840, v66
    v_add_u32 v71, 99840, v67
    s_lshl_b32 s96, s76, 11
    s_add_u32 s14, s96, 156416
    v_bfe_u32 v4, v1, 2, 2
    v_lshl_add_u32 v4, v4, 6, s14
    v_bfe_u32 v9, v1, 4, 1
    v_lshl_add_u32 v4, v9, 5, v4
    v_and_b32 v9, 3, v1
    v_lshl_add_u32 v4, v9, 3, v4
    v_lshrrev_b32 v9, 5, v1
    v_lshl_add_u32 v4, v9, 9, v4
    v_and_b32 v5, 7, v1
    v_lshlrev_b32 v5, 12, v5
    v_bfe_u32 v9, v1, 3, 1
    v_lshl_add_u32 v5, v9, 19, v5
    s_and_b32 s96, s12, 1
    s_lshl_b32 s97, s21, 15
    s_lshr_b32 s98, s12, 1
    s_lshl_b32 s99, s98, 6
    s_add_u32 s98, s97, s99
    s_lshl2_add_u32 s97, s96, s98
    s_add_u32 s13, s97, 1048576
    v_bfe_u32 v6, v1, 4, 1
    v_lshlrev_b32 v6, 6, v6
    v_lshrrev_b32 v9, 5, v1
    v_lshl_add_u32 v6, v9, 4, v6
    v_and_b32 v74, 7, v1
    v_lshlrev_b32 v74, 4, v74
    v_xor_b32 v74, v74, v6
    v_lshrrev_b32 v6, 3, v1
    v_lshlrev_b32 v6, 11, v6
    v_add_u32 v74, v74, v6
    s_and_b32 s96, s3, 2
    s_lshl_b32 s14, s96, 5
    v_bfe_u32 v6, v1, 4, 1
    v_lshl_add_u32 v6, v6, 5, s14
    v_and_b32 v72, 7, v1
    v_lshlrev_b32 v72, 4, v72
    v_xor_b32 v72, v72, v6
    v_lshrrev_b32 v6, 3, v1
    v_mul_u32_u24 v6, 7168, v6
    v_add_u32 v72, v72, v6
    s_and_b32 s96, s3, 1
    s_lshl_b32 s14, s96, 7
    v_lshrrev_b32 v6, 5, v1
    v_lshl_add_u32 v6, v6, 6, s14
    v_and_b32 v73, 31, v1
    v_lshlrev_b32 v73, 4, v73
    v_lshrrev_b32 v9, 5, v1
    v_lshl_add_u32 v73, v9, 11, v73
    v_xor_b32 v73, v73, v6
    s_lshl3_add_u32 s96, s75, s3
    s_mul_i32 s97, s96, 229376
    s_lshl_b32 s98, s74, 7
    s_add_u32 s80, s97, s98
    s_lshl3_add_u32 s96, s74, s3
    s_lshl_b32 s97, s96, 14
    s_lshl_b32 s98, s75, 9
    s_add_u32 s81, s97, s98
    s_lshr_b32 s96, s9, 2
    s_add_u32 s90, s96, 1
    s_cmp_ge_u32 s90, 7
    s_cselect_b32 s90, 4294967290, 1
    s_cmp_ge_u32 s9, 28
    s_cselect_b32 s54, 0, s54
    s_cselect_b32 s58, 0, s58
    s_cselect_b32 s62, 0, s62
    s_waitcnt vmcnt(0)
    s_barrier
    s_cmp_lg_u32 s3, 0
    s_cbranch_scc1 L_PB
    v_mov_b32 v6, s4
    s_mov_b32 exec_hi, 0
    s_mov_b32 exec_lo, 65535
    buffer_store_dword v6, v5, s[32:35], s13 offen sc1
    s_mov_b64 exec, -1
L_PB:
    s_and_b32 s20, s9, 3
    s_cmp_le_u32 s20, 0
    s_cselect_b32 s20, 1, 0
    s_add_u32 s96, s20, s85
    s_and_b32 s97, s96, 15
    s_lshl3_add_u32 s98, s97, s3
    s_mul_i32 s99, s98, 49152
    s_lshl_b32 s96, s11, 7
    s_add_u32 s82, s99, s96
    s_mul_i32 s96, s20, 24960
    s_lshr_b32 s97, s3, 1
    s_mul_i32 s98, s97, 2080
    s_add_u32 s99, s96, s98
    s_and_b32 s97, s3, 1
    s_mul_i32 s96, s97, 1056
    s_add_u32 s20, s99, s96
    s_mov_b32 m0, s20
    s_nop 0
    buffer_load_dwordx4 v62, s[40:43], s82 offen lds
    s_add_u32 s82, s82, 2048
    s_add_u32 m0, s20, 8320
    s_nop 0
    buffer_load_dwordx4 v62, s[40:43], s82 offen lds
    s_add_u32 s82, s82, 2048
    s_add_u32 m0, s20, 16640
    s_nop 0
    buffer_load_dwordx4 v62, s[40:43], s82 offen lds
    s_and_b32 s20, s9, 3
    s_cmp_le_u32 s20, 1
    s_cselect_b32 s20, 2, 1
    s_add_u32 s96, s20, s85
    s_and_b32 s97, s96, 15
    s_lshl3_add_u32 s98, s97, s3
    s_mul_i32 s99, s98, 49152
    s_lshl_b32 s96, s11, 7
    s_add_u32 s82, s99, s96
    s_mul_i32 s96, s20, 24960
    s_lshr_b32 s97, s3, 1
    s_mul_i32 s98, s97, 2080
    s_add_u32 s99, s96, s98
    s_and_b32 s97, s3, 1
    s_mul_i32 s96, s97, 1056
    s_add_u32 s20, s99, s96
    s_mov_b32 m0, s20
    s_nop 0
    buffer_load_dwordx4 v62, s[40:43], s82 offen lds
    s_add_u32 s82, s82, 2048
    s_add_u32 m0, s20, 8320
    s_nop 0
    buffer_load_dwordx4 v62, s[40:43], s82 offen lds
    s_add_u32 s82, s82, 2048
    s_add_u32 m0, s20, 16640
    s_nop 0
    buffer_load_dwordx4 v62, s[40:43], s82 offen lds
    ds_read_b64_tr_b16 v[28:29], v4
    ds_read_b64_tr_b16 v[30:31], v4 offset:256
    ds_read_b64_tr_b16 v[32:33], v4 offset:1024
    ds_read_b64_tr_b16 v[34:35], v4 offset:1280
    s_lshl_b32 s96, s10, 6
    s_add_u32 s97, s96, s3
    s_lshl_b32 s98, s97, 12
    s_add_u32 s15, s98, 4194304
    s_and_b32 s96, s3, 3
    s_lshl_b32 s97, s96, 12
    s_add_u32 s13, s97, 147456
    v_add_u32 v76, s13, v2
    v_and_b32 v77, 15, v1
    v_lshl_add_u32 v77, v77, 4, s13
    v_lshrrev_b32 v9, 5, v1
    v_lshl_add_u32 v77, v9, 9, v77
    v_bfe_u32 v9, v1, 4, 1
    v_lshl_add_u32 v77, v9, 3, v77
    s_and_b32 s96, s3, 3
    s_lshl_b32 s97, s96, 10
    s_add_u32 s13, s97, 32768
    v_and_b32 v78, 15, v1
    v_lshl_add_u32 v78, v78, 5, s13
    v_lshrrev_b32 v9, 4, v1
    v_lshl_add_u32 v78, v9, 3, v78
    s_and_b32 s96, s3, 3
    s_lshl_b32 s97, s96, 10
    s_lshl_b32 s98, s76, 14
    s_add_u32 s13, s97, s98
    v_and_b32 v75, 31, v1
    v_lshl_add_u32 v75, v75, 5, s13
    v_lshrrev_b32 v9, 5, v1
    v_lshl_add_u32 v75, v9, 4, v75
    s_lshl_b32 s84, s3, 14
    s_lshr_b32 s96, s9, 4
    s_lshl_b32 s97, s96, 20
    s_lshl_b32 s98, s12, 7
    s_add_u32 s88, s97, s98
    s_lshl_b32 s89, s3, 10
    s_load_dwordx2 s[24:25], s[32:33], s92 offset:0 glc
    s_and_b32 s20, s9, 3
    s_cmp_le_u32 s20, 2
    s_cselect_b32 s20, 3, 2
    s_add_u32 s96, s20, s85
    s_and_b32 s97, s96, 15
    s_lshl3_add_u32 s98, s97, s3
    s_mul_i32 s99, s98, 49152
    s_lshl_b32 s96, s11, 7
    s_add_u32 s82, s99, s96
    s_mul_i32 s96, s20, 24960
    s_lshr_b32 s97, s3, 1
    s_mul_i32 s98, s97, 2080
    s_add_u32 s99, s96, s98
    s_and_b32 s97, s3, 1
    s_mul_i32 s96, s97, 1056
    s_add_u32 s20, s99, s96
    s_mov_b32 m0, s20
    s_nop 0
    buffer_load_dwordx4 v62, s[40:43], s82 offen lds
    s_add_u32 s82, s82, 2048
    s_add_u32 m0, s20, 8320
    s_nop 0
    buffer_load_dwordx4 v62, s[40:43], s82 offen lds
    s_add_u32 s82, s82, 2048
    s_add_u32 m0, s20, 16640
    s_nop 0
    buffer_load_dwordx4 v62, s[40:43], s82 offen lds
    s_add_u32 s96, s85, 4
    s_and_b32 s97, s96, 15
    s_lshl3_add_u32 s98, s97, s3
    s_mul_i32 s99, s98, 49152
    s_lshl_b32 s96, s11, 7
    s_add_u32 s82, s99, s96
    s_lshr_b32 s96, s3, 1
    s_mul_i32 s97, s96, 2080
    s_and_b32 s98, s3, 1
    s_mul_i32 s99, s98, 1056
    s_add_u32 s96, s97, s99
    s_add_u32 s20, s96, 99840
    s_mov_b32 m0, s20
    s_nop 0
    buffer_load_dwordx4 v62, s[40:43], s82 offen lds
    s_add_u32 s82, s82, 2048
    s_add_u32 m0, s20, 8320
    s_nop 0
    buffer_load_dwordx4 v62, s[40:43], s82 offen lds
    s_add_u32 s82, s82, 2048
    s_add_u32 m0, s20, 16640
    s_nop 0
    buffer_load_dwordx4 v62, s[40:43], s82 offen lds
    s_branch SCHK_12
SPOLL_11:
    s_load_dwordx2 s[24:25], s[32:33], s92 offset:0 glc
SCHK_12:
    s_add_u32 s5, s5, 1
    s_cmp_ge_u32 s5, 300000
    s_waitcnt lgkmcnt(0)
    s_cbranch_scc1 SDONE_13
    s_cmp_lg_u32 s24, s4
    s_cbranch_scc1 SPOLL_11
    s_cmp_lg_u32 s25, s4
    s_cbranch_scc1 SPOLL_11
SDONE_13:
    s_waitcnt vmcnt(9)
    s_barrier
    s_cmp_ge_u32 s3, 4
    s_cbranch_scc1 L_HELP
    s_setprio 2
    s_and_b32 s96, s85, 15
    s_lshl_b32 s97, s96, 14
    s_add_u32 s16, s97, s15
    buffer_load_dwordx4 v[176:179], v2, s[32:35], s16 offen sc1
    buffer_load_dwordx4 v[180:183], v2, s[32:35], s16 offen offset:1024 sc1
    ds_read_b64_tr_b16 v[224:225], v67 offset:8320
    ds_read_b64_tr_b16 v[226:227], v67 offset:8832
    ds_read_b64_tr_b16 v[228:229], v67 offset:8352
    ds_read_b64_tr_b16 v[230:231], v67 offset:8864
    ds_read_b64_tr_b16 v[232:233], v66 offset:8320
    ds_read_b64_tr_b16 v[234:235], v66 offset:8832
    ds_read_b64_tr_b16 v[236:237], v66 offset:8352
    ds_read_b64_tr_b16 v[238:239], v66 offset:8864
    ds_read_b64_tr_b16 v[240:241], v66
    ds_read_b64_tr_b16 v[242:243], v66 offset:512
    ds_read_b64_tr_b16 v[244:245], v66 offset:32
    ds_read_b64_tr_b16 v[246:247], v66 offset:544
    buffer_load_dwordx4 v[184:187], v2, s[32:35], s16 offen offset:2048 sc1
    buffer_load_dwordx4 v[188:191], v2, s[32:35], s16 offen offset:3072 sc1
    s_waitcnt lgkmcnt(8)
    s_waitcnt vmcnt(3)
    v_mfma_f32_16x16x32_bf16 v[128:131], v[224:227], v[176:179], 0
    ds_read_b64_tr_b16 v[248:249], v67
    s_waitcnt vmcnt(2)
    v_mfma_f32_16x16x32_bf16 v[132:135], v[224:227], v[180:183], 0
    ds_read_b64_tr_b16 v[250:251], v67 offset:512
    s_add_u32 s96, s85, 1
    s_and_b32 s97, s96, 15
    s_lshl_b32 s98, s97, 14
    s_add_u32 s16, s98, s15
    buffer_load_dwordx4 v[192:195], v2, s[32:35], s16 offen sc1
    v_mfma_f32_16x16x32_bf16 v[136:139], v[228:231], v[176:179], 0
    ds_read_b64_tr_b16 v[224:225], v67 offset:32
    v_mfma_f32_16x16x32_bf16 v[140:143], v[228:231], v[180:183], 0
    ds_read_b64_tr_b16 v[226:227], v67 offset:544
    s_waitcnt lgkmcnt(8)
    v_mfma_f32_16x16x32_bf16 v[112:115], v[232:235], v[176:179], 0
    ds_read_b64_tr_b16 v[228:229], v66 offset:16640
    v_mfma_f32_16x16x32_bf16 v[116:119], v[232:235], v[180:183], 0
    ds_read_b64_tr_b16 v[230:231], v66 offset:17152
    v_mfma_f32_16x16x32_bf16 v[120:123], v[236:239], v[176:179], 0
    ds_read_b64_tr_b16 v[232:233], v66 offset:16672
    v_mfma_f32_16x16x32_bf16 v[124:127], v[236:239], v[180:183], 0
    ds_read_b64_tr_b16 v[234:235], v66 offset:17184
    buffer_load_dwordx4 v[196:199], v2, s[32:35], s16 offen offset:1024 sc1
    s_waitcnt lgkmcnt(8)
    v_mfma_f32_16x16x32_bf16 v[80:83], v[240:243], v[176:179], 0
    ds_read_b64_tr_b16 v[236:237], v67 offset:16640
    v_mfma_f32_16x16x32_bf16 v[84:87], v[240:243], v[180:183], 0
    ds_read_b64_tr_b16 v[238:239], v67 offset:17152
    v_mfma_f32_16x16x32_bf16 v[88:91], v[244:247], v[176:179], 0
    ds_read_b64_tr_b16 v[240:241], v67 offset:16672
    v_mfma_f32_16x16x32_bf16 v[92:95], v[244:247], v[180:183], 0
    ds_read_b64_tr_b16 v[242:243], v67 offset:17184
    s_waitcnt lgkmcnt(8)
    v_mfma_f32_16x16x32_bf16 v[96:99], v[248:251], v[176:179], 0
    ds_read_b64_tr_b16 v[244:245], v67 offset:12480
    v_mfma_f32_16x16x32_bf16 v[100:103], v[248:251], v[180:183], 0
    ds_read_b64_tr_b16 v[246:247], v67 offset:12992
    buffer_load_dwordx4 v[200:203], v2, s[32:35], s16 offen offset:2048 sc1
    v_mfma_f32_16x16x32_bf16 v[104:107], v[224:227], v[176:179], 0
    ds_read_b64_tr_b16 v[248:249], v67 offset:12512
    v_mfma_f32_16x16x32_bf16 v[108:111], v[224:227], v[180:183], 0
    ds_read_b64_tr_b16 v[250:251], v67 offset:13024
    s_waitcnt lgkmcnt(8)
    v_mfma_f32_16x16x32_bf16 v[144:147], v[228:231], v[176:179], 0
    ds_read_b64_tr_b16 v[224:225], v66 offset:12480
    v_mfma_f32_16x16x32_bf16 v[148:151], v[228:231], v[180:183], 0
    ds_read_b64_tr_b16 v[226:227], v66 offset:12992
    v_mfma_f32_16x16x32_bf16 v[152:155], v[232:235], v[176:179], 0
    ds_read_b64_tr_b16 v[228:229], v66 offset:12512
    v_mfma_f32_16x16x32_bf16 v[156:159], v[232:235], v[180:183], 0
    ds_read_b64_tr_b16 v[230:231], v66 offset:13024
    buffer_load_dwordx4 v[204:207], v2, s[32:35], s16 offen offset:3072 sc1
    s_waitcnt lgkmcnt(8)
    v_mfma_f32_16x16x32_bf16 v[160:163], v[236:239], v[176:179], 0
    ds_read_b64_tr_b16 v[232:233], v66 offset:4160
    v_mfma_f32_16x16x32_bf16 v[164:167], v[236:239], v[180:183], 0
    ds_read_b64_tr_b16 v[234:235], v66 offset:4672
    v_mfma_f32_16x16x32_bf16 v[168:171], v[240:243], v[176:179], 0
    ds_read_b64_tr_b16 v[236:237], v66 offset:4192
    v_mfma_f32_16x16x32_bf16 v[172:175], v[240:243], v[180:183], 0
    ds_read_b64_tr_b16 v[238:239], v66 offset:4704
    s_waitcnt lgkmcnt(8)
    s_waitcnt vmcnt(5)
    v_mfma_f32_16x16x32_bf16 v[128:131], v[244:247], v[184:187], v[128:131]
    ds_read_b64_tr_b16 v[240:241], v67 offset:4160
    s_waitcnt vmcnt(4)
    v_mfma_f32_16x16x32_bf16 v[132:135], v[244:247], v[188:191], v[132:135]
    ds_read_b64_tr_b16 v[242:243], v67 offset:4672
    s_add_u32 s96, s85, 2
    s_and_b32 s97, s96, 15
    s_lshl_b32 s98, s97, 14
    s_add_u32 s16, s98, s15
    buffer_load_dwordx4 v[208:211], v2, s[32:35], s16 offen sc1
    v_mfma_f32_16x16x32_bf16 v[136:139], v[248:251], v[184:187], v[136:139]
    ds_read_b64_tr_b16 v[244:245], v67 offset:4192
    v_mfma_f32_16x16x32_bf16 v[140:143], v[248:251], v[188:191], v[140:143]
    ds_read_b64_tr_b16 v[246:247], v67 offset:4704
    s_waitcnt lgkmcnt(8)
    v_mfma_f32_16x16x32_bf16 v[112:115], v[224:227], v[184:187], v[112:115]
    ds_read_b64_tr_b16 v[248:249], v66 offset:20800
    v_mfma_f32_16x16x32_bf16 v[116:119], v[224:227], v[188:191], v[116:119]
    ds_read_b64_tr_b16 v[250:251], v66 offset:21312
    v_mfma_f32_16x16x32_bf16 v[120:123], v[228:231], v[184:187], v[120:123]
    ds_read_b64_tr_b16 v[224:225], v66 offset:20832
    v_mfma_f32_16x16x32_bf16 v[124:127], v[228:231], v[188:191], v[124:127]
    ds_read_b64_tr_b16 v[226:227], v66 offset:21344
    buffer_load_dwordx4 v[212:215], v2, s[32:35], s16 offen offset:1024 sc1
    s_waitcnt lgkmcnt(8)
    v_mfma_f32_16x16x32_bf16 v[80:83], v[232:235], v[184:187], v[80:83]
    ds_read_b64_tr_b16 v[228:229], v67 offset:20800
    v_mfma_f32_16x16x32_bf16 v[84:87], v[232:235], v[188:191], v[84:87]
    ds_read_b64_tr_b16 v[230:231], v67 offset:21312
    v_mfma_f32_16x16x32_bf16 v[88:91], v[236:239], v[184:187], v[88:91]
    ds_read_b64_tr_b16 v[232:233], v67 offset:20832
    v_mfma_f32_16x16x32_bf16 v[92:95], v[236:239], v[188:191], v[92:95]
    ds_read_b64_tr_b16 v[234:235], v67 offset:21344
    s_waitcnt lgkmcnt(8)
    v_mfma_f32_16x16x32_bf16 v[96:99], v[240:243], v[184:187], v[96:99]
    s_barrier
    ds_read_b64_tr_b16 v[236:237], v67 offset:33280
    v_mfma_f32_16x16x32_bf16 v[100:103], v[240:243], v[188:191], v[100:103]
    ds_read_b64_tr_b16 v[238:239], v67 offset:33792
    buffer_load_dwordx4 v[216:219], v2, s[32:35], s16 offen offset:2048 sc1
    v_mfma_f32_16x16x32_bf16 v[104:107], v[244:247], v[184:187], v[104:107]
    ds_read_b64_tr_b16 v[240:241], v67 offset:33312
    v_mfma_f32_16x16x32_bf16 v[108:111], v[244:247], v[188:191], v[108:111]
    ds_read_b64_tr_b16 v[242:243], v67 offset:33824
    s_waitcnt lgkmcnt(8)
    v_mfma_f32_16x16x32_bf16 v[144:147], v[248:251], v[184:187], v[144:147]
    ds_read_b64_tr_b16 v[244:245], v66 offset:33280
    v_mfma_f32_16x16x32_bf16 v[148:151], v[248:251], v[188:191], v[148:151]
    ds_read_b64_tr_b16 v[246:247], v66 offset:33792
    v_mfma_f32_16x16x32_bf16 v[152:155], v[224:227], v[184:187], v[152:155]
    ds_read_b64_tr_b16 v[248:249], v66 offset:33312
    v_mfma_f32_16x16x32_bf16 v[156:159], v[224:227], v[188:191], v[156:159]
    ds_read_b64_tr_b16 v[250:251], v66 offset:33824
    buffer_load_dwordx4 v[220:223], v2, s[32:35], s16 offen offset:3072 sc1
    s_waitcnt lgkmcnt(8)
    v_mfma_f32_16x16x32_bf16 v[160:163], v[228:231], v[184:187], v[160:163]
    ds_read_b64_tr_b16 v[224:225], v66 offset:24960
    v_mfma_f32_16x16x32_bf16 v[164:167], v[228:231], v[188:191], v[164:167]
    ds_read_b64_tr_b16 v[226:227], v66 offset:25472
    v_mfma_f32_16x16x32_bf16 v[168:171], v[232:235], v[184:187], v[168:171]
    ds_read_b64_tr_b16 v[228:229], v66 offset:24992
    v_mfma_f32_16x16x32_bf16 v[172:175], v[232:235], v[188:191], v[172:175]
    ds_read_b64_tr_b16 v[230:231], v66 offset:25504
    s_waitcnt lgkmcnt(8)
    s_waitcnt vmcnt(6)
    v_mfma_f32_16x16x32_bf16 v[128:131], v[236:239], v[192:195], v[128:131]
    ds_read_b64_tr_b16 v[232:233], v67 offset:24960
    v_mfma_f32_16x16x32_bf16 v[132:135], v[236:239], v[196:199], v[132:135]
    ds_read_b64_tr_b16 v[234:235], v67 offset:25472
    s_add_u32 s96, s85, 3
    s_and_b32 s97, s96, 15
    s_lshl_b32 s98, s97, 14
    s_add_u32 s16, s98, s15
    buffer_load_dwordx4 v[36:39], v2, s[32:35], s16 offen sc1
    v_mfma_f32_16x16x32_bf16 v[136:139], v[240:243], v[192:195], v[136:139]
    ds_read_b64_tr_b16 v[236:237], v67 offset:24992
    v_mfma_f32_16x16x32_bf16 v[140:143], v[240:243], v[196:199], v[140:143]
    ds_read_b64_tr_b16 v[238:239], v67 offset:25504
    s_waitcnt lgkmcnt(8)
    v_mfma_f32_16x16x32_bf16 v[112:115], v[244:247], v[192:195], v[112:115]
    ds_read_b64_tr_b16 v[240:241], v66 offset:41600
    v_mfma_f32_16x16x32_bf16 v[116:119], v[244:247], v[196:199], v[116:119]
    ds_read_b64_tr_b16 v[242:243], v66 offset:42112
    v_mfma_f32_16x16x32_bf16 v[120:123], v[248:251], v[192:195], v[120:123]
    ds_read_b64_tr_b16 v[244:245], v66 offset:41632
    v_mfma_f32_16x16x32_bf16 v[124:127], v[248:251], v[196:199], v[124:127]
    ds_read_b64_tr_b16 v[246:247], v66 offset:42144
    buffer_load_dwordx4 v[176:179], v2, s[32:35], s16 offen offset:1024 sc1
    s_waitcnt lgkmcnt(8)
    v_mfma_f32_16x16x32_bf16 v[80:83], v[224:227], v[192:195], v[80:83]
    ds_read_b64_tr_b16 v[248:249], v67 offset:41600
    v_mfma_f32_16x16x32_bf16 v[84:87], v[224:227], v[196:199], v[84:87]
    ds_read_b64_tr_b16 v[250:251], v67 offset:42112
    v_mfma_f32_16x16x32_bf16 v[88:91], v[228:231], v[192:195], v[88:91]
    ds_read_b64_tr_b16 v[224:225], v67 offset:41632
    v_mfma_f32_16x16x32_bf16 v[92:95], v[228:231], v[196:199], v[92:95]
    ds_read_b64_tr_b16 v[226:227], v67 offset:42144
    s_waitcnt lgkmcnt(8)
    v_mfma_f32_16x16x32_bf16 v[96:99], v[232:235], v[192:195], v[96:99]
    ds_read_b64_tr_b16 v[228:229], v67 offset:37440
    v_mfma_f32_16x16x32_bf16 v[100:103], v[232:235], v[196:199], v[100:103]
    ds_read_b64_tr_b16 v[230:231], v67 offset:37952
    buffer_load_dwordx4 v[180:183], v2, s[32:35], s16 offen offset:2048 sc1
    v_mfma_f32_16x16x32_bf16 v[104:107], v[236:239], v[192:195], v[104:107]
    ds_read_b64_tr_b16 v[232:233], v67 offset:37472
    v_mfma_f32_16x16x32_bf16 v[108:111], v[236:239], v[196:199], v[108:111]
    ds_read_b64_tr_b16 v[234:235], v67 offset:37984
    s_waitcnt lgkmcnt(8)
    v_mfma_f32_16x16x32_bf16 v[144:147], v[240:243], v[192:195], v[144:147]
    ds_read_b64_tr_b16 v[236:237], v66 offset:37440
    v_mfma_f32_16x16x32_bf16 v[148:151], v[240:243], v[196:199], v[148:151]
    ds_read_b64_tr_b16 v[238:239], v66 offset:37952
    v_mfma_f32_16x16x32_bf16 v[152:155], v[244:247], v[192:195], v[152:155]
    ds_read_b64_tr_b16 v[240:241], v66 offset:37472
    v_mfma_f32_16x16x32_bf16 v[156:159], v[244:247], v[196:199], v[156:159]
    ds_read_b64_tr_b16 v[242:243], v66 offset:37984
    buffer_load_dwordx4 v[184:187], v2, s[32:35], s16 offen offset:3072 sc1
    s_waitcnt lgkmcnt(8)
    v_mfma_f32_16x16x32_bf16 v[160:163], v[248:251], v[192:195], v[160:163]
    ds_read_b64_tr_b16 v[244:245], v66 offset:29120
    v_mfma_f32_16x16x32_bf16 v[164:167], v[248:251], v[196:199], v[164:167]
    ds_read_b64_tr_b16 v[246:247], v66 offset:29632
    v_mfma_f32_16x16x32_bf16 v[168:171], v[224:227], v[192:195], v[168:171]
    ds_read_b64_tr_b16 v[248:249], v66 offset:29152
    v_mfma_f32_16x16x32_bf16 v[172:175], v[224:227], v[196:199], v[172:175]
    ds_read_b64_tr_b16 v[250:251], v66 offset:29664
    s_waitcnt lgkmcnt(8)
    s_waitcnt vmcnt(8)
    v_mfma_f32_16x16x32_bf16 v[128:131], v[228:231], v[200:203], v[128:131]
    ds_read_b64_tr_b16 v[224:225], v67 offset:29120
    v_mfma_f32_16x16x32_bf16 v[132:135], v[228:231], v[204:207], v[132:135]
    ds_read_b64_tr_b16 v[226:227], v67 offset:29632
    s_add_u32 s96, s85, 4
    s_and_b32 s97, s96, 15
    s_lshl_b32 s98, s97, 14
    s_add_u32 s16, s98, s15
    buffer_load_dwordx4 v[188:191], v2, s[32:35], s16 offen sc1
    v_mfma_f32_16x16x32_bf16 v[136:139], v[232:235], v[200:203], v[136:139]
    ds_read_b64_tr_b16 v[228:229], v67 offset:29152
    v_mfma_f32_16x16x32_bf16 v[140:143], v[232:235], v[204:207], v[140:143]
    ds_read_b64_tr_b16 v[230:231], v67 offset:29664
    s_waitcnt lgkmcnt(8)
    v_mfma_f32_16x16x32_bf16 v[112:115], v[236:239], v[200:203], v[112:115]
    ds_read_b64_tr_b16 v[232:233], v66 offset:45760
    v_mfma_f32_16x16x32_bf16 v[116:119], v[236:239], v[204:207], v[116:119]
    ds_read_b64_tr_b16 v[234:235], v66 offset:46272
    v_mfma_f32_16x16x32_bf16 v[120:123], v[240:243], v[200:203], v[120:123]
    ds_read_b64_tr_b16 v[236:237], v66 offset:45792
    v_mfma_f32_16x16x32_bf16 v[124:127], v[240:243], v[204:207], v[124:127]
    ds_read_b64_tr_b16 v[238:239], v66 offset:46304
    buffer_load_dwordx4 v[192:195], v2, s[32:35], s16 offen offset:1024 sc1
    s_waitcnt lgkmcnt(8)
    v_mfma_f32_16x16x32_bf16 v[80:83], v[244:247], v[200:203], v[80:83]
    ds_read_b64_tr_b16 v[240:241], v67 offset:45760
    v_mfma_f32_16x16x32_bf16 v[84:87], v[244:247], v[204:207], v[84:87]
    ds_read_b64_tr_b16 v[242:243], v67 offset:46272
    v_mfma_f32_16x16x32_bf16 v[88:91], v[248:251], v[200:203], v[88:91]
    ds_read_b64_tr_b16 v[244:245], v67 offset:45792
    v_mfma_f32_16x16x32_bf16 v[92:95], v[248:251], v[204:207], v[92:95]
    ds_read_b64_tr_b16 v[246:247], v67 offset:46304
    s_waitcnt lgkmcnt(8)
    v_mfma_f32_16x16x32_bf16 v[96:99], v[224:227], v[200:203], v[96:99]
    s_barrier
    ds_read_b64_tr_b16 v[248:249], v69 offset:8320
    v_mfma_f32_16x16x32_bf16 v[100:103], v[224:227], v[204:207], v[100:103]
    ds_read_b64_tr_b16 v[250:251], v69 offset:8832
    buffer_load_dwordx4 v[196:199], v2, s[32:35], s16 offen offset:2048 sc1
    v_mfma_f32_16x16x32_bf16 v[104:107], v[228:231], v[200:203], v[104:107]
    ds_read_b64_tr_b16 v[224:225], v69 offset:8352
    v_mfma_f32_16x16x32_bf16 v[108:111], v[228:231], v[204:207], v[108:111]
    ds_read_b64_tr_b16 v[226:227], v69 offset:8864
    s_waitcnt lgkmcnt(8)
    v_mfma_f32_16x16x32_bf16 v[144:147], v[232:235], v[200:203], v[144:147]
    ds_read_b64_tr_b16 v[228:229], v68 offset:8320
    v_mfma_f32_16x16x32_bf16 v[148:151], v[232:235], v[204:207], v[148:151]
    ds_read_b64_tr_b16 v[230:231], v68 offset:8832
    v_mfma_f32_16x16x32_bf16 v[152:155], v[236:239], v[200:203], v[152:155]
    ds_read_b64_tr_b16 v[232:233], v68 offset:8352
    v_mfma_f32_16x16x32_bf16 v[156:159], v[236:239], v[204:207], v[156:159]
    ds_read_b64_tr_b16 v[234:235], v68 offset:8864
    s_waitcnt lgkmcnt(8)
    v_mfma_f32_16x16x32_bf16 v[160:163], v[240:243], v[200:203], v[160:163]
    ds_read_b64_tr_b16 v[236:237], v68
    v_mfma_f32_16x16x32_bf16 v[164:167], v[240:243], v[204:207], v[164:167]
    ds_read_b64_tr_b16 v[238:239], v68 offset:512
    v_mfma_f32_16x16x32_bf16 v[168:171], v[244:247], v[200:203], v[168:171]
    ds_read_b64_tr_b16 v[240:241], v68 offset:32
    v_mfma_f32_16x16x32_bf16 v[172:175], v[244:247], v[204:207], v[172:175]
    ds_read_b64_tr_b16 v[242:243], v68 offset:544
    s_waitcnt lgkmcnt(8)
    s_waitcnt vmcnt(9)
    v_mfma_f32_16x16x32_bf16 v[128:131], v[248:251], v[208:211], v[128:131]
    ds_read_b64_tr_b16 v[244:245], v69
    v_mfma_f32_16x16x32_bf16 v[132:135], v[248:251], v[212:215], v[132:135]
    ds_read_b64_tr_b16 v[246:247], v69 offset:512
    buffer_load_dwordx4 v[200:203], v2, s[32:35], s16 offen offset:3072 sc1
    v_mfma_f32_16x16x32_bf16 v[136:139], v[224:227], v[208:211], v[136:139]
    ds_read_b64_tr_b16 v[248:249], v69 offset:32
    v_mfma_f32_16x16x32_bf16 v[140:143], v[224:227], v[212:215], v[140:143]
    ds_read_b64_tr_b16 v[250:251], v69 offset:544
    s_waitcnt lgkmcnt(8)
    v_mfma_f32_16x16x32_bf16 v[112:115], v[228:231], v[208:211], v[112:115]
    ds_read_b64_tr_b16 v[224:225], v68 offset:16640
    v_mfma_f32_16x16x32_bf16 v[116:119], v[228:231], v[212:215], v[116:119]
    ds_read_b64_tr_b16 v[226:227], v68 offset:17152
    v_mfma_f32_16x16x32_bf16 v[120:123], v[232:235], v[208:211], v[120:123]
    ds_read_b64_tr_b16 v[228:229], v68 offset:16672
    v_mfma_f32_16x16x32_bf16 v[124:127], v[232:235], v[212:215], v[124:127]
    ds_read_b64_tr_b16 v[230:231], v68 offset:17184
    s_add_u32 s96, s85, 5
    s_and_b32 s97, s96, 15
    s_lshl_b32 s98, s97, 14
    s_add_u32 s16, s98, s15
    buffer_load_dwordx4 v[204:207], v2, s[32:35], s16 offen sc1
    s_waitcnt lgkmcnt(8)
    v_mfma_f32_16x16x32_bf16 v[80:83], v[236:239], v[208:211], v[80:83]
    ds_read_b64_tr_b16 v[232:233], v69 offset:16640
    v_mfma_f32_16x16x32_bf16 v[84:87], v[236:239], v[212:215], v[84:87]
    ds_read_b64_tr_b16 v[234:235], v69 offset:17152
    v_mfma_f32_16x16x32_bf16 v[88:91], v[240:243], v[208:211], v[88:91]
    ds_read_b64_tr_b16 v[236:237], v69 offset:16672
    v_mfma_f32_16x16x32_bf16 v[92:95], v[240:243], v[212:215], v[92:95]
    ds_read_b64_tr_b16 v[238:239], v69 offset:17184
    s_waitcnt lgkmcnt(8)
    v_mfma_f32_16x16x32_bf16 v[96:99], v[244:247], v[208:211], v[96:99]
    ds_read_b64_tr_b16 v[240:241], v69 offset:12480
    v_mfma_f32_16x16x32_bf16 v[100:103], v[244:247], v[212:215], v[100:103]
    ds_read_b64_tr_b16 v[242:243], v69 offset:12992
    v_mfma_f32_16x16x32_bf16 v[104:107], v[248:251], v[208:211], v[104:107]
    ds_read_b64_tr_b16 v[244:245], v69 offset:12512
    v_mfma_f32_16x16x32_bf16 v[108:111], v[248:251], v[212:215], v[108:111]
    ds_read_b64_tr_b16 v[246:247], v69 offset:13024
    s_waitcnt lgkmcnt(8)
    v_mfma_f32_16x16x32_bf16 v[144:147], v[224:227], v[208:211], v[144:147]
    ds_read_b64_tr_b16 v[248:249], v68 offset:12480
    v_mfma_f32_16x16x32_bf16 v[148:151], v[224:227], v[212:215], v[148:151]
    ds_read_b64_tr_b16 v[250:251], v68 offset:12992
    v_mfma_f32_16x16x32_bf16 v[152:155], v[228:231], v[208:211], v[152:155]
    ds_read_b64_tr_b16 v[224:225], v68 offset:12512
    v_mfma_f32_16x16x32_bf16 v[156:159], v[228:231], v[212:215], v[156:159]
    ds_read_b64_tr_b16 v[226:227], v68 offset:13024
    s_waitcnt lgkmcnt(8)
    v_mfma_f32_16x16x32_bf16 v[160:163], v[232:235], v[208:211], v[160:163]
    ds_read_b64_tr_b16 v[228:229], v68 offset:4160
    v_mfma_f32_16x16x32_bf16 v[164:167], v[232:235], v[212:215], v[164:167]
    ds_read_b64_tr_b16 v[230:231], v68 offset:4672
    v_mfma_f32_16x16x32_bf16 v[168:171], v[236:239], v[208:211], v[168:171]
    ds_read_b64_tr_b16 v[232:233], v68 offset:4192
    v_mfma_f32_16x16x32_bf16 v[172:175], v[236:239], v[212:215], v[172:175]
    ds_read_b64_tr_b16 v[234:235], v68 offset:4704
    s_waitcnt lgkmcnt(8)
    s_waitcnt vmcnt(9)
    v_mfma_f32_16x16x32_bf16 v[128:131], v[240:243], v[216:219], v[128:131]
    ds_read_b64_tr_b16 v[236:237], v69 offset:4160
    v_mfma_f32_16x16x32_bf16 v[132:135], v[240:243], v[220:223], v[132:135]
    ds_read_b64_tr_b16 v[238:239], v69 offset:4672
    buffer_load_dwordx4 v[208:211], v2, s[32:35], s16 offen offset:1024 sc1
    v_mfma_f32_16x16x32_bf16 v[136:139], v[244:247], v[216:219], v[136:139]
    ds_read_b64_tr_b16 v[240:241], v69 offset:4192
    v_mfma_f32_16x16x32_bf16 v[140:143], v[244:247], v[220:223], v[140:143]
    ds_read_b64_tr_b16 v[242:243], v69 offset:4704
    s_waitcnt lgkmcnt(8)
    v_mfma_f32_16x16x32_bf16 v[112:115], v[248:251], v[216:219], v[112:115]
    ds_read_b64_tr_b16 v[244:245], v68 offset:20800
    v_mfma_f32_16x16x32_bf16 v[116:119], v[248:251], v[220:223], v[116:119]
    ds_read_b64_tr_b16 v[246:247], v68 offset:21312
    v_mfma_f32_16x16x32_bf16 v[120:123], v[224:227], v[216:219], v[120:123]
    ds_read_b64_tr_b16 v[248:249], v68 offset:20832
    v_mfma_f32_16x16x32_bf16 v[124:127], v[224:227], v[220:223], v[124:127]
    ds_read_b64_tr_b16 v[250:251], v68 offset:21344
    buffer_load_dwordx4 v[212:215], v2, s[32:35], s16 offen offset:2048 sc1
    s_waitcnt lgkmcnt(8)
    v_mfma_f32_16x16x32_bf16 v[80:83], v[228:231], v[216:219], v[80:83]
    ds_read_b64_tr_b16 v[224:225], v69 offset:20800
    v_mfma_f32_16x16x32_bf16 v[84:87], v[228:231], v[220:223], v[84:87]
    ds_read_b64_tr_b16 v[226:227], v69 offset:21312
    v_mfma_f32_16x16x32_bf16 v[88:91], v[232:235], v[216:219], v[88:91]
    ds_read_b64_tr_b16 v[228:229], v69 offset:20832
    v_mfma_f32_16x16x32_bf16 v[92:95], v[232:235], v[220:223], v[92:95]
    ds_read_b64_tr_b16 v[230:231], v69 offset:21344
    s_waitcnt lgkmcnt(8)
    v_mfma_f32_16x16x32_bf16 v[96:99], v[236:239], v[216:219], v[96:99]
    s_barrier
    ds_read_b64_tr_b16 v[232:233], v69 offset:33280
    v_mfma_f32_16x16x32_bf16 v[100:103], v[236:239], v[220:223], v[100:103]
    ds_read_b64_tr_b16 v[234:235], v69 offset:33792
    v_mfma_f32_16x16x32_bf16 v[104:107], v[240:243], v[216:219], v[104:107]
    ds_read_b64_tr_b16 v[236:237], v69 offset:33312
    v_mfma_f32_16x16x32_bf16 v[108:111], v[240:243], v[220:223], v[108:111]
    ds_read_b64_tr_b16 v[238:239], v69 offset:33824
    s_waitcnt lgkmcnt(8)
    v_mfma_f32_16x16x32_bf16 v[144:147], v[244:247], v[216:219], v[144:147]
    ds_read_b64_tr_b16 v[240:241], v68 offset:33280
    v_mfma_f32_16x16x32_bf16 v[148:151], v[244:247], v[220:223], v[148:151]
    ds_read_b64_tr_b16 v[242:243], v68 offset:33792
    v_mfma_f32_16x16x32_bf16 v[152:155], v[248:251], v[216:219], v[152:155]
    ds_read_b64_tr_b16 v[244:245], v68 offset:33312
    v_mfma_f32_16x16x32_bf16 v[156:159], v[248:251], v[220:223], v[156:159]
    ds_read_b64_tr_b16 v[246:247], v68 offset:33824
    s_waitcnt lgkmcnt(8)
    v_mfma_f32_16x16x32_bf16 v[160:163], v[224:227], v[216:219], v[160:163]
    ds_read_b64_tr_b16 v[248:249], v68 offset:24960
    v_mfma_f32_16x16x32_bf16 v[164:167], v[224:227], v[220:223], v[164:167]
    ds_read_b64_tr_b16 v[250:251], v68 offset:25472
    v_mfma_f32_16x16x32_bf16 v[168:171], v[228:231], v[216:219], v[168:171]
    ds_read_b64_tr_b16 v[224:225], v68 offset:24992
    v_mfma_f32_16x16x32_bf16 v[172:175], v[228:231], v[220:223], v[172:175]
    ds_read_b64_tr_b16 v[226:227], v68 offset:25504
    s_waitcnt lgkmcnt(8)
    s_waitcnt vmcnt(9)
    v_mfma_f32_16x16x32_bf16 v[128:131], v[232:235], v[36:39], v[128:131]
    ds_read_b64_tr_b16 v[228:229], v69 offset:24960
    v_mfma_f32_16x16x32_bf16 v[132:135], v[232:235], v[176:179], v[132:135]
    ds_read_b64_tr_b16 v[230:231], v69 offset:25472
    buffer_load_dwordx4 v[216:219], v2, s[32:35], s16 offen offset:3072 sc1
    v_mfma_f32_16x16x32_bf16 v[136:139], v[236:239], v[36:39], v[136:139]
    ds_read_b64_tr_b16 v[232:233], v69 offset:24992
    v_mfma_f32_16x16x32_bf16 v[140:143], v[236:239], v[176:179], v[140:143]
    ds_read_b64_tr_b16 v[234:235], v69 offset:25504
    s_waitcnt lgkmcnt(8)
    v_mfma_f32_16x16x32_bf16 v[112:115], v[240:243], v[36:39], v[112:115]
    ds_read_b64_tr_b16 v[236:237], v68 offset:41600
    v_mfma_f32_16x16x32_bf16 v[116:119], v[240:243], v[176:179], v[116:119]
    ds_read_b64_tr_b16 v[238:239], v68 offset:42112
    v_mfma_f32_16x16x32_bf16 v[120:123], v[244:247], v[36:39], v[120:123]
    ds_read_b64_tr_b16 v[240:241], v68 offset:41632
    v_mfma_f32_16x16x32_bf16 v[124:127], v[244:247], v[176:179], v[124:127]
    ds_read_b64_tr_b16 v[242:243], v68 offset:42144
    s_add_u32 s96, s85, 6
    s_and_b32 s97, s96, 15
    s_lshl_b32 s98, s97, 14
    s_add_u32 s16, s98, s15
    buffer_load_dwordx4 v[220:223], v2, s[32:35], s16 offen sc1
    s_waitcnt lgkmcnt(8)
    v_mfma_f32_16x16x32_bf16 v[80:83], v[248:251], v[36:39], v[80:83]
    ds_read_b64_tr_b16 v[244:245], v69 offset:41600
    v_mfma_f32_16x16x32_bf16 v[84:87], v[248:251], v[176:179], v[84:87]
    ds_read_b64_tr_b16 v[246:247], v69 offset:42112
    v_mfma_f32_16x16x32_bf16 v[88:91], v[224:227], v[36:39], v[88:91]
    ds_read_b64_tr_b16 v[248:249], v69 offset:41632
    v_mfma_f32_16x16x32_bf16 v[92:95], v[224:227], v[176:179], v[92:95]
    ds_read_b64_tr_b16 v[250:251], v69 offset:42144
    s_waitcnt lgkmcnt(8)
    v_mfma_f32_16x16x32_bf16 v[96:99], v[228:231], v[36:39], v[96:99]
    ds_read_b64_tr_b16 v[224:225], v69 offset:37440
    v_mfma_f32_16x16x32_bf16 v[100:103], v[228:231], v[176:179], v[100:103]
    ds_read_b64_tr_b16 v[226:227], v69 offset:37952
    v_mfma_f32_16x16x32_bf16 v[104:107], v[232:235], v[36:39], v[104:107]
    ds_read_b64_tr_b16 v[228:229], v69 offset:37472
    v_mfma_f32_16x16x32_bf16 v[108:111], v[232:235], v[176:179], v[108:111]
    ds_read_b64_tr_b16 v[230:231], v69 offset:37984
    s_waitcnt lgkmcnt(8)
    v_mfma_f32_16x16x32_bf16 v[144:147], v[236:239], v[36:39], v[144:147]
    ds_read_b64_tr_b16 v[232:233], v68 offset:37440
    v_mfma_f32_16x16x32_bf16 v[148:151], v[236:239], v[176:179], v[148:151]
    ds_read_b64_tr_b16 v[234:235], v68 offset:37952
    v_mfma_f32_16x16x32_bf16 v[152:155], v[240:243], v[36:39], v[152:155]
    ds_read_b64_tr_b16 v[236:237], v68 offset:37472
    v_mfma_f32_16x16x32_bf16 v[156:159], v[240:243], v[176:179], v[156:159]
    ds_read_b64_tr_b16 v[238:239], v68 offset:37984
    s_waitcnt lgkmcnt(8)
    v_mfma_f32_16x16x32_bf16 v[160:163], v[244:247], v[36:39], v[160:163]
    ds_read_b64_tr_b16 v[240:241], v68 offset:29120
    v_mfma_f32_16x16x32_bf16 v[164:167], v[244:247], v[176:179], v[164:167]
    ds_read_b64_tr_b16 v[242:243], v68 offset:29632
    v_mfma_f32_16x16x32_bf16 v[168:171], v[248:251], v[36:39], v[168:171]
    ds_read_b64_tr_b16 v[244:245], v68 offset:29152
    v_mfma_f32_16x16x32_bf16 v[172:175], v[248:251], v[176:179], v[172:175]
    ds_read_b64_tr_b16 v[246:247], v68 offset:29664
    s_waitcnt lgkmcnt(8)
    s_waitcnt vmcnt(9)
    v_mfma_f32_16x16x32_bf16 v[128:131], v[224:227], v[180:183], v[128:131]
    ds_read_b64_tr_b16 v[248:249], v69 offset:29120
    v_mfma_f32_16x16x32_bf16 v[132:135], v[224:227], v[184:187], v[132:135]
    ds_read_b64_tr_b16 v[250:251], v69 offset:29632
    buffer_load_dwordx4 v[36:39], v2, s[32:35], s16 offen offset:1024 sc1
    v_mfma_f32_16x16x32_bf16 v[136:139], v[228:231], v[180:183], v[136:139]
    ds_read_b64_tr_b16 v[224:225], v69 offset:29152
    v_mfma_f32_16x16x32_bf16 v[140:143], v[228:231], v[184:187], v[140:143]
    ds_read_b64_tr_b16 v[226:227], v69 offset:29664
    s_waitcnt lgkmcnt(8)
    v_mfma_f32_16x16x32_bf16 v[112:115], v[232:235], v[180:183], v[112:115]
    ds_read_b64_tr_b16 v[228:229], v68 offset:45760
    v_mfma_f32_16x16x32_bf16 v[116:119], v[232:235], v[184:187], v[116:119]
    ds_read_b64_tr_b16 v[230:231], v68 offset:46272
    v_mfma_f32_16x16x32_bf16 v[120:123], v[236:239], v[180:183], v[120:123]
    ds_read_b64_tr_b16 v[232:233], v68 offset:45792
    v_mfma_f32_16x16x32_bf16 v[124:127], v[236:239], v[184:187], v[124:127]
    ds_read_b64_tr_b16 v[234:235], v68 offset:46304
    buffer_load_dwordx4 v[176:179], v2, s[32:35], s16 offen offset:2048 sc1
    s_waitcnt lgkmcnt(8)
    v_mfma_f32_16x16x32_bf16 v[80:83], v[240:243], v[180:183], v[80:83]
    ds_read_b64_tr_b16 v[236:237], v69 offset:45760
    v_mfma_f32_16x16x32_bf16 v[84:87], v[240:243], v[184:187], v[84:87]
    ds_read_b64_tr_b16 v[238:239], v69 offset:46272
    v_mfma_f32_16x16x32_bf16 v[88:91], v[244:247], v[180:183], v[88:91]
    ds_read_b64_tr_b16 v[240:241], v69 offset:45792
    v_mfma_f32_16x16x32_bf16 v[92:95], v[244:247], v[184:187], v[92:95]
    ds_read_b64_tr_b16 v[242:243], v69 offset:46304
    s_waitcnt lgkmcnt(8)
    v_mfma_f32_16x16x32_bf16 v[96:99], v[248:251], v[180:183], v[96:99]
    s_barrier
    ds_read_b64_tr_b16 v[244:245], v71 offset:8320
    v_mfma_f32_16x16x32_bf16 v[100:103], v[248:251], v[184:187], v[100:103]
    ds_read_b64_tr_b16 v[246:247], v71 offset:8832
    v_mfma_f32_16x16x32_bf16 v[104:107], v[224:227], v[180:183], v[104:107]
    ds_read_b64_tr_b16 v[248:249], v71 offset:8352
    v_mfma_f32_16x16x32_bf16 v[108:111], v[224:227], v[184:187], v[108:111]
    ds_read_b64_tr_b16 v[250:251], v71 offset:8864
    s_waitcnt lgkmcnt(8)
    v_mfma_f32_16x16x32_bf16 v[144:147], v[228:231], v[180:183], v[144:147]
    ds_read_b64_tr_b16 v[224:225], v70 offset:8320
    v_mfma_f32_16x16x32_bf16 v[148:151], v[228:231], v[184:187], v[148:151]
    ds_read_b64_tr_b16 v[226:227], v70 offset:8832
    v_mfma_f32_16x16x32_bf16 v[152:155], v[232:235], v[180:183], v[152:155]
    ds_read_b64_tr_b16 v[228:229], v70 offset:8352
    v_mfma_f32_16x16x32_bf16 v[156:159], v[232:235], v[184:187], v[156:159]
    ds_read_b64_tr_b16 v[230:231], v70 offset:8864
    s_waitcnt lgkmcnt(8)
    v_mfma_f32_16x16x32_bf16 v[160:163], v[236:239], v[180:183], v[160:163]
    ds_read_b64_tr_b16 v[232:233], v70
    v_mfma_f32_16x16x32_bf16 v[164:167], v[236:239], v[184:187], v[164:167]
    ds_read_b64_tr_b16 v[234:235], v70 offset:512
    v_mfma_f32_16x16x32_bf16 v[168:171], v[240:243], v[180:183], v[168:171]
    ds_read_b64_tr_b16 v[236:237], v70 offset:32
    v_mfma_f32_16x16x32_bf16 v[172:175], v[240:243], v[184:187], v[172:175]
    ds_read_b64_tr_b16 v[238:239], v70 offset:544
    s_waitcnt lgkmcnt(8)
    s_waitcnt vmcnt(9)
    v_mfma_f32_16x16x32_bf16 v[128:131], v[244:247], v[188:191], v[128:131]
    ds_read_b64_tr_b16 v[240:241], v71
    v_mfma_f32_16x16x32_bf16 v[132:135], v[244:247], v[192:195], v[132:135]
    ds_read_b64_tr_b16 v[242:243], v71 offset:512
    buffer_load_dwordx4 v[180:183], v2, s[32:35], s16 offen offset:3072 sc1
    v_mfma_f32_16x16x32_bf16 v[136:139], v[248:251], v[188:191], v[136:139]
    ds_read_b64_tr_b16 v[244:245], v71 offset:32
    v_mfma_f32_16x16x32_bf16 v[140:143], v[248:251], v[192:195], v[140:143]
    ds_read_b64_tr_b16 v[246:247], v71 offset:544
    s_waitcnt lgkmcnt(8)
    v_mfma_f32_16x16x32_bf16 v[112:115], v[224:227], v[188:191], v[112:115]
    ds_read_b64_tr_b16 v[248:249], v70 offset:16640
    v_mfma_f32_16x16x32_bf16 v[116:119], v[224:227], v[192:195], v[116:119]
    ds_read_b64_tr_b16 v[250:251], v70 offset:17152
    v_mfma_f32_16x16x32_bf16 v[120:123], v[228:231], v[188:191], v[120:123]
    ds_read_b64_tr_b16 v[224:225], v70 offset:16672
    v_mfma_f32_16x16x32_bf16 v[124:127], v[228:231], v[192:195], v[124:127]
    ds_read_b64_tr_b16 v[226:227], v70 offset:17184
    s_add_u32 s96, s85, 7
    s_and_b32 s97, s96, 15
    s_lshl_b32 s98, s97, 14
    s_add_u32 s16, s98, s15
    buffer_load_dwordx4 v[184:187], v2, s[32:35], s16 offen sc1
    s_waitcnt lgkmcnt(8)
    v_mfma_f32_16x16x32_bf16 v[80:83], v[232:235], v[188:191], v[80:83]
    ds_read_b64_tr_b16 v[228:229], v71 offset:16640
    v_mfma_f32_16x16x32_bf16 v[84:87], v[232:235], v[192:195], v[84:87]
    ds_read_b64_tr_b16 v[230:231], v71 offset:17152
    v_mfma_f32_16x16x32_bf16 v[88:91], v[236:239], v[188:191], v[88:91]
    ds_read_b64_tr_b16 v[232:233], v71 offset:16672
    v_mfma_f32_16x16x32_bf16 v[92:95], v[236:239], v[192:195], v[92:95]
    ds_read_b64_tr_b16 v[234:235], v71 offset:17184
    s_waitcnt lgkmcnt(8)
    v_mfma_f32_16x16x32_bf16 v[96:99], v[240:243], v[188:191], v[96:99]
    ds_read_b64_tr_b16 v[236:237], v71 offset:12480
    v_mfma_f32_16x16x32_bf16 v[100:103], v[240:243], v[192:195], v[100:103]
    ds_read_b64_tr_b16 v[238:239], v71 offset:12992
    v_mfma_f32_16x16x32_bf16 v[104:107], v[244:247], v[188:191], v[104:107]
    ds_read_b64_tr_b16 v[240:241], v71 offset:12512
    v_mfma_f32_16x16x32_bf16 v[108:111], v[244:247], v[192:195], v[108:111]
    ds_read_b64_tr_b16 v[242:243], v71 offset:13024
    s_waitcnt lgkmcnt(8)
    v_mfma_f32_16x16x32_bf16 v[144:147], v[248:251], v[188:191], v[144:147]
    ds_read_b64_tr_b16 v[244:245], v70 offset:12480
    v_mfma_f32_16x16x32_bf16 v[148:151], v[248:251], v[192:195], v[148:151]
    ds_read_b64_tr_b16 v[246:247], v70 offset:12992
    v_mfma_f32_16x16x32_bf16 v[152:155], v[224:227], v[188:191], v[152:155]
    ds_read_b64_tr_b16 v[248:249], v70 offset:12512
    v_mfma_f32_16x16x32_bf16 v[156:159], v[224:227], v[192:195], v[156:159]
    ds_read_b64_tr_b16 v[250:251], v70 offset:13024
    s_waitcnt lgkmcnt(8)
    v_mfma_f32_16x16x32_bf16 v[160:163], v[228:231], v[188:191], v[160:163]
    ds_read_b64_tr_b16 v[224:225], v70 offset:4160
    v_mfma_f32_16x16x32_bf16 v[164:167], v[228:231], v[192:195], v[164:167]
    ds_read_b64_tr_b16 v[226:227], v70 offset:4672
    v_mfma_f32_16x16x32_bf16 v[168:171], v[232:235], v[188:191], v[168:171]
    ds_read_b64_tr_b16 v[228:229], v70 offset:4192
    v_mfma_f32_16x16x32_bf16 v[172:175], v[232:235], v[192:195], v[172:175]
    ds_read_b64_tr_b16 v[230:231], v70 offset:4704
    s_waitcnt lgkmcnt(8)
    s_waitcnt vmcnt(9)
    v_mfma_f32_16x16x32_bf16 v[128:131], v[236:239], v[196:199], v[128:131]
    ds_read_b64_tr_b16 v[232:233], v71 offset:4160
    v_mfma_f32_16x16x32_bf16 v[132:135], v[236:239], v[200:203], v[132:135]
    ds_read_b64_tr_b16 v[234:235], v71 offset:4672
    buffer_load_dwordx4 v[188:191], v2, s[32:35], s16 offen offset:1024 sc1
    v_mfma_f32_16x16x32_bf16 v[136:139], v[240:243], v[196:199], v[136:139]
    ds_read_b64_tr_b16 v[236:237], v71 offset:4192
    v_mfma_f32_16x16x32_bf16 v[140:143], v[240:243], v[200:203], v[140:143]
    ds_read_b64_tr_b16 v[238:239], v71 offset:4704
    s_waitcnt lgkmcnt(8)
    v_mfma_f32_16x16x32_bf16 v[112:115], v[244:247], v[196:199], v[112:115]
    ds_read_b64_tr_b16 v[240:241], v70 offset:20800
    v_mfma_f32_16x16x32_bf16 v[116:119], v[244:247], v[200:203], v[116:119]
    ds_read_b64_tr_b16 v[242:243], v70 offset:21312
    v_mfma_f32_16x16x32_bf16 v[120:123], v[248:251], v[196:199], v[120:123]
    ds_read_b64_tr_b16 v[244:245], v70 offset:20832
    v_mfma_f32_16x16x32_bf16 v[124:127], v[248:251], v[200:203], v[124:127]
    ds_read_b64_tr_b16 v[246:247], v70 offset:21344
    buffer_load_dwordx4 v[192:195], v2, s[32:35], s16 offen offset:2048 sc1
    s_waitcnt lgkmcnt(8)
    v_mfma_f32_16x16x32_bf16 v[80:83], v[224:227], v[196:199], v[80:83]
    ds_read_b64_tr_b16 v[248:249], v71 offset:20800
    v_mfma_f32_16x16x32_bf16 v[84:87], v[224:227], v[200:203], v[84:87]
    ds_read_b64_tr_b16 v[250:251], v71 offset:21312
    v_mfma_f32_16x16x32_bf16 v[88:91], v[228:231], v[196:199], v[88:91]
    ds_read_b64_tr_b16 v[224:225], v71 offset:20832
    v_mfma_f32_16x16x32_bf16 v[92:95], v[228:231], v[200:203], v[92:95]
    ds_read_b64_tr_b16 v[226:227], v71 offset:21344
    s_waitcnt lgkmcnt(8)
    v_mfma_f32_16x16x32_bf16 v[96:99], v[232:235], v[196:199], v[96:99]
    s_barrier
    ds_read_b64_tr_b16 v[228:229], v71 offset:33280
    v_mfma_f32_16x16x32_bf16 v[100:103], v[232:235], v[200:203], v[100:103]
    ds_read_b64_tr_b16 v[230:231], v71 offset:33792
    v_mfma_f32_16x16x32_bf16 v[104:107], v[236:239], v[196:199], v[104:107]
    ds_read_b64_tr_b16 v[232:233], v71 offset:33312
    v_mfma_f32_16x16x32_bf16 v[108:111], v[236:239], v[200:203], v[108:111]
    ds_read_b64_tr_b16 v[234:235], v71 offset:33824
    s_waitcnt lgkmcnt(8)
    v_mfma_f32_16x16x32_bf16 v[144:147], v[240:243], v[196:199], v[144:147]
    ds_read_b64_tr_b16 v[236:237], v70 offset:33280
    v_mfma_f32_16x16x32_bf16 v[148:151], v[240:243], v[200:203], v[148:151]
    ds_read_b64_tr_b16 v[238:239], v70 offset:33792
    v_mfma_f32_16x16x32_bf16 v[152:155], v[244:247], v[196:199], v[152:155]
    ds_read_b64_tr_b16 v[240:241], v70 offset:33312
    v_mfma_f32_16x16x32_bf16 v[156:159], v[244:247], v[200:203], v[156:159]
    ds_read_b64_tr_b16 v[242:243], v70 offset:33824
    s_waitcnt lgkmcnt(8)
    v_mfma_f32_16x16x32_bf16 v[160:163], v[248:251], v[196:199], v[160:163]
    ds_read_b64_tr_b16 v[244:245], v70 offset:24960
    v_mfma_f32_16x16x32_bf16 v[164:167], v[248:251], v[200:203], v[164:167]
    ds_read_b64_tr_b16 v[246:247], v70 offset:25472
    v_mfma_f32_16x16x32_bf16 v[168:171], v[224:227], v[196:199], v[168:171]
    ds_read_b64_tr_b16 v[248:249], v70 offset:24992
    v_mfma_f32_16x16x32_bf16 v[172:175], v[224:227], v[200:203], v[172:175]
    ds_read_b64_tr_b16 v[250:251], v70 offset:25504
    s_waitcnt lgkmcnt(8)
    s_waitcnt vmcnt(9)
    v_mfma_f32_16x16x32_bf16 v[128:131], v[228:231], v[204:207], v[128:131]
    ds_read_b64_tr_b16 v[224:225], v71 offset:24960
    v_mfma_f32_16x16x32_bf16 v[132:135], v[228:231], v[208:211], v[132:135]
    ds_read_b64_tr_b16 v[226:227], v71 offset:25472
    buffer_load_dwordx4 v[196:199], v2, s[32:35], s16 offen offset:3072 sc1
    v_mfma_f32_16x16x32_bf16 v[136:139], v[232:235], v[204:207], v[136:139]
    ds_read_b64_tr_b16 v[228:229], v71 offset:24992
    v_mfma_f32_16x16x32_bf16 v[140:143], v[232:235], v[208:211], v[140:143]
    ds_read_b64_tr_b16 v[230:231], v71 offset:25504
    s_waitcnt lgkmcnt(8)
    v_mfma_f32_16x16x32_bf16 v[112:115], v[236:239], v[204:207], v[112:115]
    ds_read_b64_tr_b16 v[232:233], v70 offset:41600
    v_mfma_f32_16x16x32_bf16 v[116:119], v[236:239], v[208:211], v[116:119]
    ds_read_b64_tr_b16 v[234:235], v70 offset:42112
    v_mfma_f32_16x16x32_bf16 v[120:123], v[240:243], v[204:207], v[120:123]
    ds_read_b64_tr_b16 v[236:237], v70 offset:41632
    v_mfma_f32_16x16x32_bf16 v[124:127], v[240:243], v[208:211], v[124:127]
    ds_read_b64_tr_b16 v[238:239], v70 offset:42144
    s_add_u32 s96, s85, 8
    s_and_b32 s97, s96, 15
    s_lshl_b32 s98, s97, 14
    s_add_u32 s16, s98, s15
    buffer_load_dwordx4 v[200:203], v2, s[32:35], s16 offen sc1
    s_waitcnt lgkmcnt(8)
    v_mfma_f32_16x16x32_bf16 v[80:83], v[244:247], v[204:207], v[80:83]
    ds_read_b64_tr_b16 v[240:241], v71 offset:41600
    v_mfma_f32_16x16x32_bf16 v[84:87], v[244:247], v[208:211], v[84:87]
    ds_read_b64_tr_b16 v[242:243], v71 offset:42112
    v_mfma_f32_16x16x32_bf16 v[88:91], v[248:251], v[204:207], v[88:91]
    ds_read_b64_tr_b16 v[244:245], v71 offset:41632
    v_mfma_f32_16x16x32_bf16 v[92:95], v[248:251], v[208:211], v[92:95]
    ds_read_b64_tr_b16 v[246:247], v71 offset:42144
    s_waitcnt lgkmcnt(8)
    v_mfma_f32_16x16x32_bf16 v[96:99], v[224:227], v[204:207], v[96:99]
    ds_read_b64_tr_b16 v[248:249], v71 offset:37440
    v_mfma_f32_16x16x32_bf16 v[100:103], v[224:227], v[208:211], v[100:103]
    ds_read_b64_tr_b16 v[250:251], v71 offset:37952
    v_mfma_f32_16x16x32_bf16 v[104:107], v[228:231], v[204:207], v[104:107]
    ds_read_b64_tr_b16 v[224:225], v71 offset:37472
    v_mfma_f32_16x16x32_bf16 v[108:111], v[228:231], v[208:211], v[108:111]
    ds_read_b64_tr_b16 v[226:227], v71 offset:37984
    s_waitcnt lgkmcnt(8)
    v_mfma_f32_16x16x32_bf16 v[144:147], v[232:235], v[204:207], v[144:147]
    ds_read_b64_tr_b16 v[228:229], v70 offset:37440
    v_mfma_f32_16x16x32_bf16 v[148:151], v[232:235], v[208:211], v[148:151]
    ds_read_b64_tr_b16 v[230:231], v70 offset:37952
    v_mfma_f32_16x16x32_bf16 v[152:155], v[236:239], v[204:207], v[152:155]
    ds_read_b64_tr_b16 v[232:233], v70 offset:37472
    v_mfma_f32_16x16x32_bf16 v[156:159], v[236:239], v[208:211], v[156:159]
    ds_read_b64_tr_b16 v[234:235], v70 offset:37984
    s_waitcnt lgkmcnt(8)
    v_mfma_f32_16x16x32_bf16 v[160:163], v[240:243], v[204:207], v[160:163]
    ds_read_b64_tr_b16 v[236:237], v70 offset:29120
    v_mfma_f32_16x16x32_bf16 v[164:167], v[240:243], v[208:211], v[164:167]
    ds_read_b64_tr_b16 v[238:239], v70 offset:29632
    v_mfma_f32_16x16x32_bf16 v[168:171], v[244:247], v[204:207], v[168:171]
    ds_read_b64_tr_b16 v[240:241], v70 offset:29152
    v_mfma_f32_16x16x32_bf16 v[172:175], v[244:247], v[208:211], v[172:175]
    ds_read_b64_tr_b16 v[242:243], v70 offset:29664
    s_waitcnt lgkmcnt(8)
    s_waitcnt vmcnt(9)
    v_mfma_f32_16x16x32_bf16 v[128:131], v[248:251], v[212:215], v[128:131]
    ds_read_b64_tr_b16 v[244:245], v71 offset:29120
    v_mfma_f32_16x16x32_bf16 v[132:135], v[248:251], v[216:219], v[132:135]
    ds_read_b64_tr_b16 v[246:247], v71 offset:29632
    buffer_load_dwordx4 v[204:207], v2, s[32:35], s16 offen offset:1024 sc1
    v_mfma_f32_16x16x32_bf16 v[136:139], v[224:227], v[212:215], v[136:139]
    ds_read_b64_tr_b16 v[248:249], v71 offset:29152
    v_mfma_f32_16x16x32_bf16 v[140:143], v[224:227], v[216:219], v[140:143]
    ds_read_b64_tr_b16 v[250:251], v71 offset:29664
    s_waitcnt lgkmcnt(8)
    v_mfma_f32_16x16x32_bf16 v[112:115], v[228:231], v[212:215], v[112:115]
    ds_read_b64_tr_b16 v[224:225], v70 offset:45760
    v_mfma_f32_16x16x32_bf16 v[116:119], v[228:231], v[216:219], v[116:119]
    ds_read_b64_tr_b16 v[226:227], v70 offset:46272
    v_mfma_f32_16x16x32_bf16 v[120:123], v[232:235], v[212:215], v[120:123]
    ds_read_b64_tr_b16 v[228:229], v70 offset:45792
    v_mfma_f32_16x16x32_bf16 v[124:127], v[232:235], v[216:219], v[124:127]
    ds_read_b64_tr_b16 v[230:231], v70 offset:46304
    buffer_load_dwordx4 v[208:211], v2, s[32:35], s16 offen offset:2048 sc1
    s_waitcnt lgkmcnt(8)
    v_mfma_f32_16x16x32_bf16 v[80:83], v[236:239], v[212:215], v[80:83]
    ds_read_b64_tr_b16 v[232:233], v71 offset:45760
    v_mfma_f32_16x16x32_bf16 v[84:87], v[236:239], v[216:219], v[84:87]
    ds_read_b64_tr_b16 v[234:235], v71 offset:46272
    v_mfma_f32_16x16x32_bf16 v[88:91], v[240:243], v[212:215], v[88:91]
    ds_read_b64_tr_b16 v[236:237], v71 offset:45792
    v_mfma_f32_16x16x32_bf16 v[92:95], v[240:243], v[216:219], v[92:95]
    ds_read_b64_tr_b16 v[238:239], v71 offset:46304
    s_waitcnt lgkmcnt(8)
    v_mfma_f32_16x16x32_bf16 v[96:99], v[244:247], v[212:215], v[96:99]
    s_barrier
    ds_read_b64_tr_b16 v[240:241], v67 offset:8320
    v_mfma_f32_16x16x32_bf16 v[100:103], v[244:247], v[216:219], v[100:103]
    ds_read_b64_tr_b16 v[242:243], v67 offset:8832
    v_mfma_f32_16x16x32_bf16 v[104:107], v[248:251], v[212:215], v[104:107]
    ds_read_b64_tr_b16 v[244:245], v67 offset:8352
    v_mfma_f32_16x16x32_bf16 v[108:111], v[248:251], v[216:219], v[108:111]
    ds_read_b64_tr_b16 v[246:247], v67 offset:8864
    s_waitcnt lgkmcnt(8)
    v_mfma_f32_16x16x32_bf16 v[144:147], v[224:227], v[212:215], v[144:147]
    ds_read_b64_tr_b16 v[248:249], v66 offset:8320
    v_mfma_f32_16x16x32_bf16 v[148:151], v[224:227], v[216:219], v[148:151]
    ds_read_b64_tr_b16 v[250:251], v66 offset:8832
    v_mfma_f32_16x16x32_bf16 v[152:155], v[228:231], v[212:215], v[152:155]
    ds_read_b64_tr_b16 v[224:225], v66 offset:8352
    v_mfma_f32_16x16x32_bf16 v[156:159], v[228:231], v[216:219], v[156:159]
    ds_read_b64_tr_b16 v[226:227], v66 offset:8864
    s_waitcnt lgkmcnt(8)
    v_mfma_f32_16x16x32_bf16 v[160:163], v[232:235], v[212:215], v[160:163]
    ds_read_b64_tr_b16 v[228:229], v66
    v_mfma_f32_16x16x32_bf16 v[164:167], v[232:235], v[216:219], v[164:167]
    ds_read_b64_tr_b16 v[230:231], v66 offset:512
    v_mfma_f32_16x16x32_bf16 v[168:171], v[236:239], v[212:215], v[168:171]
    ds_read_b64_tr_b16 v[232:233], v66 offset:32
    v_mfma_f32_16x16x32_bf16 v[172:175], v[236:239], v[216:219], v[172:175]
    ds_read_b64_tr_b16 v[234:235], v66 offset:544
    s_waitcnt lgkmcnt(8)
    s_waitcnt vmcnt(9)
    v_mfma_f32_16x16x32_bf16 v[128:131], v[240:243], v[220:223], v[128:131]
    ds_read_b64_tr_b16 v[236:237], v67
    v_mfma_f32_16x16x32_bf16 v[132:135], v[240:243], v[36:39], v[132:135]
    ds_read_b64_tr_b16 v[238:239], v67 offset:512
    buffer_load_dwordx4 v[212:215], v2, s[32:35], s16 offen offset:3072 sc1
    v_mfma_f32_16x16x32_bf16 v[136:139], v[244:247], v[220:223], v[136:139]
    ds_read_b64_tr_b16 v[240:241], v67 offset:32
    v_mfma_f32_16x16x32_bf16 v[140:143], v[244:247], v[36:39], v[140:143]
    ds_read_b64_tr_b16 v[242:243], v67 offset:544
    s_waitcnt lgkmcnt(8)
    v_mfma_f32_16x16x32_bf16 v[112:115], v[248:251], v[220:223], v[112:115]
    ds_read_b64_tr_b16 v[244:245], v66 offset:16640
    v_mfma_f32_16x16x32_bf16 v[116:119], v[248:251], v[36:39], v[116:119]
    ds_read_b64_tr_b16 v[246:247], v66 offset:17152
    v_mfma_f32_16x16x32_bf16 v[120:123], v[224:227], v[220:223], v[120:123]
    ds_read_b64_tr_b16 v[248:249], v66 offset:16672
    v_mfma_f32_16x16x32_bf16 v[124:127], v[224:227], v[36:39], v[124:127]
    ds_read_b64_tr_b16 v[250:251], v66 offset:17184
    s_add_u32 s96, s85, 9
    s_and_b32 s97, s96, 15
    s_lshl_b32 s98, s97, 14
    s_add_u32 s16, s98, s15
    buffer_load_dwordx4 v[216:219], v2, s[32:35], s16 offen sc1
    s_waitcnt lgkmcnt(8)
    v_mfma_f32_16x16x32_bf16 v[80:83], v[228:231], v[220:223], v[80:83]
    ds_read_b64_tr_b16 v[224:225], v67 offset:16640
    v_mfma_f32_16x16x32_bf16 v[84:87], v[228:231], v[36:39], v[84:87]
    ds_read_b64_tr_b16 v[226:227], v67 offset:17152
    v_mfma_f32_16x16x32_bf16 v[88:91], v[232:235], v[220:223], v[88:91]
    ds_read_b64_tr_b16 v[228:229], v67 offset:16672
    v_mfma_f32_16x16x32_bf16 v[92:95], v[232:235], v[36:39], v[92:95]
    ds_read_b64_tr_b16 v[230:231], v67 offset:17184
    s_waitcnt lgkmcnt(8)
    v_mfma_f32_16x16x32_bf16 v[96:99], v[236:239], v[220:223], v[96:99]
    ds_read_b64_tr_b16 v[232:233], v67 offset:12480
    v_mfma_f32_16x16x32_bf16 v[100:103], v[236:239], v[36:39], v[100:103]
    ds_read_b64_tr_b16 v[234:235], v67 offset:12992
    v_mfma_f32_16x16x32_bf16 v[104:107], v[240:243], v[220:223], v[104:107]
    ds_read_b64_tr_b16 v[236:237], v67 offset:12512
    v_mfma_f32_16x16x32_bf16 v[108:111], v[240:243], v[36:39], v[108:111]
    ds_read_b64_tr_b16 v[238:239], v67 offset:13024
    s_waitcnt lgkmcnt(8)
    v_mfma_f32_16x16x32_bf16 v[144:147], v[244:247], v[220:223], v[144:147]
    ds_read_b64_tr_b16 v[240:241], v66 offset:12480
    v_mfma_f32_16x16x32_bf16 v[148:151], v[244:247], v[36:39], v[148:151]
    ds_read_b64_tr_b16 v[242:243], v66 offset:12992
    v_mfma_f32_16x16x32_bf16 v[152:155], v[248:251], v[220:223], v[152:155]
    ds_read_b64_tr_b16 v[244:245], v66 offset:12512
    v_mfma_f32_16x16x32_bf16 v[156:159], v[248:251], v[36:39], v[156:159]
    ds_read_b64_tr_b16 v[246:247], v66 offset:13024
    s_waitcnt lgkmcnt(8)
    v_mfma_f32_16x16x32_bf16 v[160:163], v[224:227], v[220:223], v[160:163]
    ds_read_b64_tr_b16 v[248:249], v66 offset:4160
    v_mfma_f32_16x16x32_bf16 v[164:167], v[224:227], v[36:39], v[164:167]
    ds_read_b64_tr_b16 v[250:251], v66 offset:4672
    v_mfma_f32_16x16x32_bf16 v[168:171], v[228:231], v[220:223], v[168:171]
    ds_read_b64_tr_b16 v[224:225], v66 offset:4192
    v_mfma_f32_16x16x32_bf16 v[172:175], v[228:231], v[36:39], v[172:175]
    ds_read_b64_tr_b16 v[226:227], v66 offset:4704
    s_waitcnt lgkmcnt(8)
    s_waitcnt vmcnt(9)
    v_mfma_f32_16x16x32_bf16 v[128:131], v[232:235], v[176:179], v[128:131]
    ds_read_b64_tr_b16 v[228:229], v67 offset:4160
    v_mfma_f32_16x16x32_bf16 v[132:135], v[232:235], v[180:183], v[132:135]
    ds_read_b64_tr_b16 v[230:231], v67 offset:4672
    buffer_load_dwordx4 v[220:223], v2, s[32:35], s16 offen offset:1024 sc1
    v_mfma_f32_16x16x32_bf16 v[136:139], v[236:239], v[176:179], v[136:139]
    ds_read_b64_tr_b16 v[232:233], v67 offset:4192
    v_mfma_f32_16x16x32_bf16 v[140:143], v[236:239], v[180:183], v[140:143]
    ds_read_b64_tr_b16 v[234:235], v67 offset:4704
    s_waitcnt lgkmcnt(8)
    v_mfma_f32_16x16x32_bf16 v[112:115], v[240:243], v[176:179], v[112:115]
    ds_read_b64_tr_b16 v[236:237], v66 offset:20800
    v_mfma_f32_16x16x32_bf16 v[116:119], v[240:243], v[180:183], v[116:119]
    ds_read_b64_tr_b16 v[238:239], v66 offset:21312
    v_mfma_f32_16x16x32_bf16 v[120:123], v[244:247], v[176:179], v[120:123]
    ds_read_b64_tr_b16 v[240:241], v66 offset:20832
    v_mfma_f32_16x16x32_bf16 v[124:127], v[244:247], v[180:183], v[124:127]
    ds_read_b64_tr_b16 v[242:243], v66 offset:21344
    buffer_load_dwordx4 v[36:39], v2, s[32:35], s16 offen offset:2048 sc1
    s_waitcnt lgkmcnt(8)
    v_mfma_f32_16x16x32_bf16 v[80:83], v[248:251], v[176:179], v[80:83]
    ds_read_b64_tr_b16 v[244:245], v67 offset:20800
    v_mfma_f32_16x16x32_bf16 v[84:87], v[248:251], v[180:183], v[84:87]
    ds_read_b64_tr_b16 v[246:247], v67 offset:21312
    v_mfma_f32_16x16x32_bf16 v[88:91], v[224:227], v[176:179], v[88:91]
    ds_read_b64_tr_b16 v[248:249], v67 offset:20832
    v_mfma_f32_16x16x32_bf16 v[92:95], v[224:227], v[180:183], v[92:95]
    ds_read_b64_tr_b16 v[250:251], v67 offset:21344
    s_waitcnt lgkmcnt(8)
    v_mfma_f32_16x16x32_bf16 v[96:99], v[228:231], v[176:179], v[96:99]
    s_barrier
    ds_read_b64_tr_b16 v[224:225], v67 offset:33280
    v_mfma_f32_16x16x32_bf16 v[100:103], v[228:231], v[180:183], v[100:103]
    ds_read_b64_tr_b16 v[226:227], v67 offset:33792
    v_mfma_f32_16x16x32_bf16 v[104:107], v[232:235], v[176:179], v[104:107]
    ds_read_b64_tr_b16 v[228:229], v67 offset:33312
    v_mfma_f32_16x16x32_bf16 v[108:111], v[232:235], v[180:183], v[108:111]
    ds_read_b64_tr_b16 v[230:231], v67 offset:33824
    s_waitcnt lgkmcnt(8)
    v_mfma_f32_16x16x32_bf16 v[144:147], v[236:239], v[176:179], v[144:147]
    ds_read_b64_tr_b16 v[232:233], v66 offset:33280
    v_mfma_f32_16x16x32_bf16 v[148:151], v[236:239], v[180:183], v[148:151]
    ds_read_b64_tr_b16 v[234:235], v66 offset:33792
    v_mfma_f32_16x16x32_bf16 v[152:155], v[240:243], v[176:179], v[152:155]
    ds_read_b64_tr_b16 v[236:237], v66 offset:33312
    v_mfma_f32_16x16x32_bf16 v[156:159], v[240:243], v[180:183], v[156:159]
    ds_read_b64_tr_b16 v[238:239], v66 offset:33824
    s_waitcnt lgkmcnt(8)
    v_mfma_f32_16x16x32_bf16 v[160:163], v[244:247], v[176:179], v[160:163]
    ds_read_b64_tr_b16 v[240:241], v66 offset:24960
    v_mfma_f32_16x16x32_bf16 v[164:167], v[244:247], v[180:183], v[164:167]
    ds_read_b64_tr_b16 v[242:243], v66 offset:25472
    v_mfma_f32_16x16x32_bf16 v[168:171], v[248:251], v[176:179], v[168:171]
    ds_read_b64_tr_b16 v[244:245], v66 offset:24992
    v_mfma_f32_16x16x32_bf16 v[172:175], v[248:251], v[180:183], v[172:175]
    ds_read_b64_tr_b16 v[246:247], v66 offset:25504
    s_waitcnt lgkmcnt(8)
    s_waitcnt vmcnt(9)
    v_mfma_f32_16x16x32_bf16 v[128:131], v[224:227], v[184:187], v[128:131]
    ds_read_b64_tr_b16 v[248:249], v67 offset:24960
    v_mfma_f32_16x16x32_bf16 v[132:135], v[224:227], v[188:191], v[132:135]
    ds_read_b64_tr_b16 v[250:251], v67 offset:25472
    buffer_load_dwordx4 v[176:179], v2, s[32:35], s16 offen offset:3072 sc1
    v_mfma_f32_16x16x32_bf16 v[136:139], v[228:231], v[184:187], v[136:139]
    ds_read_b64_tr_b16 v[224:225], v67 offset:24992
    v_mfma_f32_16x16x32_bf16 v[140:143], v[228:231], v[188:191], v[140:143]
    ds_read_b64_tr_b16 v[226:227], v67 offset:25504
    s_waitcnt lgkmcnt(8)
    v_mfma_f32_16x16x32_bf16 v[112:115], v[232:235], v[184:187], v[112:115]
    ds_read_b64_tr_b16 v[228:229], v66 offset:41600
    v_mfma_f32_16x16x32_bf16 v[116:119], v[232:235], v[188:191], v[116:119]
    ds_read_b64_tr_b16 v[230:231], v66 offset:42112
    v_mfma_f32_16x16x32_bf16 v[120:123], v[236:239], v[184:187], v[120:123]
    ds_read_b64_tr_b16 v[232:233], v66 offset:41632
    v_mfma_f32_16x16x32_bf16 v[124:127], v[236:239], v[188:191], v[124:127]
    ds_read_b64_tr_b16 v[234:235], v66 offset:42144
    s_add_u32 s96, s85, 10
    s_and_b32 s97, s96, 15
    s_lshl_b32 s98, s97, 14
    s_add_u32 s16, s98, s15
    buffer_load_dwordx4 v[180:183], v2, s[32:35], s16 offen sc1
    s_waitcnt lgkmcnt(8)
    v_mfma_f32_16x16x32_bf16 v[80:83], v[240:243], v[184:187], v[80:83]
    ds_read_b64_tr_b16 v[236:237], v67 offset:41600
    v_mfma_f32_16x16x32_bf16 v[84:87], v[240:243], v[188:191], v[84:87]
    ds_read_b64_tr_b16 v[238:239], v67 offset:42112
    v_mfma_f32_16x16x32_bf16 v[88:91], v[244:247], v[184:187], v[88:91]
    ds_read_b64_tr_b16 v[240:241], v67 offset:41632
    v_mfma_f32_16x16x32_bf16 v[92:95], v[244:247], v[188:191], v[92:95]
    ds_read_b64_tr_b16 v[242:243], v67 offset:42144
    s_waitcnt lgkmcnt(8)
    v_mfma_f32_16x16x32_bf16 v[96:99], v[248:251], v[184:187], v[96:99]
    ds_read_b64_tr_b16 v[244:245], v67 offset:37440
    v_mfma_f32_16x16x32_bf16 v[100:103], v[248:251], v[188:191], v[100:103]
    ds_read_b64_tr_b16 v[246:247], v67 offset:37952
    v_mfma_f32_16x16x32_bf16 v[104:107], v[224:227], v[184:187], v[104:107]
    ds_read_b64_tr_b16 v[248:249], v67 offset:37472
    v_mfma_f32_16x16x32_bf16 v[108:111], v[224:227], v[188:191], v[108:111]
    ds_read_b64_tr_b16 v[250:251], v67 offset:37984
    s_waitcnt lgkmcnt(8)
    v_mfma_f32_16x16x32_bf16 v[144:147], v[228:231], v[184:187], v[144:147]
    ds_read_b64_tr_b16 v[224:225], v66 offset:37440
    v_mfma_f32_16x16x32_bf16 v[148:151], v[228:231], v[188:191], v[148:151]
    ds_read_b64_tr_b16 v[226:227], v66 offset:37952
    v_mfma_f32_16x16x32_bf16 v[152:155], v[232:235], v[184:187], v[152:155]
    ds_read_b64_tr_b16 v[228:229], v66 offset:37472
    v_mfma_f32_16x16x32_bf16 v[156:159], v[232:235], v[188:191], v[156:159]
    ds_read_b64_tr_b16 v[230:231], v66 offset:37984
    s_waitcnt lgkmcnt(8)
    v_mfma_f32_16x16x32_bf16 v[160:163], v[236:239], v[184:187], v[160:163]
    ds_read_b64_tr_b16 v[232:233], v66 offset:29120
    v_mfma_f32_16x16x32_bf16 v[164:167], v[236:239], v[188:191], v[164:167]
    ds_read_b64_tr_b16 v[234:235], v66 offset:29632
    v_mfma_f32_16x16x32_bf16 v[168:171], v[240:243], v[184:187], v[168:171]
    ds_read_b64_tr_b16 v[236:237], v66 offset:29152
    v_mfma_f32_16x16x32_bf16 v[172:175], v[240:243], v[188:191], v[172:175]
    ds_read_b64_tr_b16 v[238:239], v66 offset:29664
    s_waitcnt lgkmcnt(8)
    s_waitcnt vmcnt(9)
    v_mfma_f32_16x16x32_bf16 v[128:131], v[244:247], v[192:195], v[128:131]
    ds_read_b64_tr_b16 v[240:241], v67 offset:29120
    v_mfma_f32_16x16x32_bf16 v[132:135], v[244:247], v[196:199], v[132:135]
    ds_read_b64_tr_b16 v[242:243], v67 offset:29632
    buffer_load_dwordx4 v[184:187], v2, s[32:35], s16 offen offset:1024 sc1
    v_mfma_f32_16x16x32_bf16 v[136:139], v[248:251], v[192:195], v[136:139]
    ds_read_b64_tr_b16 v[244:245], v67 offset:29152
    v_mfma_f32_16x16x32_bf16 v[140:143], v[248:251], v[196:199], v[140:143]
    ds_read_b64_tr_b16 v[246:247], v67 offset:29664
    s_waitcnt lgkmcnt(8)
    v_mfma_f32_16x16x32_bf16 v[112:115], v[224:227], v[192:195], v[112:115]
    ds_read_b64_tr_b16 v[248:249], v66 offset:45760
    v_mfma_f32_16x16x32_bf16 v[116:119], v[224:227], v[196:199], v[116:119]
    ds_read_b64_tr_b16 v[250:251], v66 offset:46272
    v_mfma_f32_16x16x32_bf16 v[120:123], v[228:231], v[192:195], v[120:123]
    ds_read_b64_tr_b16 v[224:225], v66 offset:45792
    v_mfma_f32_16x16x32_bf16 v[124:127], v[228:231], v[196:199], v[124:127]
    ds_read_b64_tr_b16 v[226:227], v66 offset:46304
    buffer_load_dwordx4 v[188:191], v2, s[32:35], s16 offen offset:2048 sc1
    s_waitcnt lgkmcnt(8)
    v_mfma_f32_16x16x32_bf16 v[80:83], v[232:235], v[192:195], v[80:83]
    ds_read_b64_tr_b16 v[228:229], v67 offset:45760
    v_mfma_f32_16x16x32_bf16 v[84:87], v[232:235], v[196:199], v[84:87]
    ds_read_b64_tr_b16 v[230:231], v67 offset:46272
    v_mfma_f32_16x16x32_bf16 v[88:91], v[236:239], v[192:195], v[88:91]
    ds_read_b64_tr_b16 v[232:233], v67 offset:45792
    v_mfma_f32_16x16x32_bf16 v[92:95], v[236:239], v[196:199], v[92:95]
    ds_read_b64_tr_b16 v[234:235], v67 offset:46304
    s_waitcnt lgkmcnt(8)
    v_mfma_f32_16x16x32_bf16 v[96:99], v[240:243], v[192:195], v[96:99]
    s_barrier
    ds_read_b64_tr_b16 v[236:237], v69 offset:8320
    v_mfma_f32_16x16x32_bf16 v[100:103], v[240:243], v[196:199], v[100:103]
    ds_read_b64_tr_b16 v[238:239], v69 offset:8832
    v_mfma_f32_16x16x32_bf16 v[104:107], v[244:247], v[192:195], v[104:107]
    ds_read_b64_tr_b16 v[240:241], v69 offset:8352
    v_mfma_f32_16x16x32_bf16 v[108:111], v[244:247], v[196:199], v[108:111]
    ds_read_b64_tr_b16 v[242:243], v69 offset:8864
    s_waitcnt lgkmcnt(8)
    v_mfma_f32_16x16x32_bf16 v[144:147], v[248:251], v[192:195], v[144:147]
    ds_read_b64_tr_b16 v[244:245], v68 offset:8320
    v_mfma_f32_16x16x32_bf16 v[148:151], v[248:251], v[196:199], v[148:151]
    ds_read_b64_tr_b16 v[246:247], v68 offset:8832
    v_mfma_f32_16x16x32_bf16 v[152:155], v[224:227], v[192:195], v[152:155]
    ds_read_b64_tr_b16 v[248:249], v68 offset:8352
    v_mfma_f32_16x16x32_bf16 v[156:159], v[224:227], v[196:199], v[156:159]
    ds_read_b64_tr_b16 v[250:251], v68 offset:8864
    s_waitcnt lgkmcnt(8)
    v_mfma_f32_16x16x32_bf16 v[160:163], v[228:231], v[192:195], v[160:163]
    ds_read_b64_tr_b16 v[224:225], v68
    v_mfma_f32_16x16x32_bf16 v[164:167], v[228:231], v[196:199], v[164:167]
    ds_read_b64_tr_b16 v[226:227], v68 offset:512
    v_mfma_f32_16x16x32_bf16 v[168:171], v[232:235], v[192:195], v[168:171]
    ds_read_b64_tr_b16 v[228:229], v68 offset:32
    v_mfma_f32_16x16x32_bf16 v[172:175], v[232:235], v[196:199], v[172:175]
    ds_read_b64_tr_b16 v[230:231], v68 offset:544
    s_waitcnt lgkmcnt(8)
    s_waitcnt vmcnt(9)
    v_mfma_f32_16x16x32_bf16 v[128:131], v[236:239], v[200:203], v[128:131]
    ds_read_b64_tr_b16 v[232:233], v69
    v_mfma_f32_16x16x32_bf16 v[132:135], v[236:239], v[204:207], v[132:135]
    ds_read_b64_tr_b16 v[234:235], v69 offset:512
    buffer_load_dwordx4 v[192:195], v2, s[32:35], s16 offen offset:3072 sc1
    v_mfma_f32_16x16x32_bf16 v[136:139], v[240:243], v[200:203], v[136:139]
    ds_read_b64_tr_b16 v[236:237], v69 offset:32
    v_mfma_f32_16x16x32_bf16 v[140:143], v[240:243], v[204:207], v[140:143]
    ds_read_b64_tr_b16 v[238:239], v69 offset:544
    s_waitcnt lgkmcnt(8)
    v_mfma_f32_16x16x32_bf16 v[112:115], v[244:247], v[200:203], v[112:115]
    ds_read_b64_tr_b16 v[240:241], v68 offset:16640
    v_mfma_f32_16x16x32_bf16 v[116:119], v[244:247], v[204:207], v[116:119]
    ds_read_b64_tr_b16 v[242:243], v68 offset:17152
    v_mfma_f32_16x16x32_bf16 v[120:123], v[248:251], v[200:203], v[120:123]
    ds_read_b64_tr_b16 v[244:245], v68 offset:16672
    v_mfma_f32_16x16x32_bf16 v[124:127], v[248:251], v[204:207], v[124:127]
    ds_read_b64_tr_b16 v[246:247], v68 offset:17184
    s_add_u32 s96, s85, 11
    s_and_b32 s97, s96, 15
    s_lshl_b32 s98, s97, 14
    s_add_u32 s16, s98, s15
    buffer_load_dwordx4 v[196:199], v2, s[32:35], s16 offen sc1
    s_waitcnt lgkmcnt(8)
    v_mfma_f32_16x16x32_bf16 v[80:83], v[224:227], v[200:203], v[80:83]
    ds_read_b64_tr_b16 v[248:249], v69 offset:16640
    v_mfma_f32_16x16x32_bf16 v[84:87], v[224:227], v[204:207], v[84:87]
    ds_read_b64_tr_b16 v[250:251], v69 offset:17152
    v_mfma_f32_16x16x32_bf16 v[88:91], v[228:231], v[200:203], v[88:91]
    ds_read_b64_tr_b16 v[224:225], v69 offset:16672
    v_mfma_f32_16x16x32_bf16 v[92:95], v[228:231], v[204:207], v[92:95]
    ds_read_b64_tr_b16 v[226:227], v69 offset:17184
    s_waitcnt lgkmcnt(8)
    v_mfma_f32_16x16x32_bf16 v[96:99], v[232:235], v[200:203], v[96:99]
    ds_read_b64_tr_b16 v[228:229], v69 offset:12480
    v_mfma_f32_16x16x32_bf16 v[100:103], v[232:235], v[204:207], v[100:103]
    ds_read_b64_tr_b16 v[230:231], v69 offset:12992
    v_mfma_f32_16x16x32_bf16 v[104:107], v[236:239], v[200:203], v[104:107]
    ds_read_b64_tr_b16 v[232:233], v69 offset:12512
    v_mfma_f32_16x16x32_bf16 v[108:111], v[236:239], v[204:207], v[108:111]
    ds_read_b64_tr_b16 v[234:235], v69 offset:13024
    s_waitcnt lgkmcnt(8)
    v_mfma_f32_16x16x32_bf16 v[144:147], v[240:243], v[200:203], v[144:147]
    ds_read_b64_tr_b16 v[236:237], v68 offset:12480
    v_mfma_f32_16x16x32_bf16 v[148:151], v[240:243], v[204:207], v[148:151]
    ds_read_b64_tr_b16 v[238:239], v68 offset:12992
    v_mfma_f32_16x16x32_bf16 v[152:155], v[244:247], v[200:203], v[152:155]
    ds_read_b64_tr_b16 v[240:241], v68 offset:12512
    v_mfma_f32_16x16x32_bf16 v[156:159], v[244:247], v[204:207], v[156:159]
    ds_read_b64_tr_b16 v[242:243], v68 offset:13024
    s_waitcnt lgkmcnt(8)
    v_mfma_f32_16x16x32_bf16 v[160:163], v[248:251], v[200:203], v[160:163]
    ds_read_b64_tr_b16 v[244:245], v68 offset:4160
    v_mfma_f32_16x16x32_bf16 v[164:167], v[248:251], v[204:207], v[164:167]
    ds_read_b64_tr_b16 v[246:247], v68 offset:4672
    v_mfma_f32_16x16x32_bf16 v[168:171], v[224:227], v[200:203], v[168:171]
    ds_read_b64_tr_b16 v[248:249], v68 offset:4192
    v_mfma_f32_16x16x32_bf16 v[172:175], v[224:227], v[204:207], v[172:175]
    ds_read_b64_tr_b16 v[250:251], v68 offset:4704
    s_waitcnt lgkmcnt(8)
    s_waitcnt vmcnt(9)
    v_mfma_f32_16x16x32_bf16 v[128:131], v[228:231], v[208:211], v[128:131]
    ds_read_b64_tr_b16 v[224:225], v69 offset:4160
    v_mfma_f32_16x16x32_bf16 v[132:135], v[228:231], v[212:215], v[132:135]
    ds_read_b64_tr_b16 v[226:227], v69 offset:4672
    buffer_load_dwordx4 v[200:203], v2, s[32:35], s16 offen offset:1024 sc1
    v_mfma_f32_16x16x32_bf16 v[136:139], v[232:235], v[208:211], v[136:139]
    ds_read_b64_tr_b16 v[228:229], v69 offset:4192
    v_mfma_f32_16x16x32_bf16 v[140:143], v[232:235], v[212:215], v[140:143]
    ds_read_b64_tr_b16 v[230:231], v69 offset:4704
    s_waitcnt lgkmcnt(8)
    v_mfma_f32_16x16x32_bf16 v[112:115], v[236:239], v[208:211], v[112:115]
    ds_read_b64_tr_b16 v[232:233], v68 offset:20800
    v_mfma_f32_16x16x32_bf16 v[116:119], v[236:239], v[212:215], v[116:119]
    ds_read_b64_tr_b16 v[234:235], v68 offset:21312
    v_mfma_f32_16x16x32_bf16 v[120:123], v[240:243], v[208:211], v[120:123]
    ds_read_b64_tr_b16 v[236:237], v68 offset:20832
    v_mfma_f32_16x16x32_bf16 v[124:127], v[240:243], v[212:215], v[124:127]
    ds_read_b64_tr_b16 v[238:239], v68 offset:21344
    buffer_load_dwordx4 v[204:207], v2, s[32:35], s16 offen offset:2048 sc1
    s_waitcnt lgkmcnt(8)
    v_mfma_f32_16x16x32_bf16 v[80:83], v[244:247], v[208:211], v[80:83]
    ds_read_b64_tr_b16 v[240:241], v69 offset:20800
    v_mfma_f32_16x16x32_bf16 v[84:87], v[244:247], v[212:215], v[84:87]
    ds_read_b64_tr_b16 v[242:243], v69 offset:21312
    v_mfma_f32_16x16x32_bf16 v[88:91], v[248:251], v[208:211], v[88:91]
    ds_read_b64_tr_b16 v[244:245], v69 offset:20832
    v_mfma_f32_16x16x32_bf16 v[92:95], v[248:251], v[212:215], v[92:95]
    ds_read_b64_tr_b16 v[246:247], v69 offset:21344
    s_waitcnt lgkmcnt(8)
    v_mfma_f32_16x16x32_bf16 v[96:99], v[224:227], v[208:211], v[96:99]
    s_barrier
    ds_read_b64_tr_b16 v[248:249], v69 offset:33280
    v_mfma_f32_16x16x32_bf16 v[100:103], v[224:227], v[212:215], v[100:103]
    ds_read_b64_tr_b16 v[250:251], v69 offset:33792
    v_mfma_f32_16x16x32_bf16 v[104:107], v[228:231], v[208:211], v[104:107]
    ds_read_b64_tr_b16 v[224:225], v69 offset:33312
    v_mfma_f32_16x16x32_bf16 v[108:111], v[228:231], v[212:215], v[108:111]
    ds_read_b64_tr_b16 v[226:227], v69 offset:33824
    s_waitcnt lgkmcnt(8)
    v_mfma_f32_16x16x32_bf16 v[144:147], v[232:235], v[208:211], v[144:147]
    ds_read_b64_tr_b16 v[228:229], v68 offset:33280
    v_mfma_f32_16x16x32_bf16 v[148:151], v[232:235], v[212:215], v[148:151]
    ds_read_b64_tr_b16 v[230:231], v68 offset:33792
    v_mfma_f32_16x16x32_bf16 v[152:155], v[236:239], v[208:211], v[152:155]
    ds_read_b64_tr_b16 v[232:233], v68 offset:33312
    v_mfma_f32_16x16x32_bf16 v[156:159], v[236:239], v[212:215], v[156:159]
    ds_read_b64_tr_b16 v[234:235], v68 offset:33824
    s_waitcnt lgkmcnt(8)
    v_mfma_f32_16x16x32_bf16 v[160:163], v[240:243], v[208:211], v[160:163]
    ds_read_b64_tr_b16 v[236:237], v68 offset:24960
    v_mfma_f32_16x16x32_bf16 v[164:167], v[240:243], v[212:215], v[164:167]
    ds_read_b64_tr_b16 v[238:239], v68 offset:25472
    v_mfma_f32_16x16x32_bf16 v[168:171], v[244:247], v[208:211], v[168:171]
    ds_read_b64_tr_b16 v[240:241], v68 offset:24992
    v_mfma_f32_16x16x32_bf16 v[172:175], v[244:247], v[212:215], v[172:175]
    ds_read_b64_tr_b16 v[242:243], v68 offset:25504
    s_waitcnt lgkmcnt(8)
    s_waitcnt vmcnt(9)
    v_mfma_f32_16x16x32_bf16 v[128:131], v[248:251], v[216:219], v[128:131]
    ds_read_b64_tr_b16 v[244:245], v69 offset:24960
    v_mfma_f32_16x16x32_bf16 v[132:135], v[248:251], v[220:223], v[132:135]
    ds_read_b64_tr_b16 v[246:247], v69 offset:25472
    buffer_load_dwordx4 v[208:211], v2, s[32:35], s16 offen offset:3072 sc1
    v_mfma_f32_16x16x32_bf16 v[136:139], v[224:227], v[216:219], v[136:139]
    ds_read_b64_tr_b16 v[248:249], v69 offset:24992
    v_mfma_f32_16x16x32_bf16 v[140:143], v[224:227], v[220:223], v[140:143]
    ds_read_b64_tr_b16 v[250:251], v69 offset:25504
    s_waitcnt lgkmcnt(8)
    v_mfma_f32_16x16x32_bf16 v[112:115], v[228:231], v[216:219], v[112:115]
    ds_read_b64_tr_b16 v[224:225], v68 offset:41600
    v_mfma_f32_16x16x32_bf16 v[116:119], v[228:231], v[220:223], v[116:119]
    ds_read_b64_tr_b16 v[226:227], v68 offset:42112
    v_mfma_f32_16x16x32_bf16 v[120:123], v[232:235], v[216:219], v[120:123]
    ds_read_b64_tr_b16 v[228:229], v68 offset:41632
    v_mfma_f32_16x16x32_bf16 v[124:127], v[232:235], v[220:223], v[124:127]
    ds_read_b64_tr_b16 v[230:231], v68 offset:42144
    s_add_u32 s96, s85, 12
    s_and_b32 s97, s96, 15
    s_lshl_b32 s98, s97, 14
    s_add_u32 s16, s98, s15
    buffer_load_dwordx4 v[212:215], v2, s[32:35], s16 offen sc1
    s_waitcnt lgkmcnt(8)
    v_mfma_f32_16x16x32_bf16 v[80:83], v[236:239], v[216:219], v[80:83]
    ds_read_b64_tr_b16 v[232:233], v69 offset:41600
    v_mfma_f32_16x16x32_bf16 v[84:87], v[236:239], v[220:223], v[84:87]
    ds_read_b64_tr_b16 v[234:235], v69 offset:42112
    v_mfma_f32_16x16x32_bf16 v[88:91], v[240:243], v[216:219], v[88:91]
    ds_read_b64_tr_b16 v[236:237], v69 offset:41632
    v_mfma_f32_16x16x32_bf16 v[92:95], v[240:243], v[220:223], v[92:95]
    ds_read_b64_tr_b16 v[238:239], v69 offset:42144
    s_waitcnt lgkmcnt(8)
    v_mfma_f32_16x16x32_bf16 v[96:99], v[244:247], v[216:219], v[96:99]
    ds_read_b64_tr_b16 v[240:241], v69 offset:37440
    v_mfma_f32_16x16x32_bf16 v[100:103], v[244:247], v[220:223], v[100:103]
    ds_read_b64_tr_b16 v[242:243], v69 offset:37952
    v_mfma_f32_16x16x32_bf16 v[104:107], v[248:251], v[216:219], v[104:107]
    ds_read_b64_tr_b16 v[244:245], v69 offset:37472
    v_mfma_f32_16x16x32_bf16 v[108:111], v[248:251], v[220:223], v[108:111]
    ds_read_b64_tr_b16 v[246:247], v69 offset:37984
    s_waitcnt lgkmcnt(8)
    v_mfma_f32_16x16x32_bf16 v[144:147], v[224:227], v[216:219], v[144:147]
    ds_read_b64_tr_b16 v[248:249], v68 offset:37440
    v_mfma_f32_16x16x32_bf16 v[148:151], v[224:227], v[220:223], v[148:151]
    ds_read_b64_tr_b16 v[250:251], v68 offset:37952
    v_mfma_f32_16x16x32_bf16 v[152:155], v[228:231], v[216:219], v[152:155]
    ds_read_b64_tr_b16 v[224:225], v68 offset:37472
    v_mfma_f32_16x16x32_bf16 v[156:159], v[228:231], v[220:223], v[156:159]
    ds_read_b64_tr_b16 v[226:227], v68 offset:37984
    s_waitcnt lgkmcnt(8)
    v_mfma_f32_16x16x32_bf16 v[160:163], v[232:235], v[216:219], v[160:163]
    ds_read_b64_tr_b16 v[228:229], v68 offset:29120
    v_mfma_f32_16x16x32_bf16 v[164:167], v[232:235], v[220:223], v[164:167]
    ds_read_b64_tr_b16 v[230:231], v68 offset:29632
    v_mfma_f32_16x16x32_bf16 v[168:171], v[236:239], v[216:219], v[168:171]
    ds_read_b64_tr_b16 v[232:233], v68 offset:29152
    v_mfma_f32_16x16x32_bf16 v[172:175], v[236:239], v[220:223], v[172:175]
    ds_read_b64_tr_b16 v[234:235], v68 offset:29664
    s_waitcnt lgkmcnt(8)
    s_waitcnt vmcnt(9)
    v_mfma_f32_16x16x32_bf16 v[128:131], v[240:243], v[36:39], v[128:131]
    ds_read_b64_tr_b16 v[236:237], v69 offset:29120
    v_mfma_f32_16x16x32_bf16 v[132:135], v[240:243], v[176:179], v[132:135]
    ds_read_b64_tr_b16 v[238:239], v69 offset:29632
    buffer_load_dwordx4 v[216:219], v2, s[32:35], s16 offen offset:1024 sc1
    v_mfma_f32_16x16x32_bf16 v[136:139], v[244:247], v[36:39], v[136:139]
    ds_read_b64_tr_b16 v[240:241], v69 offset:29152
    v_mfma_f32_16x16x32_bf16 v[140:143], v[244:247], v[176:179], v[140:143]
    ds_read_b64_tr_b16 v[242:243], v69 offset:29664
    s_waitcnt lgkmcnt(8)
    v_mfma_f32_16x16x32_bf16 v[112:115], v[248:251], v[36:39], v[112:115]
    ds_read_b64_tr_b16 v[244:245], v68 offset:45760
    v_mfma_f32_16x16x32_bf16 v[116:119], v[248:251], v[176:179], v[116:119]
    ds_read_b64_tr_b16 v[246:247], v68 offset:46272
    v_mfma_f32_16x16x32_bf16 v[120:123], v[224:227], v[36:39], v[120:123]
    ds_read_b64_tr_b16 v[248:249], v68 offset:45792
    v_mfma_f32_16x16x32_bf16 v[124:127], v[224:227], v[176:179], v[124:127]
    ds_read_b64_tr_b16 v[250:251], v68 offset:46304
    buffer_load_dwordx4 v[220:223], v2, s[32:35], s16 offen offset:2048 sc1
    s_waitcnt lgkmcnt(8)
    v_mfma_f32_16x16x32_bf16 v[80:83], v[228:231], v[36:39], v[80:83]
    ds_read_b64_tr_b16 v[224:225], v69 offset:45760
    v_mfma_f32_16x16x32_bf16 v[84:87], v[228:231], v[176:179], v[84:87]
    ds_read_b64_tr_b16 v[226:227], v69 offset:46272
    v_mfma_f32_16x16x32_bf16 v[88:91], v[232:235], v[36:39], v[88:91]
    ds_read_b64_tr_b16 v[228:229], v69 offset:45792
    v_mfma_f32_16x16x32_bf16 v[92:95], v[232:235], v[176:179], v[92:95]
    ds_read_b64_tr_b16 v[230:231], v69 offset:46304
    s_waitcnt lgkmcnt(8)
    v_mfma_f32_16x16x32_bf16 v[96:99], v[236:239], v[36:39], v[96:99]
    s_barrier
    ds_read_b64_tr_b16 v[232:233], v71 offset:8320
    v_mfma_f32_16x16x32_bf16 v[100:103], v[236:239], v[176:179], v[100:103]
    ds_read_b64_tr_b16 v[234:235], v71 offset:8832
    v_mfma_f32_16x16x32_bf16 v[104:107], v[240:243], v[36:39], v[104:107]
    ds_read_b64_tr_b16 v[236:237], v71 offset:8352
    v_mfma_f32_16x16x32_bf16 v[108:111], v[240:243], v[176:179], v[108:111]
    ds_read_b64_tr_b16 v[238:239], v71 offset:8864
    s_waitcnt lgkmcnt(8)
    v_mfma_f32_16x16x32_bf16 v[144:147], v[244:247], v[36:39], v[144:147]
    ds_read_b64_tr_b16 v[240:241], v70 offset:8320
    v_mfma_f32_16x16x32_bf16 v[148:151], v[244:247], v[176:179], v[148:151]
    ds_read_b64_tr_b16 v[242:243], v70 offset:8832
    v_mfma_f32_16x16x32_bf16 v[152:155], v[248:251], v[36:39], v[152:155]
    ds_read_b64_tr_b16 v[244:245], v70 offset:8352
    v_mfma_f32_16x16x32_bf16 v[156:159], v[248:251], v[176:179], v[156:159]
    ds_read_b64_tr_b16 v[246:247], v70 offset:8864
    s_waitcnt lgkmcnt(8)
    v_mfma_f32_16x16x32_bf16 v[160:163], v[224:227], v[36:39], v[160:163]
    ds_read_b64_tr_b16 v[248:249], v70
    v_mfma_f32_16x16x32_bf16 v[164:167], v[224:227], v[176:179], v[164:167]
    ds_read_b64_tr_b16 v[250:251], v70 offset:512
    v_mfma_f32_16x16x32_bf16 v[168:171], v[228:231], v[36:39], v[168:171]
    ds_read_b64_tr_b16 v[224:225], v70 offset:32
    v_mfma_f32_16x16x32_bf16 v[172:175], v[228:231], v[176:179], v[172:175]
    ds_read_b64_tr_b16 v[226:227], v70 offset:544
    s_waitcnt lgkmcnt(8)
    s_waitcnt vmcnt(9)
    v_mfma_f32_16x16x32_bf16 v[128:131], v[232:235], v[180:183], v[128:131]
    ds_read_b64_tr_b16 v[228:229], v71
    v_mfma_f32_16x16x32_bf16 v[132:135], v[232:235], v[184:187], v[132:135]
    ds_read_b64_tr_b16 v[230:231], v71 offset:512
    buffer_load_dwordx4 v[36:39], v2, s[32:35], s16 offen offset:3072 sc1
    v_mfma_f32_16x16x32_bf16 v[136:139], v[236:239], v[180:183], v[136:139]
    ds_read_b64_tr_b16 v[232:233], v71 offset:32
    v_mfma_f32_16x16x32_bf16 v[140:143], v[236:239], v[184:187], v[140:143]
    ds_read_b64_tr_b16 v[234:235], v71 offset:544
    s_waitcnt lgkmcnt(8)
    v_mfma_f32_16x16x32_bf16 v[112:115], v[240:243], v[180:183], v[112:115]
    ds_read_b64_tr_b16 v[236:237], v70 offset:16640
    v_mfma_f32_16x16x32_bf16 v[116:119], v[240:243], v[184:187], v[116:119]
    ds_read_b64_tr_b16 v[238:239], v70 offset:17152
    v_mfma_f32_16x16x32_bf16 v[120:123], v[244:247], v[180:183], v[120:123]
    ds_read_b64_tr_b16 v[240:241], v70 offset:16672
    v_mfma_f32_16x16x32_bf16 v[124:127], v[244:247], v[184:187], v[124:127]
    ds_read_b64_tr_b16 v[242:243], v70 offset:17184
    s_add_u32 s96, s85, 13
    s_and_b32 s97, s96, 15
    s_lshl_b32 s98, s97, 14
    s_add_u32 s16, s98, s15
    buffer_load_dwordx4 v[176:179], v2, s[32:35], s16 offen sc1
    s_waitcnt lgkmcnt(8)
    v_mfma_f32_16x16x32_bf16 v[80:83], v[248:251], v[180:183], v[80:83]
    ds_read_b64_tr_b16 v[244:245], v71 offset:16640
    v_mfma_f32_16x16x32_bf16 v[84:87], v[248:251], v[184:187], v[84:87]
    ds_read_b64_tr_b16 v[246:247], v71 offset:17152
    v_mfma_f32_16x16x32_bf16 v[88:91], v[224:227], v[180:183], v[88:91]
    ds_read_b64_tr_b16 v[248:249], v71 offset:16672
    v_mfma_f32_16x16x32_bf16 v[92:95], v[224:227], v[184:187], v[92:95]
    ds_read_b64_tr_b16 v[250:251], v71 offset:17184
    s_waitcnt lgkmcnt(8)
    v_mfma_f32_16x16x32_bf16 v[96:99], v[228:231], v[180:183], v[96:99]
    ds_read_b64_tr_b16 v[224:225], v71 offset:12480
    v_mfma_f32_16x16x32_bf16 v[100:103], v[228:231], v[184:187], v[100:103]
    ds_read_b64_tr_b16 v[226:227], v71 offset:12992
    v_mfma_f32_16x16x32_bf16 v[104:107], v[232:235], v[180:183], v[104:107]
    ds_read_b64_tr_b16 v[228:229], v71 offset:12512
    v_mfma_f32_16x16x32_bf16 v[108:111], v[232:235], v[184:187], v[108:111]
    ds_read_b64_tr_b16 v[230:231], v71 offset:13024
    s_waitcnt lgkmcnt(8)
    v_mfma_f32_16x16x32_bf16 v[144:147], v[236:239], v[180:183], v[144:147]
    ds_read_b64_tr_b16 v[232:233], v70 offset:12480
    v_mfma_f32_16x16x32_bf16 v[148:151], v[236:239], v[184:187], v[148:151]
    ds_read_b64_tr_b16 v[234:235], v70 offset:12992
    v_mfma_f32_16x16x32_bf16 v[152:155], v[240:243], v[180:183], v[152:155]
    ds_read_b64_tr_b16 v[236:237], v70 offset:12512
    v_mfma_f32_16x16x32_bf16 v[156:159], v[240:243], v[184:187], v[156:159]
    ds_read_b64_tr_b16 v[238:239], v70 offset:13024
    s_waitcnt lgkmcnt(8)
    v_mfma_f32_16x16x32_bf16 v[160:163], v[244:247], v[180:183], v[160:163]
    ds_read_b64_tr_b16 v[240:241], v70 offset:4160
    v_mfma_f32_16x16x32_bf16 v[164:167], v[244:247], v[184:187], v[164:167]
    ds_read_b64_tr_b16 v[242:243], v70 offset:4672
    v_mfma_f32_16x16x32_bf16 v[168:171], v[248:251], v[180:183], v[168:171]
    ds_read_b64_tr_b16 v[244:245], v70 offset:4192
    v_mfma_f32_16x16x32_bf16 v[172:175], v[248:251], v[184:187], v[172:175]
    ds_read_b64_tr_b16 v[246:247], v70 offset:4704
    s_waitcnt lgkmcnt(8)
    s_waitcnt vmcnt(9)
    v_mfma_f32_16x16x32_bf16 v[128:131], v[224:227], v[188:191], v[128:131]
    ds_read_b64_tr_b16 v[248:249], v71 offset:4160
    v_mfma_f32_16x16x32_bf16 v[132:135], v[224:227], v[192:195], v[132:135]
    ds_read_b64_tr_b16 v[250:251], v71 offset:4672
    buffer_load_dwordx4 v[180:183], v2, s[32:35], s16 offen offset:1024 sc1
    v_mfma_f32_16x16x32_bf16 v[136:139], v[228:231], v[188:191], v[136:139]
    ds_read_b64_tr_b16 v[224:225], v71 offset:4192
    v_mfma_f32_16x16x32_bf16 v[140:143], v[228:231], v[192:195], v[140:143]
    ds_read_b64_tr_b16 v[226:227], v71 offset:4704
    s_waitcnt lgkmcnt(8)
    v_mfma_f32_16x16x32_bf16 v[112:115], v[232:235], v[188:191], v[112:115]
    ds_read_b64_tr_b16 v[228:229], v70 offset:20800
    v_mfma_f32_16x16x32_bf16 v[116:119], v[232:235], v[192:195], v[116:119]
    ds_read_b64_tr_b16 v[230:231], v70 offset:21312
    v_mfma_f32_16x16x32_bf16 v[120:123], v[236:239], v[188:191], v[120:123]
    ds_read_b64_tr_b16 v[232:233], v70 offset:20832
    v_mfma_f32_16x16x32_bf16 v[124:127], v[236:239], v[192:195], v[124:127]
    ds_read_b64_tr_b16 v[234:235], v70 offset:21344
    buffer_load_dwordx4 v[184:187], v2, s[32:35], s16 offen offset:2048 sc1
    s_waitcnt lgkmcnt(8)
    v_mfma_f32_16x16x32_bf16 v[80:83], v[240:243], v[188:191], v[80:83]
    ds_read_b64_tr_b16 v[236:237], v71 offset:20800
    v_mfma_f32_16x16x32_bf16 v[84:87], v[240:243], v[192:195], v[84:87]
    ds_read_b64_tr_b16 v[238:239], v71 offset:21312
    v_mfma_f32_16x16x32_bf16 v[88:91], v[244:247], v[188:191], v[88:91]
    ds_read_b64_tr_b16 v[240:241], v71 offset:20832
    v_mfma_f32_16x16x32_bf16 v[92:95], v[244:247], v[192:195], v[92:95]
    ds_read_b64_tr_b16 v[242:243], v71 offset:21344
    s_waitcnt lgkmcnt(8)
    v_mfma_f32_16x16x32_bf16 v[96:99], v[248:251], v[188:191], v[96:99]
    s_barrier
    ds_read_b64_tr_b16 v[244:245], v71 offset:33280
    v_mfma_f32_16x16x32_bf16 v[100:103], v[248:251], v[192:195], v[100:103]
    ds_read_b64_tr_b16 v[246:247], v71 offset:33792
    v_mfma_f32_16x16x32_bf16 v[104:107], v[224:227], v[188:191], v[104:107]
    ds_read_b64_tr_b16 v[248:249], v71 offset:33312
    v_mfma_f32_16x16x32_bf16 v[108:111], v[224:227], v[192:195], v[108:111]
    ds_read_b64_tr_b16 v[250:251], v71 offset:33824
    s_waitcnt lgkmcnt(8)
    v_mfma_f32_16x16x32_bf16 v[144:147], v[228:231], v[188:191], v[144:147]
    ds_read_b64_tr_b16 v[224:225], v70 offset:33280
    v_mfma_f32_16x16x32_bf16 v[148:151], v[228:231], v[192:195], v[148:151]
    ds_read_b64_tr_b16 v[226:227], v70 offset:33792
    v_mfma_f32_16x16x32_bf16 v[152:155], v[232:235], v[188:191], v[152:155]
    ds_read_b64_tr_b16 v[228:229], v70 offset:33312
    v_mfma_f32_16x16x32_bf16 v[156:159], v[232:235], v[192:195], v[156:159]
    ds_read_b64_tr_b16 v[230:231], v70 offset:33824
    s_waitcnt lgkmcnt(8)
    v_mfma_f32_16x16x32_bf16 v[160:163], v[236:239], v[188:191], v[160:163]
    ds_read_b64_tr_b16 v[232:233], v70 offset:24960
    v_mfma_f32_16x16x32_bf16 v[164:167], v[236:239], v[192:195], v[164:167]
    ds_read_b64_tr_b16 v[234:235], v70 offset:25472
    v_mfma_f32_16x16x32_bf16 v[168:171], v[240:243], v[188:191], v[168:171]
    ds_read_b64_tr_b16 v[236:237], v70 offset:24992
    v_mfma_f32_16x16x32_bf16 v[172:175], v[240:243], v[192:195], v[172:175]
    ds_read_b64_tr_b16 v[238:239], v70 offset:25504
    s_waitcnt lgkmcnt(8)
    s_waitcnt vmcnt(9)
    v_mfma_f32_16x16x32_bf16 v[128:131], v[244:247], v[196:199], v[128:131]
    ds_read_b64_tr_b16 v[240:241], v71 offset:24960
    v_mfma_f32_16x16x32_bf16 v[132:135], v[244:247], v[200:203], v[132:135]
    ds_read_b64_tr_b16 v[242:243], v71 offset:25472
    buffer_load_dwordx4 v[188:191], v2, s[32:35], s16 offen offset:3072 sc1
    v_mfma_f32_16x16x32_bf16 v[136:139], v[248:251], v[196:199], v[136:139]
    ds_read_b64_tr_b16 v[244:245], v71 offset:24992
    v_mfma_f32_16x16x32_bf16 v[140:143], v[248:251], v[200:203], v[140:143]
    ds_read_b64_tr_b16 v[246:247], v71 offset:25504
    s_waitcnt lgkmcnt(8)
    v_mfma_f32_16x16x32_bf16 v[112:115], v[224:227], v[196:199], v[112:115]
    ds_read_b64_tr_b16 v[248:249], v70 offset:41600
    v_mfma_f32_16x16x32_bf16 v[116:119], v[224:227], v[200:203], v[116:119]
    ds_read_b64_tr_b16 v[250:251], v70 offset:42112
    v_mfma_f32_16x16x32_bf16 v[120:123], v[228:231], v[196:199], v[120:123]
    ds_read_b64_tr_b16 v[224:225], v70 offset:41632
    v_mfma_f32_16x16x32_bf16 v[124:127], v[228:231], v[200:203], v[124:127]
    ds_read_b64_tr_b16 v[226:227], v70 offset:42144
    s_add_u32 s96, s85, 14
    s_and_b32 s97, s96, 15
    s_lshl_b32 s98, s97, 14
    s_add_u32 s16, s98, s15
    buffer_load_dwordx4 v[192:195], v2, s[32:35], s16 offen sc1
    s_waitcnt lgkmcnt(8)
    v_mfma_f32_16x16x32_bf16 v[80:83], v[232:235], v[196:199], v[80:83]
    ds_read_b64_tr_b16 v[228:229], v71 offset:41600
    v_mfma_f32_16x16x32_bf16 v[84:87], v[232:235], v[200:203], v[84:87]
    ds_read_b64_tr_b16 v[230:231], v71 offset:42112
    v_mfma_f32_16x16x32_bf16 v[88:91], v[236:239], v[196:199], v[88:91]
    ds_read_b64_tr_b16 v[232:233], v71 offset:41632
    v_mfma_f32_16x16x32_bf16 v[92:95], v[236:239], v[200:203], v[92:95]
    ds_read_b64_tr_b16 v[234:235], v71 offset:42144
    s_waitcnt lgkmcnt(8)
    v_mfma_f32_16x16x32_bf16 v[96:99], v[240:243], v[196:199], v[96:99]
    ds_read_b64_tr_b16 v[236:237], v71 offset:37440
    v_mfma_f32_16x16x32_bf16 v[100:103], v[240:243], v[200:203], v[100:103]
    ds_read_b64_tr_b16 v[238:239], v71 offset:37952
    v_mfma_f32_16x16x32_bf16 v[104:107], v[244:247], v[196:199], v[104:107]
    ds_read_b64_tr_b16 v[240:241], v71 offset:37472
    v_mfma_f32_16x16x32_bf16 v[108:111], v[244:247], v[200:203], v[108:111]
    ds_read_b64_tr_b16 v[242:243], v71 offset:37984
    s_waitcnt lgkmcnt(8)
    v_mfma_f32_16x16x32_bf16 v[144:147], v[248:251], v[196:199], v[144:147]
    ds_read_b64_tr_b16 v[244:245], v70 offset:37440
    v_mfma_f32_16x16x32_bf16 v[148:151], v[248:251], v[200:203], v[148:151]
    ds_read_b64_tr_b16 v[246:247], v70 offset:37952
    v_mfma_f32_16x16x32_bf16 v[152:155], v[224:227], v[196:199], v[152:155]
    ds_read_b64_tr_b16 v[248:249], v70 offset:37472
    v_mfma_f32_16x16x32_bf16 v[156:159], v[224:227], v[200:203], v[156:159]
    ds_read_b64_tr_b16 v[250:251], v70 offset:37984
    s_waitcnt lgkmcnt(8)
    v_mfma_f32_16x16x32_bf16 v[160:163], v[228:231], v[196:199], v[160:163]
    ds_read_b64_tr_b16 v[224:225], v70 offset:29120
    v_mfma_f32_16x16x32_bf16 v[164:167], v[228:231], v[200:203], v[164:167]
    ds_read_b64_tr_b16 v[226:227], v70 offset:29632
    v_mfma_f32_16x16x32_bf16 v[168:171], v[232:235], v[196:199], v[168:171]
    ds_read_b64_tr_b16 v[228:229], v70 offset:29152
    v_mfma_f32_16x16x32_bf16 v[172:175], v[232:235], v[200:203], v[172:175]
    ds_read_b64_tr_b16 v[230:231], v70 offset:29664
    s_waitcnt lgkmcnt(8)
    s_waitcnt vmcnt(9)
    v_mfma_f32_16x16x32_bf16 v[128:131], v[236:239], v[204:207], v[128:131]
    ds_read_b64_tr_b16 v[232:233], v71 offset:29120
    v_mfma_f32_16x16x32_bf16 v[132:135], v[236:239], v[208:211], v[132:135]
    ds_read_b64_tr_b16 v[234:235], v71 offset:29632
    buffer_load_dwordx4 v[196:199], v2, s[32:35], s16 offen offset:1024 sc1
    v_mfma_f32_16x16x32_bf16 v[136:139], v[240:243], v[204:207], v[136:139]
    ds_read_b64_tr_b16 v[236:237], v71 offset:29152
    v_mfma_f32_16x16x32_bf16 v[140:143], v[240:243], v[208:211], v[140:143]
    ds_read_b64_tr_b16 v[238:239], v71 offset:29664
    s_waitcnt lgkmcnt(8)
    v_mfma_f32_16x16x32_bf16 v[112:115], v[244:247], v[204:207], v[112:115]
    ds_read_b64_tr_b16 v[240:241], v70 offset:45760
    v_mfma_f32_16x16x32_bf16 v[116:119], v[244:247], v[208:211], v[116:119]
    ds_read_b64_tr_b16 v[242:243], v70 offset:46272
    v_mfma_f32_16x16x32_bf16 v[120:123], v[248:251], v[204:207], v[120:123]
    ds_read_b64_tr_b16 v[244:245], v70 offset:45792
    v_mfma_f32_16x16x32_bf16 v[124:127], v[248:251], v[208:211], v[124:127]
    ds_read_b64_tr_b16 v[246:247], v70 offset:46304
    buffer_load_dwordx4 v[200:203], v2, s[32:35], s16 offen offset:2048 sc1
    s_waitcnt lgkmcnt(8)
    v_mfma_f32_16x16x32_bf16 v[80:83], v[224:227], v[204:207], v[80:83]
    ds_read_b64_tr_b16 v[248:249], v71 offset:45760
    v_mfma_f32_16x16x32_bf16 v[84:87], v[224:227], v[208:211], v[84:87]
    ds_read_b64_tr_b16 v[250:251], v71 offset:46272
    v_mfma_f32_16x16x32_bf16 v[88:91], v[228:231], v[204:207], v[88:91]
    ds_read_b64_tr_b16 v[224:225], v71 offset:45792
    v_mfma_f32_16x16x32_bf16 v[92:95], v[228:231], v[208:211], v[92:95]
    ds_read_b64_tr_b16 v[226:227], v71 offset:46304
    s_waitcnt lgkmcnt(8)
    v_mfma_f32_16x16x32_bf16 v[96:99], v[232:235], v[204:207], v[96:99]
    s_barrier
    ds_read_b64_tr_b16 v[228:229], v67 offset:8320
    v_mfma_f32_16x16x32_bf16 v[100:103], v[232:235], v[208:211], v[100:103]
    ds_read_b64_tr_b16 v[230:231], v67 offset:8832
    v_mfma_f32_16x16x32_bf16 v[104:107], v[236:239], v[204:207], v[104:107]
    ds_read_b64_tr_b16 v[232:233], v67 offset:8352
    v_mfma_f32_16x16x32_bf16 v[108:111], v[236:239], v[208:211], v[108:111]
    ds_read_b64_tr_b16 v[234:235], v67 offset:8864
    s_waitcnt lgkmcnt(8)
    v_mfma_f32_16x16x32_bf16 v[144:147], v[240:243], v[204:207], v[144:147]
    ds_read_b64_tr_b16 v[236:237], v66 offset:8320
    v_mfma_f32_16x16x32_bf16 v[148:151], v[240:243], v[208:211], v[148:151]
    ds_read_b64_tr_b16 v[238:239], v66 offset:8832
    v_mfma_f32_16x16x32_bf16 v[152:155], v[244:247], v[204:207], v[152:155]
    ds_read_b64_tr_b16 v[240:241], v66 offset:8352
    v_mfma_f32_16x16x32_bf16 v[156:159], v[244:247], v[208:211], v[156:159]
    ds_read_b64_tr_b16 v[242:243], v66 offset:8864
    s_waitcnt lgkmcnt(8)
    v_mfma_f32_16x16x32_bf16 v[160:163], v[248:251], v[204:207], v[160:163]
    ds_read_b64_tr_b16 v[244:245], v66
    v_mfma_f32_16x16x32_bf16 v[164:167], v[248:251], v[208:211], v[164:167]
    ds_read_b64_tr_b16 v[246:247], v66 offset:512
    v_mfma_f32_16x16x32_bf16 v[168:171], v[224:227], v[204:207], v[168:171]
    ds_read_b64_tr_b16 v[248:249], v66 offset:32
    v_mfma_f32_16x16x32_bf16 v[172:175], v[224:227], v[208:211], v[172:175]
    ds_read_b64_tr_b16 v[250:251], v66 offset:544
    s_waitcnt lgkmcnt(8)
    s_waitcnt vmcnt(9)
    v_mfma_f32_16x16x32_bf16 v[128:131], v[228:231], v[212:215], v[128:131]
    ds_read_b64_tr_b16 v[224:225], v67
    v_mfma_f32_16x16x32_bf16 v[132:135], v[228:231], v[216:219], v[132:135]
    ds_read_b64_tr_b16 v[226:227], v67 offset:512
    buffer_load_dwordx4 v[204:207], v2, s[32:35], s16 offen offset:3072 sc1
    v_mfma_f32_16x16x32_bf16 v[136:139], v[232:235], v[212:215], v[136:139]
    ds_read_b64_tr_b16 v[228:229], v67 offset:32
    v_mfma_f32_16x16x32_bf16 v[140:143], v[232:235], v[216:219], v[140:143]
    ds_read_b64_tr_b16 v[230:231], v67 offset:544
    s_waitcnt lgkmcnt(8)
    v_mfma_f32_16x16x32_bf16 v[112:115], v[236:239], v[212:215], v[112:115]
    ds_read_b64_tr_b16 v[232:233], v66 offset:16640
    v_mfma_f32_16x16x32_bf16 v[116:119], v[236:239], v[216:219], v[116:119]
    ds_read_b64_tr_b16 v[234:235], v66 offset:17152
    v_mfma_f32_16x16x32_bf16 v[120:123], v[240:243], v[212:215], v[120:123]
    ds_read_b64_tr_b16 v[236:237], v66 offset:16672
    v_mfma_f32_16x16x32_bf16 v[124:127], v[240:243], v[216:219], v[124:127]
    ds_read_b64_tr_b16 v[238:239], v66 offset:17184
    s_add_u32 s96, s85, 15
    s_and_b32 s97, s96, 15
    s_lshl_b32 s98, s97, 14
    s_add_u32 s16, s98, s15
    buffer_load_dwordx4 v[208:211], v2, s[32:35], s16 offen sc1
    s_waitcnt lgkmcnt(8)
    v_mfma_f32_16x16x32_bf16 v[80:83], v[244:247], v[212:215], v[80:83]
    ds_read_b64_tr_b16 v[240:241], v67 offset:16640
    v_mfma_f32_16x16x32_bf16 v[84:87], v[244:247], v[216:219], v[84:87]
    ds_read_b64_tr_b16 v[242:243], v67 offset:17152
    v_mfma_f32_16x16x32_bf16 v[88:91], v[248:251], v[212:215], v[88:91]
    ds_read_b64_tr_b16 v[244:245], v67 offset:16672
    v_mfma_f32_16x16x32_bf16 v[92:95], v[248:251], v[216:219], v[92:95]
    ds_read_b64_tr_b16 v[246:247], v67 offset:17184
    s_waitcnt lgkmcnt(8)
    v_mfma_f32_16x16x32_bf16 v[96:99], v[224:227], v[212:215], v[96:99]
    ds_read_b64_tr_b16 v[248:249], v67 offset:12480
    v_mfma_f32_16x16x32_bf16 v[100:103], v[224:227], v[216:219], v[100:103]
    ds_read_b64_tr_b16 v[250:251], v67 offset:12992
    v_mfma_f32_16x16x32_bf16 v[104:107], v[228:231], v[212:215], v[104:107]
    ds_read_b64_tr_b16 v[224:225], v67 offset:12512
    v_mfma_f32_16x16x32_bf16 v[108:111], v[228:231], v[216:219], v[108:111]
    ds_read_b64_tr_b16 v[226:227], v67 offset:13024
    s_waitcnt lgkmcnt(8)
    v_mfma_f32_16x16x32_bf16 v[144:147], v[232:235], v[212:215], v[144:147]
    ds_read_b64_tr_b16 v[228:229], v66 offset:12480
    v_mfma_f32_16x16x32_bf16 v[148:151], v[232:235], v[216:219], v[148:151]
    ds_read_b64_tr_b16 v[230:231], v66 offset:12992
    v_mfma_f32_16x16x32_bf16 v[152:155], v[236:239], v[212:215], v[152:155]
    ds_read_b64_tr_b16 v[232:233], v66 offset:12512
    v_mfma_f32_16x16x32_bf16 v[156:159], v[236:239], v[216:219], v[156:159]
    ds_read_b64_tr_b16 v[234:235], v66 offset:13024
    s_waitcnt lgkmcnt(8)
    v_mfma_f32_16x16x32_bf16 v[160:163], v[240:243], v[212:215], v[160:163]
    ds_read_b64_tr_b16 v[236:237], v66 offset:4160
    v_mfma_f32_16x16x32_bf16 v[164:167], v[240:243], v[216:219], v[164:167]
    ds_read_b64_tr_b16 v[238:239], v66 offset:4672
    v_mfma_f32_16x16x32_bf16 v[168:171], v[244:247], v[212:215], v[168:171]
    ds_read_b64_tr_b16 v[240:241], v66 offset:4192
    v_mfma_f32_16x16x32_bf16 v[172:175], v[244:247], v[216:219], v[172:175]
    ds_read_b64_tr_b16 v[242:243], v66 offset:4704
    s_waitcnt lgkmcnt(8)
    s_waitcnt vmcnt(9)
    v_mfma_f32_16x16x32_bf16 v[128:131], v[248:251], v[220:223], v[128:131]
    ds_read_b64_tr_b16 v[244:245], v67 offset:4160
    v_mfma_f32_16x16x32_bf16 v[132:135], v[248:251], v[36:39], v[132:135]
    ds_read_b64_tr_b16 v[246:247], v67 offset:4672
    buffer_load_dwordx4 v[212:215], v2, s[32:35], s16 offen offset:1024 sc1
    v_mfma_f32_16x16x32_bf16 v[136:139], v[224:227], v[220:223], v[136:139]
    ds_read_b64_tr_b16 v[248:249], v67 offset:4192
    v_mfma_f32_16x16x32_bf16 v[140:143], v[224:227], v[36:39], v[140:143]
    ds_read_b64_tr_b16 v[250:251], v67 offset:4704
    s_waitcnt lgkmcnt(8)
    v_mfma_f32_16x16x32_bf16 v[112:115], v[228:231], v[220:223], v[112:115]
    ds_read_b64_tr_b16 v[224:225], v66 offset:20800
    v_mfma_f32_16x16x32_bf16 v[116:119], v[228:231], v[36:39], v[116:119]
    ds_read_b64_tr_b16 v[226:227], v66 offset:21312
    v_mfma_f32_16x16x32_bf16 v[120:123], v[232:235], v[220:223], v[120:123]
    ds_read_b64_tr_b16 v[228:229], v66 offset:20832
    v_mfma_f32_16x16x32_bf16 v[124:127], v[232:235], v[36:39], v[124:127]
    ds_read_b64_tr_b16 v[230:231], v66 offset:21344
    buffer_load_dwordx4 v[216:219], v2, s[32:35], s16 offen offset:2048 sc1
    s_waitcnt lgkmcnt(8)
    v_mfma_f32_16x16x32_bf16 v[80:83], v[236:239], v[220:223], v[80:83]
    ds_read_b64_tr_b16 v[232:233], v67 offset:20800
    v_mfma_f32_16x16x32_bf16 v[84:87], v[236:239], v[36:39], v[84:87]
    ds_read_b64_tr_b16 v[234:235], v67 offset:21312
    v_mfma_f32_16x16x32_bf16 v[88:91], v[240:243], v[220:223], v[88:91]
    ds_read_b64_tr_b16 v[236:237], v67 offset:20832
    v_mfma_f32_16x16x32_bf16 v[92:95], v[240:243], v[36:39], v[92:95]
    ds_read_b64_tr_b16 v[238:239], v67 offset:21344
    s_waitcnt lgkmcnt(8)
    v_mfma_f32_16x16x32_bf16 v[96:99], v[244:247], v[220:223], v[96:99]
    s_barrier
    ds_read_b64_tr_b16 v[240:241], v67 offset:33280
    v_mfma_f32_16x16x32_bf16 v[100:103], v[244:247], v[36:39], v[100:103]
    ds_read_b64_tr_b16 v[242:243], v67 offset:33792
    v_mfma_f32_16x16x32_bf16 v[104:107], v[248:251], v[220:223], v[104:107]
    ds_read_b64_tr_b16 v[244:245], v67 offset:33312
    v_mfma_f32_16x16x32_bf16 v[108:111], v[248:251], v[36:39], v[108:111]
    ds_read_b64_tr_b16 v[246:247], v67 offset:33824
    s_waitcnt lgkmcnt(8)
    v_mfma_f32_16x16x32_bf16 v[144:147], v[224:227], v[220:223], v[144:147]
    ds_read_b64_tr_b16 v[248:249], v66 offset:33280
    v_mfma_f32_16x16x32_bf16 v[148:151], v[224:227], v[36:39], v[148:151]
    ds_read_b64_tr_b16 v[250:251], v66 offset:33792
    v_mfma_f32_16x16x32_bf16 v[152:155], v[228:231], v[220:223], v[152:155]
    ds_read_b64_tr_b16 v[224:225], v66 offset:33312
    v_mfma_f32_16x16x32_bf16 v[156:159], v[228:231], v[36:39], v[156:159]
    ds_read_b64_tr_b16 v[226:227], v66 offset:33824
    s_waitcnt lgkmcnt(8)
    v_mfma_f32_16x16x32_bf16 v[160:163], v[232:235], v[220:223], v[160:163]
    ds_read_b64_tr_b16 v[228:229], v66 offset:24960
    v_mfma_f32_16x16x32_bf16 v[164:167], v[232:235], v[36:39], v[164:167]
    ds_read_b64_tr_b16 v[230:231], v66 offset:25472
    v_mfma_f32_16x16x32_bf16 v[168:171], v[236:239], v[220:223], v[168:171]
    ds_read_b64_tr_b16 v[232:233], v66 offset:24992
    v_mfma_f32_16x16x32_bf16 v[172:175], v[236:239], v[36:39], v[172:175]
    ds_read_b64_tr_b16 v[234:235], v66 offset:25504
    s_waitcnt lgkmcnt(8)
    s_waitcnt vmcnt(9)
    v_mfma_f32_16x16x32_bf16 v[128:131], v[240:243], v[176:179], v[128:131]
    ds_read_b64_tr_b16 v[236:237], v67 offset:24960
    v_mfma_f32_16x16x32_bf16 v[132:135], v[240:243], v[180:183], v[132:135]
    ds_read_b64_tr_b16 v[238:239], v67 offset:25472
    buffer_load_dwordx4 v[220:223], v2, s[32:35], s16 offen offset:3072 sc1
    s_barrier
    v_mfma_f32_16x16x32_bf16 v[136:139], v[244:247], v[176:179], v[136:139]
    ds_read_b64_tr_b16 v[240:241], v67 offset:24992
    v_mfma_f32_16x16x32_bf16 v[140:143], v[244:247], v[180:183], v[140:143]
    ds_read_b64_tr_b16 v[242:243], v67 offset:25504
    s_waitcnt lgkmcnt(8)
    v_mfma_f32_16x16x32_bf16 v[112:115], v[248:251], v[176:179], v[112:115]
    ds_read_b64_tr_b16 v[244:245], v66 offset:41600
    v_mfma_f32_16x16x32_bf16 v[116:119], v[248:251], v[180:183], v[116:119]
    ds_read_b64_tr_b16 v[246:247], v66 offset:42112
    v_mfma_f32_16x16x32_bf16 v[120:123], v[224:227], v[176:179], v[120:123]
    ds_read_b64_tr_b16 v[248:249], v66 offset:41632
    v_mfma_f32_16x16x32_bf16 v[124:127], v[224:227], v[180:183], v[124:127]
    ds_read_b64_tr_b16 v[250:251], v66 offset:42144
    s_waitcnt lgkmcnt(8)
    v_mfma_f32_16x16x32_bf16 v[80:83], v[228:231], v[176:179], v[80:83]
    ds_read_b64_tr_b16 v[224:225], v67 offset:41600
    v_mfma_f32_16x16x32_bf16 v[84:87], v[228:231], v[180:183], v[84:87]
    ds_read_b64_tr_b16 v[226:227], v67 offset:42112
    v_mfma_f32_16x16x32_bf16 v[88:91], v[232:235], v[176:179], v[88:91]
    ds_read_b64_tr_b16 v[228:229], v67 offset:41632
    v_mfma_f32_16x16x32_bf16 v[92:95], v[232:235], v[180:183], v[92:95]
    ds_read_b64_tr_b16 v[230:231], v67 offset:42144
    s_waitcnt lgkmcnt(8)
    v_mfma_f32_16x16x32_bf16 v[96:99], v[236:239], v[176:179], v[96:99]
    ds_read_b64_tr_b16 v[232:233], v67 offset:37440
    v_mfma_f32_16x16x32_bf16 v[100:103], v[236:239], v[180:183], v[100:103]
    ds_read_b64_tr_b16 v[234:235], v67 offset:37952
    v_mfma_f32_16x16x32_bf16 v[104:107], v[240:243], v[176:179], v[104:107]
    ds_read_b64_tr_b16 v[236:237], v67 offset:37472
    v_mfma_f32_16x16x32_bf16 v[108:111], v[240:243], v[180:183], v[108:111]
    ds_read_b64_tr_b16 v[238:239], v67 offset:37984
    s_waitcnt lgkmcnt(8)
    v_mfma_f32_16x16x32_bf16 v[144:147], v[244:247], v[176:179], v[144:147]
    ds_read_b64_tr_b16 v[240:241], v66 offset:37440
    v_mfma_f32_16x16x32_bf16 v[148:151], v[244:247], v[180:183], v[148:151]
    ds_read_b64_tr_b16 v[242:243], v66 offset:37952
    v_mfma_f32_16x16x32_bf16 v[152:155], v[248:251], v[176:179], v[152:155]
    ds_read_b64_tr_b16 v[244:245], v66 offset:37472
    v_mfma_f32_16x16x32_bf16 v[156:159], v[248:251], v[180:183], v[156:159]
    ds_read_b64_tr_b16 v[246:247], v66 offset:37984
    s_waitcnt lgkmcnt(8)
    v_mfma_f32_16x16x32_bf16 v[160:163], v[224:227], v[176:179], v[160:163]
    ds_read_b64_tr_b16 v[248:249], v66 offset:29120
    v_mfma_f32_16x16x32_bf16 v[164:167], v[224:227], v[180:183], v[164:167]
    ds_read_b64_tr_b16 v[250:251], v66 offset:29632
    v_mfma_f32_16x16x32_bf16 v[168:171], v[228:231], v[176:179], v[168:171]
    ds_read_b64_tr_b16 v[224:225], v66 offset:29152
    v_mfma_f32_16x16x32_bf16 v[172:175], v[228:231], v[180:183], v[172:175]
    ds_read_b64_tr_b16 v[226:227], v66 offset:29664
    s_waitcnt lgkmcnt(8)
    s_waitcnt vmcnt(8)
    v_mfma_f32_16x16x32_bf16 v[128:131], v[232:235], v[184:187], v[128:131]
    ds_read_b64_tr_b16 v[228:229], v67 offset:29120
    v_mfma_f32_16x16x32_bf16 v[132:135], v[232:235], v[188:191], v[132:135]
    ds_read_b64_tr_b16 v[230:231], v67 offset:29632
    v_mfma_f32_16x16x32_bf16 v[136:139], v[236:239], v[184:187], v[136:139]
    ds_read_b64_tr_b16 v[232:233], v67 offset:29152
    v_mfma_f32_16x16x32_bf16 v[140:143], v[236:239], v[188:191], v[140:143]
    ds_read_b64_tr_b16 v[234:235], v67 offset:29664
    s_waitcnt lgkmcnt(8)
    v_mfma_f32_16x16x32_bf16 v[112:115], v[240:243], v[184:187], v[112:115]
    ds_read_b64_tr_b16 v[236:237], v66 offset:45760
    v_mfma_f32_16x16x32_bf16 v[116:119], v[240:243], v[188:191], v[116:119]
    ds_read_b64_tr_b16 v[238:239], v66 offset:46272
    v_mfma_f32_16x16x32_bf16 v[120:123], v[244:247], v[184:187], v[120:123]
    ds_read_b64_tr_b16 v[240:241], v66 offset:45792
    v_mfma_f32_16x16x32_bf16 v[124:127], v[244:247], v[188:191], v[124:127]
    ds_read_b64_tr_b16 v[242:243], v66 offset:46304
    s_waitcnt lgkmcnt(8)
    v_mfma_f32_16x16x32_bf16 v[80:83], v[248:251], v[184:187], v[80:83]
    ds_read_b64_tr_b16 v[244:245], v67 offset:45760
    v_mfma_f32_16x16x32_bf16 v[84:87], v[248:251], v[188:191], v[84:87]
    ds_read_b64_tr_b16 v[246:247], v67 offset:46272
    v_mfma_f32_16x16x32_bf16 v[88:91], v[224:227], v[184:187], v[88:91]
    ds_read_b64_tr_b16 v[248:249], v67 offset:45792
    v_mfma_f32_16x16x32_bf16 v[92:95], v[224:227], v[188:191], v[92:95]
    ds_read_b64_tr_b16 v[250:251], v67 offset:46304
    s_waitcnt lgkmcnt(8)
    v_mfma_f32_16x16x32_bf16 v[96:99], v[228:231], v[184:187], v[96:99]
    s_barrier
    ds_read_b64_tr_b16 v[224:225], v69 offset:8320
    v_mfma_f32_16x16x32_bf16 v[100:103], v[228:231], v[188:191], v[100:103]
    ds_read_b64_tr_b16 v[226:227], v69 offset:8832
    v_mfma_f32_16x16x32_bf16 v[104:107], v[232:235], v[184:187], v[104:107]
    ds_read_b64_tr_b16 v[228:229], v69 offset:8352
    v_mfma_f32_16x16x32_bf16 v[108:111], v[232:235], v[188:191], v[108:111]
    ds_read_b64_tr_b16 v[230:231], v69 offset:8864
    s_waitcnt lgkmcnt(8)
    v_mfma_f32_16x16x32_bf16 v[144:147], v[236:239], v[184:187], v[144:147]
    ds_read_b64_tr_b16 v[232:233], v68 offset:8320
    v_mfma_f32_16x16x32_bf16 v[148:151], v[236:239], v[188:191], v[148:151]
    ds_read_b64_tr_b16 v[234:235], v68 offset:8832
    v_mfma_f32_16x16x32_bf16 v[152:155], v[240:243], v[184:187], v[152:155]
    ds_read_b64_tr_b16 v[236:237], v68 offset:8352
    v_mfma_f32_16x16x32_bf16 v[156:159], v[240:243], v[188:191], v[156:159]
    ds_read_b64_tr_b16 v[238:239], v68 offset:8864
    s_waitcnt lgkmcnt(8)
    v_mfma_f32_16x16x32_bf16 v[160:163], v[244:247], v[184:187], v[160:163]
    ds_read_b64_tr_b16 v[240:241], v68
    v_mfma_f32_16x16x32_bf16 v[164:167], v[244:247], v[188:191], v[164:167]
    ds_read_b64_tr_b16 v[242:243], v68 offset:512
    v_mfma_f32_16x16x32_bf16 v[168:171], v[248:251], v[184:187], v[168:171]
    ds_read_b64_tr_b16 v[244:245], v68 offset:32
    v_mfma_f32_16x16x32_bf16 v[172:175], v[248:251], v[188:191], v[172:175]
    ds_read_b64_tr_b16 v[246:247], v68 offset:544
    s_waitcnt lgkmcnt(8)
    s_waitcnt vmcnt(6)
    v_mfma_f32_16x16x32_bf16 v[128:131], v[224:227], v[192:195], v[128:131]
    ds_read_b64_tr_b16 v[248:249], v69
    v_mfma_f32_16x16x32_bf16 v[132:135], v[224:227], v[196:199], v[132:135]
    ds_read_b64_tr_b16 v[250:251], v69 offset:512
    v_mfma_f32_16x16x32_bf16 v[136:139], v[228:231], v[192:195], v[136:139]
    ds_read_b64_tr_b16 v[224:225], v69 offset:32
    v_mfma_f32_16x16x32_bf16 v[140:143], v[228:231], v[196:199], v[140:143]
    ds_read_b64_tr_b16 v[226:227], v69 offset:544
    s_waitcnt lgkmcnt(8)
    v_mfma_f32_16x16x32_bf16 v[112:115], v[232:235], v[192:195], v[112:115]
    ds_read_b64_tr_b16 v[228:229], v68 offset:16640
    v_mfma_f32_16x16x32_bf16 v[116:119], v[232:235], v[196:199], v[116:119]
    ds_read_b64_tr_b16 v[230:231], v68 offset:17152
    v_mfma_f32_16x16x32_bf16 v[120:123], v[236:239], v[192:195], v[120:123]
    ds_read_b64_tr_b16 v[232:233], v68 offset:16672
    v_mfma_f32_16x16x32_bf16 v[124:127], v[236:239], v[196:199], v[124:127]
    ds_read_b64_tr_b16 v[234:235], v68 offset:17184
    s_waitcnt lgkmcnt(8)
    v_mfma_f32_16x16x32_bf16 v[80:83], v[240:243], v[192:195], v[80:83]
    ds_read_b64_tr_b16 v[236:237], v69 offset:16640
    v_mfma_f32_16x16x32_bf16 v[84:87], v[240:243], v[196:199], v[84:87]
    ds_read_b64_tr_b16 v[238:239], v69 offset:17152
    v_mfma_f32_16x16x32_bf16 v[88:91], v[244:247], v[192:195], v[88:91]
    ds_read_b64_tr_b16 v[240:241], v69 offset:16672
    v_mfma_f32_16x16x32_bf16 v[92:95], v[244:247], v[196:199], v[92:95]
    ds_read_b64_tr_b16 v[242:243], v69 offset:17184
    s_waitcnt lgkmcnt(8)
    v_mfma_f32_16x16x32_bf16 v[96:99], v[248:251], v[192:195], v[96:99]
    ds_read_b64_tr_b16 v[244:245], v69 offset:12480
    v_mfma_f32_16x16x32_bf16 v[100:103], v[248:251], v[196:199], v[100:103]
    ds_read_b64_tr_b16 v[246:247], v69 offset:12992
    v_mfma_f32_16x16x32_bf16 v[104:107], v[224:227], v[192:195], v[104:107]
    ds_read_b64_tr_b16 v[248:249], v69 offset:12512
    v_mfma_f32_16x16x32_bf16 v[108:111], v[224:227], v[196:199], v[108:111]
    ds_read_b64_tr_b16 v[250:251], v69 offset:13024
    s_waitcnt lgkmcnt(8)
    v_mfma_f32_16x16x32_bf16 v[144:147], v[228:231], v[192:195], v[144:147]
    ds_read_b64_tr_b16 v[224:225], v68 offset:12480
    v_mfma_f32_16x16x32_bf16 v[148:151], v[228:231], v[196:199], v[148:151]
    ds_read_b64_tr_b16 v[226:227], v68 offset:12992
    v_mfma_f32_16x16x32_bf16 v[152:155], v[232:235], v[192:195], v[152:155]
    ds_read_b64_tr_b16 v[228:229], v68 offset:12512
    v_mfma_f32_16x16x32_bf16 v[156:159], v[232:235], v[196:199], v[156:159]
    ds_read_b64_tr_b16 v[230:231], v68 offset:13024
    s_waitcnt lgkmcnt(8)
    v_mfma_f32_16x16x32_bf16 v[160:163], v[236:239], v[192:195], v[160:163]
    ds_read_b64_tr_b16 v[232:233], v68 offset:4160
    v_mfma_f32_16x16x32_bf16 v[164:167], v[236:239], v[196:199], v[164:167]
    ds_read_b64_tr_b16 v[234:235], v68 offset:4672
    v_mfma_f32_16x16x32_bf16 v[168:171], v[240:243], v[192:195], v[168:171]
    ds_read_b64_tr_b16 v[236:237], v68 offset:4192
    v_mfma_f32_16x16x32_bf16 v[172:175], v[240:243], v[196:199], v[172:175]
    ds_read_b64_tr_b16 v[238:239], v68 offset:4704
    s_waitcnt lgkmcnt(8)
    s_waitcnt vmcnt(4)
    v_mfma_f32_16x16x32_bf16 v[128:131], v[244:247], v[200:203], v[128:131]
    ds_read_b64_tr_b16 v[240:241], v69 offset:4160
    v_mfma_f32_16x16x32_bf16 v[132:135], v[244:247], v[204:207], v[132:135]
    ds_read_b64_tr_b16 v[242:243], v69 offset:4672
    v_mfma_f32_16x16x32_bf16 v[136:139], v[248:251], v[200:203], v[136:139]
    ds_read_b64_tr_b16 v[244:245], v69 offset:4192
    v_mfma_f32_16x16x32_bf16 v[140:143], v[248:251], v[204:207], v[140:143]
    ds_read_b64_tr_b16 v[246:247], v69 offset:4704
    s_waitcnt lgkmcnt(8)
    v_mfma_f32_16x16x32_bf16 v[112:115], v[224:227], v[200:203], v[112:115]
    ds_read_b64_tr_b16 v[248:249], v68 offset:20800
    v_mfma_f32_16x16x32_bf16 v[116:119], v[224:227], v[204:207], v[116:119]
    ds_read_b64_tr_b16 v[250:251], v68 offset:21312
    v_mfma_f32_16x16x32_bf16 v[120:123], v[228:231], v[200:203], v[120:123]
    ds_read_b64_tr_b16 v[224:225], v68 offset:20832
    v_mfma_f32_16x16x32_bf16 v[124:127], v[228:231], v[204:207], v[124:127]
    ds_read_b64_tr_b16 v[226:227], v68 offset:21344
    s_waitcnt lgkmcnt(8)
    v_mfma_f32_16x16x32_bf16 v[80:83], v[232:235], v[200:203], v[80:83]
    ds_read_b64_tr_b16 v[228:229], v69 offset:20800
    v_mfma_f32_16x16x32_bf16 v[84:87], v[232:235], v[204:207], v[84:87]
    ds_read_b64_tr_b16 v[230:231], v69 offset:21312
    v_mfma_f32_16x16x32_bf16 v[88:91], v[236:239], v[200:203], v[88:91]
    ds_read_b64_tr_b16 v[232:233], v69 offset:20832
    v_mfma_f32_16x16x32_bf16 v[92:95], v[236:239], v[204:207], v[92:95]
    ds_read_b64_tr_b16 v[234:235], v69 offset:21344
    s_waitcnt lgkmcnt(8)
    v_mfma_f32_16x16x32_bf16 v[96:99], v[240:243], v[200:203], v[96:99]
    ds_read_b64_tr_b16 v[236:237], v69 offset:33280
    v_mfma_f32_16x16x32_bf16 v[100:103], v[240:243], v[204:207], v[100:103]
    ds_read_b64_tr_b16 v[238:239], v69 offset:33792
    v_mfma_f32_16x16x32_bf16 v[104:107], v[244:247], v[200:203], v[104:107]
    ds_read_b64_tr_b16 v[240:241], v69 offset:33312
    v_mfma_f32_16x16x32_bf16 v[108:111], v[244:247], v[204:207], v[108:111]
    ds_read_b64_tr_b16 v[242:243], v69 offset:33824
    s_waitcnt lgkmcnt(8)
    v_mfma_f32_16x16x32_bf16 v[144:147], v[248:251], v[200:203], v[144:147]
    ds_read_b64_tr_b16 v[244:245], v68 offset:33280
    v_mfma_f32_16x16x32_bf16 v[148:151], v[248:251], v[204:207], v[148:151]
    ds_read_b64_tr_b16 v[246:247], v68 offset:33792
    v_mfma_f32_16x16x32_bf16 v[152:155], v[224:227], v[200:203], v[152:155]
    ds_read_b64_tr_b16 v[248:249], v68 offset:33312
    v_mfma_f32_16x16x32_bf16 v[156:159], v[224:227], v[204:207], v[156:159]
    ds_read_b64_tr_b16 v[250:251], v68 offset:33824
    s_waitcnt lgkmcnt(8)
    v_mfma_f32_16x16x32_bf16 v[160:163], v[228:231], v[200:203], v[160:163]
    ds_read_b64_tr_b16 v[224:225], v68 offset:24960
    v_mfma_f32_16x16x32_bf16 v[164:167], v[228:231], v[204:207], v[164:167]
    ds_read_b64_tr_b16 v[226:227], v68 offset:25472
    v_mfma_f32_16x16x32_bf16 v[168:171], v[232:235], v[200:203], v[168:171]
    ds_read_b64_tr_b16 v[228:229], v68 offset:24992
    v_mfma_f32_16x16x32_bf16 v[172:175], v[232:235], v[204:207], v[172:175]
    ds_read_b64_tr_b16 v[230:231], v68 offset:25504
    s_waitcnt lgkmcnt(8)
    s_waitcnt vmcnt(2)
    v_mfma_f32_16x16x32_bf16 v[128:131], v[236:239], v[208:211], v[128:131]
    ds_read_b64_tr_b16 v[232:233], v69 offset:24960
    v_mfma_f32_16x16x32_bf16 v[132:135], v[236:239], v[212:215], v[132:135]
    ds_read_b64_tr_b16 v[234:235], v69 offset:25472
    v_mfma_f32_16x16x32_bf16 v[136:139], v[240:243], v[208:211], v[136:139]
    ds_read_b64_tr_b16 v[236:237], v69 offset:24992
    v_mfma_f32_16x16x32_bf16 v[140:143], v[240:243], v[212:215], v[140:143]
    ds_read_b64_tr_b16 v[238:239], v69 offset:25504
    s_waitcnt lgkmcnt(8)
    v_mfma_f32_16x16x32_bf16 v[112:115], v[244:247], v[208:211], v[112:115]
    ds_read_b64_tr_b16 v[240:241], v68 offset:41600
    v_mfma_f32_16x16x32_bf16 v[116:119], v[244:247], v[212:215], v[116:119]
    ds_read_b64_tr_b16 v[242:243], v68 offset:42112
    v_mfma_f32_16x16x32_bf16 v[120:123], v[248:251], v[208:211], v[120:123]
    ds_read_b64_tr_b16 v[244:245], v68 offset:41632
    v_mfma_f32_16x16x32_bf16 v[124:127], v[248:251], v[212:215], v[124:127]
    ds_read_b64_tr_b16 v[246:247], v68 offset:42144
    s_waitcnt lgkmcnt(8)
    v_mfma_f32_16x16x32_bf16 v[80:83], v[224:227], v[208:211], v[80:83]
    ds_read_b64_tr_b16 v[248:249], v69 offset:41600
    v_mfma_f32_16x16x32_bf16 v[84:87], v[224:227], v[212:215], v[84:87]
    ds_read_b64_tr_b16 v[250:251], v69 offset:42112
    v_mfma_f32_16x16x32_bf16 v[88:91], v[228:231], v[208:211], v[88:91]
    ds_read_b64_tr_b16 v[224:225], v69 offset:41632
    v_mfma_f32_16x16x32_bf16 v[92:95], v[228:231], v[212:215], v[92:95]
    ds_read_b64_tr_b16 v[226:227], v69 offset:42144
    s_waitcnt lgkmcnt(8)
    v_mfma_f32_16x16x32_bf16 v[96:99], v[232:235], v[208:211], v[96:99]
    ds_read_b64_tr_b16 v[228:229], v69 offset:37440
    v_mfma_f32_16x16x32_bf16 v[100:103], v[232:235], v[212:215], v[100:103]
    ds_read_b64_tr_b16 v[230:231], v69 offset:37952
    v_mfma_f32_16x16x32_bf16 v[104:107], v[236:239], v[208:211], v[104:107]
    ds_read_b64_tr_b16 v[232:233], v69 offset:37472
    v_mfma_f32_16x16x32_bf16 v[108:111], v[236:239], v[212:215], v[108:111]
    ds_read_b64_tr_b16 v[234:235], v69 offset:37984
    s_waitcnt lgkmcnt(8)
    v_mfma_f32_16x16x32_bf16 v[144:147], v[240:243], v[208:211], v[144:147]
    ds_read_b64_tr_b16 v[236:237], v68 offset:37440
    v_mfma_f32_16x16x32_bf16 v[148:151], v[240:243], v[212:215], v[148:151]
    ds_read_b64_tr_b16 v[238:239], v68 offset:37952
    v_mfma_f32_16x16x32_bf16 v[152:155], v[244:247], v[208:211], v[152:155]
    ds_read_b64_tr_b16 v[240:241], v68 offset:37472
    v_mfma_f32_16x16x32_bf16 v[156:159], v[244:247], v[212:215], v[156:159]
    ds_read_b64_tr_b16 v[242:243], v68 offset:37984
    s_waitcnt lgkmcnt(8)
    v_mfma_f32_16x16x32_bf16 v[160:163], v[248:251], v[208:211], v[160:163]
    ds_read_b64_tr_b16 v[244:245], v68 offset:29120
    v_mfma_f32_16x16x32_bf16 v[164:167], v[248:251], v[212:215], v[164:167]
    ds_read_b64_tr_b16 v[246:247], v68 offset:29632
    v_mfma_f32_16x16x32_bf16 v[168:171], v[224:227], v[208:211], v[168:171]
    ds_read_b64_tr_b16 v[248:249], v68 offset:29152
    v_mfma_f32_16x16x32_bf16 v[172:175], v[224:227], v[212:215], v[172:175]
    ds_read_b64_tr_b16 v[250:251], v68 offset:29664
    s_waitcnt lgkmcnt(8)
    s_waitcnt vmcnt(0)
    v_mfma_f32_16x16x32_bf16 v[128:131], v[228:231], v[216:219], v[128:131]
    ds_read_b64_tr_b16 v[224:225], v69 offset:29120
    v_mfma_f32_16x16x32_bf16 v[132:135], v[228:231], v[220:223], v[132:135]
    ds_read_b64_tr_b16 v[226:227], v69 offset:29632
    v_mfma_f32_16x16x32_bf16 v[136:139], v[232:235], v[216:219], v[136:139]
    ds_read_b64_tr_b16 v[228:229], v69 offset:29152
    v_mfma_f32_16x16x32_bf16 v[140:143], v[232:235], v[220:223], v[140:143]
    ds_read_b64_tr_b16 v[230:231], v69 offset:29664
    s_waitcnt lgkmcnt(8)
    v_mfma_f32_16x16x32_bf16 v[112:115], v[236:239], v[216:219], v[112:115]
    ds_read_b64_tr_b16 v[232:233], v68 offset:45760
    v_mfma_f32_16x16x32_bf16 v[116:119], v[236:239], v[220:223], v[116:119]
    ds_read_b64_tr_b16 v[234:235], v68 offset:46272
    v_mfma_f32_16x16x32_bf16 v[120:123], v[240:243], v[216:219], v[120:123]
    ds_read_b64_tr_b16 v[236:237], v68 offset:45792
    v_mfma_f32_16x16x32_bf16 v[124:127], v[240:243], v[220:223], v[124:127]
    ds_read_b64_tr_b16 v[238:239], v68 offset:46304
    s_waitcnt lgkmcnt(8)
    v_mfma_f32_16x16x32_bf16 v[80:83], v[244:247], v[216:219], v[80:83]
    ds_read_b64_tr_b16 v[240:241], v69 offset:45760
    v_mfma_f32_16x16x32_bf16 v[84:87], v[244:247], v[220:223], v[84:87]
    ds_read_b64_tr_b16 v[242:243], v69 offset:46272
    v_mfma_f32_16x16x32_bf16 v[88:91], v[248:251], v[216:219], v[88:91]
    ds_read_b64_tr_b16 v[244:245], v69 offset:45792
    v_mfma_f32_16x16x32_bf16 v[92:95], v[248:251], v[220:223], v[92:95]
    ds_read_b64_tr_b16 v[246:247], v69 offset:46304
    s_waitcnt lgkmcnt(8)
    v_mfma_f32_16x16x32_bf16 v[96:99], v[224:227], v[216:219], v[96:99]
    v_mfma_f32_16x16x32_bf16 v[100:103], v[224:227], v[220:223], v[100:103]
    v_mfma_f32_16x16x32_bf16 v[104:107], v[228:231], v[216:219], v[104:107]
    v_mfma_f32_16x16x32_bf16 v[108:111], v[228:231], v[220:223], v[108:111]
    s_waitcnt lgkmcnt(4)
    v_mfma_f32_16x16x32_bf16 v[144:147], v[232:235], v[216:219], v[144:147]
    v_mfma_f32_16x16x32_bf16 v[148:151], v[232:235], v[220:223], v[148:151]
    v_mfma_f32_16x16x32_bf16 v[152:155], v[236:239], v[216:219], v[152:155]
    v_mfma_f32_16x16x32_bf16 v[156:159], v[236:239], v[220:223], v[156:159]
    s_waitcnt lgkmcnt(0)
    v_mfma_f32_16x16x32_bf16 v[160:163], v[240:243], v[216:219], v[160:163]
    v_mfma_f32_16x16x32_bf16 v[164:167], v[240:243], v[220:223], v[164:167]
    v_mfma_f32_16x16x32_bf16 v[168:171], v[244:247], v[216:219], v[168:171]
    v_mfma_f32_16x16x32_bf16 v[172:175], v[244:247], v[220:223], v[172:175]
    v_cvt_pk_bf16_f32 v52, v128, v129
    v_cvt_pk_bf16_f32 v53, v130, v131
    v_cvt_pk_bf16_f32 v54, v132, v133
    v_cvt_pk_bf16_f32 v55, v134, v135
    v_cvt_pk_bf16_f32 v56, v136, v137
    v_cvt_pk_bf16_f32 v57, v138, v139
    v_cvt_pk_bf16_f32 v58, v140, v141
    v_cvt_pk_bf16_f32 v59, v142, v143
    ds_write_b64 v77, v[52:53]
    ds_write_b64 v77, v[54:55] offset:256
    ds_write_b64 v77, v[56:57] offset:1024
    ds_write_b64 v77, v[58:59] offset:1280
    v_cvt_pk_bf16_f32 v36, v112, v113
    v_cvt_pk_bf16_f32 v37, v114, v115
    v_cvt_pk_bf16_f32 v38, v116, v117
    v_cvt_pk_bf16_f32 v39, v118, v119
    v_cvt_pk_bf16_f32 v40, v120, v121
    v_cvt_pk_bf16_f32 v41, v122, v123
    v_cvt_pk_bf16_f32 v42, v124, v125
    v_cvt_pk_bf16_f32 v43, v126, v127
    v_permlane16_swap_b32 v36, v38
    v_permlane16_swap_b32 v37, v39
    v_permlane16_swap_b32 v40, v42
    v_permlane16_swap_b32 v41, v43
    s_waitcnt lgkmcnt(0)
    s_barrier
    s_setprio 0
    v_mfma_f32_32x32x16_bf16 v[112:127], v[28:31], v[36:39], 0
    v_mfma_f32_32x32x16_bf16 v[112:127], v[32:35], v[40:43], v[112:127]
    v_cvt_pk_bf16_f32 v52, v144, v145
    v_cvt_pk_bf16_f32 v53, v146, v147
    v_cvt_pk_bf16_f32 v54, v148, v149
    v_cvt_pk_bf16_f32 v55, v150, v151
    v_cvt_pk_bf16_f32 v56, v152, v153
    v_cvt_pk_bf16_f32 v57, v154, v155
    v_cvt_pk_bf16_f32 v58, v156, v157
    v_cvt_pk_bf16_f32 v59, v158, v159
    ds_write_b64 v78, v[52:53]
    ds_write_b64 v78, v[54:55] offset:512
    ds_write_b64 v78, v[56:57] offset:4096
    ds_write_b64 v78, v[58:59] offset:4608
    v_cvt_pk_bf16_f32 v44, v160, v161
    v_cvt_pk_bf16_f32 v45, v162, v163
    v_cvt_pk_bf16_f32 v46, v164, v165
    v_cvt_pk_bf16_f32 v47, v166, v167
    v_cvt_pk_bf16_f32 v48, v168, v169
    v_cvt_pk_bf16_f32 v49, v170, v171
    v_cvt_pk_bf16_f32 v50, v172, v173
    v_cvt_pk_bf16_f32 v51, v174, v175
    ds_write_b64 v78, v[44:45] offset:8192
    ds_write_b64 v78, v[46:47] offset:8704
    ds_write_b64 v78, v[48:49] offset:12288
    ds_write_b64 v78, v[50:51] offset:12800
    v_cvt_pk_bf16_f32 v36, v96, v97
    v_cvt_pk_bf16_f32 v37, v98, v99
    v_cvt_pk_bf16_f32 v38, v100, v101
    v_cvt_pk_bf16_f32 v39, v102, v103
    v_cvt_pk_bf16_f32 v40, v104, v105
    v_cvt_pk_bf16_f32 v41, v106, v107
    v_cvt_pk_bf16_f32 v42, v108, v109
    v_cvt_pk_bf16_f32 v43, v110, v111
    ds_write_b64 v77, v[36:37] offset:2048
    ds_write_b64 v77, v[38:39] offset:2304
    ds_write_b64 v77, v[40:41] offset:3072
    ds_write_b64 v77, v[42:43] offset:3328
    v_cvt_pk_bf16_f32 v44, v80, v81
    v_cvt_pk_bf16_f32 v45, v82, v83
    v_cvt_pk_bf16_f32 v46, v84, v85
    v_cvt_pk_bf16_f32 v47, v86, v87
    v_cvt_pk_bf16_f32 v48, v88, v89
    v_cvt_pk_bf16_f32 v49, v90, v91
    v_cvt_pk_bf16_f32 v50, v92, v93
    v_cvt_pk_bf16_f32 v51, v94, v95
    v_permlane16_swap_b32 v44, v46
    v_permlane16_swap_b32 v45, v47
    v_permlane16_swap_b32 v48, v50
    v_permlane16_swap_b32 v49, v51
    s_branch L_JOIN
L_HELP:
    s_add_u32 s96, s85, 5
    s_and_b32 s97, s96, 15
    s_lshl3_add_u32 s98, s97, s3
    s_sub_u32 s99, s98, 4
    s_mul_i32 s96, s99, 49152
    s_lshl_b32 s97, s11, 7
    s_add_u32 s82, s96, s97
    s_sub_u32 s96, s3, 4
    s_lshr_b32 s97, s96, 1
    s_mul_i32 s98, s97, 2080
    s_sub_u32 s99, s3, 4
    s_and_b32 s96, s99, 1
    s_mul_i32 s97, s96, 1056
    s_add_u32 s99, s98, s97
    s_add_u32 s20, s99, 124800
    s_mov_b32 m0, s20
    s_nop 0
    buffer_load_dwordx4 v62, s[40:43], s82 offen lds
    s_add_u32 s82, s82, 2048
    s_add_u32 m0, s20, 8320
    s_nop 0
    buffer_load_dwordx4 v62, s[40:43], s82 offen lds
    s_add_u32 s82, s82, 2048
    s_add_u32 m0, s20, 16640
    s_nop 0
    buffer_load_dwordx4 v62, s[40:43], s82 offen lds
    s_add_u32 s96, s85, 5
    s_and_b32 s97, s96, 15
    s_lshl3_add_u32 s98, s97, s3
    s_mul_i32 s99, s98, 49152
    s_lshl_b32 s96, s11, 7
    s_add_u32 s82, s99, s96
    s_lshr_b32 s96, s3, 1
    s_mul_i32 s97, s96, 2080
    s_and_b32 s98, s3, 1
    s_mul_i32 s99, s98, 1056
    s_add_u32 s96, s97, s99
    s_add_u32 s20, s96, 124800
    s_mov_b32 m0, s20
    s_nop 0
    buffer_load_dwordx4 v62, s[40:43], s82 offen lds
    s_add_u32 s82, s82, 2048
    s_add_u32 m0, s20, 8320
    s_nop 0
    buffer_load_dwordx4 v62, s[40:43], s82 offen lds
    s_add_u32 s82, s82, 2048
    s_add_u32 m0, s20, 16640
    s_nop 0
    buffer_load_dwordx4 v62, s[40:43], s82 offen lds
    s_and_b32 s96, s9, 3
    s_lshl2_add_u32 s97, s96, s3
    s_sub_u32 s98, s97, 4
    s_lshl_b32 s13, s98, 7
    v_lshrrev_b32 v61, 3, v1
    v_lshl_add_u32 v61, v61, 4, s13
    v_lshrrev_b32 v60, 3, v1
    v_mul_u32_u24 v60, 98304, v60
    v_and_b32 v9, 7, v1
    v_lshl_add_u32 v60, v9, 4, v60
    s_mul_i32 s96, s13, 6144
    s_bfe_u32 s97, s9, 131074
    s_lshl_b32 s98, s8, 1
    s_lshl4_add_u32 s99, s97, s98
    s_lshr_b32 s97, s9, 4
    s_add_u32 s98, s99, s97
    s_lshl_b32 s99, s98, 7
    s_add_u32 s97, s96, s99
    s_add_u32 s17, s97, 4096
    global_load_dwordx4 v[120:123], v61, s[86:87]
    s_waitcnt vmcnt(13)
    s_barrier
    buffer_load_dwordx4 v[80:83], v60, s[48:51], s17 offen nt
    s_add_u32 s17, s17, 12288
    buffer_load_dwordx4 v[84:87], v60, s[48:51], s17 offen nt
    s_add_u32 s17, s17, 12288
    s_waitcnt lgkmcnt(0)
    s_load_dword s24, s[32:33], s92 offset:512 glc
    s_load_dword s25, s[32:33], s92 offset:256 glc
    s_load_dword s26, s[32:33], s92 offset:1024 glc
    s_load_dword s27, s[32:33], s92 offset:768 glc
    s_waitcnt vmcnt(12)
    s_barrier
    s_add_u32 s96, s85, 6
    s_and_b32 s97, s96, 15
    s_lshl3_add_u32 s98, s97, s3
    s_sub_u32 s99, s98, 4
    s_mul_i32 s96, s99, 49152
    s_lshl_b32 s97, s11, 7
    s_add_u32 s82, s96, s97
    s_sub_u32 s96, s3, 4
    s_lshr_b32 s97, s96, 1
    s_mul_i32 s98, s97, 2080
    s_sub_u32 s99, s3, 4
    s_and_b32 s96, s99, 1
    s_mul_i32 s97, s96, 1056
    s_add_u32 s20, s98, s97
    s_mov_b32 m0, s20
    s_nop 0
    buffer_load_dwordx4 v62, s[40:43], s82 offen lds
    s_add_u32 s82, s82, 2048
    s_add_u32 m0, s20, 8320
    s_nop 0
    buffer_load_dwordx4 v62, s[40:43], s82 offen lds
    s_add_u32 s82, s82, 2048
    s_add_u32 m0, s20, 16640
    s_nop 0
    buffer_load_dwordx4 v62, s[40:43], s82 offen lds
    s_add_u32 s96, s85, 6
    s_and_b32 s97, s96, 15
    s_lshl3_add_u32 s98, s97, s3
    s_mul_i32 s99, s98, 49152
    s_lshl_b32 s96, s11, 7
    s_add_u32 s82, s99, s96
    s_lshr_b32 s96, s3, 1
    s_mul_i32 s97, s96, 2080
    s_and_b32 s98, s3, 1
    s_mul_i32 s99, s98, 1056
    s_add_u32 s20, s97, s99
    s_mov_b32 m0, s20
    s_nop 0
    buffer_load_dwordx4 v62, s[40:43], s82 offen lds
    s_add_u32 s82, s82, 2048
    s_add_u32 m0, s20, 8320
    s_nop 0
    buffer_load_dwordx4 v62, s[40:43], s82 offen lds
    s_add_u32 s82, s82, 2048
    s_add_u32 m0, s20, 16640
    s_nop 0
    buffer_load_dwordx4 v62, s[40:43], s82 offen lds
    s_waitcnt vmcnt(8)
    v_lshlrev_b32 v112, 16, v120
    v_mul_f32 v4, s7, v112
    v_exp_f32 v4, -v4
    s_nop 0
    v_add_f32 v4, 1.0, v4
    v_rcp_f32 v4, v4
    s_nop 0
    v_mul_f32 v112, v112, v4
    v_cvt_pk_bf16_f32 v112, 0, v112
    v_and_b32 v113, s6, v120
    v_mul_f32 v5, s7, v113
    v_exp_f32 v5, -v5
    s_nop 0
    v_add_f32 v5, 1.0, v5
    v_rcp_f32 v5, v5
    s_nop 0
    v_mul_f32 v113, v113, v5
    v_cvt_pk_bf16_f32 v113, 0, v113
    v_lshlrev_b32 v114, 16, v121
    v_mul_f32 v4, s7, v114
    v_exp_f32 v4, -v4
    s_nop 0
    v_add_f32 v4, 1.0, v4
    v_rcp_f32 v4, v4
    s_nop 0
    v_mul_f32 v114, v114, v4
    v_cvt_pk_bf16_f32 v114, 0, v114
    v_and_b32 v115, s6, v121
    v_mul_f32 v5, s7, v115
    v_exp_f32 v5, -v5
    s_nop 0
    v_add_f32 v5, 1.0, v5
    v_rcp_f32 v5, v5
    s_nop 0
    v_mul_f32 v115, v115, v5
    v_cvt_pk_bf16_f32 v115, 0, v115
    s_barrier
    s_add_u32 s96, s85, 7
    s_and_b32 s97, s96, 15
    s_lshl3_add_u32 s98, s97, s3
    s_sub_u32 s99, s98, 4
    s_mul_i32 s96, s99, 49152
    s_lshl_b32 s97, s11, 7
    s_add_u32 s82, s96, s97
    s_sub_u32 s96, s3, 4
    s_lshr_b32 s97, s96, 1
    s_mul_i32 s98, s97, 2080
    s_sub_u32 s99, s3, 4
    s_and_b32 s96, s99, 1
    s_mul_i32 s97, s96, 1056
    s_add_u32 s99, s98, s97
    s_add_u32 s20, s99, 24960
    s_mov_b32 m0, s20
    s_nop 0
    buffer_load_dwordx4 v62, s[40:43], s82 offen lds
    s_add_u32 s82, s82, 2048
    s_add_u32 m0, s20, 8320
    s_nop 0
    buffer_load_dwordx4 v62, s[40:43], s82 offen lds
    s_add_u32 s82, s82, 2048
    s_add_u32 m0, s20, 16640
    s_nop 0
    buffer_load_dwordx4 v62, s[40:43], s82 offen lds
    buffer_load_dwordx4 v[88:91], v60, s[48:51], s17 offen nt
    s_add_u32 s17, s17, 12288
    buffer_load_dwordx4 v[92:95], v60, s[48:51], s17 offen nt
    s_add_u32 s17, s17, 12288
    s_barrier
    s_add_u32 s96, s85, 7
    s_and_b32 s97, s96, 15
    s_lshl3_add_u32 s98, s97, s3
    s_mul_i32 s99, s98, 49152
    s_lshl_b32 s96, s11, 7
    s_add_u32 s82, s99, s96
    s_lshr_b32 s96, s3, 1
    s_mul_i32 s97, s96, 2080
    s_and_b32 s98, s3, 1
    s_mul_i32 s99, s98, 1056
    s_add_u32 s96, s97, s99
    s_add_u32 s20, s96, 24960
    s_mov_b32 m0, s20
    s_nop 0
    buffer_load_dwordx4 v62, s[40:43], s82 offen lds
    s_add_u32 s82, s82, 2048
    s_add_u32 m0, s20, 8320
    s_nop 0
    buffer_load_dwordx4 v62, s[40:43], s82 offen lds
    s_add_u32 s82, s82, 2048
    s_add_u32 m0, s20, 16640
    s_nop 0
    buffer_load_dwordx4 v62, s[40:43], s82 offen lds
    s_add_u32 s96, s85, 8
    s_and_b32 s97, s96, 15
    s_lshl3_add_u32 s98, s97, s3
    s_sub_u32 s99, s98, 4
    s_mul_i32 s96, s99, 49152
    s_lshl_b32 s97, s11, 7
    s_add_u32 s82, s96, s97
    s_sub_u32 s96, s3, 4
    s_lshr_b32 s97, s96, 1
    s_mul_i32 s98, s97, 2080
    s_sub_u32 s99, s3, 4
    s_and_b32 s96, s99, 1
    s_mul_i32 s97, s96, 1056
    s_add_u32 s99, s98, s97
    s_add_u32 s20, s99, 49920
    s_mov_b32 m0, s20
    s_nop 0
    buffer_load_dwordx4 v62, s[40:43], s82 offen lds
    s_add_u32 s82, s82, 2048
    s_add_u32 m0, s20, 8320
    s_nop 0
    buffer_load_dwordx4 v62, s[40:43], s82 offen lds
    s_add_u32 s82, s82, 2048
    s_add_u32 m0, s20, 16640
    s_nop 0
    buffer_load_dwordx4 v62, s[40:43], s82 offen lds
    v_lshlrev_b32 v116, 16, v122
    v_mul_f32 v4, s7, v116
    v_exp_f32 v4, -v4
    s_nop 0
    v_add_f32 v4, 1.0, v4
    v_rcp_f32 v4, v4
    s_nop 0
    v_mul_f32 v116, v116, v4
    v_cvt_pk_bf16_f32 v116, 0, v116
    v_and_b32 v117, s6, v122
    v_mul_f32 v5, s7, v117
    v_exp_f32 v5, -v5
    s_nop 0
    v_add_f32 v5, 1.0, v5
    v_rcp_f32 v5, v5
    s_nop 0
    v_mul_f32 v117, v117, v5
    v_cvt_pk_bf16_f32 v117, 0, v117
    v_lshlrev_b32 v118, 16, v123
    v_mul_f32 v4, s7, v118
    v_exp_f32 v4, -v4
    s_nop 0
    v_add_f32 v4, 1.0, v4
    v_rcp_f32 v4, v4
    s_nop 0
    v_mul_f32 v118, v118, v4
    v_cvt_pk_bf16_f32 v118, 0, v118
    v_and_b32 v119, s6, v123
    v_mul_f32 v5, s7, v119
    v_exp_f32 v5, -v5
    s_nop 0
    v_add_f32 v5, 1.0, v5
    v_rcp_f32 v5, v5
    s_nop 0
    v_mul_f32 v119, v119, v5
    v_cvt_pk_bf16_f32 v119, 0, v119
    s_waitcnt lgkmcnt(0)
    s_load_dword s24, s[32:33], s92 offset:1536 glc
    s_load_dword s25, s[32:33], s92 offset:1280 glc
    s_load_dword s26, s[32:33], s92 offset:2048 glc
    s_load_dword s27, s[32:33], s92 offset:1792 glc
    s_barrier
    s_add_u32 s96, s85, 8
    s_and_b32 s97, s96, 15
    s_lshl3_add_u32 s98, s97, s3
    s_mul_i32 s99, s98, 49152
    s_lshl_b32 s96, s11, 7
    s_add_u32 s82, s99, s96
    s_lshr_b32 s96, s3, 1
    s_mul_i32 s97, s96, 2080
    s_and_b32 s98, s3, 1
    s_mul_i32 s99, s98, 1056
    s_add_u32 s96, s97, s99
    s_add_u32 s20, s96, 49920
    s_mov_b32 m0, s20
    s_nop 0
    buffer_load_dwordx4 v62, s[40:43], s82 offen lds
    s_add_u32 s82, s82, 2048
    s_add_u32 m0, s20, 8320
    s_nop 0
    buffer_load_dwordx4 v62, s[40:43], s82 offen lds
    s_add_u32 s82, s82, 2048
    s_add_u32 m0, s20, 16640
    s_nop 0
    buffer_load_dwordx4 v62, s[40:43], s82 offen lds
    buffer_load_dwordx4 v[96:99], v60, s[48:51], s17 offen nt
    s_add_u32 s17, s17, 12288
    buffer_load_dwordx4 v[100:103], v60, s[48:51], s17 offen nt
    s_add_u32 s17, s17, 12288
    s_waitcnt vmcnt(16)
    s_barrier
    s_add_u32 s96, s85, 9
    s_and_b32 s97, s96, 15
    s_lshl3_add_u32 s98, s97, s3
    s_sub_u32 s99, s98, 4
    s_mul_i32 s96, s99, 49152
    s_lshl_b32 s97, s11, 7
    s_add_u32 s82, s96, s97
    s_sub_u32 s96, s3, 4
    s_lshr_b32 s97, s96, 1
    s_mul_i32 s98, s97, 2080
    s_sub_u32 s99, s3, 4
    s_and_b32 s96, s99, 1
    s_mul_i32 s97, s96, 1056
    s_add_u32 s99, s98, s97
    s_add_u32 s20, s99, 74880
    s_mov_b32 m0, s20
    s_nop 0
    buffer_load_dwordx4 v62, s[40:43], s82 offen lds
    s_add_u32 s82, s82, 2048
    s_add_u32 m0, s20, 8320
    s_nop 0
    buffer_load_dwordx4 v62, s[40:43], s82 offen lds
    s_add_u32 s82, s82, 2048
    s_add_u32 m0, s20, 16640
    s_nop 0
    buffer_load_dwordx4 v62, s[40:43], s82 offen lds
    s_add_u32 s96, s85, 9
    s_and_b32 s97, s96, 15
    s_lshl3_add_u32 s98, s97, s3
    s_mul_i32 s99, s98, 49152
    s_lshl_b32 s96, s11, 7
    s_add_u32 s82, s99, s96
    s_lshr_b32 s96, s3, 1
    s_mul_i32 s97, s96, 2080
    s_and_b32 s98, s3, 1
    s_mul_i32 s99, s98, 1056
    s_add_u32 s96, s97, s99
    s_add_u32 s20, s96, 74880
    s_mov_b32 m0, s20
    s_nop 0
    buffer_load_dwordx4 v62, s[40:43], s82 offen lds
    s_add_u32 s82, s82, 2048
    s_add_u32 m0, s20, 8320
    s_nop 0
    buffer_load_dwordx4 v62, s[40:43], s82 offen lds
    s_add_u32 s82, s82, 2048
    s_add_u32 m0, s20, 16640
    s_nop 0
    buffer_load_dwordx4 v62, s[40:43], s82 offen lds
    v_lshlrev_b32 v4, 16, v80
    v_and_b32 v5, s6, v80
    v_mul_f32 v20, v4, v112
    v_mul_f32 v21, v5, v112
    v_lshlrev_b32 v6, 16, v81
    v_and_b32 v7, s6, v81
    v_mul_f32 v22, v6, v112
    v_mul_f32 v23, v7, v112
    v_lshlrev_b32 v4, 16, v82
    v_and_b32 v5, s6, v82
    v_mul_f32 v24, v4, v112
    v_mul_f32 v25, v5, v112
    v_lshlrev_b32 v6, 16, v83
    v_and_b32 v7, s6, v83
    v_mul_f32 v26, v6, v112
    v_mul_f32 v27, v7, v112
    s_waitcnt vmcnt(14)
    s_barrier
    s_add_u32 s96, s85, 10
    s_and_b32 s97, s96, 15
    s_lshl3_add_u32 s98, s97, s3
    s_sub_u32 s99, s98, 4
    s_mul_i32 s96, s99, 49152
    s_lshl_b32 s97, s11, 7
    s_add_u32 s82, s96, s97
    s_sub_u32 s96, s3, 4
    s_lshr_b32 s97, s96, 1
    s_mul_i32 s98, s97, 2080
    s_sub_u32 s99, s3, 4
    s_and_b32 s96, s99, 1
    s_mul_i32 s97, s96, 1056
    s_add_u32 s99, s98, s97
    s_add_u32 s20, s99, 99840
    s_mov_b32 m0, s20
    s_nop 0
    buffer_load_dwordx4 v62, s[40:43], s82 offen lds
    s_add_u32 s82, s82, 2048
    s_add_u32 m0, s20, 8320
    s_nop 0
    buffer_load_dwordx4 v62, s[40:43], s82 offen lds
    s_add_u32 s82, s82, 2048
    s_add_u32 m0, s20, 16640
    s_nop 0
    buffer_load_dwordx4 v62, s[40:43], s82 offen lds
    buffer_load_dwordx4 v[104:107], v60, s[48:51], s17 offen nt
    s_add_u32 s17, s17, 12288
    buffer_load_dwordx4 v[108:111], v60, s[48:51], s17 offen nt
    s_lshl2_add_u32 s96, s74, s75
    s_lshl_b32 s97, s96, 11
    s_and_b32 s98, s3, 1
    s_lshl_b32 s99, s98, 10
    s_add_u32 s96, s97, s99
    s_add_u32 s13, s96, 20971520
    s_lshl4_add_u32 s96, s21, s12
    s_lshl_b32 s97, s96, 11
    s_and_b32 s98, s3, 1
    s_lshl_b32 s99, s98, 10
    s_add_u32 s96, s97, s99
    s_add_u32 s14, s96, 12582912
    buffer_load_dwordx4 v[124:127], v2, s[32:35], s13 offen
    s_waitcnt lgkmcnt(0)
    s_load_dword s24, s[32:33], s92 offset:2560 glc
    s_load_dword s25, s[32:33], s92 offset:2304 glc
    s_load_dword s26, s[32:33], s92 offset:3072 glc
    s_load_dword s27, s[32:33], s92 offset:2816 glc
    s_load_dword s28, s[32:33], s92 offset:3584 glc
    s_load_dword s29, s[32:33], s92 offset:3328 glc
    s_waitcnt vmcnt(14)
    s_barrier
    s_add_u32 s96, s85, 10
    s_and_b32 s97, s96, 15
    s_lshl3_add_u32 s98, s97, s3
    s_mul_i32 s99, s98, 49152
    s_lshl_b32 s96, s11, 7
    s_add_u32 s82, s99, s96
    s_lshr_b32 s96, s3, 1
    s_mul_i32 s97, s96, 2080
    s_and_b32 s98, s3, 1
    s_mul_i32 s99, s98, 1056
    s_add_u32 s96, s97, s99
    s_add_u32 s20, s96, 99840
    s_mov_b32 m0, s20
    s_nop 0
    buffer_load_dwordx4 v62, s[40:43], s82 offen lds
    s_add_u32 s82, s82, 2048
    s_add_u32 m0, s20, 8320
    s_nop 0
    buffer_load_dwordx4 v62, s[40:43], s82 offen lds
    s_add_u32 s82, s82, 2048
    s_add_u32 m0, s20, 16640
    s_nop 0
    buffer_load_dwordx4 v62, s[40:43], s82 offen lds
    s_add_u32 s96, s85, 11
    s_and_b32 s97, s96, 15
    s_lshl3_add_u32 s98, s97, s3
    s_sub_u32 s99, s98, 4
    s_mul_i32 s96, s99, 49152
    s_lshl_b32 s97, s11, 7
    s_add_u32 s82, s96, s97
    s_sub_u32 s96, s3, 4
    s_lshr_b32 s97, s96, 1
    s_mul_i32 s98, s97, 2080
    s_sub_u32 s99, s3, 4
    s_and_b32 s96, s99, 1
    s_mul_i32 s97, s96, 1056
    s_add_u32 s99, s98, s97
    s_add_u32 s20, s99, 124800
    s_mov_b32 m0, s20
    s_nop 0
    buffer_load_dwordx4 v62, s[40:43], s82 offen lds
    s_add_u32 s82, s82, 2048
    s_add_u32 m0, s20, 8320
    s_nop 0
    buffer_load_dwordx4 v62, s[40:43], s82 offen lds
    s_add_u32 s82, s82, 2048
    s_add_u32 m0, s20, 16640
    s_nop 0
    buffer_load_dwordx4 v62, s[40:43], s82 offen lds
    v_lshlrev_b32 v4, 16, v84
    v_and_b32 v5, s6, v84
    v_fmac_f32 v20, v4, v113
    v_fmac_f32 v21, v5, v113
    v_lshlrev_b32 v6, 16, v85
    v_and_b32 v7, s6, v85
    v_fmac_f32 v22, v6, v113
    v_fmac_f32 v23, v7, v113
    v_lshlrev_b32 v4, 16, v86
    v_and_b32 v5, s6, v86
    v_fmac_f32 v24, v4, v113
    v_fmac_f32 v25, v5, v113
    v_lshlrev_b32 v6, 16, v87
    v_and_b32 v7, s6, v87
    v_fmac_f32 v26, v6, v113
    v_fmac_f32 v27, v7, v113
    s_waitcnt vmcnt(12)
    s_barrier
    s_add_u32 s96, s85, 11
    s_and_b32 s97, s96, 15
    s_lshl3_add_u32 s98, s97, s3
    s_mul_i32 s99, s98, 49152
    s_lshl_b32 s96, s11, 7
    s_add_u32 s82, s99, s96
    s_lshr_b32 s96, s3, 1
    s_mul_i32 s97, s96, 2080
    s_and_b32 s98, s3, 1
    s_mul_i32 s99, s98, 1056
    s_add_u32 s96, s97, s99
    s_add_u32 s20, s96, 124800
    s_mov_b32 m0, s20
    s_nop 0
    buffer_load_dwordx4 v62, s[40:43], s82 offen lds
    s_add_u32 s82, s82, 2048
    s_add_u32 m0, s20, 8320
    s_nop 0
    buffer_load_dwordx4 v62, s[40:43], s82 offen lds
    s_add_u32 s82, s82, 2048
    s_add_u32 m0, s20, 16640
    s_nop 0
    buffer_load_dwordx4 v62, s[40:43], s82 offen lds
    s_add_u32 s96, s85, 12
    s_and_b32 s97, s96, 15
    s_lshl3_add_u32 s98, s97, s3
    s_sub_u32 s99, s98, 4
    s_mul_i32 s96, s99, 49152
    s_lshl_b32 s97, s11, 7
    s_add_u32 s82, s96, s97
    s_sub_u32 s96, s3, 4
    s_lshr_b32 s97, s96, 1
    s_mul_i32 s98, s97, 2080
    s_sub_u32 s99, s3, 4
    s_and_b32 s96, s99, 1
    s_mul_i32 s97, s96, 1056
    s_add_u32 s20, s98, s97
    s_mov_b32 m0, s20
    s_nop 0
    buffer_load_dwordx4 v62, s[40:43], s82 offen lds
    s_add_u32 s82, s82, 2048
    s_add_u32 m0, s20, 8320
    s_nop 0
    buffer_load_dwordx4 v62, s[40:43], s82 offen lds
    s_add_u32 s82, s82, 2048
    s_add_u32 m0, s20, 16640
    s_nop 0
    buffer_load_dwordx4 v62, s[40:43], s82 offen lds
    v_lshlrev_b32 v4, 16, v88
    v_and_b32 v5, s6, v88
    v_fmac_f32 v20, v4, v114
    v_fmac_f32 v21, v5, v114
    v_lshlrev_b32 v6, 16, v89
    v_and_b32 v7, s6, v89
    v_fmac_f32 v22, v6, v114
    v_fmac_f32 v23, v7, v114
    v_lshlrev_b32 v4, 16, v90
    v_and_b32 v5, s6, v90
    v_fmac_f32 v24, v4, v114
    v_fmac_f32 v25, v5, v114
    v_lshlrev_b32 v6, 16, v91
    v_and_b32 v7, s6, v91
    v_fmac_f32 v26, v6, v114
    v_fmac_f32 v27, v7, v114
    s_waitcnt vmcnt(9)
    s_barrier
    s_add_u32 s96, s85, 12
    s_and_b32 s97, s96, 15
    s_lshl3_add_u32 s98, s97, s3
    s_mul_i32 s99, s98, 49152
    s_lshl_b32 s96, s11, 7
    s_add_u32 s82, s99, s96
    s_lshr_b32 s96, s3, 1
    s_mul_i32 s97, s96, 2080
    s_and_b32 s98, s3, 1
    s_mul_i32 s99, s98, 1056
    s_add_u32 s20, s97, s99
    s_mov_b32 m0, s20
    s_nop 0
    buffer_load_dwordx4 v62, s[40:43], s82 offen lds
    s_add_u32 s82, s82, 2048
    s_add_u32 m0, s20, 8320
    s_nop 0
    buffer_load_dwordx4 v62, s[40:43], s82 offen lds
    s_add_u32 s82, s82, 2048
    s_add_u32 m0, s20, 16640
    s_nop 0
    buffer_load_dwordx4 v62, s[40:43], s82 offen lds
    s_add_u32 s96, s85, 13
    s_and_b32 s97, s96, 15
    s_lshl3_add_u32 s98, s97, s3
    s_sub_u32 s99, s98, 4
    s_mul_i32 s96, s99, 49152
    s_lshl_b32 s97, s11, 7
    s_add_u32 s82, s96, s97
    s_sub_u32 s96, s3, 4
    s_lshr_b32 s97, s96, 1
    s_mul_i32 s98, s97, 2080
    s_sub_u32 s99, s3, 4
    s_and_b32 s96, s99, 1
    s_mul_i32 s97, s96, 1056
    s_add_u32 s99, s98, s97
    s_add_u32 s20, s99, 24960
    s_mov_b32 m0, s20
    s_nop 0
    buffer_load_dwordx4 v62, s[40:43], s82 offen lds
    s_add_u32 s82, s82, 2048
    s_add_u32 m0, s20, 8320
    s_nop 0
    buffer_load_dwordx4 v62, s[40:43], s82 offen lds
    s_add_u32 s82, s82, 2048
    s_add_u32 m0, s20, 16640
    s_nop 0
    buffer_load_dwordx4 v62, s[40:43], s82 offen lds
    v_lshlrev_b32 v4, 16, v92
    v_and_b32 v5, s6, v92
    v_fmac_f32 v20, v4, v115
    v_fmac_f32 v21, v5, v115
    v_lshlrev_b32 v6, 16, v93
    v_and_b32 v7, s6, v93
    v_fmac_f32 v22, v6, v115
    v_fmac_f32 v23, v7, v115
    v_lshlrev_b32 v4, 16, v94
    v_and_b32 v5, s6, v94
    v_fmac_f32 v24, v4, v115
    v_fmac_f32 v25, v5, v115
    v_lshlrev_b32 v6, 16, v95
    v_and_b32 v7, s6, v95
    v_fmac_f32 v26, v6, v115
    v_fmac_f32 v27, v7, v115
    s_waitcnt vmcnt(9)
    s_barrier
    s_add_u32 s96, s85, 13
    s_and_b32 s97, s96, 15
    s_lshl3_add_u32 s98, s97, s3
    s_mul_i32 s99, s98, 49152
    s_lshl_b32 s96, s11, 7
    s_add_u32 s82, s99, s96
    s_lshr_b32 s96, s3, 1
    s_mul_i32 s97, s96, 2080
    s_and_b32 s98, s3, 1
    s_mul_i32 s99, s98, 1056
    s_add_u32 s96, s97, s99
    s_add_u32 s20, s96, 24960
    s_mov_b32 m0, s20
    s_nop 0
    buffer_load_dwordx4 v62, s[40:43], s82 offen lds
    s_add_u32 s82, s82, 2048
    s_add_u32 m0, s20, 8320
    s_nop 0
    buffer_load_dwordx4 v62, s[40:43], s82 offen lds
    s_add_u32 s82, s82, 2048
    s_add_u32 m0, s20, 16640
    s_nop 0
    buffer_load_dwordx4 v62, s[40:43], s82 offen lds
    s_add_u32 s96, s85, 14
    s_and_b32 s97, s96, 15
    s_lshl3_add_u32 s98, s97, s3
    s_sub_u32 s99, s98, 4
    s_mul_i32 s96, s99, 49152
    s_lshl_b32 s97, s11, 7
    s_add_u32 s82, s96, s97
    s_sub_u32 s96, s3, 4
    s_lshr_b32 s97, s96, 1
    s_mul_i32 s98, s97, 2080
    s_sub_u32 s99, s3, 4
    s_and_b32 s96, s99, 1
    s_mul_i32 s97, s96, 1056
    s_add_u32 s99, s98, s97
    s_add_u32 s20, s99, 49920
    s_mov_b32 m0, s20
    s_nop 0
    buffer_load_dwordx4 v62, s[40:43], s82 offen lds
    s_add_u32 s82, s82, 2048
    s_add_u32 m0, s20, 8320
    s_nop 0
    buffer_load_dwordx4 v62, s[40:43], s82 offen lds
    s_add_u32 s82, s82, 2048
    s_add_u32 m0, s20, 16640
    s_nop 0
    buffer_load_dwordx4 v62, s[40:43], s82 offen lds
    v_lshlrev_b32 v4, 16, v96
    v_and_b32 v5, s6, v96
    v_fmac_f32 v20, v4, v116
    v_fmac_f32 v21, v5, v116
    v_lshlrev_b32 v6, 16, v97
    v_and_b32 v7, s6, v97
    v_fmac_f32 v22, v6, v116
    v_fmac_f32 v23, v7, v116
    v_lshlrev_b32 v4, 16, v98
    v_and_b32 v5, s6, v98
    v_fmac_f32 v24, v4, v116
    v_fmac_f32 v25, v5, v116
    v_lshlrev_b32 v6, 16, v99
    v_and_b32 v7, s6, v99
    v_fmac_f32 v26, v6, v116
    v_fmac_f32 v27, v7, v116
    v_lshlrev_b32 v4, 16, v100
    v_and_b32 v5, s6, v100
    v_fmac_f32 v20, v4, v117
    v_fmac_f32 v21, v5, v117
    v_lshlrev_b32 v6, 16, v101
    v_and_b32 v7, s6, v101
    v_fmac_f32 v22, v6, v117
    v_fmac_f32 v23, v7, v117
    v_lshlrev_b32 v4, 16, v102
    v_and_b32 v5, s6, v102
    v_fmac_f32 v24, v4, v117
    v_fmac_f32 v25, v5, v117
    v_lshlrev_b32 v6, 16, v103
    v_and_b32 v7, s6, v103
    v_fmac_f32 v26, v6, v117
    v_fmac_f32 v27, v7, v117
    s_waitcnt vmcnt(9)
    s_barrier
    s_add_u32 s96, s85, 14
    s_and_b32 s97, s96, 15
    s_lshl3_add_u32 s98, s97, s3
    s_mul_i32 s99, s98, 49152
    s_lshl_b32 s96, s11, 7
    s_add_u32 s82, s99, s96
    s_lshr_b32 s96, s3, 1
    s_mul_i32 s97, s96, 2080
    s_and_b32 s98, s3, 1
    s_mul_i32 s99, s98, 1056
    s_add_u32 s96, s97, s99
    s_add_u32 s20, s96, 49920
    s_mov_b32 m0, s20
    s_nop 0
    buffer_load_dwordx4 v62, s[40:43], s82 offen lds
    s_add_u32 s82, s82, 2048
    s_add_u32 m0, s20, 8320
    s_nop 0
    buffer_load_dwordx4 v62, s[40:43], s82 offen lds
    s_add_u32 s82, s82, 2048
    s_add_u32 m0, s20, 16640
    s_nop 0
    buffer_load_dwordx4 v62, s[40:43], s82 offen lds
    s_add_u32 s96, s85, 15
    s_and_b32 s97, s96, 15
    s_lshl3_add_u32 s98, s97, s3
    s_sub_u32 s99, s98, 4
    s_mul_i32 s96, s99, 49152
    s_lshl_b32 s97, s11, 7
    s_add_u32 s82, s96, s97
    s_sub_u32 s96, s3, 4
    s_lshr_b32 s97, s96, 1
    s_mul_i32 s98, s97, 2080
    s_sub_u32 s99, s3, 4
    s_and_b32 s96, s99, 1
    s_mul_i32 s97, s96, 1056
    s_add_u32 s99, s98, s97
    s_add_u32 s20, s99, 74880
    s_mov_b32 m0, s20
    s_nop 0
    buffer_load_dwordx4 v62, s[40:43], s82 offen lds
    s_add_u32 s82, s82, 2048
    s_add_u32 m0, s20, 8320
    s_nop 0
    buffer_load_dwordx4 v62, s[40:43], s82 offen lds
    s_add_u32 s82, s82, 2048
    s_add_u32 m0, s20, 16640
    s_nop 0
    buffer_load_dwordx4 v62, s[40:43], s82 offen lds
    v_lshlrev_b32 v4, 16, v104
    v_and_b32 v5, s6, v104
    v_fmac_f32 v20, v4, v118
    v_fmac_f32 v21, v5, v118
    v_lshlrev_b32 v6, 16, v105
    v_and_b32 v7, s6, v105
    v_fmac_f32 v22, v6, v118
    v_fmac_f32 v23, v7, v118
    v_lshlrev_b32 v4, 16, v106
    v_and_b32 v5, s6, v106
    v_fmac_f32 v24, v4, v118
    v_fmac_f32 v25, v5, v118
    v_lshlrev_b32 v6, 16, v107
    v_and_b32 v7, s6, v107
    v_fmac_f32 v26, v6, v118
    v_fmac_f32 v27, v7, v118
    v_lshlrev_b32 v4, 16, v108
    v_and_b32 v5, s6, v108
    v_fmac_f32 v20, v4, v119
    v_fmac_f32 v21, v5, v119
    v_lshlrev_b32 v6, 16, v109
    v_and_b32 v7, s6, v109
    v_fmac_f32 v22, v6, v119
    v_fmac_f32 v23, v7, v119
    v_lshlrev_b32 v4, 16, v110
    v_and_b32 v5, s6, v110
    v_fmac_f32 v24, v4, v119
    v_fmac_f32 v25, v5, v119
    v_lshlrev_b32 v6, 16, v111
    v_and_b32 v7, s6, v111
    v_fmac_f32 v26, v6, v119
    v_fmac_f32 v27, v7, v119
    s_waitcnt vmcnt(9)
    s_barrier
    s_add_u32 s96, s85, 15
    s_and_b32 s97, s96, 15
    s_lshl3_add_u32 s98, s97, s3
    s_mul_i32 s99, s98, 49152
    s_lshl_b32 s96, s11, 7
    s_add_u32 s82, s99, s96
    s_lshr_b32 s96, s3, 1
    s_mul_i32 s97, s96, 2080
    s_and_b32 s98, s3, 1
    s_mul_i32 s99, s98, 1056
    s_add_u32 s96, s97, s99
    s_add_u32 s20, s96, 74880
    s_mov_b32 m0, s20
    s_nop 0
    buffer_load_dwordx4 v62, s[40:43], s82 offen lds
    s_add_u32 s82, s82, 2048
    s_add_u32 m0, s20, 8320
    s_nop 0
    buffer_load_dwordx4 v62, s[40:43], s82 offen lds
    s_add_u32 s82, s82, 2048
    s_add_u32 m0, s20, 16640
    s_nop 0
    buffer_load_dwordx4 v62, s[40:43], s82 offen lds
    s_lshl_b32 s13, s12, 7
    v_and_b32 v4, 31, v1
    v_lshl_add_u32 v4, v4, 2, s13
    global_load_dword v104, v4, s[78:79]
    v_permlane32_swap_b32 v20, v24
    v_permlane32_swap_b32 v21, v25
    v_permlane32_swap_b32 v22, v26
    v_permlane32_swap_b32 v23, v27
    v_add_f32 v20, v20, v24
    v_add_f32 v21, v21, v25
    v_add_f32 v22, v22, v26
    v_add_f32 v23, v23, v27
    s_nop 0
    v_permlane16_swap_b32 v20, v22
    v_permlane16_swap_b32 v21, v23
    v_add_f32 v20, v20, v22
    v_add_f32 v21, v21, v23
    s_nop 0
    v_add_f32_dpp v20, v20, v20 row_ror:8 row_mask:0xf bank_mask:0xf
    v_add_f32_dpp v21, v21, v21 row_ror:8 row_mask:0xf bank_mask:0xf
    s_nop 1
    v_mov_b32_dpp v20, v21 quad_perm:[0,1,2,3] row_mask:0xf bank_mask:0xc
    ds_write_b32 v65, v20 offset:1024
    s_waitcnt lgkmcnt(0)
    s_barrier
    s_waitcnt vmcnt(7)
    s_waitcnt vmcnt(1)
    s_barrier
    s_cmp_lg_u32 s3, 4
    s_cbranch_scc1 L_M2F
    ds_read_b128 v[20:23], v64 offset:1024
    s_bfe_u32 s96, s9, 131074
    s_lshl_b32 s97, s8, 1
    s_lshl4_add_u32 s98, s96, s97
    s_lshr_b32 s99, s9, 4
    s_add_u32 s96, s98, s99
    s_and_b32 s97, s9, 3
    s_lshl2_add_u32 s98, s96, s97
    s_lshl_b32 s99, s98, 9
    s_add_u32 s13, s99, 131072
    s_waitcnt lgkmcnt(0)
    v_add_f32 v20, v20, v21
    v_add_f32 v22, v22, v23
    v_mov_b32 v21, s4
    v_add_f32 v20, v20, v22
    buffer_store_dwordx2 v[20:21], v63, s[32:35], s13 offen sc1
L_M2F:
    s_lshl4_add_u32 s96, s11, s10
    s_lshl_b32 s97, s96, 10
    s_and_b32 s98, s3, 3
    s_lshl_b32 s99, s98, 8
    s_add_u32 s96, s97, s99
    s_add_u32 s13, s96, 29360128
    s_lshl_b32 s96, s11, 7
    s_add_u32 s14, s96, 32768
    v_lshlrev_b32 v60, 7, v1
    s_mov_b64 exec, 3
    buffer_load_dword v60, v60, s[32:35], s13 offen
    buffer_load_dword v61, v3, s[32:35], s14 offen
    s_mov_b64 exec, -1
    s_add_u32 s96, s84, 1114112
    s_and_b32 s97, s96, 1048575
    s_lshl_b32 s98, s83, 16
    s_xor_b32 s99, s97, s98
    s_xor_b32 s96, s88, 1048576
    s_add_u32 s13, s99, s96
    s_add_u32 m0, s89, 102400
    s_nop 0
    buffer_load_dwordx4 v74, s[44:47], s13 offen lds
    s_add_u32 s96, s84, 1179648
    s_and_b32 s97, s96, 1048575
    s_lshl_b32 s98, s83, 16
    s_xor_b32 s99, s97, s98
    s_xor_b32 s96, s88, 1048576
    s_add_u32 s13, s99, s96
    s_add_u32 m0, s89, 106496
    s_nop 0
    buffer_load_dwordx4 v74, s[44:47], s13 offen lds
    s_add_u32 s96, s84, 1245184
    s_and_b32 s97, s96, 1048575
    s_lshl_b32 s98, s83, 16
    s_xor_b32 s99, s97, s98
    s_xor_b32 s96, s88, 1048576
    s_add_u32 s13, s99, s96
    s_add_u32 m0, s89, 110592
    s_nop 0
    buffer_load_dwordx4 v74, s[44:47], s13 offen lds
    s_add_u32 s96, s84, 1310720
    s_and_b32 s97, s96, 1048575
    s_lshl_b32 s98, s83, 16
    s_xor_b32 s99, s97, s98
    s_xor_b32 s96, s88, 1048576
    s_add_u32 s13, s99, s96
    s_add_u32 m0, s89, 114688
    s_nop 0
    buffer_load_dwordx4 v74, s[44:47], s13 offen lds
    s_add_u32 s96, s84, 1376256
    s_and_b32 s97, s96, 1048575
    s_lshl_b32 s98, s83, 16
    s_xor_b32 s99, s97, s98
    s_xor_b32 s96, s88, 1048576
    s_add_u32 s13, s99, s96
    s_add_u32 m0, s89, 118784
    s_nop 0
    buffer_load_dwordx4 v74, s[44:47], s13 offen lds
    s_add_u32 s96, s84, 1441792
    s_and_b32 s97, s96, 1048575
    s_lshl_b32 s98, s83, 16
    s_xor_b32 s99, s97, s98
    s_xor_b32 s96, s88, 1048576
    s_add_u32 s13, s99, s96
    s_add_u32 m0, s89, 122880
    s_nop 0
    buffer_load_dwordx4 v74, s[44:47], s13 offen lds
    s_add_u32 s96, s84, 1507328
    s_and_b32 s97, s96, 1048575
    s_lshl_b32 s98, s83, 16
    s_xor_b32 s99, s97, s98
    s_xor_b32 s96, s88, 1048576
    s_add_u32 s13, s99, s96
    s_add_u32 m0, s89, 126976
    s_nop 0
    buffer_load_dwordx4 v74, s[44:47], s13 offen lds
    s_add_u32 s96, s84, 1572864
    s_and_b32 s97, s96, 1048575
    s_lshl_b32 s98, s83, 16
    s_xor_b32 s99, s97, s98
    s_xor_b32 s96, s88, 1048576
    s_add_u32 s13, s99, s96
    s_add_u32 m0, s89, 131072
    s_nop 0
    buffer_load_dwordx4 v74, s[44:47], s13 offen lds
    s_mov_b32 s13, s80
    buffer_load_dwordx4 v[176:179], v72, s[52:55], s13 offen nt
    s_add_u32 s13, s80, 4294049792
    buffer_load_dwordx4 v[180:183], v72, s[52:55], s13 offen nt
    s_lshl_b32 s96, s90, 7
    s_add_u32 s13, s96, s80
    buffer_load_dwordx4 v[184:187], v72, s[56:59], s13 offen nt
    s_lshl_b32 s96, s90, 7
    s_add_u32 s97, s96, s80
    s_add_u32 s13, s97, 4294049792
    buffer_load_dwordx4 v[188:191], v72, s[56:59], s13 offen nt
    s_add_u32 s13, s80, 57344
    buffer_load_dwordx4 v[192:195], v72, s[52:55], s13 offen nt
    s_add_u32 s13, s80, 4294107136
    buffer_load_dwordx4 v[196:199], v72, s[52:55], s13 offen nt
    s_lshl_b32 s96, s90, 7
    s_add_u32 s97, s96, s80
    s_add_u32 s13, s97, 57344
    buffer_load_dwordx4 v[200:203], v72, s[56:59], s13 offen nt
    s_lshl_b32 s96, s90, 7
    s_add_u32 s97, s96, s80
    s_add_u32 s13, s97, 4294107136
    buffer_load_dwordx4 v[204:207], v72, s[56:59], s13 offen nt
    s_waitcnt lgkmcnt(0)
    s_barrier
    ds_read_b128 v[36:39], v76
    ds_read_b128 v[40:43], v76 offset:1024
    s_waitcnt lgkmcnt(0)
    v_mfma_f32_32x32x16_bf16 v[112:127], v[28:31], v[36:39], 0
    v_mfma_f32_32x32x16_bf16 v[112:127], v[32:35], v[40:43], v[112:127]
    s_add_u32 s13, s80, 114688
    buffer_load_dwordx4 v[208:211], v72, s[52:55], s13 offen nt
    s_add_u32 s13, s80, 4294164480
    buffer_load_dwordx4 v[212:215], v72, s[52:55], s13 offen nt
    s_lshl_b32 s96, s90, 7
    s_add_u32 s97, s96, s80
    s_add_u32 s13, s97, 114688
    buffer_load_dwordx4 v[216:219], v72, s[56:59], s13 offen nt
    s_lshl_b32 s96, s90, 7
    s_add_u32 s97, s96, s80
    s_add_u32 s13, s97, 4294164480
    buffer_load_dwordx4 v[220:223], v72, s[56:59], s13 offen nt
L_JOIN:
    v_cvt_pk_bf16_f32 v112, 0, v112
    v_cvt_pk_bf16_f32 v113, 0, v113
    v_cvt_pk_bf16_f32 v114, 0, v114
    v_cvt_pk_bf16_f32 v115, 0, v115
    v_cvt_pk_bf16_f32 v116, 0, v116
    v_cvt_pk_bf16_f32 v117, 0, v117
    v_cvt_pk_bf16_f32 v118, 0, v118
    v_cvt_pk_bf16_f32 v119, 0, v119
    v_cvt_pk_bf16_f32 v120, 0, v120
    v_cvt_pk_bf16_f32 v121, 0, v121
    v_cvt_pk_bf16_f32 v122, 0, v122
    v_cvt_pk_bf16_f32 v123, 0, v123
    v_cvt_pk_bf16_f32 v124, 0, v124
    v_cvt_pk_bf16_f32 v125, 0, v125
    v_cvt_pk_bf16_f32 v126, 0, v126
    v_cvt_pk_bf16_f32 v127, 0, v127
    v_max3_f32 v4, v112, v113, v114
    v_min3_f32 v5, v112, v113, v114
    v_max3_f32 v4, v4, v115, v116
    v_min3_f32 v5, v5, v115, v116
    v_max3_f32 v4, v4, v117, v118
    v_min3_f32 v5, v5, v117, v118
    v_max3_f32 v4, v4, v119, v120
    v_min3_f32 v5, v5, v119, v120
    v_max3_f32 v4, v4, v121, v122
    v_min3_f32 v5, v5, v121, v122
    v_max3_f32 v4, v4, v123, v124
    v_min3_f32 v5, v5, v123, v124
    v_max3_f32 v4, v4, v125, v126
    v_min3_f32 v5, v5, v125, v126
    v_max_f32 v6, v4, v127
    v_min_f32 v7, v5, v127
    v_max_f32 v4, v4, v127
    v_min_f32 v5, v5, v127
    s_nop 0
    v_permlane32_swap_b32 v4, v6
    v_permlane32_swap_b32 v5, v7
    v_max_f32 v4, v4, v6
    v_min_f32 v5, v5, v7
    v_pk_mul_f32 v[4:5], v[4:5], s[6:7] op_sel:[0,1]
    v_pk_fma_f32 v[128:129], v[112:113], s[6:7], v[4:5] op_sel:[0,1,0] op_sel_hi:[1,1,0] neg_lo:[0,0,1] neg_hi:[0,0,1]
    v_pk_fma_f32 v[112:113], v[112:113], s[6:7], v[4:5] op_sel:[0,1,1] neg_lo:[1,0,0] neg_hi:[1,0,0]
    v_pk_fma_f32 v[130:131], v[114:115], s[6:7], v[4:5] op_sel:[0,1,0] op_sel_hi:[1,1,0] neg_lo:[0,0,1] neg_hi:[0,0,1]
    v_pk_fma_f32 v[114:115], v[114:115], s[6:7], v[4:5] op_sel:[0,1,1] neg_lo:[1,0,0] neg_hi:[1,0,0]
    v_pk_fma_f32 v[132:133], v[116:117], s[6:7], v[4:5] op_sel:[0,1,0] op_sel_hi:[1,1,0] neg_lo:[0,0,1] neg_hi:[0,0,1]
    v_pk_fma_f32 v[116:117], v[116:117], s[6:7], v[4:5] op_sel:[0,1,1] neg_lo:[1,0,0] neg_hi:[1,0,0]
    v_pk_fma_f32 v[134:135], v[118:119], s[6:7], v[4:5] op_sel:[0,1,0] op_sel_hi:[1,1,0] neg_lo:[0,0,1] neg_hi:[0,0,1]
    v_pk_fma_f32 v[118:119], v[118:119], s[6:7], v[4:5] op_sel:[0,1,1] neg_lo:[1,0,0] neg_hi:[1,0,0]
    v_pk_fma_f32 v[136:137], v[120:121], s[6:7], v[4:5] op_sel:[0,1,0] op_sel_hi:[1,1,0] neg_lo:[0,0,1] neg_hi:[0,0,1]
    v_pk_fma_f32 v[120:121], v[120:121], s[6:7], v[4:5] op_sel:[0,1,1] neg_lo:[1,0,0] neg_hi:[1,0,0]
    v_pk_fma_f32 v[138:139], v[122:123], s[6:7], v[4:5] op_sel:[0,1,0] op_sel_hi:[1,1,0] neg_lo:[0,0,1] neg_hi:[0,0,1]
    v_pk_fma_f32 v[122:123], v[122:123], s[6:7], v[4:5] op_sel:[0,1,1] neg_lo:[1,0,0] neg_hi:[1,0,0]
    v_pk_fma_f32 v[140:141], v[124:125], s[6:7], v[4:5] op_sel:[0,1,0] op_sel_hi:[1,1,0] neg_lo:[0,0,1] neg_hi:[0,0,1]
    v_pk_fma_f32 v[124:125], v[124:125], s[6:7], v[4:5] op_sel:[0,1,1] neg_lo:[1,0,0] neg_hi:[1,0,0]
    v_pk_fma_f32 v[142:143], v[126:127], s[6:7], v[4:5] op_sel:[0,1,0] op_sel_hi:[1,1,0] neg_lo:[0,0,1] neg_hi:[0,0,1]
    v_pk_fma_f32 v[126:127], v[126:127], s[6:7], v[4:5] op_sel:[0,1,1] neg_lo:[1,0,0] neg_hi:[1,0,0]
    v_exp_f32 v128, v128
    v_exp_f32 v112, v112
    v_exp_f32 v129, v129
    v_exp_f32 v113, v113
    v_exp_f32 v130, v130
    v_exp_f32 v114, v114
    v_exp_f32 v131, v131
    v_exp_f32 v115, v115
    v_exp_f32 v132, v132
    v_exp_f32 v116, v116
    v_exp_f32 v133, v133
    v_exp_f32 v117, v117
    v_exp_f32 v134, v134
    v_exp_f32 v118, v118
    v_exp_f32 v135, v135
    v_exp_f32 v119, v119
    v_exp_f32 v136, v136
    v_exp_f32 v120, v120
    v_exp_f32 v137, v137
    v_exp_f32 v121, v121
    v_exp_f32 v138, v138
    v_exp_f32 v122, v122
    v_exp_f32 v139, v139
    v_exp_f32 v123, v123
    v_exp_f32 v140, v140
    v_exp_f32 v124, v124
    v_exp_f32 v141, v141
    v_exp_f32 v125, v125
    v_exp_f32 v142, v142
    v_exp_f32 v126, v126
    v_exp_f32 v143, v143
    v_exp_f32 v127, v127
    v_pk_add_f32 v[8:9], v[128:129], v[130:131]
    v_pk_add_f32 v[10:11], v[112:113], v[114:115]
    v_pk_add_f32 v[8:9], v[8:9], v[132:133]
    v_pk_add_f32 v[10:11], v[10:11], v[116:117]
    v_pk_add_f32 v[8:9], v[8:9], v[134:135]
    v_pk_add_f32 v[10:11], v[10:11], v[118:119]
    v_pk_add_f32 v[8:9], v[8:9], v[136:137]
    v_pk_add_f32 v[10:11], v[10:11], v[120:121]
    v_pk_add_f32 v[8:9], v[8:9], v[138:139]
    v_pk_add_f32 v[10:11], v[10:11], v[122:123]
    v_pk_add_f32 v[8:9], v[8:9], v[140:141]
    v_pk_add_f32 v[10:11], v[10:11], v[124:125]
    v_pk_add_f32 v[8:9], v[8:9], v[142:143]
    v_pk_add_f32 v[10:11], v[10:11], v[126:127]
    v_add_f32 v6, v8, v9
    v_add_f32 v7, v10, v11
    v_add_f32 v4, v8, v9
    v_add_f32 v5, v10, v11
    s_nop 0
    v_permlane32_swap_b32 v4, v6
    v_permlane32_swap_b32 v5, v7
    v_pk_add_f32 v[4:5], v[4:5], v[6:7]
    v_rcp_f32 v4, v4
    v_rcp_f32 v5, v5
    s_nop 0
    v_pk_mul_f32 v[128:129], v[128:129], v[4:5] op_sel_hi:[1,0]
    v_pk_mul_f32 v[112:113], v[112:113], v[4:5] op_sel:[0,1]
    v_pk_mul_f32 v[130:131], v[130:131], v[4:5] op_sel_hi:[1,0]
    v_pk_mul_f32 v[114:115], v[114:115], v[4:5] op_sel:[0,1]
    v_pk_mul_f32 v[132:133], v[132:133], v[4:5] op_sel_hi:[1,0]
    v_pk_mul_f32 v[116:117], v[116:117], v[4:5] op_sel:[0,1]
    v_pk_mul_f32 v[134:135], v[134:135], v[4:5] op_sel_hi:[1,0]
    v_pk_mul_f32 v[118:119], v[118:119], v[4:5] op_sel:[0,1]
    v_pk_mul_f32 v[136:137], v[136:137], v[4:5] op_sel_hi:[1,0]
    v_pk_mul_f32 v[120:121], v[120:121], v[4:5] op_sel:[0,1]
    v_pk_mul_f32 v[138:139], v[138:139], v[4:5] op_sel_hi:[1,0]
    v_pk_mul_f32 v[122:123], v[122:123], v[4:5] op_sel:[0,1]
    v_pk_mul_f32 v[140:141], v[140:141], v[4:5] op_sel_hi:[1,0]
    v_pk_mul_f32 v[124:125], v[124:125], v[4:5] op_sel:[0,1]
    v_pk_mul_f32 v[142:143], v[142:143], v[4:5] op_sel_hi:[1,0]
    v_pk_mul_f32 v[126:127], v[126:127], v[4:5] op_sel:[0,1]
    v_cvt_pk_bf16_f32 v80, v128, v129
    v_cvt_pk_bf16_f32 v88, v112, v113
    v_cvt_pk_bf16_f32 v81, v130, v131
    v_cvt_pk_bf16_f32 v89, v114, v115
    v_cvt_pk_bf16_f32 v82, v132, v133
    v_cvt_pk_bf16_f32 v90, v116, v117
    v_cvt_pk_bf16_f32 v83, v134, v135
    v_cvt_pk_bf16_f32 v91, v118, v119
    v_cvt_pk_bf16_f32 v84, v136, v137
    v_cvt_pk_bf16_f32 v92, v120, v121
    v_cvt_pk_bf16_f32 v85, v138, v139
    v_cvt_pk_bf16_f32 v93, v122, v123
    v_cvt_pk_bf16_f32 v86, v140, v141
    v_cvt_pk_bf16_f32 v94, v124, v125
    v_cvt_pk_bf16_f32 v87, v142, v143
    v_cvt_pk_bf16_f32 v95, v126, v127
    ds_write_b128 v75, v[80:83]
    ds_write_b128 v75, v[84:87] offset:4096
    ds_write_b128 v75, v[88:91] offset:8192
    ds_write_b128 v75, v[92:95] offset:12288
    s_lshl_b32 s13, s3, 12
    v_add_u32 v20, s13, v63
    s_lshl_b32 s96, s76, 13
    s_add_u32 s13, s96, 32768
    v_add_u32 v21, s13, v63
    v_mov_b32 v36, 0x3f803f80
    v_mov_b32 v37, 0x3f803f80
    v_mov_b32 v38, 0x3f803f80
    v_mov_b32 v39, 0x3f803f80
    s_lshl3_add_u32 s96, s11, s3
    s_lshl_b32 s97, s96, 5
    s_add_u32 s98, s97, s10
    s_lshl_b32 s99, s98, 10
    s_add_u32 s13, s99, 25165824
    s_add_u32 s15, s13, 16384
    s_lshl3_add_u32 s96, s11, s3
    s_lshl_b32 s97, s96, 10
    s_add_u32 s16, s97, 21495808
    s_lshl_b32 s96, s10, 6
    s_add_u32 s14, s96, s16
    s_waitcnt lgkmcnt(0)
    s_barrier
    ds_read_b64_tr_b16 v[128:129], v20
    ds_read_b64_tr_b16 v[130:131], v20 offset:512
    ds_read_b64_tr_b16 v[144:145], v21
    ds_read_b64_tr_b16 v[146:147], v21 offset:512
    ds_read_b64_tr_b16 v[148:149], v21 offset:4096
    ds_read_b64_tr_b16 v[150:151], v21 offset:4608
    ds_read_b64_tr_b16 v[132:133], v20 offset:1024
    ds_read_b64_tr_b16 v[134:135], v20 offset:1536
    ds_read_b64_tr_b16 v[152:153], v21 offset:1024
    ds_read_b64_tr_b16 v[154:155], v21 offset:1536
    ds_read_b64_tr_b16 v[156:157], v21 offset:5120
    ds_read_b64_tr_b16 v[158:159], v21 offset:5632
    ds_read_b64_tr_b16 v[136:137], v20 offset:2048
    ds_read_b64_tr_b16 v[138:139], v20 offset:2560
    ds_read_b64_tr_b16 v[160:161], v21 offset:2048
    ds_read_b64_tr_b16 v[162:163], v21 offset:2560
    ds_read_b64_tr_b16 v[164:165], v21 offset:6144
    ds_read_b64_tr_b16 v[166:167], v21 offset:6656
    s_waitcnt lgkmcnt(12)
    v_mfma_f32_16x16x32_bf16 v[52:55], v[128:131], v[144:147], 0
    v_mfma_f32_16x16x32_bf16 v[56:59], v[128:131], v[148:151], 0
    v_mfma_f32_16x16x32_bf16 v[40:43], v[128:131], v[36:39], 0
    ds_read_b64_tr_b16 v[140:141], v20 offset:3072
    ds_read_b64_tr_b16 v[142:143], v20 offset:3584
    ds_read_b64_tr_b16 v[168:169], v21 offset:3072
    ds_read_b64_tr_b16 v[170:171], v21 offset:3584
    ds_read_b64_tr_b16 v[172:173], v21 offset:7168
    ds_read_b64_tr_b16 v[174:175], v21 offset:7680
    s_waitcnt lgkmcnt(12)
    v_mfma_f32_16x16x32_bf16 v[52:55], v[132:135], v[152:155], v[52:55]
    v_mfma_f32_16x16x32_bf16 v[56:59], v[132:135], v[156:159], v[56:59]
    v_mfma_f32_16x16x32_bf16 v[40:43], v[132:135], v[36:39], v[40:43]
    v_and_b32 v75, 15, v1
    v_lshlrev_b32 v75, 15, v75
    s_and_b32 s96, s10, 1
    s_and_b32 s97, s2, 135
    s_lshl_b32 s98, s97, 12
    s_lshr_b32 s99, s10, 1
    s_lshl_b32 s97, s99, 6
    s_add_u32 s99, s98, s97
    s_lshl2_add_u32 s98, s96, s99
    s_add_u32 s97, s98, 1048576
    s_add_u32 s17, s97, 512
    s_waitcnt lgkmcnt(6)
    v_mfma_f32_16x16x32_bf16 v[52:55], v[136:139], v[160:163], v[52:55]
    v_mfma_f32_16x16x32_bf16 v[56:59], v[136:139], v[164:167], v[56:59]
    v_mfma_f32_16x16x32_bf16 v[40:43], v[136:139], v[36:39], v[40:43]
    s_waitcnt lgkmcnt(0)
    v_mfma_f32_16x16x32_bf16 v[52:55], v[140:143], v[168:171], v[52:55]
    v_mfma_f32_16x16x32_bf16 v[56:59], v[140:143], v[172:175], v[56:59]
    v_mfma_f32_16x16x32_bf16 v[40:43], v[140:143], v[36:39], v[40:43]
    s_cmp_lt_u32 s3, 4
    s_cbranch_scc1 L_NOQX
    ds_read_b128 v[44:47], v76 offset:2048
    ds_read_b128 v[48:51], v76 offset:3072
L_NOQX:
    s_nop 3
    buffer_store_dwordx4 v[52:55], v2, s[32:35], s13 offen sc1
    buffer_store_dwordx4 v[56:59], v2, s[32:35], s15 offen sc1
    s_mov_b32 exec_lo, 0x00010001
    s_mov_b32 exec_hi, 0x00010001
    buffer_store_dwordx4 v[40:43], v1, s[32:35], s14 offen sc1
    s_mov_b64 exec, -1
    s_waitcnt lgkmcnt(0)
    v_mfma_f32_32x32x16_bf16 v[112:127], v[28:31], v[44:47], 0
    v_mfma_f32_32x32x16_bf16 v[112:127], v[32:35], v[48:51], v[112:127]
    v_lshrrev_b32 v22, 3, v1
    v_lshlrev_b32 v22, 10, v22
    v_and_b32 v9, 7, v1
    v_lshl_add_u32 v22, v9, 4, v22
    s_nop 7
    v_cvt_pk_bf16_f32 v112, 0, v112
    v_cvt_pk_bf16_f32 v113, 0, v113
    v_cvt_pk_bf16_f32 v114, 0, v114
    v_cvt_pk_bf16_f32 v115, 0, v115
    v_cvt_pk_bf16_f32 v116, 0, v116
    v_cvt_pk_bf16_f32 v117, 0, v117
    v_cvt_pk_bf16_f32 v118, 0, v118
    v_cvt_pk_bf16_f32 v119, 0, v119
    v_cvt_pk_bf16_f32 v120, 0, v120
    v_cvt_pk_bf16_f32 v121, 0, v121
    v_cvt_pk_bf16_f32 v122, 0, v122
    v_cvt_pk_bf16_f32 v123, 0, v123
    v_cvt_pk_bf16_f32 v124, 0, v124
    v_cvt_pk_bf16_f32 v125, 0, v125
    v_cvt_pk_bf16_f32 v126, 0, v126
    v_cvt_pk_bf16_f32 v127, 0, v127
    v_max3_f32 v52, v112, v113, v114
    v_min3_f32 v53, v112, v113, v114
    v_max3_f32 v52, v52, v115, v116
    v_min3_f32 v53, v53, v115, v116
    v_max3_f32 v52, v52, v117, v118
    v_min3_f32 v53, v53, v117, v118
    v_max3_f32 v52, v52, v119, v120
    v_min3_f32 v53, v53, v119, v120
    v_max3_f32 v52, v52, v121, v122
    v_min3_f32 v53, v53, v121, v122
    v_max3_f32 v52, v52, v123, v124
    v_min3_f32 v53, v53, v123, v124
    v_max3_f32 v52, v52, v125, v126
    v_min3_f32 v53, v53, v125, v126
    v_max_f32 v54, v52, v127
    v_min_f32 v55, v53, v127
    v_max_f32 v52, v52, v127
    v_min_f32 v53, v53, v127
    s_nop 0
    v_permlane32_swap_b32 v52, v54
    v_permlane32_swap_b32 v53, v55
    v_max_f32 v52, v52, v54
    v_min_f32 v53, v53, v55
    v_pk_mul_f32 v[52:53], v[52:53], s[6:7] op_sel:[0,1]
    v_pk_fma_f32 v[128:129], v[112:113], s[6:7], v[52:53] op_sel:[0,1,0] op_sel_hi:[1,1,0] neg_lo:[0,0,1] neg_hi:[0,0,1]
    v_pk_fma_f32 v[112:113], v[112:113], s[6:7], v[52:53] op_sel:[0,1,1] neg_lo:[1,0,0] neg_hi:[1,0,0]
    v_pk_fma_f32 v[130:131], v[114:115], s[6:7], v[52:53] op_sel:[0,1,0] op_sel_hi:[1,1,0] neg_lo:[0,0,1] neg_hi:[0,0,1]
    v_pk_fma_f32 v[114:115], v[114:115], s[6:7], v[52:53] op_sel:[0,1,1] neg_lo:[1,0,0] neg_hi:[1,0,0]
    v_pk_fma_f32 v[132:133], v[116:117], s[6:7], v[52:53] op_sel:[0,1,0] op_sel_hi:[1,1,0] neg_lo:[0,0,1] neg_hi:[0,0,1]
    v_pk_fma_f32 v[116:117], v[116:117], s[6:7], v[52:53] op_sel:[0,1,1] neg_lo:[1,0,0] neg_hi:[1,0,0]
    v_pk_fma_f32 v[134:135], v[118:119], s[6:7], v[52:53] op_sel:[0,1,0] op_sel_hi:[1,1,0] neg_lo:[0,0,1] neg_hi:[0,0,1]
    v_pk_fma_f32 v[118:119], v[118:119], s[6:7], v[52:53] op_sel:[0,1,1] neg_lo:[1,0,0] neg_hi:[1,0,0]
    v_pk_fma_f32 v[136:137], v[120:121], s[6:7], v[52:53] op_sel:[0,1,0] op_sel_hi:[1,1,0] neg_lo:[0,0,1] neg_hi:[0,0,1]
    v_pk_fma_f32 v[120:121], v[120:121], s[6:7], v[52:53] op_sel:[0,1,1] neg_lo:[1,0,0] neg_hi:[1,0,0]
    v_pk_fma_f32 v[138:139], v[122:123], s[6:7], v[52:53] op_sel:[0,1,0] op_sel_hi:[1,1,0] neg_lo:[0,0,1] neg_hi:[0,0,1]
    v_pk_fma_f32 v[122:123], v[122:123], s[6:7], v[52:53] op_sel:[0,1,1] neg_lo:[1,0,0] neg_hi:[1,0,0]
    v_pk_fma_f32 v[140:141], v[124:125], s[6:7], v[52:53] op_sel:[0,1,0] op_sel_hi:[1,1,0] neg_lo:[0,0,1] neg_hi:[0,0,1]
    v_pk_fma_f32 v[124:125], v[124:125], s[6:7], v[52:53] op_sel:[0,1,1] neg_lo:[1,0,0] neg_hi:[1,0,0]
    v_pk_fma_f32 v[142:143], v[126:127], s[6:7], v[52:53] op_sel:[0,1,0] op_sel_hi:[1,1,0] neg_lo:[0,0,1] neg_hi:[0,0,1]
    v_pk_fma_f32 v[126:127], v[126:127], s[6:7], v[52:53] op_sel:[0,1,1] neg_lo:[1,0,0] neg_hi:[1,0,0]
    v_exp_f32 v128, v128
    v_exp_f32 v112, v112
    v_exp_f32 v129, v129
    s_lshl_b32 s96, s11, 7
    s_add_u32 s18, s96, 32768
    s_lshl3_add_u32 s14, s10, s18
    v_and_b32 v23, 15, v1
    v_lshlrev_b32 v23, 3, v23
    s_waitcnt vmcnt(0)
    s_barrier
    s_cmp_lg_u32 s3, 0
    s_cbranch_scc1 L_PC
    v_mov_b32 v21, s4
    s_mov_b32 exec_hi, 0
    s_mov_b32 exec_lo, 65535
    buffer_store_dword v21, v75, s[32:35], s17 offen sc1
    s_mov_b64 exec, -1
L_PC:
    s_cmp_lt_u32 s3, 4
    s_cbranch_scc1 L_NOM
    v_and_b32 v105, 31, v1
    v_lshlrev_b32 v105, 4, v105
    v_lshrrev_b32 v9, 5, v1
    v_lshl_add_u32 v105, v9, 9, v105
    s_and_b32 s96, s3, 3
    s_lshl4_add_u32 s97, s96, s12
    s_lshl_b32 s98, s97, 11
    s_add_u32 s20, s98, 131072
    buffer_load_dwordx4 v[96:99], v105, s[32:35], s20 offen sc1
    buffer_load_dwordx4 v[100:103], v105, s[32:35], s20 offen offset:1024 sc1
L_NOM:
    s_lshl4_add_u32 s96, s11, s10
    s_lshl_b32 s97, s96, 14
    s_lshl_b32 s98, s3, 7
    s_add_u32 s99, s97, s98
    s_add_u32 s13, s99, 25165824
    s_lshl4_add_u32 s96, s11, s10
    s_lshl_b32 s97, s96, 10
    s_lshl_b32 s98, s3, 7
    s_add_u32 s99, s97, s98
    s_add_u32 s15, s99, 29360128
    s_add_u32 s17, s17, 3072
    s_load_dwordx2 s[24:25], s[32:33], s92 offset:512 glc
    s_add_u32 s96, s84, 262144
    s_and_b32 s97, s96, 1048575
    s_lshl_b32 s98, s83, 16
    s_xor_b32 s99, s97, s98
    s_add_u32 s19, s99, s88
    s_add_u32 m0, s89, 49152
    s_nop 0
    buffer_load_dwordx4 v74, s[44:47], s19 offen lds
    v_exp_f32 v113, v113
    v_exp_f32 v130, v130
    v_exp_f32 v114, v114
    v_exp_f32 v131, v131
    v_exp_f32 v115, v115
    v_exp_f32 v132, v132
    v_exp_f32 v116, v116
    v_exp_f32 v133, v133
    v_exp_f32 v117, v117
    v_exp_f32 v134, v134
    s_add_u32 s96, s84, 393216
    s_and_b32 s97, s96, 1048575
    s_lshl_b32 s98, s83, 16
    s_xor_b32 s99, s97, s98
    s_add_u32 s19, s99, s88
    s_add_u32 m0, s89, 57344
    s_nop 0
    buffer_load_dwordx4 v74, s[44:47], s19 offen lds
    v_exp_f32 v118, v118
    v_exp_f32 v135, v135
    v_exp_f32 v119, v119
    v_exp_f32 v136, v136
    v_exp_f32 v120, v120
    v_exp_f32 v137, v137
    v_exp_f32 v121, v121
    v_exp_f32 v138, v138
    v_exp_f32 v122, v122
    s_add_u32 s96, s84, 524288
    s_and_b32 s97, s96, 1048575
    s_lshl_b32 s98, s83, 16
    s_xor_b32 s99, s97, s98
    s_add_u32 s19, s99, s88
    s_add_u32 m0, s89, 65536
    s_nop 0
    buffer_load_dwordx4 v74, s[44:47], s19 offen lds
    v_exp_f32 v139, v139
    v_exp_f32 v123, v123
    v_exp_f32 v140, v140
    v_exp_f32 v124, v124
    v_exp_f32 v141, v141
    v_exp_f32 v125, v125
    v_exp_f32 v142, v142
    v_exp_f32 v126, v126
    v_exp_f32 v143, v143
    v_exp_f32 v127, v127
    s_add_u32 s96, s84, 655360
    s_and_b32 s97, s96, 1048575
    s_lshl_b32 s98, s83, 16
    s_xor_b32 s99, s97, s98
    s_add_u32 s19, s99, s88
    s_add_u32 m0, s89, 73728
    s_nop 0
    buffer_load_dwordx4 v74, s[44:47], s19 offen lds
    v_pk_add_f32 v[56:57], v[128:129], v[130:131]
    v_pk_add_f32 v[58:59], v[112:113], v[114:115]
    v_pk_add_f32 v[56:57], v[56:57], v[132:133]
    v_pk_add_f32 v[58:59], v[58:59], v[116:117]
    v_pk_add_f32 v[56:57], v[56:57], v[134:135]
    v_pk_add_f32 v[58:59], v[58:59], v[118:119]
    v_pk_add_f32 v[56:57], v[56:57], v[136:137]
    v_pk_add_f32 v[58:59], v[58:59], v[120:121]
    v_pk_add_f32 v[56:57], v[56:57], v[138:139]
    s_add_u32 s96, s84, 786432
    s_and_b32 s97, s96, 1048575
    s_lshl_b32 s98, s83, 16
    s_xor_b32 s99, s97, s98
    s_add_u32 s19, s99, s88
    s_add_u32 m0, s89, 81920
    s_nop 0
    buffer_load_dwordx4 v74, s[44:47], s19 offen lds
    v_pk_add_f32 v[58:59], v[58:59], v[122:123]
    v_pk_add_f32 v[56:57], v[56:57], v[140:141]
    v_pk_add_f32 v[58:59], v[58:59], v[124:125]
    v_pk_add_f32 v[56:57], v[56:57], v[142:143]
    v_pk_add_f32 v[58:59], v[58:59], v[126:127]
    v_add_f32 v54, v56, v57
    v_add_f32 v55, v58, v59
    v_add_f32 v52, v56, v57
    v_add_f32 v53, v58, v59
    s_nop 0
    v_permlane32_swap_b32 v52, v54
    s_add_u32 s96, s84, 917504
    s_and_b32 s97, s96, 1048575
    s_lshl_b32 s98, s83, 16
    s_xor_b32 s99, s97, s98
    s_add_u32 s19, s99, s88
    s_add_u32 m0, s89, 90112
    s_nop 0
    buffer_load_dwordx4 v74, s[44:47], s19 offen lds
    v_permlane32_swap_b32 v53, v55
    v_pk_add_f32 v[52:53], v[52:53], v[54:55]
    v_rcp_f32 v52, v52
    v_rcp_f32 v53, v53
    s_nop 0
    v_pk_mul_f32 v[128:129], v[128:129], v[52:53] op_sel_hi:[1,0]
    v_pk_mul_f32 v[112:113], v[112:113], v[52:53] op_sel:[0,1]
    v_pk_mul_f32 v[130:131], v[130:131], v[52:53] op_sel_hi:[1,0]
    v_pk_mul_f32 v[114:115], v[114:115], v[52:53] op_sel:[0,1]
    v_pk_mul_f32 v[132:133], v[132:133], v[52:53] op_sel_hi:[1,0]
    s_cmp_lt_u32 s3, 4
    s_cbranch_scc1 L_NOG
    s_waitcnt vmcnt(6)
    v_bitop3_b32 v4, v97, v99, s4 bitop3:0x7e
    v_bitop3_b32 v4, v4, v101, s4 bitop3:0xf6
    v_bitop3_b32 v4, v4, v103, s4 bitop3:0xf6
    v_cmp_ne_u32 vcc, 0, v4
    s_cbranch_vccz TOK_17
POLL_18:
    buffer_load_dwordx4 v[96:99], v105, s[32:35], s20 offen sc1
    buffer_load_dwordx4 v[100:103], v105, s[32:35], s20 offen offset:1024 sc1
    s_waitcnt vmcnt(0)
    v_bitop3_b32 v4, v97, v99, s4 bitop3:0x7e
    v_bitop3_b32 v4, v4, v101, s4 bitop3:0xf6
    v_bitop3_b32 v4, v4, v103, s4 bitop3:0xf6
    v_cmp_ne_u32 vcc, 0, v4
    s_cbranch_vccz PDONE_19
    s_add_u32 s5, s5, 1
    s_cmp_lt_u32 s5, 300000
    s_cbranch_scc1 POLL_18
PDONE_19:
TOK_17:
    s_and_b32 s96, s3, 3
    s_lshl_b32 s97, s96, 7
    s_add_u32 s14, s97, 12288
    v_and_b32 v4, 31, v1
    v_lshl_add_u32 v4, v4, 2, s14
    s_and_b32 s82, s3, 3
    v_add_f32 v96, v96, v100
    v_add_f32 v97, v98, v102
    v_mov_b32 v98, v96
    v_mov_b32 v99, v97
    s_cmp_eq_u32 s82, 2
    s_cselect_b32 s91, 1.0, 0
    v_permlane32_swap_b32 v96, v98
    v_permlane32_swap_b32 v97, v99
    v_pk_add_f32 v[96:97], v[96:97], v[98:99]
    v_cvt_pk_bf16_f32 v96, 0, v96
    v_cvt_pk_bf16_f32 v97, 0, v97
    v_add_f32 v96, s91, v96
    v_add_f32 v97, s91, v97
    v_cvt_pk_bf16_f32 v98, v96, v97
    ds_write_b32 v4, v98
    s_cbranch_scc0 L_NOG
    v_lshlrev_b32 v96, 16, v98
    v_and_b32 v97, s6, v98
    v_lshlrev_b32 v100, 16, v104
    v_and_b32 v101, s6, v104
    v_pk_mul_f32 v[100:101], v[100:101], v[96:97]
    v_cvt_pk_bf16_f32 v102, v100, v101
    v_lshlrev_b32 v96, 16, v102
    v_and_b32 v97, s6, v102
    v_pk_add_f32 v[96:97], v[100:101], v[96:97] neg_lo:[0,1] neg_hi:[0,1]
    v_cvt_pk_bf16_f32 v103, v96, v97
    v_add_f32 v96, v100, v101
    ds_write2_b32 v4, v102, v103 offset0:64 offset1:96
    ds_write_b32 v4, v104 offset:512
    v_add_f32_dpp v96, v96, v96 quad_perm:[1,0,3,2] row_mask:0xf bank_mask:0xf
    s_nop 1
    v_add_f32_dpp v96, v96, v96 quad_perm:[2,3,0,1] row_mask:0xf bank_mask:0xf
    s_nop 1
    v_add_f32_dpp v96, v96, v96 row_half_mirror row_mask:0xf bank_mask:0xf
    s_nop 1
    v_add_f32_dpp v96, v96, v96 row_ror:8 row_mask:0xf bank_mask:0xf
    s_lshl4_add_u32 s96, s21, s12
    s_lshl3_add_u32 s14, s96, 65536
    v_mov_b32 v98, v96
    v_mov_b32 v97, s4
    s_nop 0
    v_permlane16_swap_b32 v96, v98
    v_add_f32 v96, v96, v98
    s_mov_b64 exec, 1
    buffer_store_dwordx2 v[96:97], v3, s[32:35], s14 offen sc1
    s_mov_b64 exec, -1
L_NOG:
    s_branch SCHK_15
SPOLL_14:
    s_load_dwordx2 s[24:25], s[32:33], s92 offset:512 glc
SCHK_15:
    s_add_u32 s5, s5, 1
    s_cmp_ge_u32 s5, 300000
    s_waitcnt lgkmcnt(0)
    s_cbranch_scc1 SDONE_16
    s_cmp_lg_u32 s24, s4
    s_cbranch_scc1 SPOLL_14
    s_cmp_lg_u32 s25, s4
    s_cbranch_scc1 SPOLL_14
SDONE_16:
    s_barrier
    s_add_u32 s18, s13, 8192
    buffer_load_dword v24, v3, s[32:35], 0 offen offset:256 sc1
    buffer_load_dwordx4 v[144:147], v22, s[32:35], s13 offen sc1
    buffer_load_dwordx4 v[148:151], v22, s[32:35], s18 offen sc1
    buffer_load_dwordx4 v[160:163], v2, s[32:35], s16 offen sc1
    s_lshl_b32 s96, s3, 5
    s_add_u32 s14, s96, 8192
    v_and_b32 v6, 3, v1
    v_lshl_add_u32 v6, v6, 3, s14
    v_lshrrev_b32 v9, 5, v1
    v_lshl_add_u32 v6, v9, 2, v6
    s_lshl_b32 s14, s3, 10
    v_and_b32 v5, 15, v1
    v_lshl_add_u32 v5, v5, 4, s14
    v_lshrrev_b32 v9, 5, v1
    v_lshl_add_u32 v5, v9, 9, v5
    v_bfe_u32 v9, v1, 4, 1
    v_lshl_add_u32 v5, v9, 3, v5
    s_lshl_b32 s96, s76, 7
    s_add_u32 s14, s96, 8192
    v_lshrrev_b32 v7, 5, v1
    v_lshl_add_u32 v7, v7, 4, s14
    s_lshl_b32 s14, s76, 12
    v_add_u32 v20, s14, v2
    v_pk_mul_f32 v[116:117], v[116:117], v[52:53] op_sel:[0,1]
    v_pk_mul_f32 v[134:135], v[134:135], v[52:53] op_sel_hi:[1,0]
    v_pk_mul_f32 v[118:119], v[118:119], v[52:53] op_sel:[0,1]
    v_pk_mul_f32 v[136:137], v[136:137], v[52:53] op_sel_hi:[1,0]
    v_pk_mul_f32 v[120:121], v[120:121], v[52:53] op_sel:[0,1]
    v_pk_mul_f32 v[138:139], v[138:139], v[52:53] op_sel_hi:[1,0]
    v_pk_mul_f32 v[122:123], v[122:123], v[52:53] op_sel:[0,1]
    v_pk_mul_f32 v[140:141], v[140:141], v[52:53] op_sel_hi:[1,0]
    v_pk_mul_f32 v[124:125], v[124:125], v[52:53] op_sel:[0,1]
    v_pk_mul_f32 v[142:143], v[142:143], v[52:53] op_sel_hi:[1,0]
    v_pk_mul_f32 v[126:127], v[126:127], v[52:53] op_sel:[0,1]
    v_cvt_pk_bf16_f32 v80, v128, v129
    v_cvt_pk_bf16_f32 v88, v112, v113
    v_cvt_pk_bf16_f32 v81, v130, v131
    v_cvt_pk_bf16_f32 v89, v114, v115
    v_cvt_pk_bf16_f32 v82, v132, v133
    v_cvt_pk_bf16_f32 v90, v116, v117
    v_cvt_pk_bf16_f32 v83, v134, v135
    v_cvt_pk_bf16_f32 v91, v118, v119
    v_cvt_pk_bf16_f32 v84, v136, v137
    v_cvt_pk_bf16_f32 v92, v120, v121
    v_cvt_pk_bf16_f32 v85, v138, v139
    v_cvt_pk_bf16_f32 v93, v122, v123
    v_cvt_pk_bf16_f32 v86, v140, v141
    v_cvt_pk_bf16_f32 v94, v124, v125
    v_cvt_pk_bf16_f32 v87, v142, v143
    v_cvt_pk_bf16_f32 v95, v126, v127
    s_waitcnt vmcnt(1)
    v_cmp_eq_u32 vcc, s4, v24
    s_nop 0
    s_cmp_eq_u32 vcc_lo, 0
    s_cselect_b32 s93, 1, 0
    v_pk_add_f32 v[144:145], v[144:145], v[148:149]
    v_pk_add_f32 v[146:147], v[146:147], v[150:151]
    s_nop 1
    v_permlane32_swap_b32 v144, v146
    v_permlane32_swap_b32 v145, v147
    v_pk_add_f32 v[144:145], v[144:145], v[146:147]
    s_nop 1
    v_add_f32_dpp v144, v144, v144 row_ror:8 row_mask:0xf bank_mask:0xf
    v_add_f32_dpp v145, v145, v145 row_ror:8 row_mask:0xf bank_mask:0xf
    v_mov_b32 v146, v144
    v_mov_b32 v147, v145
    s_nop 0
    v_permlane16_swap_b32 v144, v146
    v_permlane16_swap_b32 v145, v147
    v_pk_add_f32 v[144:145], v[144:145], v[146:147]
    v_cvt_pk_bf16_f32 v144, v144, v145
    v_mov_b32 v224, v144
    v_mov_b32 v226, v144
    v_mov_b32 v225, s4
    v_mov_b32 v227, s4
    v_permlane32_swap_b32 v224, v226
    v_add_u32 v228, s15, v2
    s_mov_b64 exec, 0xff
    s_cmp_lg_u32 s93, 0
    s_cbranch_scc1 LOC_20
    buffer_store_dwordx4 v[224:227], v2, s[32:35], s15 offen sc1
    s_branch LOCD_21
LOC_20:
    buffer_store_dwordx4 v[224:227], v2, s[32:35], s15 offen
LOCD_21:
    s_mov_b64 exec, -1
    s_cbranch_scc1 L_PC2
    s_barrier
    s_cmp_lg_u32 s3, 0
    s_cbranch_scc1 L_PC2
    v_mov_b32 v21, s4
    s_mov_b32 exec_hi, 0
    s_mov_b32 exec_lo, 65535
    buffer_store_dword v21, v75, s[32:35], s17 offen sc1
    s_mov_b64 exec, -1
L_PC2:
    s_lshl3_add_u32 s96, s11, s3
    s_lshl_b32 s97, s96, 11
    s_add_u32 s13, s97, 29360128
    s_waitcnt vmcnt(0)
    v_permlane32_swap_b32 v160, v162
    v_permlane32_swap_b32 v161, v163
    v_pk_add_f32 v[160:161], v[160:161], v[162:163]
    s_nop 1
    v_add_f32_dpp v160, v160, v160 row_ror:4 row_mask:0xf bank_mask:0xf
    v_add_f32_dpp v161, v161, v161 row_ror:4 row_mask:0xf bank_mask:0xf
    s_nop 0
    v_add_f32_dpp v160, v160, v160 row_ror:8 row_mask:0xf bank_mask:0xf
    v_add_f32_dpp v161, v161, v161 row_ror:8 row_mask:0xf bank_mask:0xf
    v_mov_b32 v162, v160
    v_mov_b32 v163, v161
    s_nop 0
    v_permlane16_swap_b32 v160, v162
    v_permlane16_swap_b32 v161, v163
    v_pk_add_f32 v[160:161], v[160:161], v[162:163]
    v_cvt_pk_bf16_f32 v160, v160, v161
    ds_write_b32 v6, v160
    s_cmp_lg_u32 s93, 0
    s_cbranch_scc1 L_C2L
SPOLL_22:
    s_load_dwordx2 s[24:25], s[32:33], s92 offset:3584 glc
SCHK_23:
    s_add_u32 s5, s5, 1
    s_cmp_ge_u32 s5, 300000
    s_waitcnt lgkmcnt(0)
    s_cbranch_scc1 SDONE_24
    s_cmp_lg_u32 s24, s4
    s_cbranch_scc1 SPOLL_22
    s_cmp_lg_u32 s25, s4
    s_cbranch_scc1 SPOLL_22
SDONE_24:
L_C2L:
    buffer_load_dwordx4 v[152:155], v2, s[32:35], s13 offen sc1
    buffer_load_dwordx4 v[156:159], v2, s[32:35], s13 offen offset:1024 sc1
    s_waitcnt vmcnt(0)
    v_bitop3_b32 v4, v153, v155, s4 bitop3:0x7e
    v_bitop3_b32 v4, v4, v157, s4 bitop3:0xf6
    v_bitop3_b32 v4, v4, v159, s4 bitop3:0xf6
    v_cmp_ne_u32 vcc, 0, v4
    s_cbranch_vccz TOK_26
POLL_27:
    buffer_load_dwordx4 v[152:155], v2, s[32:35], s13 offen sc1
    buffer_load_dwordx4 v[156:159], v2, s[32:35], s13 offen offset:1024 sc1
    s_waitcnt vmcnt(0)
    v_bitop3_b32 v4, v153, v155, s4 bitop3:0x7e
    v_bitop3_b32 v4, v4, v157, s4 bitop3:0xf6
    v_bitop3_b32 v4, v4, v159, s4 bitop3:0xf6
    v_cmp_ne_u32 vcc, 0, v4
    s_cbranch_vccz PDONE_28
    s_add_u32 s5, s5, 1
    s_cmp_lt_u32 s5, 300000
    s_cbranch_scc1 POLL_27
PDONE_28:
TOK_26:
    ds_write2_b32 v5, v152, v154 offset0:0 offset1:1
    ds_write2_b32 v5, v156, v158 offset0:64 offset1:65
    s_waitcnt lgkmcnt(0)
    s_barrier
    ds_read_b128 v[160:163], v7
    ds_read_b128 v[164:167], v7 offset:32
    ds_read_b128 v[168:171], v7 offset:64
    ds_read_b128 v[172:175], v7 offset:96
    ds_read_b128 v[144:147], v20
    ds_read_b128 v[148:151], v20 offset:1024
    ds_read_b128 v[152:155], v20 offset:2048
    ds_read_b128 v[156:159], v20 offset:3072
    s_lshl_b32 s96, s76, 6
    s_add_u32 s18, s96, 12288
    v_and_b32 v67, 7, v1
    v_lshl_add_u32 v67, v67, 2, s18
    v_lshrrev_b32 v9, 5, v1
    v_lshl_add_u32 v67, v9, 5, v67
    ds_read_b32 v64, v67
    ds_read_b32 v65, v67 offset:512
    ds_read_b32 v66, v67 offset:640
    ds_read_b32 v68, v67 offset:128
    ds_read_b32 v69, v67 offset:256
    ds_read_b32 v70, v67 offset:384
    ds_read_b32 v71, v67 offset:768
    s_add_u32 s96, s84, 1048576
    s_and_b32 s97, s96, 1048575
    s_lshl_b32 s98, s83, 16
    s_xor_b32 s99, s97, s98
    s_xor_b32 s96, s88, 1048576
    s_add_u32 s19, s99, s96
    s_add_u32 m0, s89, 98304
    s_nop 0
    buffer_load_dwordx4 v74, s[44:47], s19 offen lds
    s_add_u32 s96, s84, 1703936
    s_and_b32 s97, s96, 1048575
    s_lshl_b32 s98, s83, 16
    s_xor_b32 s99, s97, s98
    s_xor_b32 s96, s88, 1048576
    s_add_u32 s19, s99, s96
    s_add_u32 m0, s89, 139264
    s_nop 0
    buffer_load_dwordx4 v74, s[44:47], s19 offen lds
    s_add_u32 s96, s84, 1835008
    s_and_b32 s97, s96, 1048575
    s_lshl_b32 s98, s83, 16
    s_xor_b32 s99, s97, s98
    s_xor_b32 s96, s88, 1048576
    s_add_u32 s19, s99, s96
    s_add_u32 m0, s89, 147456
    s_nop 0
    buffer_load_dwordx4 v74, s[44:47], s19 offen lds
    s_and_b32 s96, s3, 3
    s_lshl2_add_u32 s97, s10, s96
    s_lshl4_add_u32 s98, s97, s11
    s_lshl1_add_u32 s99, s98, s76
    s_lshl_b32 s96, s99, 11
    s_add_u32 s13, s96, 8388608
    v_and_b32 v8, 15, v1
    v_lshlrev_b32 v8, 4, v8
    v_bfe_u32 v9, v1, 4, 1
    v_lshl_add_u32 v8, v9, 10, v8
    v_lshrrev_b32 v9, 5, v1
    v_lshl_add_u32 v8, v9, 8, v8
    s_waitcnt lgkmcnt(14)
    v_mfma_f32_32x32x16_bf16 v[128:143], v[160:163], v[80:83], 0
    s_waitcnt lgkmcnt(13)
    v_mfma_f32_32x32x16_bf16 v[128:143], v[164:167], v[84:87], v[128:143]
    s_waitcnt lgkmcnt(12)
    v_mfma_f32_32x32x16_bf16 v[128:143], v[168:171], v[88:91], v[128:143]
    s_waitcnt lgkmcnt(11)
    v_mfma_f32_32x32x16_bf16 v[128:143], v[172:175], v[92:95], v[128:143]
    s_waitcnt lgkmcnt(10)
    v_mfma_f32_32x32x16_bf16 v[112:127], v[144:147], v[80:83], 0
    s_waitcnt lgkmcnt(9)
    v_mfma_f32_32x32x16_bf16 v[112:127], v[148:151], v[84:87], v[112:127]
    s_waitcnt lgkmcnt(8)
    v_mfma_f32_32x32x16_bf16 v[112:127], v[152:155], v[88:91], v[112:127]
    s_waitcnt lgkmcnt(7)
    v_mfma_f32_32x32x16_bf16 v[112:127], v[156:159], v[92:95], v[112:127]
    s_nop 3
    v_cvt_pk_bf16_f32 v128, 0, v128
    v_add_f32 v128, 0x358637bd, v128
    v_cvt_pk_bf16_f32 v128, 0, v128
    v_rcp_f32 v128, v128
    s_nop 3
    v_cvt_pk_bf16_f32 v112, 0, v112
    v_cvt_pk_bf16_f32 v113, 0, v113
    v_cvt_pk_bf16_f32 v114, 0, v114
    v_cvt_pk_bf16_f32 v115, 0, v115
    v_cvt_pk_bf16_f32 v116, 0, v116
    v_cvt_pk_bf16_f32 v117, 0, v117
    v_cvt_pk_bf16_f32 v118, 0, v118
    v_cvt_pk_bf16_f32 v119, 0, v119
    v_pk_mul_f32 v[112:113], v[112:113], v[128:129] op_sel_hi:[1,0]
    v_pk_mul_f32 v[114:115], v[114:115], v[128:129] op_sel_hi:[1,0]
    v_pk_mul_f32 v[116:117], v[116:117], v[128:129] op_sel_hi:[1,0]
    v_pk_mul_f32 v[118:119], v[118:119], v[128:129] op_sel_hi:[1,0]
    v_cvt_pk_bf16_f32 v44, v112, v113
    v_cvt_pk_bf16_f32 v45, v114, v115
    v_cvt_pk_bf16_f32 v46, v116, v117
    v_cvt_pk_bf16_f32 v47, v118, v119
    buffer_store_dwordx4 v[44:47], v8, s[32:35], s13 offen sc1
    v_cvt_pk_bf16_f32 v120, 0, v120
    v_cvt_pk_bf16_f32 v121, 0, v121
    v_cvt_pk_bf16_f32 v122, 0, v122
    v_cvt_pk_bf16_f32 v123, 0, v123
    v_cvt_pk_bf16_f32 v124, 0, v124
    v_cvt_pk_bf16_f32 v125, 0, v125
    v_cvt_pk_bf16_f32 v126, 0, v126
    v_cvt_pk_bf16_f32 v127, 0, v127
    v_pk_mul_f32 v[120:121], v[120:121], v[128:129] op_sel_hi:[1,0]
    v_pk_mul_f32 v[122:123], v[122:123], v[128:129] op_sel_hi:[1,0]
    v_pk_mul_f32 v[124:125], v[124:125], v[128:129] op_sel_hi:[1,0]
    v_pk_mul_f32 v[126:127], v[126:127], v[128:129] op_sel_hi:[1,0]
    v_cvt_pk_bf16_f32 v48, v120, v121
    v_cvt_pk_bf16_f32 v49, v122, v123
    v_cvt_pk_bf16_f32 v50, v124, v125
    v_cvt_pk_bf16_f32 v51, v126, v127
    buffer_store_dwordx4 v[48:51], v8, s[32:35], s13 offen offset:512 sc1
    s_mul_i32 s96, s76, 65600
    s_add_u32 s17, s96, 32768
    v_lshrrev_b32 v20, 5, v1
    v_lshlrev_b32 v20, 11, v20
    v_bfe_u32 v9, v1, 4, 1
    v_lshl_add_u32 v20, v9, 9, v20
    v_bfe_u32 v9, v1, 2, 2
    v_lshl_add_u32 v20, v9, 7, v20
    v_bfe_u32 v9, v1, 3, 1
    v_lshl_add_u32 v20, v9, 6, v20
    v_bfe_u32 v9, v1, 1, 1
    v_lshl_add_u32 v20, v9, 5, v20
    v_bfe_u32 v9, v1, 4, 1
    v_lshl_add_u32 v20, v9, 4, v20
    v_and_b32 v9, 1, v1
    v_lshl_add_u32 v20, v9, 3, v20
    v_xor_b32 v20, s17, v20
    v_xor_b32 v21, 16, v20
    v_xor_b32 v22, 64, v20
    v_xor_b32 v23, 80, v20
    v_and_b32 v5, 7, v1
    v_lshlrev_b32 v5, 15, v5
    v_bfe_u32 v9, v1, 3, 1
    v_lshl_add_u32 v5, v9, 12, v5
    s_lshr_b32 s96, s11, 2
    s_xor_b32 s97, s96, 1
    s_and_b32 s98, s97, 1
    s_lshr_b32 s99, s10, 2
    s_and_b32 s96, s10, 3
    s_lshl_b32 s97, s96, 6
    s_lshl1_add_u32 s96, s99, s97
    s_lshl_b32 s99, s96, 12
    s_lshr_b32 s97, s11, 3
    s_and_b32 s96, s11, 3
    s_lshl2_add_u32 s97, s97, s96
    s_lshl_b32 s96, s97, 6
    s_add_u32 s97, s99, s96
    s_lshl2_add_u32 s99, s98, s97
    s_add_u32 s96, s99, 1048576
    s_add_u32 s15, s96, 1024
    v_mov_b32 v52, 0x10000
    v_mov_b32 v53, s6
    v_lshlrev_b32 v28, 16, v12
    v_and_b32 v29, s6, v12
    v_lshlrev_b32 v30, 16, v13
    v_and_b32 v31, s6, v13
    v_lshlrev_b32 v32, 16, v14
    v_and_b32 v33, s6, v14
    v_lshlrev_b32 v34, 16, v15
    v_and_b32 v35, s6, v15
    v_lshlrev_b32 v36, 16, v16
    v_and_b32 v37, s6, v16
    v_lshlrev_b32 v38, 16, v17
    v_and_b32 v39, s6, v17
    v_lshlrev_b32 v40, 16, v18
    v_and_b32 v41, s6, v18
    v_lshlrev_b32 v42, 16, v19
    v_and_b32 v43, s6, v19
    s_waitcnt lgkmcnt(0)
    v_mul_u32_u24_dpp v76, v64, v52 row_newbcast:0 row_mask:0xf bank_mask:0xf
    v_and_b32_dpp v77, v64, v53 row_newbcast:0 row_mask:0xf bank_mask:0xf
    v_mul_u32_u24_dpp v78, v64, v52 row_newbcast:1 row_mask:0xf bank_mask:0xf
    v_and_b32_dpp v79, v64, v53 row_newbcast:1 row_mask:0xf bank_mask:0xf
    v_mul_u32_u24_dpp v80, v64, v52 row_newbcast:2 row_mask:0xf bank_mask:0xf
    v_and_b32_dpp v81, v64, v53 row_newbcast:2 row_mask:0xf bank_mask:0xf
    v_mul_u32_u24_dpp v82, v64, v52 row_newbcast:3 row_mask:0xf bank_mask:0xf
    v_and_b32_dpp v83, v64, v53 row_newbcast:3 row_mask:0xf bank_mask:0xf
    v_mul_u32_u24_dpp v84, v64, v52 row_newbcast:4 row_mask:0xf bank_mask:0xf
    v_and_b32_dpp v85, v64, v53 row_newbcast:4 row_mask:0xf bank_mask:0xf
    v_mul_u32_u24_dpp v86, v64, v52 row_newbcast:5 row_mask:0xf bank_mask:0xf
    v_and_b32_dpp v87, v64, v53 row_newbcast:5 row_mask:0xf bank_mask:0xf
    v_mul_u32_u24_dpp v88, v64, v52 row_newbcast:6 row_mask:0xf bank_mask:0xf
    v_and_b32_dpp v89, v64, v53 row_newbcast:6 row_mask:0xf bank_mask:0xf
    v_mul_u32_u24_dpp v90, v64, v52 row_newbcast:7 row_mask:0xf bank_mask:0xf
    v_and_b32_dpp v91, v64, v53 row_newbcast:7 row_mask:0xf bank_mask:0xf
    s_lshl1_add_u32 s96, s94, s77
    s_lshl_b32 s97, s96, 15
    s_add_u32 s19, s97, 8388608
    v_and_b32 v25, 15, v1
    v_lshlrev_b32 v25, 3, v25
    s_waitcnt vmcnt(0)
    s_waitcnt lgkmcnt(0)
    s_barrier
    s_cmp_lg_u32 s3, 0
    s_cbranch_scc1 L_PD
    v_mov_b32 v6, s4
    s_mov_b32 exec_hi, 0
    s_mov_b32 exec_lo, 65535
    buffer_store_dword v6, v5, s[32:35], s15 offen sc1
    s_mov_b64 exec, -1
L_PD:
    s_add_u32 s96, s84, 1966080
    s_and_b32 s97, s96, 1048575
    s_lshl_b32 s98, s83, 16
    s_xor_b32 s99, s97, s98
    s_xor_b32 s96, s88, 1048576
    s_add_u32 s13, s99, s96
    s_add_u32 m0, s89, 155648
    s_nop 0
    buffer_load_dwordx4 v74, s[44:47], s13 offen lds
    s_and_b32 s96, s84, 1048575
    s_lshl_b32 s97, s83, 16
    s_xor_b32 s98, s96, s97
    s_add_u32 s13, s98, s88
    s_add_u32 m0, s89, 32768
    s_nop 0
    buffer_load_dwordx4 v74, s[44:47], s13 offen lds
    s_add_u32 s96, s84, 131072
    s_and_b32 s97, s96, 1048575
    s_lshl_b32 s98, s83, 16
    s_xor_b32 s99, s97, s98
    s_add_u32 s13, s99, s88
    s_add_u32 m0, s89, 40960
    s_nop 0
    buffer_load_dwordx4 v74, s[44:47], s13 offen lds
    s_load_dwordx2 s[24:25], s[32:33], s92 offset:1024 glc
    v_mov_b32_dpp v92, v65 row_newbcast:0 row_mask:0xf bank_mask:0xf
    v_mov_b32_dpp v93, v65 row_newbcast:1 row_mask:0xf bank_mask:0xf
    v_mov_b32_dpp v94, v65 row_newbcast:2 row_mask:0xf bank_mask:0xf
    v_mov_b32_dpp v95, v65 row_newbcast:3 row_mask:0xf bank_mask:0xf
    v_mov_b32_dpp v96, v65 row_newbcast:4 row_mask:0xf bank_mask:0xf
    v_mov_b32_dpp v97, v65 row_newbcast:5 row_mask:0xf bank_mask:0xf
    v_mov_b32_dpp v98, v65 row_newbcast:6 row_mask:0xf bank_mask:0xf
    v_mov_b32_dpp v99, v65 row_newbcast:7 row_mask:0xf bank_mask:0xf
    v_mov_b32_dpp v100, v66 row_newbcast:0 row_mask:0xf bank_mask:0xf
    v_mov_b32_dpp v101, v66 row_newbcast:1 row_mask:0xf bank_mask:0xf
    v_mov_b32_dpp v102, v66 row_newbcast:2 row_mask:0xf bank_mask:0xf
    v_mov_b32_dpp v103, v66 row_newbcast:3 row_mask:0xf bank_mask:0xf
    v_mov_b32_dpp v104, v66 row_newbcast:4 row_mask:0xf bank_mask:0xf
    v_mov_b32_dpp v105, v66 row_newbcast:5 row_mask:0xf bank_mask:0xf
    v_mov_b32_dpp v106, v66 row_newbcast:6 row_mask:0xf bank_mask:0xf
    v_mov_b32_dpp v107, v66 row_newbcast:7 row_mask:0xf bank_mask:0xf
    v_and_b32 v4, 3, v1
    v_cmp_eq_u32 vcc, 1, v4
    v_cmp_eq_u32 s[22:23], 0, v4
    v_mov_b32 v5, 0x3f803f80
    v_cndmask_b32 v92, v100, v92, vcc
    v_cndmask_b32 v93, v101, v93, vcc
    v_cndmask_b32 v94, v102, v94, vcc
    v_cndmask_b32 v95, v103, v95, vcc
    v_cndmask_b32 v96, v104, v96, vcc
    v_cndmask_b32 v97, v105, v97, vcc
    v_cndmask_b32 v98, v106, v98, vcc
    v_cndmask_b32 v99, v107, v99, vcc
    v_cndmask_b32 v92, v92, v5, s[22:23]
    v_cndmask_b32 v93, v93, v5, s[22:23]
    v_cndmask_b32 v94, v94, v5, s[22:23]
    v_cndmask_b32 v95, v95, v5, s[22:23]
    v_cndmask_b32 v96, v96, v5, s[22:23]
    v_cndmask_b32 v97, v97, v5, s[22:23]
    v_cndmask_b32 v98, v98, v5, s[22:23]
    v_cndmask_b32 v99, v99, v5, s[22:23]
    s_waitcnt vmcnt(0)
    s_branch SCHK_30
SPOLL_29:
    s_load_dwordx2 s[24:25], s[32:33], s92 offset:1024 glc
SCHK_30:
    s_add_u32 s5, s5, 1
    s_cmp_ge_u32 s5, 300000
    s_waitcnt lgkmcnt(0)
    s_cbranch_scc1 SDONE_31
    s_cmp_lg_u32 s24, s4
    s_cbranch_scc1 SPOLL_29
SDONE_31:
    s_barrier
    s_cmp_lt_u32 s3, 4
    s_cbranch_scc1 L_P2
    s_setprio 1
L_P2:
    s_lshl_b32 s96, s21, 7
    s_add_u32 s18, s96, 65536
    s_lshl_b32 s96, s83, 11
    s_add_u32 s20, s96, s19
    buffer_load_dwordx4 v[140:143], v2, s[32:35], s20 offen sc1
    buffer_load_dwordx4 v[144:147], v2, s[32:35], s20 offen offset:1024 sc1
    ds_read_b64_tr_b16 v[232:233], v22
    ds_read_b64_tr_b16 v[234:235], v22 offset:1024
    ds_read_b64_tr_b16 v[236:237], v23
    ds_read_b64_tr_b16 v[238:239], v23 offset:1024
    ds_read_b64_tr_b16 v[240:241], v20
    ds_read_b64_tr_b16 v[242:243], v20 offset:1024
    ds_read_b64_tr_b16 v[244:245], v21
    ds_read_b64_tr_b16 v[246:247], v21 offset:1024
    s_xor_b32 s96, s83, 1
    s_lshl_b32 s97, s96, 11
    s_add_u32 s20, s97, s19
    buffer_load_dwordx4 v[148:151], v2, s[32:35], s20 offen sc1
    buffer_load_dwordx4 v[152:155], v2, s[32:35], s20 offen offset:1024 sc1
    s_xor_b32 s96, s83, 2
    s_lshl_b32 s97, s96, 11
    s_add_u32 s20, s97, s19
    buffer_load_dwordx4 v[156:159], v2, s[32:35], s20 offen sc1
    buffer_load_dwordx4 v[160:163], v2, s[32:35], s20 offen offset:1024 sc1
    s_waitcnt lgkmcnt(6)
    s_waitcnt vmcnt(5)
    v_mfma_f32_16x16x32_bf16 v[124:127], v[232:235], v[140:143], 0
    ds_read_b64_tr_b16 v[248:249], v22 offset:4096
    s_waitcnt vmcnt(4)
    v_mfma_f32_16x16x32_bf16 v[128:131], v[232:235], v[144:147], 0
    ds_read_b64_tr_b16 v[250:251], v22 offset:5120
    s_xor_b32 s96, s83, 3
    s_lshl_b32 s97, s96, 11
    s_add_u32 s20, s97, s19
    buffer_load_dwordx4 v[164:167], v2, s[32:35], s20 offen sc1
    s_waitcnt lgkmcnt(6)
    v_mfma_f32_16x16x32_bf16 v[132:135], v[236:239], v[140:143], 0
    ds_read_b64_tr_b16 v[232:233], v23 offset:4096
    v_mfma_f32_16x16x32_bf16 v[136:139], v[236:239], v[144:147], 0
    ds_read_b64_tr_b16 v[234:235], v23 offset:5120
    buffer_load_dwordx4 v[168:171], v2, s[32:35], s20 offen offset:1024 sc1
    s_waitcnt lgkmcnt(6)
    v_mfma_f32_16x16x32_bf16 v[108:111], v[240:243], v[140:143], 0
    ds_read_b64_tr_b16 v[236:237], v20 offset:4096
    v_mfma_f32_16x16x32_bf16 v[112:115], v[240:243], v[144:147], 0
    ds_read_b64_tr_b16 v[238:239], v20 offset:5120
    s_waitcnt lgkmcnt(6)
    v_mfma_f32_16x16x32_bf16 v[116:119], v[244:247], v[140:143], 0
    ds_read_b64_tr_b16 v[240:241], v21 offset:4096
    v_mfma_f32_16x16x32_bf16 v[120:123], v[244:247], v[144:147], 0
    ds_read_b64_tr_b16 v[242:243], v21 offset:5120
    s_waitcnt lgkmcnt(6)
    s_waitcnt vmcnt(4)
    v_mfma_f32_16x16x32_bf16 v[124:127], v[248:251], v[148:151], v[124:127]
    ds_read_b64_tr_b16 v[244:245], v22 offset:8192
    v_mfma_f32_16x16x32_bf16 v[128:131], v[248:251], v[152:155], v[128:131]
    ds_read_b64_tr_b16 v[246:247], v22 offset:9216
    s_xor_b32 s96, s83, 4
    s_lshl_b32 s97, s96, 11
    s_add_u32 s20, s97, s19
    buffer_load_dwordx4 v[140:143], v2, s[32:35], s20 offen sc1
    s_waitcnt lgkmcnt(6)
    v_mfma_f32_16x16x32_bf16 v[132:135], v[232:235], v[148:151], v[132:135]
    ds_read_b64_tr_b16 v[248:249], v23 offset:8192
    v_mfma_f32_16x16x32_bf16 v[136:139], v[232:235], v[152:155], v[136:139]
    ds_read_b64_tr_b16 v[250:251], v23 offset:9216
    buffer_load_dwordx4 v[144:147], v2, s[32:35], s20 offen offset:1024 sc1
    s_waitcnt lgkmcnt(6)
    v_mfma_f32_16x16x32_bf16 v[108:111], v[236:239], v[148:151], v[108:111]
    ds_read_b64_tr_b16 v[232:233], v20 offset:8192
    v_mfma_f32_16x16x32_bf16 v[112:115], v[236:239], v[152:155], v[112:115]
    ds_read_b64_tr_b16 v[234:235], v20 offset:9216
    s_waitcnt lgkmcnt(6)
    v_mfma_f32_16x16x32_bf16 v[116:119], v[240:243], v[148:151], v[116:119]
    ds_read_b64_tr_b16 v[236:237], v21 offset:8192
    v_mfma_f32_16x16x32_bf16 v[120:123], v[240:243], v[152:155], v[120:123]
    ds_read_b64_tr_b16 v[238:239], v21 offset:9216
    s_waitcnt lgkmcnt(6)
    s_waitcnt vmcnt(4)
    v_mfma_f32_16x16x32_bf16 v[124:127], v[244:247], v[156:159], v[124:127]
    ds_read_b64_tr_b16 v[240:241], v22 offset:12288
    v_mfma_f32_16x16x32_bf16 v[128:131], v[244:247], v[160:163], v[128:131]
    ds_read_b64_tr_b16 v[242:243], v22 offset:13312
    s_xor_b32 s96, s83, 5
    s_lshl_b32 s97, s96, 11
    s_add_u32 s20, s97, s19
    buffer_load_dwordx4 v[148:151], v2, s[32:35], s20 offen sc1
    s_waitcnt lgkmcnt(6)
    v_mfma_f32_16x16x32_bf16 v[132:135], v[248:251], v[156:159], v[132:135]
    ds_read_b64_tr_b16 v[244:245], v23 offset:12288
    v_mfma_f32_16x16x32_bf16 v[136:139], v[248:251], v[160:163], v[136:139]
    ds_read_b64_tr_b16 v[246:247], v23 offset:13312
    buffer_load_dwordx4 v[152:155], v2, s[32:35], s20 offen offset:1024 sc1
    s_waitcnt lgkmcnt(6)
    v_mfma_f32_16x16x32_bf16 v[108:111], v[232:235], v[156:159], v[108:111]
    ds_read_b64_tr_b16 v[248:249], v20 offset:12288
    v_mfma_f32_16x16x32_bf16 v[112:115], v[232:235], v[160:163], v[112:115]
    ds_read_b64_tr_b16 v[250:251], v20 offset:13312
    s_waitcnt lgkmcnt(6)
    v_mfma_f32_16x16x32_bf16 v[116:119], v[236:239], v[156:159], v[116:119]
    ds_read_b64_tr_b16 v[232:233], v21 offset:12288
    v_mfma_f32_16x16x32_bf16 v[120:123], v[236:239], v[160:163], v[120:123]
    ds_read_b64_tr_b16 v[234:235], v21 offset:13312
    s_waitcnt lgkmcnt(6)
    s_waitcnt vmcnt(4)
    v_mfma_f32_16x16x32_bf16 v[124:127], v[240:243], v[164:167], v[124:127]
    ds_read_b64_tr_b16 v[236:237], v22 offset:16384
    v_mfma_f32_16x16x32_bf16 v[128:131], v[240:243], v[168:171], v[128:131]
    ds_read_b64_tr_b16 v[238:239], v22 offset:17408
    s_xor_b32 s96, s83, 6
    s_lshl_b32 s97, s96, 11
    s_add_u32 s20, s97, s19
    buffer_load_dwordx4 v[156:159], v2, s[32:35], s20 offen sc1
    s_waitcnt lgkmcnt(6)
    v_mfma_f32_16x16x32_bf16 v[132:135], v[244:247], v[164:167], v[132:135]
    ds_read_b64_tr_b16 v[240:241], v23 offset:16384
    v_mfma_f32_16x16x32_bf16 v[136:139], v[244:247], v[168:171], v[136:139]
    ds_read_b64_tr_b16 v[242:243], v23 offset:17408
    buffer_load_dwordx4 v[160:163], v2, s[32:35], s20 offen offset:1024 sc1
    s_waitcnt lgkmcnt(6)
    v_mfma_f32_16x16x32_bf16 v[108:111], v[248:251], v[164:167], v[108:111]
    ds_read_b64_tr_b16 v[244:245], v20 offset:16384
    v_mfma_f32_16x16x32_bf16 v[112:115], v[248:251], v[168:171], v[112:115]
    ds_read_b64_tr_b16 v[246:247], v20 offset:17408
    s_waitcnt lgkmcnt(6)
    v_mfma_f32_16x16x32_bf16 v[116:119], v[232:235], v[164:167], v[116:119]
    ds_read_b64_tr_b16 v[248:249], v21 offset:16384
    v_mfma_f32_16x16x32_bf16 v[120:123], v[232:235], v[168:171], v[120:123]
    ds_read_b64_tr_b16 v[250:251], v21 offset:17408
    s_waitcnt lgkmcnt(6)
    s_waitcnt vmcnt(4)
    v_mfma_f32_16x16x32_bf16 v[124:127], v[236:239], v[140:143], v[124:127]
    ds_read_b64_tr_b16 v[232:233], v22 offset:20480
    v_mfma_f32_16x16x32_bf16 v[128:131], v[236:239], v[144:147], v[128:131]
    ds_read_b64_tr_b16 v[234:235], v22 offset:21504
    s_xor_b32 s96, s83, 7
    s_lshl_b32 s97, s96, 11
    s_add_u32 s20, s97, s19
    buffer_load_dwordx4 v[164:167], v2, s[32:35], s20 offen sc1
    s_waitcnt lgkmcnt(6)
    v_mfma_f32_16x16x32_bf16 v[132:135], v[240:243], v[140:143], v[132:135]
    ds_read_b64_tr_b16 v[236:237], v23 offset:20480
    v_mfma_f32_16x16x32_bf16 v[136:139], v[240:243], v[144:147], v[136:139]
    ds_read_b64_tr_b16 v[238:239], v23 offset:21504
    buffer_load_dwordx4 v[168:171], v2, s[32:35], s20 offen offset:1024 sc1
    s_waitcnt lgkmcnt(6)
    v_mfma_f32_16x16x32_bf16 v[108:111], v[244:247], v[140:143], v[108:111]
    ds_read_b64_tr_b16 v[240:241], v20 offset:20480
    v_mfma_f32_16x16x32_bf16 v[112:115], v[244:247], v[144:147], v[112:115]
    ds_read_b64_tr_b16 v[242:243], v20 offset:21504
    s_setprio 0
    s_waitcnt lgkmcnt(6)
    v_mfma_f32_16x16x32_bf16 v[116:119], v[248:251], v[140:143], v[116:119]
    ds_read_b64_tr_b16 v[244:245], v21 offset:20480
    v_mfma_f32_16x16x32_bf16 v[120:123], v[248:251], v[144:147], v[120:123]
    ds_read_b64_tr_b16 v[246:247], v21 offset:21504
    s_waitcnt lgkmcnt(6)
    s_waitcnt vmcnt(4)
    v_mfma_f32_16x16x32_bf16 v[124:127], v[232:235], v[148:151], v[124:127]
    ds_read_b64_tr_b16 v[248:249], v22 offset:24576
    v_mfma_f32_16x16x32_bf16 v[128:131], v[232:235], v[152:155], v[128:131]
    ds_read_b64_tr_b16 v[250:251], v22 offset:25600
    s_cmp_eq_u32 s25, s4
    s_cbranch_scc1 L_D2
SPOLL_32:
    s_load_dwordx2 s[24:25], s[32:33], s92 offset:1024 glc
SCHK_33:
    s_add_u32 s5, s5, 1
    s_cmp_ge_u32 s5, 300000
    s_waitcnt lgkmcnt(0)
    s_cbranch_scc1 SDONE_34
    s_cmp_lg_u32 s25, s4
    s_cbranch_scc1 SPOLL_32
SDONE_34:
L_D2:
    s_barrier
    s_xor_b32 s96, s83, 8
    s_lshl_b32 s97, s96, 11
    s_add_u32 s20, s97, s19
    buffer_load_dwordx4 v[140:143], v2, s[32:35], s20 offen sc1
    s_waitcnt lgkmcnt(6)
    v_mfma_f32_16x16x32_bf16 v[132:135], v[236:239], v[148:151], v[132:135]
    ds_read_b64_tr_b16 v[232:233], v23 offset:24576
    v_mfma_f32_16x16x32_bf16 v[136:139], v[236:239], v[152:155], v[136:139]
    ds_read_b64_tr_b16 v[234:235], v23 offset:25600
    buffer_load_dwordx4 v[144:147], v2, s[32:35], s20 offen offset:1024 sc1
    s_waitcnt lgkmcnt(6)
    v_mfma_f32_16x16x32_bf16 v[108:111], v[240:243], v[148:151], v[108:111]
    ds_read_b64_tr_b16 v[236:237], v20 offset:24576
    v_mfma_f32_16x16x32_bf16 v[112:115], v[240:243], v[152:155], v[112:115]
    ds_read_b64_tr_b16 v[238:239], v20 offset:25600
    s_waitcnt lgkmcnt(6)
    v_mfma_f32_16x16x32_bf16 v[116:119], v[244:247], v[148:151], v[116:119]
    ds_read_b64_tr_b16 v[240:241], v21 offset:24576
    v_mfma_f32_16x16x32_bf16 v[120:123], v[244:247], v[152:155], v[120:123]
    ds_read_b64_tr_b16 v[242:243], v21 offset:25600
    s_waitcnt lgkmcnt(6)
    s_waitcnt vmcnt(4)
    v_mfma_f32_16x16x32_bf16 v[124:127], v[248:251], v[156:159], v[124:127]
    ds_read_b64_tr_b16 v[244:245], v22 offset:28672
    v_mfma_f32_16x16x32_bf16 v[128:131], v[248:251], v[160:163], v[128:131]
    ds_read_b64_tr_b16 v[246:247], v22 offset:29696
    s_xor_b32 s96, s83, 9
    s_lshl_b32 s97, s96, 11
    s_add_u32 s20, s97, s19
    buffer_load_dwordx4 v[148:151], v2, s[32:35], s20 offen sc1
    s_waitcnt lgkmcnt(6)
    v_mfma_f32_16x16x32_bf16 v[132:135], v[232:235], v[156:159], v[132:135]
    ds_read_b64_tr_b16 v[248:249], v23 offset:28672
    v_mfma_f32_16x16x32_bf16 v[136:139], v[232:235], v[160:163], v[136:139]
    ds_read_b64_tr_b16 v[250:251], v23 offset:29696
    buffer_load_dwordx4 v[152:155], v2, s[32:35], s20 offen offset:1024 sc1
    s_waitcnt lgkmcnt(6)
    v_mfma_f32_16x16x32_bf16 v[108:111], v[236:239], v[156:159], v[108:111]
    ds_read_b64_tr_b16 v[232:233], v20 offset:28672
    v_mfma_f32_16x16x32_bf16 v[112:115], v[236:239], v[160:163], v[112:115]
    ds_read_b64_tr_b16 v[234:235], v20 offset:29696
    s_waitcnt lgkmcnt(6)
    v_mfma_f32_16x16x32_bf16 v[116:119], v[240:243], v[156:159], v[116:119]
    ds_read_b64_tr_b16 v[236:237], v21 offset:28672
    v_mfma_f32_16x16x32_bf16 v[120:123], v[240:243], v[160:163], v[120:123]
    ds_read_b64_tr_b16 v[238:239], v21 offset:29696
    s_waitcnt lgkmcnt(6)
    s_waitcnt vmcnt(4)
    v_mfma_f32_16x16x32_bf16 v[124:127], v[244:247], v[164:167], v[124:127]
    ds_read_b64_tr_b16 v[240:241], v22 offset:32768
    v_mfma_f32_16x16x32_bf16 v[128:131], v[244:247], v[168:171], v[128:131]
    ds_read_b64_tr_b16 v[242:243], v22 offset:33792
    s_xor_b32 s96, s83, 10
    s_lshl_b32 s97, s96, 11
    s_add_u32 s20, s97, s19
    buffer_load_dwordx4 v[156:159], v2, s[32:35], s20 offen sc1
    s_waitcnt lgkmcnt(6)
    v_mfma_f32_16x16x32_bf16 v[132:135], v[248:251], v[164:167], v[132:135]
    ds_read_b64_tr_b16 v[244:245], v23 offset:32768
    v_mfma_f32_16x16x32_bf16 v[136:139], v[248:251], v[168:171], v[136:139]
    ds_read_b64_tr_b16 v[246:247], v23 offset:33792
    buffer_load_dwordx4 v[160:163], v2, s[32:35], s20 offen offset:1024 sc1
    s_waitcnt lgkmcnt(6)
    v_mfma_f32_16x16x32_bf16 v[108:111], v[232:235], v[164:167], v[108:111]
    ds_read_b64_tr_b16 v[248:249], v20 offset:32768
    v_mfma_f32_16x16x32_bf16 v[112:115], v[232:235], v[168:171], v[112:115]
    ds_read_b64_tr_b16 v[250:251], v20 offset:33792
    s_waitcnt lgkmcnt(6)
    v_mfma_f32_16x16x32_bf16 v[116:119], v[236:239], v[164:167], v[116:119]
    ds_read_b64_tr_b16 v[232:233], v21 offset:32768
    v_mfma_f32_16x16x32_bf16 v[120:123], v[236:239], v[168:171], v[120:123]
    ds_read_b64_tr_b16 v[234:235], v21 offset:33792
    s_waitcnt lgkmcnt(6)
    s_waitcnt vmcnt(4)
    v_mfma_f32_16x16x32_bf16 v[124:127], v[240:243], v[140:143], v[124:127]
    ds_read_b64_tr_b16 v[236:237], v22 offset:36864
    v_mfma_f32_16x16x32_bf16 v[128:131], v[240:243], v[144:147], v[128:131]
    ds_read_b64_tr_b16 v[238:239], v22 offset:37888
    s_xor_b32 s96, s83, 11
    s_lshl_b32 s97, s96, 11
    s_add_u32 s20, s97, s19
    buffer_load_dwordx4 v[164:167], v2, s[32:35], s20 offen sc1
    s_waitcnt lgkmcnt(6)
    v_mfma_f32_16x16x32_bf16 v[132:135], v[244:247], v[140:143], v[132:135]
    ds_read_b64_tr_b16 v[240:241], v23 offset:36864
    v_mfma_f32_16x16x32_bf16 v[136:139], v[244:247], v[144:147], v[136:139]
    ds_read_b64_tr_b16 v[242:243], v23 offset:37888
    buffer_load_dwordx4 v[168:171], v2, s[32:35], s20 offen offset:1024 sc1
    s_waitcnt lgkmcnt(6)
    v_mfma_f32_16x16x32_bf16 v[108:111], v[248:251], v[140:143], v[108:111]
    ds_read_b64_tr_b16 v[244:245], v20 offset:36864
    v_mfma_f32_16x16x32_bf16 v[112:115], v[248:251], v[144:147], v[112:115]
    ds_read_b64_tr_b16 v[246:247], v20 offset:37888
    s_waitcnt lgkmcnt(6)
    v_mfma_f32_16x16x32_bf16 v[116:119], v[232:235], v[140:143], v[116:119]
    ds_read_b64_tr_b16 v[248:249], v21 offset:36864
    v_mfma_f32_16x16x32_bf16 v[120:123], v[232:235], v[144:147], v[120:123]
    ds_read_b64_tr_b16 v[250:251], v21 offset:37888
    s_waitcnt lgkmcnt(6)
    s_waitcnt vmcnt(4)
    v_mfma_f32_16x16x32_bf16 v[124:127], v[236:239], v[148:151], v[124:127]
    ds_read_b64_tr_b16 v[232:233], v22 offset:40960
    v_mfma_f32_16x16x32_bf16 v[128:131], v[236:239], v[152:155], v[128:131]
    ds_read_b64_tr_b16 v[234:235], v22 offset:41984
    s_xor_b32 s96, s83, 12
    s_lshl_b32 s97, s96, 11
    s_add_u32 s20, s97, s19
    buffer_load_dwordx4 v[140:143], v2, s[32:35], s20 offen sc1
    s_waitcnt lgkmcnt(6)
    v_mfma_f32_16x16x32_bf16 v[132:135], v[240:243], v[148:151], v[132:135]
    ds_read_b64_tr_b16 v[236:237], v23 offset:40960
    v_mfma_f32_16x16x32_bf16 v[136:139], v[240:243], v[152:155], v[136:139]
    ds_read_b64_tr_b16 v[238:239], v23 offset:41984
    buffer_load_dwordx4 v[144:147], v2, s[32:35], s20 offen offset:1024 sc1
    s_waitcnt lgkmcnt(6)
    v_mfma_f32_16x16x32_bf16 v[108:111], v[244:247], v[148:151], v[108:111]
    ds_read_b64_tr_b16 v[240:241], v20 offset:40960
    v_mfma_f32_16x16x32_bf16 v[112:115], v[244:247], v[152:155], v[112:115]
    ds_read_b64_tr_b16 v[242:243], v20 offset:41984
    s_waitcnt lgkmcnt(6)
    v_mfma_f32_16x16x32_bf16 v[116:119], v[248:251], v[148:151], v[116:119]
    ds_read_b64_tr_b16 v[244:245], v21 offset:40960
    v_mfma_f32_16x16x32_bf16 v[120:123], v[248:251], v[152:155], v[120:123]
    ds_read_b64_tr_b16 v[246:247], v21 offset:41984
    s_waitcnt lgkmcnt(6)
    s_waitcnt vmcnt(4)
    v_mfma_f32_16x16x32_bf16 v[124:127], v[232:235], v[156:159], v[124:127]
    ds_read_b64_tr_b16 v[248:249], v22 offset:45056
    v_mfma_f32_16x16x32_bf16 v[128:131], v[232:235], v[160:163], v[128:131]
    ds_read_b64_tr_b16 v[250:251], v22 offset:46080
    s_xor_b32 s96, s83, 13
    s_lshl_b32 s97, s96, 11
    s_add_u32 s20, s97, s19
    buffer_load_dwordx4 v[148:151], v2, s[32:35], s20 offen sc1
    s_waitcnt lgkmcnt(6)
    v_mfma_f32_16x16x32_bf16 v[132:135], v[236:239], v[156:159], v[132:135]
    ds_read_b64_tr_b16 v[232:233], v23 offset:45056
    v_mfma_f32_16x16x32_bf16 v[136:139], v[236:239], v[160:163], v[136:139]
    ds_read_b64_tr_b16 v[234:235], v23 offset:46080
    buffer_load_dwordx4 v[152:155], v2, s[32:35], s20 offen offset:1024 sc1
    s_waitcnt lgkmcnt(6)
    v_mfma_f32_16x16x32_bf16 v[108:111], v[240:243], v[156:159], v[108:111]
    ds_read_b64_tr_b16 v[236:237], v20 offset:45056
    v_mfma_f32_16x16x32_bf16 v[112:115], v[240:243], v[160:163], v[112:115]
    ds_read_b64_tr_b16 v[238:239], v20 offset:46080
    s_waitcnt lgkmcnt(6)
    v_mfma_f32_16x16x32_bf16 v[116:119], v[244:247], v[156:159], v[116:119]
    ds_read_b64_tr_b16 v[240:241], v21 offset:45056
    v_mfma_f32_16x16x32_bf16 v[120:123], v[244:247], v[160:163], v[120:123]
    ds_read_b64_tr_b16 v[242:243], v21 offset:46080
    s_waitcnt lgkmcnt(6)
    s_waitcnt vmcnt(4)
    v_mfma_f32_16x16x32_bf16 v[124:127], v[248:251], v[164:167], v[124:127]
    ds_read_b64_tr_b16 v[244:245], v22 offset:49152
    v_mfma_f32_16x16x32_bf16 v[128:131], v[248:251], v[168:171], v[128:131]
    ds_read_b64_tr_b16 v[246:247], v22 offset:50176
    s_xor_b32 s96, s83, 14
    s_lshl_b32 s97, s96, 11
    s_add_u32 s20, s97, s19
    buffer_load_dwordx4 v[156:159], v2, s[32:35], s20 offen sc1
    s_waitcnt lgkmcnt(6)
    v_mfma_f32_16x16x32_bf16 v[132:135], v[232:235], v[164:167], v[132:135]
    ds_read_b64_tr_b16 v[248:249], v23 offset:49152
    v_mfma_f32_16x16x32_bf16 v[136:139], v[232:235], v[168:171], v[136:139]
    ds_read_b64_tr_b16 v[250:251], v23 offset:50176
    buffer_load_dwordx4 v[160:163], v2, s[32:35], s20 offen offset:1024 sc1
    s_waitcnt lgkmcnt(6)
    v_mfma_f32_16x16x32_bf16 v[108:111], v[236:239], v[164:167], v[108:111]
    ds_read_b64_tr_b16 v[232:233], v20 offset:49152
    v_mfma_f32_16x16x32_bf16 v[112:115], v[236:239], v[168:171], v[112:115]
    ds_read_b64_tr_b16 v[234:235], v20 offset:50176
    s_waitcnt lgkmcnt(6)
    v_mfma_f32_16x16x32_bf16 v[116:119], v[240:243], v[164:167], v[116:119]
    ds_read_b64_tr_b16 v[236:237], v21 offset:49152
    v_mfma_f32_16x16x32_bf16 v[120:123], v[240:243], v[168:171], v[120:123]
    ds_read_b64_tr_b16 v[238:239], v21 offset:50176
    s_waitcnt lgkmcnt(6)
    s_waitcnt vmcnt(4)
    v_mfma_f32_16x16x32_bf16 v[124:127], v[244:247], v[140:143], v[124:127]
    ds_read_b64_tr_b16 v[240:241], v22 offset:53248
    v_mfma_f32_16x16x32_bf16 v[128:131], v[244:247], v[144:147], v[128:131]
    ds_read_b64_tr_b16 v[242:243], v22 offset:54272
    s_xor_b32 s96, s83, 15
    s_lshl_b32 s97, s96, 11
    s_add_u32 s20, s97, s19
    buffer_load_dwordx4 v[164:167], v2, s[32:35], s20 offen sc1
    s_waitcnt lgkmcnt(6)
    v_mfma_f32_16x16x32_bf16 v[132:135], v[248:251], v[140:143], v[132:135]
    ds_read_b64_tr_b16 v[244:245], v23 offset:53248
    v_mfma_f32_16x16x32_bf16 v[136:139], v[248:251], v[144:147], v[136:139]
    ds_read_b64_tr_b16 v[246:247], v23 offset:54272
    buffer_load_dwordx4 v[168:171], v2, s[32:35], s20 offen offset:1024 sc1
    buffer_load_dwordx2 v[26:27], v25, s[32:35], s18 offen sc1
    s_waitcnt lgkmcnt(6)
    v_mfma_f32_16x16x32_bf16 v[108:111], v[232:235], v[140:143], v[108:111]
    ds_read_b64_tr_b16 v[248:249], v20 offset:53248
    v_mfma_f32_16x16x32_bf16 v[112:115], v[232:235], v[144:147], v[112:115]
    ds_read_b64_tr_b16 v[250:251], v20 offset:54272
    s_waitcnt lgkmcnt(6)
    v_mfma_f32_16x16x32_bf16 v[116:119], v[236:239], v[140:143], v[116:119]
    ds_read_b64_tr_b16 v[232:233], v21 offset:53248
    v_mfma_f32_16x16x32_bf16 v[120:123], v[236:239], v[144:147], v[120:123]
    ds_read_b64_tr_b16 v[234:235], v21 offset:54272
    s_waitcnt lgkmcnt(6)
    s_waitcnt vmcnt(5)
    v_mfma_f32_16x16x32_bf16 v[124:127], v[240:243], v[148:151], v[124:127]
    ds_read_b64_tr_b16 v[236:237], v22 offset:57344
    v_mfma_f32_16x16x32_bf16 v[128:131], v[240:243], v[152:155], v[128:131]
    ds_read_b64_tr_b16 v[238:239], v22 offset:58368
    s_waitcnt lgkmcnt(6)
    v_mfma_f32_16x16x32_bf16 v[132:135], v[244:247], v[148:151], v[132:135]
    ds_read_b64_tr_b16 v[240:241], v23 offset:57344
    v_mfma_f32_16x16x32_bf16 v[136:139], v[244:247], v[152:155], v[136:139]
    ds_read_b64_tr_b16 v[242:243], v23 offset:58368
    s_waitcnt lgkmcnt(6)
    v_mfma_f32_16x16x32_bf16 v[108:111], v[248:251], v[148:151], v[108:111]
    ds_read_b64_tr_b16 v[244:245], v20 offset:57344
    v_mfma_f32_16x16x32_bf16 v[112:115], v[248:251], v[152:155], v[112:115]
    ds_read_b64_tr_b16 v[246:247], v20 offset:58368
    s_waitcnt lgkmcnt(6)
    v_mfma_f32_16x16x32_bf16 v[116:119], v[232:235], v[148:151], v[116:119]
    ds_read_b64_tr_b16 v[248:249], v21 offset:57344
    v_mfma_f32_16x16x32_bf16 v[120:123], v[232:235], v[152:155], v[120:123]
    ds_read_b64_tr_b16 v[250:251], v21 offset:58368
    s_waitcnt lgkmcnt(6)
    s_waitcnt vmcnt(3)
    v_mfma_f32_16x16x32_bf16 v[124:127], v[236:239], v[156:159], v[124:127]
    ds_read_b64_tr_b16 v[232:233], v22 offset:61440
    v_mfma_f32_16x16x32_bf16 v[128:131], v[236:239], v[160:163], v[128:131]
    ds_read_b64_tr_b16 v[234:235], v22 offset:62464
    s_waitcnt lgkmcnt(6)
    v_mfma_f32_16x16x32_bf16 v[132:135], v[240:243], v[156:159], v[132:135]
    ds_read_b64_tr_b16 v[236:237], v23 offset:61440
    v_mfma_f32_16x16x32_bf16 v[136:139], v[240:243], v[160:163], v[136:139]
    ds_read_b64_tr_b16 v[238:239], v23 offset:62464
    s_waitcnt lgkmcnt(6)
    v_mfma_f32_16x16x32_bf16 v[108:111], v[244:247], v[156:159], v[108:111]
    ds_read_b64_tr_b16 v[240:241], v20 offset:61440
    v_mfma_f32_16x16x32_bf16 v[112:115], v[244:247], v[160:163], v[112:115]
    ds_read_b64_tr_b16 v[242:243], v20 offset:62464
    s_waitcnt lgkmcnt(6)
    v_mfma_f32_16x16x32_bf16 v[116:119], v[248:251], v[156:159], v[116:119]
    ds_read_b64_tr_b16 v[244:245], v21 offset:61440
    v_mfma_f32_16x16x32_bf16 v[120:123], v[248:251], v[160:163], v[120:123]
    ds_read_b64_tr_b16 v[246:247], v21 offset:62464
    s_waitcnt lgkmcnt(6)
    s_waitcnt vmcnt(1)
    v_mfma_f32_16x16x32_bf16 v[124:127], v[232:235], v[164:167], v[124:127]
    v_mfma_f32_16x16x32_bf16 v[128:131], v[232:235], v[168:171], v[128:131]
    s_waitcnt lgkmcnt(4)
    v_mfma_f32_16x16x32_bf16 v[132:135], v[236:239], v[164:167], v[132:135]
    v_mfma_f32_16x16x32_bf16 v[136:139], v[236:239], v[168:171], v[136:139]
    s_waitcnt lgkmcnt(2)
    v_mfma_f32_16x16x32_bf16 v[108:111], v[240:243], v[164:167], v[108:111]
    v_mfma_f32_16x16x32_bf16 v[112:115], v[240:243], v[168:171], v[112:115]
    s_waitcnt lgkmcnt(0)
    v_mfma_f32_16x16x32_bf16 v[116:119], v[244:247], v[164:167], v[116:119]
    v_mfma_f32_16x16x32_bf16 v[120:123], v[244:247], v[168:171], v[120:123]
    s_setprio 0
    s_lshl_b32 s13, s3, 12
    v_add_u32 v4, s13, v2
    ds_write_b128 v4, v[124:127]
    ds_write_b128 v4, v[128:131] offset:1024
    ds_write_b128 v4, v[132:135] offset:2048
    ds_write_b128 v4, v[136:139] offset:3072
    v_permlane16_swap_b32 v108, v112
    v_permlane16_swap_b32 v109, v113
    v_permlane16_swap_b32 v110, v114
    v_permlane16_swap_b32 v111, v115
    v_permlane16_swap_b32 v116, v120
    v_permlane16_swap_b32 v117, v121
    v_permlane16_swap_b32 v118, v122
    v_permlane16_swap_b32 v119, v123
    s_xor_b32 s96, s3, 4
    s_lshl_b32 s13, s96, 12
    v_and_b32 v5, 15, v1
    v_lshl_add_u32 v5, v5, 4, s13
    v_bfe_u32 v9, v1, 4, 1
    v_lshl_add_u32 v5, v9, 10, v5
    v_lshrrev_b32 v9, 5, v1
    v_lshl_add_u32 v5, v9, 9, v5
    s_lshl_b32 s96, s76, 11
    s_and_b32 s97, s3, 3
    s_lshl_b32 s98, s97, 9
    s_add_u32 s99, s96, s98
    s_add_u32 s13, s99, 131072
    v_and_b32 v6, 31, v1
    v_lshl_add_u32 v6, v6, 4, s13
    v_lshrrev_b32 v9, 5, v1
    v_lshl_add_u32 v6, v9, 3, v6
    s_lshl_b32 s96, s76, 6
    s_add_u32 s13, s96, 139008
    v_and_b32 v7, 7, v1
    v_lshl_add_u32 v7, v7, 2, s13
    v_lshrrev_b32 v9, 5, v1
    v_lshl_add_u32 v7, v9, 5, v7
    s_lshl_b32 s96, s21, 15
    s_lshl_b32 s97, s3, 8
    s_add_u32 s98, s96, s97
    s_add_u32 s19, s98, 12582912
    v_and_b32 v44, 15, v1
    v_lshlrev_b32 v44, 4, v44
    v_lshrrev_b32 v9, 4, v1
    v_lshl_add_u32 v44, v9, 11, v44
    v_mov_b32 v236, 0x3f803f80
    s_waitcnt lgkmcnt(0)
    s_barrier
    ds_read_b128 v[124:127], v5
    ds_read_b128 v[128:131], v5 offset:256
    ds_read_b128 v[132:135], v5 offset:2048
    ds_read_b128 v[136:139], v5 offset:2304
    s_add_u32 s14, s80, 172032
    s_lshl2_add_u32 m0, s89, 35840
    s_nop 0
    buffer_load_dwordx4 v72, s[52:55], s14 offen nt lds
    s_lshl_b32 s96, s90, 7
    s_add_u32 s97, s96, s80
    s_add_u32 s14, s97, 172032
    s_lshl2_add_u32 m0, s89, 68608
    s_nop 0
    buffer_load_dwordx4 v72, s[56:59], s14 offen nt lds
    s_mov_b32 s14, s81
    s_lshl2_add_u32 m0, s89, 98304
    s_nop 0
    buffer_load_dwordx4 v73, s[60:63], s14 offen nt lds
    s_waitcnt lgkmcnt(3)
    v_pk_add_f32 v[108:109], v[108:109], v[124:125]
    v_pk_add_f32 v[110:111], v[110:111], v[126:127]
    s_waitcnt lgkmcnt(2)
    v_pk_add_f32 v[112:113], v[112:113], v[128:129]
    v_pk_add_f32 v[114:115], v[114:115], v[130:131]
    v_cvt_pk_bf16_f32 v108, 0, v108
    v_cvt_pk_bf16_f32 v109, 0, v109
    v_cvt_pk_bf16_f32 v110, 0, v110
    v_cvt_pk_bf16_f32 v111, 0, v111
    v_cvt_pk_bf16_f32 v112, 0, v112
    v_cvt_pk_bf16_f32 v113, 0, v113
    v_cvt_pk_bf16_f32 v114, 0, v114
    v_cvt_pk_bf16_f32 v115, 0, v115
    v_pk_mul_f32 v[108:109], v[108:109], v[76:77]
    v_pk_mul_f32 v[110:111], v[110:111], v[78:79]
    v_pk_mul_f32 v[112:113], v[112:113], v[80:81]
    v_pk_mul_f32 v[114:115], v[114:115], v[82:83]
    v_cvt_pk_bf16_f32 v108, 0, v108
    v_cvt_pk_bf16_f32 v109, 0, v109
    v_cvt_pk_bf16_f32 v110, 0, v110
    v_cvt_pk_bf16_f32 v111, 0, v111
    v_cvt_pk_bf16_f32 v112, 0, v112
    v_cvt_pk_bf16_f32 v113, 0, v113
    v_cvt_pk_bf16_f32 v114, 0, v114
    v_cvt_pk_bf16_f32 v115, 0, v115
    v_pk_add_f32 v[108:109], v[108:109], v[28:29]
    v_pk_add_f32 v[110:111], v[110:111], v[30:31]
    v_pk_add_f32 v[112:113], v[112:113], v[32:33]
    v_pk_add_f32 v[114:115], v[114:115], v[34:35]
    v_cvt_pk_bf16_f32 v12, v108, v109
    v_cvt_pk_bf16_f32 v13, v110, v111
    v_cvt_pk_bf16_f32 v14, v112, v113
    v_cvt_pk_bf16_f32 v15, v114, v115
    s_waitcnt lgkmcnt(1)
    v_pk_add_f32 v[116:117], v[116:117], v[132:133]
    v_pk_add_f32 v[118:119], v[118:119], v[134:135]
    s_waitcnt lgkmcnt(0)
    v_pk_add_f32 v[120:121], v[120:121], v[136:137]
    v_pk_add_f32 v[122:123], v[122:123], v[138:139]
    v_cvt_pk_bf16_f32 v116, 0, v116
    v_cvt_pk_bf16_f32 v117, 0, v117
    v_cvt_pk_bf16_f32 v118, 0, v118
    v_cvt_pk_bf16_f32 v119, 0, v119
    v_cvt_pk_bf16_f32 v120, 0, v120
    v_cvt_pk_bf16_f32 v121, 0, v121
    v_cvt_pk_bf16_f32 v122, 0, v122
    v_cvt_pk_bf16_f32 v123, 0, v123
    v_pk_mul_f32 v[116:117], v[116:117], v[84:85]
    v_pk_mul_f32 v[118:119], v[118:119], v[86:87]
    v_pk_mul_f32 v[120:121], v[120:121], v[88:89]
    v_pk_mul_f32 v[122:123], v[122:123], v[90:91]
    v_cvt_pk_bf16_f32 v116, 0, v116
    v_cvt_pk_bf16_f32 v117, 0, v117
    v_cvt_pk_bf16_f32 v118, 0, v118
    v_cvt_pk_bf16_f32 v119, 0, v119
    v_cvt_pk_bf16_f32 v120, 0, v120
    v_cvt_pk_bf16_f32 v121, 0, v121
    v_cvt_pk_bf16_f32 v122, 0, v122
    v_cvt_pk_bf16_f32 v123, 0, v123
    v_pk_add_f32 v[116:117], v[116:117], v[36:37]
    v_pk_add_f32 v[118:119], v[118:119], v[38:39]
    v_pk_add_f32 v[120:121], v[120:121], v[40:41]
    v_pk_add_f32 v[122:123], v[122:123], v[42:43]
    v_cvt_pk_bf16_f32 v16, v116, v117
    v_cvt_pk_bf16_f32 v17, v118, v119
    v_cvt_pk_bf16_f32 v18, v120, v121
    v_cvt_pk_bf16_f32 v19, v122, v123
    v_mfma_f32_32x32x16_bf16 v[124:139], v[92:95], v[12:15], 0
    s_nop 0
    v_mfma_f32_32x32x16_bf16 v[124:139], v[96:99], v[16:19], v[124:139]
    v_dot2_f32_bf16 v232, v12, v12, 0
    v_dot2_f32_bf16 v233, v13, v13, 0
    v_dot2_f32_bf16 v232, v14, v14, v232
    v_dot2_f32_bf16 v233, v15, v15, v233
    v_dot2_f32_bf16 v232, v16, v16, v232
    v_dot2_f32_bf16 v233, v17, v17, v233
    v_dot2_f32_bf16 v232, v18, v18, v232
    v_dot2_f32_bf16 v233, v19, v19, v233
    s_nop 2
    v_add_f32 v234, v232, v233
    v_add_f32 v232, v232, v233
    s_nop 1
    v_permlane32_swap_b32 v232, v234
    s_mov_b32 exec_lo, 0
    v_add_f32 v124, v232, v234
    v_mov_b32 v125, v126
    s_mov_b32 exec_lo, -1
    ds_write_b64 v6, v[124:125]
    ds_write_b32 v7, v68
    ds_write_b32 v7, v69 offset:128
    ds_write_b32 v7, v70 offset:256
    ds_write_b32 v7, v71 offset:384
    v_add_u32 v4, 131072, v2
    v_and_b32 v5, 7, v1
    v_lshlrev_b32 v5, 15, v5
    v_bfe_u32 v9, v1, 3, 1
    v_lshl_add_u32 v5, v9, 12, v5
    s_lshl4_add_u32 s96, s21, s12
    s_lshl_b32 s97, s96, 11
    s_add_u32 s13, s97, 12582912
    s_and_b32 s96, s12, 1
    s_lshr_b32 s97, s21, 2
    s_and_b32 s98, s21, 3
    s_lshl_b32 s99, s98, 6
    s_lshl1_add_u32 s98, s97, s99
    s_lshl_b32 s97, s98, 12
    s_lshr_b32 s99, s12, 1
    s_lshl_b32 s98, s99, 6
    s_add_u32 s99, s97, s98
    s_lshl2_add_u32 s97, s96, s99
    s_add_u32 s98, s97, 1048576
    s_add_u32 s16, s98, 1536
    s_waitcnt lgkmcnt(0)
    s_barrier
    s_cmp_lg_u32 s3, 0
    s_cbranch_scc1 L_PE
    s_setprio 3
    ds_read_b128 v[124:127], v4 offset:0
    ds_read_b128 v[128:131], v4 offset:2048
    ds_read_b128 v[132:135], v4 offset:1024
    ds_read_b128 v[136:139], v4 offset:3072
    s_waitcnt lgkmcnt(2)
    v_pk_add_f32 v[124:125], v[124:125], v[128:129]
    v_pk_add_f32 v[126:127], v[126:127], v[130:131]
    v_add_f32 v125, v125, v127
    v_mov_b32 v127, s4
    s_waitcnt lgkmcnt(0)
    v_pk_add_f32 v[132:133], v[132:133], v[136:137]
    v_pk_add_f32 v[134:135], v[134:135], v[138:139]
    v_add_f32 v133, v133, v135
    v_mov_b32 v135, s4
    buffer_store_dwordx4 v[124:127], v2, s[32:35], s13 offen sc1
    buffer_store_dwordx4 v[132:135], v2, s[32:35], s13 offen offset:1024 sc1
    s_mov_b64 exec, 0xffff
    buffer_store_dword v127, v5, s[32:35], s16 offen sc1
    s_setprio 0
    s_mov_b64 exec, -1
L_PE:
    s_load_dwordx2 s[24:25], s[32:33], s92 offset:1536 glc
    s_and_b32 s96, s3, 3
    s_mul_i32 s97, s96, 4608
    s_lshl_b32 s98, s76, 6
    s_add_u32 s16, s97, s98
    v_and_b32 v23, 31, v1
    v_mul_u32_u24 v23, 144, v23
    v_lshrrev_b32 v9, 5, v1
    v_lshl_add_u32 v23, v9, 5, v23
    v_add_u32 v23, s16, v23
    ds_write_b128 v23, v[12:15]
    ds_write_b128 v23, v[16:19] offset:16
    v_add_u32 v23, 139776, v23
    s_lshl3_add_u32 s96, s21, s3
    s_lshl_b32 s97, s96, 5
    s_sub_u32 s15, 4094, s97
    v_and_b32 v22, 15, v1
    v_lshlrev_b32 v22, 1, v22
    v_sub_u32 v22, s15, v22
    s_lshl_b32 s96, s3, 7
    s_add_u32 s15, s96, 135168
    v_and_b32 v8, 15, v1
    v_lshl_add_u32 v8, v8, 3, s15
    s_and_b32 s96, s3, 3
    s_lshl_b32 s97, s96, 8
    s_add_u32 s15, s97, 135168
    v_and_b32 v10, 31, v1
    v_lshl_add_u32 v10, v10, 3, s15
    v_and_b32 v11, 7, v1
    v_lshlrev_b32 v11, 3, v11
    v_add_u32 v11, 136192, v11
    s_waitcnt vmcnt(3)
    v_cmp_ne_u32 vcc, s4, v27
    s_cbranch_vccz TOK_38
POLL_39:
    buffer_load_dwordx2 v[26:27], v25, s[32:35], s18 offen sc1
    s_waitcnt vmcnt(0)
    v_cmp_ne_u32 vcc, s4, v27
    s_cbranch_vccz PDONE_40
    s_add_u32 s5, s5, 1
    s_cmp_lt_u32 s5, 300000
    s_cbranch_scc1 POLL_39
PDONE_40:
TOK_38:
    v_add_f32_dpp v26, v26, v26 quad_perm:[1,0,3,2] row_mask:0xf bank_mask:0xf
    s_nop 1
    v_add_f32_dpp v26, v26, v26 quad_perm:[2,3,0,1] row_mask:0xf bank_mask:0xf
    s_nop 1
    v_add_f32_dpp v26, v26, v26 row_half_mirror row_mask:0xf bank_mask:0xf
    s_nop 1
    v_add_f32_dpp v26, v26, v26 row_ror:8 row_mask:0xf bank_mask:0xf
    s_cmp_lg_u32 s3, 1
    s_cbranch_scc1 L_NOCT
    v_and_b32 v5, 15, v1
    v_lshlrev_b32 v5, 3, v5
    v_add_u32 v5, 139008, v5
    ds_read_b64 v[150:151], v5
    ds_read_b64 v[154:155], v5 offset:128
    ds_read_b64 v[156:157], v5 offset:384
    s_waitcnt lgkmcnt(0)
    v_lshlrev_b32 v148, 16, v150
    v_and_b32 v149, s6, v150
    v_lshlrev_b32 v150, 16, v151
    v_and_b32 v151, s6, v151
    v_lshlrev_b32 v152, 16, v154
    v_and_b32 v153, s6, v154
    v_lshlrev_b32 v154, 16, v155
    v_and_b32 v155, s6, v155
L_NOCT:
    s_cmp_lt_u32 s3, 4
    s_cbranch_scc1 L_NOST
    s_sub_u32 s96, s3, 4
    s_lshl_b32 s97, s96, 12
    s_add_u32 s13, s97, 32768
    v_add_u32 v4, s13, v2
    v_add_u32 v7, 65536, v4
    ds_write_b128 v4, v[176:179] offset:16384
    ds_write_b128 v4, v[180:183]
    ds_write_b128 v4, v[184:187] offset:49152
    ds_write_b128 v4, v[188:191] offset:32768
    ds_write_b128 v4, v[192:195] offset:17408
    ds_write_b128 v4, v[196:199] offset:1024
    ds_write_b128 v4, v[200:203] offset:50176
    ds_write_b128 v4, v[204:207] offset:33792
    ds_write_b128 v4, v[208:211] offset:18432
    ds_write_b128 v4, v[212:215] offset:2048
    ds_write_b128 v4, v[216:219] offset:51200
    ds_write_b128 v4, v[220:223] offset:34816
L_NOST:
    s_branch SCHK_36
SPOLL_35:
    s_load_dwordx2 s[24:25], s[32:33], s92 offset:1536 glc
SCHK_36:
    s_add_u32 s5, s5, 1
    s_cmp_ge_u32 s5, 300000
    s_waitcnt lgkmcnt(0)
    s_cbranch_scc1 SDONE_37
    s_cmp_lg_u32 s24, s4
    s_cbranch_scc1 SPOLL_35
    s_cmp_lg_u32 s25, s4
    s_cbranch_scc1 SPOLL_35
SDONE_37:
    s_barrier
    s_mov_b32 s13, s19
    buffer_load_dwordx4 v[124:127], v44, s[32:35], s13 offen sc1
    s_add_u32 s13, s19, 8192
    buffer_load_dwordx4 v[128:131], v44, s[32:35], s13 offen sc1
    s_add_u32 s13, s19, 16384
    buffer_load_dwordx4 v[132:135], v44, s[32:35], s13 offen sc1
    s_add_u32 s13, s19, 24576
    buffer_load_dwordx4 v[136:139], v44, s[32:35], s13 offen sc1
    v_lshlrev_b32 v28, 16, v12
    v_and_b32 v29, s6, v12
    v_lshlrev_b32 v30, 16, v13
    v_and_b32 v31, s6, v13
    v_lshlrev_b32 v32, 16, v14
    v_and_b32 v33, s6, v14
    v_lshlrev_b32 v34, 16, v15
    v_and_b32 v35, s6, v15
    v_lshlrev_b32 v36, 16, v16
    v_and_b32 v37, s6, v16
    v_lshlrev_b32 v38, 16, v17
    v_and_b32 v39, s6, v17
    v_lshlrev_b32 v40, 16, v18
    v_and_b32 v41, s6, v18
    v_lshlrev_b32 v42, 16, v19
    v_and_b32 v43, s6, v19
    v_mul_u32_u24_dpp v92, v68, v52 row_newbcast:0 row_mask:0xf bank_mask:0xf
    v_and_b32_dpp v93, v68, v53 row_newbcast:0 row_mask:0xf bank_mask:0xf
    v_mul_u32_u24_dpp v94, v68, v52 row_newbcast:1 row_mask:0xf bank_mask:0xf
    v_and_b32_dpp v95, v68, v53 row_newbcast:1 row_mask:0xf bank_mask:0xf
    v_mul_u32_u24_dpp v96, v68, v52 row_newbcast:2 row_mask:0xf bank_mask:0xf
    v_and_b32_dpp v97, v68, v53 row_newbcast:2 row_mask:0xf bank_mask:0xf
    v_mul_u32_u24_dpp v98, v68, v52 row_newbcast:3 row_mask:0xf bank_mask:0xf
    v_and_b32_dpp v99, v68, v53 row_newbcast:3 row_mask:0xf bank_mask:0xf
    v_mul_u32_u24_dpp v100, v68, v52 row_newbcast:4 row_mask:0xf bank_mask:0xf
    v_and_b32_dpp v101, v68, v53 row_newbcast:4 row_mask:0xf bank_mask:0xf
    v_mul_u32_u24_dpp v102, v68, v52 row_newbcast:5 row_mask:0xf bank_mask:0xf
    v_and_b32_dpp v103, v68, v53 row_newbcast:5 row_mask:0xf bank_mask:0xf
    v_mul_u32_u24_dpp v104, v68, v52 row_newbcast:6 row_mask:0xf bank_mask:0xf
    v_and_b32_dpp v105, v68, v53 row_newbcast:6 row_mask:0xf bank_mask:0xf
    v_mul_u32_u24_dpp v106, v68, v52 row_newbcast:7 row_mask:0xf bank_mask:0xf
    v_and_b32_dpp v107, v68, v53 row_newbcast:7 row_mask:0xf bank_mask:0xf
    v_mul_u32_u24_dpp v108, v69, v52 row_newbcast:0 row_mask:0xf bank_mask:0xf
    v_and_b32_dpp v109, v69, v53 row_newbcast:0 row_mask:0xf bank_mask:0xf
    v_mul_u32_u24_dpp v110, v69, v52 row_newbcast:1 row_mask:0xf bank_mask:0xf
    v_and_b32_dpp v111, v69, v53 row_newbcast:1 row_mask:0xf bank_mask:0xf
    v_mul_u32_u24_dpp v112, v69, v52 row_newbcast:2 row_mask:0xf bank_mask:0xf
    v_and_b32_dpp v113, v69, v53 row_newbcast:2 row_mask:0xf bank_mask:0xf
    v_mul_u32_u24_dpp v114, v69, v52 row_newbcast:3 row_mask:0xf bank_mask:0xf
    v_and_b32_dpp v115, v69, v53 row_newbcast:3 row_mask:0xf bank_mask:0xf
    v_mul_u32_u24_dpp v116, v69, v52 row_newbcast:4 row_mask:0xf bank_mask:0xf
    v_and_b32_dpp v117, v69, v53 row_newbcast:4 row_mask:0xf bank_mask:0xf
    v_mul_u32_u24_dpp v118, v69, v52 row_newbcast:5 row_mask:0xf bank_mask:0xf
    v_and_b32_dpp v119, v69, v53 row_newbcast:5 row_mask:0xf bank_mask:0xf
    v_mul_u32_u24_dpp v120, v69, v52 row_newbcast:6 row_mask:0xf bank_mask:0xf
    v_and_b32_dpp v121, v69, v53 row_newbcast:6 row_mask:0xf bank_mask:0xf
    v_mul_u32_u24_dpp v122, v69, v52 row_newbcast:7 row_mask:0xf bank_mask:0xf
    v_and_b32_dpp v123, v69, v53 row_newbcast:7 row_mask:0xf bank_mask:0xf
    s_waitcnt vmcnt(0)
    v_bitop3_b32 v4, v127, v131, s4 bitop3:0x7e
    v_bitop3_b32 v4, v4, v135, s4 bitop3:0xf6
    v_bitop3_b32 v4, v4, v139, s4 bitop3:0xf6
    v_cmp_ne_u32 vcc, 0, v4
    s_cbranch_vccz TOK_42
POLL_43:
    s_mov_b32 s13, s19
    buffer_load_dwordx4 v[124:127], v44, s[32:35], s13 offen sc1
    s_add_u32 s13, s19, 8192
    buffer_load_dwordx4 v[128:131], v44, s[32:35], s13 offen sc1
    s_add_u32 s13, s19, 16384
    buffer_load_dwordx4 v[132:135], v44, s[32:35], s13 offen sc1
    s_add_u32 s13, s19, 24576
    buffer_load_dwordx4 v[136:139], v44, s[32:35], s13 offen sc1
    s_waitcnt vmcnt(0)
    v_bitop3_b32 v4, v127, v131, s4 bitop3:0x7e
    v_bitop3_b32 v4, v4, v135, s4 bitop3:0xf6
    v_bitop3_b32 v4, v4, v139, s4 bitop3:0xf6
    v_cmp_ne_u32 vcc, 0, v4
    s_cbranch_vccz PDONE_44
    s_add_u32 s5, s5, 1
    s_cmp_lt_u32 s5, 300000
    s_cbranch_scc1 POLL_43
PDONE_44:
TOK_42:
    s_lshl2_add_u32 s96, s74, s75
    s_lshl_b32 s97, s96, 11
    s_lshl_b32 s98, s3, 8
    s_add_u32 s99, s97, s98
    s_add_u32 s15, s99, 20971520
    v_lshlrev_b32 v44, 7, v1
    s_mov_b64 exec, 3
    buffer_load_dword v44, v44, s[32:35], s15 offen
    s_mov_b64 exec, -1
    s_add_u32 s15, s81, 4096
    s_lshl2_add_u32 m0, s89, 99328
    s_nop 0
    buffer_load_dwordx4 v73, s[60:63], s15 offen nt lds
    v_pk_add_f32 v[124:125], v[124:125], v[128:129]
    v_pk_add_f32 v[132:133], v[132:133], v[136:137]
    v_add_f32 v126, v126, v130
    v_add_f32 v134, v134, v138
    v_pk_add_f32 v[124:125], v[124:125], v[132:133]
    v_add_f32 v126, v126, v134
    v_mov_b32 v127, v125
    s_nop 0
    v_permlane32_swap_b32 v124, v126
    v_permlane32_swap_b32 v125, v127
    v_add_f32 v124, v124, v126
    v_add_f32 v125, v125, v127
    s_nop 1
    v_permlane16_swap_b32 v124, v125
    v_add_f32 v127, v124, v125
    v_add_f32 v124, v124, v125
    s_nop 1
    v_permlane16_swap_b32 v124, v127
    v_mul_f32 v126, 0x3a800000, v124
    v_mul_f32 v124, 0x3a800000, v124
    s_nop 1
    v_permlane32_swap_b32 v124, v126
    v_fma_f32 v21, -v124, v124, v126
    v_cvt_pk_bf16_f32 v20, 0, v124
    v_max_f32 v21, 0, v21
    v_cvt_pk_bf16_f32 v21, 0, v21
    v_add_f32 v21, 0x3727c5ac, v21
    v_cvt_pk_bf16_f32 v21, 0, v21
    v_sqrt_f32 v21, v21
    s_nop 0
    v_cvt_pk_bf16_f32 v21, 0, v21
    s_lshl3_add_u32 s13, s3, 136192
    v_rcp_f32 v21, v21
    v_fma_f32 v127, -v20, v26, v127
    v_mov_b32 v5, s13
    v_mul_f32 v127, v127, v21
    ds_write_b64 v8, v[20:21]
    s_movk_i32 s13, 0xfff
    v_ashrrev_i32 v124, 31, v127
    v_or_b32 v124, 0x80000000, v124
    v_xor_b32 v124, v124, v127
    v_bfi_b32 v48, s13, v22, v124
    s_nop 1
    v_min_u32_dpp v49, v48, v48 row_ror:8 row_mask:0xf bank_mask:0xf
    v_max_u32_dpp v48, v48, v48 row_ror:8 row_mask:0xf bank_mask:0xf
    s_nop 1
    v_min_u32_dpp v50, v48, v48 row_ror:4 row_mask:0xf bank_mask:0xf
    v_max_u32_dpp v49, v49, v49 row_ror:4 row_mask:0xf bank_mask:0xf
    v_max_u32_dpp v48, v48, v48 row_ror:4 row_mask:0xf bank_mask:0xf
    v_max_u32 v49, v49, v50
    s_nop 0
    v_min_u32_dpp v50, v48, v48 row_ror:2 row_mask:0xf bank_mask:0xf
    v_max_u32_dpp v49, v49, v49 row_ror:2 row_mask:0xf bank_mask:0xf
    v_max_u32_dpp v48, v48, v48 row_ror:2 row_mask:0xf bank_mask:0xf
    v_max_u32 v49, v49, v50
    s_nop 0
    v_min_u32_dpp v50, v48, v48 row_ror:1 row_mask:0xf bank_mask:0xf
    v_max_u32_dpp v49, v49, v49 row_ror:1 row_mask:0xf bank_mask:0xf
    v_max_u32_dpp v48, v48, v48 row_ror:1 row_mask:0xf bank_mask:0xf
    v_max_u32 v49, v49, v50
    ds_write_b64 v5, v[48:49]
    v_and_b32 v6, 3, v1
    v_lshlrev_b32 v6, 18, v6
    v_bfe_u32 v9, v1, 2, 2
    v_lshl_add_u32 v6, v9, 13, v6
    s_and_b32 s96, s21, 1
    s_and_b32 s97, s12, 7
    s_lshr_b32 s98, s12, 3
    s_lshl3_add_u32 s99, s97, s98
    s_lshl_b32 s97, s99, 12
    s_lshr_b32 s98, s21, 1
    s_lshl_b32 s99, s98, 6
    s_add_u32 s98, s97, s99
    s_lshl4_add_u32 s97, s96, s98
    s_add_u32 s99, s97, 1048576
    s_add_u32 s14, s99, 2560
    s_waitcnt lgkmcnt(0)
    s_barrier
    s_cmp_ge_u32 s3, 2
    s_cbranch_scc1 L_PR1
    s_setprio 3
L_PR1:
    ds_read_b64 v[48:49], v11
    ds_read_b64 v[20:21], v10
    s_waitcnt lgkmcnt(1)
    v_min_u32_dpp v50, v48, v48 quad_perm:[1,0,3,2] row_mask:0xf bank_mask:0xf
    v_max_u32_dpp v49, v49, v49 quad_perm:[1,0,3,2] row_mask:0xf bank_mask:0xf
    v_max_u32_dpp v48, v48, v48 quad_perm:[1,0,3,2] row_mask:0xf bank_mask:0xf
    v_max_u32 v49, v49, v50
    s_nop 0
    v_min_u32_dpp v50, v48, v48 quad_perm:[2,3,0,1] row_mask:0xf bank_mask:0xf
    v_max_u32_dpp v49, v49, v49 quad_perm:[2,3,0,1] row_mask:0xf bank_mask:0xf
    v_max_u32_dpp v48, v48, v48 quad_perm:[2,3,0,1] row_mask:0xf bank_mask:0xf
    v_max_u32 v49, v49, v50
    s_nop 0
    v_min_u32_dpp v50, v48, v48 row_half_mirror row_mask:0xf bank_mask:0xf
    v_max_u32_dpp v49, v49, v49 row_half_mirror row_mask:0xf bank_mask:0xf
    v_max_u32_dpp v48, v48, v48 row_half_mirror row_mask:0xf bank_mask:0xf
    v_max_u32 v49, v49, v50
    v_or_b32 v50, 1, v49
    v_mov_b32 v49, s4
    v_mov_b32 v51, s4
    s_cmp_lg_u32 s3, 0
    s_cbranch_scc1 L_NOF
    s_mov_b64 exec, 0xffff
    buffer_store_dwordx4 v[48:51], v6, s[32:35], s14 offen sc1
    s_mov_b64 exec, -1
L_NOF:
    s_cmp_lg_u32 s3, 1
    s_cbranch_scc1 L_NOC
    v_and_b32 v4, 16, v1
    v_cmp_eq_u32 vcc, 0, v4
    s_nop 1
    v_cndmask_b32 v4, v50, v48, vcc
    v_not_b32 v4, v4
    v_bfe_u32 v4, v4, 1, 7
    v_lshlrev_b32 v6, 3, v4
    v_mul_u32_u24 v4, 144, v4
    v_add_u32 v6, 135168, v6
    v_and_b32 v5, 15, v1
    v_lshlrev_b32 v5, 3, v5
    v_add_u32 v4, v4, v5
    ds_read_b64 v[128:129], v6
    ds_read_b64 v[124:125], v4 offset:0
    v_and_b32 v6, 15, v1
    v_lshlrev_b32 v6, 4, v6
    v_bfe_u32 v9, v1, 4, 1
    v_lshl_add_u32 v6, v9, 14, v6
    v_lshrrev_b32 v9, 5, v1
    v_lshl_add_u32 v6, v9, 12, v6
    v_bfe_u32 v7, v1, 4, 1
    v_lshlrev_b32 v7, 14, v7
    s_lshl_b32 s96, s21, 15
    s_lshl_b32 s97, s12, 8
    s_add_u32 s98, s96, s97
    s_add_u32 s13, s98, 33554432
    s_lshl_b32 s96, s21, 15
    s_lshl3_add_u32 s97, s12, s96
    s_add_u32 s98, s97, 8192
    s_add_u32 s16, s98, 33554432
    v_mov_b32 v127, s4
    s_waitcnt lgkmcnt(0)
    v_lshlrev_b32 v132, 16, v124
    v_and_b32 v133, s6, v124
    v_lshlrev_b32 v134, 16, v125
    v_and_b32 v135, s6, v125
    v_pk_add_f32 v[132:133], v[132:133], v[128:129] op_sel_hi:[1,0] neg_lo:[0,1] neg_hi:[0,1]
    v_pk_add_f32 v[134:135], v[134:135], v[128:129] op_sel_hi:[1,0] neg_lo:[0,1] neg_hi:[0,1]
    v_cvt_pk_bf16_f32 v132, 0, v132
    v_cvt_pk_bf16_f32 v133, 0, v133
    v_cvt_pk_bf16_f32 v134, 0, v134
    v_cvt_pk_bf16_f32 v135, 0, v135
    v_pk_mul_f32 v[132:133], v[132:133], v[128:129] op_sel:[0,1]
    v_pk_mul_f32 v[134:135], v[134:135], v[128:129] op_sel:[0,1]
    v_cvt_pk_bf16_f32 v132, 0, v132
    v_cvt_pk_bf16_f32 v133, 0, v133
    v_cvt_pk_bf16_f32 v134, 0, v134
    v_cvt_pk_bf16_f32 v135, 0, v135
    v_pk_mul_f32 v[132:133], v[132:133], v[152:153]
    v_pk_mul_f32 v[134:135], v[134:135], v[154:155]
    v_cvt_pk_bf16_f32 v132, 0, v132
    v_cvt_pk_bf16_f32 v133, 0, v133
    v_cvt_pk_bf16_f32 v134, 0, v134
    v_cvt_pk_bf16_f32 v135, 0, v135
    v_pk_add_f32 v[132:133], v[132:133], v[148:149]
    v_pk_add_f32 v[134:135], v[134:135], v[150:151]
    v_mov_b32 v126, v125
    v_mov_b32 v125, s4
    s_mov_b32 exec_hi, 0
    v_cvt_pk_bf16_f32 v124, v132, v133
    v_cvt_pk_bf16_f32 v126, v134, v135
    s_mov_b32 exec_hi, -1
    v_dot2_f32_bf16 v128, v124, v156, 0
    v_mov_b32 v129, s4
    v_dot2_f32_bf16 v128, v126, v157, v128
    buffer_store_dwordx4 v[124:127], v6, s[32:35], s13 offen sc1
    s_nop 1
    v_add_f32_dpp v128, v128, v128 quad_perm:[1,0,3,2] row_mask:0xf bank_mask:0xf
    s_nop 1
    v_add_f32_dpp v128, v128, v128 quad_perm:[2,3,0,1] row_mask:0xf bank_mask:0xf
    s_nop 1
    v_add_f32_dpp v128, v128, v128 row_half_mirror row_mask:0xf bank_mask:0xf
    s_nop 1
    v_add_f32_dpp v128, v128, v128 row_ror:8 row_mask:0xf bank_mask:0xf
    s_mov_b64 exec, 0x10001
    buffer_store_dwordx2 v[128:129], v7, s[32:35], s16 offen sc1
    s_mov_b64 exec, -1
L_NOC:
    s_waitcnt lgkmcnt(0)
    s_setprio 0
    s_mov_b64 exec, 0xff
    buffer_store_dwordx4 v[224:227], v228, s[32:35], 0 offen sc1
    s_mov_b64 exec, -1
    s_add_u32 s13, s81, 8192
    s_lshl2_add_u32 m0, s89, 100352
    s_nop 0
    buffer_load_dwordx4 v73, s[60:63], s13 offen nt lds
    s_load_dwordx8 s[24:31], s[32:33], s92 offset:2560 glc
    v_pk_add_f32 v[76:77], v[28:29], v[20:21] op_sel_hi:[1,0] neg_lo:[0,1] neg_hi:[0,1]
    v_pk_add_f32 v[78:79], v[30:31], v[20:21] op_sel_hi:[1,0] neg_lo:[0,1] neg_hi:[0,1]
    v_pk_add_f32 v[80:81], v[32:33], v[20:21] op_sel_hi:[1,0] neg_lo:[0,1] neg_hi:[0,1]
    v_pk_add_f32 v[82:83], v[34:35], v[20:21] op_sel_hi:[1,0] neg_lo:[0,1] neg_hi:[0,1]
    v_pk_add_f32 v[84:85], v[36:37], v[20:21] op_sel_hi:[1,0] neg_lo:[0,1] neg_hi:[0,1]
    v_pk_add_f32 v[86:87], v[38:39], v[20:21] op_sel_hi:[1,0] neg_lo:[0,1] neg_hi:[0,1]
    v_pk_add_f32 v[88:89], v[40:41], v[20:21] op_sel_hi:[1,0] neg_lo:[0,1] neg_hi:[0,1]
    v_pk_add_f32 v[90:91], v[42:43], v[20:21] op_sel_hi:[1,0] neg_lo:[0,1] neg_hi:[0,1]
    v_cvt_pk_bf16_f32 v76, 0, v76
    v_cvt_pk_bf16_f32 v77, 0, v77
    v_cvt_pk_bf16_f32 v78, 0, v78
    v_cvt_pk_bf16_f32 v79, 0, v79
    v_cvt_pk_bf16_f32 v80, 0, v80
    v_cvt_pk_bf16_f32 v81, 0, v81
    v_cvt_pk_bf16_f32 v82, 0, v82
    v_cvt_pk_bf16_f32 v83, 0, v83
    v_cvt_pk_bf16_f32 v84, 0, v84
    v_cvt_pk_bf16_f32 v85, 0, v85
    v_cvt_pk_bf16_f32 v86, 0, v86
    v_cvt_pk_bf16_f32 v87, 0, v87
    v_cvt_pk_bf16_f32 v88, 0, v88
    v_cvt_pk_bf16_f32 v89, 0, v89
    v_cvt_pk_bf16_f32 v90, 0, v90
    v_cvt_pk_bf16_f32 v91, 0, v91
    v_pk_mul_f32 v[76:77], v[76:77], v[20:21] op_sel:[0,1]
    v_pk_mul_f32 v[78:79], v[78:79], v[20:21] op_sel:[0,1]
    v_pk_mul_f32 v[80:81], v[80:81], v[20:21] op_sel:[0,1]
    v_pk_mul_f32 v[82:83], v[82:83], v[20:21] op_sel:[0,1]
    v_pk_mul_f32 v[84:85], v[84:85], v[20:21] op_sel:[0,1]
    v_pk_mul_f32 v[86:87], v[86:87], v[20:21] op_sel:[0,1]
    v_pk_mul_f32 v[88:89], v[88:89], v[20:21] op_sel:[0,1]
    v_pk_mul_f32 v[90:91], v[90:91], v[20:21] op_sel:[0,1]
    v_cvt_pk_bf16_f32 v76, 0, v76
    v_cvt_pk_bf16_f32 v77, 0, v77
    v_cvt_pk_bf16_f32 v78, 0, v78
    v_cvt_pk_bf16_f32 v79, 0, v79
    v_cvt_pk_bf16_f32 v80, 0, v80
    v_cvt_pk_bf16_f32 v81, 0, v81
    v_cvt_pk_bf16_f32 v82, 0, v82
    v_cvt_pk_bf16_f32 v83, 0, v83
    v_cvt_pk_bf16_f32 v84, 0, v84
    v_cvt_pk_bf16_f32 v85, 0, v85
    v_cvt_pk_bf16_f32 v86, 0, v86
    v_cvt_pk_bf16_f32 v87, 0, v87
    v_cvt_pk_bf16_f32 v88, 0, v88
    v_cvt_pk_bf16_f32 v89, 0, v89
    v_cvt_pk_bf16_f32 v90, 0, v90
    v_cvt_pk_bf16_f32 v91, 0, v91
    v_pk_mul_f32 v[76:77], v[76:77], v[108:109]
    v_pk_mul_f32 v[78:79], v[78:79], v[110:111]
    v_pk_mul_f32 v[80:81], v[80:81], v[112:113]
    v_pk_mul_f32 v[82:83], v[82:83], v[114:115]
    v_pk_mul_f32 v[84:85], v[84:85], v[116:117]
    v_pk_mul_f32 v[86:87], v[86:87], v[118:119]
    v_pk_mul_f32 v[88:89], v[88:89], v[120:121]
    v_pk_mul_f32 v[90:91], v[90:91], v[122:123]
    v_cvt_pk_bf16_f32 v76, 0, v76
    v_cvt_pk_bf16_f32 v77, 0, v77
    v_cvt_pk_bf16_f32 v78, 0, v78
    v_cvt_pk_bf16_f32 v79, 0, v79
    v_cvt_pk_bf16_f32 v80, 0, v80
    v_cvt_pk_bf16_f32 v81, 0, v81
    v_cvt_pk_bf16_f32 v82, 0, v82
    v_cvt_pk_bf16_f32 v83, 0, v83
    v_cvt_pk_bf16_f32 v84, 0, v84
    v_cvt_pk_bf16_f32 v85, 0, v85
    v_cvt_pk_bf16_f32 v86, 0, v86
    v_cvt_pk_bf16_f32 v87, 0, v87
    v_cvt_pk_bf16_f32 v88, 0, v88
    v_cvt_pk_bf16_f32 v89, 0, v89
    v_cvt_pk_bf16_f32 v90, 0, v90
    v_cvt_pk_bf16_f32 v91, 0, v91
    v_pk_add_f32 v[76:77], v[76:77], v[92:93]
    v_pk_add_f32 v[78:79], v[78:79], v[94:95]
    v_pk_add_f32 v[80:81], v[80:81], v[96:97]
    v_pk_add_f32 v[82:83], v[82:83], v[98:99]
    v_pk_add_f32 v[84:85], v[84:85], v[100:101]
    v_pk_add_f32 v[86:87], v[86:87], v[102:103]
    v_pk_add_f32 v[88:89], v[88:89], v[104:105]
    v_pk_add_f32 v[90:91], v[90:91], v[106:107]
    v_cvt_pk_bf16_f32 v76, 0, v76
    v_cvt_pk_bf16_f32 v77, 0, v77
    v_cvt_pk_bf16_f32 v78, 0, v78
    v_cvt_pk_bf16_f32 v79, 0, v79
    v_cvt_pk_bf16_f32 v80, 0, v80
    v_cvt_pk_bf16_f32 v81, 0, v81
    v_cvt_pk_bf16_f32 v82, 0, v82
    v_cvt_pk_bf16_f32 v83, 0, v83
    v_cvt_pk_bf16_f32 v84, 0, v84
    v_cvt_pk_bf16_f32 v85, 0, v85
    v_cvt_pk_bf16_f32 v86, 0, v86
    v_cvt_pk_bf16_f32 v87, 0, v87
    v_cvt_pk_bf16_f32 v88, 0, v88
    v_cvt_pk_bf16_f32 v89, 0, v89
    v_cvt_pk_bf16_f32 v90, 0, v90
    v_cvt_pk_bf16_f32 v91, 0, v91
    s_lshr_b32 s96, s3, 2
    s_lshl_b32 s97, s96, 15
    s_and_b32 s98, s3, 3
    s_lshl_b32 s99, s98, 5
    s_add_u32 s96, s97, s99
    s_add_u32 s13, s96, 32768
    v_lshrrev_b32 v24, 4, v1
    v_lshlrev_b32 v24, 13, v24
    v_bfe_u32 v9, v1, 2, 2
    v_lshl_add_u32 v24, v9, 7, v24
    v_bfe_u32 v9, v1, 3, 2
    v_lshl_add_u32 v24, v9, 5, v24
    v_and_b32 v9, 3, v1
    v_lshl_add_u32 v24, v9, 3, v24
    v_xor_b32 v24, s13, v24
    s_lshl_b32 s13, s3, 6
    v_bfe_u32 v45, v1, 2, 1
    v_lshlrev_b32 v45, 9, v45
    v_bfe_u32 v9, v1, 3, 1
    v_lshl_add_u32 v45, v9, 12, v45
    v_lshrrev_b32 v9, 5, v1
    v_lshl_add_u32 v45, v9, 11, v45
    v_bfe_u32 v9, v1, 2, 2
    v_lshl_add_u32 v45, v9, 6, v45
    v_bfe_u32 v9, v1, 4, 1
    v_lshl_add_u32 v45, v9, 5, v45
    v_and_b32 v9, 3, v1
    v_lshl_add_u32 v45, v9, 3, v45
    v_xor_b32 v45, s13, v45
    v_add_u32 v45, 98304, v45
    v_and_b32 v46, 7, v1
    v_lshlrev_b32 v46, 4, v46
    v_lshrrev_b32 v9, 4, v1
    v_lshl_add_u32 v46, v9, 7, v46
    v_add_u32 v46, 136704, v46
    s_lshl4_add_u32 s13, s3, 136256
    v_mov_b32 v4, s13
    v_and_b32 v5, 7, v1
    v_lshlrev_b32 v5, 4, v5
    v_add_u32 v5, 136256, v5
    v_and_b32 v8, 8, v1
    v_cmp_eq_u32 s[22:23], 0, v8
    s_branch SCHK_46
SPOLL_45:
    s_load_dwordx8 s[24:31], s[32:33], s92 offset:2560 glc
SCHK_46:
    s_add_u32 s5, s5, 1
    s_cmp_ge_u32 s5, 300000
    s_waitcnt lgkmcnt(0)
    s_cbranch_scc1 SDONE_47
    s_cmp_lg_u32 s25, s4
    s_cbranch_scc1 SPOLL_45
    s_cmp_lg_u32 s27, s4
    s_cbranch_scc1 SPOLL_45
    s_cmp_lg_u32 s29, s4
    s_cbranch_scc1 SPOLL_45
    s_cmp_lg_u32 s31, s4
    s_cbranch_scc1 SPOLL_45
SDONE_47:
    s_min_u32 s25, s24, s28
    s_max_u32 s24, s24, s28
    s_max_u32 s27, s26, s30
    s_min_u32 s26, s26, s30
    s_max_u32 s28, s25, s27
    s_min_u32 s25, s25, s27
    v_mov_b32 v148, s24
    v_mov_b32 v151, s26
    v_mov_b32 v149, s28
    v_mov_b32 v150, s25
    ds_write_b128 v4, v[148:151]
    s_waitcnt lgkmcnt(0)
    s_barrier
    s_cmp_lt_u32 s3, 4
    s_cbranch_scc1 L_CSEL
    ds_read_b64_tr_b16 v[164:165], v24
    ds_read_b64_tr_b16 v[166:167], v24 offset:512
    ds_read_b64_tr_b16 v[168:169], v24 offset:1024
    ds_read_b64_tr_b16 v[170:171], v24 offset:1536
    ds_read_b64_tr_b16 v[172:173], v24 offset:2048
    ds_read_b64_tr_b16 v[174:175], v24 offset:2560
    ds_read_b64_tr_b16 v[176:177], v24 offset:3072
    ds_read_b64_tr_b16 v[178:179], v24 offset:3584
    ds_read_b64_tr_b16 v[180:181], v24 offset:4096
    ds_read_b64_tr_b16 v[182:183], v24 offset:4608
    ds_read_b64_tr_b16 v[184:185], v24 offset:5120
    ds_read_b64_tr_b16 v[186:187], v24 offset:5632
    ds_read_b64_tr_b16 v[188:189], v24 offset:6144
    ds_read_b64_tr_b16 v[190:191], v24 offset:6656
    ds_read_b64_tr_b16 v[192:193], v24 offset:7168
    ds_read_b64_tr_b16 v[194:195], v24 offset:7680
    v_mul_u32_u24_dpp v92, v70, v52 row_newbcast:0 row_mask:0xf bank_mask:0xf
    v_and_b32_dpp v93, v70, v53 row_newbcast:0 row_mask:0xf bank_mask:0xf
    v_mul_u32_u24_dpp v94, v70, v52 row_newbcast:1 row_mask:0xf bank_mask:0xf
    v_and_b32_dpp v95, v70, v53 row_newbcast:1 row_mask:0xf bank_mask:0xf
    v_mul_u32_u24_dpp v96, v70, v52 row_newbcast:2 row_mask:0xf bank_mask:0xf
    v_and_b32_dpp v97, v70, v53 row_newbcast:2 row_mask:0xf bank_mask:0xf
    v_mul_u32_u24_dpp v98, v70, v52 row_newbcast:3 row_mask:0xf bank_mask:0xf
    v_and_b32_dpp v99, v70, v53 row_newbcast:3 row_mask:0xf bank_mask:0xf
    v_mul_u32_u24_dpp v100, v70, v52 row_newbcast:4 row_mask:0xf bank_mask:0xf
    v_and_b32_dpp v101, v70, v53 row_newbcast:4 row_mask:0xf bank_mask:0xf
    v_mul_u32_u24_dpp v102, v70, v52 row_newbcast:5 row_mask:0xf bank_mask:0xf
    v_and_b32_dpp v103, v70, v53 row_newbcast:5 row_mask:0xf bank_mask:0xf
    v_mul_u32_u24_dpp v104, v70, v52 row_newbcast:6 row_mask:0xf bank_mask:0xf
    v_and_b32_dpp v105, v70, v53 row_newbcast:6 row_mask:0xf bank_mask:0xf
    v_mul_u32_u24_dpp v106, v70, v52 row_newbcast:7 row_mask:0xf bank_mask:0xf
    v_and_b32_dpp v107, v70, v53 row_newbcast:7 row_mask:0xf bank_mask:0xf
    v_pk_mul_f32 v[76:77], v[76:77], v[92:93]
    v_pk_mul_f32 v[78:79], v[78:79], v[94:95]
    v_pk_mul_f32 v[80:81], v[80:81], v[96:97]
    v_pk_mul_f32 v[82:83], v[82:83], v[98:99]
    v_pk_mul_f32 v[84:85], v[84:85], v[100:101]
    v_pk_mul_f32 v[86:87], v[86:87], v[102:103]
    v_pk_mul_f32 v[88:89], v[88:89], v[104:105]
    v_pk_mul_f32 v[90:91], v[90:91], v[106:107]
    v_cvt_pk_bf16_f32 v76, 0, v76
    v_cvt_pk_bf16_f32 v77, 0, v77
    v_cvt_pk_bf16_f32 v78, 0, v78
    v_cvt_pk_bf16_f32 v79, 0, v79
    v_cvt_pk_bf16_f32 v80, 0, v80
    v_cvt_pk_bf16_f32 v81, 0, v81
    v_cvt_pk_bf16_f32 v82, 0, v82
    v_cvt_pk_bf16_f32 v83, 0, v83
    v_cvt_pk_bf16_f32 v84, 0, v84
    v_cvt_pk_bf16_f32 v85, 0, v85
    v_cvt_pk_bf16_f32 v86, 0, v86
    v_cvt_pk_bf16_f32 v87, 0, v87
    v_cvt_pk_bf16_f32 v88, 0, v88
    v_cvt_pk_bf16_f32 v89, 0, v89
    v_cvt_pk_bf16_f32 v90, 0, v90
    v_cvt_pk_bf16_f32 v91, 0, v91
    v_pk_add_f32 v[76:77], v[76:77], v[28:29]
    v_pk_add_f32 v[78:79], v[78:79], v[30:31]
    v_pk_add_f32 v[80:81], v[80:81], v[32:33]
    v_pk_add_f32 v[82:83], v[82:83], v[34:35]
    v_pk_add_f32 v[84:85], v[84:85], v[36:37]
    v_pk_add_f32 v[86:87], v[86:87], v[38:39]
    v_pk_add_f32 v[88:89], v[88:89], v[40:41]
    v_pk_add_f32 v[90:91], v[90:91], v[42:43]
    v_cvt_pk_bf16_f32 v140, v76, v77
    v_cvt_pk_bf16_f32 v141, v78, v79
    v_cvt_pk_bf16_f32 v142, v80, v81
    v_cvt_pk_bf16_f32 v143, v82, v83
    v_cvt_pk_bf16_f32 v144, v84, v85
    v_cvt_pk_bf16_f32 v145, v86, v87
    v_cvt_pk_bf16_f32 v146, v88, v89
    v_cvt_pk_bf16_f32 v147, v90, v91
    ds_write_b128 v23, v[140:143]
    ds_write_b128 v23, v[144:147] offset:16
    s_mul_i32 s96, s3, 2304
    s_add_u32 s16, s96, 139776
    v_lshrrev_b32 v23, 3, v1
    v_mul_u32_u24 v23, 144, v23
    v_and_b32 v9, 7, v1
    v_lshl_add_u32 v23, v9, 4, v23
    v_add_u32 v23, s16, v23
    s_add_u32 s13, s81, 12288
    s_lshl2_add_u32 m0, s89, 101376
    s_nop 0
    buffer_load_dwordx4 v73, s[60:63], s13 offen nt lds
    s_branch L_CSELD
L_CSEL:
    s_setprio 3
    ds_read_b128 v[148:151], v5
    s_lshl_b32 s96, s3, 9
    s_add_u32 s13, s96, 136704
    v_add_u32 v6, s13, v63
    s_lshl2_add_u32 s13, s3, 136384
    v_mov_b32 v7, s13
    s_waitcnt lgkmcnt(0)
    v_max_u32_dpp v152, v151, v148 quad_perm:[1,0,3,2] row_mask:0xf bank_mask:0xf
    v_max_u32_dpp v153, v150, v149 quad_perm:[1,0,3,2] row_mask:0xf bank_mask:0xf
    v_max_u32_dpp v154, v149, v150 quad_perm:[1,0,3,2] row_mask:0xf bank_mask:0xf
    v_max_u32_dpp v155, v148, v151 quad_perm:[1,0,3,2] row_mask:0xf bank_mask:0xf
    v_max_u32 v156, v152, v154
    v_max_u32 v157, v153, v155
    v_min_u32 v158, v152, v154
    v_min_u32 v159, v153, v155
    v_max_u32 v148, v156, v157
    v_min_u32 v149, v156, v157
    v_max_u32 v150, v158, v159
    v_min_u32 v151, v158, v159
    s_nop 1
    v_max_u32_dpp v152, v151, v148 quad_perm:[2,3,0,1] row_mask:0xf bank_mask:0xf
    v_max_u32_dpp v153, v150, v149 quad_perm:[2,3,0,1] row_mask:0xf bank_mask:0xf
    v_max_u32_dpp v154, v149, v150 quad_perm:[2,3,0,1] row_mask:0xf bank_mask:0xf
    v_max_u32_dpp v155, v148, v151 quad_perm:[2,3,0,1] row_mask:0xf bank_mask:0xf
    v_max_u32 v156, v152, v154
    v_max_u32 v157, v153, v155
    v_min_u32 v158, v152, v154
    v_min_u32 v159, v153, v155
    v_max_u32 v148, v156, v157
    v_min_u32 v149, v156, v157
    v_max_u32 v150, v158, v159
    v_min_u32 v151, v158, v159
    s_nop 1
    v_max_u32_dpp v152, v151, v148 row_half_mirror row_mask:0xf bank_mask:0xf
    v_max_u32_dpp v153, v150, v149 row_half_mirror row_mask:0xf bank_mask:0xf
    v_max_u32_dpp v154, v149, v150 row_half_mirror row_mask:0xf bank_mask:0xf
    v_max_u32_dpp v155, v148, v151 row_half_mirror row_mask:0xf bank_mask:0xf
    v_readfirstlane_b32 s24, v152
    v_readfirstlane_b32 s25, v153
    v_readfirstlane_b32 s26, v154
    v_readfirstlane_b32 s27, v155
    s_bitcmp1_b32 s3, 0
    s_cselect_b32 s24, s25, s24
    s_cselect_b32 s26, s27, s26
    s_bitcmp1_b32 s3, 1
    s_cselect_b32 s24, s26, s24
    s_and_b32 s15, s24, 4095
    s_lshr_b32 s96, s15, 8
    s_sub_u32 s97, 15, s96
    s_and_b32 s98, s15, 1
    s_lshl1_add_u32 s99, s97, s98
    s_lshl_b32 s96, s99, 14
    s_add_u32 s13, s96, 33554432
    s_lshl_b32 s96, s75, 10
    s_add_u32 s14, s96, s13
    s_add_u32 s13, s13, 8192
    v_and_b32 v10, 15, v1
    v_lshlrev_b32 v10, 3, v10
    buffer_load_dwordx2 v[152:153], v10, s[32:35], s13 offen sc1
    buffer_load_dwordx4 v[148:151], v2, s[32:35], s14 offen sc1
    s_setprio 0
    s_add_u32 s16, s81, 12288
    s_lshl2_add_u32 m0, s89, 101376
    s_nop 0
    buffer_load_dwordx4 v73, s[60:63], s16 offen nt lds
    ds_read_b64_tr_b16 v[164:165], v24
    ds_read_b64_tr_b16 v[166:167], v24 offset:512
    ds_read_b64_tr_b16 v[168:169], v24 offset:1024
    ds_read_b64_tr_b16 v[170:171], v24 offset:1536
    ds_read_b64_tr_b16 v[172:173], v24 offset:2048
    ds_read_b64_tr_b16 v[174:175], v24 offset:2560
    ds_read_b64_tr_b16 v[176:177], v24 offset:3072
    ds_read_b64_tr_b16 v[178:179], v24 offset:3584
    ds_read_b64_tr_b16 v[180:181], v24 offset:4096
    ds_read_b64_tr_b16 v[182:183], v24 offset:4608
    ds_read_b64_tr_b16 v[184:185], v24 offset:5120
    ds_read_b64_tr_b16 v[186:187], v24 offset:5632
    ds_read_b64_tr_b16 v[188:189], v24 offset:6144
    ds_read_b64_tr_b16 v[190:191], v24 offset:6656
    ds_read_b64_tr_b16 v[192:193], v24 offset:7168
    ds_read_b64_tr_b16 v[194:195], v24 offset:7680
    v_mul_u32_u24_dpp v92, v70, v52 row_newbcast:0 row_mask:0xf bank_mask:0xf
    v_and_b32_dpp v93, v70, v53 row_newbcast:0 row_mask:0xf bank_mask:0xf
    v_mul_u32_u24_dpp v94, v70, v52 row_newbcast:1 row_mask:0xf bank_mask:0xf
    v_and_b32_dpp v95, v70, v53 row_newbcast:1 row_mask:0xf bank_mask:0xf
    v_mul_u32_u24_dpp v96, v70, v52 row_newbcast:2 row_mask:0xf bank_mask:0xf
    v_and_b32_dpp v97, v70, v53 row_newbcast:2 row_mask:0xf bank_mask:0xf
    v_mul_u32_u24_dpp v98, v70, v52 row_newbcast:3 row_mask:0xf bank_mask:0xf
    v_and_b32_dpp v99, v70, v53 row_newbcast:3 row_mask:0xf bank_mask:0xf
    v_mul_u32_u24_dpp v100, v70, v52 row_newbcast:4 row_mask:0xf bank_mask:0xf
    v_and_b32_dpp v101, v70, v53 row_newbcast:4 row_mask:0xf bank_mask:0xf
    v_mul_u32_u24_dpp v102, v70, v52 row_newbcast:5 row_mask:0xf bank_mask:0xf
    v_and_b32_dpp v103, v70, v53 row_newbcast:5 row_mask:0xf bank_mask:0xf
    v_mul_u32_u24_dpp v104, v70, v52 row_newbcast:6 row_mask:0xf bank_mask:0xf
    v_and_b32_dpp v105, v70, v53 row_newbcast:6 row_mask:0xf bank_mask:0xf
    v_mul_u32_u24_dpp v106, v70, v52 row_newbcast:7 row_mask:0xf bank_mask:0xf
    v_and_b32_dpp v107, v70, v53 row_newbcast:7 row_mask:0xf bank_mask:0xf
    v_pk_mul_f32 v[76:77], v[76:77], v[92:93]
    v_pk_mul_f32 v[78:79], v[78:79], v[94:95]
    v_pk_mul_f32 v[80:81], v[80:81], v[96:97]
    v_pk_mul_f32 v[82:83], v[82:83], v[98:99]
    v_pk_mul_f32 v[84:85], v[84:85], v[100:101]
    v_pk_mul_f32 v[86:87], v[86:87], v[102:103]
    v_pk_mul_f32 v[88:89], v[88:89], v[104:105]
    v_pk_mul_f32 v[90:91], v[90:91], v[106:107]
    v_cvt_pk_bf16_f32 v76, 0, v76
    v_cvt_pk_bf16_f32 v77, 0, v77
    v_cvt_pk_bf16_f32 v78, 0, v78
    v_cvt_pk_bf16_f32 v79, 0, v79
    v_cvt_pk_bf16_f32 v80, 0, v80
    v_cvt_pk_bf16_f32 v81, 0, v81
    v_cvt_pk_bf16_f32 v82, 0, v82
    v_cvt_pk_bf16_f32 v83, 0, v83
    v_cvt_pk_bf16_f32 v84, 0, v84
    v_cvt_pk_bf16_f32 v85, 0, v85
    v_cvt_pk_bf16_f32 v86, 0, v86
    v_cvt_pk_bf16_f32 v87, 0, v87
    v_cvt_pk_bf16_f32 v88, 0, v88
    v_cvt_pk_bf16_f32 v89, 0, v89
    v_cvt_pk_bf16_f32 v90, 0, v90
    v_cvt_pk_bf16_f32 v91, 0, v91
    v_pk_add_f32 v[76:77], v[76:77], v[28:29]
    v_pk_add_f32 v[78:79], v[78:79], v[30:31]
    v_pk_add_f32 v[80:81], v[80:81], v[32:33]
    v_pk_add_f32 v[82:83], v[82:83], v[34:35]
    v_pk_add_f32 v[84:85], v[84:85], v[36:37]
    v_pk_add_f32 v[86:87], v[86:87], v[38:39]
    v_pk_add_f32 v[88:89], v[88:89], v[40:41]
    v_pk_add_f32 v[90:91], v[90:91], v[42:43]
    v_cvt_pk_bf16_f32 v140, v76, v77
    v_cvt_pk_bf16_f32 v141, v78, v79
    v_cvt_pk_bf16_f32 v142, v80, v81
    v_cvt_pk_bf16_f32 v143, v82, v83
    v_cvt_pk_bf16_f32 v144, v84, v85
    v_cvt_pk_bf16_f32 v145, v86, v87
    v_cvt_pk_bf16_f32 v146, v88, v89
    v_cvt_pk_bf16_f32 v147, v90, v91
    ds_write_b128 v23, v[140:143]
    ds_write_b128 v23, v[144:147] offset:16
    s_mul_i32 s96, s3, 2304
    s_add_u32 s16, s96, 139776
    v_lshrrev_b32 v23, 3, v1
    v_mul_u32_u24 v23, 144, v23
    v_and_b32 v9, 7, v1
    v_lshl_add_u32 v23, v9, 4, v23
    v_add_u32 v23, s16, v23
    s_lshl2_add_u32 s15, s15, s3
    s_waitcnt vmcnt(1)
    v_bitop3_b32 v8, v149, v151, s4 bitop3:0x7e
    v_bitop3_b32 v8, v8, v153, s4 bitop3:0xf6
    v_cmp_ne_u32 vcc, 0, v8
    s_cbranch_vccz TOK_49
POLL_50:
    buffer_load_dwordx2 v[152:153], v10, s[32:35], s13 offen sc1
    buffer_load_dwordx4 v[148:151], v2, s[32:35], s14 offen sc1
    s_waitcnt vmcnt(0)
    v_bitop3_b32 v8, v149, v151, s4 bitop3:0x7e
    v_bitop3_b32 v8, v8, v153, s4 bitop3:0xf6
    v_cmp_ne_u32 vcc, 0, v8
    s_cbranch_vccz PDONE_51
    s_add_u32 s5, s5, 1
    s_cmp_lt_u32 s5, 300000
    s_cbranch_scc1 POLL_50
PDONE_51:
TOK_49:
    s_setprio 3
    ds_write2_b32 v6, v148, v150 offset0:0 offset1:1
    v_add_f32_dpp v152, v152, v152 quad_perm:[1,0,3,2] row_mask:0xf bank_mask:0xf
    s_nop 1
    v_add_f32_dpp v152, v152, v152 quad_perm:[2,3,0,1] row_mask:0xf bank_mask:0xf
    s_nop 1
    v_add_f32_dpp v152, v152, v152 row_half_mirror row_mask:0xf bank_mask:0xf
    s_nop 1
    v_add_f32_dpp v152, v152, v152 row_ror:8 row_mask:0xf bank_mask:0xf
    v_cvt_pk_bf16_f32 v152, 0, v152
    v_ashrrev_i32 v153, 31, v152
    v_or_b32 v153, 0x80000000, v153
    v_xor_b32 v152, v152, v153
    v_and_b32 v152, s6, v152
    v_or_b32 v152, s15, v152
    ds_write_b32 v7, v152
    s_setprio 0
L_CSELD:
    v_mov_b32 v4, 136384
    s_lshl_b32 s96, s74, 13
    s_add_u32 s14, s96, 20971520
    s_mul_i32 s96, s90, s76
    s_lshl_b32 s97, s96, 13
    s_lshl3_add_u32 s98, s75, s3
    s_lshl_b32 s99, s98, 8
    s_add_u32 s96, s97, s99
    s_add_u32 s20, s96, s14
    s_waitcnt lgkmcnt(0)
    s_barrier
    ds_read_b128 v[148:151], v4
    s_waitcnt lgkmcnt(0)
    v_max_u32 v152, v148, v149
    v_max_u32 v153, v150, v151
    v_min_u32 v154, v148, v149
    v_min_u32 v155, v150, v151
    v_min_u32 v149, v152, v153
    v_max_u32 v148, v152, v153
    v_max3_u32 v149, v149, v154, v155
    v_cndmask_b32 v4, v149, v148, s[22:23]
    v_readfirstlane_b32 s68, v148
    v_and_b32 v4, 3, v4
    v_readfirstlane_b32 s69, v149
    v_lshl_add_u32 v4, v4, 9, v46
    ds_read_b128 v[152:155], v4
    ds_read_b128 v[140:143], v23
    ds_read_b128 v[144:147], v23 offset:1152
    s_bfe_u32 s70, s68, 720899
    s_bfe_u32 s71, s69, 720899
    s_sub_u32 s70, 2047, s70
    s_sub_u32 s71, 2047, s71
    s_waitcnt lgkmcnt(2)
    v_mfma_f32_16x16x32_bf16 v[212:215], v[152:155], v[164:167], 0
    v_mfma_f32_16x16x32_bf16 v[216:219], v[152:155], v[168:171], 0
    v_mfma_f32_16x16x32_bf16 v[220:223], v[152:155], v[172:175], 0
    v_mfma_f32_16x16x32_bf16 v[224:227], v[152:155], v[176:179], 0
    v_mfma_f32_16x16x32_bf16 v[228:231], v[152:155], v[180:183], 0
    v_mfma_f32_16x16x32_bf16 v[232:235], v[152:155], v[184:187], 0
    v_mfma_f32_16x16x32_bf16 v[236:239], v[152:155], v[188:191], 0
    v_mfma_f32_16x16x32_bf16 v[240:243], v[152:155], v[192:195], 0
    s_nop 1
    v_add_f32 v148, v212, v217
    s_nop 0
    v_add_f32 v149, v222, v227
    s_nop 0
    v_add_f32 v150, v228, v233
    s_nop 0
    v_add_f32 v151, v238, v243
    v_add_f32 v148, v148, v149
    v_add_f32 v150, v150, v151
    s_nop 1
    v_permlane16_swap_b32 v150, v151
    v_add_f32 v56, v148, v151
    v_add_f32 v58, v148, v151
    v_mov_b32 v57, s4
    v_mov_b32 v59, s4
    v_permlane32_swap_b32 v56, v58
    s_cmp_ge_u32 s9, 28
    s_cbranch_scc1 L_NOHP
    s_mov_b64 exec, 0xffff
    s_cmp_lg_u32 s93, 0
    s_cbranch_scc1 LOC_52
    buffer_store_dwordx4 v[56:59], v2, s[32:35], s20 offen sc1
    s_branch LOCD_53
LOC_52:
    buffer_store_dwordx4 v[56:59], v2, s[32:35], s20 offen
LOCD_53:
    s_mov_b64 exec, -1
L_NOHP:
    v_add_u32 v60, s20, v2
    s_waitcnt lgkmcnt(0)
    s_bitcmp1_b32 s21, 2
    s_cselect_b32 s17, s71, s70
    s_cselect_b32 s18, s69, s68
    s_cmp_lg_u32 s3, 7
    s_cbranch_scc1 L_NOFZ
    s_cmp_lg_u32 s2, 0
    s_cbranch_scc1 L_NONON
    v_mov_b32 v6, s4
    s_mov_b64 exec, 1
    buffer_store_dword v6, v3, s[32:35], 0 offen sc1
    s_mov_b64 exec, -1
L_NONON:
    s_lshr_b32 s96, s21, 3
    s_and_b32 s97, s21, 1
    s_lshl1_add_u32 s19, s96, s97
    s_lshr_b32 s96, s21, 2
    s_lshl_b32 s97, s96, 1
    s_lshl3_add_u32 s98, s12, s97
    s_and_b32 s99, s21, 1
    s_add_u32 s96, s98, s99
    s_mul_i32 s97, s96, 7168
    s_add_u32 s20, s97, 22020096
    s_lshl_b32 s96, s17, 11
    s_lshl_b32 s97, s12, 7
    s_add_u32 s98, s96, s97
    s_lshl_b32 s99, s19, 5
    s_add_u32 s82, s98, s99
    v_and_b32 v10, 7, v1
    v_lshlrev_b32 v10, 2, v10
    s_lshl_b32 s96, s19, 5
    s_add_u32 s13, s96, 139264
    v_add_u32 v5, s13, v10
    ds_read_b32 v74, v5
    s_lshr_b32 s96, s17, 7
    s_bfe_u32 s97, s18, 65538
    s_lshl1_add_u32 s98, s96, s97
    s_lshl_b32 s99, s98, 14
    s_lshl_b32 s96, s12, 8
    s_add_u32 s97, s99, s96
    s_lshl_b32 s98, s19, 6
    s_add_u32 s99, s97, s98
    s_add_u32 s68, s99, 33554432
    s_add_u32 s69, s68, 4096
    v_and_b32 v11, 7, v1
    v_lshlrev_b32 v11, 3, v11
    buffer_load_dwordx2 v[20:21], v11, s[32:35], s68 offen sc1
    buffer_load_dwordx2 v[72:73], v11, s[32:35], s69 offen sc1
    s_and_b32 s13, s18, s6
    s_ashr_i32 s15, s13, 31
    s_andn2_b32 s15, 0x7fff0000, s15
    s_or_b32 s15, s15, 0x80000000
    s_xor_b32 s13, s13, s15
    v_mov_b32 v75, s13
    v_mul_f32 v75, s7, v75
    v_exp_f32 v75, -v75
    s_nop 0
    v_add_f32 v75, 1.0, v75
    v_rcp_f32 v75, v75
    s_nop 0
    v_cvt_pk_bf16_f32 v75, 0, v75
L_NOFZ:
    s_cmp_lt_u32 s9, 28
    s_cbranch_scc1 L_HSEC
    s_branch L_GSEC
L_HSEC:
    s_cmp_lt_u32 s3, 4
    s_cbranch_scc1 L_HW
    s_branch L_NOH
L_HW:
    s_lshl_b32 s96, s3, 8
    s_add_u32 s13, s96, s14
    v_lshrrev_b32 v4, 4, v1
    v_lshlrev_b32 v4, 11, v4
    v_and_b32 v9, 15, v1
    v_lshl_add_u32 v4, v9, 4, v4
    s_lshl_b32 s96, s3, 5
    s_add_u32 s15, s96, 138752
    v_lshrrev_b32 v5, 5, v1
    v_lshl_add_u32 v5, v5, 7, s15
    v_bfe_u32 v9, v1, 2, 1
    v_lshl_add_u32 v5, v9, 4, v5
    v_bfe_u32 v9, v1, 1, 1
    v_lshl_add_u32 v5, v9, 3, v5
    v_bfe_u32 v9, v1, 3, 1
    v_lshl_add_u32 v5, v9, 2, v5
    v_and_b32 v9, 1, v1
    v_lshl_add_u32 v5, v9, 1, v5
    s_cmp_lg_u32 s93, 0
    s_cbranch_scc1 L_HLOC
SPOLL_54:
    s_load_dword s24, s[32:33], s13 offset:1276 glc
    s_load_dword s25, s[32:33], s13 offset:3324 glc
    s_load_dword s26, s[32:33], s13 offset:5372 glc
    s_load_dword s27, s[32:33], s13 offset:7420 glc
SCHK_55:
    s_add_u32 s5, s5, 1
    s_cmp_ge_u32 s5, 300000
    s_waitcnt lgkmcnt(0)
    s_cbranch_scc1 SDONE_56
    s_cmp_lg_u32 s24, s4
    s_cbranch_scc1 SPOLL_54
    s_cmp_lg_u32 s25, s4
    s_cbranch_scc1 SPOLL_54
    s_cmp_lg_u32 s26, s4
    s_cbranch_scc1 SPOLL_54
    s_cmp_lg_u32 s27, s4
    s_cbranch_scc1 SPOLL_54
SDONE_56:
L_HLOC:
    buffer_load_dwordx4 v[212:215], v4, s[32:35], s13 offen sc1
    buffer_load_dwordx4 v[216:219], v4, s[32:35], s13 offen offset:1024 sc1
    s_waitcnt vmcnt(0)
    v_bitop3_b32 v6, v213, v215, s4 bitop3:0x7e
    v_bitop3_b32 v6, v6, v217, s4 bitop3:0xf6
    v_bitop3_b32 v6, v6, v219, s4 bitop3:0xf6
    v_cmp_ne_u32 vcc, 0, v6
    s_cbranch_vccz TOK_58
POLL_59:
    buffer_load_dwordx4 v[212:215], v4, s[32:35], s13 offen sc1
    buffer_load_dwordx4 v[216:219], v4, s[32:35], s13 offen offset:1024 sc1
    s_waitcnt vmcnt(0)
    v_bitop3_b32 v6, v213, v215, s4 bitop3:0x7e
    v_bitop3_b32 v6, v6, v217, s4 bitop3:0xf6
    v_bitop3_b32 v6, v6, v219, s4 bitop3:0xf6
    v_cmp_ne_u32 vcc, 0, v6
    s_cbranch_vccz PDONE_60
    s_add_u32 s5, s5, 1
    s_cmp_lt_u32 s5, 300000
    s_cbranch_scc1 POLL_59
PDONE_60:
TOK_58:
    v_permlane32_swap_b32 v212, v214
    v_permlane32_swap_b32 v216, v218
    v_add_f32 v212, v212, v214
    v_add_f32 v216, v216, v218
    v_mov_b32 v214, v212
    v_mov_b32 v218, v216
    s_nop 0
    v_permlane16_swap_b32 v212, v214
    v_permlane16_swap_b32 v216, v218
    v_add_f32 v212, v212, v214
    v_add_f32 v216, v216, v218
    v_cvt_pk_bf16_f32 v212, 0, v212
    v_cvt_pk_bf16_f32 v216, 0, v216
    v_mul_f32 v6, s7, v212
    v_exp_f32 v6, -v6
    s_nop 0
    v_add_f32 v6, 1.0, v6
    v_rcp_f32 v6, v6
    s_nop 0
    v_mul_f32 v212, v212, v6
    v_cvt_pk_bf16_f32 v212, 0, v212
    v_mul_f32 v212, v212, v216
    v_cvt_pk_bf16_f32 v212, v212, v212
    ds_write_b16 v5, v212
L_NOH:
    v_bfe_u32 v4, v1, 2, 1
    v_lshlrev_b32 v4, 7, v4
    v_lshrrev_b32 v9, 5, v1
    v_lshl_add_u32 v4, v9, 4, v4
    v_add_u32 v4, 138752, v4
    v_lshrrev_b32 v5, 4, v1
    v_mul_u32_u24 v5, 7168, v5
    v_and_b32 v9, 15, v1
    v_lshl_add_u32 v5, v9, 3, v5
    v_and_b32 v6, 1, v1
    v_lshlrev_b32 v6, 18, v6
    v_bfe_u32 v9, v1, 1, 1
    v_lshl_add_u32 v6, v9, 13, v6
    s_lshl3_add_u32 s96, s75, s3
    s_mul_i32 s97, s96, 28672
    s_lshl_b32 s98, s74, 7
    s_add_u32 s99, s97, s98
    s_add_u32 s13, s99, 22020096
    s_lshr_b32 s96, s9, 2
    s_and_b32 s97, s75, 1
    s_lshr_b32 s98, s3, 1
    s_lshl2_add_u32 s99, s97, s98
    s_and_b32 s97, s3, 1
    s_lshl_b32 s98, s97, 2
    s_lshl3_add_u32 s97, s99, s98
    s_lshr_b32 s99, s75, 1
    s_add_u32 s98, s97, s99
    s_lshl_b32 s97, s98, 12
    s_lshl_b32 s99, s8, 6
    s_add_u32 s98, s97, s99
    s_lshl2_add_u32 s97, s96, s98
    s_add_u32 s99, s97, 1048576
    s_add_u32 s14, s99, 3072
    s_waitcnt vmcnt(0)
    s_waitcnt lgkmcnt(0)
    s_barrier
    ds_read_b128 v[212:215], v4
    ds_read_b64_tr_b16 v[196:197], v45
    ds_read_b64_tr_b16 v[198:199], v45 offset:1024
    ds_read_b128 v[216:219], v4 offset:32
    ds_read_b64_tr_b16 v[200:201], v45 offset:8192
    ds_read_b64_tr_b16 v[202:203], v45 offset:9216
    ds_read_b128 v[220:223], v4 offset:64
    ds_read_b64_tr_b16 v[204:205], v45 offset:16384
    ds_read_b64_tr_b16 v[206:207], v45 offset:17408
    ds_read_b128 v[224:227], v4 offset:96
    ds_read_b64_tr_b16 v[208:209], v45 offset:24576
    ds_read_b64_tr_b16 v[210:211], v45 offset:25600
    s_waitcnt lgkmcnt(9)
    v_mfma_f32_32x32x16_bf16 v[228:243], v[212:215], v[196:199], 0
    s_waitcnt lgkmcnt(6)
    v_mfma_f32_32x32x16_bf16 v[228:243], v[216:219], v[200:203], v[228:243]
    s_waitcnt lgkmcnt(3)
    v_mfma_f32_32x32x16_bf16 v[228:243], v[220:223], v[204:207], v[228:243]
    s_waitcnt lgkmcnt(0)
    v_mfma_f32_32x32x16_bf16 v[228:243], v[224:227], v[208:211], v[228:243]
    s_nop 11
    v_mov_b32 v229, s4
    buffer_store_dwordx2 v[228:229], v5, s[32:35], s13 offen sc1
    s_mov_b64 exec, 15
    buffer_store_dword v229, v6, s[32:35], s14 offen sc1
    s_mov_b64 exec, -1
    s_waitcnt lgkmcnt(0)
L_GSEC:
    s_lshl_b32 s96, s21, 7
    s_lshl4_add_u32 s13, s3, s96
    v_lshrrev_b32 v22, 3, v1
    v_lshl_add_u32 v22, v22, 0, s13
    s_lshl_b32 s96, s13, 11
    s_lshl_b32 s97, s12, 7
    s_add_u32 s15, s96, s97
    s_add_u32 s16, s15, 16384
    v_lshrrev_b32 v25, 3, v1
    v_lshlrev_b32 v25, 11, v25
    v_and_b32 v9, 7, v1
    v_lshl_add_u32 v25, v9, 4, v25
    v_cmp_ne_u32 vcc, s70, v22
    v_cmp_ne_u32 s[22:23], s71, v22
    s_nop 0
    s_and_b64 exec, vcc, s[22:23]
    buffer_store_dwordx4 v[140:143], v25, s[64:67], s15 offen sc1
    s_mov_b64 exec, -1
    v_add_u32 v22, 8, v22
    v_cmp_ne_u32 vcc, s70, v22
    v_cmp_ne_u32 s[22:23], s71, v22
    s_nop 0
    s_and_b64 exec, vcc, s[22:23]
    buffer_store_dwordx4 v[144:147], v25, s[64:67], s16 offen sc1
    s_mov_b64 exec, -1
    s_cmp_lt_u32 s9, 16
    s_cbranch_scc1 L_GF
    s_cmp_ge_u32 s9, 28
    s_cbranch_scc1 L_FIN
    s_waitcnt vmcnt(0)
    s_mov_b64 exec, 0xffff
    buffer_store_dwordx4 v[56:59], v60, s[32:35], 0 offen sc1
    s_mov_b64 exec, -1
    s_branch L_FIN
L_GF:
SPOLL_61:
    s_load_dwordx8 s[24:31], s[32:33], s92 offset:3072 glc
SCHK_62:
    s_add_u32 s5, s5, 1
    s_cmp_ge_u32 s5, 300000
    s_waitcnt lgkmcnt(0)
    s_cbranch_scc1 SDONE_63
    s_cmp_lg_u32 s24, s4
    s_cbranch_scc1 SPOLL_61
    s_cmp_lg_u32 s25, s4
    s_cbranch_scc1 SPOLL_61
    s_cmp_lg_u32 s26, s4
    s_cbranch_scc1 SPOLL_61
    s_cmp_lg_u32 s27, s4
    s_cbranch_scc1 SPOLL_61
    s_cmp_lg_u32 s28, s4
    s_cbranch_scc1 SPOLL_61
    s_cmp_lg_u32 s29, s4
    s_cbranch_scc1 SPOLL_61
    s_cmp_lg_u32 s30, s4
    s_cbranch_scc1 SPOLL_61
SDONE_63:
    s_barrier
    s_cmp_eq_u32 s3, 7
    s_cbranch_scc1 L_G7
    s_barrier
    s_mov_b64 exec, 0xffff
    buffer_store_dwordx4 v[56:59], v60, s[32:35], 0 offen sc1
    s_mov_b64 exec, -1
    s_branch L_FIN
L_G7:
    s_cmp_lg_u32 s3, 7
    s_cbranch_scc1 L_FIN
    s_add_u32 s13, s20, 4096
POLL_64:
    buffer_load_dwordx4 v[212:215], v2, s[32:35], s20 offen sc1
    buffer_load_dwordx4 v[216:219], v2, s[32:35], s20 offen offset:1024 sc1
    buffer_load_dwordx4 v[220:223], v2, s[32:35], s20 offen offset:2048 sc1
    buffer_load_dwordx4 v[224:227], v2, s[32:35], s20 offen offset:3072 sc1
    buffer_load_dwordx4 v[148:151], v2, s[32:35], s13 offen sc1
    buffer_load_dwordx4 v[152:155], v2, s[32:35], s13 offen offset:1024 sc1
    buffer_load_dwordx4 v[156:159], v2, s[32:35], s13 offen offset:2048 sc1
    s_waitcnt vmcnt(0)
    v_bitop3_b32 v4, v213, v215, s4 bitop3:0x7e
    v_bitop3_b32 v4, v4, v217, s4 bitop3:0xf6
    v_bitop3_b32 v4, v4, v219, s4 bitop3:0xf6
    v_bitop3_b32 v4, v4, v221, s4 bitop3:0xf6
    v_bitop3_b32 v4, v4, v223, s4 bitop3:0xf6
    v_bitop3_b32 v4, v4, v225, s4 bitop3:0xf6
    v_bitop3_b32 v4, v4, v227, s4 bitop3:0xf6
    v_bitop3_b32 v4, v4, v149, s4 bitop3:0xf6
    v_bitop3_b32 v4, v4, v151, s4 bitop3:0xf6
    v_bitop3_b32 v4, v4, v153, s4 bitop3:0xf6
    v_bitop3_b32 v4, v4, v155, s4 bitop3:0xf6
    v_bitop3_b32 v4, v4, v157, s4 bitop3:0xf6
    v_bitop3_b32 v4, v4, v159, s4 bitop3:0xf6
    v_cmp_ne_u32 vcc, 0, v4
    s_cbranch_vccz PDONE_65
    s_add_u32 s5, s5, 1
    s_cmp_lt_u32 s5, 300000
    s_cbranch_scc1 POLL_64
PDONE_65:
    v_bitop3_b32 v4, v21, v73, s4 bitop3:0x7e
    v_cmp_ne_u32 vcc, 0, v4
    s_cbranch_vccz TOK_66
POLL_67:
    buffer_load_dwordx2 v[20:21], v11, s[32:35], s68 offen sc1
    buffer_load_dwordx2 v[72:73], v11, s[32:35], s69 offen sc1
    s_waitcnt vmcnt(0)
    v_bitop3_b32 v4, v21, v73, s4 bitop3:0x7e
    v_cmp_ne_u32 vcc, 0, v4
    s_cbranch_vccz PDONE_68
    s_add_u32 s5, s5, 1
    s_cmp_lt_u32 s5, 300000
    s_cbranch_scc1 POLL_67
PDONE_68:
TOK_66:
    s_barrier
    v_add_f32 v212, v212, v216
    v_add_f32 v214, v214, v218
    v_add_f32 v220, v220, v224
    v_add_f32 v222, v222, v226
    v_add_f32 v148, v148, v152
    v_add_f32 v150, v150, v154
    v_add_f32 v212, v212, v220
    v_add_f32 v214, v214, v222
    v_add_f32 v148, v148, v156
    v_add_f32 v150, v150, v158
    v_add_f32 v212, v212, v148
    v_add_f32 v214, v214, v150
    v_mov_b32 v213, v214
    v_add_f32_dpp v212, v212, v212 row_ror:8 row_mask:0xf bank_mask:0xf
    s_nop 0
    v_add_f32_dpp v213, v213, v213 row_ror:8 row_mask:0xf bank_mask:0xf
    v_mov_b32 v214, v212
    v_mov_b32 v215, v213
    s_nop 0
    v_permlane16_swap_b32 v212, v214
    v_permlane16_swap_b32 v213, v215
    v_pk_add_f32 v[212:213], v[212:213], v[214:215]
    v_mov_b32 v214, v212
    v_mov_b32 v215, v213
    s_nop 0
    v_permlane32_swap_b32 v212, v214
    v_permlane32_swap_b32 v213, v215
    v_pk_add_f32 v[212:213], v[212:213], v[214:215]
    v_cvt_pk_bf16_f32 v212, 0, v212
    v_cvt_pk_bf16_f32 v213, 0, v213
    v_pk_mul_f32 v[212:213], v[212:213], v[74:75] op_sel:[0,1]
    v_lshlrev_b32 v4, 16, v20
    v_and_b32 v5, s6, v20
    v_cvt_pk_bf16_f32 v212, 0, v212
    v_cvt_pk_bf16_f32 v213, 0, v213
    v_pk_add_f32 v[212:213], v[212:213], v[4:5]
    v_lshlrev_b32 v4, 16, v74
    v_and_b32 v5, s6, v74
    v_cvt_pk_bf16_f32 v212, 0, v212
    v_cvt_pk_bf16_f32 v213, 0, v213
    v_pk_mul_f32 v[212:213], v[212:213], v[4:5]
    v_lshlrev_b32 v4, 16, v72
    v_and_b32 v5, s6, v72
    v_cvt_pk_bf16_f32 v212, 0, v212
    v_cvt_pk_bf16_f32 v213, 0, v213
    v_pk_add_f32 v[212:213], v[212:213], v[4:5]
    v_cvt_pk_bf16_f32 v212, v212, v213
    s_mov_b64 exec, 0xff
    buffer_store_dword v212, v10, s[64:67], s82 offen sc1
    s_mov_b64 exec, -1
    s_mov_b64 exec, 0xffff
    buffer_store_dwordx4 v[56:59], v60, s[32:35], 0 offen sc1
    s_mov_b64 exec, -1
L_FIN:
L_END:
    s_endpgm
.p2align 10
.fill 768, 4, 0xbf800000
.section .rodata,"a"
.p2align 6
.amdhsa_kernel adaLN_cond__linear_kernel_hedgehog__moe_arch_mod__prompt_kernel
  .amdhsa_next_free_vgpr 256
  .amdhsa_next_free_sgpr 102
  .amdhsa_accum_offset 256
  .amdhsa_group_segment_fixed_size 0
  .amdhsa_kernarg_size 112
  .amdhsa_user_sgpr_count 2
  .amdhsa_user_sgpr_kernarg_segment_ptr 1
  .amdhsa_system_sgpr_workgroup_id_x 1
  .amdhsa_float_denorm_mode_32 3
  .amdhsa_float_denorm_mode_16_64 3
.end_amdhsa_kernel
```

```asm
; @launch grid=(256,1,1) block=(512,1,1) lds=163840
.amdgcn_target "amdgcn-amd-amdhsa--gfx950"
.text
.globl adaLN_cond__linear_kernel_hedgehog__moe_arch_mod__prompt_kernel
.p2align 8
.type adaLN_cond__linear_kernel_hedgehog__moe_arch_mod__prompt_kernel,@function
adaLN_cond__linear_kernel_hedgehog__moe_arch_mod__prompt_kernel:
    s_load_dwordx16 s[68:83], s[0:1], 0
    s_load_dwordx8 s[84:91], s[0:1], 64
    s_load_dwordx2 s[32:33], s[0:1], 104
    s_load_dwordx2 s[30:31], s[0:1], 96
    s_cmp_ge_u32 s2, 256
    s_cbranch_scc1 L_END
    v_lshrrev_b32 v4, 6, v0
    v_and_b32 v1, 63, v0
    v_mov_b32 v3, 0
    v_readfirstlane_b32 s3, v4
    v_lshlrev_b32 v2, 4, v1
    s_and_b32 s8, s2, 7
    s_lshr_b32 s9, s2, 3
    s_lshl2_add_u32 s96, s8, s3
    s_lshl_b32 s15, s96, 6
    s_mul_i32 s96, s15, 6144
    s_xor_b32 s97, s9, 1
    s_lshl_b32 s98, s97, 7
    s_add_u32 s13, s96, s98
    v_lshrrev_b32 v60, 3, v1
    v_mul_u32_u24 v60, 49152, v60
    v_and_b32 v9, 7, v1
    v_lshl_add_u32 v60, v9, 4, v60
    v_lshrrev_b32 v61, 3, v1
    v_lshl_add_u32 v61, v61, 3, s15
    s_lshl_b32 s96, s8, 5
    s_add_u32 s97, s96, s9
    s_lshl2_add_u32 s98, s97, s3
    s_sub_u32 s99, s98, 4
    s_lshl_b32 s16, s99, 12
    s_mov_b32 s50, 12582912
    s_mov_b32 s51, 0x20000
    s_mov_b32 s38, 4194304
    s_mov_b32 s39, 0x20000
    s_mov_b32 s34, 268435456
    s_mov_b32 s35, 0x20000
    s_getreg_b32 s94, hwreg(HW_REG_XCC_ID, 0, 3)
    s_getpc_b64 s[22:23]
    s_mul_i32 s96, s9, 7
    s_add_u32 s97, s96, s3
    s_lshl_b32 s19, s97, 7
    v_lshrrev_b32 v10, 5, v1
    v_mul_u32_u24 v10, 28672, v10
    v_add_u32 v10, s19, v10
    v_min_u32 v10, 45056, v10
    s_cmp_ge_u32 s3, 4
    s_waitcnt lgkmcnt(0)
    s_mov_b64 s[48:49], s[88:89]
    s_mov_b64 s[36:37], s[68:69]
    s_load_dword s4, s[32:33], 0
    s_cbranch_scc1 L_FS
    global_load_dwordx2 v[96:97], v61, s[86:87]
    buffer_load_dwordx4 v[80:83], v60, s[48:51], s13 offen nt
    s_add_u32 s13, s13, 12288
    buffer_load_dwordx4 v[84:87], v60, s[48:51], s13 offen nt
    s_add_u32 s13, s13, 12288
    buffer_load_dwordx4 v[88:91], v60, s[48:51], s13 offen nt
    s_add_u32 s13, s13, 12288
    buffer_load_dwordx4 v[92:95], v60, s[48:51], s13 offen nt
    s_barrier
    s_barrier
    s_and_b32 s22, s22, 0xfffffc00
    global_load_dword v78, v10, s[22:23]
    s_mov_b32 s42, 6291456
    s_mov_b32 s43, 0x20000
    s_mov_b32 s46, 2097152
    s_mov_b32 s47, 0x20000
    s_mov_b32 s54, 7340032
    s_mov_b32 s55, 0x20000
    s_mov_b32 s58, 7340032
    s_mov_b32 s59, 0x20000
    s_mov_b32 s62, 7340032
    s_mov_b32 s63, 0x20000
    s_mov_b32 s66, 4194304
    s_mov_b32 s67, 0x20000
    s_mov_b64 s[40:41], s[70:71]
    s_mov_b64 s[44:45], s[74:75]
    s_mov_b64 s[52:53], s[80:81]
    s_mov_b64 s[56:57], s[82:83]
    s_mov_b64 s[60:61], s[84:85]
    s_mov_b64 s[64:65], s[90:91]
    s_mov_b32 s5, 0
    s_mov_b32 s6, 0xffff0000
    s_mov_b32 s7, 0x3fb8aa3b
    s_lshr_b32 s76, s3, 2
    v_bfe_u32 v6, v1, 4, 1
    v_lshlrev_b32 v6, 6, v6
    v_and_b32 v62, 7, v1
    v_lshlrev_b32 v62, 4, v62
    v_xor_b32 v62, v62, v6
    v_lshrrev_b32 v6, 3, v1
    v_mul_u32_u24 v6, 6144, v6
    v_add_u32 v62, v62, v6
    v_lshlrev_b32 v63, 3, v1
    v_and_b32 v64, 31, v1
    v_lshlrev_b32 v64, 5, v64
    v_add_u32 v64, 149760, v64
    s_and_b32 s96, s3, 3
    s_lshl2_add_u32 s13, s96, 149760
    v_lshrrev_b32 v65, 4, v1
    v_lshl_add_u32 v65, v65, 5, s13
    v_and_b32 v9, 7, v1
    v_lshl_add_u32 v65, v9, 7, v65
    v_bfe_u32 v9, v1, 3, 1
    v_lshl_add_u32 v65, v9, 4, v65
    s_and_b32 s96, s8, 6
    s_and_b32 s97, s8, 1
    s_lshr_b32 s98, s9, 4
    s_lshl1_add_u32 s99, s97, s98
    s_lshl_b32 s97, s99, 6
    s_add_u32 s98, s96, s97
    s_lshl3_add_u32 s99, s3, s98
    s_lshl_b32 s96, s99, 10
    s_and_b32 s97, s9, 15
    s_lshl_b32 s98, s97, 6
    s_add_u32 s99, s96, s98
    s_add_u32 s14, s99, 262144
    s_xor_b32 s96, s9, 1
    s_and_b32 s97, s96, 15
    s_lshl4_add_u32 s98, s3, s97
    s_lshr_b32 s99, s9, 4
    s_lshl1_add_u32 s96, s98, s99
    s_lshl3_add_u32 s97, s96, s8
    s_lshl_b32 s98, s97, 9
    s_add_u32 s13, s98, 524288
    s_lshr_b32 s96, s9, 4
    s_xor_b32 s97, s9, 1
    s_and_b32 s98, s97, 7
    s_lshl_b32 s99, s3, 1
    s_lshl3_add_u32 s97, s98, s99
    s_bfe_u32 s98, s9, 65539
    s_add_u32 s99, s97, s98
    s_lshl_b32 s97, s99, 9
    s_lshl_b32 s98, s8, 6
    s_add_u32 s99, s97, s98
    s_lshl2_add_u32 s97, s96, s99
    s_add_u32 s15, s97, 2097152
    v_and_b32 v10, 3, v1
    v_lshlrev_b32 v10, 15, v10
    s_waitcnt vmcnt(5)
    v_lshlrev_b32 v98, 16, v97
    v_and_b32 v99, s6, v97
    v_and_b32 v97, s6, v96
    v_lshlrev_b32 v96, 16, v96
    v_mul_f32 v4, s7, v96
    v_exp_f32 v4, -v4
    s_nop 0
    v_add_f32 v4, 1.0, v4
    v_rcp_f32 v4, v4
    s_nop 0
    v_mul_f32 v96, v96, v4
    v_cvt_pk_bf16_f32 v96, 0, v96
    v_mul_f32 v5, s7, v97
    v_exp_f32 v5, -v5
    s_nop 0
    v_add_f32 v5, 1.0, v5
    v_rcp_f32 v5, v5
    s_nop 0
    v_mul_f32 v97, v97, v5
    v_cvt_pk_bf16_f32 v97, 0, v97
    v_mul_f32 v4, s7, v98
    v_exp_f32 v4, -v4
    s_nop 0
    v_add_f32 v4, 1.0, v4
    v_rcp_f32 v4, v4
    s_nop 0
    v_mul_f32 v98, v98, v4
    v_cvt_pk_bf16_f32 v98, 0, v98
    v_mul_f32 v5, s7, v99
    v_exp_f32 v5, -v5
    s_nop 0
    v_add_f32 v5, 1.0, v5
    v_rcp_f32 v5, v5
    s_nop 0
    v_mul_f32 v99, v99, v5
    v_cvt_pk_bf16_f32 v99, 0, v99
    s_waitcnt vmcnt(4)
    v_lshlrev_b32 v4, 16, v80
    v_and_b32 v5, s6, v80
    v_pk_mul_f32 v[20:21], v[4:5], v[96:97] op_sel:[0,0] op_sel_hi:[1,0]
    v_lshlrev_b32 v6, 16, v81
    v_and_b32 v7, s6, v81
    v_pk_mul_f32 v[22:23], v[6:7], v[96:97] op_sel:[0,0] op_sel_hi:[1,0]
    v_lshlrev_b32 v4, 16, v82
    v_and_b32 v5, s6, v82
    v_pk_mul_f32 v[24:25], v[4:5], v[96:97] op_sel:[0,0] op_sel_hi:[1,0]
    v_lshlrev_b32 v6, 16, v83
    v_and_b32 v7, s6, v83
    v_pk_mul_f32 v[26:27], v[6:7], v[96:97] op_sel:[0,0] op_sel_hi:[1,0]
    s_waitcnt vmcnt(3)
    v_lshlrev_b32 v4, 16, v84
    v_and_b32 v5, s6, v84
    v_pk_fma_f32 v[20:21], v[4:5], v[96:97], v[20:21] op_sel:[0,1,0] op_sel_hi:[1,1,1]
    v_lshlrev_b32 v6, 16, v85
    v_and_b32 v7, s6, v85
    v_pk_fma_f32 v[22:23], v[6:7], v[96:97], v[22:23] op_sel:[0,1,0] op_sel_hi:[1,1,1]
    v_lshlrev_b32 v4, 16, v86
    v_and_b32 v5, s6, v86
    v_pk_fma_f32 v[24:25], v[4:5], v[96:97], v[24:25] op_sel:[0,1,0] op_sel_hi:[1,1,1]
    v_lshlrev_b32 v6, 16, v87
    v_and_b32 v7, s6, v87
    v_pk_fma_f32 v[26:27], v[6:7], v[96:97], v[26:27] op_sel:[0,1,0] op_sel_hi:[1,1,1]
    s_waitcnt vmcnt(2)
    v_lshlrev_b32 v4, 16, v88
    v_and_b32 v5, s6, v88
    v_pk_fma_f32 v[20:21], v[4:5], v[98:99], v[20:21] op_sel:[0,0,0] op_sel_hi:[1,0,1]
    v_lshlrev_b32 v6, 16, v89
    v_and_b32 v7, s6, v89
    v_pk_fma_f32 v[22:23], v[6:7], v[98:99], v[22:23] op_sel:[0,0,0] op_sel_hi:[1,0,1]
    v_lshlrev_b32 v4, 16, v90
    v_and_b32 v5, s6, v90
    v_pk_fma_f32 v[24:25], v[4:5], v[98:99], v[24:25] op_sel:[0,0,0] op_sel_hi:[1,0,1]
    v_lshlrev_b32 v6, 16, v91
    v_and_b32 v7, s6, v91
    v_pk_fma_f32 v[26:27], v[6:7], v[98:99], v[26:27] op_sel:[0,0,0] op_sel_hi:[1,0,1]
    s_waitcnt vmcnt(1)
    v_lshlrev_b32 v4, 16, v92
    v_and_b32 v5, s6, v92
    v_pk_fma_f32 v[20:21], v[4:5], v[98:99], v[20:21] op_sel:[0,1,0] op_sel_hi:[1,1,1]
    v_lshlrev_b32 v6, 16, v93
    v_and_b32 v7, s6, v93
    v_pk_fma_f32 v[22:23], v[6:7], v[98:99], v[22:23] op_sel:[0,1,0] op_sel_hi:[1,1,1]
    v_lshlrev_b32 v4, 16, v94
    v_and_b32 v5, s6, v94
    v_pk_fma_f32 v[24:25], v[4:5], v[98:99], v[24:25] op_sel:[0,1,0] op_sel_hi:[1,1,1]
    v_lshlrev_b32 v6, 16, v95
    v_and_b32 v7, s6, v95
    v_pk_fma_f32 v[26:27], v[6:7], v[98:99], v[26:27] op_sel:[0,1,0] op_sel_hi:[1,1,1]
    v_permlane32_swap_b32 v20, v24
    v_permlane32_swap_b32 v21, v25
    v_permlane32_swap_b32 v22, v26
    v_permlane32_swap_b32 v23, v27
    v_add_f32 v20, v20, v24
    v_add_f32 v21, v21, v25
    v_add_f32 v22, v22, v26
    v_add_f32 v23, v23, v27
    s_nop 0
    v_permlane16_swap_b32 v20, v22
    v_permlane16_swap_b32 v21, v23
    v_add_f32 v20, v20, v22
    v_add_f32 v21, v21, v23
    s_nop 0
    v_add_f32_dpp v20, v20, v20 row_ror:8 row_mask:0xf bank_mask:0xf
    v_add_f32_dpp v21, v21, v21 row_ror:8 row_mask:0xf bank_mask:0xf
    s_nop 1
    v_mov_b32_dpp v20, v21 quad_perm:[0,1,2,3] row_mask:0xf bank_mask:0xc
    ds_write_b32 v65, v20
    s_waitcnt lgkmcnt(0)
    s_barrier
    s_mul_i32 s4, s4, 0x9e3779b1
    s_add_u32 s4, s4, 0x7f4a7c15
    ds_read_b128 v[20:23], v64 offset:0
    ds_read_b128 v[24:27], v64 offset:16
    s_waitcnt lgkmcnt(0)
    v_add_f32 v20, v20, v22
    v_add_f32 v21, v21, v23
    v_add_f32 v24, v24, v26
    v_add_f32 v25, v25, v27
    v_add_f32 v20, v20, v21
    v_add_f32 v22, v24, v25
    v_mov_b32 v21, s4
    v_mov_b32 v23, s4
    s_mov_b32 exec_hi, 0
    buffer_store_dwordx4 v[20:23], v2, s[32:35], s13 offen sc1
    s_mov_b64 exec, 15
    buffer_store_dword v21, v10, s[32:35], s15 offen sc1
    s_mov_b64 exec, -1
    s_branch L_FJ
L_FS:
    s_barrier
    buffer_load_dwordx4 v[80:83], v2, s[36:39], s16 offen
    buffer_load_dwordx4 v[84:87], v2, s[36:39], s16 offen offset:1024
    buffer_load_dwordx4 v[88:91], v2, s[36:39], s16 offen offset:2048
    buffer_load_dwordx4 v[92:95], v2, s[36:39], s16 offen offset:3072
    s_lshl2_add_u32 s96, s2, s3
    s_sub_u32 s97, s96, 4
    s_lshl_b32 s98, s97, 7
    s_add_u32 s17, s98, 2097152
    s_load_dword s24, s[32:33], s17 offset:0 glc
    s_load_dword s25, s[32:33], s17 offset:64 glc
    s_lshl_b32 s96, s2, 5
    s_add_u32 s97, s96, s3
    s_sub_u32 s98, s97, 4
    s_lshl_b32 s99, s98, 7
    s_add_u32 s17, s99, 1048576
    s_load_dword s24, s[32:33], s17 offset:0 glc
    s_load_dword s25, s[32:33], s17 offset:64 glc
    s_lshl_b32 s19, s94, 5
    v_mov_b32 v78, 1
    v_mov_b32 v79, s19
    s_barrier
    s_cmp_lg_u32 s3, 7
    s_cbranch_scc1 L_NOTK
    s_mov_b64 exec, 1
    global_atomic_add v78, v79, v78, s[30:31] sc0 sc1
    s_mov_b64 exec, -1
    s_branch L_TK0
L_NOTK:
    s_and_b32 s22, s22, 0xfffffc00
    global_load_dword v78, v10, s[22:23]
L_TK0:
    s_mov_b32 s42, 6291456
    s_mov_b32 s43, 0x20000
    s_mov_b32 s46, 2097152
    s_mov_b32 s47, 0x20000
    s_mov_b32 s54, 7340032
    s_mov_b32 s55, 0x20000
    s_mov_b32 s58, 7340032
    s_mov_b32 s59, 0x20000
    s_mov_b32 s62, 7340032
    s_mov_b32 s63, 0x20000
    s_mov_b32 s66, 4194304
    s_mov_b32 s67, 0x20000
    s_mov_b64 s[40:41], s[70:71]
    s_mov_b64 s[44:45], s[74:75]
    s_mov_b64 s[52:53], s[80:81]
    s_mov_b64 s[56:57], s[82:83]
    s_mov_b64 s[60:61], s[84:85]
    s_mov_b64 s[64:65], s[90:91]
    s_mov_b32 s5, 0
    s_mov_b32 s6, 0xffff0000
    s_mov_b32 s7, 0x3fb8aa3b
    s_lshr_b32 s76, s3, 2
    v_bfe_u32 v6, v1, 4, 1
    v_lshlrev_b32 v6, 6, v6
    v_and_b32 v62, 7, v1
    v_lshlrev_b32 v62, 4, v62
    v_xor_b32 v62, v62, v6
    v_lshrrev_b32 v6, 3, v1
    v_mul_u32_u24 v6, 6144, v6
    v_add_u32 v62, v62, v6
    v_lshlrev_b32 v63, 3, v1
    v_and_b32 v64, 31, v1
    v_lshlrev_b32 v64, 5, v64
    v_add_u32 v64, 149760, v64
    s_and_b32 s96, s3, 3
    s_lshl2_add_u32 s13, s96, 149760
    v_lshrrev_b32 v65, 4, v1
    v_lshl_add_u32 v65, v65, 5, s13
    v_and_b32 v9, 7, v1
    v_lshl_add_u32 v65, v9, 7, v65
    v_bfe_u32 v9, v1, 3, 1
    v_lshl_add_u32 v65, v9, 4, v65
    s_and_b32 s96, s8, 6
    s_and_b32 s97, s8, 1
    s_lshr_b32 s98, s9, 4
    s_lshl1_add_u32 s99, s97, s98
    s_lshl_b32 s97, s99, 6
    s_add_u32 s98, s96, s97
    s_lshl3_add_u32 s99, s3, s98
    s_lshl_b32 s96, s99, 10
    s_and_b32 s97, s9, 15
    s_lshl_b32 s98, s97, 6
    s_add_u32 s99, s96, s98
    s_add_u32 s14, s99, 262144
    s_sub_u32 s96, s3, 4
    s_lshl4_add_u32 s13, s96, 151808
    v_lshrrev_b32 v10, 5, v1
    v_lshl_add_u32 v10, v10, 3, s13
    s_barrier
    s_waitcnt vmcnt(1)
    s_waitcnt lgkmcnt(0)
    s_mul_i32 s4, s4, 0x9e3779b1
    s_add_u32 s4, s4, 0x7f4a7c15
    v_mov_b32 v104, 0x3f803f80
    v_dot2_f32_bf16 v100, v80, v104, 0
    v_dot2_f32_bf16 v102, v80, v80, 0
    v_dot2_f32_bf16 v101, v88, v104, 0
    v_dot2_f32_bf16 v103, v88, v88, 0
    v_dot2_f32_bf16 v100, v81, v104, v100
    v_dot2_f32_bf16 v102, v81, v81, v102
    v_dot2_f32_bf16 v101, v89, v104, v101
    v_dot2_f32_bf16 v103, v89, v89, v103
    v_dot2_f32_bf16 v100, v82, v104, v100
    v_dot2_f32_bf16 v102, v82, v82, v102
    v_dot2_f32_bf16 v101, v90, v104, v101
    v_dot2_f32_bf16 v103, v90, v90, v103
    v_dot2_f32_bf16 v100, v83, v104, v100
    v_dot2_f32_bf16 v102, v83, v83, v102
    v_dot2_f32_bf16 v101, v91, v104, v101
    v_dot2_f32_bf16 v103, v91, v91, v103
    v_dot2_f32_bf16 v100, v84, v104, v100
    v_dot2_f32_bf16 v102, v84, v84, v102
    v_dot2_f32_bf16 v101, v92, v104, v101
    v_dot2_f32_bf16 v103, v92, v92, v103
    v_dot2_f32_bf16 v100, v85, v104, v100
    v_dot2_f32_bf16 v102, v85, v85, v102
    v_dot2_f32_bf16 v101, v93, v104, v101
    v_dot2_f32_bf16 v103, v93, v93, v103
    v_dot2_f32_bf16 v100, v86, v104, v100
    v_dot2_f32_bf16 v102, v86, v86, v102
    v_dot2_f32_bf16 v101, v94, v104, v101
    v_dot2_f32_bf16 v103, v94, v94, v103
    v_dot2_f32_bf16 v100, v87, v104, v100
    v_dot2_f32_bf16 v102, v87, v87, v102
    v_dot2_f32_bf16 v101, v95, v104, v101
    v_dot2_f32_bf16 v103, v95, v95, v103
    s_nop 1
    v_permlane32_swap_b32 v100, v101
    v_permlane32_swap_b32 v102, v103
    v_add_f32 v100, v100, v101
    v_add_f32 v102, v102, v103
    s_nop 1
    v_permlane16_swap_b32 v100, v102
    v_add_f32 v100, v100, v102
    s_nop 1
    v_add_f32_dpp v100, v100, v100 quad_perm:[1,0,3,2] row_mask:0xf bank_mask:0xf
    s_nop 1
    v_add_f32_dpp v100, v100, v100 quad_perm:[2,3,0,1] row_mask:0xf bank_mask:0xf
    s_nop 1
    v_add_f32_dpp v100, v100, v100 row_half_mirror row_mask:0xf bank_mask:0xf
    s_nop 1
    v_add_f32_dpp v100, v100, v100 row_ror:8 row_mask:0xf bank_mask:0xf
    v_mul_f32 v102, 0x3a800000, v100
    v_mul_f32 v100, 0x3a800000, v100
    s_nop 1
    v_permlane16_swap_b32 v100, v102
    v_fma_f32 v117, -v100, v100, v102
    v_cvt_pk_bf16_f32 v116, 0, v100
    v_max_f32 v117, 0, v117
    v_cvt_pk_bf16_f32 v117, 0, v117
    v_add_f32 v117, 0x3727c5ac, v117
    v_cvt_pk_bf16_f32 v117, 0, v117
    v_sqrt_f32 v117, v117
    s_nop 0
    v_cvt_pk_bf16_f32 v117, 0, v117
    v_lshrrev_b32 v116, 16, v116
    v_or_b32 v116, v116, v117
    v_mov_b32 v117, s4
    ds_write_b64 v10, v[116:117]
L_FJ:
    v_and_b32 v5, 3, v1
    v_lshlrev_b32 v5, 4, v5
    v_add_u32 v5, 151808, v5
    v_and_b32 v4, 3, v1
    v_lshlrev_b32 v4, 4, v4
    v_bfe_u32 v9, v1, 2, 1
    v_lshl_add_u32 v4, v9, 10, v4
    v_and_b32 v10, 31, v1
    v_lshlrev_b32 v10, 11, v10
    v_lshrrev_b32 v9, 5, v1
    v_lshl_add_u32 v10, v9, 5, v10
    v_and_b32 v6, 1, v1
    v_lshlrev_b32 v6, 9, v6
    v_bfe_u32 v9, v1, 1, 1
    v_lshl_add_u32 v6, v9, 8, v6
    s_and_b32 s96, s9, 3
    s_and_b32 s97, s8, 6
    s_and_b32 s98, s8, 1
    s_lshr_b32 s99, s9, 4
    s_lshl1_add_u32 s98, s98, s99
    s_lshl_b32 s99, s98, 6
    s_add_u32 s98, s97, s99
    s_lshl3_add_u32 s97, s3, s98
    s_lshl_b32 s99, s97, 9
    s_bfe_u32 s98, s9, 131074
    s_lshl_b32 s97, s98, 6
    s_add_u32 s98, s99, s97
    s_lshl2_add_u32 s99, s96, s98
    s_add_u32 s97, s99, 16
    s_add_u32 s15, s97, 2097152
    s_waitcnt lgkmcnt(0)
    s_barrier
    ds_read_b128 v[116:119], v5
    s_waitcnt lgkmcnt(0)
    s_mov_b64 exec, 0xff
    buffer_store_dwordx4 v[116:119], v4, s[32:35], s14 offen sc1
    s_mov_b64 exec, 15
    buffer_store_dword v117, v6, s[32:35], s15 offen sc1
    s_mov_b64 exec, -1
    s_cmp_lg_u32 s3, 7
    s_cbranch_scc1 L_NOTK2
    s_mov_b32 s13, 0
    s_waitcnt vmcnt(2)
L_TK:
    v_readfirstlane_b32 s15, v78
    s_nop 0
    s_cmp_lt_u32 s15, 32
    s_cbranch_scc1 L_TKOK
    v_mov_b32 v78, s4
    s_mov_b64 exec, 1
    buffer_store_dword v78, v3, s[32:35], 0 offen offset:256 sc1
    s_mov_b64 exec, -1
    s_add_u32 s13, s13, 1
    s_cmp_lt_u32 s13, 8
    s_cbranch_scc0 L_TKNO
    s_add_u32 s94, s94, 1
    s_and_b32 s94, s94, 7
    s_lshl_b32 s19, s94, 5
    v_mov_b32 v78, 1
    v_mov_b32 v79, s19
    s_mov_b64 exec, 1
    global_atomic_add v78, v79, v78, s[30:31] sc0 sc1
    s_mov_b64 exec, -1
    s_waitcnt vmcnt(0)
    s_branch L_TK
L_TKNO:
    s_and_b32 s94, s2, 7
    s_lshr_b32 s15, s2, 3
L_TKOK:
    s_lshl3_add_u32 s15, s15, s94
    v_mov_b32 v78, s15
    ds_write_b32 v5, v78 offset:64
L_NOTK2:
    s_waitcnt lgkmcnt(0)
    s_barrier
    ds_read_b32 v120, v5 offset:64
    s_waitcnt lgkmcnt(0)
    v_readfirstlane_b32 s2, v120
    s_nop 0
    s_and_b32 s8, s2, 7
    s_lshr_b32 s9, s2, 3
    s_and_b32 s96, s8, 1
    s_and_b32 s97, s9, 7
    s_lshl3_add_u32 s12, s96, s97
    s_lshr_b32 s96, s8, 1
    s_lshr_b32 s97, s9, 3
    s_lshl2_add_u32 s21, s96, s97
    s_and_b32 s96, s3, 3
    s_lshl2_add_u32 s94, s21, s96
    s_lshl1_add_u32 s95, s12, s76
    s_lshl_b32 s96, s94, 16
    s_lshl_b32 s97, s95, 6
    s_add_u32 s18, s96, s97
    buffer_load_dwordx4 v[12:15], v10, s[36:39], s18 offen
    buffer_load_dwordx4 v[16:19], v10, s[36:39], s18 offen offset:16
    s_lshr_b32 s96, s8, 1
    s_lshl4_add_u32 s97, s96, s12
    s_lshl4_add_u32 s98, s97, s3
    s_lshl_b32 s99, s98, 9
    s_add_u32 s13, s99, 524288
    s_lshl3_add_u32 s96, s2, s3
    s_lshl_b32 s97, s96, 6
    s_add_u32 s15, s97, 2097152
    s_and_b32 s96, s3, 3
    s_lshl2_add_u32 s97, s2, s96
    s_lshl_b32 s98, s97, 8
    s_add_u32 s14, s98, 262144
    s_load_dwordx8 s[24:31], s[32:33], s15 offset:0 glc
    s_and_b32 s10, s9, 15
    s_lshr_b32 s96, s8, 2
    s_and_b32 s97, s8, 1
    s_lshl1_add_u32 s98, s96, s97
    s_and_b32 s99, s8, 2
    s_lshl2_add_u32 s96, s98, s99
    s_lshr_b32 s97, s9, 4
    s_add_u32 s11, s96, s97
    s_and_b32 s85, s9, 12
    s_lshl_b32 s96, s2, 6
    s_add_u32 s97, s96, s3
    s_lshl_b32 s98, s97, 6
    s_add_u32 s92, s98, 1048576
    s_lshr_b32 s96, s9, 4
    s_xor_b32 s77, s76, s96
    s_lshr_b32 s96, s9, 3
    s_xor_b32 s97, s96, s9
    s_and_b32 s98, s97, 1
    s_lshl2_add_u32 s83, s98, 8
    s_mul_i32 s96, s8, 7
    s_lshr_b32 s97, s9, 2
    s_add_u32 s74, s96, s97
    s_and_b32 s75, s9, 3
    v_and_b32 v8, 31, v1
    v_lshlrev_b32 v8, 3, v8
    v_and_b32 v4, 31, v1
    v_lshlrev_b32 v4, 4, v4
    v_lshrrev_b32 v9, 5, v1
    v_lshl_add_u32 v4, v9, 12, v4
    s_lshl2_add_u32 s16, s3, 152320
    v_lshl_add_u32 v5, v1, 6, s16
    s_lshl_b32 s96, s76, 10
    s_add_u32 s16, s96, 152320
    v_and_b32 v6, 15, v1
    v_lshl_add_u32 v6, v6, 5, s16
    v_lshrrev_b32 v9, 5, v1
    v_lshl_add_u32 v6, v9, 9, v6
    s_branch SCHK_2
SPOLL_1:
    s_load_dwordx8 s[24:31], s[32:33], s15 offset:0 glc
SCHK_2:
    s_add_u32 s5, s5, 1
    s_cmp_ge_u32 s5, 300000
    s_waitcnt lgkmcnt(0)
    s_cbranch_scc1 SDONE_3
    s_cmp_lg_u32 s24, s4
    s_cbranch_scc1 SPOLL_1
    s_cmp_lg_u32 s25, s4
    s_cbranch_scc1 SPOLL_1
    s_cmp_lg_u32 s28, s4
    s_cbranch_scc1 SPOLL_1
    s_cmp_lg_u32 s29, s4
    s_cbranch_scc1 SPOLL_1
    s_cmp_lg_u32 s30, s4
    s_cbranch_scc1 SPOLL_1
    s_cmp_lg_u32 s31, s4
    s_cbranch_scc1 SPOLL_1
SDONE_3:
    buffer_load_dwordx4 v[120:123], v4, s[32:35], s13 offen sc1
    buffer_load_dwordx2 v[116:117], v8, s[32:35], s14 offen sc1
    s_barrier
    s_lshl_b32 s96, s11, 12
    s_lshl_b32 s97, s3, 9
    s_add_u32 s16, s96, s97
    v_add_u32 v10, s16, v2
    s_lshl_b32 s96, s3, 9
    s_add_u32 m0, s96, 156416
    s_mov_b32 exec_hi, 0
    global_load_lds_dwordx4 v10, s[72:73]
    s_mov_b32 exec_hi, -1
    s_and_b32 s20, s9, 3
    s_add_u32 s96, s20, s85
    s_and_b32 s97, s96, 15
    s_lshl3_add_u32 s98, s97, s3
    s_mul_i32 s99, s98, 49152
    s_lshl_b32 s96, s11, 7
    s_add_u32 s82, s99, s96
    s_mul_i32 s96, s20, 24960
    s_lshr_b32 s97, s3, 1
    s_mul_i32 s98, s97, 2080
    s_add_u32 s99, s96, s98
    s_and_b32 s97, s3, 1
    s_mul_i32 s96, s97, 1056
    s_add_u32 s20, s99, s96
    s_mov_b32 m0, s20
    s_nop 0
    buffer_load_dwordx4 v62, s[40:43], s82 offen lds
    s_add_u32 s82, s82, 2048
    s_add_u32 m0, s20, 8320
    s_nop 0
    buffer_load_dwordx4 v62, s[40:43], s82 offen lds
    s_add_u32 s82, s82, 2048
    s_add_u32 m0, s20, 16640
    s_nop 0
    buffer_load_dwordx4 v62, s[40:43], s82 offen lds
    s_waitcnt vmcnt(5)
    v_bitop3_b32 v7, v121, v123, s4 bitop3:0x7e
    v_cmp_ne_u32 vcc, 0, v7
    s_cbranch_vccz TOK_5
POLL_6:
    buffer_load_dwordx4 v[120:123], v4, s[32:35], s13 offen sc1
    s_waitcnt vmcnt(0)
    v_bitop3_b32 v7, v121, v123, s4 bitop3:0x7e
    v_cmp_ne_u32 vcc, 0, v7
    s_cbranch_vccz PDONE_7
    s_add_u32 s5, s5, 1
    s_cmp_lt_u32 s5, 300000
    s_cbranch_scc1 POLL_6
PDONE_7:
TOK_5:
    ds_write2_b32 v5, v120, v122 offset0:0 offset1:8
    v_lshlrev_b32 v100, 16, v12
    v_and_b32 v101, s6, v12
    v_lshlrev_b32 v102, 16, v13
    v_and_b32 v103, s6, v13
    v_lshlrev_b32 v104, 16, v14
    v_and_b32 v105, s6, v14
    v_lshlrev_b32 v106, 16, v15
    v_and_b32 v107, s6, v15
    v_lshlrev_b32 v108, 16, v16
    v_and_b32 v109, s6, v16
    v_lshlrev_b32 v110, 16, v17
    v_and_b32 v111, s6, v17
    v_lshlrev_b32 v112, 16, v18
    v_and_b32 v113, s6, v18
    v_lshlrev_b32 v114, 16, v19
    v_and_b32 v115, s6, v19
    s_waitcnt lgkmcnt(0)
    s_barrier
    ds_read_b128 v[88:91], v6 offset:2048
    ds_read_b128 v[92:95], v6 offset:2064
    ds_read_b128 v[80:83], v6
    ds_read_b128 v[84:87], v6 offset:16
    s_waitcnt vmcnt(4)
    v_cmp_ne_u32 vcc, s4, v117
    s_cbranch_vccz TOK_8
POLL_9:
    buffer_load_dwordx2 v[116:117], v8, s[32:35], s14 offen sc1
    s_waitcnt vmcnt(0)
    v_cmp_ne_u32 vcc, s4, v117
    s_cbranch_vccz PDONE_10
    s_add_u32 s5, s5, 1
    s_cmp_lt_u32 s5, 300000
    s_cbranch_scc1 POLL_9
PDONE_10:
TOK_8:
    v_lshlrev_b32 v117, 16, v116
    v_and_b32 v116, s6, v116
    v_rcp_f32 v116, v116
    s_nop 0
    v_pk_add_f32 v[100:101], v[100:101], v[116:117] op_sel:[0,1] neg_lo:[0,1] neg_hi:[0,1]
    v_pk_add_f32 v[102:103], v[102:103], v[116:117] op_sel:[0,1] neg_lo:[0,1] neg_hi:[0,1]
    v_pk_add_f32 v[104:105], v[104:105], v[116:117] op_sel:[0,1] neg_lo:[0,1] neg_hi:[0,1]
    v_pk_add_f32 v[106:107], v[106:107], v[116:117] op_sel:[0,1] neg_lo:[0,1] neg_hi:[0,1]
    v_pk_add_f32 v[108:109], v[108:109], v[116:117] op_sel:[0,1] neg_lo:[0,1] neg_hi:[0,1]
    v_pk_add_f32 v[110:111], v[110:111], v[116:117] op_sel:[0,1] neg_lo:[0,1] neg_hi:[0,1]
    v_pk_add_f32 v[112:113], v[112:113], v[116:117] op_sel:[0,1] neg_lo:[0,1] neg_hi:[0,1]
    v_pk_add_f32 v[114:115], v[114:115], v[116:117] op_sel:[0,1] neg_lo:[0,1] neg_hi:[0,1]
    s_lshl4_add_u32 s96, s21, s12
    s_and_b32 s97, s3, 3
    s_lshl2_add_u32 s98, s96, s97
    s_lshl1_add_u32 s99, s98, s76
    s_lshl_b32 s96, s99, 11
    s_add_u32 s13, s96, 4194304
    v_and_b32 v8, 15, v1
    v_lshlrev_b32 v8, 4, v8
    v_bfe_u32 v9, v1, 4, 1
    v_lshl_add_u32 v8, v9, 10, v8
    v_lshrrev_b32 v9, 5, v1
    v_lshl_add_u32 v8, v9, 9, v8
    s_waitcnt lgkmcnt(2)
    v_pk_add_f32 v[88:89], v[88:89], v[90:91]
    v_pk_add_f32 v[92:93], v[92:93], v[94:95]
    v_pk_add_f32 v[88:89], v[88:89], v[92:93]
    v_add_f32 v88, v88, v89
    v_cvt_pk_bf16_f32 v88, 0, v88
    s_waitcnt lgkmcnt(0)
    v_pk_add_f32 v[80:81], v[80:81], v[82:83]
    v_pk_add_f32 v[84:85], v[84:85], v[86:87]
    v_pk_add_f32 v[80:81], v[80:81], v[84:85]
    v_add_f32 v80, v80, v81
    v_add_f32 v88, 1.0, v88
    v_cvt_pk_bf16_f32 v88, 0, v88
    v_cvt_pk_bf16_f32 v80, 0, v80
    s_lshl_b32 s96, s3, 8
    s_add_u32 s16, s96, 160512
    v_and_b32 v4, 15, v1
    v_lshl_add_u32 v4, v4, 2, s16
    v_lshrrev_b32 v9, 5, v1
    v_lshl_add_u32 v4, v9, 6, v4
    v_lshrrev_b32 v5, 5, v1
    v_lshl_add_u32 v5, v5, 6, s16
    ds_write2_b32 v4, v88, v80 offset0:0 offset1:32
    ds_read_b128 v[132:135], v5
    ds_read_b128 v[136:139], v5 offset:16
    ds_read_b128 v[140:143], v5 offset:32
    ds_read_b128 v[144:147], v5 offset:48
    ds_read_b128 v[148:151], v5 offset:128
    ds_read_b128 v[152:155], v5 offset:144
    ds_read_b128 v[156:159], v5 offset:160
    ds_read_b128 v[160:163], v5 offset:176
    v_cvt_pk_bf16_f32 v100, 0, v100
    v_cvt_pk_bf16_f32 v101, 0, v101
    v_cvt_pk_bf16_f32 v102, 0, v102
    v_cvt_pk_bf16_f32 v103, 0, v103
    v_cvt_pk_bf16_f32 v104, 0, v104
    v_cvt_pk_bf16_f32 v105, 0, v105
    v_cvt_pk_bf16_f32 v106, 0, v106
    v_cvt_pk_bf16_f32 v107, 0, v107
    v_pk_mul_f32 v[100:101], v[100:101], v[116:117] op_sel_hi:[1,0]
    v_pk_mul_f32 v[102:103], v[102:103], v[116:117] op_sel_hi:[1,0]
    v_pk_mul_f32 v[104:105], v[104:105], v[116:117] op_sel_hi:[1,0]
    v_pk_mul_f32 v[106:107], v[106:107], v[116:117] op_sel_hi:[1,0]
    v_cvt_pk_bf16_f32 v100, 0, v100
    v_cvt_pk_bf16_f32 v101, 0, v101
    v_cvt_pk_bf16_f32 v102, 0, v102
    v_cvt_pk_bf16_f32 v103, 0, v103
    v_cvt_pk_bf16_f32 v104, 0, v104
    v_cvt_pk_bf16_f32 v105, 0, v105
    v_cvt_pk_bf16_f32 v106, 0, v106
    v_cvt_pk_bf16_f32 v107, 0, v107
    v_cvt_pk_bf16_f32 v108, 0, v108
    v_cvt_pk_bf16_f32 v109, 0, v109
    v_cvt_pk_bf16_f32 v110, 0, v110
    v_cvt_pk_bf16_f32 v111, 0, v111
    v_cvt_pk_bf16_f32 v112, 0, v112
    v_cvt_pk_bf16_f32 v113, 0, v113
    v_cvt_pk_bf16_f32 v114, 0, v114
    v_cvt_pk_bf16_f32 v115, 0, v115
    v_pk_mul_f32 v[108:109], v[108:109], v[116:117] op_sel_hi:[1,0]
    v_pk_mul_f32 v[110:111], v[110:111], v[116:117] op_sel_hi:[1,0]
    v_pk_mul_f32 v[112:113], v[112:113], v[116:117] op_sel_hi:[1,0]
    v_pk_mul_f32 v[114:115], v[114:115], v[116:117] op_sel_hi:[1,0]
    v_cvt_pk_bf16_f32 v108, 0, v108
    v_cvt_pk_bf16_f32 v109, 0, v109
    v_cvt_pk_bf16_f32 v110, 0, v110
    v_cvt_pk_bf16_f32 v111, 0, v111
    v_cvt_pk_bf16_f32 v112, 0, v112
    v_cvt_pk_bf16_f32 v113, 0, v113
    v_cvt_pk_bf16_f32 v114, 0, v114
    v_cvt_pk_bf16_f32 v115, 0, v115
    s_waitcnt lgkmcnt(6)
    v_pk_mul_f32 v[100:101], v[100:101], v[132:133]
    v_pk_mul_f32 v[102:103], v[102:103], v[134:135]
    v_pk_mul_f32 v[104:105], v[104:105], v[136:137]
    v_pk_mul_f32 v[106:107], v[106:107], v[138:139]
    v_cvt_pk_bf16_f32 v100, 0, v100
    v_cvt_pk_bf16_f32 v101, 0, v101
    v_cvt_pk_bf16_f32 v102, 0, v102
    v_cvt_pk_bf16_f32 v103, 0, v103
    v_cvt_pk_bf16_f32 v104, 0, v104
    v_cvt_pk_bf16_f32 v105, 0, v105
    v_cvt_pk_bf16_f32 v106, 0, v106
    v_cvt_pk_bf16_f32 v107, 0, v107
    s_waitcnt lgkmcnt(2)
    v_pk_add_f32 v[100:101], v[100:101], v[148:149]
    v_pk_add_f32 v[102:103], v[102:103], v[150:151]
    v_pk_add_f32 v[104:105], v[104:105], v[152:153]
    v_pk_add_f32 v[106:107], v[106:107], v[154:155]
    v_cvt_pk_bf16_f32 v124, v100, v101
    v_cvt_pk_bf16_f32 v125, v102, v103
    v_cvt_pk_bf16_f32 v126, v104, v105
    v_cvt_pk_bf16_f32 v127, v106, v107
    buffer_store_dwordx4 v[124:127], v8, s[32:35], s13 offen sc1
    v_pk_mul_f32 v[108:109], v[108:109], v[140:141]
    v_pk_mul_f32 v[110:111], v[110:111], v[142:143]
    v_pk_mul_f32 v[112:113], v[112:113], v[144:145]
    v_pk_mul_f32 v[114:115], v[114:115], v[146:147]
    v_cvt_pk_bf16_f32 v108, 0, v108
    v_cvt_pk_bf16_f32 v109, 0, v109
    v_cvt_pk_bf16_f32 v110, 0, v110
    v_cvt_pk_bf16_f32 v111, 0, v111
    v_cvt_pk_bf16_f32 v112, 0, v112
    v_cvt_pk_bf16_f32 v113, 0, v113
    v_cvt_pk_bf16_f32 v114, 0, v114
    v_cvt_pk_bf16_f32 v115, 0, v115
    s_waitcnt lgkmcnt(0)
    v_pk_add_f32 v[108:109], v[108:109], v[156:157]
    v_pk_add_f32 v[110:111], v[110:111], v[158:159]
    v_pk_add_f32 v[112:113], v[112:113], v[160:161]
    v_pk_add_f32 v[114:115], v[114:115], v[162:163]
    v_cvt_pk_bf16_f32 v128, v108, v109
    v_cvt_pk_bf16_f32 v129, v110, v111
    v_cvt_pk_bf16_f32 v130, v112, v113
    v_cvt_pk_bf16_f32 v131, v114, v115
    buffer_store_dwordx4 v[128:131], v8, s[32:35], s13 offen offset:256 sc1
    v_lshrrev_b32 v66, 5, v1
    v_mul_u32_u24 v66, 2080, v66
    v_bfe_u32 v9, v1, 2, 2
    v_lshl_add_u32 v66, v9, 7, v66
    v_bfe_u32 v9, v1, 3, 1
    v_lshl_add_u32 v66, v9, 6, v66
    v_and_b32 v9, 3, v1
    v_lshl_add_u32 v66, v9, 3, v66
    v_bfe_u32 v67, v1, 4, 1
    v_mul_u32_u24 v67, 1056, v67
    v_bfe_u32 v68, v1, 3, 1
    v_lshlrev_b32 v68, 7, v68
    v_add_u32 v66, v66, v67
    v_sub_u32 v67, v66, v68
    v_add_u32 v67, 64, v67
    v_add_u32 v68, 49920, v66
    v_add_u32 v69, 49920, v67
    v_add_u32 v70, 99840, v66
    v_add_u32 v71, 99840, v67
    s_lshl_b32 s96, s76, 11
    s_add_u32 s14, s96, 156416
    v_bfe_u32 v4, v1, 2, 2
    v_lshl_add_u32 v4, v4, 6, s14
    v_bfe_u32 v9, v1, 4, 1
    v_lshl_add_u32 v4, v9, 5, v4
    v_and_b32 v9, 3, v1
    v_lshl_add_u32 v4, v9, 3, v4
    v_lshrrev_b32 v9, 5, v1
    v_lshl_add_u32 v4, v9, 9, v4
    v_and_b32 v5, 7, v1
    v_lshlrev_b32 v5, 12, v5
    v_bfe_u32 v9, v1, 3, 1
    v_lshl_add_u32 v5, v9, 19, v5
    s_and_b32 s96, s12, 1
    s_lshl_b32 s97, s21, 15
    s_lshr_b32 s98, s12, 1
    s_lshl_b32 s99, s98, 6
    s_add_u32 s98, s97, s99
    s_lshl2_add_u32 s97, s96, s98
    s_add_u32 s13, s97, 1048576
    v_bfe_u32 v6, v1, 4, 1
    v_lshlrev_b32 v6, 6, v6
    v_lshrrev_b32 v9, 5, v1
    v_lshl_add_u32 v6, v9, 4, v6
    v_and_b32 v74, 7, v1
    v_lshlrev_b32 v74, 4, v74
    v_xor_b32 v74, v74, v6
    v_lshrrev_b32 v6, 3, v1
    v_lshlrev_b32 v6, 11, v6
    v_add_u32 v74, v74, v6
    s_and_b32 s96, s3, 2
    s_lshl_b32 s14, s96, 5
    v_bfe_u32 v6, v1, 4, 1
    v_lshl_add_u32 v6, v6, 5, s14
    v_and_b32 v72, 7, v1
    v_lshlrev_b32 v72, 4, v72
    v_xor_b32 v72, v72, v6
    v_lshrrev_b32 v6, 3, v1
    v_mul_u32_u24 v6, 7168, v6
    v_add_u32 v72, v72, v6
    s_and_b32 s96, s3, 1
    s_lshl_b32 s14, s96, 7
    v_lshrrev_b32 v6, 5, v1
    v_lshl_add_u32 v6, v6, 6, s14
    v_and_b32 v73, 31, v1
    v_lshlrev_b32 v73, 4, v73
    v_lshrrev_b32 v9, 5, v1
    v_lshl_add_u32 v73, v9, 11, v73
    v_xor_b32 v73, v73, v6
    s_lshl3_add_u32 s96, s75, s3
    s_mul_i32 s97, s96, 229376
    s_lshl_b32 s98, s74, 7
    s_add_u32 s80, s97, s98
    s_lshl3_add_u32 s96, s74, s3
    s_lshl_b32 s97, s96, 14
    s_lshl_b32 s98, s75, 9
    s_add_u32 s81, s97, s98
    s_lshr_b32 s96, s9, 2
    s_add_u32 s90, s96, 1
    s_cmp_ge_u32 s90, 7
    s_cselect_b32 s90, 4294967290, 1
    s_cmp_ge_u32 s9, 28
    s_cselect_b32 s54, 0, s54
    s_cselect_b32 s58, 0, s58
    s_cselect_b32 s62, 0, s62
    s_waitcnt vmcnt(0)
    s_barrier
    s_cmp_lg_u32 s3, 0
    s_cbranch_scc1 L_PB
    v_mov_b32 v6, s4
    s_mov_b32 exec_hi, 0
    s_mov_b32 exec_lo, 65535
    buffer_store_dword v6, v5, s[32:35], s13 offen sc1
    s_mov_b64 exec, -1
L_PB:
    s_and_b32 s20, s9, 3
    s_cmp_le_u32 s20, 0
    s_cselect_b32 s20, 1, 0
    s_add_u32 s96, s20, s85
    s_and_b32 s97, s96, 15
    s_lshl3_add_u32 s98, s97, s3
    s_mul_i32 s99, s98, 49152
    s_lshl_b32 s96, s11, 7
    s_add_u32 s82, s99, s96
    s_mul_i32 s96, s20, 24960
    s_lshr_b32 s97, s3, 1
    s_mul_i32 s98, s97, 2080
    s_add_u32 s99, s96, s98
    s_and_b32 s97, s3, 1
    s_mul_i32 s96, s97, 1056
    s_add_u32 s20, s99, s96
    s_mov_b32 m0, s20
    s_nop 0
    buffer_load_dwordx4 v62, s[40:43], s82 offen lds
    s_add_u32 s82, s82, 2048
    s_add_u32 m0, s20, 8320
    s_nop 0
    buffer_load_dwordx4 v62, s[40:43], s82 offen lds
    s_add_u32 s82, s82, 2048
    s_add_u32 m0, s20, 16640
    s_nop 0
    buffer_load_dwordx4 v62, s[40:43], s82 offen lds
    s_and_b32 s20, s9, 3
    s_cmp_le_u32 s20, 1
    s_cselect_b32 s20, 2, 1
    s_add_u32 s96, s20, s85
    s_and_b32 s97, s96, 15
    s_lshl3_add_u32 s98, s97, s3
    s_mul_i32 s99, s98, 49152
    s_lshl_b32 s96, s11, 7
    s_add_u32 s82, s99, s96
    s_mul_i32 s96, s20, 24960
    s_lshr_b32 s97, s3, 1
    s_mul_i32 s98, s97, 2080
    s_add_u32 s99, s96, s98
    s_and_b32 s97, s3, 1
    s_mul_i32 s96, s97, 1056
    s_add_u32 s20, s99, s96
    s_mov_b32 m0, s20
    s_nop 0
    buffer_load_dwordx4 v62, s[40:43], s82 offen lds
    s_add_u32 s82, s82, 2048
    s_add_u32 m0, s20, 8320
    s_nop 0
    buffer_load_dwordx4 v62, s[40:43], s82 offen lds
    s_add_u32 s82, s82, 2048
    s_add_u32 m0, s20, 16640
    s_nop 0
    buffer_load_dwordx4 v62, s[40:43], s82 offen lds
    ds_read_b64_tr_b16 v[28:29], v4
    ds_read_b64_tr_b16 v[30:31], v4 offset:256
    ds_read_b64_tr_b16 v[32:33], v4 offset:1024
    ds_read_b64_tr_b16 v[34:35], v4 offset:1280
    s_lshl_b32 s96, s10, 6
    s_add_u32 s97, s96, s3
    s_lshl_b32 s98, s97, 12
    s_add_u32 s15, s98, 4194304
    s_and_b32 s96, s3, 3
    s_lshl_b32 s97, s96, 12
    s_add_u32 s13, s97, 147456
    v_add_u32 v76, s13, v2
    v_and_b32 v77, 15, v1
    v_lshl_add_u32 v77, v77, 4, s13
    v_lshrrev_b32 v9, 5, v1
    v_lshl_add_u32 v77, v9, 9, v77
    v_bfe_u32 v9, v1, 4, 1
    v_lshl_add_u32 v77, v9, 3, v77
    s_and_b32 s96, s3, 3
    s_lshl_b32 s97, s96, 10
    s_add_u32 s13, s97, 32768
    v_and_b32 v78, 15, v1
    v_lshl_add_u32 v78, v78, 5, s13
    v_lshrrev_b32 v9, 4, v1
    v_lshl_add_u32 v78, v9, 3, v78
    s_and_b32 s96, s3, 3
    s_lshl_b32 s97, s96, 10
    s_lshl_b32 s98, s76, 14
    s_add_u32 s13, s97, s98
    v_and_b32 v75, 31, v1
    v_lshl_add_u32 v75, v75, 5, s13
    v_lshrrev_b32 v9, 5, v1
    v_lshl_add_u32 v75, v9, 4, v75
    s_lshl_b32 s84, s3, 14
    s_lshr_b32 s96, s9, 4
    s_lshl_b32 s97, s96, 20
    s_lshl_b32 s98, s12, 7
    s_add_u32 s88, s97, s98
    s_lshl_b32 s89, s3, 10
    s_load_dwordx2 s[24:25], s[32:33], s92 offset:0 glc
    s_and_b32 s20, s9, 3
    s_cmp_le_u32 s20, 2
    s_cselect_b32 s20, 3, 2
    s_add_u32 s96, s20, s85
    s_and_b32 s97, s96, 15
    s_lshl3_add_u32 s98, s97, s3
    s_mul_i32 s99, s98, 49152
    s_lshl_b32 s96, s11, 7
    s_add_u32 s82, s99, s96
    s_mul_i32 s96, s20, 24960
    s_lshr_b32 s97, s3, 1
    s_mul_i32 s98, s97, 2080
    s_add_u32 s99, s96, s98
    s_and_b32 s97, s3, 1
    s_mul_i32 s96, s97, 1056
    s_add_u32 s20, s99, s96
    s_mov_b32 m0, s20
    s_nop 0
    buffer_load_dwordx4 v62, s[40:43], s82 offen lds
    s_add_u32 s82, s82, 2048
    s_add_u32 m0, s20, 8320
    s_nop 0
    buffer_load_dwordx4 v62, s[40:43], s82 offen lds
    s_add_u32 s82, s82, 2048
    s_add_u32 m0, s20, 16640
    s_nop 0
    buffer_load_dwordx4 v62, s[40:43], s82 offen lds
    s_add_u32 s96, s85, 4
    s_and_b32 s97, s96, 15
    s_lshl3_add_u32 s98, s97, s3
    s_mul_i32 s99, s98, 49152
    s_lshl_b32 s96, s11, 7
    s_add_u32 s82, s99, s96
    s_lshr_b32 s96, s3, 1
    s_mul_i32 s97, s96, 2080
    s_and_b32 s98, s3, 1
    s_mul_i32 s99, s98, 1056
    s_add_u32 s96, s97, s99
    s_add_u32 s20, s96, 99840
    s_mov_b32 m0, s20
    s_nop 0
    buffer_load_dwordx4 v62, s[40:43], s82 offen lds
    s_add_u32 s82, s82, 2048
    s_add_u32 m0, s20, 8320
    s_nop 0
    buffer_load_dwordx4 v62, s[40:43], s82 offen lds
    s_add_u32 s82, s82, 2048
    s_add_u32 m0, s20, 16640
    s_nop 0
    buffer_load_dwordx4 v62, s[40:43], s82 offen lds
    s_branch SCHK_12
SPOLL_11:
    s_load_dwordx2 s[24:25], s[32:33], s92 offset:0 glc
SCHK_12:
    s_add_u32 s5, s5, 1
    s_cmp_ge_u32 s5, 300000
    s_waitcnt lgkmcnt(0)
    s_cbranch_scc1 SDONE_13
    s_cmp_lg_u32 s24, s4
    s_cbranch_scc1 SPOLL_11
    s_cmp_lg_u32 s25, s4
    s_cbranch_scc1 SPOLL_11
SDONE_13:
    s_waitcnt vmcnt(9)
    s_barrier
    s_cmp_ge_u32 s3, 4
    s_cbranch_scc1 L_HELP
    s_setprio 2
    s_and_b32 s96, s85, 15
    s_lshl_b32 s97, s96, 14
    s_add_u32 s16, s97, s15
    buffer_load_dwordx4 v[176:179], v2, s[32:35], s16 offen sc1
    buffer_load_dwordx4 v[180:183], v2, s[32:35], s16 offen offset:1024 sc1
    ds_read_b64_tr_b16 v[224:225], v67 offset:8320
    ds_read_b64_tr_b16 v[226:227], v67 offset:8832
    ds_read_b64_tr_b16 v[228:229], v67 offset:8352
    ds_read_b64_tr_b16 v[230:231], v67 offset:8864
    ds_read_b64_tr_b16 v[232:233], v66 offset:8320
    ds_read_b64_tr_b16 v[234:235], v66 offset:8832
    ds_read_b64_tr_b16 v[236:237], v66 offset:8352
    ds_read_b64_tr_b16 v[238:239], v66 offset:8864
    ds_read_b64_tr_b16 v[240:241], v66
    ds_read_b64_tr_b16 v[242:243], v66 offset:512
    ds_read_b64_tr_b16 v[244:245], v66 offset:32
    ds_read_b64_tr_b16 v[246:247], v66 offset:544
    buffer_load_dwordx4 v[184:187], v2, s[32:35], s16 offen offset:2048 sc1
    buffer_load_dwordx4 v[188:191], v2, s[32:35], s16 offen offset:3072 sc1
    s_waitcnt lgkmcnt(8)
    s_waitcnt vmcnt(3)
    v_mfma_f32_16x16x32_bf16 v[128:131], v[224:227], v[176:179], 0
    ds_read_b64_tr_b16 v[248:249], v67
    s_waitcnt vmcnt(2)
    v_mfma_f32_16x16x32_bf16 v[132:135], v[224:227], v[180:183], 0
    ds_read_b64_tr_b16 v[250:251], v67 offset:512
    s_add_u32 s96, s85, 1
    s_and_b32 s97, s96, 15
    s_lshl_b32 s98, s97, 14
    s_add_u32 s16, s98, s15
    buffer_load_dwordx4 v[192:195], v2, s[32:35], s16 offen sc1
    v_mfma_f32_16x16x32_bf16 v[136:139], v[228:231], v[176:179], 0
    ds_read_b64_tr_b16 v[224:225], v67 offset:32
    v_mfma_f32_16x16x32_bf16 v[140:143], v[228:231], v[180:183], 0
    ds_read_b64_tr_b16 v[226:227], v67 offset:544
    s_waitcnt lgkmcnt(8)
    v_mfma_f32_16x16x32_bf16 v[112:115], v[232:235], v[176:179], 0
    ds_read_b64_tr_b16 v[228:229], v66 offset:16640
    v_mfma_f32_16x16x32_bf16 v[116:119], v[232:235], v[180:183], 0
    ds_read_b64_tr_b16 v[230:231], v66 offset:17152
    v_mfma_f32_16x16x32_bf16 v[120:123], v[236:239], v[176:179], 0
    ds_read_b64_tr_b16 v[232:233], v66 offset:16672
    v_mfma_f32_16x16x32_bf16 v[124:127], v[236:239], v[180:183], 0
    ds_read_b64_tr_b16 v[234:235], v66 offset:17184
    buffer_load_dwordx4 v[196:199], v2, s[32:35], s16 offen offset:1024 sc1
    s_waitcnt lgkmcnt(8)
    v_mfma_f32_16x16x32_bf16 v[80:83], v[240:243], v[176:179], 0
    ds_read_b64_tr_b16 v[236:237], v67 offset:16640
    v_mfma_f32_16x16x32_bf16 v[84:87], v[240:243], v[180:183], 0
    ds_read_b64_tr_b16 v[238:239], v67 offset:17152
    v_mfma_f32_16x16x32_bf16 v[88:91], v[244:247], v[176:179], 0
    ds_read_b64_tr_b16 v[240:241], v67 offset:16672
    v_mfma_f32_16x16x32_bf16 v[92:95], v[244:247], v[180:183], 0
    ds_read_b64_tr_b16 v[242:243], v67 offset:17184
    s_waitcnt lgkmcnt(8)
    v_mfma_f32_16x16x32_bf16 v[96:99], v[248:251], v[176:179], 0
    ds_read_b64_tr_b16 v[244:245], v67 offset:12480
    v_mfma_f32_16x16x32_bf16 v[100:103], v[248:251], v[180:183], 0
    ds_read_b64_tr_b16 v[246:247], v67 offset:12992
    buffer_load_dwordx4 v[200:203], v2, s[32:35], s16 offen offset:2048 sc1
    v_mfma_f32_16x16x32_bf16 v[104:107], v[224:227], v[176:179], 0
    ds_read_b64_tr_b16 v[248:249], v67 offset:12512
    v_mfma_f32_16x16x32_bf16 v[108:111], v[224:227], v[180:183], 0
    ds_read_b64_tr_b16 v[250:251], v67 offset:13024
    s_waitcnt lgkmcnt(8)
    v_mfma_f32_16x16x32_bf16 v[144:147], v[228:231], v[176:179], 0
    ds_read_b64_tr_b16 v[224:225], v66 offset:12480
    v_mfma_f32_16x16x32_bf16 v[148:151], v[228:231], v[180:183], 0
    ds_read_b64_tr_b16 v[226:227], v66 offset:12992
    v_mfma_f32_16x16x32_bf16 v[152:155], v[232:235], v[176:179], 0
    ds_read_b64_tr_b16 v[228:229], v66 offset:12512
    v_mfma_f32_16x16x32_bf16 v[156:159], v[232:235], v[180:183], 0
    ds_read_b64_tr_b16 v[230:231], v66 offset:13024
    buffer_load_dwordx4 v[204:207], v2, s[32:35], s16 offen offset:3072 sc1
    s_waitcnt lgkmcnt(8)
    v_mfma_f32_16x16x32_bf16 v[160:163], v[236:239], v[176:179], 0
    ds_read_b64_tr_b16 v[232:233], v66 offset:4160
    v_mfma_f32_16x16x32_bf16 v[164:167], v[236:239], v[180:183], 0
    ds_read_b64_tr_b16 v[234:235], v66 offset:4672
    v_mfma_f32_16x16x32_bf16 v[168:171], v[240:243], v[176:179], 0
    ds_read_b64_tr_b16 v[236:237], v66 offset:4192
    v_mfma_f32_16x16x32_bf16 v[172:175], v[240:243], v[180:183], 0
    ds_read_b64_tr_b16 v[238:239], v66 offset:4704
    s_waitcnt lgkmcnt(8)
    s_waitcnt vmcnt(5)
    v_mfma_f32_16x16x32_bf16 v[128:131], v[244:247], v[184:187], v[128:131]
    ds_read_b64_tr_b16 v[240:241], v67 offset:4160
    s_waitcnt vmcnt(4)
    v_mfma_f32_16x16x32_bf16 v[132:135], v[244:247], v[188:191], v[132:135]
    ds_read_b64_tr_b16 v[242:243], v67 offset:4672
    s_add_u32 s96, s85, 2
    s_and_b32 s97, s96, 15
    s_lshl_b32 s98, s97, 14
    s_add_u32 s16, s98, s15
    buffer_load_dwordx4 v[208:211], v2, s[32:35], s16 offen sc1
    v_mfma_f32_16x16x32_bf16 v[136:139], v[248:251], v[184:187], v[136:139]
    ds_read_b64_tr_b16 v[244:245], v67 offset:4192
    v_mfma_f32_16x16x32_bf16 v[140:143], v[248:251], v[188:191], v[140:143]
    ds_read_b64_tr_b16 v[246:247], v67 offset:4704
    s_waitcnt lgkmcnt(8)
    v_mfma_f32_16x16x32_bf16 v[112:115], v[224:227], v[184:187], v[112:115]
    ds_read_b64_tr_b16 v[248:249], v66 offset:20800
    v_mfma_f32_16x16x32_bf16 v[116:119], v[224:227], v[188:191], v[116:119]
    ds_read_b64_tr_b16 v[250:251], v66 offset:21312
    v_mfma_f32_16x16x32_bf16 v[120:123], v[228:231], v[184:187], v[120:123]
    ds_read_b64_tr_b16 v[224:225], v66 offset:20832
    v_mfma_f32_16x16x32_bf16 v[124:127], v[228:231], v[188:191], v[124:127]
    ds_read_b64_tr_b16 v[226:227], v66 offset:21344
    buffer_load_dwordx4 v[212:215], v2, s[32:35], s16 offen offset:1024 sc1
    s_waitcnt lgkmcnt(8)
    v_mfma_f32_16x16x32_bf16 v[80:83], v[232:235], v[184:187], v[80:83]
    ds_read_b64_tr_b16 v[228:229], v67 offset:20800
    v_mfma_f32_16x16x32_bf16 v[84:87], v[232:235], v[188:191], v[84:87]
    ds_read_b64_tr_b16 v[230:231], v67 offset:21312
    v_mfma_f32_16x16x32_bf16 v[88:91], v[236:239], v[184:187], v[88:91]
    ds_read_b64_tr_b16 v[232:233], v67 offset:20832
    v_mfma_f32_16x16x32_bf16 v[92:95], v[236:239], v[188:191], v[92:95]
    ds_read_b64_tr_b16 v[234:235], v67 offset:21344
    s_waitcnt lgkmcnt(8)
    v_mfma_f32_16x16x32_bf16 v[96:99], v[240:243], v[184:187], v[96:99]
    s_barrier
    ds_read_b64_tr_b16 v[236:237], v67 offset:33280
    v_mfma_f32_16x16x32_bf16 v[100:103], v[240:243], v[188:191], v[100:103]
    ds_read_b64_tr_b16 v[238:239], v67 offset:33792
    buffer_load_dwordx4 v[216:219], v2, s[32:35], s16 offen offset:2048 sc1
    v_mfma_f32_16x16x32_bf16 v[104:107], v[244:247], v[184:187], v[104:107]
    ds_read_b64_tr_b16 v[240:241], v67 offset:33312
    v_mfma_f32_16x16x32_bf16 v[108:111], v[244:247], v[188:191], v[108:111]
    ds_read_b64_tr_b16 v[242:243], v67 offset:33824
    s_waitcnt lgkmcnt(8)
    v_mfma_f32_16x16x32_bf16 v[144:147], v[248:251], v[184:187], v[144:147]
    ds_read_b64_tr_b16 v[244:245], v66 offset:33280
    v_mfma_f32_16x16x32_bf16 v[148:151], v[248:251], v[188:191], v[148:151]
    ds_read_b64_tr_b16 v[246:247], v66 offset:33792
    v_mfma_f32_16x16x32_bf16 v[152:155], v[224:227], v[184:187], v[152:155]
    ds_read_b64_tr_b16 v[248:249], v66 offset:33312
    v_mfma_f32_16x16x32_bf16 v[156:159], v[224:227], v[188:191], v[156:159]
    ds_read_b64_tr_b16 v[250:251], v66 offset:33824
    buffer_load_dwordx4 v[220:223], v2, s[32:35], s16 offen offset:3072 sc1
    s_waitcnt lgkmcnt(8)
    v_mfma_f32_16x16x32_bf16 v[160:163], v[228:231], v[184:187], v[160:163]
    ds_read_b64_tr_b16 v[224:225], v66 offset:24960
    v_mfma_f32_16x16x32_bf16 v[164:167], v[228:231], v[188:191], v[164:167]
    ds_read_b64_tr_b16 v[226:227], v66 offset:25472
    v_mfma_f32_16x16x32_bf16 v[168:171], v[232:235], v[184:187], v[168:171]
    ds_read_b64_tr_b16 v[228:229], v66 offset:24992
    v_mfma_f32_16x16x32_bf16 v[172:175], v[232:235], v[188:191], v[172:175]
    ds_read_b64_tr_b16 v[230:231], v66 offset:25504
    s_waitcnt lgkmcnt(8)
    s_waitcnt vmcnt(6)
    v_mfma_f32_16x16x32_bf16 v[128:131], v[236:239], v[192:195], v[128:131]
    ds_read_b64_tr_b16 v[232:233], v67 offset:24960
    v_mfma_f32_16x16x32_bf16 v[132:135], v[236:239], v[196:199], v[132:135]
    ds_read_b64_tr_b16 v[234:235], v67 offset:25472
    s_add_u32 s96, s85, 3
    s_and_b32 s97, s96, 15
    s_lshl_b32 s98, s97, 14
    s_add_u32 s16, s98, s15
    buffer_load_dwordx4 v[36:39], v2, s[32:35], s16 offen sc1
    v_mfma_f32_16x16x32_bf16 v[136:139], v[240:243], v[192:195], v[136:139]
    ds_read_b64_tr_b16 v[236:237], v67 offset:24992
    v_mfma_f32_16x16x32_bf16 v[140:143], v[240:243], v[196:199], v[140:143]
    ds_read_b64_tr_b16 v[238:239], v67 offset:25504
    s_waitcnt lgkmcnt(8)
    v_mfma_f32_16x16x32_bf16 v[112:115], v[244:247], v[192:195], v[112:115]
    ds_read_b64_tr_b16 v[240:241], v66 offset:41600
    v_mfma_f32_16x16x32_bf16 v[116:119], v[244:247], v[196:199], v[116:119]
    ds_read_b64_tr_b16 v[242:243], v66 offset:42112
    v_mfma_f32_16x16x32_bf16 v[120:123], v[248:251], v[192:195], v[120:123]
    ds_read_b64_tr_b16 v[244:245], v66 offset:41632
    v_mfma_f32_16x16x32_bf16 v[124:127], v[248:251], v[196:199], v[124:127]
    ds_read_b64_tr_b16 v[246:247], v66 offset:42144
    buffer_load_dwordx4 v[176:179], v2, s[32:35], s16 offen offset:1024 sc1
    s_waitcnt lgkmcnt(8)
    v_mfma_f32_16x16x32_bf16 v[80:83], v[224:227], v[192:195], v[80:83]
    ds_read_b64_tr_b16 v[248:249], v67 offset:41600
    v_mfma_f32_16x16x32_bf16 v[84:87], v[224:227], v[196:199], v[84:87]
    ds_read_b64_tr_b16 v[250:251], v67 offset:42112
    v_mfma_f32_16x16x32_bf16 v[88:91], v[228:231], v[192:195], v[88:91]
    ds_read_b64_tr_b16 v[224:225], v67 offset:41632
    v_mfma_f32_16x16x32_bf16 v[92:95], v[228:231], v[196:199], v[92:95]
    ds_read_b64_tr_b16 v[226:227], v67 offset:42144
    s_waitcnt lgkmcnt(8)
    v_mfma_f32_16x16x32_bf16 v[96:99], v[232:235], v[192:195], v[96:99]
    ds_read_b64_tr_b16 v[228:229], v67 offset:37440
    v_mfma_f32_16x16x32_bf16 v[100:103], v[232:235], v[196:199], v[100:103]
    ds_read_b64_tr_b16 v[230:231], v67 offset:37952
    buffer_load_dwordx4 v[180:183], v2, s[32:35], s16 offen offset:2048 sc1
    v_mfma_f32_16x16x32_bf16 v[104:107], v[236:239], v[192:195], v[104:107]
    ds_read_b64_tr_b16 v[232:233], v67 offset:37472
    v_mfma_f32_16x16x32_bf16 v[108:111], v[236:239], v[196:199], v[108:111]
    ds_read_b64_tr_b16 v[234:235], v67 offset:37984
    s_waitcnt lgkmcnt(8)
    v_mfma_f32_16x16x32_bf16 v[144:147], v[240:243], v[192:195], v[144:147]
    ds_read_b64_tr_b16 v[236:237], v66 offset:37440
    v_mfma_f32_16x16x32_bf16 v[148:151], v[240:243], v[196:199], v[148:151]
    ds_read_b64_tr_b16 v[238:239], v66 offset:37952
    v_mfma_f32_16x16x32_bf16 v[152:155], v[244:247], v[192:195], v[152:155]
    ds_read_b64_tr_b16 v[240:241], v66 offset:37472
    v_mfma_f32_16x16x32_bf16 v[156:159], v[244:247], v[196:199], v[156:159]
    ds_read_b64_tr_b16 v[242:243], v66 offset:37984
    buffer_load_dwordx4 v[184:187], v2, s[32:35], s16 offen offset:3072 sc1
    s_waitcnt lgkmcnt(8)
    v_mfma_f32_16x16x32_bf16 v[160:163], v[248:251], v[192:195], v[160:163]
    ds_read_b64_tr_b16 v[244:245], v66 offset:29120
    v_mfma_f32_16x16x32_bf16 v[164:167], v[248:251], v[196:199], v[164:167]
    ds_read_b64_tr_b16 v[246:247], v66 offset:29632
    v_mfma_f32_16x16x32_bf16 v[168:171], v[224:227], v[192:195], v[168:171]
    ds_read_b64_tr_b16 v[248:249], v66 offset:29152
    v_mfma_f32_16x16x32_bf16 v[172:175], v[224:227], v[196:199], v[172:175]
    ds_read_b64_tr_b16 v[250:251], v66 offset:29664
    s_waitcnt lgkmcnt(8)
    s_waitcnt vmcnt(8)
    v_mfma_f32_16x16x32_bf16 v[128:131], v[228:231], v[200:203], v[128:131]
    ds_read_b64_tr_b16 v[224:225], v67 offset:29120
    v_mfma_f32_16x16x32_bf16 v[132:135], v[228:231], v[204:207], v[132:135]
    ds_read_b64_tr_b16 v[226:227], v67 offset:29632
    s_add_u32 s96, s85, 4
    s_and_b32 s97, s96, 15
    s_lshl_b32 s98, s97, 14
    s_add_u32 s16, s98, s15
    buffer_load_dwordx4 v[188:191], v2, s[32:35], s16 offen sc1
    v_mfma_f32_16x16x32_bf16 v[136:139], v[232:235], v[200:203], v[136:139]
    ds_read_b64_tr_b16 v[228:229], v67 offset:29152
    v_mfma_f32_16x16x32_bf16 v[140:143], v[232:235], v[204:207], v[140:143]
    ds_read_b64_tr_b16 v[230:231], v67 offset:29664
    s_waitcnt lgkmcnt(8)
    v_mfma_f32_16x16x32_bf16 v[112:115], v[236:239], v[200:203], v[112:115]
    ds_read_b64_tr_b16 v[232:233], v66 offset:45760
    v_mfma_f32_16x16x32_bf16 v[116:119], v[236:239], v[204:207], v[116:119]
    ds_read_b64_tr_b16 v[234:235], v66 offset:46272
    v_mfma_f32_16x16x32_bf16 v[120:123], v[240:243], v[200:203], v[120:123]
    ds_read_b64_tr_b16 v[236:237], v66 offset:45792
    v_mfma_f32_16x16x32_bf16 v[124:127], v[240:243], v[204:207], v[124:127]
    ds_read_b64_tr_b16 v[238:239], v66 offset:46304
    buffer_load_dwordx4 v[192:195], v2, s[32:35], s16 offen offset:1024 sc1
    s_waitcnt lgkmcnt(8)
    v_mfma_f32_16x16x32_bf16 v[80:83], v[244:247], v[200:203], v[80:83]
    ds_read_b64_tr_b16 v[240:241], v67 offset:45760
    v_mfma_f32_16x16x32_bf16 v[84:87], v[244:247], v[204:207], v[84:87]
    ds_read_b64_tr_b16 v[242:243], v67 offset:46272
    v_mfma_f32_16x16x32_bf16 v[88:91], v[248:251], v[200:203], v[88:91]
    ds_read_b64_tr_b16 v[244:245], v67 offset:45792
    v_mfma_f32_16x16x32_bf16 v[92:95], v[248:251], v[204:207], v[92:95]
    ds_read_b64_tr_b16 v[246:247], v67 offset:46304
    s_waitcnt lgkmcnt(8)
    v_mfma_f32_16x16x32_bf16 v[96:99], v[224:227], v[200:203], v[96:99]
    s_barrier
    ds_read_b64_tr_b16 v[248:249], v69 offset:8320
    v_mfma_f32_16x16x32_bf16 v[100:103], v[224:227], v[204:207], v[100:103]
    ds_read_b64_tr_b16 v[250:251], v69 offset:8832
    buffer_load_dwordx4 v[196:199], v2, s[32:35], s16 offen offset:2048 sc1
    v_mfma_f32_16x16x32_bf16 v[104:107], v[228:231], v[200:203], v[104:107]
    ds_read_b64_tr_b16 v[224:225], v69 offset:8352
    v_mfma_f32_16x16x32_bf16 v[108:111], v[228:231], v[204:207], v[108:111]
    ds_read_b64_tr_b16 v[226:227], v69 offset:8864
    s_waitcnt lgkmcnt(8)
    v_mfma_f32_16x16x32_bf16 v[144:147], v[232:235], v[200:203], v[144:147]
    ds_read_b64_tr_b16 v[228:229], v68 offset:8320
    v_mfma_f32_16x16x32_bf16 v[148:151], v[232:235], v[204:207], v[148:151]
    ds_read_b64_tr_b16 v[230:231], v68 offset:8832
    v_mfma_f32_16x16x32_bf16 v[152:155], v[236:239], v[200:203], v[152:155]
    ds_read_b64_tr_b16 v[232:233], v68 offset:8352
    v_mfma_f32_16x16x32_bf16 v[156:159], v[236:239], v[204:207], v[156:159]
    ds_read_b64_tr_b16 v[234:235], v68 offset:8864
    s_waitcnt lgkmcnt(8)
    v_mfma_f32_16x16x32_bf16 v[160:163], v[240:243], v[200:203], v[160:163]
    ds_read_b64_tr_b16 v[236:237], v68
    v_mfma_f32_16x16x32_bf16 v[164:167], v[240:243], v[204:207], v[164:167]
    ds_read_b64_tr_b16 v[238:239], v68 offset:512
    v_mfma_f32_16x16x32_bf16 v[168:171], v[244:247], v[200:203], v[168:171]
    ds_read_b64_tr_b16 v[240:241], v68 offset:32
    v_mfma_f32_16x16x32_bf16 v[172:175], v[244:247], v[204:207], v[172:175]
    ds_read_b64_tr_b16 v[242:243], v68 offset:544
    s_waitcnt lgkmcnt(8)
    s_waitcnt vmcnt(9)
    v_mfma_f32_16x16x32_bf16 v[128:131], v[248:251], v[208:211], v[128:131]
    ds_read_b64_tr_b16 v[244:245], v69
    v_mfma_f32_16x16x32_bf16 v[132:135], v[248:251], v[212:215], v[132:135]
    ds_read_b64_tr_b16 v[246:247], v69 offset:512
    buffer_load_dwordx4 v[200:203], v2, s[32:35], s16 offen offset:3072 sc1
    v_mfma_f32_16x16x32_bf16 v[136:139], v[224:227], v[208:211], v[136:139]
    ds_read_b64_tr_b16 v[248:249], v69 offset:32
    v_mfma_f32_16x16x32_bf16 v[140:143], v[224:227], v[212:215], v[140:143]
    ds_read_b64_tr_b16 v[250:251], v69 offset:544
    s_waitcnt lgkmcnt(8)
    v_mfma_f32_16x16x32_bf16 v[112:115], v[228:231], v[208:211], v[112:115]
    ds_read_b64_tr_b16 v[224:225], v68 offset:16640
    v_mfma_f32_16x16x32_bf16 v[116:119], v[228:231], v[212:215], v[116:119]
    ds_read_b64_tr_b16 v[226:227], v68 offset:17152
    v_mfma_f32_16x16x32_bf16 v[120:123], v[232:235], v[208:211], v[120:123]
    ds_read_b64_tr_b16 v[228:229], v68 offset:16672
    v_mfma_f32_16x16x32_bf16 v[124:127], v[232:235], v[212:215], v[124:127]
    ds_read_b64_tr_b16 v[230:231], v68 offset:17184
    s_add_u32 s96, s85, 5
    s_and_b32 s97, s96, 15
    s_lshl_b32 s98, s97, 14
    s_add_u32 s16, s98, s15
    buffer_load_dwordx4 v[204:207], v2, s[32:35], s16 offen sc1
    s_waitcnt lgkmcnt(8)
    v_mfma_f32_16x16x32_bf16 v[80:83], v[236:239], v[208:211], v[80:83]
    ds_read_b64_tr_b16 v[232:233], v69 offset:16640
    v_mfma_f32_16x16x32_bf16 v[84:87], v[236:239], v[212:215], v[84:87]
    ds_read_b64_tr_b16 v[234:235], v69 offset:17152
    v_mfma_f32_16x16x32_bf16 v[88:91], v[240:243], v[208:211], v[88:91]
    ds_read_b64_tr_b16 v[236:237], v69 offset:16672
    v_mfma_f32_16x16x32_bf16 v[92:95], v[240:243], v[212:215], v[92:95]
    ds_read_b64_tr_b16 v[238:239], v69 offset:17184
    s_waitcnt lgkmcnt(8)
    v_mfma_f32_16x16x32_bf16 v[96:99], v[244:247], v[208:211], v[96:99]
    ds_read_b64_tr_b16 v[240:241], v69 offset:12480
    v_mfma_f32_16x16x32_bf16 v[100:103], v[244:247], v[212:215], v[100:103]
    ds_read_b64_tr_b16 v[242:243], v69 offset:12992
    v_mfma_f32_16x16x32_bf16 v[104:107], v[248:251], v[208:211], v[104:107]
    ds_read_b64_tr_b16 v[244:245], v69 offset:12512
    v_mfma_f32_16x16x32_bf16 v[108:111], v[248:251], v[212:215], v[108:111]
    ds_read_b64_tr_b16 v[246:247], v69 offset:13024
    s_waitcnt lgkmcnt(8)
    v_mfma_f32_16x16x32_bf16 v[144:147], v[224:227], v[208:211], v[144:147]
    ds_read_b64_tr_b16 v[248:249], v68 offset:12480
    v_mfma_f32_16x16x32_bf16 v[148:151], v[224:227], v[212:215], v[148:151]
    ds_read_b64_tr_b16 v[250:251], v68 offset:12992
    v_mfma_f32_16x16x32_bf16 v[152:155], v[228:231], v[208:211], v[152:155]
    ds_read_b64_tr_b16 v[224:225], v68 offset:12512
    v_mfma_f32_16x16x32_bf16 v[156:159], v[228:231], v[212:215], v[156:159]
    ds_read_b64_tr_b16 v[226:227], v68 offset:13024
    s_waitcnt lgkmcnt(8)
    v_mfma_f32_16x16x32_bf16 v[160:163], v[232:235], v[208:211], v[160:163]
    ds_read_b64_tr_b16 v[228:229], v68 offset:4160
    v_mfma_f32_16x16x32_bf16 v[164:167], v[232:235], v[212:215], v[164:167]
    ds_read_b64_tr_b16 v[230:231], v68 offset:4672
    v_mfma_f32_16x16x32_bf16 v[168:171], v[236:239], v[208:211], v[168:171]
    ds_read_b64_tr_b16 v[232:233], v68 offset:4192
    v_mfma_f32_16x16x32_bf16 v[172:175], v[236:239], v[212:215], v[172:175]
    ds_read_b64_tr_b16 v[234:235], v68 offset:4704
    s_waitcnt lgkmcnt(8)
    s_waitcnt vmcnt(9)
    v_mfma_f32_16x16x32_bf16 v[128:131], v[240:243], v[216:219], v[128:131]
    ds_read_b64_tr_b16 v[236:237], v69 offset:4160
    v_mfma_f32_16x16x32_bf16 v[132:135], v[240:243], v[220:223], v[132:135]
    ds_read_b64_tr_b16 v[238:239], v69 offset:4672
    buffer_load_dwordx4 v[208:211], v2, s[32:35], s16 offen offset:1024 sc1
    v_mfma_f32_16x16x32_bf16 v[136:139], v[244:247], v[216:219], v[136:139]
    ds_read_b64_tr_b16 v[240:241], v69 offset:4192
    v_mfma_f32_16x16x32_bf16 v[140:143], v[244:247], v[220:223], v[140:143]
    ds_read_b64_tr_b16 v[242:243], v69 offset:4704
    s_waitcnt lgkmcnt(8)
    v_mfma_f32_16x16x32_bf16 v[112:115], v[248:251], v[216:219], v[112:115]
    ds_read_b64_tr_b16 v[244:245], v68 offset:20800
    v_mfma_f32_16x16x32_bf16 v[116:119], v[248:251], v[220:223], v[116:119]
    ds_read_b64_tr_b16 v[246:247], v68 offset:21312
    v_mfma_f32_16x16x32_bf16 v[120:123], v[224:227], v[216:219], v[120:123]
    ds_read_b64_tr_b16 v[248:249], v68 offset:20832
    v_mfma_f32_16x16x32_bf16 v[124:127], v[224:227], v[220:223], v[124:127]
    ds_read_b64_tr_b16 v[250:251], v68 offset:21344
    buffer_load_dwordx4 v[212:215], v2, s[32:35], s16 offen offset:2048 sc1
    s_waitcnt lgkmcnt(8)
    v_mfma_f32_16x16x32_bf16 v[80:83], v[228:231], v[216:219], v[80:83]
    ds_read_b64_tr_b16 v[224:225], v69 offset:20800
    v_mfma_f32_16x16x32_bf16 v[84:87], v[228:231], v[220:223], v[84:87]
    ds_read_b64_tr_b16 v[226:227], v69 offset:21312
    v_mfma_f32_16x16x32_bf16 v[88:91], v[232:235], v[216:219], v[88:91]
    ds_read_b64_tr_b16 v[228:229], v69 offset:20832
    v_mfma_f32_16x16x32_bf16 v[92:95], v[232:235], v[220:223], v[92:95]
    ds_read_b64_tr_b16 v[230:231], v69 offset:21344
    s_waitcnt lgkmcnt(8)
    v_mfma_f32_16x16x32_bf16 v[96:99], v[236:239], v[216:219], v[96:99]
    s_barrier
    ds_read_b64_tr_b16 v[232:233], v69 offset:33280
    v_mfma_f32_16x16x32_bf16 v[100:103], v[236:239], v[220:223], v[100:103]
    ds_read_b64_tr_b16 v[234:235], v69 offset:33792
    v_mfma_f32_16x16x32_bf16 v[104:107], v[240:243], v[216:219], v[104:107]
    ds_read_b64_tr_b16 v[236:237], v69 offset:33312
    v_mfma_f32_16x16x32_bf16 v[108:111], v[240:243], v[220:223], v[108:111]
    ds_read_b64_tr_b16 v[238:239], v69 offset:33824
    s_waitcnt lgkmcnt(8)
    v_mfma_f32_16x16x32_bf16 v[144:147], v[244:247], v[216:219], v[144:147]
    ds_read_b64_tr_b16 v[240:241], v68 offset:33280
    v_mfma_f32_16x16x32_bf16 v[148:151], v[244:247], v[220:223], v[148:151]
    ds_read_b64_tr_b16 v[242:243], v68 offset:33792
    v_mfma_f32_16x16x32_bf16 v[152:155], v[248:251], v[216:219], v[152:155]
    ds_read_b64_tr_b16 v[244:245], v68 offset:33312
    v_mfma_f32_16x16x32_bf16 v[156:159], v[248:251], v[220:223], v[156:159]
    ds_read_b64_tr_b16 v[246:247], v68 offset:33824
    s_waitcnt lgkmcnt(8)
    v_mfma_f32_16x16x32_bf16 v[160:163], v[224:227], v[216:219], v[160:163]
    ds_read_b64_tr_b16 v[248:249], v68 offset:24960
    v_mfma_f32_16x16x32_bf16 v[164:167], v[224:227], v[220:223], v[164:167]
    ds_read_b64_tr_b16 v[250:251], v68 offset:25472
    v_mfma_f32_16x16x32_bf16 v[168:171], v[228:231], v[216:219], v[168:171]
    ds_read_b64_tr_b16 v[224:225], v68 offset:24992
    v_mfma_f32_16x16x32_bf16 v[172:175], v[228:231], v[220:223], v[172:175]
    ds_read_b64_tr_b16 v[226:227], v68 offset:25504
    s_waitcnt lgkmcnt(8)
    s_waitcnt vmcnt(9)
    v_mfma_f32_16x16x32_bf16 v[128:131], v[232:235], v[36:39], v[128:131]
    ds_read_b64_tr_b16 v[228:229], v69 offset:24960
    v_mfma_f32_16x16x32_bf16 v[132:135], v[232:235], v[176:179], v[132:135]
    ds_read_b64_tr_b16 v[230:231], v69 offset:25472
    buffer_load_dwordx4 v[216:219], v2, s[32:35], s16 offen offset:3072 sc1
    v_mfma_f32_16x16x32_bf16 v[136:139], v[236:239], v[36:39], v[136:139]
    ds_read_b64_tr_b16 v[232:233], v69 offset:24992
    v_mfma_f32_16x16x32_bf16 v[140:143], v[236:239], v[176:179], v[140:143]
    ds_read_b64_tr_b16 v[234:235], v69 offset:25504
    s_waitcnt lgkmcnt(8)
    v_mfma_f32_16x16x32_bf16 v[112:115], v[240:243], v[36:39], v[112:115]
    ds_read_b64_tr_b16 v[236:237], v68 offset:41600
    v_mfma_f32_16x16x32_bf16 v[116:119], v[240:243], v[176:179], v[116:119]
    ds_read_b64_tr_b16 v[238:239], v68 offset:42112
    v_mfma_f32_16x16x32_bf16 v[120:123], v[244:247], v[36:39], v[120:123]
    ds_read_b64_tr_b16 v[240:241], v68 offset:41632
    v_mfma_f32_16x16x32_bf16 v[124:127], v[244:247], v[176:179], v[124:127]
    ds_read_b64_tr_b16 v[242:243], v68 offset:42144
    s_add_u32 s96, s85, 6
    s_and_b32 s97, s96, 15
    s_lshl_b32 s98, s97, 14
    s_add_u32 s16, s98, s15
    buffer_load_dwordx4 v[220:223], v2, s[32:35], s16 offen sc1
    s_waitcnt lgkmcnt(8)
    v_mfma_f32_16x16x32_bf16 v[80:83], v[248:251], v[36:39], v[80:83]
    ds_read_b64_tr_b16 v[244:245], v69 offset:41600
    v_mfma_f32_16x16x32_bf16 v[84:87], v[248:251], v[176:179], v[84:87]
    ds_read_b64_tr_b16 v[246:247], v69 offset:42112
    v_mfma_f32_16x16x32_bf16 v[88:91], v[224:227], v[36:39], v[88:91]
    ds_read_b64_tr_b16 v[248:249], v69 offset:41632
    v_mfma_f32_16x16x32_bf16 v[92:95], v[224:227], v[176:179], v[92:95]
    ds_read_b64_tr_b16 v[250:251], v69 offset:42144
    s_waitcnt lgkmcnt(8)
    v_mfma_f32_16x16x32_bf16 v[96:99], v[228:231], v[36:39], v[96:99]
    ds_read_b64_tr_b16 v[224:225], v69 offset:37440
    v_mfma_f32_16x16x32_bf16 v[100:103], v[228:231], v[176:179], v[100:103]
    ds_read_b64_tr_b16 v[226:227], v69 offset:37952
    v_mfma_f32_16x16x32_bf16 v[104:107], v[232:235], v[36:39], v[104:107]
    ds_read_b64_tr_b16 v[228:229], v69 offset:37472
    v_mfma_f32_16x16x32_bf16 v[108:111], v[232:235], v[176:179], v[108:111]
    ds_read_b64_tr_b16 v[230:231], v69 offset:37984
    s_waitcnt lgkmcnt(8)
    v_mfma_f32_16x16x32_bf16 v[144:147], v[236:239], v[36:39], v[144:147]
    ds_read_b64_tr_b16 v[232:233], v68 offset:37440
    v_mfma_f32_16x16x32_bf16 v[148:151], v[236:239], v[176:179], v[148:151]
    ds_read_b64_tr_b16 v[234:235], v68 offset:37952
    v_mfma_f32_16x16x32_bf16 v[152:155], v[240:243], v[36:39], v[152:155]
    ds_read_b64_tr_b16 v[236:237], v68 offset:37472
    v_mfma_f32_16x16x32_bf16 v[156:159], v[240:243], v[176:179], v[156:159]
    ds_read_b64_tr_b16 v[238:239], v68 offset:37984
    s_waitcnt lgkmcnt(8)
    v_mfma_f32_16x16x32_bf16 v[160:163], v[244:247], v[36:39], v[160:163]
    ds_read_b64_tr_b16 v[240:241], v68 offset:29120
    v_mfma_f32_16x16x32_bf16 v[164:167], v[244:247], v[176:179], v[164:167]
    ds_read_b64_tr_b16 v[242:243], v68 offset:29632
    v_mfma_f32_16x16x32_bf16 v[168:171], v[248:251], v[36:39], v[168:171]
    ds_read_b64_tr_b16 v[244:245], v68 offset:29152
    v_mfma_f32_16x16x32_bf16 v[172:175], v[248:251], v[176:179], v[172:175]
    ds_read_b64_tr_b16 v[246:247], v68 offset:29664
    s_waitcnt lgkmcnt(8)
    s_waitcnt vmcnt(9)
    v_mfma_f32_16x16x32_bf16 v[128:131], v[224:227], v[180:183], v[128:131]
    ds_read_b64_tr_b16 v[248:249], v69 offset:29120
    v_mfma_f32_16x16x32_bf16 v[132:135], v[224:227], v[184:187], v[132:135]
    ds_read_b64_tr_b16 v[250:251], v69 offset:29632
    buffer_load_dwordx4 v[36:39], v2, s[32:35], s16 offen offset:1024 sc1
    v_mfma_f32_16x16x32_bf16 v[136:139], v[228:231], v[180:183], v[136:139]
    ds_read_b64_tr_b16 v[224:225], v69 offset:29152
    v_mfma_f32_16x16x32_bf16 v[140:143], v[228:231], v[184:187], v[140:143]
    ds_read_b64_tr_b16 v[226:227], v69 offset:29664
    s_waitcnt lgkmcnt(8)
    v_mfma_f32_16x16x32_bf16 v[112:115], v[232:235], v[180:183], v[112:115]
    ds_read_b64_tr_b16 v[228:229], v68 offset:45760
    v_mfma_f32_16x16x32_bf16 v[116:119], v[232:235], v[184:187], v[116:119]
    ds_read_b64_tr_b16 v[230:231], v68 offset:46272
    v_mfma_f32_16x16x32_bf16 v[120:123], v[236:239], v[180:183], v[120:123]
    ds_read_b64_tr_b16 v[232:233], v68 offset:45792
    v_mfma_f32_16x16x32_bf16 v[124:127], v[236:239], v[184:187], v[124:127]
    ds_read_b64_tr_b16 v[234:235], v68 offset:46304
    buffer_load_dwordx4 v[176:179], v2, s[32:35], s16 offen offset:2048 sc1
    s_waitcnt lgkmcnt(8)
    v_mfma_f32_16x16x32_bf16 v[80:83], v[240:243], v[180:183], v[80:83]
    ds_read_b64_tr_b16 v[236:237], v69 offset:45760
    v_mfma_f32_16x16x32_bf16 v[84:87], v[240:243], v[184:187], v[84:87]
    ds_read_b64_tr_b16 v[238:239], v69 offset:46272
    v_mfma_f32_16x16x32_bf16 v[88:91], v[244:247], v[180:183], v[88:91]
    ds_read_b64_tr_b16 v[240:241], v69 offset:45792
    v_mfma_f32_16x16x32_bf16 v[92:95], v[244:247], v[184:187], v[92:95]
    ds_read_b64_tr_b16 v[242:243], v69 offset:46304
    s_waitcnt lgkmcnt(8)
    v_mfma_f32_16x16x32_bf16 v[96:99], v[248:251], v[180:183], v[96:99]
    s_barrier
    ds_read_b64_tr_b16 v[244:245], v71 offset:8320
    v_mfma_f32_16x16x32_bf16 v[100:103], v[248:251], v[184:187], v[100:103]
    ds_read_b64_tr_b16 v[246:247], v71 offset:8832
    v_mfma_f32_16x16x32_bf16 v[104:107], v[224:227], v[180:183], v[104:107]
    ds_read_b64_tr_b16 v[248:249], v71 offset:8352
    v_mfma_f32_16x16x32_bf16 v[108:111], v[224:227], v[184:187], v[108:111]
    ds_read_b64_tr_b16 v[250:251], v71 offset:8864
    s_waitcnt lgkmcnt(8)
    v_mfma_f32_16x16x32_bf16 v[144:147], v[228:231], v[180:183], v[144:147]
    ds_read_b64_tr_b16 v[224:225], v70 offset:8320
    v_mfma_f32_16x16x32_bf16 v[148:151], v[228:231], v[184:187], v[148:151]
    ds_read_b64_tr_b16 v[226:227], v70 offset:8832
    v_mfma_f32_16x16x32_bf16 v[152:155], v[232:235], v[180:183], v[152:155]
    ds_read_b64_tr_b16 v[228:229], v70 offset:8352
    v_mfma_f32_16x16x32_bf16 v[156:159], v[232:235], v[184:187], v[156:159]
    ds_read_b64_tr_b16 v[230:231], v70 offset:8864
    s_waitcnt lgkmcnt(8)
    v_mfma_f32_16x16x32_bf16 v[160:163], v[236:239], v[180:183], v[160:163]
    ds_read_b64_tr_b16 v[232:233], v70
    v_mfma_f32_16x16x32_bf16 v[164:167], v[236:239], v[184:187], v[164:167]
    ds_read_b64_tr_b16 v[234:235], v70 offset:512
    v_mfma_f32_16x16x32_bf16 v[168:171], v[240:243], v[180:183], v[168:171]
    ds_read_b64_tr_b16 v[236:237], v70 offset:32
    v_mfma_f32_16x16x32_bf16 v[172:175], v[240:243], v[184:187], v[172:175]
    ds_read_b64_tr_b16 v[238:239], v70 offset:544
    s_waitcnt lgkmcnt(8)
    s_waitcnt vmcnt(9)
    v_mfma_f32_16x16x32_bf16 v[128:131], v[244:247], v[188:191], v[128:131]
    ds_read_b64_tr_b16 v[240:241], v71
    v_mfma_f32_16x16x32_bf16 v[132:135], v[244:247], v[192:195], v[132:135]
    ds_read_b64_tr_b16 v[242:243], v71 offset:512
    buffer_load_dwordx4 v[180:183], v2, s[32:35], s16 offen offset:3072 sc1
    v_mfma_f32_16x16x32_bf16 v[136:139], v[248:251], v[188:191], v[136:139]
    ds_read_b64_tr_b16 v[244:245], v71 offset:32
    v_mfma_f32_16x16x32_bf16 v[140:143], v[248:251], v[192:195], v[140:143]
    ds_read_b64_tr_b16 v[246:247], v71 offset:544
    s_waitcnt lgkmcnt(8)
    v_mfma_f32_16x16x32_bf16 v[112:115], v[224:227], v[188:191], v[112:115]
    ds_read_b64_tr_b16 v[248:249], v70 offset:16640
    v_mfma_f32_16x16x32_bf16 v[116:119], v[224:227], v[192:195], v[116:119]
    ds_read_b64_tr_b16 v[250:251], v70 offset:17152
    v_mfma_f32_16x16x32_bf16 v[120:123], v[228:231], v[188:191], v[120:123]
    ds_read_b64_tr_b16 v[224:225], v70 offset:16672
    v_mfma_f32_16x16x32_bf16 v[124:127], v[228:231], v[192:195], v[124:127]
    ds_read_b64_tr_b16 v[226:227], v70 offset:17184
    s_add_u32 s96, s85, 7
    s_and_b32 s97, s96, 15
    s_lshl_b32 s98, s97, 14
    s_add_u32 s16, s98, s15
    buffer_load_dwordx4 v[184:187], v2, s[32:35], s16 offen sc1
    s_waitcnt lgkmcnt(8)
    v_mfma_f32_16x16x32_bf16 v[80:83], v[232:235], v[188:191], v[80:83]
    ds_read_b64_tr_b16 v[228:229], v71 offset:16640
    v_mfma_f32_16x16x32_bf16 v[84:87], v[232:235], v[192:195], v[84:87]
    ds_read_b64_tr_b16 v[230:231], v71 offset:17152
    v_mfma_f32_16x16x32_bf16 v[88:91], v[236:239], v[188:191], v[88:91]
    ds_read_b64_tr_b16 v[232:233], v71 offset:16672
    v_mfma_f32_16x16x32_bf16 v[92:95], v[236:239], v[192:195], v[92:95]
    ds_read_b64_tr_b16 v[234:235], v71 offset:17184
    s_waitcnt lgkmcnt(8)
    v_mfma_f32_16x16x32_bf16 v[96:99], v[240:243], v[188:191], v[96:99]
    ds_read_b64_tr_b16 v[236:237], v71 offset:12480
    v_mfma_f32_16x16x32_bf16 v[100:103], v[240:243], v[192:195], v[100:103]
    ds_read_b64_tr_b16 v[238:239], v71 offset:12992
    v_mfma_f32_16x16x32_bf16 v[104:107], v[244:247], v[188:191], v[104:107]
    ds_read_b64_tr_b16 v[240:241], v71 offset:12512
    v_mfma_f32_16x16x32_bf16 v[108:111], v[244:247], v[192:195], v[108:111]
    ds_read_b64_tr_b16 v[242:243], v71 offset:13024
    s_waitcnt lgkmcnt(8)
    v_mfma_f32_16x16x32_bf16 v[144:147], v[248:251], v[188:191], v[144:147]
    ds_read_b64_tr_b16 v[244:245], v70 offset:12480
    v_mfma_f32_16x16x32_bf16 v[148:151], v[248:251], v[192:195], v[148:151]
    ds_read_b64_tr_b16 v[246:247], v70 offset:12992
    v_mfma_f32_16x16x32_bf16 v[152:155], v[224:227], v[188:191], v[152:155]
    ds_read_b64_tr_b16 v[248:249], v70 offset:12512
    v_mfma_f32_16x16x32_bf16 v[156:159], v[224:227], v[192:195], v[156:159]
    ds_read_b64_tr_b16 v[250:251], v70 offset:13024
    s_waitcnt lgkmcnt(8)
    v_mfma_f32_16x16x32_bf16 v[160:163], v[228:231], v[188:191], v[160:163]
    ds_read_b64_tr_b16 v[224:225], v70 offset:4160
    v_mfma_f32_16x16x32_bf16 v[164:167], v[228:231], v[192:195], v[164:167]
    ds_read_b64_tr_b16 v[226:227], v70 offset:4672
    v_mfma_f32_16x16x32_bf16 v[168:171], v[232:235], v[188:191], v[168:171]
    ds_read_b64_tr_b16 v[228:229], v70 offset:4192
    v_mfma_f32_16x16x32_bf16 v[172:175], v[232:235], v[192:195], v[172:175]
    ds_read_b64_tr_b16 v[230:231], v70 offset:4704
    s_waitcnt lgkmcnt(8)
    s_waitcnt vmcnt(9)
    v_mfma_f32_16x16x32_bf16 v[128:131], v[236:239], v[196:199], v[128:131]
    ds_read_b64_tr_b16 v[232:233], v71 offset:4160
    v_mfma_f32_16x16x32_bf16 v[132:135], v[236:239], v[200:203], v[132:135]
    ds_read_b64_tr_b16 v[234:235], v71 offset:4672
    buffer_load_dwordx4 v[188:191], v2, s[32:35], s16 offen offset:1024 sc1
    v_mfma_f32_16x16x32_bf16 v[136:139], v[240:243], v[196:199], v[136:139]
    ds_read_b64_tr_b16 v[236:237], v71 offset:4192
    v_mfma_f32_16x16x32_bf16 v[140:143], v[240:243], v[200:203], v[140:143]
    ds_read_b64_tr_b16 v[238:239], v71 offset:4704
    s_waitcnt lgkmcnt(8)
    v_mfma_f32_16x16x32_bf16 v[112:115], v[244:247], v[196:199], v[112:115]
    ds_read_b64_tr_b16 v[240:241], v70 offset:20800
    v_mfma_f32_16x16x32_bf16 v[116:119], v[244:247], v[200:203], v[116:119]
    ds_read_b64_tr_b16 v[242:243], v70 offset:21312
    v_mfma_f32_16x16x32_bf16 v[120:123], v[248:251], v[196:199], v[120:123]
    ds_read_b64_tr_b16 v[244:245], v70 offset:20832
    v_mfma_f32_16x16x32_bf16 v[124:127], v[248:251], v[200:203], v[124:127]
    ds_read_b64_tr_b16 v[246:247], v70 offset:21344
    buffer_load_dwordx4 v[192:195], v2, s[32:35], s16 offen offset:2048 sc1
    s_waitcnt lgkmcnt(8)
    v_mfma_f32_16x16x32_bf16 v[80:83], v[224:227], v[196:199], v[80:83]
    ds_read_b64_tr_b16 v[248:249], v71 offset:20800
    v_mfma_f32_16x16x32_bf16 v[84:87], v[224:227], v[200:203], v[84:87]
    ds_read_b64_tr_b16 v[250:251], v71 offset:21312
    v_mfma_f32_16x16x32_bf16 v[88:91], v[228:231], v[196:199], v[88:91]
    ds_read_b64_tr_b16 v[224:225], v71 offset:20832
    v_mfma_f32_16x16x32_bf16 v[92:95], v[228:231], v[200:203], v[92:95]
    ds_read_b64_tr_b16 v[226:227], v71 offset:21344
    s_waitcnt lgkmcnt(8)
    v_mfma_f32_16x16x32_bf16 v[96:99], v[232:235], v[196:199], v[96:99]
    s_barrier
    ds_read_b64_tr_b16 v[228:229], v71 offset:33280
    v_mfma_f32_16x16x32_bf16 v[100:103], v[232:235], v[200:203], v[100:103]
    ds_read_b64_tr_b16 v[230:231], v71 offset:33792
    v_mfma_f32_16x16x32_bf16 v[104:107], v[236:239], v[196:199], v[104:107]
    ds_read_b64_tr_b16 v[232:233], v71 offset:33312
    v_mfma_f32_16x16x32_bf16 v[108:111], v[236:239], v[200:203], v[108:111]
    ds_read_b64_tr_b16 v[234:235], v71 offset:33824
    s_waitcnt lgkmcnt(8)
    v_mfma_f32_16x16x32_bf16 v[144:147], v[240:243], v[196:199], v[144:147]
    ds_read_b64_tr_b16 v[236:237], v70 offset:33280
    v_mfma_f32_16x16x32_bf16 v[148:151], v[240:243], v[200:203], v[148:151]
    ds_read_b64_tr_b16 v[238:239], v70 offset:33792
    v_mfma_f32_16x16x32_bf16 v[152:155], v[244:247], v[196:199], v[152:155]
    ds_read_b64_tr_b16 v[240:241], v70 offset:33312
    v_mfma_f32_16x16x32_bf16 v[156:159], v[244:247], v[200:203], v[156:159]
    ds_read_b64_tr_b16 v[242:243], v70 offset:33824
    s_waitcnt lgkmcnt(8)
    v_mfma_f32_16x16x32_bf16 v[160:163], v[248:251], v[196:199], v[160:163]
    ds_read_b64_tr_b16 v[244:245], v70 offset:24960
    v_mfma_f32_16x16x32_bf16 v[164:167], v[248:251], v[200:203], v[164:167]
    ds_read_b64_tr_b16 v[246:247], v70 offset:25472
    v_mfma_f32_16x16x32_bf16 v[168:171], v[224:227], v[196:199], v[168:171]
    ds_read_b64_tr_b16 v[248:249], v70 offset:24992
    v_mfma_f32_16x16x32_bf16 v[172:175], v[224:227], v[200:203], v[172:175]
    ds_read_b64_tr_b16 v[250:251], v70 offset:25504
    s_waitcnt lgkmcnt(8)
    s_waitcnt vmcnt(9)
    v_mfma_f32_16x16x32_bf16 v[128:131], v[228:231], v[204:207], v[128:131]
    ds_read_b64_tr_b16 v[224:225], v71 offset:24960
    v_mfma_f32_16x16x32_bf16 v[132:135], v[228:231], v[208:211], v[132:135]
    ds_read_b64_tr_b16 v[226:227], v71 offset:25472
    buffer_load_dwordx4 v[196:199], v2, s[32:35], s16 offen offset:3072 sc1
    v_mfma_f32_16x16x32_bf16 v[136:139], v[232:235], v[204:207], v[136:139]
    ds_read_b64_tr_b16 v[228:229], v71 offset:24992
    v_mfma_f32_16x16x32_bf16 v[140:143], v[232:235], v[208:211], v[140:143]
    ds_read_b64_tr_b16 v[230:231], v71 offset:25504
    s_waitcnt lgkmcnt(8)
    v_mfma_f32_16x16x32_bf16 v[112:115], v[236:239], v[204:207], v[112:115]
    ds_read_b64_tr_b16 v[232:233], v70 offset:41600
    v_mfma_f32_16x16x32_bf16 v[116:119], v[236:239], v[208:211], v[116:119]
    ds_read_b64_tr_b16 v[234:235], v70 offset:42112
    v_mfma_f32_16x16x32_bf16 v[120:123], v[240:243], v[204:207], v[120:123]
    ds_read_b64_tr_b16 v[236:237], v70 offset:41632
    v_mfma_f32_16x16x32_bf16 v[124:127], v[240:243], v[208:211], v[124:127]
    ds_read_b64_tr_b16 v[238:239], v70 offset:42144
    s_add_u32 s96, s85, 8
    s_and_b32 s97, s96, 15
    s_lshl_b32 s98, s97, 14
    s_add_u32 s16, s98, s15
    buffer_load_dwordx4 v[200:203], v2, s[32:35], s16 offen sc1
    s_waitcnt lgkmcnt(8)
    v_mfma_f32_16x16x32_bf16 v[80:83], v[244:247], v[204:207], v[80:83]
    ds_read_b64_tr_b16 v[240:241], v71 offset:41600
    v_mfma_f32_16x16x32_bf16 v[84:87], v[244:247], v[208:211], v[84:87]
    ds_read_b64_tr_b16 v[242:243], v71 offset:42112
    v_mfma_f32_16x16x32_bf16 v[88:91], v[248:251], v[204:207], v[88:91]
    ds_read_b64_tr_b16 v[244:245], v71 offset:41632
    v_mfma_f32_16x16x32_bf16 v[92:95], v[248:251], v[208:211], v[92:95]
    ds_read_b64_tr_b16 v[246:247], v71 offset:42144
    s_waitcnt lgkmcnt(8)
    v_mfma_f32_16x16x32_bf16 v[96:99], v[224:227], v[204:207], v[96:99]
    ds_read_b64_tr_b16 v[248:249], v71 offset:37440
    v_mfma_f32_16x16x32_bf16 v[100:103], v[224:227], v[208:211], v[100:103]
    ds_read_b64_tr_b16 v[250:251], v71 offset:37952
    v_mfma_f32_16x16x32_bf16 v[104:107], v[228:231], v[204:207], v[104:107]
    ds_read_b64_tr_b16 v[224:225], v71 offset:37472
    v_mfma_f32_16x16x32_bf16 v[108:111], v[228:231], v[208:211], v[108:111]
    ds_read_b64_tr_b16 v[226:227], v71 offset:37984
    s_waitcnt lgkmcnt(8)
    v_mfma_f32_16x16x32_bf16 v[144:147], v[232:235], v[204:207], v[144:147]
    ds_read_b64_tr_b16 v[228:229], v70 offset:37440
    v_mfma_f32_16x16x32_bf16 v[148:151], v[232:235], v[208:211], v[148:151]
    ds_read_b64_tr_b16 v[230:231], v70 offset:37952
    v_mfma_f32_16x16x32_bf16 v[152:155], v[236:239], v[204:207], v[152:155]
    ds_read_b64_tr_b16 v[232:233], v70 offset:37472
    v_mfma_f32_16x16x32_bf16 v[156:159], v[236:239], v[208:211], v[156:159]
    ds_read_b64_tr_b16 v[234:235], v70 offset:37984
    s_waitcnt lgkmcnt(8)
    v_mfma_f32_16x16x32_bf16 v[160:163], v[240:243], v[204:207], v[160:163]
    ds_read_b64_tr_b16 v[236:237], v70 offset:29120
    v_mfma_f32_16x16x32_bf16 v[164:167], v[240:243], v[208:211], v[164:167]
    ds_read_b64_tr_b16 v[238:239], v70 offset:29632
    v_mfma_f32_16x16x32_bf16 v[168:171], v[244:247], v[204:207], v[168:171]
    ds_read_b64_tr_b16 v[240:241], v70 offset:29152
    v_mfma_f32_16x16x32_bf16 v[172:175], v[244:247], v[208:211], v[172:175]
    ds_read_b64_tr_b16 v[242:243], v70 offset:29664
    s_waitcnt lgkmcnt(8)
    s_waitcnt vmcnt(9)
    v_mfma_f32_16x16x32_bf16 v[128:131], v[248:251], v[212:215], v[128:131]
    ds_read_b64_tr_b16 v[244:245], v71 offset:29120
    v_mfma_f32_16x16x32_bf16 v[132:135], v[248:251], v[216:219], v[132:135]
    ds_read_b64_tr_b16 v[246:247], v71 offset:29632
    buffer_load_dwordx4 v[204:207], v2, s[32:35], s16 offen offset:1024 sc1
    v_mfma_f32_16x16x32_bf16 v[136:139], v[224:227], v[212:215], v[136:139]
    ds_read_b64_tr_b16 v[248:249], v71 offset:29152
    v_mfma_f32_16x16x32_bf16 v[140:143], v[224:227], v[216:219], v[140:143]
    ds_read_b64_tr_b16 v[250:251], v71 offset:29664
    s_waitcnt lgkmcnt(8)
    v_mfma_f32_16x16x32_bf16 v[112:115], v[228:231], v[212:215], v[112:115]
    ds_read_b64_tr_b16 v[224:225], v70 offset:45760
    v_mfma_f32_16x16x32_bf16 v[116:119], v[228:231], v[216:219], v[116:119]
    ds_read_b64_tr_b16 v[226:227], v70 offset:46272
    v_mfma_f32_16x16x32_bf16 v[120:123], v[232:235], v[212:215], v[120:123]
    ds_read_b64_tr_b16 v[228:229], v70 offset:45792
    v_mfma_f32_16x16x32_bf16 v[124:127], v[232:235], v[216:219], v[124:127]
    ds_read_b64_tr_b16 v[230:231], v70 offset:46304
    buffer_load_dwordx4 v[208:211], v2, s[32:35], s16 offen offset:2048 sc1
    s_waitcnt lgkmcnt(8)
    v_mfma_f32_16x16x32_bf16 v[80:83], v[236:239], v[212:215], v[80:83]
    ds_read_b64_tr_b16 v[232:233], v71 offset:45760
    v_mfma_f32_16x16x32_bf16 v[84:87], v[236:239], v[216:219], v[84:87]
    ds_read_b64_tr_b16 v[234:235], v71 offset:46272
    v_mfma_f32_16x16x32_bf16 v[88:91], v[240:243], v[212:215], v[88:91]
    ds_read_b64_tr_b16 v[236:237], v71 offset:45792
    v_mfma_f32_16x16x32_bf16 v[92:95], v[240:243], v[216:219], v[92:95]
    ds_read_b64_tr_b16 v[238:239], v71 offset:46304
    s_waitcnt lgkmcnt(8)
    v_mfma_f32_16x16x32_bf16 v[96:99], v[244:247], v[212:215], v[96:99]
    s_barrier
    ds_read_b64_tr_b16 v[240:241], v67 offset:8320
    v_mfma_f32_16x16x32_bf16 v[100:103], v[244:247], v[216:219], v[100:103]
    ds_read_b64_tr_b16 v[242:243], v67 offset:8832
    v_mfma_f32_16x16x32_bf16 v[104:107], v[248:251], v[212:215], v[104:107]
    ds_read_b64_tr_b16 v[244:245], v67 offset:8352
    v_mfma_f32_16x16x32_bf16 v[108:111], v[248:251], v[216:219], v[108:111]
    ds_read_b64_tr_b16 v[246:247], v67 offset:8864
    s_waitcnt lgkmcnt(8)
    v_mfma_f32_16x16x32_bf16 v[144:147], v[224:227], v[212:215], v[144:147]
    ds_read_b64_tr_b16 v[248:249], v66 offset:8320
    v_mfma_f32_16x16x32_bf16 v[148:151], v[224:227], v[216:219], v[148:151]
    ds_read_b64_tr_b16 v[250:251], v66 offset:8832
    v_mfma_f32_16x16x32_bf16 v[152:155], v[228:231], v[212:215], v[152:155]
    ds_read_b64_tr_b16 v[224:225], v66 offset:8352
    v_mfma_f32_16x16x32_bf16 v[156:159], v[228:231], v[216:219], v[156:159]
    ds_read_b64_tr_b16 v[226:227], v66 offset:8864
    s_waitcnt lgkmcnt(8)
    v_mfma_f32_16x16x32_bf16 v[160:163], v[232:235], v[212:215], v[160:163]
    ds_read_b64_tr_b16 v[228:229], v66
    v_mfma_f32_16x16x32_bf16 v[164:167], v[232:235], v[216:219], v[164:167]
    ds_read_b64_tr_b16 v[230:231], v66 offset:512
    v_mfma_f32_16x16x32_bf16 v[168:171], v[236:239], v[212:215], v[168:171]
    ds_read_b64_tr_b16 v[232:233], v66 offset:32
    v_mfma_f32_16x16x32_bf16 v[172:175], v[236:239], v[216:219], v[172:175]
    ds_read_b64_tr_b16 v[234:235], v66 offset:544
    s_waitcnt lgkmcnt(8)
    s_waitcnt vmcnt(9)
    v_mfma_f32_16x16x32_bf16 v[128:131], v[240:243], v[220:223], v[128:131]
    ds_read_b64_tr_b16 v[236:237], v67
    v_mfma_f32_16x16x32_bf16 v[132:135], v[240:243], v[36:39], v[132:135]
    ds_read_b64_tr_b16 v[238:239], v67 offset:512
    buffer_load_dwordx4 v[212:215], v2, s[32:35], s16 offen offset:3072 sc1
    v_mfma_f32_16x16x32_bf16 v[136:139], v[244:247], v[220:223], v[136:139]
    ds_read_b64_tr_b16 v[240:241], v67 offset:32
    v_mfma_f32_16x16x32_bf16 v[140:143], v[244:247], v[36:39], v[140:143]
    ds_read_b64_tr_b16 v[242:243], v67 offset:544
    s_waitcnt lgkmcnt(8)
    v_mfma_f32_16x16x32_bf16 v[112:115], v[248:251], v[220:223], v[112:115]
    ds_read_b64_tr_b16 v[244:245], v66 offset:16640
    v_mfma_f32_16x16x32_bf16 v[116:119], v[248:251], v[36:39], v[116:119]
    ds_read_b64_tr_b16 v[246:247], v66 offset:17152
    v_mfma_f32_16x16x32_bf16 v[120:123], v[224:227], v[220:223], v[120:123]
    ds_read_b64_tr_b16 v[248:249], v66 offset:16672
    v_mfma_f32_16x16x32_bf16 v[124:127], v[224:227], v[36:39], v[124:127]
    ds_read_b64_tr_b16 v[250:251], v66 offset:17184
    s_add_u32 s96, s85, 9
    s_and_b32 s97, s96, 15
    s_lshl_b32 s98, s97, 14
    s_add_u32 s16, s98, s15
    buffer_load_dwordx4 v[216:219], v2, s[32:35], s16 offen sc1
    s_waitcnt lgkmcnt(8)
    v_mfma_f32_16x16x32_bf16 v[80:83], v[228:231], v[220:223], v[80:83]
    ds_read_b64_tr_b16 v[224:225], v67 offset:16640
    v_mfma_f32_16x16x32_bf16 v[84:87], v[228:231], v[36:39], v[84:87]
    ds_read_b64_tr_b16 v[226:227], v67 offset:17152
    v_mfma_f32_16x16x32_bf16 v[88:91], v[232:235], v[220:223], v[88:91]
    ds_read_b64_tr_b16 v[228:229], v67 offset:16672
    v_mfma_f32_16x16x32_bf16 v[92:95], v[232:235], v[36:39], v[92:95]
    ds_read_b64_tr_b16 v[230:231], v67 offset:17184
    s_waitcnt lgkmcnt(8)
    v_mfma_f32_16x16x32_bf16 v[96:99], v[236:239], v[220:223], v[96:99]
    ds_read_b64_tr_b16 v[232:233], v67 offset:12480
    v_mfma_f32_16x16x32_bf16 v[100:103], v[236:239], v[36:39], v[100:103]
    ds_read_b64_tr_b16 v[234:235], v67 offset:12992
    v_mfma_f32_16x16x32_bf16 v[104:107], v[240:243], v[220:223], v[104:107]
    ds_read_b64_tr_b16 v[236:237], v67 offset:12512
    v_mfma_f32_16x16x32_bf16 v[108:111], v[240:243], v[36:39], v[108:111]
    ds_read_b64_tr_b16 v[238:239], v67 offset:13024
    s_waitcnt lgkmcnt(8)
    v_mfma_f32_16x16x32_bf16 v[144:147], v[244:247], v[220:223], v[144:147]
    ds_read_b64_tr_b16 v[240:241], v66 offset:12480
    v_mfma_f32_16x16x32_bf16 v[148:151], v[244:247], v[36:39], v[148:151]
    ds_read_b64_tr_b16 v[242:243], v66 offset:12992
    v_mfma_f32_16x16x32_bf16 v[152:155], v[248:251], v[220:223], v[152:155]
    ds_read_b64_tr_b16 v[244:245], v66 offset:12512
    v_mfma_f32_16x16x32_bf16 v[156:159], v[248:251], v[36:39], v[156:159]
    ds_read_b64_tr_b16 v[246:247], v66 offset:13024
    s_waitcnt lgkmcnt(8)
    v_mfma_f32_16x16x32_bf16 v[160:163], v[224:227], v[220:223], v[160:163]
    ds_read_b64_tr_b16 v[248:249], v66 offset:4160
    v_mfma_f32_16x16x32_bf16 v[164:167], v[224:227], v[36:39], v[164:167]
    ds_read_b64_tr_b16 v[250:251], v66 offset:4672
    v_mfma_f32_16x16x32_bf16 v[168:171], v[228:231], v[220:223], v[168:171]
    ds_read_b64_tr_b16 v[224:225], v66 offset:4192
    v_mfma_f32_16x16x32_bf16 v[172:175], v[228:231], v[36:39], v[172:175]
    ds_read_b64_tr_b16 v[226:227], v66 offset:4704
    s_waitcnt lgkmcnt(8)
    s_waitcnt vmcnt(9)
    v_mfma_f32_16x16x32_bf16 v[128:131], v[232:235], v[176:179], v[128:131]
    ds_read_b64_tr_b16 v[228:229], v67 offset:4160
    v_mfma_f32_16x16x32_bf16 v[132:135], v[232:235], v[180:183], v[132:135]
    ds_read_b64_tr_b16 v[230:231], v67 offset:4672
    buffer_load_dwordx4 v[220:223], v2, s[32:35], s16 offen offset:1024 sc1
    v_mfma_f32_16x16x32_bf16 v[136:139], v[236:239], v[176:179], v[136:139]
    ds_read_b64_tr_b16 v[232:233], v67 offset:4192
    v_mfma_f32_16x16x32_bf16 v[140:143], v[236:239], v[180:183], v[140:143]
    ds_read_b64_tr_b16 v[234:235], v67 offset:4704
    s_waitcnt lgkmcnt(8)
    v_mfma_f32_16x16x32_bf16 v[112:115], v[240:243], v[176:179], v[112:115]
    ds_read_b64_tr_b16 v[236:237], v66 offset:20800
    v_mfma_f32_16x16x32_bf16 v[116:119], v[240:243], v[180:183], v[116:119]
    ds_read_b64_tr_b16 v[238:239], v66 offset:21312
    v_mfma_f32_16x16x32_bf16 v[120:123], v[244:247], v[176:179], v[120:123]
    ds_read_b64_tr_b16 v[240:241], v66 offset:20832
    v_mfma_f32_16x16x32_bf16 v[124:127], v[244:247], v[180:183], v[124:127]
    ds_read_b64_tr_b16 v[242:243], v66 offset:21344
    buffer_load_dwordx4 v[36:39], v2, s[32:35], s16 offen offset:2048 sc1
    s_waitcnt lgkmcnt(8)
    v_mfma_f32_16x16x32_bf16 v[80:83], v[248:251], v[176:179], v[80:83]
    ds_read_b64_tr_b16 v[244:245], v67 offset:20800
    v_mfma_f32_16x16x32_bf16 v[84:87], v[248:251], v[180:183], v[84:87]
    ds_read_b64_tr_b16 v[246:247], v67 offset:21312
    v_mfma_f32_16x16x32_bf16 v[88:91], v[224:227], v[176:179], v[88:91]
    ds_read_b64_tr_b16 v[248:249], v67 offset:20832
    v_mfma_f32_16x16x32_bf16 v[92:95], v[224:227], v[180:183], v[92:95]
    ds_read_b64_tr_b16 v[250:251], v67 offset:21344
    s_waitcnt lgkmcnt(8)
    v_mfma_f32_16x16x32_bf16 v[96:99], v[228:231], v[176:179], v[96:99]
    s_barrier
    ds_read_b64_tr_b16 v[224:225], v67 offset:33280
    v_mfma_f32_16x16x32_bf16 v[100:103], v[228:231], v[180:183], v[100:103]
    ds_read_b64_tr_b16 v[226:227], v67 offset:33792
    v_mfma_f32_16x16x32_bf16 v[104:107], v[232:235], v[176:179], v[104:107]
    ds_read_b64_tr_b16 v[228:229], v67 offset:33312
    v_mfma_f32_16x16x32_bf16 v[108:111], v[232:235], v[180:183], v[108:111]
    ds_read_b64_tr_b16 v[230:231], v67 offset:33824
    s_waitcnt lgkmcnt(8)
    v_mfma_f32_16x16x32_bf16 v[144:147], v[236:239], v[176:179], v[144:147]
    ds_read_b64_tr_b16 v[232:233], v66 offset:33280
    v_mfma_f32_16x16x32_bf16 v[148:151], v[236:239], v[180:183], v[148:151]
    ds_read_b64_tr_b16 v[234:235], v66 offset:33792
    v_mfma_f32_16x16x32_bf16 v[152:155], v[240:243], v[176:179], v[152:155]
    ds_read_b64_tr_b16 v[236:237], v66 offset:33312
    v_mfma_f32_16x16x32_bf16 v[156:159], v[240:243], v[180:183], v[156:159]
    ds_read_b64_tr_b16 v[238:239], v66 offset:33824
    s_waitcnt lgkmcnt(8)
    v_mfma_f32_16x16x32_bf16 v[160:163], v[244:247], v[176:179], v[160:163]
    ds_read_b64_tr_b16 v[240:241], v66 offset:24960
    v_mfma_f32_16x16x32_bf16 v[164:167], v[244:247], v[180:183], v[164:167]
    ds_read_b64_tr_b16 v[242:243], v66 offset:25472
    v_mfma_f32_16x16x32_bf16 v[168:171], v[248:251], v[176:179], v[168:171]
    ds_read_b64_tr_b16 v[244:245], v66 offset:24992
    v_mfma_f32_16x16x32_bf16 v[172:175], v[248:251], v[180:183], v[172:175]
    ds_read_b64_tr_b16 v[246:247], v66 offset:25504
    s_waitcnt lgkmcnt(8)
    s_waitcnt vmcnt(9)
    v_mfma_f32_16x16x32_bf16 v[128:131], v[224:227], v[184:187], v[128:131]
    ds_read_b64_tr_b16 v[248:249], v67 offset:24960
    v_mfma_f32_16x16x32_bf16 v[132:135], v[224:227], v[188:191], v[132:135]
    ds_read_b64_tr_b16 v[250:251], v67 offset:25472
    buffer_load_dwordx4 v[176:179], v2, s[32:35], s16 offen offset:3072 sc1
    v_mfma_f32_16x16x32_bf16 v[136:139], v[228:231], v[184:187], v[136:139]
    ds_read_b64_tr_b16 v[224:225], v67 offset:24992
    v_mfma_f32_16x16x32_bf16 v[140:143], v[228:231], v[188:191], v[140:143]
    ds_read_b64_tr_b16 v[226:227], v67 offset:25504
    s_waitcnt lgkmcnt(8)
    v_mfma_f32_16x16x32_bf16 v[112:115], v[232:235], v[184:187], v[112:115]
    ds_read_b64_tr_b16 v[228:229], v66 offset:41600
    v_mfma_f32_16x16x32_bf16 v[116:119], v[232:235], v[188:191], v[116:119]
    ds_read_b64_tr_b16 v[230:231], v66 offset:42112
    v_mfma_f32_16x16x32_bf16 v[120:123], v[236:239], v[184:187], v[120:123]
    ds_read_b64_tr_b16 v[232:233], v66 offset:41632
    v_mfma_f32_16x16x32_bf16 v[124:127], v[236:239], v[188:191], v[124:127]
    ds_read_b64_tr_b16 v[234:235], v66 offset:42144
    s_add_u32 s96, s85, 10
    s_and_b32 s97, s96, 15
    s_lshl_b32 s98, s97, 14
    s_add_u32 s16, s98, s15
    buffer_load_dwordx4 v[180:183], v2, s[32:35], s16 offen sc1
    s_waitcnt lgkmcnt(8)
    v_mfma_f32_16x16x32_bf16 v[80:83], v[240:243], v[184:187], v[80:83]
    ds_read_b64_tr_b16 v[236:237], v67 offset:41600
    v_mfma_f32_16x16x32_bf16 v[84:87], v[240:243], v[188:191], v[84:87]
    ds_read_b64_tr_b16 v[238:239], v67 offset:42112
    v_mfma_f32_16x16x32_bf16 v[88:91], v[244:247], v[184:187], v[88:91]
    ds_read_b64_tr_b16 v[240:241], v67 offset:41632
    v_mfma_f32_16x16x32_bf16 v[92:95], v[244:247], v[188:191], v[92:95]
    ds_read_b64_tr_b16 v[242:243], v67 offset:42144
    s_waitcnt lgkmcnt(8)
    v_mfma_f32_16x16x32_bf16 v[96:99], v[248:251], v[184:187], v[96:99]
    ds_read_b64_tr_b16 v[244:245], v67 offset:37440
    v_mfma_f32_16x16x32_bf16 v[100:103], v[248:251], v[188:191], v[100:103]
    ds_read_b64_tr_b16 v[246:247], v67 offset:37952
    v_mfma_f32_16x16x32_bf16 v[104:107], v[224:227], v[184:187], v[104:107]
    ds_read_b64_tr_b16 v[248:249], v67 offset:37472
    v_mfma_f32_16x16x32_bf16 v[108:111], v[224:227], v[188:191], v[108:111]
    ds_read_b64_tr_b16 v[250:251], v67 offset:37984
    s_waitcnt lgkmcnt(8)
    v_mfma_f32_16x16x32_bf16 v[144:147], v[228:231], v[184:187], v[144:147]
    ds_read_b64_tr_b16 v[224:225], v66 offset:37440
    v_mfma_f32_16x16x32_bf16 v[148:151], v[228:231], v[188:191], v[148:151]
    ds_read_b64_tr_b16 v[226:227], v66 offset:37952
    v_mfma_f32_16x16x32_bf16 v[152:155], v[232:235], v[184:187], v[152:155]
    ds_read_b64_tr_b16 v[228:229], v66 offset:37472
    v_mfma_f32_16x16x32_bf16 v[156:159], v[232:235], v[188:191], v[156:159]
    ds_read_b64_tr_b16 v[230:231], v66 offset:37984
    s_waitcnt lgkmcnt(8)
    v_mfma_f32_16x16x32_bf16 v[160:163], v[236:239], v[184:187], v[160:163]
    ds_read_b64_tr_b16 v[232:233], v66 offset:29120
    v_mfma_f32_16x16x32_bf16 v[164:167], v[236:239], v[188:191], v[164:167]
    ds_read_b64_tr_b16 v[234:235], v66 offset:29632
    v_mfma_f32_16x16x32_bf16 v[168:171], v[240:243], v[184:187], v[168:171]
    ds_read_b64_tr_b16 v[236:237], v66 offset:29152
    v_mfma_f32_16x16x32_bf16 v[172:175], v[240:243], v[188:191], v[172:175]
    ds_read_b64_tr_b16 v[238:239], v66 offset:29664
    s_waitcnt lgkmcnt(8)
    s_waitcnt vmcnt(9)
    v_mfma_f32_16x16x32_bf16 v[128:131], v[244:247], v[192:195], v[128:131]
    ds_read_b64_tr_b16 v[240:241], v67 offset:29120
    v_mfma_f32_16x16x32_bf16 v[132:135], v[244:247], v[196:199], v[132:135]
    ds_read_b64_tr_b16 v[242:243], v67 offset:29632
    buffer_load_dwordx4 v[184:187], v2, s[32:35], s16 offen offset:1024 sc1
    v_mfma_f32_16x16x32_bf16 v[136:139], v[248:251], v[192:195], v[136:139]
    ds_read_b64_tr_b16 v[244:245], v67 offset:29152
    v_mfma_f32_16x16x32_bf16 v[140:143], v[248:251], v[196:199], v[140:143]
    ds_read_b64_tr_b16 v[246:247], v67 offset:29664
    s_waitcnt lgkmcnt(8)
    v_mfma_f32_16x16x32_bf16 v[112:115], v[224:227], v[192:195], v[112:115]
    ds_read_b64_tr_b16 v[248:249], v66 offset:45760
    v_mfma_f32_16x16x32_bf16 v[116:119], v[224:227], v[196:199], v[116:119]
    ds_read_b64_tr_b16 v[250:251], v66 offset:46272
    v_mfma_f32_16x16x32_bf16 v[120:123], v[228:231], v[192:195], v[120:123]
    ds_read_b64_tr_b16 v[224:225], v66 offset:45792
    v_mfma_f32_16x16x32_bf16 v[124:127], v[228:231], v[196:199], v[124:127]
    ds_read_b64_tr_b16 v[226:227], v66 offset:46304
    buffer_load_dwordx4 v[188:191], v2, s[32:35], s16 offen offset:2048 sc1
    s_waitcnt lgkmcnt(8)
    v_mfma_f32_16x16x32_bf16 v[80:83], v[232:235], v[192:195], v[80:83]
    ds_read_b64_tr_b16 v[228:229], v67 offset:45760
    v_mfma_f32_16x16x32_bf16 v[84:87], v[232:235], v[196:199], v[84:87]
    ds_read_b64_tr_b16 v[230:231], v67 offset:46272
    v_mfma_f32_16x16x32_bf16 v[88:91], v[236:239], v[192:195], v[88:91]
    ds_read_b64_tr_b16 v[232:233], v67 offset:45792
    v_mfma_f32_16x16x32_bf16 v[92:95], v[236:239], v[196:199], v[92:95]
    ds_read_b64_tr_b16 v[234:235], v67 offset:46304
    s_waitcnt lgkmcnt(8)
    v_mfma_f32_16x16x32_bf16 v[96:99], v[240:243], v[192:195], v[96:99]
    s_barrier
    ds_read_b64_tr_b16 v[236:237], v69 offset:8320
    v_mfma_f32_16x16x32_bf16 v[100:103], v[240:243], v[196:199], v[100:103]
    ds_read_b64_tr_b16 v[238:239], v69 offset:8832
    v_mfma_f32_16x16x32_bf16 v[104:107], v[244:247], v[192:195], v[104:107]
    ds_read_b64_tr_b16 v[240:241], v69 offset:8352
    v_mfma_f32_16x16x32_bf16 v[108:111], v[244:247], v[196:199], v[108:111]
    ds_read_b64_tr_b16 v[242:243], v69 offset:8864
    s_waitcnt lgkmcnt(8)
    v_mfma_f32_16x16x32_bf16 v[144:147], v[248:251], v[192:195], v[144:147]
    ds_read_b64_tr_b16 v[244:245], v68 offset:8320
    v_mfma_f32_16x16x32_bf16 v[148:151], v[248:251], v[196:199], v[148:151]
    ds_read_b64_tr_b16 v[246:247], v68 offset:8832
    v_mfma_f32_16x16x32_bf16 v[152:155], v[224:227], v[192:195], v[152:155]
    ds_read_b64_tr_b16 v[248:249], v68 offset:8352
    v_mfma_f32_16x16x32_bf16 v[156:159], v[224:227], v[196:199], v[156:159]
    ds_read_b64_tr_b16 v[250:251], v68 offset:8864
    s_waitcnt lgkmcnt(8)
    v_mfma_f32_16x16x32_bf16 v[160:163], v[228:231], v[192:195], v[160:163]
    ds_read_b64_tr_b16 v[224:225], v68
    v_mfma_f32_16x16x32_bf16 v[164:167], v[228:231], v[196:199], v[164:167]
    ds_read_b64_tr_b16 v[226:227], v68 offset:512
    v_mfma_f32_16x16x32_bf16 v[168:171], v[232:235], v[192:195], v[168:171]
    ds_read_b64_tr_b16 v[228:229], v68 offset:32
    v_mfma_f32_16x16x32_bf16 v[172:175], v[232:235], v[196:199], v[172:175]
    ds_read_b64_tr_b16 v[230:231], v68 offset:544
    s_waitcnt lgkmcnt(8)
    s_waitcnt vmcnt(9)
    v_mfma_f32_16x16x32_bf16 v[128:131], v[236:239], v[200:203], v[128:131]
    ds_read_b64_tr_b16 v[232:233], v69
    v_mfma_f32_16x16x32_bf16 v[132:135], v[236:239], v[204:207], v[132:135]
    ds_read_b64_tr_b16 v[234:235], v69 offset:512
    buffer_load_dwordx4 v[192:195], v2, s[32:35], s16 offen offset:3072 sc1
    v_mfma_f32_16x16x32_bf16 v[136:139], v[240:243], v[200:203], v[136:139]
    ds_read_b64_tr_b16 v[236:237], v69 offset:32
    v_mfma_f32_16x16x32_bf16 v[140:143], v[240:243], v[204:207], v[140:143]
    ds_read_b64_tr_b16 v[238:239], v69 offset:544
    s_waitcnt lgkmcnt(8)
    v_mfma_f32_16x16x32_bf16 v[112:115], v[244:247], v[200:203], v[112:115]
    ds_read_b64_tr_b16 v[240:241], v68 offset:16640
    v_mfma_f32_16x16x32_bf16 v[116:119], v[244:247], v[204:207], v[116:119]
    ds_read_b64_tr_b16 v[242:243], v68 offset:17152
    v_mfma_f32_16x16x32_bf16 v[120:123], v[248:251], v[200:203], v[120:123]
    ds_read_b64_tr_b16 v[244:245], v68 offset:16672
    v_mfma_f32_16x16x32_bf16 v[124:127], v[248:251], v[204:207], v[124:127]
    ds_read_b64_tr_b16 v[246:247], v68 offset:17184
    s_add_u32 s96, s85, 11
    s_and_b32 s97, s96, 15
    s_lshl_b32 s98, s97, 14
    s_add_u32 s16, s98, s15
    buffer_load_dwordx4 v[196:199], v2, s[32:35], s16 offen sc1
    s_waitcnt lgkmcnt(8)
    v_mfma_f32_16x16x32_bf16 v[80:83], v[224:227], v[200:203], v[80:83]
    ds_read_b64_tr_b16 v[248:249], v69 offset:16640
    v_mfma_f32_16x16x32_bf16 v[84:87], v[224:227], v[204:207], v[84:87]
    ds_read_b64_tr_b16 v[250:251], v69 offset:17152
    v_mfma_f32_16x16x32_bf16 v[88:91], v[228:231], v[200:203], v[88:91]
    ds_read_b64_tr_b16 v[224:225], v69 offset:16672
    v_mfma_f32_16x16x32_bf16 v[92:95], v[228:231], v[204:207], v[92:95]
    ds_read_b64_tr_b16 v[226:227], v69 offset:17184
    s_waitcnt lgkmcnt(8)
    v_mfma_f32_16x16x32_bf16 v[96:99], v[232:235], v[200:203], v[96:99]
    ds_read_b64_tr_b16 v[228:229], v69 offset:12480
    v_mfma_f32_16x16x32_bf16 v[100:103], v[232:235], v[204:207], v[100:103]
    ds_read_b64_tr_b16 v[230:231], v69 offset:12992
    v_mfma_f32_16x16x32_bf16 v[104:107], v[236:239], v[200:203], v[104:107]
    ds_read_b64_tr_b16 v[232:233], v69 offset:12512
    v_mfma_f32_16x16x32_bf16 v[108:111], v[236:239], v[204:207], v[108:111]
    ds_read_b64_tr_b16 v[234:235], v69 offset:13024
    s_waitcnt lgkmcnt(8)
    v_mfma_f32_16x16x32_bf16 v[144:147], v[240:243], v[200:203], v[144:147]
    ds_read_b64_tr_b16 v[236:237], v68 offset:12480
    v_mfma_f32_16x16x32_bf16 v[148:151], v[240:243], v[204:207], v[148:151]
    ds_read_b64_tr_b16 v[238:239], v68 offset:12992
    v_mfma_f32_16x16x32_bf16 v[152:155], v[244:247], v[200:203], v[152:155]
    ds_read_b64_tr_b16 v[240:241], v68 offset:12512
    v_mfma_f32_16x16x32_bf16 v[156:159], v[244:247], v[204:207], v[156:159]
    ds_read_b64_tr_b16 v[242:243], v68 offset:13024
    s_waitcnt lgkmcnt(8)
    v_mfma_f32_16x16x32_bf16 v[160:163], v[248:251], v[200:203], v[160:163]
    ds_read_b64_tr_b16 v[244:245], v68 offset:4160
    v_mfma_f32_16x16x32_bf16 v[164:167], v[248:251], v[204:207], v[164:167]
    ds_read_b64_tr_b16 v[246:247], v68 offset:4672
    v_mfma_f32_16x16x32_bf16 v[168:171], v[224:227], v[200:203], v[168:171]
    ds_read_b64_tr_b16 v[248:249], v68 offset:4192
    v_mfma_f32_16x16x32_bf16 v[172:175], v[224:227], v[204:207], v[172:175]
    ds_read_b64_tr_b16 v[250:251], v68 offset:4704
    s_waitcnt lgkmcnt(8)
    s_waitcnt vmcnt(9)
    v_mfma_f32_16x16x32_bf16 v[128:131], v[228:231], v[208:211], v[128:131]
    ds_read_b64_tr_b16 v[224:225], v69 offset:4160
    v_mfma_f32_16x16x32_bf16 v[132:135], v[228:231], v[212:215], v[132:135]
    ds_read_b64_tr_b16 v[226:227], v69 offset:4672
    buffer_load_dwordx4 v[200:203], v2, s[32:35], s16 offen offset:1024 sc1
    v_mfma_f32_16x16x32_bf16 v[136:139], v[232:235], v[208:211], v[136:139]
    ds_read_b64_tr_b16 v[228:229], v69 offset:4192
    v_mfma_f32_16x16x32_bf16 v[140:143], v[232:235], v[212:215], v[140:143]
    ds_read_b64_tr_b16 v[230:231], v69 offset:4704
    s_waitcnt lgkmcnt(8)
    v_mfma_f32_16x16x32_bf16 v[112:115], v[236:239], v[208:211], v[112:115]
    ds_read_b64_tr_b16 v[232:233], v68 offset:20800
    v_mfma_f32_16x16x32_bf16 v[116:119], v[236:239], v[212:215], v[116:119]
    ds_read_b64_tr_b16 v[234:235], v68 offset:21312
    v_mfma_f32_16x16x32_bf16 v[120:123], v[240:243], v[208:211], v[120:123]
    ds_read_b64_tr_b16 v[236:237], v68 offset:20832
    v_mfma_f32_16x16x32_bf16 v[124:127], v[240:243], v[212:215], v[124:127]
    ds_read_b64_tr_b16 v[238:239], v68 offset:21344
    buffer_load_dwordx4 v[204:207], v2, s[32:35], s16 offen offset:2048 sc1
    s_waitcnt lgkmcnt(8)
    v_mfma_f32_16x16x32_bf16 v[80:83], v[244:247], v[208:211], v[80:83]
    ds_read_b64_tr_b16 v[240:241], v69 offset:20800
    v_mfma_f32_16x16x32_bf16 v[84:87], v[244:247], v[212:215], v[84:87]
    ds_read_b64_tr_b16 v[242:243], v69 offset:21312
    v_mfma_f32_16x16x32_bf16 v[88:91], v[248:251], v[208:211], v[88:91]
    ds_read_b64_tr_b16 v[244:245], v69 offset:20832
    v_mfma_f32_16x16x32_bf16 v[92:95], v[248:251], v[212:215], v[92:95]
    ds_read_b64_tr_b16 v[246:247], v69 offset:21344
    s_waitcnt lgkmcnt(8)
    v_mfma_f32_16x16x32_bf16 v[96:99], v[224:227], v[208:211], v[96:99]
    s_barrier
    ds_read_b64_tr_b16 v[248:249], v69 offset:33280
    v_mfma_f32_16x16x32_bf16 v[100:103], v[224:227], v[212:215], v[100:103]
    ds_read_b64_tr_b16 v[250:251], v69 offset:33792
    v_mfma_f32_16x16x32_bf16 v[104:107], v[228:231], v[208:211], v[104:107]
    ds_read_b64_tr_b16 v[224:225], v69 offset:33312
    v_mfma_f32_16x16x32_bf16 v[108:111], v[228:231], v[212:215], v[108:111]
    ds_read_b64_tr_b16 v[226:227], v69 offset:33824
    s_waitcnt lgkmcnt(8)
    v_mfma_f32_16x16x32_bf16 v[144:147], v[232:235], v[208:211], v[144:147]
    ds_read_b64_tr_b16 v[228:229], v68 offset:33280
    v_mfma_f32_16x16x32_bf16 v[148:151], v[232:235], v[212:215], v[148:151]
    ds_read_b64_tr_b16 v[230:231], v68 offset:33792
    v_mfma_f32_16x16x32_bf16 v[152:155], v[236:239], v[208:211], v[152:155]
    ds_read_b64_tr_b16 v[232:233], v68 offset:33312
    v_mfma_f32_16x16x32_bf16 v[156:159], v[236:239], v[212:215], v[156:159]
    ds_read_b64_tr_b16 v[234:235], v68 offset:33824
    s_waitcnt lgkmcnt(8)
    v_mfma_f32_16x16x32_bf16 v[160:163], v[240:243], v[208:211], v[160:163]
    ds_read_b64_tr_b16 v[236:237], v68 offset:24960
    v_mfma_f32_16x16x32_bf16 v[164:167], v[240:243], v[212:215], v[164:167]
    ds_read_b64_tr_b16 v[238:239], v68 offset:25472
    v_mfma_f32_16x16x32_bf16 v[168:171], v[244:247], v[208:211], v[168:171]
    ds_read_b64_tr_b16 v[240:241], v68 offset:24992
    v_mfma_f32_16x16x32_bf16 v[172:175], v[244:247], v[212:215], v[172:175]
    ds_read_b64_tr_b16 v[242:243], v68 offset:25504
    s_waitcnt lgkmcnt(8)
    s_waitcnt vmcnt(9)
    v_mfma_f32_16x16x32_bf16 v[128:131], v[248:251], v[216:219], v[128:131]
    ds_read_b64_tr_b16 v[244:245], v69 offset:24960
    v_mfma_f32_16x16x32_bf16 v[132:135], v[248:251], v[220:223], v[132:135]
    ds_read_b64_tr_b16 v[246:247], v69 offset:25472
    buffer_load_dwordx4 v[208:211], v2, s[32:35], s16 offen offset:3072 sc1
    v_mfma_f32_16x16x32_bf16 v[136:139], v[224:227], v[216:219], v[136:139]
    ds_read_b64_tr_b16 v[248:249], v69 offset:24992
    v_mfma_f32_16x16x32_bf16 v[140:143], v[224:227], v[220:223], v[140:143]
    ds_read_b64_tr_b16 v[250:251], v69 offset:25504
    s_waitcnt lgkmcnt(8)
    v_mfma_f32_16x16x32_bf16 v[112:115], v[228:231], v[216:219], v[112:115]
    ds_read_b64_tr_b16 v[224:225], v68 offset:41600
    v_mfma_f32_16x16x32_bf16 v[116:119], v[228:231], v[220:223], v[116:119]
    ds_read_b64_tr_b16 v[226:227], v68 offset:42112
    v_mfma_f32_16x16x32_bf16 v[120:123], v[232:235], v[216:219], v[120:123]
    ds_read_b64_tr_b16 v[228:229], v68 offset:41632
    v_mfma_f32_16x16x32_bf16 v[124:127], v[232:235], v[220:223], v[124:127]
    ds_read_b64_tr_b16 v[230:231], v68 offset:42144
    s_add_u32 s96, s85, 12
    s_and_b32 s97, s96, 15
    s_lshl_b32 s98, s97, 14
    s_add_u32 s16, s98, s15
    buffer_load_dwordx4 v[212:215], v2, s[32:35], s16 offen sc1
    s_waitcnt lgkmcnt(8)
    v_mfma_f32_16x16x32_bf16 v[80:83], v[236:239], v[216:219], v[80:83]
    ds_read_b64_tr_b16 v[232:233], v69 offset:41600
    v_mfma_f32_16x16x32_bf16 v[84:87], v[236:239], v[220:223], v[84:87]
    ds_read_b64_tr_b16 v[234:235], v69 offset:42112
    v_mfma_f32_16x16x32_bf16 v[88:91], v[240:243], v[216:219], v[88:91]
    ds_read_b64_tr_b16 v[236:237], v69 offset:41632
    v_mfma_f32_16x16x32_bf16 v[92:95], v[240:243], v[220:223], v[92:95]
    ds_read_b64_tr_b16 v[238:239], v69 offset:42144
    s_waitcnt lgkmcnt(8)
    v_mfma_f32_16x16x32_bf16 v[96:99], v[244:247], v[216:219], v[96:99]
    ds_read_b64_tr_b16 v[240:241], v69 offset:37440
    v_mfma_f32_16x16x32_bf16 v[100:103], v[244:247], v[220:223], v[100:103]
    ds_read_b64_tr_b16 v[242:243], v69 offset:37952
    v_mfma_f32_16x16x32_bf16 v[104:107], v[248:251], v[216:219], v[104:107]
    ds_read_b64_tr_b16 v[244:245], v69 offset:37472
    v_mfma_f32_16x16x32_bf16 v[108:111], v[248:251], v[220:223], v[108:111]
    ds_read_b64_tr_b16 v[246:247], v69 offset:37984
    s_waitcnt lgkmcnt(8)
    v_mfma_f32_16x16x32_bf16 v[144:147], v[224:227], v[216:219], v[144:147]
    ds_read_b64_tr_b16 v[248:249], v68 offset:37440
    v_mfma_f32_16x16x32_bf16 v[148:151], v[224:227], v[220:223], v[148:151]
    ds_read_b64_tr_b16 v[250:251], v68 offset:37952
    v_mfma_f32_16x16x32_bf16 v[152:155], v[228:231], v[216:219], v[152:155]
    ds_read_b64_tr_b16 v[224:225], v68 offset:37472
    v_mfma_f32_16x16x32_bf16 v[156:159], v[228:231], v[220:223], v[156:159]
    ds_read_b64_tr_b16 v[226:227], v68 offset:37984
    s_waitcnt lgkmcnt(8)
    v_mfma_f32_16x16x32_bf16 v[160:163], v[232:235], v[216:219], v[160:163]
    ds_read_b64_tr_b16 v[228:229], v68 offset:29120
    v_mfma_f32_16x16x32_bf16 v[164:167], v[232:235], v[220:223], v[164:167]
    ds_read_b64_tr_b16 v[230:231], v68 offset:29632
    v_mfma_f32_16x16x32_bf16 v[168:171], v[236:239], v[216:219], v[168:171]
    ds_read_b64_tr_b16 v[232:233], v68 offset:29152
    v_mfma_f32_16x16x32_bf16 v[172:175], v[236:239], v[220:223], v[172:175]
    ds_read_b64_tr_b16 v[234:235], v68 offset:29664
    s_waitcnt lgkmcnt(8)
    s_waitcnt vmcnt(9)
    v_mfma_f32_16x16x32_bf16 v[128:131], v[240:243], v[36:39], v[128:131]
    ds_read_b64_tr_b16 v[236:237], v69 offset:29120
    v_mfma_f32_16x16x32_bf16 v[132:135], v[240:243], v[176:179], v[132:135]
    ds_read_b64_tr_b16 v[238:239], v69 offset:29632
    buffer_load_dwordx4 v[216:219], v2, s[32:35], s16 offen offset:1024 sc1
    v_mfma_f32_16x16x32_bf16 v[136:139], v[244:247], v[36:39], v[136:139]
    ds_read_b64_tr_b16 v[240:241], v69 offset:29152
    v_mfma_f32_16x16x32_bf16 v[140:143], v[244:247], v[176:179], v[140:143]
    ds_read_b64_tr_b16 v[242:243], v69 offset:29664
    s_waitcnt lgkmcnt(8)
    v_mfma_f32_16x16x32_bf16 v[112:115], v[248:251], v[36:39], v[112:115]
    ds_read_b64_tr_b16 v[244:245], v68 offset:45760
    v_mfma_f32_16x16x32_bf16 v[116:119], v[248:251], v[176:179], v[116:119]
    ds_read_b64_tr_b16 v[246:247], v68 offset:46272
    v_mfma_f32_16x16x32_bf16 v[120:123], v[224:227], v[36:39], v[120:123]
    ds_read_b64_tr_b16 v[248:249], v68 offset:45792
    v_mfma_f32_16x16x32_bf16 v[124:127], v[224:227], v[176:179], v[124:127]
    ds_read_b64_tr_b16 v[250:251], v68 offset:46304
    buffer_load_dwordx4 v[220:223], v2, s[32:35], s16 offen offset:2048 sc1
    s_waitcnt lgkmcnt(8)
    v_mfma_f32_16x16x32_bf16 v[80:83], v[228:231], v[36:39], v[80:83]
    ds_read_b64_tr_b16 v[224:225], v69 offset:45760
    v_mfma_f32_16x16x32_bf16 v[84:87], v[228:231], v[176:179], v[84:87]
    ds_read_b64_tr_b16 v[226:227], v69 offset:46272
    v_mfma_f32_16x16x32_bf16 v[88:91], v[232:235], v[36:39], v[88:91]
    ds_read_b64_tr_b16 v[228:229], v69 offset:45792
    v_mfma_f32_16x16x32_bf16 v[92:95], v[232:235], v[176:179], v[92:95]
    ds_read_b64_tr_b16 v[230:231], v69 offset:46304
    s_waitcnt lgkmcnt(8)
    v_mfma_f32_16x16x32_bf16 v[96:99], v[236:239], v[36:39], v[96:99]
    s_barrier
    ds_read_b64_tr_b16 v[232:233], v71 offset:8320
    v_mfma_f32_16x16x32_bf16 v[100:103], v[236:239], v[176:179], v[100:103]
    ds_read_b64_tr_b16 v[234:235], v71 offset:8832
    v_mfma_f32_16x16x32_bf16 v[104:107], v[240:243], v[36:39], v[104:107]
    ds_read_b64_tr_b16 v[236:237], v71 offset:8352
    v_mfma_f32_16x16x32_bf16 v[108:111], v[240:243], v[176:179], v[108:111]
    ds_read_b64_tr_b16 v[238:239], v71 offset:8864
    s_waitcnt lgkmcnt(8)
    v_mfma_f32_16x16x32_bf16 v[144:147], v[244:247], v[36:39], v[144:147]
    ds_read_b64_tr_b16 v[240:241], v70 offset:8320
    v_mfma_f32_16x16x32_bf16 v[148:151], v[244:247], v[176:179], v[148:151]
    ds_read_b64_tr_b16 v[242:243], v70 offset:8832
    v_mfma_f32_16x16x32_bf16 v[152:155], v[248:251], v[36:39], v[152:155]
    ds_read_b64_tr_b16 v[244:245], v70 offset:8352
    v_mfma_f32_16x16x32_bf16 v[156:159], v[248:251], v[176:179], v[156:159]
    ds_read_b64_tr_b16 v[246:247], v70 offset:8864
    s_waitcnt lgkmcnt(8)
    v_mfma_f32_16x16x32_bf16 v[160:163], v[224:227], v[36:39], v[160:163]
    ds_read_b64_tr_b16 v[248:249], v70
    v_mfma_f32_16x16x32_bf16 v[164:167], v[224:227], v[176:179], v[164:167]
    ds_read_b64_tr_b16 v[250:251], v70 offset:512
    v_mfma_f32_16x16x32_bf16 v[168:171], v[228:231], v[36:39], v[168:171]
    ds_read_b64_tr_b16 v[224:225], v70 offset:32
    v_mfma_f32_16x16x32_bf16 v[172:175], v[228:231], v[176:179], v[172:175]
    ds_read_b64_tr_b16 v[226:227], v70 offset:544
    s_waitcnt lgkmcnt(8)
    s_waitcnt vmcnt(9)
    v_mfma_f32_16x16x32_bf16 v[128:131], v[232:235], v[180:183], v[128:131]
    ds_read_b64_tr_b16 v[228:229], v71
    v_mfma_f32_16x16x32_bf16 v[132:135], v[232:235], v[184:187], v[132:135]
    ds_read_b64_tr_b16 v[230:231], v71 offset:512
    buffer_load_dwordx4 v[36:39], v2, s[32:35], s16 offen offset:3072 sc1
    v_mfma_f32_16x16x32_bf16 v[136:139], v[236:239], v[180:183], v[136:139]
    ds_read_b64_tr_b16 v[232:233], v71 offset:32
    v_mfma_f32_16x16x32_bf16 v[140:143], v[236:239], v[184:187], v[140:143]
    ds_read_b64_tr_b16 v[234:235], v71 offset:544
    s_waitcnt lgkmcnt(8)
    v_mfma_f32_16x16x32_bf16 v[112:115], v[240:243], v[180:183], v[112:115]
    ds_read_b64_tr_b16 v[236:237], v70 offset:16640
    v_mfma_f32_16x16x32_bf16 v[116:119], v[240:243], v[184:187], v[116:119]
    ds_read_b64_tr_b16 v[238:239], v70 offset:17152
    v_mfma_f32_16x16x32_bf16 v[120:123], v[244:247], v[180:183], v[120:123]
    ds_read_b64_tr_b16 v[240:241], v70 offset:16672
    v_mfma_f32_16x16x32_bf16 v[124:127], v[244:247], v[184:187], v[124:127]
    ds_read_b64_tr_b16 v[242:243], v70 offset:17184
    s_add_u32 s96, s85, 13
    s_and_b32 s97, s96, 15
    s_lshl_b32 s98, s97, 14
    s_add_u32 s16, s98, s15
    buffer_load_dwordx4 v[176:179], v2, s[32:35], s16 offen sc1
    s_waitcnt lgkmcnt(8)
    v_mfma_f32_16x16x32_bf16 v[80:83], v[248:251], v[180:183], v[80:83]
    ds_read_b64_tr_b16 v[244:245], v71 offset:16640
    v_mfma_f32_16x16x32_bf16 v[84:87], v[248:251], v[184:187], v[84:87]
    ds_read_b64_tr_b16 v[246:247], v71 offset:17152
    v_mfma_f32_16x16x32_bf16 v[88:91], v[224:227], v[180:183], v[88:91]
    ds_read_b64_tr_b16 v[248:249], v71 offset:16672
    v_mfma_f32_16x16x32_bf16 v[92:95], v[224:227], v[184:187], v[92:95]
    ds_read_b64_tr_b16 v[250:251], v71 offset:17184
    s_waitcnt lgkmcnt(8)
    v_mfma_f32_16x16x32_bf16 v[96:99], v[228:231], v[180:183], v[96:99]
    ds_read_b64_tr_b16 v[224:225], v71 offset:12480
    v_mfma_f32_16x16x32_bf16 v[100:103], v[228:231], v[184:187], v[100:103]
    ds_read_b64_tr_b16 v[226:227], v71 offset:12992
    v_mfma_f32_16x16x32_bf16 v[104:107], v[232:235], v[180:183], v[104:107]
    ds_read_b64_tr_b16 v[228:229], v71 offset:12512
    v_mfma_f32_16x16x32_bf16 v[108:111], v[232:235], v[184:187], v[108:111]
    ds_read_b64_tr_b16 v[230:231], v71 offset:13024
    s_waitcnt lgkmcnt(8)
    v_mfma_f32_16x16x32_bf16 v[144:147], v[236:239], v[180:183], v[144:147]
    ds_read_b64_tr_b16 v[232:233], v70 offset:12480
    v_mfma_f32_16x16x32_bf16 v[148:151], v[236:239], v[184:187], v[148:151]
    ds_read_b64_tr_b16 v[234:235], v70 offset:12992
    v_mfma_f32_16x16x32_bf16 v[152:155], v[240:243], v[180:183], v[152:155]
    ds_read_b64_tr_b16 v[236:237], v70 offset:12512
    v_mfma_f32_16x16x32_bf16 v[156:159], v[240:243], v[184:187], v[156:159]
    ds_read_b64_tr_b16 v[238:239], v70 offset:13024
    s_waitcnt lgkmcnt(8)
    v_mfma_f32_16x16x32_bf16 v[160:163], v[244:247], v[180:183], v[160:163]
    ds_read_b64_tr_b16 v[240:241], v70 offset:4160
    v_mfma_f32_16x16x32_bf16 v[164:167], v[244:247], v[184:187], v[164:167]
    ds_read_b64_tr_b16 v[242:243], v70 offset:4672
    v_mfma_f32_16x16x32_bf16 v[168:171], v[248:251], v[180:183], v[168:171]
    ds_read_b64_tr_b16 v[244:245], v70 offset:4192
    v_mfma_f32_16x16x32_bf16 v[172:175], v[248:251], v[184:187], v[172:175]
    ds_read_b64_tr_b16 v[246:247], v70 offset:4704
    s_waitcnt lgkmcnt(8)
    s_waitcnt vmcnt(9)
    v_mfma_f32_16x16x32_bf16 v[128:131], v[224:227], v[188:191], v[128:131]
    ds_read_b64_tr_b16 v[248:249], v71 offset:4160
    v_mfma_f32_16x16x32_bf16 v[132:135], v[224:227], v[192:195], v[132:135]
    ds_read_b64_tr_b16 v[250:251], v71 offset:4672
    buffer_load_dwordx4 v[180:183], v2, s[32:35], s16 offen offset:1024 sc1
    v_mfma_f32_16x16x32_bf16 v[136:139], v[228:231], v[188:191], v[136:139]
    ds_read_b64_tr_b16 v[224:225], v71 offset:4192
    v_mfma_f32_16x16x32_bf16 v[140:143], v[228:231], v[192:195], v[140:143]
    ds_read_b64_tr_b16 v[226:227], v71 offset:4704
    s_waitcnt lgkmcnt(8)
    v_mfma_f32_16x16x32_bf16 v[112:115], v[232:235], v[188:191], v[112:115]
    ds_read_b64_tr_b16 v[228:229], v70 offset:20800
    v_mfma_f32_16x16x32_bf16 v[116:119], v[232:235], v[192:195], v[116:119]
    ds_read_b64_tr_b16 v[230:231], v70 offset:21312
    v_mfma_f32_16x16x32_bf16 v[120:123], v[236:239], v[188:191], v[120:123]
    ds_read_b64_tr_b16 v[232:233], v70 offset:20832
    v_mfma_f32_16x16x32_bf16 v[124:127], v[236:239], v[192:195], v[124:127]
    ds_read_b64_tr_b16 v[234:235], v70 offset:21344
    buffer_load_dwordx4 v[184:187], v2, s[32:35], s16 offen offset:2048 sc1
    s_waitcnt lgkmcnt(8)
    v_mfma_f32_16x16x32_bf16 v[80:83], v[240:243], v[188:191], v[80:83]
    ds_read_b64_tr_b16 v[236:237], v71 offset:20800
    v_mfma_f32_16x16x32_bf16 v[84:87], v[240:243], v[192:195], v[84:87]
    ds_read_b64_tr_b16 v[238:239], v71 offset:21312
    v_mfma_f32_16x16x32_bf16 v[88:91], v[244:247], v[188:191], v[88:91]
    ds_read_b64_tr_b16 v[240:241], v71 offset:20832
    v_mfma_f32_16x16x32_bf16 v[92:95], v[244:247], v[192:195], v[92:95]
    ds_read_b64_tr_b16 v[242:243], v71 offset:21344
    s_waitcnt lgkmcnt(8)
    v_mfma_f32_16x16x32_bf16 v[96:99], v[248:251], v[188:191], v[96:99]
    s_barrier
    ds_read_b64_tr_b16 v[244:245], v71 offset:33280
    v_mfma_f32_16x16x32_bf16 v[100:103], v[248:251], v[192:195], v[100:103]
    ds_read_b64_tr_b16 v[246:247], v71 offset:33792
    v_mfma_f32_16x16x32_bf16 v[104:107], v[224:227], v[188:191], v[104:107]
    ds_read_b64_tr_b16 v[248:249], v71 offset:33312
    v_mfma_f32_16x16x32_bf16 v[108:111], v[224:227], v[192:195], v[108:111]
    ds_read_b64_tr_b16 v[250:251], v71 offset:33824
    s_waitcnt lgkmcnt(8)
    v_mfma_f32_16x16x32_bf16 v[144:147], v[228:231], v[188:191], v[144:147]
    ds_read_b64_tr_b16 v[224:225], v70 offset:33280
    v_mfma_f32_16x16x32_bf16 v[148:151], v[228:231], v[192:195], v[148:151]
    ds_read_b64_tr_b16 v[226:227], v70 offset:33792
    v_mfma_f32_16x16x32_bf16 v[152:155], v[232:235], v[188:191], v[152:155]
    ds_read_b64_tr_b16 v[228:229], v70 offset:33312
    v_mfma_f32_16x16x32_bf16 v[156:159], v[232:235], v[192:195], v[156:159]
    ds_read_b64_tr_b16 v[230:231], v70 offset:33824
    s_waitcnt lgkmcnt(8)
    v_mfma_f32_16x16x32_bf16 v[160:163], v[236:239], v[188:191], v[160:163]
    ds_read_b64_tr_b16 v[232:233], v70 offset:24960
    v_mfma_f32_16x16x32_bf16 v[164:167], v[236:239], v[192:195], v[164:167]
    ds_read_b64_tr_b16 v[234:235], v70 offset:25472
    v_mfma_f32_16x16x32_bf16 v[168:171], v[240:243], v[188:191], v[168:171]
    ds_read_b64_tr_b16 v[236:237], v70 offset:24992
    v_mfma_f32_16x16x32_bf16 v[172:175], v[240:243], v[192:195], v[172:175]
    ds_read_b64_tr_b16 v[238:239], v70 offset:25504
    s_waitcnt lgkmcnt(8)
    s_waitcnt vmcnt(9)
    v_mfma_f32_16x16x32_bf16 v[128:131], v[244:247], v[196:199], v[128:131]
    ds_read_b64_tr_b16 v[240:241], v71 offset:24960
    v_mfma_f32_16x16x32_bf16 v[132:135], v[244:247], v[200:203], v[132:135]
    ds_read_b64_tr_b16 v[242:243], v71 offset:25472
    buffer_load_dwordx4 v[188:191], v2, s[32:35], s16 offen offset:3072 sc1
    v_mfma_f32_16x16x32_bf16 v[136:139], v[248:251], v[196:199], v[136:139]
    ds_read_b64_tr_b16 v[244:245], v71 offset:24992
    v_mfma_f32_16x16x32_bf16 v[140:143], v[248:251], v[200:203], v[140:143]
    ds_read_b64_tr_b16 v[246:247], v71 offset:25504
    s_waitcnt lgkmcnt(8)
    v_mfma_f32_16x16x32_bf16 v[112:115], v[224:227], v[196:199], v[112:115]
    ds_read_b64_tr_b16 v[248:249], v70 offset:41600
    v_mfma_f32_16x16x32_bf16 v[116:119], v[224:227], v[200:203], v[116:119]
    ds_read_b64_tr_b16 v[250:251], v70 offset:42112
    v_mfma_f32_16x16x32_bf16 v[120:123], v[228:231], v[196:199], v[120:123]
    ds_read_b64_tr_b16 v[224:225], v70 offset:41632
    v_mfma_f32_16x16x32_bf16 v[124:127], v[228:231], v[200:203], v[124:127]
    ds_read_b64_tr_b16 v[226:227], v70 offset:42144
    s_add_u32 s96, s85, 14
    s_and_b32 s97, s96, 15
    s_lshl_b32 s98, s97, 14
    s_add_u32 s16, s98, s15
    buffer_load_dwordx4 v[192:195], v2, s[32:35], s16 offen sc1
    s_waitcnt lgkmcnt(8)
    v_mfma_f32_16x16x32_bf16 v[80:83], v[232:235], v[196:199], v[80:83]
    ds_read_b64_tr_b16 v[228:229], v71 offset:41600
    v_mfma_f32_16x16x32_bf16 v[84:87], v[232:235], v[200:203], v[84:87]
    ds_read_b64_tr_b16 v[230:231], v71 offset:42112
    v_mfma_f32_16x16x32_bf16 v[88:91], v[236:239], v[196:199], v[88:91]
    ds_read_b64_tr_b16 v[232:233], v71 offset:41632
    v_mfma_f32_16x16x32_bf16 v[92:95], v[236:239], v[200:203], v[92:95]
    ds_read_b64_tr_b16 v[234:235], v71 offset:42144
    s_waitcnt lgkmcnt(8)
    v_mfma_f32_16x16x32_bf16 v[96:99], v[240:243], v[196:199], v[96:99]
    ds_read_b64_tr_b16 v[236:237], v71 offset:37440
    v_mfma_f32_16x16x32_bf16 v[100:103], v[240:243], v[200:203], v[100:103]
    ds_read_b64_tr_b16 v[238:239], v71 offset:37952
    v_mfma_f32_16x16x32_bf16 v[104:107], v[244:247], v[196:199], v[104:107]
    ds_read_b64_tr_b16 v[240:241], v71 offset:37472
    v_mfma_f32_16x16x32_bf16 v[108:111], v[244:247], v[200:203], v[108:111]
    ds_read_b64_tr_b16 v[242:243], v71 offset:37984
    s_waitcnt lgkmcnt(8)
    v_mfma_f32_16x16x32_bf16 v[144:147], v[248:251], v[196:199], v[144:147]
    ds_read_b64_tr_b16 v[244:245], v70 offset:37440
    v_mfma_f32_16x16x32_bf16 v[148:151], v[248:251], v[200:203], v[148:151]
    ds_read_b64_tr_b16 v[246:247], v70 offset:37952
    v_mfma_f32_16x16x32_bf16 v[152:155], v[224:227], v[196:199], v[152:155]
    ds_read_b64_tr_b16 v[248:249], v70 offset:37472
    v_mfma_f32_16x16x32_bf16 v[156:159], v[224:227], v[200:203], v[156:159]
    ds_read_b64_tr_b16 v[250:251], v70 offset:37984
    s_waitcnt lgkmcnt(8)
    v_mfma_f32_16x16x32_bf16 v[160:163], v[228:231], v[196:199], v[160:163]
    ds_read_b64_tr_b16 v[224:225], v70 offset:29120
    v_mfma_f32_16x16x32_bf16 v[164:167], v[228:231], v[200:203], v[164:167]
    ds_read_b64_tr_b16 v[226:227], v70 offset:29632
    v_mfma_f32_16x16x32_bf16 v[168:171], v[232:235], v[196:199], v[168:171]
    ds_read_b64_tr_b16 v[228:229], v70 offset:29152
    v_mfma_f32_16x16x32_bf16 v[172:175], v[232:235], v[200:203], v[172:175]
    ds_read_b64_tr_b16 v[230:231], v70 offset:29664
    s_waitcnt lgkmcnt(8)
    s_waitcnt vmcnt(9)
    v_mfma_f32_16x16x32_bf16 v[128:131], v[236:239], v[204:207], v[128:131]
    ds_read_b64_tr_b16 v[232:233], v71 offset:29120
    v_mfma_f32_16x16x32_bf16 v[132:135], v[236:239], v[208:211], v[132:135]
    ds_read_b64_tr_b16 v[234:235], v71 offset:29632
    buffer_load_dwordx4 v[196:199], v2, s[32:35], s16 offen offset:1024 sc1
    v_mfma_f32_16x16x32_bf16 v[136:139], v[240:243], v[204:207], v[136:139]
    ds_read_b64_tr_b16 v[236:237], v71 offset:29152
    v_mfma_f32_16x16x32_bf16 v[140:143], v[240:243], v[208:211], v[140:143]
    ds_read_b64_tr_b16 v[238:239], v71 offset:29664
    s_waitcnt lgkmcnt(8)
    v_mfma_f32_16x16x32_bf16 v[112:115], v[244:247], v[204:207], v[112:115]
    ds_read_b64_tr_b16 v[240:241], v70 offset:45760
    v_mfma_f32_16x16x32_bf16 v[116:119], v[244:247], v[208:211], v[116:119]
    ds_read_b64_tr_b16 v[242:243], v70 offset:46272
    v_mfma_f32_16x16x32_bf16 v[120:123], v[248:251], v[204:207], v[120:123]
    ds_read_b64_tr_b16 v[244:245], v70 offset:45792
    v_mfma_f32_16x16x32_bf16 v[124:127], v[248:251], v[208:211], v[124:127]
    ds_read_b64_tr_b16 v[246:247], v70 offset:46304
    buffer_load_dwordx4 v[200:203], v2, s[32:35], s16 offen offset:2048 sc1
    s_waitcnt lgkmcnt(8)
    v_mfma_f32_16x16x32_bf16 v[80:83], v[224:227], v[204:207], v[80:83]
    ds_read_b64_tr_b16 v[248:249], v71 offset:45760
    v_mfma_f32_16x16x32_bf16 v[84:87], v[224:227], v[208:211], v[84:87]
    ds_read_b64_tr_b16 v[250:251], v71 offset:46272
    v_mfma_f32_16x16x32_bf16 v[88:91], v[228:231], v[204:207], v[88:91]
    ds_read_b64_tr_b16 v[224:225], v71 offset:45792
    v_mfma_f32_16x16x32_bf16 v[92:95], v[228:231], v[208:211], v[92:95]
    ds_read_b64_tr_b16 v[226:227], v71 offset:46304
    s_waitcnt lgkmcnt(8)
    v_mfma_f32_16x16x32_bf16 v[96:99], v[232:235], v[204:207], v[96:99]
    s_barrier
    ds_read_b64_tr_b16 v[228:229], v67 offset:8320
    v_mfma_f32_16x16x32_bf16 v[100:103], v[232:235], v[208:211], v[100:103]
    ds_read_b64_tr_b16 v[230:231], v67 offset:8832
    v_mfma_f32_16x16x32_bf16 v[104:107], v[236:239], v[204:207], v[104:107]
    ds_read_b64_tr_b16 v[232:233], v67 offset:8352
    v_mfma_f32_16x16x32_bf16 v[108:111], v[236:239], v[208:211], v[108:111]
    ds_read_b64_tr_b16 v[234:235], v67 offset:8864
    s_waitcnt lgkmcnt(8)
    v_mfma_f32_16x16x32_bf16 v[144:147], v[240:243], v[204:207], v[144:147]
    ds_read_b64_tr_b16 v[236:237], v66 offset:8320
    v_mfma_f32_16x16x32_bf16 v[148:151], v[240:243], v[208:211], v[148:151]
    ds_read_b64_tr_b16 v[238:239], v66 offset:8832
    v_mfma_f32_16x16x32_bf16 v[152:155], v[244:247], v[204:207], v[152:155]
    ds_read_b64_tr_b16 v[240:241], v66 offset:8352
    v_mfma_f32_16x16x32_bf16 v[156:159], v[244:247], v[208:211], v[156:159]
    ds_read_b64_tr_b16 v[242:243], v66 offset:8864
    s_waitcnt lgkmcnt(8)
    v_mfma_f32_16x16x32_bf16 v[160:163], v[248:251], v[204:207], v[160:163]
    ds_read_b64_tr_b16 v[244:245], v66
    v_mfma_f32_16x16x32_bf16 v[164:167], v[248:251], v[208:211], v[164:167]
    ds_read_b64_tr_b16 v[246:247], v66 offset:512
    v_mfma_f32_16x16x32_bf16 v[168:171], v[224:227], v[204:207], v[168:171]
    ds_read_b64_tr_b16 v[248:249], v66 offset:32
    v_mfma_f32_16x16x32_bf16 v[172:175], v[224:227], v[208:211], v[172:175]
    ds_read_b64_tr_b16 v[250:251], v66 offset:544
    s_waitcnt lgkmcnt(8)
    s_waitcnt vmcnt(9)
    v_mfma_f32_16x16x32_bf16 v[128:131], v[228:231], v[212:215], v[128:131]
    ds_read_b64_tr_b16 v[224:225], v67
    v_mfma_f32_16x16x32_bf16 v[132:135], v[228:231], v[216:219], v[132:135]
    ds_read_b64_tr_b16 v[226:227], v67 offset:512
    buffer_load_dwordx4 v[204:207], v2, s[32:35], s16 offen offset:3072 sc1
    v_mfma_f32_16x16x32_bf16 v[136:139], v[232:235], v[212:215], v[136:139]
    ds_read_b64_tr_b16 v[228:229], v67 offset:32
    v_mfma_f32_16x16x32_bf16 v[140:143], v[232:235], v[216:219], v[140:143]
    ds_read_b64_tr_b16 v[230:231], v67 offset:544
    s_waitcnt lgkmcnt(8)
    v_mfma_f32_16x16x32_bf16 v[112:115], v[236:239], v[212:215], v[112:115]
    ds_read_b64_tr_b16 v[232:233], v66 offset:16640
    v_mfma_f32_16x16x32_bf16 v[116:119], v[236:239], v[216:219], v[116:119]
    ds_read_b64_tr_b16 v[234:235], v66 offset:17152
    v_mfma_f32_16x16x32_bf16 v[120:123], v[240:243], v[212:215], v[120:123]
    ds_read_b64_tr_b16 v[236:237], v66 offset:16672
    v_mfma_f32_16x16x32_bf16 v[124:127], v[240:243], v[216:219], v[124:127]
    ds_read_b64_tr_b16 v[238:239], v66 offset:17184
    s_add_u32 s96, s85, 15
    s_and_b32 s97, s96, 15
    s_lshl_b32 s98, s97, 14
    s_add_u32 s16, s98, s15
    buffer_load_dwordx4 v[208:211], v2, s[32:35], s16 offen sc1
    s_waitcnt lgkmcnt(8)
    v_mfma_f32_16x16x32_bf16 v[80:83], v[244:247], v[212:215], v[80:83]
    ds_read_b64_tr_b16 v[240:241], v67 offset:16640
    v_mfma_f32_16x16x32_bf16 v[84:87], v[244:247], v[216:219], v[84:87]
    ds_read_b64_tr_b16 v[242:243], v67 offset:17152
    v_mfma_f32_16x16x32_bf16 v[88:91], v[248:251], v[212:215], v[88:91]
    ds_read_b64_tr_b16 v[244:245], v67 offset:16672
    v_mfma_f32_16x16x32_bf16 v[92:95], v[248:251], v[216:219], v[92:95]
    ds_read_b64_tr_b16 v[246:247], v67 offset:17184
    s_waitcnt lgkmcnt(8)
    v_mfma_f32_16x16x32_bf16 v[96:99], v[224:227], v[212:215], v[96:99]
    ds_read_b64_tr_b16 v[248:249], v67 offset:12480
    v_mfma_f32_16x16x32_bf16 v[100:103], v[224:227], v[216:219], v[100:103]
    ds_read_b64_tr_b16 v[250:251], v67 offset:12992
    v_mfma_f32_16x16x32_bf16 v[104:107], v[228:231], v[212:215], v[104:107]
    ds_read_b64_tr_b16 v[224:225], v67 offset:12512
    v_mfma_f32_16x16x32_bf16 v[108:111], v[228:231], v[216:219], v[108:111]
    ds_read_b64_tr_b16 v[226:227], v67 offset:13024
    s_waitcnt lgkmcnt(8)
    v_mfma_f32_16x16x32_bf16 v[144:147], v[232:235], v[212:215], v[144:147]
    ds_read_b64_tr_b16 v[228:229], v66 offset:12480
    v_mfma_f32_16x16x32_bf16 v[148:151], v[232:235], v[216:219], v[148:151]
    ds_read_b64_tr_b16 v[230:231], v66 offset:12992
    v_mfma_f32_16x16x32_bf16 v[152:155], v[236:239], v[212:215], v[152:155]
    ds_read_b64_tr_b16 v[232:233], v66 offset:12512
    v_mfma_f32_16x16x32_bf16 v[156:159], v[236:239], v[216:219], v[156:159]
    ds_read_b64_tr_b16 v[234:235], v66 offset:13024
    s_waitcnt lgkmcnt(8)
    v_mfma_f32_16x16x32_bf16 v[160:163], v[240:243], v[212:215], v[160:163]
    ds_read_b64_tr_b16 v[236:237], v66 offset:4160
    v_mfma_f32_16x16x32_bf16 v[164:167], v[240:243], v[216:219], v[164:167]
    ds_read_b64_tr_b16 v[238:239], v66 offset:4672
    v_mfma_f32_16x16x32_bf16 v[168:171], v[244:247], v[212:215], v[168:171]
    ds_read_b64_tr_b16 v[240:241], v66 offset:4192
    v_mfma_f32_16x16x32_bf16 v[172:175], v[244:247], v[216:219], v[172:175]
    ds_read_b64_tr_b16 v[242:243], v66 offset:4704
    s_waitcnt lgkmcnt(8)
    s_waitcnt vmcnt(9)
    v_mfma_f32_16x16x32_bf16 v[128:131], v[248:251], v[220:223], v[128:131]
    ds_read_b64_tr_b16 v[244:245], v67 offset:4160
    v_mfma_f32_16x16x32_bf16 v[132:135], v[248:251], v[36:39], v[132:135]
    ds_read_b64_tr_b16 v[246:247], v67 offset:4672
    buffer_load_dwordx4 v[212:215], v2, s[32:35], s16 offen offset:1024 sc1
    v_mfma_f32_16x16x32_bf16 v[136:139], v[224:227], v[220:223], v[136:139]
    ds_read_b64_tr_b16 v[248:249], v67 offset:4192
    v_mfma_f32_16x16x32_bf16 v[140:143], v[224:227], v[36:39], v[140:143]
    ds_read_b64_tr_b16 v[250:251], v67 offset:4704
    s_waitcnt lgkmcnt(8)
    v_mfma_f32_16x16x32_bf16 v[112:115], v[228:231], v[220:223], v[112:115]
    ds_read_b64_tr_b16 v[224:225], v66 offset:20800
    v_mfma_f32_16x16x32_bf16 v[116:119], v[228:231], v[36:39], v[116:119]
    ds_read_b64_tr_b16 v[226:227], v66 offset:21312
    v_mfma_f32_16x16x32_bf16 v[120:123], v[232:235], v[220:223], v[120:123]
    ds_read_b64_tr_b16 v[228:229], v66 offset:20832
    v_mfma_f32_16x16x32_bf16 v[124:127], v[232:235], v[36:39], v[124:127]
    ds_read_b64_tr_b16 v[230:231], v66 offset:21344
    buffer_load_dwordx4 v[216:219], v2, s[32:35], s16 offen offset:2048 sc1
    s_waitcnt lgkmcnt(8)
    v_mfma_f32_16x16x32_bf16 v[80:83], v[236:239], v[220:223], v[80:83]
    ds_read_b64_tr_b16 v[232:233], v67 offset:20800
    v_mfma_f32_16x16x32_bf16 v[84:87], v[236:239], v[36:39], v[84:87]
    ds_read_b64_tr_b16 v[234:235], v67 offset:21312
    v_mfma_f32_16x16x32_bf16 v[88:91], v[240:243], v[220:223], v[88:91]
    ds_read_b64_tr_b16 v[236:237], v67 offset:20832
    v_mfma_f32_16x16x32_bf16 v[92:95], v[240:243], v[36:39], v[92:95]
    ds_read_b64_tr_b16 v[238:239], v67 offset:21344
    s_waitcnt lgkmcnt(8)
    v_mfma_f32_16x16x32_bf16 v[96:99], v[244:247], v[220:223], v[96:99]
    s_barrier
    ds_read_b64_tr_b16 v[240:241], v67 offset:33280
    v_mfma_f32_16x16x32_bf16 v[100:103], v[244:247], v[36:39], v[100:103]
    ds_read_b64_tr_b16 v[242:243], v67 offset:33792
    v_mfma_f32_16x16x32_bf16 v[104:107], v[248:251], v[220:223], v[104:107]
    ds_read_b64_tr_b16 v[244:245], v67 offset:33312
    v_mfma_f32_16x16x32_bf16 v[108:111], v[248:251], v[36:39], v[108:111]
    ds_read_b64_tr_b16 v[246:247], v67 offset:33824
    s_waitcnt lgkmcnt(8)
    v_mfma_f32_16x16x32_bf16 v[144:147], v[224:227], v[220:223], v[144:147]
    ds_read_b64_tr_b16 v[248:249], v66 offset:33280
    v_mfma_f32_16x16x32_bf16 v[148:151], v[224:227], v[36:39], v[148:151]
    ds_read_b64_tr_b16 v[250:251], v66 offset:33792
    v_mfma_f32_16x16x32_bf16 v[152:155], v[228:231], v[220:223], v[152:155]
    ds_read_b64_tr_b16 v[224:225], v66 offset:33312
    v_mfma_f32_16x16x32_bf16 v[156:159], v[228:231], v[36:39], v[156:159]
    ds_read_b64_tr_b16 v[226:227], v66 offset:33824
    s_waitcnt lgkmcnt(8)
    v_mfma_f32_16x16x32_bf16 v[160:163], v[232:235], v[220:223], v[160:163]
    ds_read_b64_tr_b16 v[228:229], v66 offset:24960
    v_mfma_f32_16x16x32_bf16 v[164:167], v[232:235], v[36:39], v[164:167]
    ds_read_b64_tr_b16 v[230:231], v66 offset:25472
    v_mfma_f32_16x16x32_bf16 v[168:171], v[236:239], v[220:223], v[168:171]
    ds_read_b64_tr_b16 v[232:233], v66 offset:24992
    v_mfma_f32_16x16x32_bf16 v[172:175], v[236:239], v[36:39], v[172:175]
    ds_read_b64_tr_b16 v[234:235], v66 offset:25504
    s_waitcnt lgkmcnt(8)
    s_waitcnt vmcnt(9)
    v_mfma_f32_16x16x32_bf16 v[128:131], v[240:243], v[176:179], v[128:131]
    ds_read_b64_tr_b16 v[236:237], v67 offset:24960
    v_mfma_f32_16x16x32_bf16 v[132:135], v[240:243], v[180:183], v[132:135]
    ds_read_b64_tr_b16 v[238:239], v67 offset:25472
    buffer_load_dwordx4 v[220:223], v2, s[32:35], s16 offen offset:3072 sc1
    s_barrier
    v_mfma_f32_16x16x32_bf16 v[136:139], v[244:247], v[176:179], v[136:139]
    ds_read_b64_tr_b16 v[240:241], v67 offset:24992
    v_mfma_f32_16x16x32_bf16 v[140:143], v[244:247], v[180:183], v[140:143]
    ds_read_b64_tr_b16 v[242:243], v67 offset:25504
    s_waitcnt lgkmcnt(8)
    v_mfma_f32_16x16x32_bf16 v[112:115], v[248:251], v[176:179], v[112:115]
    ds_read_b64_tr_b16 v[244:245], v66 offset:41600
    v_mfma_f32_16x16x32_bf16 v[116:119], v[248:251], v[180:183], v[116:119]
    ds_read_b64_tr_b16 v[246:247], v66 offset:42112
    v_mfma_f32_16x16x32_bf16 v[120:123], v[224:227], v[176:179], v[120:123]
    ds_read_b64_tr_b16 v[248:249], v66 offset:41632
    v_mfma_f32_16x16x32_bf16 v[124:127], v[224:227], v[180:183], v[124:127]
    ds_read_b64_tr_b16 v[250:251], v66 offset:42144
    s_waitcnt lgkmcnt(8)
    v_mfma_f32_16x16x32_bf16 v[80:83], v[228:231], v[176:179], v[80:83]
    ds_read_b64_tr_b16 v[224:225], v67 offset:41600
    v_mfma_f32_16x16x32_bf16 v[84:87], v[228:231], v[180:183], v[84:87]
    ds_read_b64_tr_b16 v[226:227], v67 offset:42112
    v_mfma_f32_16x16x32_bf16 v[88:91], v[232:235], v[176:179], v[88:91]
    ds_read_b64_tr_b16 v[228:229], v67 offset:41632
    v_mfma_f32_16x16x32_bf16 v[92:95], v[232:235], v[180:183], v[92:95]
    ds_read_b64_tr_b16 v[230:231], v67 offset:42144
    s_waitcnt lgkmcnt(8)
    v_mfma_f32_16x16x32_bf16 v[96:99], v[236:239], v[176:179], v[96:99]
    ds_read_b64_tr_b16 v[232:233], v67 offset:37440
    v_mfma_f32_16x16x32_bf16 v[100:103], v[236:239], v[180:183], v[100:103]
    ds_read_b64_tr_b16 v[234:235], v67 offset:37952
    v_mfma_f32_16x16x32_bf16 v[104:107], v[240:243], v[176:179], v[104:107]
    ds_read_b64_tr_b16 v[236:237], v67 offset:37472
    v_mfma_f32_16x16x32_bf16 v[108:111], v[240:243], v[180:183], v[108:111]
    ds_read_b64_tr_b16 v[238:239], v67 offset:37984
    s_waitcnt lgkmcnt(8)
    v_mfma_f32_16x16x32_bf16 v[144:147], v[244:247], v[176:179], v[144:147]
    ds_read_b64_tr_b16 v[240:241], v66 offset:37440
    v_mfma_f32_16x16x32_bf16 v[148:151], v[244:247], v[180:183], v[148:151]
    ds_read_b64_tr_b16 v[242:243], v66 offset:37952
    v_mfma_f32_16x16x32_bf16 v[152:155], v[248:251], v[176:179], v[152:155]
    ds_read_b64_tr_b16 v[244:245], v66 offset:37472
    v_mfma_f32_16x16x32_bf16 v[156:159], v[248:251], v[180:183], v[156:159]
    ds_read_b64_tr_b16 v[246:247], v66 offset:37984
    s_waitcnt lgkmcnt(8)
    v_mfma_f32_16x16x32_bf16 v[160:163], v[224:227], v[176:179], v[160:163]
    ds_read_b64_tr_b16 v[248:249], v66 offset:29120
    v_mfma_f32_16x16x32_bf16 v[164:167], v[224:227], v[180:183], v[164:167]
    ds_read_b64_tr_b16 v[250:251], v66 offset:29632
    v_mfma_f32_16x16x32_bf16 v[168:171], v[228:231], v[176:179], v[168:171]
    ds_read_b64_tr_b16 v[224:225], v66 offset:29152
    v_mfma_f32_16x16x32_bf16 v[172:175], v[228:231], v[180:183], v[172:175]
    ds_read_b64_tr_b16 v[226:227], v66 offset:29664
    s_waitcnt lgkmcnt(8)
    s_waitcnt vmcnt(8)
    v_mfma_f32_16x16x32_bf16 v[128:131], v[232:235], v[184:187], v[128:131]
    ds_read_b64_tr_b16 v[228:229], v67 offset:29120
    v_mfma_f32_16x16x32_bf16 v[132:135], v[232:235], v[188:191], v[132:135]
    ds_read_b64_tr_b16 v[230:231], v67 offset:29632
    v_mfma_f32_16x16x32_bf16 v[136:139], v[236:239], v[184:187], v[136:139]
    ds_read_b64_tr_b16 v[232:233], v67 offset:29152
    v_mfma_f32_16x16x32_bf16 v[140:143], v[236:239], v[188:191], v[140:143]
    ds_read_b64_tr_b16 v[234:235], v67 offset:29664
    s_waitcnt lgkmcnt(8)
    v_mfma_f32_16x16x32_bf16 v[112:115], v[240:243], v[184:187], v[112:115]
    ds_read_b64_tr_b16 v[236:237], v66 offset:45760
    v_mfma_f32_16x16x32_bf16 v[116:119], v[240:243], v[188:191], v[116:119]
    ds_read_b64_tr_b16 v[238:239], v66 offset:46272
    v_mfma_f32_16x16x32_bf16 v[120:123], v[244:247], v[184:187], v[120:123]
    ds_read_b64_tr_b16 v[240:241], v66 offset:45792
    v_mfma_f32_16x16x32_bf16 v[124:127], v[244:247], v[188:191], v[124:127]
    ds_read_b64_tr_b16 v[242:243], v66 offset:46304
    s_waitcnt lgkmcnt(8)
    v_mfma_f32_16x16x32_bf16 v[80:83], v[248:251], v[184:187], v[80:83]
    ds_read_b64_tr_b16 v[244:245], v67 offset:45760
    v_mfma_f32_16x16x32_bf16 v[84:87], v[248:251], v[188:191], v[84:87]
    ds_read_b64_tr_b16 v[246:247], v67 offset:46272
    v_mfma_f32_16x16x32_bf16 v[88:91], v[224:227], v[184:187], v[88:91]
    ds_read_b64_tr_b16 v[248:249], v67 offset:45792
    v_mfma_f32_16x16x32_bf16 v[92:95], v[224:227], v[188:191], v[92:95]
    ds_read_b64_tr_b16 v[250:251], v67 offset:46304
    s_waitcnt lgkmcnt(8)
    v_mfma_f32_16x16x32_bf16 v[96:99], v[228:231], v[184:187], v[96:99]
    s_barrier
    ds_read_b64_tr_b16 v[224:225], v69 offset:8320
    v_mfma_f32_16x16x32_bf16 v[100:103], v[228:231], v[188:191], v[100:103]
    ds_read_b64_tr_b16 v[226:227], v69 offset:8832
    v_mfma_f32_16x16x32_bf16 v[104:107], v[232:235], v[184:187], v[104:107]
    ds_read_b64_tr_b16 v[228:229], v69 offset:8352
    v_mfma_f32_16x16x32_bf16 v[108:111], v[232:235], v[188:191], v[108:111]
    ds_read_b64_tr_b16 v[230:231], v69 offset:8864
    s_waitcnt lgkmcnt(8)
    v_mfma_f32_16x16x32_bf16 v[144:147], v[236:239], v[184:187], v[144:147]
    ds_read_b64_tr_b16 v[232:233], v68 offset:8320
    v_mfma_f32_16x16x32_bf16 v[148:151], v[236:239], v[188:191], v[148:151]
    ds_read_b64_tr_b16 v[234:235], v68 offset:8832
    v_mfma_f32_16x16x32_bf16 v[152:155], v[240:243], v[184:187], v[152:155]
    ds_read_b64_tr_b16 v[236:237], v68 offset:8352
    v_mfma_f32_16x16x32_bf16 v[156:159], v[240:243], v[188:191], v[156:159]
    ds_read_b64_tr_b16 v[238:239], v68 offset:8864
    s_waitcnt lgkmcnt(8)
    v_mfma_f32_16x16x32_bf16 v[160:163], v[244:247], v[184:187], v[160:163]
    ds_read_b64_tr_b16 v[240:241], v68
    v_mfma_f32_16x16x32_bf16 v[164:167], v[244:247], v[188:191], v[164:167]
    ds_read_b64_tr_b16 v[242:243], v68 offset:512
    v_mfma_f32_16x16x32_bf16 v[168:171], v[248:251], v[184:187], v[168:171]
    ds_read_b64_tr_b16 v[244:245], v68 offset:32
    v_mfma_f32_16x16x32_bf16 v[172:175], v[248:251], v[188:191], v[172:175]
    ds_read_b64_tr_b16 v[246:247], v68 offset:544
    s_waitcnt lgkmcnt(8)
    s_waitcnt vmcnt(6)
    v_mfma_f32_16x16x32_bf16 v[128:131], v[224:227], v[192:195], v[128:131]
    ds_read_b64_tr_b16 v[248:249], v69
    v_mfma_f32_16x16x32_bf16 v[132:135], v[224:227], v[196:199], v[132:135]
    ds_read_b64_tr_b16 v[250:251], v69 offset:512
    v_mfma_f32_16x16x32_bf16 v[136:139], v[228:231], v[192:195], v[136:139]
    ds_read_b64_tr_b16 v[224:225], v69 offset:32
    v_mfma_f32_16x16x32_bf16 v[140:143], v[228:231], v[196:199], v[140:143]
    ds_read_b64_tr_b16 v[226:227], v69 offset:544
    s_waitcnt lgkmcnt(8)
    v_mfma_f32_16x16x32_bf16 v[112:115], v[232:235], v[192:195], v[112:115]
    ds_read_b64_tr_b16 v[228:229], v68 offset:16640
    v_mfma_f32_16x16x32_bf16 v[116:119], v[232:235], v[196:199], v[116:119]
    ds_read_b64_tr_b16 v[230:231], v68 offset:17152
    v_mfma_f32_16x16x32_bf16 v[120:123], v[236:239], v[192:195], v[120:123]
    ds_read_b64_tr_b16 v[232:233], v68 offset:16672
    v_mfma_f32_16x16x32_bf16 v[124:127], v[236:239], v[196:199], v[124:127]
    ds_read_b64_tr_b16 v[234:235], v68 offset:17184
    s_waitcnt lgkmcnt(8)
    v_mfma_f32_16x16x32_bf16 v[80:83], v[240:243], v[192:195], v[80:83]
    ds_read_b64_tr_b16 v[236:237], v69 offset:16640
    v_mfma_f32_16x16x32_bf16 v[84:87], v[240:243], v[196:199], v[84:87]
    ds_read_b64_tr_b16 v[238:239], v69 offset:17152
    v_mfma_f32_16x16x32_bf16 v[88:91], v[244:247], v[192:195], v[88:91]
    ds_read_b64_tr_b16 v[240:241], v69 offset:16672
    v_mfma_f32_16x16x32_bf16 v[92:95], v[244:247], v[196:199], v[92:95]
    ds_read_b64_tr_b16 v[242:243], v69 offset:17184
    s_waitcnt lgkmcnt(8)
    v_mfma_f32_16x16x32_bf16 v[96:99], v[248:251], v[192:195], v[96:99]
    ds_read_b64_tr_b16 v[244:245], v69 offset:12480
    v_mfma_f32_16x16x32_bf16 v[100:103], v[248:251], v[196:199], v[100:103]
    ds_read_b64_tr_b16 v[246:247], v69 offset:12992
    v_mfma_f32_16x16x32_bf16 v[104:107], v[224:227], v[192:195], v[104:107]
    ds_read_b64_tr_b16 v[248:249], v69 offset:12512
    v_mfma_f32_16x16x32_bf16 v[108:111], v[224:227], v[196:199], v[108:111]
    ds_read_b64_tr_b16 v[250:251], v69 offset:13024
    s_waitcnt lgkmcnt(8)
    v_mfma_f32_16x16x32_bf16 v[144:147], v[228:231], v[192:195], v[144:147]
    ds_read_b64_tr_b16 v[224:225], v68 offset:12480
    v_mfma_f32_16x16x32_bf16 v[148:151], v[228:231], v[196:199], v[148:151]
    ds_read_b64_tr_b16 v[226:227], v68 offset:12992
    v_mfma_f32_16x16x32_bf16 v[152:155], v[232:235], v[192:195], v[152:155]
    ds_read_b64_tr_b16 v[228:229], v68 offset:12512
    v_mfma_f32_16x16x32_bf16 v[156:159], v[232:235], v[196:199], v[156:159]
    ds_read_b64_tr_b16 v[230:231], v68 offset:13024
    s_waitcnt lgkmcnt(8)
    v_mfma_f32_16x16x32_bf16 v[160:163], v[236:239], v[192:195], v[160:163]
    ds_read_b64_tr_b16 v[232:233], v68 offset:4160
    v_mfma_f32_16x16x32_bf16 v[164:167], v[236:239], v[196:199], v[164:167]
    ds_read_b64_tr_b16 v[234:235], v68 offset:4672
    v_mfma_f32_16x16x32_bf16 v[168:171], v[240:243], v[192:195], v[168:171]
    ds_read_b64_tr_b16 v[236:237], v68 offset:4192
    v_mfma_f32_16x16x32_bf16 v[172:175], v[240:243], v[196:199], v[172:175]
    ds_read_b64_tr_b16 v[238:239], v68 offset:4704
    s_waitcnt lgkmcnt(8)
    s_waitcnt vmcnt(4)
    v_mfma_f32_16x16x32_bf16 v[128:131], v[244:247], v[200:203], v[128:131]
    ds_read_b64_tr_b16 v[240:241], v69 offset:4160
    v_mfma_f32_16x16x32_bf16 v[132:135], v[244:247], v[204:207], v[132:135]
    ds_read_b64_tr_b16 v[242:243], v69 offset:4672
    v_mfma_f32_16x16x32_bf16 v[136:139], v[248:251], v[200:203], v[136:139]
    ds_read_b64_tr_b16 v[244:245], v69 offset:4192
    v_mfma_f32_16x16x32_bf16 v[140:143], v[248:251], v[204:207], v[140:143]
    ds_read_b64_tr_b16 v[246:247], v69 offset:4704
    s_waitcnt lgkmcnt(8)
    v_mfma_f32_16x16x32_bf16 v[112:115], v[224:227], v[200:203], v[112:115]
    ds_read_b64_tr_b16 v[248:249], v68 offset:20800
    v_mfma_f32_16x16x32_bf16 v[116:119], v[224:227], v[204:207], v[116:119]
    ds_read_b64_tr_b16 v[250:251], v68 offset:21312
    v_mfma_f32_16x16x32_bf16 v[120:123], v[228:231], v[200:203], v[120:123]
    ds_read_b64_tr_b16 v[224:225], v68 offset:20832
    v_mfma_f32_16x16x32_bf16 v[124:127], v[228:231], v[204:207], v[124:127]
    ds_read_b64_tr_b16 v[226:227], v68 offset:21344
    s_waitcnt lgkmcnt(8)
    v_mfma_f32_16x16x32_bf16 v[80:83], v[232:235], v[200:203], v[80:83]
    ds_read_b64_tr_b16 v[228:229], v69 offset:20800
    v_mfma_f32_16x16x32_bf16 v[84:87], v[232:235], v[204:207], v[84:87]
    ds_read_b64_tr_b16 v[230:231], v69 offset:21312
    v_mfma_f32_16x16x32_bf16 v[88:91], v[236:239], v[200:203], v[88:91]
    ds_read_b64_tr_b16 v[232:233], v69 offset:20832
    v_mfma_f32_16x16x32_bf16 v[92:95], v[236:239], v[204:207], v[92:95]
    ds_read_b64_tr_b16 v[234:235], v69 offset:21344
    s_waitcnt lgkmcnt(8)
    v_mfma_f32_16x16x32_bf16 v[96:99], v[240:243], v[200:203], v[96:99]
    ds_read_b64_tr_b16 v[236:237], v69 offset:33280
    v_mfma_f32_16x16x32_bf16 v[100:103], v[240:243], v[204:207], v[100:103]
    ds_read_b64_tr_b16 v[238:239], v69 offset:33792
    v_mfma_f32_16x16x32_bf16 v[104:107], v[244:247], v[200:203], v[104:107]
    ds_read_b64_tr_b16 v[240:241], v69 offset:33312
    v_mfma_f32_16x16x32_bf16 v[108:111], v[244:247], v[204:207], v[108:111]
    ds_read_b64_tr_b16 v[242:243], v69 offset:33824
    s_waitcnt lgkmcnt(8)
    v_mfma_f32_16x16x32_bf16 v[144:147], v[248:251], v[200:203], v[144:147]
    ds_read_b64_tr_b16 v[244:245], v68 offset:33280
    v_mfma_f32_16x16x32_bf16 v[148:151], v[248:251], v[204:207], v[148:151]
    ds_read_b64_tr_b16 v[246:247], v68 offset:33792
    v_mfma_f32_16x16x32_bf16 v[152:155], v[224:227], v[200:203], v[152:155]
    ds_read_b64_tr_b16 v[248:249], v68 offset:33312
    v_mfma_f32_16x16x32_bf16 v[156:159], v[224:227], v[204:207], v[156:159]
    ds_read_b64_tr_b16 v[250:251], v68 offset:33824
    s_waitcnt lgkmcnt(8)
    v_mfma_f32_16x16x32_bf16 v[160:163], v[228:231], v[200:203], v[160:163]
    ds_read_b64_tr_b16 v[224:225], v68 offset:24960
    v_mfma_f32_16x16x32_bf16 v[164:167], v[228:231], v[204:207], v[164:167]
    ds_read_b64_tr_b16 v[226:227], v68 offset:25472
    v_mfma_f32_16x16x32_bf16 v[168:171], v[232:235], v[200:203], v[168:171]
    ds_read_b64_tr_b16 v[228:229], v68 offset:24992
    v_mfma_f32_16x16x32_bf16 v[172:175], v[232:235], v[204:207], v[172:175]
    ds_read_b64_tr_b16 v[230:231], v68 offset:25504
    s_waitcnt lgkmcnt(8)
    s_waitcnt vmcnt(2)
    v_mfma_f32_16x16x32_bf16 v[128:131], v[236:239], v[208:211], v[128:131]
    ds_read_b64_tr_b16 v[232:233], v69 offset:24960
    v_mfma_f32_16x16x32_bf16 v[132:135], v[236:239], v[212:215], v[132:135]
    ds_read_b64_tr_b16 v[234:235], v69 offset:25472
    v_mfma_f32_16x16x32_bf16 v[136:139], v[240:243], v[208:211], v[136:139]
    ds_read_b64_tr_b16 v[236:237], v69 offset:24992
    v_mfma_f32_16x16x32_bf16 v[140:143], v[240:243], v[212:215], v[140:143]
    ds_read_b64_tr_b16 v[238:239], v69 offset:25504
    s_waitcnt lgkmcnt(8)
    v_mfma_f32_16x16x32_bf16 v[112:115], v[244:247], v[208:211], v[112:115]
    ds_read_b64_tr_b16 v[240:241], v68 offset:41600
    v_mfma_f32_16x16x32_bf16 v[116:119], v[244:247], v[212:215], v[116:119]
    ds_read_b64_tr_b16 v[242:243], v68 offset:42112
    v_mfma_f32_16x16x32_bf16 v[120:123], v[248:251], v[208:211], v[120:123]
    ds_read_b64_tr_b16 v[244:245], v68 offset:41632
    v_mfma_f32_16x16x32_bf16 v[124:127], v[248:251], v[212:215], v[124:127]
    ds_read_b64_tr_b16 v[246:247], v68 offset:42144
    s_waitcnt lgkmcnt(8)
    v_mfma_f32_16x16x32_bf16 v[80:83], v[224:227], v[208:211], v[80:83]
    ds_read_b64_tr_b16 v[248:249], v69 offset:41600
    v_mfma_f32_16x16x32_bf16 v[84:87], v[224:227], v[212:215], v[84:87]
    ds_read_b64_tr_b16 v[250:251], v69 offset:42112
    v_mfma_f32_16x16x32_bf16 v[88:91], v[228:231], v[208:211], v[88:91]
    ds_read_b64_tr_b16 v[224:225], v69 offset:41632
    v_mfma_f32_16x16x32_bf16 v[92:95], v[228:231], v[212:215], v[92:95]
    ds_read_b64_tr_b16 v[226:227], v69 offset:42144
    s_waitcnt lgkmcnt(8)
    v_mfma_f32_16x16x32_bf16 v[96:99], v[232:235], v[208:211], v[96:99]
    ds_read_b64_tr_b16 v[228:229], v69 offset:37440
    v_mfma_f32_16x16x32_bf16 v[100:103], v[232:235], v[212:215], v[100:103]
    ds_read_b64_tr_b16 v[230:231], v69 offset:37952
    v_mfma_f32_16x16x32_bf16 v[104:107], v[236:239], v[208:211], v[104:107]
    ds_read_b64_tr_b16 v[232:233], v69 offset:37472
    v_mfma_f32_16x16x32_bf16 v[108:111], v[236:239], v[212:215], v[108:111]
    ds_read_b64_tr_b16 v[234:235], v69 offset:37984
    s_waitcnt lgkmcnt(8)
    v_mfma_f32_16x16x32_bf16 v[144:147], v[240:243], v[208:211], v[144:147]
    ds_read_b64_tr_b16 v[236:237], v68 offset:37440
    v_mfma_f32_16x16x32_bf16 v[148:151], v[240:243], v[212:215], v[148:151]
    ds_read_b64_tr_b16 v[238:239], v68 offset:37952
    v_mfma_f32_16x16x32_bf16 v[152:155], v[244:247], v[208:211], v[152:155]
    ds_read_b64_tr_b16 v[240:241], v68 offset:37472
    v_mfma_f32_16x16x32_bf16 v[156:159], v[244:247], v[212:215], v[156:159]
    ds_read_b64_tr_b16 v[242:243], v68 offset:37984
    s_waitcnt lgkmcnt(8)
    v_mfma_f32_16x16x32_bf16 v[160:163], v[248:251], v[208:211], v[160:163]
    ds_read_b64_tr_b16 v[244:245], v68 offset:29120
    v_mfma_f32_16x16x32_bf16 v[164:167], v[248:251], v[212:215], v[164:167]
    ds_read_b64_tr_b16 v[246:247], v68 offset:29632
    v_mfma_f32_16x16x32_bf16 v[168:171], v[224:227], v[208:211], v[168:171]
    ds_read_b64_tr_b16 v[248:249], v68 offset:29152
    v_mfma_f32_16x16x32_bf16 v[172:175], v[224:227], v[212:215], v[172:175]
    ds_read_b64_tr_b16 v[250:251], v68 offset:29664
    s_waitcnt lgkmcnt(8)
    s_waitcnt vmcnt(0)
    v_mfma_f32_16x16x32_bf16 v[128:131], v[228:231], v[216:219], v[128:131]
    ds_read_b64_tr_b16 v[224:225], v69 offset:29120
    v_mfma_f32_16x16x32_bf16 v[132:135], v[228:231], v[220:223], v[132:135]
    ds_read_b64_tr_b16 v[226:227], v69 offset:29632
    v_mfma_f32_16x16x32_bf16 v[136:139], v[232:235], v[216:219], v[136:139]
    ds_read_b64_tr_b16 v[228:229], v69 offset:29152
    v_mfma_f32_16x16x32_bf16 v[140:143], v[232:235], v[220:223], v[140:143]
    ds_read_b64_tr_b16 v[230:231], v69 offset:29664
    s_waitcnt lgkmcnt(8)
    v_mfma_f32_16x16x32_bf16 v[112:115], v[236:239], v[216:219], v[112:115]
    ds_read_b64_tr_b16 v[232:233], v68 offset:45760
    v_mfma_f32_16x16x32_bf16 v[116:119], v[236:239], v[220:223], v[116:119]
    ds_read_b64_tr_b16 v[234:235], v68 offset:46272
    v_mfma_f32_16x16x32_bf16 v[120:123], v[240:243], v[216:219], v[120:123]
    ds_read_b64_tr_b16 v[236:237], v68 offset:45792
    v_mfma_f32_16x16x32_bf16 v[124:127], v[240:243], v[220:223], v[124:127]
    ds_read_b64_tr_b16 v[238:239], v68 offset:46304
    s_waitcnt lgkmcnt(8)
    v_mfma_f32_16x16x32_bf16 v[80:83], v[244:247], v[216:219], v[80:83]
    ds_read_b64_tr_b16 v[240:241], v69 offset:45760
    v_mfma_f32_16x16x32_bf16 v[84:87], v[244:247], v[220:223], v[84:87]
    ds_read_b64_tr_b16 v[242:243], v69 offset:46272
    v_mfma_f32_16x16x32_bf16 v[88:91], v[248:251], v[216:219], v[88:91]
    ds_read_b64_tr_b16 v[244:245], v69 offset:45792
    v_mfma_f32_16x16x32_bf16 v[92:95], v[248:251], v[220:223], v[92:95]
    ds_read_b64_tr_b16 v[246:247], v69 offset:46304
    s_waitcnt lgkmcnt(8)
    v_mfma_f32_16x16x32_bf16 v[96:99], v[224:227], v[216:219], v[96:99]
    v_mfma_f32_16x16x32_bf16 v[100:103], v[224:227], v[220:223], v[100:103]
    v_mfma_f32_16x16x32_bf16 v[104:107], v[228:231], v[216:219], v[104:107]
    v_mfma_f32_16x16x32_bf16 v[108:111], v[228:231], v[220:223], v[108:111]
    s_waitcnt lgkmcnt(4)
    v_mfma_f32_16x16x32_bf16 v[144:147], v[232:235], v[216:219], v[144:147]
    v_mfma_f32_16x16x32_bf16 v[148:151], v[232:235], v[220:223], v[148:151]
    v_mfma_f32_16x16x32_bf16 v[152:155], v[236:239], v[216:219], v[152:155]
    v_mfma_f32_16x16x32_bf16 v[156:159], v[236:239], v[220:223], v[156:159]
    s_waitcnt lgkmcnt(0)
    v_mfma_f32_16x16x32_bf16 v[160:163], v[240:243], v[216:219], v[160:163]
    v_mfma_f32_16x16x32_bf16 v[164:167], v[240:243], v[220:223], v[164:167]
    v_mfma_f32_16x16x32_bf16 v[168:171], v[244:247], v[216:219], v[168:171]
    v_mfma_f32_16x16x32_bf16 v[172:175], v[244:247], v[220:223], v[172:175]
    v_cvt_pk_bf16_f32 v52, v128, v129
    v_cvt_pk_bf16_f32 v53, v130, v131
    v_cvt_pk_bf16_f32 v54, v132, v133
    v_cvt_pk_bf16_f32 v55, v134, v135
    v_cvt_pk_bf16_f32 v56, v136, v137
    v_cvt_pk_bf16_f32 v57, v138, v139
    v_cvt_pk_bf16_f32 v58, v140, v141
    v_cvt_pk_bf16_f32 v59, v142, v143
    ds_write_b64 v77, v[52:53]
    ds_write_b64 v77, v[54:55] offset:256
    ds_write_b64 v77, v[56:57] offset:1024
    ds_write_b64 v77, v[58:59] offset:1280
    v_cvt_pk_bf16_f32 v36, v112, v113
    v_cvt_pk_bf16_f32 v37, v114, v115
    v_cvt_pk_bf16_f32 v38, v116, v117
    v_cvt_pk_bf16_f32 v39, v118, v119
    v_cvt_pk_bf16_f32 v40, v120, v121
    v_cvt_pk_bf16_f32 v41, v122, v123
    v_cvt_pk_bf16_f32 v42, v124, v125
    v_cvt_pk_bf16_f32 v43, v126, v127
    v_permlane16_swap_b32 v36, v38
    v_permlane16_swap_b32 v37, v39
    v_permlane16_swap_b32 v40, v42
    v_permlane16_swap_b32 v41, v43
    s_waitcnt lgkmcnt(0)
    s_barrier
    s_setprio 0
    v_mfma_f32_32x32x16_bf16 v[112:127], v[28:31], v[36:39], 0
    v_mfma_f32_32x32x16_bf16 v[112:127], v[32:35], v[40:43], v[112:127]
    v_cvt_pk_bf16_f32 v52, v144, v145
    v_cvt_pk_bf16_f32 v53, v146, v147
    v_cvt_pk_bf16_f32 v54, v148, v149
    v_cvt_pk_bf16_f32 v55, v150, v151
    v_cvt_pk_bf16_f32 v56, v152, v153
    v_cvt_pk_bf16_f32 v57, v154, v155
    v_cvt_pk_bf16_f32 v58, v156, v157
    v_cvt_pk_bf16_f32 v59, v158, v159
    ds_write_b64 v78, v[52:53]
    ds_write_b64 v78, v[54:55] offset:512
    ds_write_b64 v78, v[56:57] offset:4096
    ds_write_b64 v78, v[58:59] offset:4608
    v_cvt_pk_bf16_f32 v44, v160, v161
    v_cvt_pk_bf16_f32 v45, v162, v163
    v_cvt_pk_bf16_f32 v46, v164, v165
    v_cvt_pk_bf16_f32 v47, v166, v167
    v_cvt_pk_bf16_f32 v48, v168, v169
    v_cvt_pk_bf16_f32 v49, v170, v171
    v_cvt_pk_bf16_f32 v50, v172, v173
    v_cvt_pk_bf16_f32 v51, v174, v175
    ds_write_b64 v78, v[44:45] offset:8192
    ds_write_b64 v78, v[46:47] offset:8704
    ds_write_b64 v78, v[48:49] offset:12288
    ds_write_b64 v78, v[50:51] offset:12800
    v_cvt_pk_bf16_f32 v36, v96, v97
    v_cvt_pk_bf16_f32 v37, v98, v99
    v_cvt_pk_bf16_f32 v38, v100, v101
    v_cvt_pk_bf16_f32 v39, v102, v103
    v_cvt_pk_bf16_f32 v40, v104, v105
    v_cvt_pk_bf16_f32 v41, v106, v107
    v_cvt_pk_bf16_f32 v42, v108, v109
    v_cvt_pk_bf16_f32 v43, v110, v111
    ds_write_b64 v77, v[36:37] offset:2048
    ds_write_b64 v77, v[38:39] offset:2304
    ds_write_b64 v77, v[40:41] offset:3072
    ds_write_b64 v77, v[42:43] offset:3328
    v_cvt_pk_bf16_f32 v44, v80, v81
    v_cvt_pk_bf16_f32 v45, v82, v83
    v_cvt_pk_bf16_f32 v46, v84, v85
    v_cvt_pk_bf16_f32 v47, v86, v87
    v_cvt_pk_bf16_f32 v48, v88, v89
    v_cvt_pk_bf16_f32 v49, v90, v91
    v_cvt_pk_bf16_f32 v50, v92, v93
    v_cvt_pk_bf16_f32 v51, v94, v95
    v_permlane16_swap_b32 v44, v46
    v_permlane16_swap_b32 v45, v47
    v_permlane16_swap_b32 v48, v50
    v_permlane16_swap_b32 v49, v51
    s_branch L_JOIN
L_HELP:
    s_add_u32 s96, s85, 5
    s_and_b32 s97, s96, 15
    s_lshl3_add_u32 s98, s97, s3
    s_sub_u32 s99, s98, 4
    s_mul_i32 s96, s99, 49152
    s_lshl_b32 s97, s11, 7
    s_add_u32 s82, s96, s97
    s_sub_u32 s96, s3, 4
    s_lshr_b32 s97, s96, 1
    s_mul_i32 s98, s97, 2080
    s_sub_u32 s99, s3, 4
    s_and_b32 s96, s99, 1
    s_mul_i32 s97, s96, 1056
    s_add_u32 s99, s98, s97
    s_add_u32 s20, s99, 124800
    s_mov_b32 m0, s20
    s_nop 0
    buffer_load_dwordx4 v62, s[40:43], s82 offen lds
    s_add_u32 s82, s82, 2048
    s_add_u32 m0, s20, 8320
    s_nop 0
    buffer_load_dwordx4 v62, s[40:43], s82 offen lds
    s_add_u32 s82, s82, 2048
    s_add_u32 m0, s20, 16640
    s_nop 0
    buffer_load_dwordx4 v62, s[40:43], s82 offen lds
    s_add_u32 s96, s85, 5
    s_and_b32 s97, s96, 15
    s_lshl3_add_u32 s98, s97, s3
    s_mul_i32 s99, s98, 49152
    s_lshl_b32 s96, s11, 7
    s_add_u32 s82, s99, s96
    s_lshr_b32 s96, s3, 1
    s_mul_i32 s97, s96, 2080
    s_and_b32 s98, s3, 1
    s_mul_i32 s99, s98, 1056
    s_add_u32 s96, s97, s99
    s_add_u32 s20, s96, 124800
    s_mov_b32 m0, s20
    s_nop 0
    buffer_load_dwordx4 v62, s[40:43], s82 offen lds
    s_add_u32 s82, s82, 2048
    s_add_u32 m0, s20, 8320
    s_nop 0
    buffer_load_dwordx4 v62, s[40:43], s82 offen lds
    s_add_u32 s82, s82, 2048
    s_add_u32 m0, s20, 16640
    s_nop 0
    buffer_load_dwordx4 v62, s[40:43], s82 offen lds
    s_and_b32 s96, s9, 3
    s_lshl2_add_u32 s97, s96, s3
    s_sub_u32 s98, s97, 4
    s_lshl_b32 s13, s98, 7
    v_lshrrev_b32 v61, 3, v1
    v_lshl_add_u32 v61, v61, 4, s13
    v_lshrrev_b32 v60, 3, v1
    v_mul_u32_u24 v60, 98304, v60
    v_and_b32 v9, 7, v1
    v_lshl_add_u32 v60, v9, 4, v60
    s_mul_i32 s96, s13, 6144
    s_bfe_u32 s97, s9, 131074
    s_lshl_b32 s98, s8, 1
    s_lshl4_add_u32 s99, s97, s98
    s_lshr_b32 s97, s9, 4
    s_add_u32 s98, s99, s97
    s_lshl_b32 s99, s98, 7
    s_add_u32 s97, s96, s99
    s_add_u32 s17, s97, 4096
    global_load_dwordx4 v[120:123], v61, s[86:87]
    s_waitcnt vmcnt(13)
    s_barrier
    buffer_load_dwordx4 v[80:83], v60, s[48:51], s17 offen nt
    s_add_u32 s17, s17, 12288
    buffer_load_dwordx4 v[84:87], v60, s[48:51], s17 offen nt
    s_add_u32 s17, s17, 12288
    s_waitcnt lgkmcnt(0)
    s_load_dword s24, s[32:33], s92 offset:512 glc
    s_load_dword s25, s[32:33], s92 offset:256 glc
    s_load_dword s26, s[32:33], s92 offset:1024 glc
    s_load_dword s27, s[32:33], s92 offset:768 glc
    s_waitcnt vmcnt(12)
    s_barrier
    s_add_u32 s96, s85, 6
    s_and_b32 s97, s96, 15
    s_lshl3_add_u32 s98, s97, s3
    s_sub_u32 s99, s98, 4
    s_mul_i32 s96, s99, 49152
    s_lshl_b32 s97, s11, 7
    s_add_u32 s82, s96, s97
    s_sub_u32 s96, s3, 4
    s_lshr_b32 s97, s96, 1
    s_mul_i32 s98, s97, 2080
    s_sub_u32 s99, s3, 4
    s_and_b32 s96, s99, 1
    s_mul_i32 s97, s96, 1056
    s_add_u32 s20, s98, s97
    s_mov_b32 m0, s20
    s_nop 0
    buffer_load_dwordx4 v62, s[40:43], s82 offen lds
    s_add_u32 s82, s82, 2048
    s_add_u32 m0, s20, 8320
    s_nop 0
    buffer_load_dwordx4 v62, s[40:43], s82 offen lds
    s_add_u32 s82, s82, 2048
    s_add_u32 m0, s20, 16640
    s_nop 0
    buffer_load_dwordx4 v62, s[40:43], s82 offen lds
    s_add_u32 s96, s85, 6
    s_and_b32 s97, s96, 15
    s_lshl3_add_u32 s98, s97, s3
    s_mul_i32 s99, s98, 49152
    s_lshl_b32 s96, s11, 7
    s_add_u32 s82, s99, s96
    s_lshr_b32 s96, s3, 1
    s_mul_i32 s97, s96, 2080
    s_and_b32 s98, s3, 1
    s_mul_i32 s99, s98, 1056
    s_add_u32 s20, s97, s99
    s_mov_b32 m0, s20
    s_nop 0
    buffer_load_dwordx4 v62, s[40:43], s82 offen lds
    s_add_u32 s82, s82, 2048
    s_add_u32 m0, s20, 8320
    s_nop 0
    buffer_load_dwordx4 v62, s[40:43], s82 offen lds
    s_add_u32 s82, s82, 2048
    s_add_u32 m0, s20, 16640
    s_nop 0
    buffer_load_dwordx4 v62, s[40:43], s82 offen lds
    s_waitcnt vmcnt(8)
    v_lshlrev_b32 v112, 16, v120
    v_mul_f32 v4, s7, v112
    v_exp_f32 v4, -v4
    s_nop 0
    v_add_f32 v4, 1.0, v4
    v_rcp_f32 v4, v4
    s_nop 0
    v_mul_f32 v112, v112, v4
    v_cvt_pk_bf16_f32 v112, 0, v112
    v_and_b32 v113, s6, v120
    v_mul_f32 v5, s7, v113
    v_exp_f32 v5, -v5
    s_nop 0
    v_add_f32 v5, 1.0, v5
    v_rcp_f32 v5, v5
    s_nop 0
    v_mul_f32 v113, v113, v5
    v_cvt_pk_bf16_f32 v113, 0, v113
    v_lshlrev_b32 v114, 16, v121
    v_mul_f32 v4, s7, v114
    v_exp_f32 v4, -v4
    s_nop 0
    v_add_f32 v4, 1.0, v4
    v_rcp_f32 v4, v4
    s_nop 0
    v_mul_f32 v114, v114, v4
    v_cvt_pk_bf16_f32 v114, 0, v114
    v_and_b32 v115, s6, v121
    v_mul_f32 v5, s7, v115
    v_exp_f32 v5, -v5
    s_nop 0
    v_add_f32 v5, 1.0, v5
    v_rcp_f32 v5, v5
    s_nop 0
    v_mul_f32 v115, v115, v5
    v_cvt_pk_bf16_f32 v115, 0, v115
    s_barrier
    s_add_u32 s96, s85, 7
    s_and_b32 s97, s96, 15
    s_lshl3_add_u32 s98, s97, s3
    s_sub_u32 s99, s98, 4
    s_mul_i32 s96, s99, 49152
    s_lshl_b32 s97, s11, 7
    s_add_u32 s82, s96, s97
    s_sub_u32 s96, s3, 4
    s_lshr_b32 s97, s96, 1
    s_mul_i32 s98, s97, 2080
    s_sub_u32 s99, s3, 4
    s_and_b32 s96, s99, 1
    s_mul_i32 s97, s96, 1056
    s_add_u32 s99, s98, s97
    s_add_u32 s20, s99, 24960
    s_mov_b32 m0, s20
    s_nop 0
    buffer_load_dwordx4 v62, s[40:43], s82 offen lds
    s_add_u32 s82, s82, 2048
    s_add_u32 m0, s20, 8320
    s_nop 0
    buffer_load_dwordx4 v62, s[40:43], s82 offen lds
    s_add_u32 s82, s82, 2048
    s_add_u32 m0, s20, 16640
    s_nop 0
    buffer_load_dwordx4 v62, s[40:43], s82 offen lds
    buffer_load_dwordx4 v[88:91], v60, s[48:51], s17 offen nt
    s_add_u32 s17, s17, 12288
    buffer_load_dwordx4 v[92:95], v60, s[48:51], s17 offen nt
    s_add_u32 s17, s17, 12288
    s_barrier
    s_add_u32 s96, s85, 7
    s_and_b32 s97, s96, 15
    s_lshl3_add_u32 s98, s97, s3
    s_mul_i32 s99, s98, 49152
    s_lshl_b32 s96, s11, 7
    s_add_u32 s82, s99, s96
    s_lshr_b32 s96, s3, 1
    s_mul_i32 s97, s96, 2080
    s_and_b32 s98, s3, 1
    s_mul_i32 s99, s98, 1056
    s_add_u32 s96, s97, s99
    s_add_u32 s20, s96, 24960
    s_mov_b32 m0, s20
    s_nop 0
    buffer_load_dwordx4 v62, s[40:43], s82 offen lds
    s_add_u32 s82, s82, 2048
    s_add_u32 m0, s20, 8320
    s_nop 0
    buffer_load_dwordx4 v62, s[40:43], s82 offen lds
    s_add_u32 s82, s82, 2048
    s_add_u32 m0, s20, 16640
    s_nop 0
    buffer_load_dwordx4 v62, s[40:43], s82 offen lds
    s_add_u32 s96, s85, 8
    s_and_b32 s97, s96, 15
    s_lshl3_add_u32 s98, s97, s3
    s_sub_u32 s99, s98, 4
    s_mul_i32 s96, s99, 49152
    s_lshl_b32 s97, s11, 7
    s_add_u32 s82, s96, s97
    s_sub_u32 s96, s3, 4
    s_lshr_b32 s97, s96, 1
    s_mul_i32 s98, s97, 2080
    s_sub_u32 s99, s3, 4
    s_and_b32 s96, s99, 1
    s_mul_i32 s97, s96, 1056
    s_add_u32 s99, s98, s97
    s_add_u32 s20, s99, 49920
    s_mov_b32 m0, s20
    s_nop 0
    buffer_load_dwordx4 v62, s[40:43], s82 offen lds
    s_add_u32 s82, s82, 2048
    s_add_u32 m0, s20, 8320
    s_nop 0
    buffer_load_dwordx4 v62, s[40:43], s82 offen lds
    s_add_u32 s82, s82, 2048
    s_add_u32 m0, s20, 16640
    s_nop 0
    buffer_load_dwordx4 v62, s[40:43], s82 offen lds
    v_lshlrev_b32 v116, 16, v122
    v_mul_f32 v4, s7, v116
    v_exp_f32 v4, -v4
    s_nop 0
    v_add_f32 v4, 1.0, v4
    v_rcp_f32 v4, v4
    s_nop 0
    v_mul_f32 v116, v116, v4
    v_cvt_pk_bf16_f32 v116, 0, v116
    v_and_b32 v117, s6, v122
    v_mul_f32 v5, s7, v117
    v_exp_f32 v5, -v5
    s_nop 0
    v_add_f32 v5, 1.0, v5
    v_rcp_f32 v5, v5
    s_nop 0
    v_mul_f32 v117, v117, v5
    v_cvt_pk_bf16_f32 v117, 0, v117
    v_lshlrev_b32 v118, 16, v123
    v_mul_f32 v4, s7, v118
    v_exp_f32 v4, -v4
    s_nop 0
    v_add_f32 v4, 1.0, v4
    v_rcp_f32 v4, v4
    s_nop 0
    v_mul_f32 v118, v118, v4
    v_cvt_pk_bf16_f32 v118, 0, v118
    v_and_b32 v119, s6, v123
    v_mul_f32 v5, s7, v119
    v_exp_f32 v5, -v5
    s_nop 0
    v_add_f32 v5, 1.0, v5
    v_rcp_f32 v5, v5
    s_nop 0
    v_mul_f32 v119, v119, v5
    v_cvt_pk_bf16_f32 v119, 0, v119
    s_waitcnt lgkmcnt(0)
    s_load_dword s24, s[32:33], s92 offset:1536 glc
    s_load_dword s25, s[32:33], s92 offset:1280 glc
    s_load_dword s26, s[32:33], s92 offset:2048 glc
    s_load_dword s27, s[32:33], s92 offset:1792 glc
    s_barrier
    s_add_u32 s96, s85, 8
    s_and_b32 s97, s96, 15
    s_lshl3_add_u32 s98, s97, s3
    s_mul_i32 s99, s98, 49152
    s_lshl_b32 s96, s11, 7
    s_add_u32 s82, s99, s96
    s_lshr_b32 s96, s3, 1
    s_mul_i32 s97, s96, 2080
    s_and_b32 s98, s3, 1
    s_mul_i32 s99, s98, 1056
    s_add_u32 s96, s97, s99
    s_add_u32 s20, s96, 49920
    s_mov_b32 m0, s20
    s_nop 0
    buffer_load_dwordx4 v62, s[40:43], s82 offen lds
    s_add_u32 s82, s82, 2048
    s_add_u32 m0, s20, 8320
    s_nop 0
    buffer_load_dwordx4 v62, s[40:43], s82 offen lds
    s_add_u32 s82, s82, 2048
    s_add_u32 m0, s20, 16640
    s_nop 0
    buffer_load_dwordx4 v62, s[40:43], s82 offen lds
    buffer_load_dwordx4 v[96:99], v60, s[48:51], s17 offen nt
    s_add_u32 s17, s17, 12288
    buffer_load_dwordx4 v[100:103], v60, s[48:51], s17 offen nt
    s_add_u32 s17, s17, 12288
    s_waitcnt vmcnt(16)
    s_barrier
    s_add_u32 s96, s85, 9
    s_and_b32 s97, s96, 15
    s_lshl3_add_u32 s98, s97, s3
    s_sub_u32 s99, s98, 4
    s_mul_i32 s96, s99, 49152
    s_lshl_b32 s97, s11, 7
    s_add_u32 s82, s96, s97
    s_sub_u32 s96, s3, 4
    s_lshr_b32 s97, s96, 1
    s_mul_i32 s98, s97, 2080
    s_sub_u32 s99, s3, 4
    s_and_b32 s96, s99, 1
    s_mul_i32 s97, s96, 1056
    s_add_u32 s99, s98, s97
    s_add_u32 s20, s99, 74880
    s_mov_b32 m0, s20
    s_nop 0
    buffer_load_dwordx4 v62, s[40:43], s82 offen lds
    s_add_u32 s82, s82, 2048
    s_add_u32 m0, s20, 8320
    s_nop 0
    buffer_load_dwordx4 v62, s[40:43], s82 offen lds
    s_add_u32 s82, s82, 2048
    s_add_u32 m0, s20, 16640
    s_nop 0
    buffer_load_dwordx4 v62, s[40:43], s82 offen lds
    s_add_u32 s96, s85, 9
    s_and_b32 s97, s96, 15
    s_lshl3_add_u32 s98, s97, s3
    s_mul_i32 s99, s98, 49152
    s_lshl_b32 s96, s11, 7
    s_add_u32 s82, s99, s96
    s_lshr_b32 s96, s3, 1
    s_mul_i32 s97, s96, 2080
    s_and_b32 s98, s3, 1
    s_mul_i32 s99, s98, 1056
    s_add_u32 s96, s97, s99
    s_add_u32 s20, s96, 74880
    s_mov_b32 m0, s20
    s_nop 0
    buffer_load_dwordx4 v62, s[40:43], s82 offen lds
    s_add_u32 s82, s82, 2048
    s_add_u32 m0, s20, 8320
    s_nop 0
    buffer_load_dwordx4 v62, s[40:43], s82 offen lds
    s_add_u32 s82, s82, 2048
    s_add_u32 m0, s20, 16640
    s_nop 0
    buffer_load_dwordx4 v62, s[40:43], s82 offen lds
    v_lshlrev_b32 v4, 16, v80
    v_and_b32 v5, s6, v80
    v_mul_f32 v20, v4, v112
    v_mul_f32 v21, v5, v112
    v_lshlrev_b32 v6, 16, v81
    v_and_b32 v7, s6, v81
    v_mul_f32 v22, v6, v112
    v_mul_f32 v23, v7, v112
    v_lshlrev_b32 v4, 16, v82
    v_and_b32 v5, s6, v82
    v_mul_f32 v24, v4, v112
    v_mul_f32 v25, v5, v112
    v_lshlrev_b32 v6, 16, v83
    v_and_b32 v7, s6, v83
    v_mul_f32 v26, v6, v112
    v_mul_f32 v27, v7, v112
    s_waitcnt vmcnt(14)
    s_barrier
    s_add_u32 s96, s85, 10
    s_and_b32 s97, s96, 15
    s_lshl3_add_u32 s98, s97, s3
    s_sub_u32 s99, s98, 4
    s_mul_i32 s96, s99, 49152
    s_lshl_b32 s97, s11, 7
    s_add_u32 s82, s96, s97
    s_sub_u32 s96, s3, 4
    s_lshr_b32 s97, s96, 1
    s_mul_i32 s98, s97, 2080
    s_sub_u32 s99, s3, 4
    s_and_b32 s96, s99, 1
    s_mul_i32 s97, s96, 1056
    s_add_u32 s99, s98, s97
    s_add_u32 s20, s99, 99840
    s_mov_b32 m0, s20
    s_nop 0
    buffer_load_dwordx4 v62, s[40:43], s82 offen lds
    s_add_u32 s82, s82, 2048
    s_add_u32 m0, s20, 8320
    s_nop 0
    buffer_load_dwordx4 v62, s[40:43], s82 offen lds
    s_add_u32 s82, s82, 2048
    s_add_u32 m0, s20, 16640
    s_nop 0
    buffer_load_dwordx4 v62, s[40:43], s82 offen lds
    buffer_load_dwordx4 v[104:107], v60, s[48:51], s17 offen nt
    s_add_u32 s17, s17, 12288
    buffer_load_dwordx4 v[108:111], v60, s[48:51], s17 offen nt
    s_lshl2_add_u32 s96, s74, s75
    s_lshl_b32 s97, s96, 11
    s_and_b32 s98, s3, 1
    s_lshl_b32 s99, s98, 10
    s_add_u32 s96, s97, s99
    s_add_u32 s13, s96, 20971520
    s_lshl4_add_u32 s96, s21, s12
    s_lshl_b32 s97, s96, 11
    s_and_b32 s98, s3, 1
    s_lshl_b32 s99, s98, 10
    s_add_u32 s96, s97, s99
    s_add_u32 s14, s96, 12582912
    buffer_load_dwordx4 v[124:127], v2, s[32:35], s13 offen
    s_waitcnt lgkmcnt(0)
    s_load_dword s24, s[32:33], s92 offset:2560 glc
    s_load_dword s25, s[32:33], s92 offset:2304 glc
    s_load_dword s26, s[32:33], s92 offset:3072 glc
    s_load_dword s27, s[32:33], s92 offset:2816 glc
    s_load_dword s28, s[32:33], s92 offset:3584 glc
    s_load_dword s29, s[32:33], s92 offset:3328 glc
    s_waitcnt vmcnt(14)
    s_barrier
    s_add_u32 s96, s85, 10
    s_and_b32 s97, s96, 15
    s_lshl3_add_u32 s98, s97, s3
    s_mul_i32 s99, s98, 49152
    s_lshl_b32 s96, s11, 7
    s_add_u32 s82, s99, s96
    s_lshr_b32 s96, s3, 1
    s_mul_i32 s97, s96, 2080
    s_and_b32 s98, s3, 1
    s_mul_i32 s99, s98, 1056
    s_add_u32 s96, s97, s99
    s_add_u32 s20, s96, 99840
    s_mov_b32 m0, s20
    s_nop 0
    buffer_load_dwordx4 v62, s[40:43], s82 offen lds
    s_add_u32 s82, s82, 2048
    s_add_u32 m0, s20, 8320
    s_nop 0
    buffer_load_dwordx4 v62, s[40:43], s82 offen lds
    s_add_u32 s82, s82, 2048
    s_add_u32 m0, s20, 16640
    s_nop 0
    buffer_load_dwordx4 v62, s[40:43], s82 offen lds
    s_add_u32 s96, s85, 11
    s_and_b32 s97, s96, 15
    s_lshl3_add_u32 s98, s97, s3
    s_sub_u32 s99, s98, 4
    s_mul_i32 s96, s99, 49152
    s_lshl_b32 s97, s11, 7
    s_add_u32 s82, s96, s97
    s_sub_u32 s96, s3, 4
    s_lshr_b32 s97, s96, 1
    s_mul_i32 s98, s97, 2080
    s_sub_u32 s99, s3, 4
    s_and_b32 s96, s99, 1
    s_mul_i32 s97, s96, 1056
    s_add_u32 s99, s98, s97
    s_add_u32 s20, s99, 124800
    s_mov_b32 m0, s20
    s_nop 0
    buffer_load_dwordx4 v62, s[40:43], s82 offen lds
    s_add_u32 s82, s82, 2048
    s_add_u32 m0, s20, 8320
    s_nop 0
    buffer_load_dwordx4 v62, s[40:43], s82 offen lds
    s_add_u32 s82, s82, 2048
    s_add_u32 m0, s20, 16640
    s_nop 0
    buffer_load_dwordx4 v62, s[40:43], s82 offen lds
    v_lshlrev_b32 v4, 16, v84
    v_and_b32 v5, s6, v84
    v_fmac_f32 v20, v4, v113
    v_fmac_f32 v21, v5, v113
    v_lshlrev_b32 v6, 16, v85
    v_and_b32 v7, s6, v85
    v_fmac_f32 v22, v6, v113
    v_fmac_f32 v23, v7, v113
    v_lshlrev_b32 v4, 16, v86
    v_and_b32 v5, s6, v86
    v_fmac_f32 v24, v4, v113
    v_fmac_f32 v25, v5, v113
    v_lshlrev_b32 v6, 16, v87
    v_and_b32 v7, s6, v87
    v_fmac_f32 v26, v6, v113
    v_fmac_f32 v27, v7, v113
    s_waitcnt vmcnt(12)
    s_barrier
    s_add_u32 s96, s85, 11
    s_and_b32 s97, s96, 15
    s_lshl3_add_u32 s98, s97, s3
    s_mul_i32 s99, s98, 49152
    s_lshl_b32 s96, s11, 7
    s_add_u32 s82, s99, s96
    s_lshr_b32 s96, s3, 1
    s_mul_i32 s97, s96, 2080
    s_and_b32 s98, s3, 1
    s_mul_i32 s99, s98, 1056
    s_add_u32 s96, s97, s99
    s_add_u32 s20, s96, 124800
    s_mov_b32 m0, s20
    s_nop 0
    buffer_load_dwordx4 v62, s[40:43], s82 offen lds
    s_add_u32 s82, s82, 2048
    s_add_u32 m0, s20, 8320
    s_nop 0
    buffer_load_dwordx4 v62, s[40:43], s82 offen lds
    s_add_u32 s82, s82, 2048
    s_add_u32 m0, s20, 16640
    s_nop 0
    buffer_load_dwordx4 v62, s[40:43], s82 offen lds
    s_add_u32 s96, s85, 12
    s_and_b32 s97, s96, 15
    s_lshl3_add_u32 s98, s97, s3
    s_sub_u32 s99, s98, 4
    s_mul_i32 s96, s99, 49152
    s_lshl_b32 s97, s11, 7
    s_add_u32 s82, s96, s97
    s_sub_u32 s96, s3, 4
    s_lshr_b32 s97, s96, 1
    s_mul_i32 s98, s97, 2080
    s_sub_u32 s99, s3, 4
    s_and_b32 s96, s99, 1
    s_mul_i32 s97, s96, 1056
    s_add_u32 s20, s98, s97
    s_mov_b32 m0, s20
    s_nop 0
    buffer_load_dwordx4 v62, s[40:43], s82 offen lds
    s_add_u32 s82, s82, 2048
    s_add_u32 m0, s20, 8320
    s_nop 0
    buffer_load_dwordx4 v62, s[40:43], s82 offen lds
    s_add_u32 s82, s82, 2048
    s_add_u32 m0, s20, 16640
    s_nop 0
    buffer_load_dwordx4 v62, s[40:43], s82 offen lds
    v_lshlrev_b32 v4, 16, v88
    v_and_b32 v5, s6, v88
    v_fmac_f32 v20, v4, v114
    v_fmac_f32 v21, v5, v114
    v_lshlrev_b32 v6, 16, v89
    v_and_b32 v7, s6, v89
    v_fmac_f32 v22, v6, v114
    v_fmac_f32 v23, v7, v114
    v_lshlrev_b32 v4, 16, v90
    v_and_b32 v5, s6, v90
    v_fmac_f32 v24, v4, v114
    v_fmac_f32 v25, v5, v114
    v_lshlrev_b32 v6, 16, v91
    v_and_b32 v7, s6, v91
    v_fmac_f32 v26, v6, v114
    v_fmac_f32 v27, v7, v114
    s_waitcnt vmcnt(9)
    s_barrier
    s_add_u32 s96, s85, 12
    s_and_b32 s97, s96, 15
    s_lshl3_add_u32 s98, s97, s3
    s_mul_i32 s99, s98, 49152
    s_lshl_b32 s96, s11, 7
    s_add_u32 s82, s99, s96
    s_lshr_b32 s96, s3, 1
    s_mul_i32 s97, s96, 2080
    s_and_b32 s98, s3, 1
    s_mul_i32 s99, s98, 1056
    s_add_u32 s20, s97, s99
    s_mov_b32 m0, s20
    s_nop 0
    buffer_load_dwordx4 v62, s[40:43], s82 offen lds
    s_add_u32 s82, s82, 2048
    s_add_u32 m0, s20, 8320
    s_nop 0
    buffer_load_dwordx4 v62, s[40:43], s82 offen lds
    s_add_u32 s82, s82, 2048
    s_add_u32 m0, s20, 16640
    s_nop 0
    buffer_load_dwordx4 v62, s[40:43], s82 offen lds
    s_add_u32 s96, s85, 13
    s_and_b32 s97, s96, 15
    s_lshl3_add_u32 s98, s97, s3
    s_sub_u32 s99, s98, 4
    s_mul_i32 s96, s99, 49152
    s_lshl_b32 s97, s11, 7
    s_add_u32 s82, s96, s97
    s_sub_u32 s96, s3, 4
    s_lshr_b32 s97, s96, 1
    s_mul_i32 s98, s97, 2080
    s_sub_u32 s99, s3, 4
    s_and_b32 s96, s99, 1
    s_mul_i32 s97, s96, 1056
    s_add_u32 s99, s98, s97
    s_add_u32 s20, s99, 24960
    s_mov_b32 m0, s20
    s_nop 0
    buffer_load_dwordx4 v62, s[40:43], s82 offen lds
    s_add_u32 s82, s82, 2048
    s_add_u32 m0, s20, 8320
    s_nop 0
    buffer_load_dwordx4 v62, s[40:43], s82 offen lds
    s_add_u32 s82, s82, 2048
    s_add_u32 m0, s20, 16640
    s_nop 0
    buffer_load_dwordx4 v62, s[40:43], s82 offen lds
    v_lshlrev_b32 v4, 16, v92
    v_and_b32 v5, s6, v92
    v_fmac_f32 v20, v4, v115
    v_fmac_f32 v21, v5, v115
    v_lshlrev_b32 v6, 16, v93
    v_and_b32 v7, s6, v93
    v_fmac_f32 v22, v6, v115
    v_fmac_f32 v23, v7, v115
    v_lshlrev_b32 v4, 16, v94
    v_and_b32 v5, s6, v94
    v_fmac_f32 v24, v4, v115
    v_fmac_f32 v25, v5, v115
    v_lshlrev_b32 v6, 16, v95
    v_and_b32 v7, s6, v95
    v_fmac_f32 v26, v6, v115
    v_fmac_f32 v27, v7, v115
    s_waitcnt vmcnt(9)
    s_barrier
    s_add_u32 s96, s85, 13
    s_and_b32 s97, s96, 15
    s_lshl3_add_u32 s98, s97, s3
    s_mul_i32 s99, s98, 49152
    s_lshl_b32 s96, s11, 7
    s_add_u32 s82, s99, s96
    s_lshr_b32 s96, s3, 1
    s_mul_i32 s97, s96, 2080
    s_and_b32 s98, s3, 1
    s_mul_i32 s99, s98, 1056
    s_add_u32 s96, s97, s99
    s_add_u32 s20, s96, 24960
    s_mov_b32 m0, s20
    s_nop 0
    buffer_load_dwordx4 v62, s[40:43], s82 offen lds
    s_add_u32 s82, s82, 2048
    s_add_u32 m0, s20, 8320
    s_nop 0
    buffer_load_dwordx4 v62, s[40:43], s82 offen lds
    s_add_u32 s82, s82, 2048
    s_add_u32 m0, s20, 16640
    s_nop 0
    buffer_load_dwordx4 v62, s[40:43], s82 offen lds
    s_add_u32 s96, s85, 14
    s_and_b32 s97, s96, 15
    s_lshl3_add_u32 s98, s97, s3
    s_sub_u32 s99, s98, 4
    s_mul_i32 s96, s99, 49152
    s_lshl_b32 s97, s11, 7
    s_add_u32 s82, s96, s97
    s_sub_u32 s96, s3, 4
    s_lshr_b32 s97, s96, 1
    s_mul_i32 s98, s97, 2080
    s_sub_u32 s99, s3, 4
    s_and_b32 s96, s99, 1
    s_mul_i32 s97, s96, 1056
    s_add_u32 s99, s98, s97
    s_add_u32 s20, s99, 49920
    s_mov_b32 m0, s20
    s_nop 0
    buffer_load_dwordx4 v62, s[40:43], s82 offen lds
    s_add_u32 s82, s82, 2048
    s_add_u32 m0, s20, 8320
    s_nop 0
    buffer_load_dwordx4 v62, s[40:43], s82 offen lds
    s_add_u32 s82, s82, 2048
    s_add_u32 m0, s20, 16640
    s_nop 0
    buffer_load_dwordx4 v62, s[40:43], s82 offen lds
    v_lshlrev_b32 v4, 16, v96
    v_and_b32 v5, s6, v96
    v_fmac_f32 v20, v4, v116
    v_fmac_f32 v21, v5, v116
    v_lshlrev_b32 v6, 16, v97
    v_and_b32 v7, s6, v97
    v_fmac_f32 v22, v6, v116
    v_fmac_f32 v23, v7, v116
    v_lshlrev_b32 v4, 16, v98
    v_and_b32 v5, s6, v98
    v_fmac_f32 v24, v4, v116
    v_fmac_f32 v25, v5, v116
    v_lshlrev_b32 v6, 16, v99
    v_and_b32 v7, s6, v99
    v_fmac_f32 v26, v6, v116
    v_fmac_f32 v27, v7, v116
    v_lshlrev_b32 v4, 16, v100
    v_and_b32 v5, s6, v100
    v_fmac_f32 v20, v4, v117
    v_fmac_f32 v21, v5, v117
    v_lshlrev_b32 v6, 16, v101
    v_and_b32 v7, s6, v101
    v_fmac_f32 v22, v6, v117
    v_fmac_f32 v23, v7, v117
    v_lshlrev_b32 v4, 16, v102
    v_and_b32 v5, s6, v102
    v_fmac_f32 v24, v4, v117
    v_fmac_f32 v25, v5, v117
    v_lshlrev_b32 v6, 16, v103
    v_and_b32 v7, s6, v103
    v_fmac_f32 v26, v6, v117
    v_fmac_f32 v27, v7, v117
    s_waitcnt vmcnt(9)
    s_barrier
    s_add_u32 s96, s85, 14
    s_and_b32 s97, s96, 15
    s_lshl3_add_u32 s98, s97, s3
    s_mul_i32 s99, s98, 49152
    s_lshl_b32 s96, s11, 7
    s_add_u32 s82, s99, s96
    s_lshr_b32 s96, s3, 1
    s_mul_i32 s97, s96, 2080
    s_and_b32 s98, s3, 1
    s_mul_i32 s99, s98, 1056
    s_add_u32 s96, s97, s99
    s_add_u32 s20, s96, 49920
    s_mov_b32 m0, s20
    s_nop 0
    buffer_load_dwordx4 v62, s[40:43], s82 offen lds
    s_add_u32 s82, s82, 2048
    s_add_u32 m0, s20, 8320
    s_nop 0
    buffer_load_dwordx4 v62, s[40:43], s82 offen lds
    s_add_u32 s82, s82, 2048
    s_add_u32 m0, s20, 16640
    s_nop 0
    buffer_load_dwordx4 v62, s[40:43], s82 offen lds
    s_add_u32 s96, s85, 15
    s_and_b32 s97, s96, 15
    s_lshl3_add_u32 s98, s97, s3
    s_sub_u32 s99, s98, 4
    s_mul_i32 s96, s99, 49152
    s_lshl_b32 s97, s11, 7
    s_add_u32 s82, s96, s97
    s_sub_u32 s96, s3, 4
    s_lshr_b32 s97, s96, 1
    s_mul_i32 s98, s97, 2080
    s_sub_u32 s99, s3, 4
    s_and_b32 s96, s99, 1
    s_mul_i32 s97, s96, 1056
    s_add_u32 s99, s98, s97
    s_add_u32 s20, s99, 74880
    s_mov_b32 m0, s20
    s_nop 0
    buffer_load_dwordx4 v62, s[40:43], s82 offen lds
    s_add_u32 s82, s82, 2048
    s_add_u32 m0, s20, 8320
    s_nop 0
    buffer_load_dwordx4 v62, s[40:43], s82 offen lds
    s_add_u32 s82, s82, 2048
    s_add_u32 m0, s20, 16640
    s_nop 0
    buffer_load_dwordx4 v62, s[40:43], s82 offen lds
    v_lshlrev_b32 v4, 16, v104
    v_and_b32 v5, s6, v104
    v_fmac_f32 v20, v4, v118
    v_fmac_f32 v21, v5, v118
    v_lshlrev_b32 v6, 16, v105
    v_and_b32 v7, s6, v105
    v_fmac_f32 v22, v6, v118
    v_fmac_f32 v23, v7, v118
    v_lshlrev_b32 v4, 16, v106
    v_and_b32 v5, s6, v106
    v_fmac_f32 v24, v4, v118
    v_fmac_f32 v25, v5, v118
    v_lshlrev_b32 v6, 16, v107
    v_and_b32 v7, s6, v107
    v_fmac_f32 v26, v6, v118
    v_fmac_f32 v27, v7, v118
    v_lshlrev_b32 v4, 16, v108
    v_and_b32 v5, s6, v108
    v_fmac_f32 v20, v4, v119
    v_fmac_f32 v21, v5, v119
    v_lshlrev_b32 v6, 16, v109
    v_and_b32 v7, s6, v109
    v_fmac_f32 v22, v6, v119
    v_fmac_f32 v23, v7, v119
    v_lshlrev_b32 v4, 16, v110
    v_and_b32 v5, s6, v110
    v_fmac_f32 v24, v4, v119
    v_fmac_f32 v25, v5, v119
    v_lshlrev_b32 v6, 16, v111
    v_and_b32 v7, s6, v111
    v_fmac_f32 v26, v6, v119
    v_fmac_f32 v27, v7, v119
    s_waitcnt vmcnt(9)
    s_barrier
    s_add_u32 s96, s85, 15
    s_and_b32 s97, s96, 15
    s_lshl3_add_u32 s98, s97, s3
    s_mul_i32 s99, s98, 49152
    s_lshl_b32 s96, s11, 7
    s_add_u32 s82, s99, s96
    s_lshr_b32 s96, s3, 1
    s_mul_i32 s97, s96, 2080
    s_and_b32 s98, s3, 1
    s_mul_i32 s99, s98, 1056
    s_add_u32 s96, s97, s99
    s_add_u32 s20, s96, 74880
    s_mov_b32 m0, s20
    s_nop 0
    buffer_load_dwordx4 v62, s[40:43], s82 offen lds
    s_add_u32 s82, s82, 2048
    s_add_u32 m0, s20, 8320
    s_nop 0
    buffer_load_dwordx4 v62, s[40:43], s82 offen lds
    s_add_u32 s82, s82, 2048
    s_add_u32 m0, s20, 16640
    s_nop 0
    buffer_load_dwordx4 v62, s[40:43], s82 offen lds
    s_lshl_b32 s13, s12, 7
    v_and_b32 v4, 31, v1
    v_lshl_add_u32 v4, v4, 2, s13
    global_load_dword v104, v4, s[78:79]
    v_permlane32_swap_b32 v20, v24
    v_permlane32_swap_b32 v21, v25
    v_permlane32_swap_b32 v22, v26
    v_permlane32_swap_b32 v23, v27
    v_add_f32 v20, v20, v24
    v_add_f32 v21, v21, v25
    v_add_f32 v22, v22, v26
    v_add_f32 v23, v23, v27
    s_nop 0
    v_permlane16_swap_b32 v20, v22
    v_permlane16_swap_b32 v21, v23
    v_add_f32 v20, v20, v22
    v_add_f32 v21, v21, v23
    s_nop 0
    v_add_f32_dpp v20, v20, v20 row_ror:8 row_mask:0xf bank_mask:0xf
    v_add_f32_dpp v21, v21, v21 row_ror:8 row_mask:0xf bank_mask:0xf
    s_nop 1
    v_mov_b32_dpp v20, v21 quad_perm:[0,1,2,3] row_mask:0xf bank_mask:0xc
    ds_write_b32 v65, v20 offset:1024
    s_waitcnt lgkmcnt(0)
    s_barrier
    s_waitcnt vmcnt(7)
    s_waitcnt vmcnt(1)
    s_barrier
    s_cmp_lg_u32 s3, 4
    s_cbranch_scc1 L_M2F
    s_bfe_u32 s96, s9, 131074
    s_lshl_b32 s97, s8, 1
    s_lshl4_add_u32 s98, s96, s97
    s_lshr_b32 s99, s9, 4
    s_add_u32 s96, s98, s99
    s_and_b32 s97, s9, 3
    s_lshl2_add_u32 s98, s96, s97
    s_lshl_b32 s99, s98, 9
    s_add_u32 s13, s99, 131072
    ds_read_b128 v[20:23], v64 offset:1024
    ds_read_b128 v[24:27], v64 offset:1040
    s_waitcnt lgkmcnt(0)
    v_add_f32 v20, v20, v22
    v_add_f32 v21, v21, v23
    v_add_f32 v24, v24, v26
    v_add_f32 v25, v25, v27
    v_add_f32 v20, v20, v21
    v_add_f32 v22, v24, v25
    v_mov_b32 v21, s4
    v_mov_b32 v23, s4
    s_mov_b32 exec_hi, 0
    buffer_store_dwordx4 v[20:23], v2, s[32:35], s13 offen sc1
    s_mov_b32 exec_hi, -1
L_M2F:
    s_lshl4_add_u32 s96, s11, s10
    s_lshl_b32 s97, s96, 10
    s_and_b32 s98, s3, 3
    s_lshl_b32 s99, s98, 8
    s_add_u32 s96, s97, s99
    s_add_u32 s13, s96, 29360128
    s_lshl_b32 s96, s11, 7
    s_add_u32 s14, s96, 32768
    v_lshlrev_b32 v60, 7, v1
    s_mov_b64 exec, 3
    buffer_load_dword v60, v60, s[32:35], s13 offen
    buffer_load_dword v61, v3, s[32:35], s14 offen
    s_mov_b64 exec, -1
    s_add_u32 s96, s84, 1114112
    s_and_b32 s97, s96, 1048575
    s_lshl_b32 s98, s83, 16
    s_xor_b32 s99, s97, s98
    s_xor_b32 s96, s88, 1048576
    s_add_u32 s13, s99, s96
    s_add_u32 m0, s89, 102400
    s_nop 0
    buffer_load_dwordx4 v74, s[44:47], s13 offen lds
    s_add_u32 s96, s84, 1179648
    s_and_b32 s97, s96, 1048575
    s_lshl_b32 s98, s83, 16
    s_xor_b32 s99, s97, s98
    s_xor_b32 s96, s88, 1048576
    s_add_u32 s13, s99, s96
    s_add_u32 m0, s89, 106496
    s_nop 0
    buffer_load_dwordx4 v74, s[44:47], s13 offen lds
    s_add_u32 s96, s84, 1245184
    s_and_b32 s97, s96, 1048575
    s_lshl_b32 s98, s83, 16
    s_xor_b32 s99, s97, s98
    s_xor_b32 s96, s88, 1048576
    s_add_u32 s13, s99, s96
    s_add_u32 m0, s89, 110592
    s_nop 0
    buffer_load_dwordx4 v74, s[44:47], s13 offen lds
    s_add_u32 s96, s84, 1310720
    s_and_b32 s97, s96, 1048575
    s_lshl_b32 s98, s83, 16
    s_xor_b32 s99, s97, s98
    s_xor_b32 s96, s88, 1048576
    s_add_u32 s13, s99, s96
    s_add_u32 m0, s89, 114688
    s_nop 0
    buffer_load_dwordx4 v74, s[44:47], s13 offen lds
    s_add_u32 s96, s84, 1376256
    s_and_b32 s97, s96, 1048575
    s_lshl_b32 s98, s83, 16
    s_xor_b32 s99, s97, s98
    s_xor_b32 s96, s88, 1048576
    s_add_u32 s13, s99, s96
    s_add_u32 m0, s89, 118784
    s_nop 0
    buffer_load_dwordx4 v74, s[44:47], s13 offen lds
    s_add_u32 s96, s84, 1441792
    s_and_b32 s97, s96, 1048575
    s_lshl_b32 s98, s83, 16
    s_xor_b32 s99, s97, s98
    s_xor_b32 s96, s88, 1048576
    s_add_u32 s13, s99, s96
    s_add_u32 m0, s89, 122880
    s_nop 0
    buffer_load_dwordx4 v74, s[44:47], s13 offen lds
    s_add_u32 s96, s84, 1507328
    s_and_b32 s97, s96, 1048575
    s_lshl_b32 s98, s83, 16
    s_xor_b32 s99, s97, s98
    s_xor_b32 s96, s88, 1048576
    s_add_u32 s13, s99, s96
    s_add_u32 m0, s89, 126976
    s_nop 0
    buffer_load_dwordx4 v74, s[44:47], s13 offen lds
    s_add_u32 s96, s84, 1572864
    s_and_b32 s97, s96, 1048575
    s_lshl_b32 s98, s83, 16
    s_xor_b32 s99, s97, s98
    s_xor_b32 s96, s88, 1048576
    s_add_u32 s13, s99, s96
    s_add_u32 m0, s89, 131072
    s_nop 0
    buffer_load_dwordx4 v74, s[44:47], s13 offen lds
    s_mov_b32 s13, s80
    buffer_load_dwordx4 v[176:179], v72, s[52:55], s13 offen nt
    s_add_u32 s13, s80, 4294049792
    buffer_load_dwordx4 v[180:183], v72, s[52:55], s13 offen nt
    s_lshl_b32 s96, s90, 7
    s_add_u32 s13, s96, s80
    buffer_load_dwordx4 v[184:187], v72, s[56:59], s13 offen nt
    s_lshl_b32 s96, s90, 7
    s_add_u32 s97, s96, s80
    s_add_u32 s13, s97, 4294049792
    buffer_load_dwordx4 v[188:191], v72, s[56:59], s13 offen nt
    s_add_u32 s13, s80, 57344
    buffer_load_dwordx4 v[192:195], v72, s[52:55], s13 offen nt
    s_add_u32 s13, s80, 4294107136
    buffer_load_dwordx4 v[196:199], v72, s[52:55], s13 offen nt
    s_lshl_b32 s96, s90, 7
    s_add_u32 s97, s96, s80
    s_add_u32 s13, s97, 57344
    buffer_load_dwordx4 v[200:203], v72, s[56:59], s13 offen nt
    s_lshl_b32 s96, s90, 7
    s_add_u32 s97, s96, s80
    s_add_u32 s13, s97, 4294107136
    buffer_load_dwordx4 v[204:207], v72, s[56:59], s13 offen nt
    s_waitcnt lgkmcnt(0)
    s_barrier
    ds_read_b128 v[36:39], v76
    ds_read_b128 v[40:43], v76 offset:1024
    s_waitcnt lgkmcnt(0)
    v_mfma_f32_32x32x16_bf16 v[112:127], v[28:31], v[36:39], 0
    v_mfma_f32_32x32x16_bf16 v[112:127], v[32:35], v[40:43], v[112:127]
    s_add_u32 s13, s80, 114688
    buffer_load_dwordx4 v[208:211], v72, s[52:55], s13 offen nt
    s_add_u32 s13, s80, 4294164480
    buffer_load_dwordx4 v[212:215], v72, s[52:55], s13 offen nt
    s_lshl_b32 s96, s90, 7
    s_add_u32 s97, s96, s80
    s_add_u32 s13, s97, 114688
    buffer_load_dwordx4 v[216:219], v72, s[56:59], s13 offen nt
    s_lshl_b32 s96, s90, 7
    s_add_u32 s97, s96, s80
    s_add_u32 s13, s97, 4294164480
    buffer_load_dwordx4 v[220:223], v72, s[56:59], s13 offen nt
L_JOIN:
    v_cvt_pk_bf16_f32 v112, 0, v112
    v_cvt_pk_bf16_f32 v113, 0, v113
    v_cvt_pk_bf16_f32 v114, 0, v114
    v_cvt_pk_bf16_f32 v115, 0, v115
    v_cvt_pk_bf16_f32 v116, 0, v116
    v_cvt_pk_bf16_f32 v117, 0, v117
    v_cvt_pk_bf16_f32 v118, 0, v118
    v_cvt_pk_bf16_f32 v119, 0, v119
    v_cvt_pk_bf16_f32 v120, 0, v120
    v_cvt_pk_bf16_f32 v121, 0, v121
    v_cvt_pk_bf16_f32 v122, 0, v122
    v_cvt_pk_bf16_f32 v123, 0, v123
    v_cvt_pk_bf16_f32 v124, 0, v124
    v_cvt_pk_bf16_f32 v125, 0, v125
    v_cvt_pk_bf16_f32 v126, 0, v126
    v_cvt_pk_bf16_f32 v127, 0, v127
    v_max3_f32 v4, v112, v113, v114
    v_min3_f32 v5, v112, v113, v114
    v_max3_f32 v4, v4, v115, v116
    v_min3_f32 v5, v5, v115, v116
    v_max3_f32 v4, v4, v117, v118
    v_min3_f32 v5, v5, v117, v118
    v_max3_f32 v4, v4, v119, v120
    v_min3_f32 v5, v5, v119, v120
    v_max3_f32 v4, v4, v121, v122
    v_min3_f32 v5, v5, v121, v122
    v_max3_f32 v4, v4, v123, v124
    v_min3_f32 v5, v5, v123, v124
    v_max3_f32 v4, v4, v125, v126
    v_min3_f32 v5, v5, v125, v126
    v_max_f32 v6, v4, v127
    v_min_f32 v7, v5, v127
    v_max_f32 v4, v4, v127
    v_min_f32 v5, v5, v127
    s_nop 0
    v_permlane32_swap_b32 v4, v6
    v_permlane32_swap_b32 v5, v7
    v_max_f32 v4, v4, v6
    v_min_f32 v5, v5, v7
    v_pk_mul_f32 v[4:5], v[4:5], s[6:7] op_sel:[0,1]
    v_pk_fma_f32 v[128:129], v[112:113], s[6:7], v[4:5] op_sel:[0,1,0] op_sel_hi:[1,1,0] neg_lo:[0,0,1] neg_hi:[0,0,1]
    v_pk_fma_f32 v[112:113], v[112:113], s[6:7], v[4:5] op_sel:[0,1,1] neg_lo:[1,0,0] neg_hi:[1,0,0]
    v_pk_fma_f32 v[130:131], v[114:115], s[6:7], v[4:5] op_sel:[0,1,0] op_sel_hi:[1,1,0] neg_lo:[0,0,1] neg_hi:[0,0,1]
    v_pk_fma_f32 v[114:115], v[114:115], s[6:7], v[4:5] op_sel:[0,1,1] neg_lo:[1,0,0] neg_hi:[1,0,0]
    v_pk_fma_f32 v[132:133], v[116:117], s[6:7], v[4:5] op_sel:[0,1,0] op_sel_hi:[1,1,0] neg_lo:[0,0,1] neg_hi:[0,0,1]
    v_pk_fma_f32 v[116:117], v[116:117], s[6:7], v[4:5] op_sel:[0,1,1] neg_lo:[1,0,0] neg_hi:[1,0,0]
    v_pk_fma_f32 v[134:135], v[118:119], s[6:7], v[4:5] op_sel:[0,1,0] op_sel_hi:[1,1,0] neg_lo:[0,0,1] neg_hi:[0,0,1]
    v_pk_fma_f32 v[118:119], v[118:119], s[6:7], v[4:5] op_sel:[0,1,1] neg_lo:[1,0,0] neg_hi:[1,0,0]
    v_pk_fma_f32 v[136:137], v[120:121], s[6:7], v[4:5] op_sel:[0,1,0] op_sel_hi:[1,1,0] neg_lo:[0,0,1] neg_hi:[0,0,1]
    v_pk_fma_f32 v[120:121], v[120:121], s[6:7], v[4:5] op_sel:[0,1,1] neg_lo:[1,0,0] neg_hi:[1,0,0]
    v_pk_fma_f32 v[138:139], v[122:123], s[6:7], v[4:5] op_sel:[0,1,0] op_sel_hi:[1,1,0] neg_lo:[0,0,1] neg_hi:[0,0,1]
    v_pk_fma_f32 v[122:123], v[122:123], s[6:7], v[4:5] op_sel:[0,1,1] neg_lo:[1,0,0] neg_hi:[1,0,0]
    v_pk_fma_f32 v[140:141], v[124:125], s[6:7], v[4:5] op_sel:[0,1,0] op_sel_hi:[1,1,0] neg_lo:[0,0,1] neg_hi:[0,0,1]
    v_pk_fma_f32 v[124:125], v[124:125], s[6:7], v[4:5] op_sel:[0,1,1] neg_lo:[1,0,0] neg_hi:[1,0,0]
    v_pk_fma_f32 v[142:143], v[126:127], s[6:7], v[4:5] op_sel:[0,1,0] op_sel_hi:[1,1,0] neg_lo:[0,0,1] neg_hi:[0,0,1]
    v_pk_fma_f32 v[126:127], v[126:127], s[6:7], v[4:5] op_sel:[0,1,1] neg_lo:[1,0,0] neg_hi:[1,0,0]
    v_exp_f32 v128, v128
    v_exp_f32 v112, v112
    v_exp_f32 v129, v129
    v_exp_f32 v113, v113
    v_exp_f32 v130, v130
    v_exp_f32 v114, v114
    v_exp_f32 v131, v131
    v_exp_f32 v115, v115
    v_exp_f32 v132, v132
    v_exp_f32 v116, v116
    v_exp_f32 v133, v133
    v_exp_f32 v117, v117
    v_exp_f32 v134, v134
    v_exp_f32 v118, v118
    v_exp_f32 v135, v135
    v_exp_f32 v119, v119
    v_exp_f32 v136, v136
    v_exp_f32 v120, v120
    v_exp_f32 v137, v137
    v_exp_f32 v121, v121
    v_exp_f32 v138, v138
    v_exp_f32 v122, v122
    v_exp_f32 v139, v139
    v_exp_f32 v123, v123
    v_exp_f32 v140, v140
    v_exp_f32 v124, v124
    v_exp_f32 v141, v141
    v_exp_f32 v125, v125
    v_exp_f32 v142, v142
    v_exp_f32 v126, v126
    v_exp_f32 v143, v143
    v_exp_f32 v127, v127
    v_pk_add_f32 v[8:9], v[128:129], v[130:131]
    v_pk_add_f32 v[10:11], v[112:113], v[114:115]
    v_pk_add_f32 v[8:9], v[8:9], v[132:133]
    v_pk_add_f32 v[10:11], v[10:11], v[116:117]
    v_pk_add_f32 v[8:9], v[8:9], v[134:135]
    v_pk_add_f32 v[10:11], v[10:11], v[118:119]
    v_pk_add_f32 v[8:9], v[8:9], v[136:137]
    v_pk_add_f32 v[10:11], v[10:11], v[120:121]
    v_pk_add_f32 v[8:9], v[8:9], v[138:139]
    v_pk_add_f32 v[10:11], v[10:11], v[122:123]
    v_pk_add_f32 v[8:9], v[8:9], v[140:141]
    v_pk_add_f32 v[10:11], v[10:11], v[124:125]
    v_pk_add_f32 v[8:9], v[8:9], v[142:143]
    v_pk_add_f32 v[10:11], v[10:11], v[126:127]
    v_add_f32 v6, v8, v9
    v_add_f32 v7, v10, v11
    v_add_f32 v4, v8, v9
    v_add_f32 v5, v10, v11
    s_nop 0
    v_permlane32_swap_b32 v4, v6
    v_permlane32_swap_b32 v5, v7
    v_pk_add_f32 v[4:5], v[4:5], v[6:7]
    v_rcp_f32 v4, v4
    v_rcp_f32 v5, v5
    s_nop 0
    v_pk_mul_f32 v[128:129], v[128:129], v[4:5] op_sel_hi:[1,0]
    v_pk_mul_f32 v[112:113], v[112:113], v[4:5] op_sel:[0,1]
    v_pk_mul_f32 v[130:131], v[130:131], v[4:5] op_sel_hi:[1,0]
    v_pk_mul_f32 v[114:115], v[114:115], v[4:5] op_sel:[0,1]
    v_pk_mul_f32 v[132:133], v[132:133], v[4:5] op_sel_hi:[1,0]
    v_pk_mul_f32 v[116:117], v[116:117], v[4:5] op_sel:[0,1]
    v_pk_mul_f32 v[134:135], v[134:135], v[4:5] op_sel_hi:[1,0]
    v_pk_mul_f32 v[118:119], v[118:119], v[4:5] op_sel:[0,1]
    v_pk_mul_f32 v[136:137], v[136:137], v[4:5] op_sel_hi:[1,0]
    v_pk_mul_f32 v[120:121], v[120:121], v[4:5] op_sel:[0,1]
    v_pk_mul_f32 v[138:139], v[138:139], v[4:5] op_sel_hi:[1,0]
    v_pk_mul_f32 v[122:123], v[122:123], v[4:5] op_sel:[0,1]
    v_pk_mul_f32 v[140:141], v[140:141], v[4:5] op_sel_hi:[1,0]
    v_pk_mul_f32 v[124:125], v[124:125], v[4:5] op_sel:[0,1]
    v_pk_mul_f32 v[142:143], v[142:143], v[4:5] op_sel_hi:[1,0]
    v_pk_mul_f32 v[126:127], v[126:127], v[4:5] op_sel:[0,1]
    v_cvt_pk_bf16_f32 v80, v128, v129
    v_cvt_pk_bf16_f32 v88, v112, v113
    v_cvt_pk_bf16_f32 v81, v130, v131
    v_cvt_pk_bf16_f32 v89, v114, v115
    v_cvt_pk_bf16_f32 v82, v132, v133
    v_cvt_pk_bf16_f32 v90, v116, v117
    v_cvt_pk_bf16_f32 v83, v134, v135
    v_cvt_pk_bf16_f32 v91, v118, v119
    v_cvt_pk_bf16_f32 v84, v136, v137
    v_cvt_pk_bf16_f32 v92, v120, v121
    v_cvt_pk_bf16_f32 v85, v138, v139
    v_cvt_pk_bf16_f32 v93, v122, v123
    v_cvt_pk_bf16_f32 v86, v140, v141
    v_cvt_pk_bf16_f32 v94, v124, v125
    v_cvt_pk_bf16_f32 v87, v142, v143
    v_cvt_pk_bf16_f32 v95, v126, v127
    ds_write_b128 v75, v[80:83]
    ds_write_b128 v75, v[84:87] offset:4096
    ds_write_b128 v75, v[88:91] offset:8192
    ds_write_b128 v75, v[92:95] offset:12288
    s_lshl_b32 s13, s3, 12
    v_add_u32 v20, s13, v63
    s_lshl_b32 s96, s76, 13
    s_add_u32 s13, s96, 32768
    v_add_u32 v21, s13, v63
    v_mov_b32 v36, 0x3f803f80
    v_mov_b32 v37, 0x3f803f80
    v_mov_b32 v38, 0x3f803f80
    v_mov_b32 v39, 0x3f803f80
    s_lshl3_add_u32 s96, s11, s3
    s_lshl_b32 s97, s96, 5
    s_add_u32 s98, s97, s10
    s_lshl_b32 s99, s98, 10
    s_add_u32 s13, s99, 25165824
    s_add_u32 s15, s13, 16384
    s_lshl3_add_u32 s96, s11, s3
    s_lshl_b32 s97, s96, 10
    s_add_u32 s16, s97, 21495808
    s_lshl_b32 s96, s10, 6
    s_add_u32 s14, s96, s16
    s_waitcnt lgkmcnt(0)
    s_barrier
    ds_read_b64_tr_b16 v[128:129], v20
    ds_read_b64_tr_b16 v[130:131], v20 offset:512
    ds_read_b64_tr_b16 v[144:145], v21
    ds_read_b64_tr_b16 v[146:147], v21 offset:512
    ds_read_b64_tr_b16 v[148:149], v21 offset:4096
    ds_read_b64_tr_b16 v[150:151], v21 offset:4608
    ds_read_b64_tr_b16 v[132:133], v20 offset:1024
    ds_read_b64_tr_b16 v[134:135], v20 offset:1536
    ds_read_b64_tr_b16 v[152:153], v21 offset:1024
    ds_read_b64_tr_b16 v[154:155], v21 offset:1536
    ds_read_b64_tr_b16 v[156:157], v21 offset:5120
    ds_read_b64_tr_b16 v[158:159], v21 offset:5632
    ds_read_b64_tr_b16 v[136:137], v20 offset:2048
    ds_read_b64_tr_b16 v[138:139], v20 offset:2560
    ds_read_b64_tr_b16 v[160:161], v21 offset:2048
    ds_read_b64_tr_b16 v[162:163], v21 offset:2560
    ds_read_b64_tr_b16 v[164:165], v21 offset:6144
    ds_read_b64_tr_b16 v[166:167], v21 offset:6656
    s_waitcnt lgkmcnt(12)
    v_mfma_f32_16x16x32_bf16 v[52:55], v[128:131], v[144:147], 0
    v_mfma_f32_16x16x32_bf16 v[56:59], v[128:131], v[148:151], 0
    v_mfma_f32_16x16x32_bf16 v[40:43], v[128:131], v[36:39], 0
    ds_read_b64_tr_b16 v[140:141], v20 offset:3072
    ds_read_b64_tr_b16 v[142:143], v20 offset:3584
    ds_read_b64_tr_b16 v[168:169], v21 offset:3072
    ds_read_b64_tr_b16 v[170:171], v21 offset:3584
    ds_read_b64_tr_b16 v[172:173], v21 offset:7168
    ds_read_b64_tr_b16 v[174:175], v21 offset:7680
    s_waitcnt lgkmcnt(12)
    v_mfma_f32_16x16x32_bf16 v[52:55], v[132:135], v[152:155], v[52:55]
    v_mfma_f32_16x16x32_bf16 v[56:59], v[132:135], v[156:159], v[56:59]
    v_mfma_f32_16x16x32_bf16 v[40:43], v[132:135], v[36:39], v[40:43]
    v_and_b32 v75, 15, v1
    v_lshlrev_b32 v75, 15, v75
    s_and_b32 s96, s10, 1
    s_and_b32 s97, s2, 135
    s_lshl_b32 s98, s97, 12
    s_lshr_b32 s99, s10, 1
    s_lshl_b32 s97, s99, 6
    s_add_u32 s99, s98, s97
    s_lshl2_add_u32 s98, s96, s99
    s_add_u32 s97, s98, 1048576
    s_add_u32 s17, s97, 512
    s_waitcnt lgkmcnt(6)
    v_mfma_f32_16x16x32_bf16 v[52:55], v[136:139], v[160:163], v[52:55]
    v_mfma_f32_16x16x32_bf16 v[56:59], v[136:139], v[164:167], v[56:59]
    v_mfma_f32_16x16x32_bf16 v[40:43], v[136:139], v[36:39], v[40:43]
    s_waitcnt lgkmcnt(0)
    v_mfma_f32_16x16x32_bf16 v[52:55], v[140:143], v[168:171], v[52:55]
    v_mfma_f32_16x16x32_bf16 v[56:59], v[140:143], v[172:175], v[56:59]
    v_mfma_f32_16x16x32_bf16 v[40:43], v[140:143], v[36:39], v[40:43]
    s_cmp_lt_u32 s3, 4
    s_cbranch_scc1 L_NOQX
    ds_read_b128 v[44:47], v76 offset:2048
    ds_read_b128 v[48:51], v76 offset:3072
L_NOQX:
    s_nop 3
    buffer_store_dwordx4 v[52:55], v2, s[32:35], s13 offen sc1
    buffer_store_dwordx4 v[56:59], v2, s[32:35], s15 offen sc1
    v_lshlrev_b32 v4, 6, v1
    ds_bpermute_b32 v40, v4, v40
    ds_bpermute_b32 v41, v4, v41
    ds_bpermute_b32 v42, v4, v42
    ds_bpermute_b32 v43, v4, v43
    s_waitcnt lgkmcnt(0)
    s_mov_b64 exec, 15
    buffer_store_dwordx4 v[40:43], v2, s[32:35], s14 offen sc1
    s_mov_b64 exec, -1
    s_waitcnt lgkmcnt(0)
    v_mfma_f32_32x32x16_bf16 v[112:127], v[28:31], v[44:47], 0
    v_mfma_f32_32x32x16_bf16 v[112:127], v[32:35], v[48:51], v[112:127]
    v_lshrrev_b32 v22, 3, v1
    v_lshlrev_b32 v22, 10, v22
    v_and_b32 v9, 7, v1
    v_lshl_add_u32 v22, v9, 4, v22
    s_nop 7
    v_cvt_pk_bf16_f32 v112, 0, v112
    v_cvt_pk_bf16_f32 v113, 0, v113
    v_cvt_pk_bf16_f32 v114, 0, v114
    v_cvt_pk_bf16_f32 v115, 0, v115
    v_cvt_pk_bf16_f32 v116, 0, v116
    v_cvt_pk_bf16_f32 v117, 0, v117
    v_cvt_pk_bf16_f32 v118, 0, v118
    v_cvt_pk_bf16_f32 v119, 0, v119
    v_cvt_pk_bf16_f32 v120, 0, v120
    v_cvt_pk_bf16_f32 v121, 0, v121
    v_cvt_pk_bf16_f32 v122, 0, v122
    v_cvt_pk_bf16_f32 v123, 0, v123
    v_cvt_pk_bf16_f32 v124, 0, v124
    v_cvt_pk_bf16_f32 v125, 0, v125
    v_cvt_pk_bf16_f32 v126, 0, v126
    v_cvt_pk_bf16_f32 v127, 0, v127
    v_max3_f32 v52, v112, v113, v114
    v_min3_f32 v53, v112, v113, v114
    v_max3_f32 v52, v52, v115, v116
    v_min3_f32 v53, v53, v115, v116
    v_max3_f32 v52, v52, v117, v118
    v_min3_f32 v53, v53, v117, v118
    v_max3_f32 v52, v52, v119, v120
    v_min3_f32 v53, v53, v119, v120
    v_max3_f32 v52, v52, v121, v122
    v_min3_f32 v53, v53, v121, v122
    v_max3_f32 v52, v52, v123, v124
    v_min3_f32 v53, v53, v123, v124
    v_max3_f32 v52, v52, v125, v126
    v_min3_f32 v53, v53, v125, v126
    v_max_f32 v54, v52, v127
    v_min_f32 v55, v53, v127
    v_max_f32 v52, v52, v127
    v_min_f32 v53, v53, v127
    s_nop 0
    v_permlane32_swap_b32 v52, v54
    v_permlane32_swap_b32 v53, v55
    v_max_f32 v52, v52, v54
    v_min_f32 v53, v53, v55
    v_pk_mul_f32 v[52:53], v[52:53], s[6:7] op_sel:[0,1]
    v_pk_fma_f32 v[128:129], v[112:113], s[6:7], v[52:53] op_sel:[0,1,0] op_sel_hi:[1,1,0] neg_lo:[0,0,1] neg_hi:[0,0,1]
    v_pk_fma_f32 v[112:113], v[112:113], s[6:7], v[52:53] op_sel:[0,1,1] neg_lo:[1,0,0] neg_hi:[1,0,0]
    v_pk_fma_f32 v[130:131], v[114:115], s[6:7], v[52:53] op_sel:[0,1,0] op_sel_hi:[1,1,0] neg_lo:[0,0,1] neg_hi:[0,0,1]
    v_pk_fma_f32 v[114:115], v[114:115], s[6:7], v[52:53] op_sel:[0,1,1] neg_lo:[1,0,0] neg_hi:[1,0,0]
    v_pk_fma_f32 v[132:133], v[116:117], s[6:7], v[52:53] op_sel:[0,1,0] op_sel_hi:[1,1,0] neg_lo:[0,0,1] neg_hi:[0,0,1]
    v_pk_fma_f32 v[116:117], v[116:117], s[6:7], v[52:53] op_sel:[0,1,1] neg_lo:[1,0,0] neg_hi:[1,0,0]
    v_pk_fma_f32 v[134:135], v[118:119], s[6:7], v[52:53] op_sel:[0,1,0] op_sel_hi:[1,1,0] neg_lo:[0,0,1] neg_hi:[0,0,1]
    v_pk_fma_f32 v[118:119], v[118:119], s[6:7], v[52:53] op_sel:[0,1,1] neg_lo:[1,0,0] neg_hi:[1,0,0]
    v_pk_fma_f32 v[136:137], v[120:121], s[6:7], v[52:53] op_sel:[0,1,0] op_sel_hi:[1,1,0] neg_lo:[0,0,1] neg_hi:[0,0,1]
    v_pk_fma_f32 v[120:121], v[120:121], s[6:7], v[52:53] op_sel:[0,1,1] neg_lo:[1,0,0] neg_hi:[1,0,0]
    v_pk_fma_f32 v[138:139], v[122:123], s[6:7], v[52:53] op_sel:[0,1,0] op_sel_hi:[1,1,0] neg_lo:[0,0,1] neg_hi:[0,0,1]
    v_pk_fma_f32 v[122:123], v[122:123], s[6:7], v[52:53] op_sel:[0,1,1] neg_lo:[1,0,0] neg_hi:[1,0,0]
    v_pk_fma_f32 v[140:141], v[124:125], s[6:7], v[52:53] op_sel:[0,1,0] op_sel_hi:[1,1,0] neg_lo:[0,0,1] neg_hi:[0,0,1]
    v_pk_fma_f32 v[124:125], v[124:125], s[6:7], v[52:53] op_sel:[0,1,1] neg_lo:[1,0,0] neg_hi:[1,0,0]
    v_pk_fma_f32 v[142:143], v[126:127], s[6:7], v[52:53] op_sel:[0,1,0] op_sel_hi:[1,1,0] neg_lo:[0,0,1] neg_hi:[0,0,1]
    v_pk_fma_f32 v[126:127], v[126:127], s[6:7], v[52:53] op_sel:[0,1,1] neg_lo:[1,0,0] neg_hi:[1,0,0]
    v_exp_f32 v128, v128
    v_exp_f32 v112, v112
    v_exp_f32 v129, v129
    s_lshl_b32 s96, s11, 7
    s_add_u32 s18, s96, 32768
    s_lshl3_add_u32 s14, s10, s18
    v_and_b32 v23, 15, v1
    v_lshlrev_b32 v23, 3, v23
    s_waitcnt vmcnt(0)
    s_barrier
    s_cmp_lg_u32 s3, 0
    s_cbranch_scc1 L_PC
    v_mov_b32 v21, s4
    s_mov_b32 exec_hi, 0
    s_mov_b32 exec_lo, 65535
    buffer_store_dword v21, v75, s[32:35], s17 offen sc1
    s_mov_b64 exec, -1
L_PC:
    s_cmp_lt_u32 s3, 4
    s_cbranch_scc1 L_NOM
    v_and_b32 v105, 31, v1
    v_lshlrev_b32 v105, 4, v105
    v_lshrrev_b32 v9, 5, v1
    v_lshl_add_u32 v105, v9, 9, v105
    s_and_b32 s96, s3, 3
    s_lshl4_add_u32 s97, s96, s12
    s_lshl_b32 s98, s97, 11
    s_add_u32 s20, s98, 131072
    buffer_load_dwordx4 v[96:99], v105, s[32:35], s20 offen sc1
    buffer_load_dwordx4 v[100:103], v105, s[32:35], s20 offen offset:1024 sc1
L_NOM:
    s_lshl4_add_u32 s96, s11, s10
    s_lshl_b32 s97, s96, 14
    s_lshl_b32 s98, s3, 7
    s_add_u32 s99, s97, s98
    s_add_u32 s13, s99, 25165824
    s_lshl4_add_u32 s96, s11, s10
    s_lshl_b32 s97, s96, 10
    s_lshl_b32 s98, s3, 7
    s_add_u32 s99, s97, s98
    s_add_u32 s15, s99, 29360128
    s_add_u32 s17, s17, 3072
    s_load_dwordx2 s[24:25], s[32:33], s92 offset:512 glc
    s_add_u32 s96, s84, 262144
    s_and_b32 s97, s96, 1048575
    s_lshl_b32 s98, s83, 16
    s_xor_b32 s99, s97, s98
    s_add_u32 s19, s99, s88
    s_add_u32 m0, s89, 49152
    s_nop 0
    buffer_load_dwordx4 v74, s[44:47], s19 offen lds
    v_exp_f32 v113, v113
    v_exp_f32 v130, v130
    v_exp_f32 v114, v114
    v_exp_f32 v131, v131
    v_exp_f32 v115, v115
    v_exp_f32 v132, v132
    v_exp_f32 v116, v116
    v_exp_f32 v133, v133
    v_exp_f32 v117, v117
    v_exp_f32 v134, v134
    s_add_u32 s96, s84, 393216
    s_and_b32 s97, s96, 1048575
    s_lshl_b32 s98, s83, 16
    s_xor_b32 s99, s97, s98
    s_add_u32 s19, s99, s88
    s_add_u32 m0, s89, 57344
    s_nop 0
    buffer_load_dwordx4 v74, s[44:47], s19 offen lds
    v_exp_f32 v118, v118
    v_exp_f32 v135, v135
    v_exp_f32 v119, v119
    v_exp_f32 v136, v136
    v_exp_f32 v120, v120
    v_exp_f32 v137, v137
    v_exp_f32 v121, v121
    v_exp_f32 v138, v138
    v_exp_f32 v122, v122
    s_add_u32 s96, s84, 524288
    s_and_b32 s97, s96, 1048575
    s_lshl_b32 s98, s83, 16
    s_xor_b32 s99, s97, s98
    s_add_u32 s19, s99, s88
    s_add_u32 m0, s89, 65536
    s_nop 0
    buffer_load_dwordx4 v74, s[44:47], s19 offen lds
    v_exp_f32 v139, v139
    v_exp_f32 v123, v123
    v_exp_f32 v140, v140
    v_exp_f32 v124, v124
    v_exp_f32 v141, v141
    v_exp_f32 v125, v125
    v_exp_f32 v142, v142
    v_exp_f32 v126, v126
    v_exp_f32 v143, v143
    v_exp_f32 v127, v127
    s_add_u32 s96, s84, 655360
    s_and_b32 s97, s96, 1048575
    s_lshl_b32 s98, s83, 16
    s_xor_b32 s99, s97, s98
    s_add_u32 s19, s99, s88
    s_add_u32 m0, s89, 73728
    s_nop 0
    buffer_load_dwordx4 v74, s[44:47], s19 offen lds
    v_pk_add_f32 v[56:57], v[128:129], v[130:131]
    v_pk_add_f32 v[58:59], v[112:113], v[114:115]
    v_pk_add_f32 v[56:57], v[56:57], v[132:133]
    v_pk_add_f32 v[58:59], v[58:59], v[116:117]
    v_pk_add_f32 v[56:57], v[56:57], v[134:135]
    v_pk_add_f32 v[58:59], v[58:59], v[118:119]
    v_pk_add_f32 v[56:57], v[56:57], v[136:137]
    v_pk_add_f32 v[58:59], v[58:59], v[120:121]
    v_pk_add_f32 v[56:57], v[56:57], v[138:139]
    s_add_u32 s96, s84, 786432
    s_and_b32 s97, s96, 1048575
    s_lshl_b32 s98, s83, 16
    s_xor_b32 s99, s97, s98
    s_add_u32 s19, s99, s88
    s_add_u32 m0, s89, 81920
    s_nop 0
    buffer_load_dwordx4 v74, s[44:47], s19 offen lds
    v_pk_add_f32 v[58:59], v[58:59], v[122:123]
    v_pk_add_f32 v[56:57], v[56:57], v[140:141]
    v_pk_add_f32 v[58:59], v[58:59], v[124:125]
    v_pk_add_f32 v[56:57], v[56:57], v[142:143]
    v_pk_add_f32 v[58:59], v[58:59], v[126:127]
    v_add_f32 v54, v56, v57
    v_add_f32 v55, v58, v59
    v_add_f32 v52, v56, v57
    v_add_f32 v53, v58, v59
    s_nop 0
    v_permlane32_swap_b32 v52, v54
    s_add_u32 s96, s84, 917504
    s_and_b32 s97, s96, 1048575
    s_lshl_b32 s98, s83, 16
    s_xor_b32 s99, s97, s98
    s_add_u32 s19, s99, s88
    s_add_u32 m0, s89, 90112
    s_nop 0
    buffer_load_dwordx4 v74, s[44:47], s19 offen lds
    v_permlane32_swap_b32 v53, v55
    v_pk_add_f32 v[52:53], v[52:53], v[54:55]
    v_rcp_f32 v52, v52
    v_rcp_f32 v53, v53
    s_nop 0
    v_pk_mul_f32 v[128:129], v[128:129], v[52:53] op_sel_hi:[1,0]
    v_pk_mul_f32 v[112:113], v[112:113], v[52:53] op_sel:[0,1]
    v_pk_mul_f32 v[130:131], v[130:131], v[52:53] op_sel_hi:[1,0]
    v_pk_mul_f32 v[114:115], v[114:115], v[52:53] op_sel:[0,1]
    v_pk_mul_f32 v[132:133], v[132:133], v[52:53] op_sel_hi:[1,0]
    s_cmp_lt_u32 s3, 4
    s_cbranch_scc1 L_NOG
    s_waitcnt vmcnt(6)
    v_bitop3_b32 v4, v97, v99, s4 bitop3:0x7e
    v_bitop3_b32 v4, v4, v101, s4 bitop3:0xf6
    v_bitop3_b32 v4, v4, v103, s4 bitop3:0xf6
    v_cmp_ne_u32 vcc, 0, v4
    s_cbranch_vccz TOK_17
POLL_18:
    buffer_load_dwordx4 v[96:99], v105, s[32:35], s20 offen sc1
    buffer_load_dwordx4 v[100:103], v105, s[32:35], s20 offen offset:1024 sc1
    s_waitcnt vmcnt(0)
    v_bitop3_b32 v4, v97, v99, s4 bitop3:0x7e
    v_bitop3_b32 v4, v4, v101, s4 bitop3:0xf6
    v_bitop3_b32 v4, v4, v103, s4 bitop3:0xf6
    v_cmp_ne_u32 vcc, 0, v4
    s_cbranch_vccz PDONE_19
    s_add_u32 s5, s5, 1
    s_cmp_lt_u32 s5, 300000
    s_cbranch_scc1 POLL_18
PDONE_19:
TOK_17:
    s_and_b32 s96, s3, 3
    s_lshl_b32 s97, s96, 7
    s_add_u32 s14, s97, 12288
    v_and_b32 v4, 31, v1
    v_lshl_add_u32 v4, v4, 2, s14
    s_and_b32 s82, s3, 3
    v_add_f32 v96, v96, v100
    v_add_f32 v97, v98, v102
    v_mov_b32 v98, v96
    v_mov_b32 v99, v97
    s_cmp_eq_u32 s82, 2
    s_cselect_b32 s91, 1.0, 0
    v_permlane32_swap_b32 v96, v98
    v_permlane32_swap_b32 v97, v99
    v_pk_add_f32 v[96:97], v[96:97], v[98:99]
    v_cvt_pk_bf16_f32 v96, 0, v96
    v_cvt_pk_bf16_f32 v97, 0, v97
    v_add_f32 v96, s91, v96
    v_add_f32 v97, s91, v97
    v_cvt_pk_bf16_f32 v98, v96, v97
    ds_write_b32 v4, v98
    s_cbranch_scc0 L_NOG
    v_lshlrev_b32 v96, 16, v98
    v_and_b32 v97, s6, v98
    v_lshlrev_b32 v100, 16, v104
    v_and_b32 v101, s6, v104
    v_pk_mul_f32 v[100:101], v[100:101], v[96:97]
    v_cvt_pk_bf16_f32 v102, v100, v101
    v_lshlrev_b32 v96, 16, v102
    v_and_b32 v97, s6, v102
    v_pk_add_f32 v[96:97], v[100:101], v[96:97] neg_lo:[0,1] neg_hi:[0,1]
    v_cvt_pk_bf16_f32 v103, v96, v97
    v_add_f32 v96, v100, v101
    ds_write2_b32 v4, v102, v103 offset0:64 offset1:96
    ds_write_b32 v4, v104 offset:512
    v_add_f32_dpp v96, v96, v96 quad_perm:[1,0,3,2] row_mask:0xf bank_mask:0xf
    s_nop 1
    v_add_f32_dpp v96, v96, v96 quad_perm:[2,3,0,1] row_mask:0xf bank_mask:0xf
    s_nop 1
    v_add_f32_dpp v96, v96, v96 row_half_mirror row_mask:0xf bank_mask:0xf
    s_nop 1
    v_add_f32_dpp v96, v96, v96 row_ror:8 row_mask:0xf bank_mask:0xf
    s_lshl4_add_u32 s96, s21, s12
    s_lshl_b32 s97, s96, 6
    s_add_u32 s14, s97, 65536
    v_mov_b32 v98, v96
    v_mov_b32 v97, s4
    s_nop 0
    v_permlane16_swap_b32 v96, v98
    v_add_f32 v96, v96, v98
    v_mov_b32 v99, s4
    s_mov_b64 exec, 15
    buffer_store_dwordx4 v[96:99], v2, s[32:35], s14 offen sc1
    s_mov_b64 exec, -1
L_NOG:
    s_branch SCHK_15
SPOLL_14:
    s_load_dwordx2 s[24:25], s[32:33], s92 offset:512 glc
SCHK_15:
    s_add_u32 s5, s5, 1
    s_cmp_ge_u32 s5, 300000
    s_waitcnt lgkmcnt(0)
    s_cbranch_scc1 SDONE_16
    s_cmp_lg_u32 s24, s4
    s_cbranch_scc1 SPOLL_14
    s_cmp_lg_u32 s25, s4
    s_cbranch_scc1 SPOLL_14
SDONE_16:
    s_barrier
    s_add_u32 s18, s13, 8192
    buffer_load_dword v24, v3, s[32:35], 0 offen offset:256 sc1
    buffer_load_dwordx4 v[144:147], v22, s[32:35], s13 offen sc1
    buffer_load_dwordx4 v[148:151], v22, s[32:35], s18 offen sc1
    buffer_load_dwordx4 v[160:163], v2, s[32:35], s16 offen sc1
    s_lshl_b32 s96, s3, 5
    s_add_u32 s14, s96, 8192
    v_and_b32 v6, 3, v1
    v_lshl_add_u32 v6, v6, 3, s14
    v_lshrrev_b32 v9, 5, v1
    v_lshl_add_u32 v6, v9, 2, v6
    s_lshl_b32 s14, s3, 10
    v_and_b32 v5, 15, v1
    v_lshl_add_u32 v5, v5, 4, s14
    v_lshrrev_b32 v9, 5, v1
    v_lshl_add_u32 v5, v9, 9, v5
    v_bfe_u32 v9, v1, 4, 1
    v_lshl_add_u32 v5, v9, 3, v5
    s_lshl_b32 s96, s76, 7
    s_add_u32 s14, s96, 8192
    v_lshrrev_b32 v7, 5, v1
    v_lshl_add_u32 v7, v7, 4, s14
    s_lshl_b32 s14, s76, 12
    v_add_u32 v20, s14, v2
    v_pk_mul_f32 v[116:117], v[116:117], v[52:53] op_sel:[0,1]
    v_pk_mul_f32 v[134:135], v[134:135], v[52:53] op_sel_hi:[1,0]
    v_pk_mul_f32 v[118:119], v[118:119], v[52:53] op_sel:[0,1]
    v_pk_mul_f32 v[136:137], v[136:137], v[52:53] op_sel_hi:[1,0]
    v_pk_mul_f32 v[120:121], v[120:121], v[52:53] op_sel:[0,1]
    v_pk_mul_f32 v[138:139], v[138:139], v[52:53] op_sel_hi:[1,0]
    v_pk_mul_f32 v[122:123], v[122:123], v[52:53] op_sel:[0,1]
    v_pk_mul_f32 v[140:141], v[140:141], v[52:53] op_sel_hi:[1,0]
    v_pk_mul_f32 v[124:125], v[124:125], v[52:53] op_sel:[0,1]
    v_pk_mul_f32 v[142:143], v[142:143], v[52:53] op_sel_hi:[1,0]
    v_pk_mul_f32 v[126:127], v[126:127], v[52:53] op_sel:[0,1]
    v_cvt_pk_bf16_f32 v80, v128, v129
    v_cvt_pk_bf16_f32 v88, v112, v113
    v_cvt_pk_bf16_f32 v81, v130, v131
    v_cvt_pk_bf16_f32 v89, v114, v115
    v_cvt_pk_bf16_f32 v82, v132, v133
    v_cvt_pk_bf16_f32 v90, v116, v117
    v_cvt_pk_bf16_f32 v83, v134, v135
    v_cvt_pk_bf16_f32 v91, v118, v119
    v_cvt_pk_bf16_f32 v84, v136, v137
    v_cvt_pk_bf16_f32 v92, v120, v121
    v_cvt_pk_bf16_f32 v85, v138, v139
    v_cvt_pk_bf16_f32 v93, v122, v123
    v_cvt_pk_bf16_f32 v86, v140, v141
    v_cvt_pk_bf16_f32 v94, v124, v125
    v_cvt_pk_bf16_f32 v87, v142, v143
    v_cvt_pk_bf16_f32 v95, v126, v127
    s_waitcnt vmcnt(1)
    v_cmp_eq_u32 vcc, s4, v24
    s_nop 0
    s_cmp_eq_u32 vcc_lo, 0
    s_cselect_b32 s93, 1, 0
    v_pk_add_f32 v[144:145], v[144:145], v[148:149]
    v_pk_add_f32 v[146:147], v[146:147], v[150:151]
    s_nop 1
    v_permlane32_swap_b32 v144, v146
    v_permlane32_swap_b32 v145, v147
    v_pk_add_f32 v[144:145], v[144:145], v[146:147]
    s_nop 1
    v_add_f32_dpp v144, v144, v144 row_ror:8 row_mask:0xf bank_mask:0xf
    v_add_f32_dpp v145, v145, v145 row_ror:8 row_mask:0xf bank_mask:0xf
    v_mov_b32 v146, v144
    v_mov_b32 v147, v145
    s_nop 0
    v_permlane16_swap_b32 v144, v146
    v_permlane16_swap_b32 v145, v147
    v_pk_add_f32 v[144:145], v[144:145], v[146:147]
    v_cvt_pk_bf16_f32 v144, v144, v145
    v_mov_b32 v224, v144
    v_mov_b32 v226, v144
    v_mov_b32 v225, s4
    v_mov_b32 v227, s4
    v_permlane32_swap_b32 v224, v226
    v_add_u32 v228, s15, v2
    s_mov_b64 exec, 0xff
    s_cmp_lg_u32 s93, 0
    s_cbranch_scc1 LOC_20
    buffer_store_dwordx4 v[224:227], v2, s[32:35], s15 offen sc1
    s_branch LOCD_21
LOC_20:
    buffer_store_dwordx4 v[224:227], v2, s[32:35], s15 offen
LOCD_21:
    s_mov_b64 exec, -1
    s_cbranch_scc1 L_PC2
    s_barrier
    s_cmp_lg_u32 s3, 0
    s_cbranch_scc1 L_PC2
    v_mov_b32 v21, s4
    s_mov_b32 exec_hi, 0
    s_mov_b32 exec_lo, 65535
    buffer_store_dword v21, v75, s[32:35], s17 offen sc1
    s_mov_b64 exec, -1
L_PC2:
    s_lshl3_add_u32 s96, s11, s3
    s_lshl_b32 s97, s96, 11
    s_add_u32 s13, s97, 29360128
    s_waitcnt vmcnt(0)
    v_permlane32_swap_b32 v160, v162
    v_permlane32_swap_b32 v161, v163
    v_pk_add_f32 v[160:161], v[160:161], v[162:163]
    s_nop 1
    v_add_f32_dpp v160, v160, v160 row_ror:4 row_mask:0xf bank_mask:0xf
    v_add_f32_dpp v161, v161, v161 row_ror:4 row_mask:0xf bank_mask:0xf
    s_nop 0
    v_add_f32_dpp v160, v160, v160 row_ror:8 row_mask:0xf bank_mask:0xf
    v_add_f32_dpp v161, v161, v161 row_ror:8 row_mask:0xf bank_mask:0xf
    v_mov_b32 v162, v160
    v_mov_b32 v163, v161
    s_nop 0
    v_permlane16_swap_b32 v160, v162
    v_permlane16_swap_b32 v161, v163
    v_pk_add_f32 v[160:161], v[160:161], v[162:163]
    v_cvt_pk_bf16_f32 v160, v160, v161
    ds_write_b32 v6, v160
    s_cmp_lg_u32 s93, 0
    s_cbranch_scc1 L_C2L
SPOLL_22:
    s_load_dwordx2 s[24:25], s[32:33], s92 offset:3584 glc
SCHK_23:
    s_add_u32 s5, s5, 1
    s_cmp_ge_u32 s5, 300000
    s_waitcnt lgkmcnt(0)
    s_cbranch_scc1 SDONE_24
    s_cmp_lg_u32 s24, s4
    s_cbranch_scc1 SPOLL_22
    s_cmp_lg_u32 s25, s4
    s_cbranch_scc1 SPOLL_22
SDONE_24:
L_C2L:
    buffer_load_dwordx4 v[152:155], v2, s[32:35], s13 offen sc1
    buffer_load_dwordx4 v[156:159], v2, s[32:35], s13 offen offset:1024 sc1
    s_waitcnt vmcnt(0)
    v_bitop3_b32 v4, v153, v155, s4 bitop3:0x7e
    v_bitop3_b32 v4, v4, v157, s4 bitop3:0xf6
    v_bitop3_b32 v4, v4, v159, s4 bitop3:0xf6
    v_cmp_ne_u32 vcc, 0, v4
    s_cbranch_vccz TOK_26
POLL_27:
    buffer_load_dwordx4 v[152:155], v2, s[32:35], s13 offen sc1
    buffer_load_dwordx4 v[156:159], v2, s[32:35], s13 offen offset:1024 sc1
    s_waitcnt vmcnt(0)
    v_bitop3_b32 v4, v153, v155, s4 bitop3:0x7e
    v_bitop3_b32 v4, v4, v157, s4 bitop3:0xf6
    v_bitop3_b32 v4, v4, v159, s4 bitop3:0xf6
    v_cmp_ne_u32 vcc, 0, v4
    s_cbranch_vccz PDONE_28
    s_add_u32 s5, s5, 1
    s_cmp_lt_u32 s5, 300000
    s_cbranch_scc1 POLL_27
PDONE_28:
TOK_26:
    ds_write2_b32 v5, v152, v154 offset0:0 offset1:1
    ds_write2_b32 v5, v156, v158 offset0:64 offset1:65
    s_waitcnt lgkmcnt(0)
    s_barrier
    ds_read_b128 v[160:163], v7
    ds_read_b128 v[164:167], v7 offset:32
    ds_read_b128 v[168:171], v7 offset:64
    ds_read_b128 v[172:175], v7 offset:96
    ds_read_b128 v[144:147], v20
    ds_read_b128 v[148:151], v20 offset:1024
    ds_read_b128 v[152:155], v20 offset:2048
    ds_read_b128 v[156:159], v20 offset:3072
    s_lshl_b32 s96, s76, 6
    s_add_u32 s18, s96, 12288
    v_and_b32 v67, 7, v1
    v_lshl_add_u32 v67, v67, 2, s18
    v_lshrrev_b32 v9, 5, v1
    v_lshl_add_u32 v67, v9, 5, v67
    ds_read_b32 v64, v67
    ds_read_b32 v65, v67 offset:512
    ds_read_b32 v66, v67 offset:640
    ds_read_b32 v68, v67 offset:128
    ds_read_b32 v69, v67 offset:256
    ds_read_b32 v70, v67 offset:384
    ds_read_b32 v71, v67 offset:768
    s_add_u32 s96, s84, 1048576
    s_and_b32 s97, s96, 1048575
    s_lshl_b32 s98, s83, 16
    s_xor_b32 s99, s97, s98
    s_xor_b32 s96, s88, 1048576
    s_add_u32 s19, s99, s96
    s_add_u32 m0, s89, 98304
    s_nop 0
    buffer_load_dwordx4 v74, s[44:47], s19 offen lds
    s_add_u32 s96, s84, 1703936
    s_and_b32 s97, s96, 1048575
    s_lshl_b32 s98, s83, 16
    s_xor_b32 s99, s97, s98
    s_xor_b32 s96, s88, 1048576
    s_add_u32 s19, s99, s96
    s_add_u32 m0, s89, 139264
    s_nop 0
    buffer_load_dwordx4 v74, s[44:47], s19 offen lds
    s_add_u32 s96, s84, 1835008
    s_and_b32 s97, s96, 1048575
    s_lshl_b32 s98, s83, 16
    s_xor_b32 s99, s97, s98
    s_xor_b32 s96, s88, 1048576
    s_add_u32 s19, s99, s96
    s_add_u32 m0, s89, 147456
    s_nop 0
    buffer_load_dwordx4 v74, s[44:47], s19 offen lds
    s_and_b32 s96, s3, 3
    s_lshl2_add_u32 s97, s10, s96
    s_lshl4_add_u32 s98, s97, s11
    s_lshl1_add_u32 s99, s98, s76
    s_lshl_b32 s96, s99, 11
    s_add_u32 s13, s96, 8388608
    v_and_b32 v8, 15, v1
    v_lshlrev_b32 v8, 4, v8
    v_bfe_u32 v9, v1, 4, 1
    v_lshl_add_u32 v8, v9, 10, v8
    v_lshrrev_b32 v9, 5, v1
    v_lshl_add_u32 v8, v9, 8, v8
    s_waitcnt lgkmcnt(14)
    v_mfma_f32_32x32x16_bf16 v[128:143], v[160:163], v[80:83], 0
    s_waitcnt lgkmcnt(13)
    v_mfma_f32_32x32x16_bf16 v[128:143], v[164:167], v[84:87], v[128:143]
    s_waitcnt lgkmcnt(12)
    v_mfma_f32_32x32x16_bf16 v[128:143], v[168:171], v[88:91], v[128:143]
    s_waitcnt lgkmcnt(11)
    v_mfma_f32_32x32x16_bf16 v[128:143], v[172:175], v[92:95], v[128:143]
    s_waitcnt lgkmcnt(10)
    v_mfma_f32_32x32x16_bf16 v[112:127], v[144:147], v[80:83], 0
    s_waitcnt lgkmcnt(9)
    v_mfma_f32_32x32x16_bf16 v[112:127], v[148:151], v[84:87], v[112:127]
    s_waitcnt lgkmcnt(8)
    v_mfma_f32_32x32x16_bf16 v[112:127], v[152:155], v[88:91], v[112:127]
    s_waitcnt lgkmcnt(7)
    v_mfma_f32_32x32x16_bf16 v[112:127], v[156:159], v[92:95], v[112:127]
    s_nop 3
    v_cvt_pk_bf16_f32 v128, 0, v128
    v_add_f32 v128, 0x358637bd, v128
    v_cvt_pk_bf16_f32 v128, 0, v128
    v_rcp_f32 v128, v128
    s_nop 3
    v_cvt_pk_bf16_f32 v112, 0, v112
    v_cvt_pk_bf16_f32 v113, 0, v113
    v_cvt_pk_bf16_f32 v114, 0, v114
    v_cvt_pk_bf16_f32 v115, 0, v115
    v_cvt_pk_bf16_f32 v116, 0, v116
    v_cvt_pk_bf16_f32 v117, 0, v117
    v_cvt_pk_bf16_f32 v118, 0, v118
    v_cvt_pk_bf16_f32 v119, 0, v119
    v_pk_mul_f32 v[112:113], v[112:113], v[128:129] op_sel_hi:[1,0]
    v_pk_mul_f32 v[114:115], v[114:115], v[128:129] op_sel_hi:[1,0]
    v_pk_mul_f32 v[116:117], v[116:117], v[128:129] op_sel_hi:[1,0]
    v_pk_mul_f32 v[118:119], v[118:119], v[128:129] op_sel_hi:[1,0]
    v_cvt_pk_bf16_f32 v44, v112, v113
    v_cvt_pk_bf16_f32 v45, v114, v115
    v_cvt_pk_bf16_f32 v46, v116, v117
    v_cvt_pk_bf16_f32 v47, v118, v119
    buffer_store_dwordx4 v[44:47], v8, s[32:35], s13 offen sc1
    v_cvt_pk_bf16_f32 v120, 0, v120
    v_cvt_pk_bf16_f32 v121, 0, v121
    v_cvt_pk_bf16_f32 v122, 0, v122
    v_cvt_pk_bf16_f32 v123, 0, v123
    v_cvt_pk_bf16_f32 v124, 0, v124
    v_cvt_pk_bf16_f32 v125, 0, v125
    v_cvt_pk_bf16_f32 v126, 0, v126
    v_cvt_pk_bf16_f32 v127, 0, v127
    v_pk_mul_f32 v[120:121], v[120:121], v[128:129] op_sel_hi:[1,0]
    v_pk_mul_f32 v[122:123], v[122:123], v[128:129] op_sel_hi:[1,0]
    v_pk_mul_f32 v[124:125], v[124:125], v[128:129] op_sel_hi:[1,0]
    v_pk_mul_f32 v[126:127], v[126:127], v[128:129] op_sel_hi:[1,0]
    v_cvt_pk_bf16_f32 v48, v120, v121
    v_cvt_pk_bf16_f32 v49, v122, v123
    v_cvt_pk_bf16_f32 v50, v124, v125
    v_cvt_pk_bf16_f32 v51, v126, v127
    buffer_store_dwordx4 v[48:51], v8, s[32:35], s13 offen offset:512 sc1
    s_mul_i32 s96, s76, 65600
    s_add_u32 s17, s96, 32768
    v_lshrrev_b32 v20, 5, v1
    v_lshlrev_b32 v20, 11, v20
    v_bfe_u32 v9, v1, 4, 1
    v_lshl_add_u32 v20, v9, 9, v20
    v_bfe_u32 v9, v1, 2, 2
    v_lshl_add_u32 v20, v9, 7, v20
    v_bfe_u32 v9, v1, 3, 1
    v_lshl_add_u32 v20, v9, 6, v20
    v_bfe_u32 v9, v1, 1, 1
    v_lshl_add_u32 v20, v9, 5, v20
    v_bfe_u32 v9, v1, 4, 1
    v_lshl_add_u32 v20, v9, 4, v20
    v_and_b32 v9, 1, v1
    v_lshl_add_u32 v20, v9, 3, v20
    v_xor_b32 v20, s17, v20
    v_xor_b32 v21, 16, v20
    v_xor_b32 v22, 64, v20
    v_xor_b32 v23, 80, v20
    v_and_b32 v5, 7, v1
    v_lshlrev_b32 v5, 15, v5
    v_bfe_u32 v9, v1, 3, 1
    v_lshl_add_u32 v5, v9, 12, v5
    s_lshr_b32 s96, s11, 2
    s_xor_b32 s97, s96, 1
    s_and_b32 s98, s97, 1
    s_lshr_b32 s99, s10, 2
    s_and_b32 s96, s10, 3
    s_lshl_b32 s97, s96, 6
    s_lshl1_add_u32 s96, s99, s97
    s_lshl_b32 s99, s96, 12
    s_lshr_b32 s97, s11, 3
    s_and_b32 s96, s11, 3
    s_lshl2_add_u32 s97, s97, s96
    s_lshl_b32 s96, s97, 6
    s_add_u32 s97, s99, s96
    s_lshl2_add_u32 s99, s98, s97
    s_add_u32 s96, s99, 1048576
    s_add_u32 s15, s96, 1024
    v_mov_b32 v52, 0x10000
    v_mov_b32 v53, s6
    v_lshlrev_b32 v28, 16, v12
    v_and_b32 v29, s6, v12
    v_lshlrev_b32 v30, 16, v13
    v_and_b32 v31, s6, v13
    v_lshlrev_b32 v32, 16, v14
    v_and_b32 v33, s6, v14
    v_lshlrev_b32 v34, 16, v15
    v_and_b32 v35, s6, v15
    v_lshlrev_b32 v36, 16, v16
    v_and_b32 v37, s6, v16
    v_lshlrev_b32 v38, 16, v17
    v_and_b32 v39, s6, v17
    v_lshlrev_b32 v40, 16, v18
    v_and_b32 v41, s6, v18
    v_lshlrev_b32 v42, 16, v19
    v_and_b32 v43, s6, v19
    s_waitcnt lgkmcnt(0)
    v_mul_u32_u24_dpp v76, v64, v52 row_newbcast:0 row_mask:0xf bank_mask:0xf
    v_and_b32_dpp v77, v64, v53 row_newbcast:0 row_mask:0xf bank_mask:0xf
    v_mul_u32_u24_dpp v78, v64, v52 row_newbcast:1 row_mask:0xf bank_mask:0xf
    v_and_b32_dpp v79, v64, v53 row_newbcast:1 row_mask:0xf bank_mask:0xf
    v_mul_u32_u24_dpp v80, v64, v52 row_newbcast:2 row_mask:0xf bank_mask:0xf
    v_and_b32_dpp v81, v64, v53 row_newbcast:2 row_mask:0xf bank_mask:0xf
    v_mul_u32_u24_dpp v82, v64, v52 row_newbcast:3 row_mask:0xf bank_mask:0xf
    v_and_b32_dpp v83, v64, v53 row_newbcast:3 row_mask:0xf bank_mask:0xf
    v_mul_u32_u24_dpp v84, v64, v52 row_newbcast:4 row_mask:0xf bank_mask:0xf
    v_and_b32_dpp v85, v64, v53 row_newbcast:4 row_mask:0xf bank_mask:0xf
    v_mul_u32_u24_dpp v86, v64, v52 row_newbcast:5 row_mask:0xf bank_mask:0xf
    v_and_b32_dpp v87, v64, v53 row_newbcast:5 row_mask:0xf bank_mask:0xf
    v_mul_u32_u24_dpp v88, v64, v52 row_newbcast:6 row_mask:0xf bank_mask:0xf
    v_and_b32_dpp v89, v64, v53 row_newbcast:6 row_mask:0xf bank_mask:0xf
    v_mul_u32_u24_dpp v90, v64, v52 row_newbcast:7 row_mask:0xf bank_mask:0xf
    v_and_b32_dpp v91, v64, v53 row_newbcast:7 row_mask:0xf bank_mask:0xf
    s_lshl1_add_u32 s96, s94, s77
    s_lshl_b32 s97, s96, 15
    s_add_u32 s19, s97, 8388608
    v_and_b32 v25, 15, v1
    v_lshlrev_b32 v25, 6, v25
    s_waitcnt vmcnt(0)
    s_waitcnt lgkmcnt(0)
    s_barrier
    s_cmp_lg_u32 s3, 0
    s_cbranch_scc1 L_PD
    v_mov_b32 v6, s4
    s_mov_b32 exec_hi, 0
    s_mov_b32 exec_lo, 65535
    buffer_store_dword v6, v5, s[32:35], s15 offen sc1
    s_mov_b64 exec, -1
L_PD:
    s_add_u32 s96, s84, 1966080
    s_and_b32 s97, s96, 1048575
    s_lshl_b32 s98, s83, 16
    s_xor_b32 s99, s97, s98
    s_xor_b32 s96, s88, 1048576
    s_add_u32 s13, s99, s96
    s_add_u32 m0, s89, 155648
    s_nop 0
    buffer_load_dwordx4 v74, s[44:47], s13 offen lds
    s_and_b32 s96, s84, 1048575
    s_lshl_b32 s97, s83, 16
    s_xor_b32 s98, s96, s97
    s_add_u32 s13, s98, s88
    s_add_u32 m0, s89, 32768
    s_nop 0
    buffer_load_dwordx4 v74, s[44:47], s13 offen lds
    s_add_u32 s96, s84, 131072
    s_and_b32 s97, s96, 1048575
    s_lshl_b32 s98, s83, 16
    s_xor_b32 s99, s97, s98
    s_add_u32 s13, s99, s88
    s_add_u32 m0, s89, 40960
    s_nop 0
    buffer_load_dwordx4 v74, s[44:47], s13 offen lds
    s_load_dwordx2 s[24:25], s[32:33], s92 offset:1024 glc
    v_mov_b32_dpp v92, v65 row_newbcast:0 row_mask:0xf bank_mask:0xf
    v_mov_b32_dpp v93, v65 row_newbcast:1 row_mask:0xf bank_mask:0xf
    v_mov_b32_dpp v94, v65 row_newbcast:2 row_mask:0xf bank_mask:0xf
    v_mov_b32_dpp v95, v65 row_newbcast:3 row_mask:0xf bank_mask:0xf
    v_mov_b32_dpp v96, v65 row_newbcast:4 row_mask:0xf bank_mask:0xf
    v_mov_b32_dpp v97, v65 row_newbcast:5 row_mask:0xf bank_mask:0xf
    v_mov_b32_dpp v98, v65 row_newbcast:6 row_mask:0xf bank_mask:0xf
    v_mov_b32_dpp v99, v65 row_newbcast:7 row_mask:0xf bank_mask:0xf
    v_mov_b32_dpp v100, v66 row_newbcast:0 row_mask:0xf bank_mask:0xf
    v_mov_b32_dpp v101, v66 row_newbcast:1 row_mask:0xf bank_mask:0xf
    v_mov_b32_dpp v102, v66 row_newbcast:2 row_mask:0xf bank_mask:0xf
    v_mov_b32_dpp v103, v66 row_newbcast:3 row_mask:0xf bank_mask:0xf
    v_mov_b32_dpp v104, v66 row_newbcast:4 row_mask:0xf bank_mask:0xf
    v_mov_b32_dpp v105, v66 row_newbcast:5 row_mask:0xf bank_mask:0xf
    v_mov_b32_dpp v106, v66 row_newbcast:6 row_mask:0xf bank_mask:0xf
    v_mov_b32_dpp v107, v66 row_newbcast:7 row_mask:0xf bank_mask:0xf
    v_and_b32 v4, 3, v1
    v_cmp_eq_u32 vcc, 1, v4
    v_cmp_eq_u32 s[22:23], 0, v4
    v_mov_b32 v5, 0x3f803f80
    v_cndmask_b32 v92, v100, v92, vcc
    v_cndmask_b32 v93, v101, v93, vcc
    v_cndmask_b32 v94, v102, v94, vcc
    v_cndmask_b32 v95, v103, v95, vcc
    v_cndmask_b32 v96, v104, v96, vcc
    v_cndmask_b32 v97, v105, v97, vcc
    v_cndmask_b32 v98, v106, v98, vcc
    v_cndmask_b32 v99, v107, v99, vcc
    v_cndmask_b32 v92, v92, v5, s[22:23]
    v_cndmask_b32 v93, v93, v5, s[22:23]
    v_cndmask_b32 v94, v94, v5, s[22:23]
    v_cndmask_b32 v95, v95, v5, s[22:23]
    v_cndmask_b32 v96, v96, v5, s[22:23]
    v_cndmask_b32 v97, v97, v5, s[22:23]
    v_cndmask_b32 v98, v98, v5, s[22:23]
    v_cndmask_b32 v99, v99, v5, s[22:23]
    s_waitcnt vmcnt(0)
    s_branch SCHK_30
SPOLL_29:
    s_load_dwordx2 s[24:25], s[32:33], s92 offset:1024 glc
SCHK_30:
    s_add_u32 s5, s5, 1
    s_cmp_ge_u32 s5, 300000
    s_waitcnt lgkmcnt(0)
    s_cbranch_scc1 SDONE_31
    s_cmp_lg_u32 s24, s4
    s_cbranch_scc1 SPOLL_29
SDONE_31:
    s_barrier
    s_cmp_lt_u32 s3, 4
    s_cbranch_scc1 L_P2
    s_setprio 1
L_P2:
    s_lshl_b32 s96, s21, 10
    s_add_u32 s18, s96, 65536
    s_lshl_b32 s96, s83, 11
    s_add_u32 s20, s96, s19
    buffer_load_dwordx4 v[140:143], v2, s[32:35], s20 offen sc1
    buffer_load_dwordx4 v[144:147], v2, s[32:35], s20 offen offset:1024 sc1
    ds_read_b64_tr_b16 v[232:233], v22
    ds_read_b64_tr_b16 v[234:235], v22 offset:1024
    ds_read_b64_tr_b16 v[236:237], v23
    ds_read_b64_tr_b16 v[238:239], v23 offset:1024
    ds_read_b64_tr_b16 v[240:241], v20
    ds_read_b64_tr_b16 v[242:243], v20 offset:1024
    ds_read_b64_tr_b16 v[244:245], v21
    ds_read_b64_tr_b16 v[246:247], v21 offset:1024
    s_xor_b32 s96, s83, 1
    s_lshl_b32 s97, s96, 11
    s_add_u32 s20, s97, s19
    buffer_load_dwordx4 v[148:151], v2, s[32:35], s20 offen sc1
    buffer_load_dwordx4 v[152:155], v2, s[32:35], s20 offen offset:1024 sc1
    s_xor_b32 s96, s83, 2
    s_lshl_b32 s97, s96, 11
    s_add_u32 s20, s97, s19
    buffer_load_dwordx4 v[156:159], v2, s[32:35], s20 offen sc1
    buffer_load_dwordx4 v[160:163], v2, s[32:35], s20 offen offset:1024 sc1
    s_waitcnt lgkmcnt(6)
    s_waitcnt vmcnt(5)
    v_mfma_f32_16x16x32_bf16 v[124:127], v[232:235], v[140:143], 0
    ds_read_b64_tr_b16 v[248:249], v22 offset:4096
    s_waitcnt vmcnt(4)
    v_mfma_f32_16x16x32_bf16 v[128:131], v[232:235], v[144:147], 0
    ds_read_b64_tr_b16 v[250:251], v22 offset:5120
    s_xor_b32 s96, s83, 3
    s_lshl_b32 s97, s96, 11
    s_add_u32 s20, s97, s19
    buffer_load_dwordx4 v[164:167], v2, s[32:35], s20 offen sc1
    s_waitcnt lgkmcnt(6)
    v_mfma_f32_16x16x32_bf16 v[132:135], v[236:239], v[140:143], 0
    ds_read_b64_tr_b16 v[232:233], v23 offset:4096
    v_mfma_f32_16x16x32_bf16 v[136:139], v[236:239], v[144:147], 0
    ds_read_b64_tr_b16 v[234:235], v23 offset:5120
    buffer_load_dwordx4 v[168:171], v2, s[32:35], s20 offen offset:1024 sc1
    s_waitcnt lgkmcnt(6)
    v_mfma_f32_16x16x32_bf16 v[108:111], v[240:243], v[140:143], 0
    ds_read_b64_tr_b16 v[236:237], v20 offset:4096
    v_mfma_f32_16x16x32_bf16 v[112:115], v[240:243], v[144:147], 0
    ds_read_b64_tr_b16 v[238:239], v20 offset:5120
    s_waitcnt lgkmcnt(6)
    v_mfma_f32_16x16x32_bf16 v[116:119], v[244:247], v[140:143], 0
    ds_read_b64_tr_b16 v[240:241], v21 offset:4096
    v_mfma_f32_16x16x32_bf16 v[120:123], v[244:247], v[144:147], 0
    ds_read_b64_tr_b16 v[242:243], v21 offset:5120
    s_waitcnt lgkmcnt(6)
    s_waitcnt vmcnt(4)
    v_mfma_f32_16x16x32_bf16 v[124:127], v[248:251], v[148:151], v[124:127]
    ds_read_b64_tr_b16 v[244:245], v22 offset:8192
    v_mfma_f32_16x16x32_bf16 v[128:131], v[248:251], v[152:155], v[128:131]
    ds_read_b64_tr_b16 v[246:247], v22 offset:9216
    s_xor_b32 s96, s83, 4
    s_lshl_b32 s97, s96, 11
    s_add_u32 s20, s97, s19
    buffer_load_dwordx4 v[140:143], v2, s[32:35], s20 offen sc1
    s_waitcnt lgkmcnt(6)
    v_mfma_f32_16x16x32_bf16 v[132:135], v[232:235], v[148:151], v[132:135]
    ds_read_b64_tr_b16 v[248:249], v23 offset:8192
    v_mfma_f32_16x16x32_bf16 v[136:139], v[232:235], v[152:155], v[136:139]
    ds_read_b64_tr_b16 v[250:251], v23 offset:9216
    buffer_load_dwordx4 v[144:147], v2, s[32:35], s20 offen offset:1024 sc1
    s_waitcnt lgkmcnt(6)
    v_mfma_f32_16x16x32_bf16 v[108:111], v[236:239], v[148:151], v[108:111]
    ds_read_b64_tr_b16 v[232:233], v20 offset:8192
    v_mfma_f32_16x16x32_bf16 v[112:115], v[236:239], v[152:155], v[112:115]
    ds_read_b64_tr_b16 v[234:235], v20 offset:9216
    s_waitcnt lgkmcnt(6)
    v_mfma_f32_16x16x32_bf16 v[116:119], v[240:243], v[148:151], v[116:119]
    ds_read_b64_tr_b16 v[236:237], v21 offset:8192
    v_mfma_f32_16x16x32_bf16 v[120:123], v[240:243], v[152:155], v[120:123]
    ds_read_b64_tr_b16 v[238:239], v21 offset:9216
    s_waitcnt lgkmcnt(6)
    s_waitcnt vmcnt(4)
    v_mfma_f32_16x16x32_bf16 v[124:127], v[244:247], v[156:159], v[124:127]
    ds_read_b64_tr_b16 v[240:241], v22 offset:12288
    v_mfma_f32_16x16x32_bf16 v[128:131], v[244:247], v[160:163], v[128:131]
    ds_read_b64_tr_b16 v[242:243], v22 offset:13312
    s_xor_b32 s96, s83, 5
    s_lshl_b32 s97, s96, 11
    s_add_u32 s20, s97, s19
    buffer_load_dwordx4 v[148:151], v2, s[32:35], s20 offen sc1
    s_waitcnt lgkmcnt(6)
    v_mfma_f32_16x16x32_bf16 v[132:135], v[248:251], v[156:159], v[132:135]
    ds_read_b64_tr_b16 v[244:245], v23 offset:12288
    v_mfma_f32_16x16x32_bf16 v[136:139], v[248:251], v[160:163], v[136:139]
    ds_read_b64_tr_b16 v[246:247], v23 offset:13312
    buffer_load_dwordx4 v[152:155], v2, s[32:35], s20 offen offset:1024 sc1
    s_waitcnt lgkmcnt(6)
    v_mfma_f32_16x16x32_bf16 v[108:111], v[232:235], v[156:159], v[108:111]
    ds_read_b64_tr_b16 v[248:249], v20 offset:12288
    v_mfma_f32_16x16x32_bf16 v[112:115], v[232:235], v[160:163], v[112:115]
    ds_read_b64_tr_b16 v[250:251], v20 offset:13312
    s_waitcnt lgkmcnt(6)
    v_mfma_f32_16x16x32_bf16 v[116:119], v[236:239], v[156:159], v[116:119]
    ds_read_b64_tr_b16 v[232:233], v21 offset:12288
    v_mfma_f32_16x16x32_bf16 v[120:123], v[236:239], v[160:163], v[120:123]
    ds_read_b64_tr_b16 v[234:235], v21 offset:13312
    s_waitcnt lgkmcnt(6)
    s_waitcnt vmcnt(4)
    v_mfma_f32_16x16x32_bf16 v[124:127], v[240:243], v[164:167], v[124:127]
    ds_read_b64_tr_b16 v[236:237], v22 offset:16384
    v_mfma_f32_16x16x32_bf16 v[128:131], v[240:243], v[168:171], v[128:131]
    ds_read_b64_tr_b16 v[238:239], v22 offset:17408
    s_xor_b32 s96, s83, 6
    s_lshl_b32 s97, s96, 11
    s_add_u32 s20, s97, s19
    buffer_load_dwordx4 v[156:159], v2, s[32:35], s20 offen sc1
    s_waitcnt lgkmcnt(6)
    v_mfma_f32_16x16x32_bf16 v[132:135], v[244:247], v[164:167], v[132:135]
    ds_read_b64_tr_b16 v[240:241], v23 offset:16384
    v_mfma_f32_16x16x32_bf16 v[136:139], v[244:247], v[168:171], v[136:139]
    ds_read_b64_tr_b16 v[242:243], v23 offset:17408
    buffer_load_dwordx4 v[160:163], v2, s[32:35], s20 offen offset:1024 sc1
    s_waitcnt lgkmcnt(6)
    v_mfma_f32_16x16x32_bf16 v[108:111], v[248:251], v[164:167], v[108:111]
    ds_read_b64_tr_b16 v[244:245], v20 offset:16384
    v_mfma_f32_16x16x32_bf16 v[112:115], v[248:251], v[168:171], v[112:115]
    ds_read_b64_tr_b16 v[246:247], v20 offset:17408
    s_waitcnt lgkmcnt(6)
    v_mfma_f32_16x16x32_bf16 v[116:119], v[232:235], v[164:167], v[116:119]
    ds_read_b64_tr_b16 v[248:249], v21 offset:16384
    v_mfma_f32_16x16x32_bf16 v[120:123], v[232:235], v[168:171], v[120:123]
    ds_read_b64_tr_b16 v[250:251], v21 offset:17408
    s_waitcnt lgkmcnt(6)
    s_waitcnt vmcnt(4)
    v_mfma_f32_16x16x32_bf16 v[124:127], v[236:239], v[140:143], v[124:127]
    ds_read_b64_tr_b16 v[232:233], v22 offset:20480
    v_mfma_f32_16x16x32_bf16 v[128:131], v[236:239], v[144:147], v[128:131]
    ds_read_b64_tr_b16 v[234:235], v22 offset:21504
    s_xor_b32 s96, s83, 7
    s_lshl_b32 s97, s96, 11
    s_add_u32 s20, s97, s19
    buffer_load_dwordx4 v[164:167], v2, s[32:35], s20 offen sc1
    s_waitcnt lgkmcnt(6)
    v_mfma_f32_16x16x32_bf16 v[132:135], v[240:243], v[140:143], v[132:135]
    ds_read_b64_tr_b16 v[236:237], v23 offset:20480
    v_mfma_f32_16x16x32_bf16 v[136:139], v[240:243], v[144:147], v[136:139]
    ds_read_b64_tr_b16 v[238:239], v23 offset:21504
    buffer_load_dwordx4 v[168:171], v2, s[32:35], s20 offen offset:1024 sc1
    s_waitcnt lgkmcnt(6)
    v_mfma_f32_16x16x32_bf16 v[108:111], v[244:247], v[140:143], v[108:111]
    ds_read_b64_tr_b16 v[240:241], v20 offset:20480
    v_mfma_f32_16x16x32_bf16 v[112:115], v[244:247], v[144:147], v[112:115]
    ds_read_b64_tr_b16 v[242:243], v20 offset:21504
    s_setprio 0
    s_waitcnt lgkmcnt(6)
    v_mfma_f32_16x16x32_bf16 v[116:119], v[248:251], v[140:143], v[116:119]
    ds_read_b64_tr_b16 v[244:245], v21 offset:20480
    v_mfma_f32_16x16x32_bf16 v[120:123], v[248:251], v[144:147], v[120:123]
    ds_read_b64_tr_b16 v[246:247], v21 offset:21504
    s_waitcnt lgkmcnt(6)
    s_waitcnt vmcnt(4)
    v_mfma_f32_16x16x32_bf16 v[124:127], v[232:235], v[148:151], v[124:127]
    ds_read_b64_tr_b16 v[248:249], v22 offset:24576
    v_mfma_f32_16x16x32_bf16 v[128:131], v[232:235], v[152:155], v[128:131]
    ds_read_b64_tr_b16 v[250:251], v22 offset:25600
    s_cmp_eq_u32 s25, s4
    s_cbranch_scc1 L_D2
SPOLL_32:
    s_load_dwordx2 s[24:25], s[32:33], s92 offset:1024 glc
SCHK_33:
    s_add_u32 s5, s5, 1
    s_cmp_ge_u32 s5, 300000
    s_waitcnt lgkmcnt(0)
    s_cbranch_scc1 SDONE_34
    s_cmp_lg_u32 s25, s4
    s_cbranch_scc1 SPOLL_32
SDONE_34:
L_D2:
    s_barrier
    s_xor_b32 s96, s83, 8
    s_lshl_b32 s97, s96, 11
    s_add_u32 s20, s97, s19
    buffer_load_dwordx4 v[140:143], v2, s[32:35], s20 offen sc1
    s_waitcnt lgkmcnt(6)
    v_mfma_f32_16x16x32_bf16 v[132:135], v[236:239], v[148:151], v[132:135]
    ds_read_b64_tr_b16 v[232:233], v23 offset:24576
    v_mfma_f32_16x16x32_bf16 v[136:139], v[236:239], v[152:155], v[136:139]
    ds_read_b64_tr_b16 v[234:235], v23 offset:25600
    buffer_load_dwordx4 v[144:147], v2, s[32:35], s20 offen offset:1024 sc1
    s_waitcnt lgkmcnt(6)
    v_mfma_f32_16x16x32_bf16 v[108:111], v[240:243], v[148:151], v[108:111]
    ds_read_b64_tr_b16 v[236:237], v20 offset:24576
    v_mfma_f32_16x16x32_bf16 v[112:115], v[240:243], v[152:155], v[112:115]
    ds_read_b64_tr_b16 v[238:239], v20 offset:25600
    s_waitcnt lgkmcnt(6)
    v_mfma_f32_16x16x32_bf16 v[116:119], v[244:247], v[148:151], v[116:119]
    ds_read_b64_tr_b16 v[240:241], v21 offset:24576
    v_mfma_f32_16x16x32_bf16 v[120:123], v[244:247], v[152:155], v[120:123]
    ds_read_b64_tr_b16 v[242:243], v21 offset:25600
    s_waitcnt lgkmcnt(6)
    s_waitcnt vmcnt(4)
    v_mfma_f32_16x16x32_bf16 v[124:127], v[248:251], v[156:159], v[124:127]
    ds_read_b64_tr_b16 v[244:245], v22 offset:28672
    v_mfma_f32_16x16x32_bf16 v[128:131], v[248:251], v[160:163], v[128:131]
    ds_read_b64_tr_b16 v[246:247], v22 offset:29696
    s_xor_b32 s96, s83, 9
    s_lshl_b32 s97, s96, 11
    s_add_u32 s20, s97, s19
    buffer_load_dwordx4 v[148:151], v2, s[32:35], s20 offen sc1
    s_waitcnt lgkmcnt(6)
    v_mfma_f32_16x16x32_bf16 v[132:135], v[232:235], v[156:159], v[132:135]
    ds_read_b64_tr_b16 v[248:249], v23 offset:28672
    v_mfma_f32_16x16x32_bf16 v[136:139], v[232:235], v[160:163], v[136:139]
    ds_read_b64_tr_b16 v[250:251], v23 offset:29696
    buffer_load_dwordx4 v[152:155], v2, s[32:35], s20 offen offset:1024 sc1
    s_waitcnt lgkmcnt(6)
    v_mfma_f32_16x16x32_bf16 v[108:111], v[236:239], v[156:159], v[108:111]
    ds_read_b64_tr_b16 v[232:233], v20 offset:28672
    v_mfma_f32_16x16x32_bf16 v[112:115], v[236:239], v[160:163], v[112:115]
    ds_read_b64_tr_b16 v[234:235], v20 offset:29696
    s_waitcnt lgkmcnt(6)
    v_mfma_f32_16x16x32_bf16 v[116:119], v[240:243], v[156:159], v[116:119]
    ds_read_b64_tr_b16 v[236:237], v21 offset:28672
    v_mfma_f32_16x16x32_bf16 v[120:123], v[240:243], v[160:163], v[120:123]
    ds_read_b64_tr_b16 v[238:239], v21 offset:29696
    s_waitcnt lgkmcnt(6)
    s_waitcnt vmcnt(4)
    v_mfma_f32_16x16x32_bf16 v[124:127], v[244:247], v[164:167], v[124:127]
    ds_read_b64_tr_b16 v[240:241], v22 offset:32768
    v_mfma_f32_16x16x32_bf16 v[128:131], v[244:247], v[168:171], v[128:131]
    ds_read_b64_tr_b16 v[242:243], v22 offset:33792
    s_xor_b32 s96, s83, 10
    s_lshl_b32 s97, s96, 11
    s_add_u32 s20, s97, s19
    buffer_load_dwordx4 v[156:159], v2, s[32:35], s20 offen sc1
    s_waitcnt lgkmcnt(6)
    v_mfma_f32_16x16x32_bf16 v[132:135], v[248:251], v[164:167], v[132:135]
    ds_read_b64_tr_b16 v[244:245], v23 offset:32768
    v_mfma_f32_16x16x32_bf16 v[136:139], v[248:251], v[168:171], v[136:139]
    ds_read_b64_tr_b16 v[246:247], v23 offset:33792
    buffer_load_dwordx4 v[160:163], v2, s[32:35], s20 offen offset:1024 sc1
    s_waitcnt lgkmcnt(6)
    v_mfma_f32_16x16x32_bf16 v[108:111], v[232:235], v[164:167], v[108:111]
    ds_read_b64_tr_b16 v[248:249], v20 offset:32768
    v_mfma_f32_16x16x32_bf16 v[112:115], v[232:235], v[168:171], v[112:115]
    ds_read_b64_tr_b16 v[250:251], v20 offset:33792
    s_waitcnt lgkmcnt(6)
    v_mfma_f32_16x16x32_bf16 v[116:119], v[236:239], v[164:167], v[116:119]
    ds_read_b64_tr_b16 v[232:233], v21 offset:32768
    v_mfma_f32_16x16x32_bf16 v[120:123], v[236:239], v[168:171], v[120:123]
    ds_read_b64_tr_b16 v[234:235], v21 offset:33792
    s_waitcnt lgkmcnt(6)
    s_waitcnt vmcnt(4)
    v_mfma_f32_16x16x32_bf16 v[124:127], v[240:243], v[140:143], v[124:127]
    ds_read_b64_tr_b16 v[236:237], v22 offset:36864
    v_mfma_f32_16x16x32_bf16 v[128:131], v[240:243], v[144:147], v[128:131]
    ds_read_b64_tr_b16 v[238:239], v22 offset:37888
    s_xor_b32 s96, s83, 11
    s_lshl_b32 s97, s96, 11
    s_add_u32 s20, s97, s19
    buffer_load_dwordx4 v[164:167], v2, s[32:35], s20 offen sc1
    s_waitcnt lgkmcnt(6)
    v_mfma_f32_16x16x32_bf16 v[132:135], v[244:247], v[140:143], v[132:135]
    ds_read_b64_tr_b16 v[240:241], v23 offset:36864
    v_mfma_f32_16x16x32_bf16 v[136:139], v[244:247], v[144:147], v[136:139]
    ds_read_b64_tr_b16 v[242:243], v23 offset:37888
    buffer_load_dwordx4 v[168:171], v2, s[32:35], s20 offen offset:1024 sc1
    s_waitcnt lgkmcnt(6)
    v_mfma_f32_16x16x32_bf16 v[108:111], v[248:251], v[140:143], v[108:111]
    ds_read_b64_tr_b16 v[244:245], v20 offset:36864
    v_mfma_f32_16x16x32_bf16 v[112:115], v[248:251], v[144:147], v[112:115]
    ds_read_b64_tr_b16 v[246:247], v20 offset:37888
    s_waitcnt lgkmcnt(6)
    v_mfma_f32_16x16x32_bf16 v[116:119], v[232:235], v[140:143], v[116:119]
    ds_read_b64_tr_b16 v[248:249], v21 offset:36864
    v_mfma_f32_16x16x32_bf16 v[120:123], v[232:235], v[144:147], v[120:123]
    ds_read_b64_tr_b16 v[250:251], v21 offset:37888
    s_waitcnt lgkmcnt(6)
    s_waitcnt vmcnt(4)
    v_mfma_f32_16x16x32_bf16 v[124:127], v[236:239], v[148:151], v[124:127]
    ds_read_b64_tr_b16 v[232:233], v22 offset:40960
    v_mfma_f32_16x16x32_bf16 v[128:131], v[236:239], v[152:155], v[128:131]
    ds_read_b64_tr_b16 v[234:235], v22 offset:41984
    s_xor_b32 s96, s83, 12
    s_lshl_b32 s97, s96, 11
    s_add_u32 s20, s97, s19
    buffer_load_dwordx4 v[140:143], v2, s[32:35], s20 offen sc1
    s_waitcnt lgkmcnt(6)
    v_mfma_f32_16x16x32_bf16 v[132:135], v[240:243], v[148:151], v[132:135]
    ds_read_b64_tr_b16 v[236:237], v23 offset:40960
    v_mfma_f32_16x16x32_bf16 v[136:139], v[240:243], v[152:155], v[136:139]
    ds_read_b64_tr_b16 v[238:239], v23 offset:41984
    buffer_load_dwordx4 v[144:147], v2, s[32:35], s20 offen offset:1024 sc1
    s_waitcnt lgkmcnt(6)
    v_mfma_f32_16x16x32_bf16 v[108:111], v[244:247], v[148:151], v[108:111]
    ds_read_b64_tr_b16 v[240:241], v20 offset:40960
    v_mfma_f32_16x16x32_bf16 v[112:115], v[244:247], v[152:155], v[112:115]
    ds_read_b64_tr_b16 v[242:243], v20 offset:41984
    s_waitcnt lgkmcnt(6)
    v_mfma_f32_16x16x32_bf16 v[116:119], v[248:251], v[148:151], v[116:119]
    ds_read_b64_tr_b16 v[244:245], v21 offset:40960
    v_mfma_f32_16x16x32_bf16 v[120:123], v[248:251], v[152:155], v[120:123]
    ds_read_b64_tr_b16 v[246:247], v21 offset:41984
    s_waitcnt lgkmcnt(6)
    s_waitcnt vmcnt(4)
    v_mfma_f32_16x16x32_bf16 v[124:127], v[232:235], v[156:159], v[124:127]
    ds_read_b64_tr_b16 v[248:249], v22 offset:45056
    v_mfma_f32_16x16x32_bf16 v[128:131], v[232:235], v[160:163], v[128:131]
    ds_read_b64_tr_b16 v[250:251], v22 offset:46080
    s_xor_b32 s96, s83, 13
    s_lshl_b32 s97, s96, 11
    s_add_u32 s20, s97, s19
    buffer_load_dwordx4 v[148:151], v2, s[32:35], s20 offen sc1
    s_waitcnt lgkmcnt(6)
    v_mfma_f32_16x16x32_bf16 v[132:135], v[236:239], v[156:159], v[132:135]
    ds_read_b64_tr_b16 v[232:233], v23 offset:45056
    v_mfma_f32_16x16x32_bf16 v[136:139], v[236:239], v[160:163], v[136:139]
    ds_read_b64_tr_b16 v[234:235], v23 offset:46080
    buffer_load_dwordx4 v[152:155], v2, s[32:35], s20 offen offset:1024 sc1
    s_waitcnt lgkmcnt(6)
    v_mfma_f32_16x16x32_bf16 v[108:111], v[240:243], v[156:159], v[108:111]
    ds_read_b64_tr_b16 v[236:237], v20 offset:45056
    v_mfma_f32_16x16x32_bf16 v[112:115], v[240:243], v[160:163], v[112:115]
    ds_read_b64_tr_b16 v[238:239], v20 offset:46080
    s_waitcnt lgkmcnt(6)
    v_mfma_f32_16x16x32_bf16 v[116:119], v[244:247], v[156:159], v[116:119]
    ds_read_b64_tr_b16 v[240:241], v21 offset:45056
    v_mfma_f32_16x16x32_bf16 v[120:123], v[244:247], v[160:163], v[120:123]
    ds_read_b64_tr_b16 v[242:243], v21 offset:46080
    s_waitcnt lgkmcnt(6)
    s_waitcnt vmcnt(4)
    v_mfma_f32_16x16x32_bf16 v[124:127], v[248:251], v[164:167], v[124:127]
    ds_read_b64_tr_b16 v[244:245], v22 offset:49152
    v_mfma_f32_16x16x32_bf16 v[128:131], v[248:251], v[168:171], v[128:131]
    ds_read_b64_tr_b16 v[246:247], v22 offset:50176
    s_xor_b32 s96, s83, 14
    s_lshl_b32 s97, s96, 11
    s_add_u32 s20, s97, s19
    buffer_load_dwordx4 v[156:159], v2, s[32:35], s20 offen sc1
    s_waitcnt lgkmcnt(6)
    v_mfma_f32_16x16x32_bf16 v[132:135], v[232:235], v[164:167], v[132:135]
    ds_read_b64_tr_b16 v[248:249], v23 offset:49152
    v_mfma_f32_16x16x32_bf16 v[136:139], v[232:235], v[168:171], v[136:139]
    ds_read_b64_tr_b16 v[250:251], v23 offset:50176
    buffer_load_dwordx4 v[160:163], v2, s[32:35], s20 offen offset:1024 sc1
    s_waitcnt lgkmcnt(6)
    v_mfma_f32_16x16x32_bf16 v[108:111], v[236:239], v[164:167], v[108:111]
    ds_read_b64_tr_b16 v[232:233], v20 offset:49152
    v_mfma_f32_16x16x32_bf16 v[112:115], v[236:239], v[168:171], v[112:115]
    ds_read_b64_tr_b16 v[234:235], v20 offset:50176
    s_waitcnt lgkmcnt(6)
    v_mfma_f32_16x16x32_bf16 v[116:119], v[240:243], v[164:167], v[116:119]
    ds_read_b64_tr_b16 v[236:237], v21 offset:49152
    v_mfma_f32_16x16x32_bf16 v[120:123], v[240:243], v[168:171], v[120:123]
    ds_read_b64_tr_b16 v[238:239], v21 offset:50176
    s_waitcnt lgkmcnt(6)
    s_waitcnt vmcnt(4)
    v_mfma_f32_16x16x32_bf16 v[124:127], v[244:247], v[140:143], v[124:127]
    ds_read_b64_tr_b16 v[240:241], v22 offset:53248
    v_mfma_f32_16x16x32_bf16 v[128:131], v[244:247], v[144:147], v[128:131]
    ds_read_b64_tr_b16 v[242:243], v22 offset:54272
    s_xor_b32 s96, s83, 15
    s_lshl_b32 s97, s96, 11
    s_add_u32 s20, s97, s19
    buffer_load_dwordx4 v[164:167], v2, s[32:35], s20 offen sc1
    s_waitcnt lgkmcnt(6)
    v_mfma_f32_16x16x32_bf16 v[132:135], v[248:251], v[140:143], v[132:135]
    ds_read_b64_tr_b16 v[244:245], v23 offset:53248
    v_mfma_f32_16x16x32_bf16 v[136:139], v[248:251], v[144:147], v[136:139]
    ds_read_b64_tr_b16 v[246:247], v23 offset:54272
    buffer_load_dwordx4 v[168:171], v2, s[32:35], s20 offen offset:1024 sc1
    buffer_load_dwordx2 v[26:27], v25, s[32:35], s18 offen sc1
    s_waitcnt lgkmcnt(6)
    v_mfma_f32_16x16x32_bf16 v[108:111], v[232:235], v[140:143], v[108:111]
    ds_read_b64_tr_b16 v[248:249], v20 offset:53248
    v_mfma_f32_16x16x32_bf16 v[112:115], v[232:235], v[144:147], v[112:115]
    ds_read_b64_tr_b16 v[250:251], v20 offset:54272
    s_waitcnt lgkmcnt(6)
    v_mfma_f32_16x16x32_bf16 v[116:119], v[236:239], v[140:143], v[116:119]
    ds_read_b64_tr_b16 v[232:233], v21 offset:53248
    v_mfma_f32_16x16x32_bf16 v[120:123], v[236:239], v[144:147], v[120:123]
    ds_read_b64_tr_b16 v[234:235], v21 offset:54272
    s_waitcnt lgkmcnt(6)
    s_waitcnt vmcnt(5)
    v_mfma_f32_16x16x32_bf16 v[124:127], v[240:243], v[148:151], v[124:127]
    ds_read_b64_tr_b16 v[236:237], v22 offset:57344
    v_mfma_f32_16x16x32_bf16 v[128:131], v[240:243], v[152:155], v[128:131]
    ds_read_b64_tr_b16 v[238:239], v22 offset:58368
    s_waitcnt lgkmcnt(6)
    v_mfma_f32_16x16x32_bf16 v[132:135], v[244:247], v[148:151], v[132:135]
    ds_read_b64_tr_b16 v[240:241], v23 offset:57344
    v_mfma_f32_16x16x32_bf16 v[136:139], v[244:247], v[152:155], v[136:139]
    ds_read_b64_tr_b16 v[242:243], v23 offset:58368
    s_waitcnt lgkmcnt(6)
    v_mfma_f32_16x16x32_bf16 v[108:111], v[248:251], v[148:151], v[108:111]
    ds_read_b64_tr_b16 v[244:245], v20 offset:57344
    v_mfma_f32_16x16x32_bf16 v[112:115], v[248:251], v[152:155], v[112:115]
    ds_read_b64_tr_b16 v[246:247], v20 offset:58368
    s_waitcnt lgkmcnt(6)
    v_mfma_f32_16x16x32_bf16 v[116:119], v[232:235], v[148:151], v[116:119]
    ds_read_b64_tr_b16 v[248:249], v21 offset:57344
    v_mfma_f32_16x16x32_bf16 v[120:123], v[232:235], v[152:155], v[120:123]
    ds_read_b64_tr_b16 v[250:251], v21 offset:58368
    s_waitcnt lgkmcnt(6)
    s_waitcnt vmcnt(3)
    v_mfma_f32_16x16x32_bf16 v[124:127], v[236:239], v[156:159], v[124:127]
    ds_read_b64_tr_b16 v[232:233], v22 offset:61440
    v_mfma_f32_16x16x32_bf16 v[128:131], v[236:239], v[160:163], v[128:131]
    ds_read_b64_tr_b16 v[234:235], v22 offset:62464
    s_waitcnt lgkmcnt(6)
    v_mfma_f32_16x16x32_bf16 v[132:135], v[240:243], v[156:159], v[132:135]
    ds_read_b64_tr_b16 v[236:237], v23 offset:61440
    v_mfma_f32_16x16x32_bf16 v[136:139], v[240:243], v[160:163], v[136:139]
    ds_read_b64_tr_b16 v[238:239], v23 offset:62464
    s_waitcnt lgkmcnt(6)
    v_mfma_f32_16x16x32_bf16 v[108:111], v[244:247], v[156:159], v[108:111]
    ds_read_b64_tr_b16 v[240:241], v20 offset:61440
    v_mfma_f32_16x16x32_bf16 v[112:115], v[244:247], v[160:163], v[112:115]
    ds_read_b64_tr_b16 v[242:243], v20 offset:62464
    s_waitcnt lgkmcnt(6)
    v_mfma_f32_16x16x32_bf16 v[116:119], v[248:251], v[156:159], v[116:119]
    ds_read_b64_tr_b16 v[244:245], v21 offset:61440
    v_mfma_f32_16x16x32_bf16 v[120:123], v[248:251], v[160:163], v[120:123]
    ds_read_b64_tr_b16 v[246:247], v21 offset:62464
    s_waitcnt lgkmcnt(6)
    s_waitcnt vmcnt(1)
    v_mfma_f32_16x16x32_bf16 v[124:127], v[232:235], v[164:167], v[124:127]
    v_mfma_f32_16x16x32_bf16 v[128:131], v[232:235], v[168:171], v[128:131]
    s_waitcnt lgkmcnt(4)
    v_mfma_f32_16x16x32_bf16 v[132:135], v[236:239], v[164:167], v[132:135]
    v_mfma_f32_16x16x32_bf16 v[136:139], v[236:239], v[168:171], v[136:139]
    s_waitcnt lgkmcnt(2)
    v_mfma_f32_16x16x32_bf16 v[108:111], v[240:243], v[164:167], v[108:111]
    v_mfma_f32_16x16x32_bf16 v[112:115], v[240:243], v[168:171], v[112:115]
    s_waitcnt lgkmcnt(0)
    v_mfma_f32_16x16x32_bf16 v[116:119], v[244:247], v[164:167], v[116:119]
    v_mfma_f32_16x16x32_bf16 v[120:123], v[244:247], v[168:171], v[120:123]
    s_setprio 0
    s_lshl_b32 s13, s3, 12
    v_add_u32 v4, s13, v2
    ds_write_b128 v4, v[124:127]
    ds_write_b128 v4, v[128:131] offset:1024
    ds_write_b128 v4, v[132:135] offset:2048
    ds_write_b128 v4, v[136:139] offset:3072
    v_permlane16_swap_b32 v108, v112
    v_permlane16_swap_b32 v109, v113
    v_permlane16_swap_b32 v110, v114
    v_permlane16_swap_b32 v111, v115
    v_permlane16_swap_b32 v116, v120
    v_permlane16_swap_b32 v117, v121
    v_permlane16_swap_b32 v118, v122
    v_permlane16_swap_b32 v119, v123
    s_xor_b32 s96, s3, 4
    s_lshl_b32 s13, s96, 12
    v_and_b32 v5, 15, v1
    v_lshl_add_u32 v5, v5, 4, s13
    v_bfe_u32 v9, v1, 4, 1
    v_lshl_add_u32 v5, v9, 10, v5
    v_lshrrev_b32 v9, 5, v1
    v_lshl_add_u32 v5, v9, 9, v5
    s_lshl_b32 s96, s76, 11
    s_and_b32 s97, s3, 3
    s_lshl_b32 s98, s97, 9
    s_add_u32 s99, s96, s98
    s_add_u32 s13, s99, 131072
    v_and_b32 v6, 31, v1
    v_lshl_add_u32 v6, v6, 4, s13
    v_lshrrev_b32 v9, 5, v1
    v_lshl_add_u32 v6, v9, 3, v6
    s_lshl_b32 s96, s76, 6
    s_add_u32 s13, s96, 139008
    v_and_b32 v7, 7, v1
    v_lshl_add_u32 v7, v7, 2, s13
    v_lshrrev_b32 v9, 5, v1
    v_lshl_add_u32 v7, v9, 5, v7
    s_lshl_b32 s96, s21, 15
    s_lshl_b32 s97, s3, 8
    s_add_u32 s98, s96, s97
    s_add_u32 s19, s98, 12582912
    v_and_b32 v44, 15, v1
    v_lshlrev_b32 v44, 4, v44
    v_lshrrev_b32 v9, 4, v1
    v_lshl_add_u32 v44, v9, 11, v44
    v_mov_b32 v236, 0x3f803f80
    s_waitcnt lgkmcnt(0)
    s_barrier
    ds_read_b128 v[124:127], v5
    ds_read_b128 v[128:131], v5 offset:256
    ds_read_b128 v[132:135], v5 offset:2048
    ds_read_b128 v[136:139], v5 offset:2304
    s_add_u32 s14, s80, 172032
    s_lshl2_add_u32 m0, s89, 35840
    s_nop 0
    buffer_load_dwordx4 v72, s[52:55], s14 offen nt lds
    s_lshl_b32 s96, s90, 7
    s_add_u32 s97, s96, s80
    s_add_u32 s14, s97, 172032
    s_lshl2_add_u32 m0, s89, 68608
    s_nop 0
    buffer_load_dwordx4 v72, s[56:59], s14 offen nt lds
    s_mov_b32 s14, s81
    s_lshl2_add_u32 m0, s89, 98304
    s_nop 0
    buffer_load_dwordx4 v73, s[60:63], s14 offen nt lds
    s_waitcnt lgkmcnt(3)
    v_pk_add_f32 v[108:109], v[108:109], v[124:125]
    v_pk_add_f32 v[110:111], v[110:111], v[126:127]
    s_waitcnt lgkmcnt(2)
    v_pk_add_f32 v[112:113], v[112:113], v[128:129]
    v_pk_add_f32 v[114:115], v[114:115], v[130:131]
    v_cvt_pk_bf16_f32 v108, 0, v108
    v_cvt_pk_bf16_f32 v109, 0, v109
    v_cvt_pk_bf16_f32 v110, 0, v110
    v_cvt_pk_bf16_f32 v111, 0, v111
    v_cvt_pk_bf16_f32 v112, 0, v112
    v_cvt_pk_bf16_f32 v113, 0, v113
    v_cvt_pk_bf16_f32 v114, 0, v114
    v_cvt_pk_bf16_f32 v115, 0, v115
    v_pk_mul_f32 v[108:109], v[108:109], v[76:77]
    v_pk_mul_f32 v[110:111], v[110:111], v[78:79]
    v_pk_mul_f32 v[112:113], v[112:113], v[80:81]
    v_pk_mul_f32 v[114:115], v[114:115], v[82:83]
    v_cvt_pk_bf16_f32 v108, 0, v108
    v_cvt_pk_bf16_f32 v109, 0, v109
    v_cvt_pk_bf16_f32 v110, 0, v110
    v_cvt_pk_bf16_f32 v111, 0, v111
    v_cvt_pk_bf16_f32 v112, 0, v112
    v_cvt_pk_bf16_f32 v113, 0, v113
    v_cvt_pk_bf16_f32 v114, 0, v114
    v_cvt_pk_bf16_f32 v115, 0, v115
    v_pk_add_f32 v[108:109], v[108:109], v[28:29]
    v_pk_add_f32 v[110:111], v[110:111], v[30:31]
    v_pk_add_f32 v[112:113], v[112:113], v[32:33]
    v_pk_add_f32 v[114:115], v[114:115], v[34:35]
    v_cvt_pk_bf16_f32 v12, v108, v109
    v_cvt_pk_bf16_f32 v13, v110, v111
    v_cvt_pk_bf16_f32 v14, v112, v113
    v_cvt_pk_bf16_f32 v15, v114, v115
    s_waitcnt lgkmcnt(1)
    v_pk_add_f32 v[116:117], v[116:117], v[132:133]
    v_pk_add_f32 v[118:119], v[118:119], v[134:135]
    s_waitcnt lgkmcnt(0)
    v_pk_add_f32 v[120:121], v[120:121], v[136:137]
    v_pk_add_f32 v[122:123], v[122:123], v[138:139]
    v_cvt_pk_bf16_f32 v116, 0, v116
    v_cvt_pk_bf16_f32 v117, 0, v117
    v_cvt_pk_bf16_f32 v118, 0, v118
    v_cvt_pk_bf16_f32 v119, 0, v119
    v_cvt_pk_bf16_f32 v120, 0, v120
    v_cvt_pk_bf16_f32 v121, 0, v121
    v_cvt_pk_bf16_f32 v122, 0, v122
    v_cvt_pk_bf16_f32 v123, 0, v123
    v_pk_mul_f32 v[116:117], v[116:117], v[84:85]
    v_pk_mul_f32 v[118:119], v[118:119], v[86:87]
    v_pk_mul_f32 v[120:121], v[120:121], v[88:89]
    v_pk_mul_f32 v[122:123], v[122:123], v[90:91]
    v_cvt_pk_bf16_f32 v116, 0, v116
    v_cvt_pk_bf16_f32 v117, 0, v117
    v_cvt_pk_bf16_f32 v118, 0, v118
    v_cvt_pk_bf16_f32 v119, 0, v119
    v_cvt_pk_bf16_f32 v120, 0, v120
    v_cvt_pk_bf16_f32 v121, 0, v121
    v_cvt_pk_bf16_f32 v122, 0, v122
    v_cvt_pk_bf16_f32 v123, 0, v123
    v_pk_add_f32 v[116:117], v[116:117], v[36:37]
    v_pk_add_f32 v[118:119], v[118:119], v[38:39]
    v_pk_add_f32 v[120:121], v[120:121], v[40:41]
    v_pk_add_f32 v[122:123], v[122:123], v[42:43]
    v_cvt_pk_bf16_f32 v16, v116, v117
    v_cvt_pk_bf16_f32 v17, v118, v119
    v_cvt_pk_bf16_f32 v18, v120, v121
    v_cvt_pk_bf16_f32 v19, v122, v123
    v_mfma_f32_32x32x16_bf16 v[124:139], v[92:95], v[12:15], 0
    s_nop 0
    v_mfma_f32_32x32x16_bf16 v[124:139], v[96:99], v[16:19], v[124:139]
    v_dot2_f32_bf16 v232, v12, v12, 0
    v_dot2_f32_bf16 v233, v13, v13, 0
    v_dot2_f32_bf16 v232, v14, v14, v232
    v_dot2_f32_bf16 v233, v15, v15, v233
    v_dot2_f32_bf16 v232, v16, v16, v232
    v_dot2_f32_bf16 v233, v17, v17, v233
    v_dot2_f32_bf16 v232, v18, v18, v232
    v_dot2_f32_bf16 v233, v19, v19, v233
    s_nop 2
    v_add_f32 v234, v232, v233
    v_add_f32 v232, v232, v233
    s_nop 1
    v_permlane32_swap_b32 v232, v234
    s_mov_b32 exec_lo, 0
    v_add_f32 v124, v232, v234
    v_mov_b32 v125, v126
    s_mov_b32 exec_lo, -1
    ds_write_b64 v6, v[124:125]
    ds_write_b32 v7, v68
    ds_write_b32 v7, v69 offset:128
    ds_write_b32 v7, v70 offset:256
    ds_write_b32 v7, v71 offset:384
    v_add_u32 v4, 131072, v2
    v_and_b32 v5, 7, v1
    v_lshlrev_b32 v5, 15, v5
    v_bfe_u32 v9, v1, 3, 1
    v_lshl_add_u32 v5, v9, 12, v5
    s_lshl4_add_u32 s96, s21, s12
    s_lshl_b32 s97, s96, 11
    s_add_u32 s13, s97, 12582912
    s_and_b32 s96, s12, 1
    s_lshr_b32 s97, s21, 2
    s_and_b32 s98, s21, 3
    s_lshl_b32 s99, s98, 6
    s_lshl1_add_u32 s98, s97, s99
    s_lshl_b32 s97, s98, 12
    s_lshr_b32 s99, s12, 1
    s_lshl_b32 s98, s99, 6
    s_add_u32 s99, s97, s98
    s_lshl2_add_u32 s97, s96, s99
    s_add_u32 s98, s97, 1048576
    s_add_u32 s16, s98, 1536
    s_waitcnt lgkmcnt(0)
    s_barrier
    s_cmp_lg_u32 s3, 0
    s_cbranch_scc1 L_PE
    s_setprio 3
    ds_read_b128 v[124:127], v4 offset:0
    ds_read_b128 v[128:131], v4 offset:2048
    ds_read_b128 v[132:135], v4 offset:1024
    ds_read_b128 v[136:139], v4 offset:3072
    s_waitcnt lgkmcnt(2)
    v_pk_add_f32 v[124:125], v[124:125], v[128:129]
    v_pk_add_f32 v[126:127], v[126:127], v[130:131]
    v_add_f32 v125, v125, v127
    v_mov_b32 v127, s4
    s_waitcnt lgkmcnt(0)
    v_pk_add_f32 v[132:133], v[132:133], v[136:137]
    v_pk_add_f32 v[134:135], v[134:135], v[138:139]
    v_add_f32 v133, v133, v135
    v_mov_b32 v135, s4
    buffer_store_dwordx4 v[124:127], v2, s[32:35], s13 offen sc1
    buffer_store_dwordx4 v[132:135], v2, s[32:35], s13 offen offset:1024 sc1
    s_mov_b64 exec, 0xffff
    buffer_store_dword v127, v5, s[32:35], s16 offen sc1
    s_setprio 0
    s_mov_b64 exec, -1
L_PE:
    s_load_dwordx2 s[24:25], s[32:33], s92 offset:1536 glc
    s_and_b32 s96, s3, 3
    s_mul_i32 s97, s96, 4608
    s_lshl_b32 s98, s76, 6
    s_add_u32 s16, s97, s98
    v_and_b32 v23, 31, v1
    v_mul_u32_u24 v23, 144, v23
    v_lshrrev_b32 v9, 5, v1
    v_lshl_add_u32 v23, v9, 5, v23
    v_add_u32 v23, s16, v23
    ds_write_b128 v23, v[12:15]
    ds_write_b128 v23, v[16:19] offset:16
    v_add_u32 v23, 139776, v23
    s_lshl3_add_u32 s96, s21, s3
    s_lshl_b32 s97, s96, 5
    s_sub_u32 s15, 4094, s97
    v_and_b32 v22, 15, v1
    v_lshlrev_b32 v22, 1, v22
    v_sub_u32 v22, s15, v22
    s_lshl_b32 s96, s3, 7
    s_add_u32 s15, s96, 135168
    v_and_b32 v8, 15, v1
    v_lshl_add_u32 v8, v8, 3, s15
    s_and_b32 s96, s3, 3
    s_lshl_b32 s97, s96, 8
    s_add_u32 s15, s97, 135168
    v_and_b32 v10, 31, v1
    v_lshl_add_u32 v10, v10, 3, s15
    v_and_b32 v11, 7, v1
    v_lshlrev_b32 v11, 3, v11
    v_add_u32 v11, 136192, v11
    s_waitcnt vmcnt(3)
    v_cmp_ne_u32 vcc, s4, v27
    s_cbranch_vccz TOK_38
POLL_39:
    buffer_load_dwordx2 v[26:27], v25, s[32:35], s18 offen sc1
    s_waitcnt vmcnt(0)
    v_cmp_ne_u32 vcc, s4, v27
    s_cbranch_vccz PDONE_40
    s_add_u32 s5, s5, 1
    s_cmp_lt_u32 s5, 300000
    s_cbranch_scc1 POLL_39
PDONE_40:
TOK_38:
    v_add_f32_dpp v26, v26, v26 quad_perm:[1,0,3,2] row_mask:0xf bank_mask:0xf
    s_nop 1
    v_add_f32_dpp v26, v26, v26 quad_perm:[2,3,0,1] row_mask:0xf bank_mask:0xf
    s_nop 1
    v_add_f32_dpp v26, v26, v26 row_half_mirror row_mask:0xf bank_mask:0xf
    s_nop 1
    v_add_f32_dpp v26, v26, v26 row_ror:8 row_mask:0xf bank_mask:0xf
    s_cmp_lg_u32 s3, 1
    s_cbranch_scc1 L_NOCT
    v_and_b32 v5, 15, v1
    v_lshlrev_b32 v5, 3, v5
    v_add_u32 v5, 139008, v5
    ds_read_b64 v[150:151], v5
    ds_read_b64 v[154:155], v5 offset:128
    ds_read_b64 v[156:157], v5 offset:384
    s_waitcnt lgkmcnt(0)
    v_lshlrev_b32 v148, 16, v150
    v_and_b32 v149, s6, v150
    v_lshlrev_b32 v150, 16, v151
    v_and_b32 v151, s6, v151
    v_lshlrev_b32 v152, 16, v154
    v_and_b32 v153, s6, v154
    v_lshlrev_b32 v154, 16, v155
    v_and_b32 v155, s6, v155
L_NOCT:
    s_cmp_lt_u32 s3, 4
    s_cbranch_scc1 L_NOST
    s_sub_u32 s96, s3, 4
    s_lshl_b32 s97, s96, 12
    s_add_u32 s13, s97, 32768
    v_add_u32 v4, s13, v2
    v_add_u32 v7, 65536, v4
    ds_write_b128 v4, v[176:179] offset:16384
    ds_write_b128 v4, v[180:183]
    ds_write_b128 v4, v[184:187] offset:49152
    ds_write_b128 v4, v[188:191] offset:32768
    ds_write_b128 v4, v[192:195] offset:17408
    ds_write_b128 v4, v[196:199] offset:1024
    ds_write_b128 v4, v[200:203] offset:50176
    ds_write_b128 v4, v[204:207] offset:33792
    ds_write_b128 v4, v[208:211] offset:18432
    ds_write_b128 v4, v[212:215] offset:2048
    ds_write_b128 v4, v[216:219] offset:51200
    ds_write_b128 v4, v[220:223] offset:34816
L_NOST:
    s_branch SCHK_36
SPOLL_35:
    s_load_dwordx2 s[24:25], s[32:33], s92 offset:1536 glc
SCHK_36:
    s_add_u32 s5, s5, 1
    s_cmp_ge_u32 s5, 300000
    s_waitcnt lgkmcnt(0)
    s_cbranch_scc1 SDONE_37
    s_cmp_lg_u32 s24, s4
    s_cbranch_scc1 SPOLL_35
    s_cmp_lg_u32 s25, s4
    s_cbranch_scc1 SPOLL_35
SDONE_37:
    s_barrier
    s_mov_b32 s13, s19
    buffer_load_dwordx4 v[124:127], v44, s[32:35], s13 offen sc1
    s_add_u32 s13, s19, 8192
    buffer_load_dwordx4 v[128:131], v44, s[32:35], s13 offen sc1
    s_add_u32 s13, s19, 16384
    buffer_load_dwordx4 v[132:135], v44, s[32:35], s13 offen sc1
    s_add_u32 s13, s19, 24576
    buffer_load_dwordx4 v[136:139], v44, s[32:35], s13 offen sc1
    v_lshlrev_b32 v28, 16, v12
    v_and_b32 v29, s6, v12
    v_lshlrev_b32 v30, 16, v13
    v_and_b32 v31, s6, v13
    v_lshlrev_b32 v32, 16, v14
    v_and_b32 v33, s6, v14
    v_lshlrev_b32 v34, 16, v15
    v_and_b32 v35, s6, v15
    v_lshlrev_b32 v36, 16, v16
    v_and_b32 v37, s6, v16
    v_lshlrev_b32 v38, 16, v17
    v_and_b32 v39, s6, v17
    v_lshlrev_b32 v40, 16, v18
    v_and_b32 v41, s6, v18
    v_lshlrev_b32 v42, 16, v19
    v_and_b32 v43, s6, v19
    v_mul_u32_u24_dpp v92, v68, v52 row_newbcast:0 row_mask:0xf bank_mask:0xf
    v_and_b32_dpp v93, v68, v53 row_newbcast:0 row_mask:0xf bank_mask:0xf
    v_mul_u32_u24_dpp v94, v68, v52 row_newbcast:1 row_mask:0xf bank_mask:0xf
    v_and_b32_dpp v95, v68, v53 row_newbcast:1 row_mask:0xf bank_mask:0xf
    v_mul_u32_u24_dpp v96, v68, v52 row_newbcast:2 row_mask:0xf bank_mask:0xf
    v_and_b32_dpp v97, v68, v53 row_newbcast:2 row_mask:0xf bank_mask:0xf
    v_mul_u32_u24_dpp v98, v68, v52 row_newbcast:3 row_mask:0xf bank_mask:0xf
    v_and_b32_dpp v99, v68, v53 row_newbcast:3 row_mask:0xf bank_mask:0xf
    v_mul_u32_u24_dpp v100, v68, v52 row_newbcast:4 row_mask:0xf bank_mask:0xf
    v_and_b32_dpp v101, v68, v53 row_newbcast:4 row_mask:0xf bank_mask:0xf
    v_mul_u32_u24_dpp v102, v68, v52 row_newbcast:5 row_mask:0xf bank_mask:0xf
    v_and_b32_dpp v103, v68, v53 row_newbcast:5 row_mask:0xf bank_mask:0xf
    v_mul_u32_u24_dpp v104, v68, v52 row_newbcast:6 row_mask:0xf bank_mask:0xf
    v_and_b32_dpp v105, v68, v53 row_newbcast:6 row_mask:0xf bank_mask:0xf
    v_mul_u32_u24_dpp v106, v68, v52 row_newbcast:7 row_mask:0xf bank_mask:0xf
    v_and_b32_dpp v107, v68, v53 row_newbcast:7 row_mask:0xf bank_mask:0xf
    v_mul_u32_u24_dpp v108, v69, v52 row_newbcast:0 row_mask:0xf bank_mask:0xf
    v_and_b32_dpp v109, v69, v53 row_newbcast:0 row_mask:0xf bank_mask:0xf
    v_mul_u32_u24_dpp v110, v69, v52 row_newbcast:1 row_mask:0xf bank_mask:0xf
    v_and_b32_dpp v111, v69, v53 row_newbcast:1 row_mask:0xf bank_mask:0xf
    v_mul_u32_u24_dpp v112, v69, v52 row_newbcast:2 row_mask:0xf bank_mask:0xf
    v_and_b32_dpp v113, v69, v53 row_newbcast:2 row_mask:0xf bank_mask:0xf
    v_mul_u32_u24_dpp v114, v69, v52 row_newbcast:3 row_mask:0xf bank_mask:0xf
    v_and_b32_dpp v115, v69, v53 row_newbcast:3 row_mask:0xf bank_mask:0xf
    v_mul_u32_u24_dpp v116, v69, v52 row_newbcast:4 row_mask:0xf bank_mask:0xf
    v_and_b32_dpp v117, v69, v53 row_newbcast:4 row_mask:0xf bank_mask:0xf
    v_mul_u32_u24_dpp v118, v69, v52 row_newbcast:5 row_mask:0xf bank_mask:0xf
    v_and_b32_dpp v119, v69, v53 row_newbcast:5 row_mask:0xf bank_mask:0xf
    v_mul_u32_u24_dpp v120, v69, v52 row_newbcast:6 row_mask:0xf bank_mask:0xf
    v_and_b32_dpp v121, v69, v53 row_newbcast:6 row_mask:0xf bank_mask:0xf
    v_mul_u32_u24_dpp v122, v69, v52 row_newbcast:7 row_mask:0xf bank_mask:0xf
    v_and_b32_dpp v123, v69, v53 row_newbcast:7 row_mask:0xf bank_mask:0xf
    s_waitcnt vmcnt(0)
    v_bitop3_b32 v4, v127, v131, s4 bitop3:0x7e
    v_bitop3_b32 v4, v4, v135, s4 bitop3:0xf6
    v_bitop3_b32 v4, v4, v139, s4 bitop3:0xf6
    v_cmp_ne_u32 vcc, 0, v4
    s_cbranch_vccz TOK_42
POLL_43:
    s_mov_b32 s13, s19
    buffer_load_dwordx4 v[124:127], v44, s[32:35], s13 offen sc1
    s_add_u32 s13, s19, 8192
    buffer_load_dwordx4 v[128:131], v44, s[32:35], s13 offen sc1
    s_add_u32 s13, s19, 16384
    buffer_load_dwordx4 v[132:135], v44, s[32:35], s13 offen sc1
    s_add_u32 s13, s19, 24576
    buffer_load_dwordx4 v[136:139], v44, s[32:35], s13 offen sc1
    s_waitcnt vmcnt(0)
    v_bitop3_b32 v4, v127, v131, s4 bitop3:0x7e
    v_bitop3_b32 v4, v4, v135, s4 bitop3:0xf6
    v_bitop3_b32 v4, v4, v139, s4 bitop3:0xf6
    v_cmp_ne_u32 vcc, 0, v4
    s_cbranch_vccz PDONE_44
    s_add_u32 s5, s5, 1
    s_cmp_lt_u32 s5, 300000
    s_cbranch_scc1 POLL_43
PDONE_44:
TOK_42:
    s_lshl2_add_u32 s96, s74, s75
    s_lshl_b32 s97, s96, 11
    s_lshl_b32 s98, s3, 8
    s_add_u32 s99, s97, s98
    s_add_u32 s15, s99, 20971520
    v_lshlrev_b32 v44, 7, v1
    s_mov_b64 exec, 3
    buffer_load_dword v44, v44, s[32:35], s15 offen
    s_mov_b64 exec, -1
    s_add_u32 s15, s81, 4096
    s_lshl2_add_u32 m0, s89, 99328
    s_nop 0
    buffer_load_dwordx4 v73, s[60:63], s15 offen nt lds
    v_pk_add_f32 v[124:125], v[124:125], v[128:129]
    v_pk_add_f32 v[132:133], v[132:133], v[136:137]
    v_add_f32 v126, v126, v130
    v_add_f32 v134, v134, v138
    v_pk_add_f32 v[124:125], v[124:125], v[132:133]
    v_add_f32 v126, v126, v134
    v_mov_b32 v127, v125
    s_nop 0
    v_permlane32_swap_b32 v124, v126
    v_permlane32_swap_b32 v125, v127
    v_add_f32 v124, v124, v126
    v_add_f32 v125, v125, v127
    s_nop 1
    v_permlane16_swap_b32 v124, v125
    v_add_f32 v127, v124, v125
    v_add_f32 v124, v124, v125
    s_nop 1
    v_permlane16_swap_b32 v124, v127
    v_mul_f32 v126, 0x3a800000, v124
    v_mul_f32 v124, 0x3a800000, v124
    s_nop 1
    v_permlane32_swap_b32 v124, v126
    v_fma_f32 v21, -v124, v124, v126
    v_cvt_pk_bf16_f32 v20, 0, v124
    v_max_f32 v21, 0, v21
    v_cvt_pk_bf16_f32 v21, 0, v21
    v_add_f32 v21, 0x3727c5ac, v21
    v_cvt_pk_bf16_f32 v21, 0, v21
    v_sqrt_f32 v21, v21
    s_nop 0
    v_cvt_pk_bf16_f32 v21, 0, v21
    s_lshl3_add_u32 s13, s3, 136192
    v_rcp_f32 v21, v21
    v_fma_f32 v127, -v20, v26, v127
    v_mov_b32 v5, s13
    v_mul_f32 v127, v127, v21
    ds_write_b64 v8, v[20:21]
    s_movk_i32 s13, 0xfff
    v_ashrrev_i32 v124, 31, v127
    v_or_b32 v124, 0x80000000, v124
    v_xor_b32 v124, v124, v127
    v_bfi_b32 v48, s13, v22, v124
    s_nop 1
    v_min_u32_dpp v49, v48, v48 row_ror:8 row_mask:0xf bank_mask:0xf
    v_max_u32_dpp v48, v48, v48 row_ror:8 row_mask:0xf bank_mask:0xf
    s_nop 1
    v_min_u32_dpp v50, v48, v48 row_ror:4 row_mask:0xf bank_mask:0xf
    v_max_u32_dpp v49, v49, v49 row_ror:4 row_mask:0xf bank_mask:0xf
    v_max_u32_dpp v48, v48, v48 row_ror:4 row_mask:0xf bank_mask:0xf
    v_max_u32 v49, v49, v50
    s_nop 0
    v_min_u32_dpp v50, v48, v48 row_ror:2 row_mask:0xf bank_mask:0xf
    v_max_u32_dpp v49, v49, v49 row_ror:2 row_mask:0xf bank_mask:0xf
    v_max_u32_dpp v48, v48, v48 row_ror:2 row_mask:0xf bank_mask:0xf
    v_max_u32 v49, v49, v50
    s_nop 0
    v_min_u32_dpp v50, v48, v48 row_ror:1 row_mask:0xf bank_mask:0xf
    v_max_u32_dpp v49, v49, v49 row_ror:1 row_mask:0xf bank_mask:0xf
    v_max_u32_dpp v48, v48, v48 row_ror:1 row_mask:0xf bank_mask:0xf
    v_max_u32 v49, v49, v50
    ds_write_b64 v5, v[48:49]
    v_and_b32 v6, 3, v1
    v_lshlrev_b32 v6, 18, v6
    v_bfe_u32 v9, v1, 2, 2
    v_lshl_add_u32 v6, v9, 13, v6
    s_and_b32 s96, s21, 1
    s_and_b32 s97, s12, 7
    s_lshr_b32 s98, s12, 3
    s_lshl3_add_u32 s99, s97, s98
    s_lshl_b32 s97, s99, 12
    s_lshr_b32 s98, s21, 1
    s_lshl_b32 s99, s98, 6
    s_add_u32 s98, s97, s99
    s_lshl4_add_u32 s97, s96, s98
    s_add_u32 s99, s97, 1048576
    s_add_u32 s14, s99, 2560
    s_waitcnt lgkmcnt(0)
    s_barrier
    s_cmp_ge_u32 s3, 2
    s_cbranch_scc1 L_PR1
    s_setprio 3
L_PR1:
    ds_read_b64 v[48:49], v11
    ds_read_b64 v[20:21], v10
    s_waitcnt lgkmcnt(1)
    v_min_u32_dpp v50, v48, v48 quad_perm:[1,0,3,2] row_mask:0xf bank_mask:0xf
    v_max_u32_dpp v49, v49, v49 quad_perm:[1,0,3,2] row_mask:0xf bank_mask:0xf
    v_max_u32_dpp v48, v48, v48 quad_perm:[1,0,3,2] row_mask:0xf bank_mask:0xf
    v_max_u32 v49, v49, v50
    s_nop 0
    v_min_u32_dpp v50, v48, v48 quad_perm:[2,3,0,1] row_mask:0xf bank_mask:0xf
    v_max_u32_dpp v49, v49, v49 quad_perm:[2,3,0,1] row_mask:0xf bank_mask:0xf
    v_max_u32_dpp v48, v48, v48 quad_perm:[2,3,0,1] row_mask:0xf bank_mask:0xf
    v_max_u32 v49, v49, v50
    s_nop 0
    v_min_u32_dpp v50, v48, v48 row_half_mirror row_mask:0xf bank_mask:0xf
    v_max_u32_dpp v49, v49, v49 row_half_mirror row_mask:0xf bank_mask:0xf
    v_max_u32_dpp v48, v48, v48 row_half_mirror row_mask:0xf bank_mask:0xf
    v_max_u32 v49, v49, v50
    v_or_b32 v50, 1, v49
    v_mov_b32 v49, s4
    v_mov_b32 v51, s4
    s_cmp_lg_u32 s3, 0
    s_cbranch_scc1 L_NOF
    s_mov_b64 exec, 0xffff
    buffer_store_dwordx4 v[48:51], v6, s[32:35], s14 offen sc1
    s_mov_b64 exec, -1
L_NOF:
    s_cmp_lg_u32 s3, 1
    s_cbranch_scc1 L_NOC
    v_and_b32 v4, 16, v1
    v_cmp_eq_u32 vcc, 0, v4
    s_nop 1
    v_cndmask_b32 v4, v50, v48, vcc
    v_not_b32 v4, v4
    v_bfe_u32 v4, v4, 1, 7
    v_lshlrev_b32 v6, 3, v4
    v_mul_u32_u24 v4, 144, v4
    v_add_u32 v6, 135168, v6
    v_and_b32 v5, 15, v1
    v_lshlrev_b32 v5, 3, v5
    v_add_u32 v4, v4, v5
    ds_read_b64 v[128:129], v6
    ds_read_b64 v[124:125], v4 offset:0
    v_and_b32 v6, 15, v1
    v_lshlrev_b32 v6, 4, v6
    v_bfe_u32 v9, v1, 4, 1
    v_lshl_add_u32 v6, v9, 14, v6
    v_lshrrev_b32 v9, 5, v1
    v_lshl_add_u32 v6, v9, 12, v6
    v_bfe_u32 v7, v1, 4, 1
    v_lshlrev_b32 v7, 14, v7
    v_and_b32 v9, 3, v1
    v_lshl_add_u32 v7, v9, 4, v7
    s_lshl_b32 s96, s21, 15
    s_lshl_b32 s97, s12, 8
    s_add_u32 s98, s96, s97
    s_add_u32 s13, s98, 33554432
    s_lshl_b32 s96, s21, 15
    s_lshl_b32 s97, s12, 6
    s_add_u32 s98, s96, s97
    s_add_u32 s99, s98, 8192
    s_add_u32 s16, s99, 33554432
    v_mov_b32 v127, s4
    s_waitcnt lgkmcnt(0)
    v_lshlrev_b32 v132, 16, v124
    v_and_b32 v133, s6, v124
    v_lshlrev_b32 v134, 16, v125
    v_and_b32 v135, s6, v125
    v_pk_add_f32 v[132:133], v[132:133], v[128:129] op_sel_hi:[1,0] neg_lo:[0,1] neg_hi:[0,1]
    v_pk_add_f32 v[134:135], v[134:135], v[128:129] op_sel_hi:[1,0] neg_lo:[0,1] neg_hi:[0,1]
    v_cvt_pk_bf16_f32 v132, 0, v132
    v_cvt_pk_bf16_f32 v133, 0, v133
    v_cvt_pk_bf16_f32 v134, 0, v134
    v_cvt_pk_bf16_f32 v135, 0, v135
    v_pk_mul_f32 v[132:133], v[132:133], v[128:129] op_sel:[0,1]
    v_pk_mul_f32 v[134:135], v[134:135], v[128:129] op_sel:[0,1]
    v_cvt_pk_bf16_f32 v132, 0, v132
    v_cvt_pk_bf16_f32 v133, 0, v133
    v_cvt_pk_bf16_f32 v134, 0, v134
    v_cvt_pk_bf16_f32 v135, 0, v135
    v_pk_mul_f32 v[132:133], v[132:133], v[152:153]
    v_pk_mul_f32 v[134:135], v[134:135], v[154:155]
    v_cvt_pk_bf16_f32 v132, 0, v132
    v_cvt_pk_bf16_f32 v133, 0, v133
    v_cvt_pk_bf16_f32 v134, 0, v134
    v_cvt_pk_bf16_f32 v135, 0, v135
    v_pk_add_f32 v[132:133], v[132:133], v[148:149]
    v_pk_add_f32 v[134:135], v[134:135], v[150:151]
    v_mov_b32 v126, v125
    v_mov_b32 v125, s4
    s_mov_b32 exec_hi, 0
    v_cvt_pk_bf16_f32 v124, v132, v133
    v_cvt_pk_bf16_f32 v126, v134, v135
    s_mov_b32 exec_hi, -1
    v_dot2_f32_bf16 v128, v124, v156, 0
    v_mov_b32 v129, s4
    v_dot2_f32_bf16 v128, v126, v157, v128
    buffer_store_dwordx4 v[124:127], v6, s[32:35], s13 offen sc1
    s_nop 1
    v_add_f32_dpp v128, v128, v128 quad_perm:[1,0,3,2] row_mask:0xf bank_mask:0xf
    s_nop 1
    v_add_f32_dpp v128, v128, v128 quad_perm:[2,3,0,1] row_mask:0xf bank_mask:0xf
    s_nop 1
    v_add_f32_dpp v128, v128, v128 row_half_mirror row_mask:0xf bank_mask:0xf
    s_nop 1
    v_add_f32_dpp v128, v128, v128 row_ror:8 row_mask:0xf bank_mask:0xf
    v_mov_b32 v130, v128
    v_mov_b32 v131, s4
    s_mov_b64 exec, 0xf000f
    buffer_store_dwordx4 v[128:131], v7, s[32:35], s16 offen sc1
    s_mov_b64 exec, -1
L_NOC:
    s_waitcnt lgkmcnt(0)
    s_setprio 0
    s_mov_b64 exec, 0xff
    buffer_store_dwordx4 v[224:227], v228, s[32:35], 0 offen sc1
    s_mov_b64 exec, -1
    s_add_u32 s13, s81, 8192
    s_lshl2_add_u32 m0, s89, 100352
    s_nop 0
    buffer_load_dwordx4 v73, s[60:63], s13 offen nt lds
    s_load_dwordx8 s[24:31], s[32:33], s92 offset:2560 glc
    v_pk_add_f32 v[76:77], v[28:29], v[20:21] op_sel_hi:[1,0] neg_lo:[0,1] neg_hi:[0,1]
    v_pk_add_f32 v[78:79], v[30:31], v[20:21] op_sel_hi:[1,0] neg_lo:[0,1] neg_hi:[0,1]
    v_pk_add_f32 v[80:81], v[32:33], v[20:21] op_sel_hi:[1,0] neg_lo:[0,1] neg_hi:[0,1]
    v_pk_add_f32 v[82:83], v[34:35], v[20:21] op_sel_hi:[1,0] neg_lo:[0,1] neg_hi:[0,1]
    v_pk_add_f32 v[84:85], v[36:37], v[20:21] op_sel_hi:[1,0] neg_lo:[0,1] neg_hi:[0,1]
    v_pk_add_f32 v[86:87], v[38:39], v[20:21] op_sel_hi:[1,0] neg_lo:[0,1] neg_hi:[0,1]
    v_pk_add_f32 v[88:89], v[40:41], v[20:21] op_sel_hi:[1,0] neg_lo:[0,1] neg_hi:[0,1]
    v_pk_add_f32 v[90:91], v[42:43], v[20:21] op_sel_hi:[1,0] neg_lo:[0,1] neg_hi:[0,1]
    v_cvt_pk_bf16_f32 v76, 0, v76
    v_cvt_pk_bf16_f32 v77, 0, v77
    v_cvt_pk_bf16_f32 v78, 0, v78
    v_cvt_pk_bf16_f32 v79, 0, v79
    v_cvt_pk_bf16_f32 v80, 0, v80
    v_cvt_pk_bf16_f32 v81, 0, v81
    v_cvt_pk_bf16_f32 v82, 0, v82
    v_cvt_pk_bf16_f32 v83, 0, v83
    v_cvt_pk_bf16_f32 v84, 0, v84
    v_cvt_pk_bf16_f32 v85, 0, v85
    v_cvt_pk_bf16_f32 v86, 0, v86
    v_cvt_pk_bf16_f32 v87, 0, v87
    v_cvt_pk_bf16_f32 v88, 0, v88
    v_cvt_pk_bf16_f32 v89, 0, v89
    v_cvt_pk_bf16_f32 v90, 0, v90
    v_cvt_pk_bf16_f32 v91, 0, v91
    v_pk_mul_f32 v[76:77], v[76:77], v[20:21] op_sel:[0,1]
    v_pk_mul_f32 v[78:79], v[78:79], v[20:21] op_sel:[0,1]
    v_pk_mul_f32 v[80:81], v[80:81], v[20:21] op_sel:[0,1]
    v_pk_mul_f32 v[82:83], v[82:83], v[20:21] op_sel:[0,1]
    v_pk_mul_f32 v[84:85], v[84:85], v[20:21] op_sel:[0,1]
    v_pk_mul_f32 v[86:87], v[86:87], v[20:21] op_sel:[0,1]
    v_pk_mul_f32 v[88:89], v[88:89], v[20:21] op_sel:[0,1]
    v_pk_mul_f32 v[90:91], v[90:91], v[20:21] op_sel:[0,1]
    v_cvt_pk_bf16_f32 v76, 0, v76
    v_cvt_pk_bf16_f32 v77, 0, v77
    v_cvt_pk_bf16_f32 v78, 0, v78
    v_cvt_pk_bf16_f32 v79, 0, v79
    v_cvt_pk_bf16_f32 v80, 0, v80
    v_cvt_pk_bf16_f32 v81, 0, v81
    v_cvt_pk_bf16_f32 v82, 0, v82
    v_cvt_pk_bf16_f32 v83, 0, v83
    v_cvt_pk_bf16_f32 v84, 0, v84
    v_cvt_pk_bf16_f32 v85, 0, v85
    v_cvt_pk_bf16_f32 v86, 0, v86
    v_cvt_pk_bf16_f32 v87, 0, v87
    v_cvt_pk_bf16_f32 v88, 0, v88
    v_cvt_pk_bf16_f32 v89, 0, v89
    v_cvt_pk_bf16_f32 v90, 0, v90
    v_cvt_pk_bf16_f32 v91, 0, v91
    v_pk_mul_f32 v[76:77], v[76:77], v[108:109]
    v_pk_mul_f32 v[78:79], v[78:79], v[110:111]
    v_pk_mul_f32 v[80:81], v[80:81], v[112:113]
    v_pk_mul_f32 v[82:83], v[82:83], v[114:115]
    v_pk_mul_f32 v[84:85], v[84:85], v[116:117]
    v_pk_mul_f32 v[86:87], v[86:87], v[118:119]
    v_pk_mul_f32 v[88:89], v[88:89], v[120:121]
    v_pk_mul_f32 v[90:91], v[90:91], v[122:123]
    v_cvt_pk_bf16_f32 v76, 0, v76
    v_cvt_pk_bf16_f32 v77, 0, v77
    v_cvt_pk_bf16_f32 v78, 0, v78
    v_cvt_pk_bf16_f32 v79, 0, v79
    v_cvt_pk_bf16_f32 v80, 0, v80
    v_cvt_pk_bf16_f32 v81, 0, v81
    v_cvt_pk_bf16_f32 v82, 0, v82
    v_cvt_pk_bf16_f32 v83, 0, v83
    v_cvt_pk_bf16_f32 v84, 0, v84
    v_cvt_pk_bf16_f32 v85, 0, v85
    v_cvt_pk_bf16_f32 v86, 0, v86
    v_cvt_pk_bf16_f32 v87, 0, v87
    v_cvt_pk_bf16_f32 v88, 0, v88
    v_cvt_pk_bf16_f32 v89, 0, v89
    v_cvt_pk_bf16_f32 v90, 0, v90
    v_cvt_pk_bf16_f32 v91, 0, v91
    v_pk_add_f32 v[76:77], v[76:77], v[92:93]
    v_pk_add_f32 v[78:79], v[78:79], v[94:95]
    v_pk_add_f32 v[80:81], v[80:81], v[96:97]
    v_pk_add_f32 v[82:83], v[82:83], v[98:99]
    v_pk_add_f32 v[84:85], v[84:85], v[100:101]
    v_pk_add_f32 v[86:87], v[86:87], v[102:103]
    v_pk_add_f32 v[88:89], v[88:89], v[104:105]
    v_pk_add_f32 v[90:91], v[90:91], v[106:107]
    v_cvt_pk_bf16_f32 v76, 0, v76
    v_cvt_pk_bf16_f32 v77, 0, v77
    v_cvt_pk_bf16_f32 v78, 0, v78
    v_cvt_pk_bf16_f32 v79, 0, v79
    v_cvt_pk_bf16_f32 v80, 0, v80
    v_cvt_pk_bf16_f32 v81, 0, v81
    v_cvt_pk_bf16_f32 v82, 0, v82
    v_cvt_pk_bf16_f32 v83, 0, v83
    v_cvt_pk_bf16_f32 v84, 0, v84
    v_cvt_pk_bf16_f32 v85, 0, v85
    v_cvt_pk_bf16_f32 v86, 0, v86
    v_cvt_pk_bf16_f32 v87, 0, v87
    v_cvt_pk_bf16_f32 v88, 0, v88
    v_cvt_pk_bf16_f32 v89, 0, v89
    v_cvt_pk_bf16_f32 v90, 0, v90
    v_cvt_pk_bf16_f32 v91, 0, v91
    s_lshr_b32 s96, s3, 2
    s_lshl_b32 s97, s96, 15
    s_and_b32 s98, s3, 3
    s_lshl_b32 s99, s98, 5
    s_add_u32 s96, s97, s99
    s_add_u32 s13, s96, 32768
    v_lshrrev_b32 v24, 4, v1
    v_lshlrev_b32 v24, 13, v24
    v_bfe_u32 v9, v1, 2, 2
    v_lshl_add_u32 v24, v9, 7, v24
    v_bfe_u32 v9, v1, 3, 2
    v_lshl_add_u32 v24, v9, 5, v24
    v_and_b32 v9, 3, v1
    v_lshl_add_u32 v24, v9, 3, v24
    v_xor_b32 v24, s13, v24
    s_lshl_b32 s13, s3, 6
    v_bfe_u32 v45, v1, 2, 1
    v_lshlrev_b32 v45, 9, v45
    v_bfe_u32 v9, v1, 3, 1
    v_lshl_add_u32 v45, v9, 12, v45
    v_lshrrev_b32 v9, 5, v1
    v_lshl_add_u32 v45, v9, 11, v45
    v_bfe_u32 v9, v1, 2, 2
    v_lshl_add_u32 v45, v9, 6, v45
    v_bfe_u32 v9, v1, 4, 1
    v_lshl_add_u32 v45, v9, 5, v45
    v_and_b32 v9, 3, v1
    v_lshl_add_u32 v45, v9, 3, v45
    v_xor_b32 v45, s13, v45
    v_add_u32 v45, 98304, v45
    v_and_b32 v46, 7, v1
    v_lshlrev_b32 v46, 4, v46
    v_lshrrev_b32 v9, 4, v1
    v_lshl_add_u32 v46, v9, 7, v46
    v_add_u32 v46, 136704, v46
    s_lshl4_add_u32 s13, s3, 136256
    v_mov_b32 v4, s13
    v_and_b32 v5, 7, v1
    v_lshlrev_b32 v5, 4, v5
    v_add_u32 v5, 136256, v5
    v_and_b32 v8, 8, v1
    v_cmp_eq_u32 s[22:23], 0, v8
    s_branch SCHK_46
SPOLL_45:
    s_load_dwordx8 s[24:31], s[32:33], s92 offset:2560 glc
SCHK_46:
    s_add_u32 s5, s5, 1
    s_cmp_ge_u32 s5, 300000
    s_waitcnt lgkmcnt(0)
    s_cbranch_scc1 SDONE_47
    s_cmp_lg_u32 s25, s4
    s_cbranch_scc1 SPOLL_45
    s_cmp_lg_u32 s27, s4
    s_cbranch_scc1 SPOLL_45
    s_cmp_lg_u32 s29, s4
    s_cbranch_scc1 SPOLL_45
    s_cmp_lg_u32 s31, s4
    s_cbranch_scc1 SPOLL_45
SDONE_47:
    s_min_u32 s25, s24, s28
    s_max_u32 s24, s24, s28
    s_max_u32 s27, s26, s30
    s_min_u32 s26, s26, s30
    s_max_u32 s28, s25, s27
    s_min_u32 s25, s25, s27
    v_mov_b32 v148, s24
    v_mov_b32 v151, s26
    v_mov_b32 v149, s28
    v_mov_b32 v150, s25
    ds_write_b128 v4, v[148:151]
    s_waitcnt lgkmcnt(0)
    s_barrier
    s_cmp_lt_u32 s3, 4
    s_cbranch_scc1 L_CSEL
    ds_read_b64_tr_b16 v[164:165], v24
    ds_read_b64_tr_b16 v[166:167], v24 offset:512
    ds_read_b64_tr_b16 v[168:169], v24 offset:1024
    ds_read_b64_tr_b16 v[170:171], v24 offset:1536
    ds_read_b64_tr_b16 v[172:173], v24 offset:2048
    ds_read_b64_tr_b16 v[174:175], v24 offset:2560
    ds_read_b64_tr_b16 v[176:177], v24 offset:3072
    ds_read_b64_tr_b16 v[178:179], v24 offset:3584
    ds_read_b64_tr_b16 v[180:181], v24 offset:4096
    ds_read_b64_tr_b16 v[182:183], v24 offset:4608
    ds_read_b64_tr_b16 v[184:185], v24 offset:5120
    ds_read_b64_tr_b16 v[186:187], v24 offset:5632
    ds_read_b64_tr_b16 v[188:189], v24 offset:6144
    ds_read_b64_tr_b16 v[190:191], v24 offset:6656
    ds_read_b64_tr_b16 v[192:193], v24 offset:7168
    ds_read_b64_tr_b16 v[194:195], v24 offset:7680
    v_mul_u32_u24_dpp v92, v70, v52 row_newbcast:0 row_mask:0xf bank_mask:0xf
    v_and_b32_dpp v93, v70, v53 row_newbcast:0 row_mask:0xf bank_mask:0xf
    v_mul_u32_u24_dpp v94, v70, v52 row_newbcast:1 row_mask:0xf bank_mask:0xf
    v_and_b32_dpp v95, v70, v53 row_newbcast:1 row_mask:0xf bank_mask:0xf
    v_mul_u32_u24_dpp v96, v70, v52 row_newbcast:2 row_mask:0xf bank_mask:0xf
    v_and_b32_dpp v97, v70, v53 row_newbcast:2 row_mask:0xf bank_mask:0xf
    v_mul_u32_u24_dpp v98, v70, v52 row_newbcast:3 row_mask:0xf bank_mask:0xf
    v_and_b32_dpp v99, v70, v53 row_newbcast:3 row_mask:0xf bank_mask:0xf
    v_mul_u32_u24_dpp v100, v70, v52 row_newbcast:4 row_mask:0xf bank_mask:0xf
    v_and_b32_dpp v101, v70, v53 row_newbcast:4 row_mask:0xf bank_mask:0xf
    v_mul_u32_u24_dpp v102, v70, v52 row_newbcast:5 row_mask:0xf bank_mask:0xf
    v_and_b32_dpp v103, v70, v53 row_newbcast:5 row_mask:0xf bank_mask:0xf
    v_mul_u32_u24_dpp v104, v70, v52 row_newbcast:6 row_mask:0xf bank_mask:0xf
    v_and_b32_dpp v105, v70, v53 row_newbcast:6 row_mask:0xf bank_mask:0xf
    v_mul_u32_u24_dpp v106, v70, v52 row_newbcast:7 row_mask:0xf bank_mask:0xf
    v_and_b32_dpp v107, v70, v53 row_newbcast:7 row_mask:0xf bank_mask:0xf
    v_pk_mul_f32 v[76:77], v[76:77], v[92:93]
    v_pk_mul_f32 v[78:79], v[78:79], v[94:95]
    v_pk_mul_f32 v[80:81], v[80:81], v[96:97]
    v_pk_mul_f32 v[82:83], v[82:83], v[98:99]
    v_pk_mul_f32 v[84:85], v[84:85], v[100:101]
    v_pk_mul_f32 v[86:87], v[86:87], v[102:103]
    v_pk_mul_f32 v[88:89], v[88:89], v[104:105]
    v_pk_mul_f32 v[90:91], v[90:91], v[106:107]
    v_cvt_pk_bf16_f32 v76, 0, v76
    v_cvt_pk_bf16_f32 v77, 0, v77
    v_cvt_pk_bf16_f32 v78, 0, v78
    v_cvt_pk_bf16_f32 v79, 0, v79
    v_cvt_pk_bf16_f32 v80, 0, v80
    v_cvt_pk_bf16_f32 v81, 0, v81
    v_cvt_pk_bf16_f32 v82, 0, v82
    v_cvt_pk_bf16_f32 v83, 0, v83
    v_cvt_pk_bf16_f32 v84, 0, v84
    v_cvt_pk_bf16_f32 v85, 0, v85
    v_cvt_pk_bf16_f32 v86, 0, v86
    v_cvt_pk_bf16_f32 v87, 0, v87
    v_cvt_pk_bf16_f32 v88, 0, v88
    v_cvt_pk_bf16_f32 v89, 0, v89
    v_cvt_pk_bf16_f32 v90, 0, v90
    v_cvt_pk_bf16_f32 v91, 0, v91
    v_pk_add_f32 v[76:77], v[76:77], v[28:29]
    v_pk_add_f32 v[78:79], v[78:79], v[30:31]
    v_pk_add_f32 v[80:81], v[80:81], v[32:33]
    v_pk_add_f32 v[82:83], v[82:83], v[34:35]
    v_pk_add_f32 v[84:85], v[84:85], v[36:37]
    v_pk_add_f32 v[86:87], v[86:87], v[38:39]
    v_pk_add_f32 v[88:89], v[88:89], v[40:41]
    v_pk_add_f32 v[90:91], v[90:91], v[42:43]
    v_cvt_pk_bf16_f32 v140, v76, v77
    v_cvt_pk_bf16_f32 v141, v78, v79
    v_cvt_pk_bf16_f32 v142, v80, v81
    v_cvt_pk_bf16_f32 v143, v82, v83
    v_cvt_pk_bf16_f32 v144, v84, v85
    v_cvt_pk_bf16_f32 v145, v86, v87
    v_cvt_pk_bf16_f32 v146, v88, v89
    v_cvt_pk_bf16_f32 v147, v90, v91
    ds_write_b128 v23, v[140:143]
    ds_write_b128 v23, v[144:147] offset:16
    s_mul_i32 s96, s3, 2304
    s_add_u32 s16, s96, 139776
    v_lshrrev_b32 v23, 3, v1
    v_mul_u32_u24 v23, 144, v23
    v_and_b32 v9, 7, v1
    v_lshl_add_u32 v23, v9, 4, v23
    v_add_u32 v23, s16, v23
    s_add_u32 s13, s81, 12288
    s_lshl2_add_u32 m0, s89, 101376
    s_nop 0
    buffer_load_dwordx4 v73, s[60:63], s13 offen nt lds
    s_branch L_CSELD
L_CSEL:
    s_setprio 3
    ds_read_b128 v[148:151], v5
    s_lshl_b32 s96, s3, 9
    s_add_u32 s13, s96, 136704
    v_add_u32 v6, s13, v63
    s_lshl2_add_u32 s13, s3, 136384
    v_mov_b32 v7, s13
    s_waitcnt lgkmcnt(0)
    v_max_u32_dpp v152, v151, v148 quad_perm:[1,0,3,2] row_mask:0xf bank_mask:0xf
    v_max_u32_dpp v153, v150, v149 quad_perm:[1,0,3,2] row_mask:0xf bank_mask:0xf
    v_max_u32_dpp v154, v149, v150 quad_perm:[1,0,3,2] row_mask:0xf bank_mask:0xf
    v_max_u32_dpp v155, v148, v151 quad_perm:[1,0,3,2] row_mask:0xf bank_mask:0xf
    v_max_u32 v156, v152, v154
    v_max_u32 v157, v153, v155
    v_min_u32 v158, v152, v154
    v_min_u32 v159, v153, v155
    v_max_u32 v148, v156, v157
    v_min_u32 v149, v156, v157
    v_max_u32 v150, v158, v159
    v_min_u32 v151, v158, v159
    s_nop 1
    v_max_u32_dpp v152, v151, v148 quad_perm:[2,3,0,1] row_mask:0xf bank_mask:0xf
    v_max_u32_dpp v153, v150, v149 quad_perm:[2,3,0,1] row_mask:0xf bank_mask:0xf
    v_max_u32_dpp v154, v149, v150 quad_perm:[2,3,0,1] row_mask:0xf bank_mask:0xf
    v_max_u32_dpp v155, v148, v151 quad_perm:[2,3,0,1] row_mask:0xf bank_mask:0xf
    v_max_u32 v156, v152, v154
    v_max_u32 v157, v153, v155
    v_min_u32 v158, v152, v154
    v_min_u32 v159, v153, v155
    v_max_u32 v148, v156, v157
    v_min_u32 v149, v156, v157
    v_max_u32 v150, v158, v159
    v_min_u32 v151, v158, v159
    s_nop 1
    v_max_u32_dpp v152, v151, v148 row_half_mirror row_mask:0xf bank_mask:0xf
    v_max_u32_dpp v153, v150, v149 row_half_mirror row_mask:0xf bank_mask:0xf
    v_max_u32_dpp v154, v149, v150 row_half_mirror row_mask:0xf bank_mask:0xf
    v_max_u32_dpp v155, v148, v151 row_half_mirror row_mask:0xf bank_mask:0xf
    v_readfirstlane_b32 s24, v152
    v_readfirstlane_b32 s25, v153
    v_readfirstlane_b32 s26, v154
    v_readfirstlane_b32 s27, v155
    s_bitcmp1_b32 s3, 0
    s_cselect_b32 s24, s25, s24
    s_cselect_b32 s26, s27, s26
    s_bitcmp1_b32 s3, 1
    s_cselect_b32 s24, s26, s24
    s_and_b32 s15, s24, 4095
    s_lshr_b32 s96, s15, 8
    s_sub_u32 s97, 15, s96
    s_and_b32 s98, s15, 1
    s_lshl1_add_u32 s99, s97, s98
    s_lshl_b32 s96, s99, 14
    s_add_u32 s13, s96, 33554432
    s_lshl_b32 s96, s75, 10
    s_add_u32 s14, s96, s13
    s_add_u32 s13, s13, 8192
    v_and_b32 v10, 15, v1
    v_lshlrev_b32 v10, 6, v10
    buffer_load_dwordx2 v[152:153], v10, s[32:35], s13 offen sc1
    buffer_load_dwordx4 v[148:151], v2, s[32:35], s14 offen sc1
    s_setprio 0
    s_add_u32 s16, s81, 12288
    s_lshl2_add_u32 m0, s89, 101376
    s_nop 0
    buffer_load_dwordx4 v73, s[60:63], s16 offen nt lds
    ds_read_b64_tr_b16 v[164:165], v24
    ds_read_b64_tr_b16 v[166:167], v24 offset:512
    ds_read_b64_tr_b16 v[168:169], v24 offset:1024
    ds_read_b64_tr_b16 v[170:171], v24 offset:1536
    ds_read_b64_tr_b16 v[172:173], v24 offset:2048
    ds_read_b64_tr_b16 v[174:175], v24 offset:2560
    ds_read_b64_tr_b16 v[176:177], v24 offset:3072
    ds_read_b64_tr_b16 v[178:179], v24 offset:3584
    ds_read_b64_tr_b16 v[180:181], v24 offset:4096
    ds_read_b64_tr_b16 v[182:183], v24 offset:4608
    ds_read_b64_tr_b16 v[184:185], v24 offset:5120
    ds_read_b64_tr_b16 v[186:187], v24 offset:5632
    ds_read_b64_tr_b16 v[188:189], v24 offset:6144
    ds_read_b64_tr_b16 v[190:191], v24 offset:6656
    ds_read_b64_tr_b16 v[192:193], v24 offset:7168
    ds_read_b64_tr_b16 v[194:195], v24 offset:7680
    v_mul_u32_u24_dpp v92, v70, v52 row_newbcast:0 row_mask:0xf bank_mask:0xf
    v_and_b32_dpp v93, v70, v53 row_newbcast:0 row_mask:0xf bank_mask:0xf
    v_mul_u32_u24_dpp v94, v70, v52 row_newbcast:1 row_mask:0xf bank_mask:0xf
    v_and_b32_dpp v95, v70, v53 row_newbcast:1 row_mask:0xf bank_mask:0xf
    v_mul_u32_u24_dpp v96, v70, v52 row_newbcast:2 row_mask:0xf bank_mask:0xf
    v_and_b32_dpp v97, v70, v53 row_newbcast:2 row_mask:0xf bank_mask:0xf
    v_mul_u32_u24_dpp v98, v70, v52 row_newbcast:3 row_mask:0xf bank_mask:0xf
    v_and_b32_dpp v99, v70, v53 row_newbcast:3 row_mask:0xf bank_mask:0xf
    v_mul_u32_u24_dpp v100, v70, v52 row_newbcast:4 row_mask:0xf bank_mask:0xf
    v_and_b32_dpp v101, v70, v53 row_newbcast:4 row_mask:0xf bank_mask:0xf
    v_mul_u32_u24_dpp v102, v70, v52 row_newbcast:5 row_mask:0xf bank_mask:0xf
    v_and_b32_dpp v103, v70, v53 row_newbcast:5 row_mask:0xf bank_mask:0xf
    v_mul_u32_u24_dpp v104, v70, v52 row_newbcast:6 row_mask:0xf bank_mask:0xf
    v_and_b32_dpp v105, v70, v53 row_newbcast:6 row_mask:0xf bank_mask:0xf
    v_mul_u32_u24_dpp v106, v70, v52 row_newbcast:7 row_mask:0xf bank_mask:0xf
    v_and_b32_dpp v107, v70, v53 row_newbcast:7 row_mask:0xf bank_mask:0xf
    v_pk_mul_f32 v[76:77], v[76:77], v[92:93]
    v_pk_mul_f32 v[78:79], v[78:79], v[94:95]
    v_pk_mul_f32 v[80:81], v[80:81], v[96:97]
    v_pk_mul_f32 v[82:83], v[82:83], v[98:99]
    v_pk_mul_f32 v[84:85], v[84:85], v[100:101]
    v_pk_mul_f32 v[86:87], v[86:87], v[102:103]
    v_pk_mul_f32 v[88:89], v[88:89], v[104:105]
    v_pk_mul_f32 v[90:91], v[90:91], v[106:107]
    v_cvt_pk_bf16_f32 v76, 0, v76
    v_cvt_pk_bf16_f32 v77, 0, v77
    v_cvt_pk_bf16_f32 v78, 0, v78
    v_cvt_pk_bf16_f32 v79, 0, v79
    v_cvt_pk_bf16_f32 v80, 0, v80
    v_cvt_pk_bf16_f32 v81, 0, v81
    v_cvt_pk_bf16_f32 v82, 0, v82
    v_cvt_pk_bf16_f32 v83, 0, v83
    v_cvt_pk_bf16_f32 v84, 0, v84
    v_cvt_pk_bf16_f32 v85, 0, v85
    v_cvt_pk_bf16_f32 v86, 0, v86
    v_cvt_pk_bf16_f32 v87, 0, v87
    v_cvt_pk_bf16_f32 v88, 0, v88
    v_cvt_pk_bf16_f32 v89, 0, v89
    v_cvt_pk_bf16_f32 v90, 0, v90
    v_cvt_pk_bf16_f32 v91, 0, v91
    v_pk_add_f32 v[76:77], v[76:77], v[28:29]
    v_pk_add_f32 v[78:79], v[78:79], v[30:31]
    v_pk_add_f32 v[80:81], v[80:81], v[32:33]
    v_pk_add_f32 v[82:83], v[82:83], v[34:35]
    v_pk_add_f32 v[84:85], v[84:85], v[36:37]
    v_pk_add_f32 v[86:87], v[86:87], v[38:39]
    v_pk_add_f32 v[88:89], v[88:89], v[40:41]
    v_pk_add_f32 v[90:91], v[90:91], v[42:43]
    v_cvt_pk_bf16_f32 v140, v76, v77
    v_cvt_pk_bf16_f32 v141, v78, v79
    v_cvt_pk_bf16_f32 v142, v80, v81
    v_cvt_pk_bf16_f32 v143, v82, v83
    v_cvt_pk_bf16_f32 v144, v84, v85
    v_cvt_pk_bf16_f32 v145, v86, v87
    v_cvt_pk_bf16_f32 v146, v88, v89
    v_cvt_pk_bf16_f32 v147, v90, v91
    ds_write_b128 v23, v[140:143]
    ds_write_b128 v23, v[144:147] offset:16
    s_mul_i32 s96, s3, 2304
    s_add_u32 s16, s96, 139776
    v_lshrrev_b32 v23, 3, v1
    v_mul_u32_u24 v23, 144, v23
    v_and_b32 v9, 7, v1
    v_lshl_add_u32 v23, v9, 4, v23
    v_add_u32 v23, s16, v23
    s_lshl2_add_u32 s15, s15, s3
    s_waitcnt vmcnt(1)
    v_bitop3_b32 v8, v149, v151, s4 bitop3:0x7e
    v_bitop3_b32 v8, v8, v153, s4 bitop3:0xf6
    v_cmp_ne_u32 vcc, 0, v8
    s_cbranch_vccz TOK_49
POLL_50:
    buffer_load_dwordx2 v[152:153], v10, s[32:35], s13 offen sc1
    buffer_load_dwordx4 v[148:151], v2, s[32:35], s14 offen sc1
    s_waitcnt vmcnt(0)
    v_bitop3_b32 v8, v149, v151, s4 bitop3:0x7e
    v_bitop3_b32 v8, v8, v153, s4 bitop3:0xf6
    v_cmp_ne_u32 vcc, 0, v8
    s_cbranch_vccz PDONE_51
    s_add_u32 s5, s5, 1
    s_cmp_lt_u32 s5, 300000
    s_cbranch_scc1 POLL_50
PDONE_51:
TOK_49:
    s_setprio 3
    ds_write2_b32 v6, v148, v150 offset0:0 offset1:1
    v_add_f32_dpp v152, v152, v152 quad_perm:[1,0,3,2] row_mask:0xf bank_mask:0xf
    s_nop 1
    v_add_f32_dpp v152, v152, v152 quad_perm:[2,3,0,1] row_mask:0xf bank_mask:0xf
    s_nop 1
    v_add_f32_dpp v152, v152, v152 row_half_mirror row_mask:0xf bank_mask:0xf
    s_nop 1
    v_add_f32_dpp v152, v152, v152 row_ror:8 row_mask:0xf bank_mask:0xf
    v_cvt_pk_bf16_f32 v152, 0, v152
    v_ashrrev_i32 v153, 31, v152
    v_or_b32 v153, 0x80000000, v153
    v_xor_b32 v152, v152, v153
    v_and_b32 v152, s6, v152
    v_or_b32 v152, s15, v152
    ds_write_b32 v7, v152
    s_setprio 0
L_CSELD:
    v_mov_b32 v4, 136384
    s_lshl_b32 s96, s74, 13
    s_add_u32 s14, s96, 20971520
    s_mul_i32 s96, s90, s76
    s_lshl_b32 s97, s96, 13
    s_lshl3_add_u32 s98, s75, s3
    s_lshl_b32 s99, s98, 8
    s_add_u32 s96, s97, s99
    s_add_u32 s20, s96, s14
    s_waitcnt lgkmcnt(0)
    s_barrier
    ds_read_b128 v[148:151], v4
    s_waitcnt lgkmcnt(0)
    v_max_u32 v152, v148, v149
    v_max_u32 v153, v150, v151
    v_min_u32 v154, v148, v149
    v_min_u32 v155, v150, v151
    v_min_u32 v149, v152, v153
    v_max_u32 v148, v152, v153
    v_max3_u32 v149, v149, v154, v155
    v_cndmask_b32 v4, v149, v148, s[22:23]
    v_readfirstlane_b32 s68, v148
    v_and_b32 v4, 3, v4
    v_readfirstlane_b32 s69, v149
    v_lshl_add_u32 v4, v4, 9, v46
    ds_read_b128 v[152:155], v4
    ds_read_b128 v[140:143], v23
    ds_read_b128 v[144:147], v23 offset:1152
    s_bfe_u32 s70, s68, 720899
    s_bfe_u32 s71, s69, 720899
    s_sub_u32 s70, 2047, s70
    s_sub_u32 s71, 2047, s71
    s_waitcnt lgkmcnt(2)
    v_mfma_f32_16x16x32_bf16 v[212:215], v[152:155], v[164:167], 0
    v_mfma_f32_16x16x32_bf16 v[216:219], v[152:155], v[168:171], 0
    v_mfma_f32_16x16x32_bf16 v[220:223], v[152:155], v[172:175], 0
    v_mfma_f32_16x16x32_bf16 v[224:227], v[152:155], v[176:179], 0
    v_mfma_f32_16x16x32_bf16 v[228:231], v[152:155], v[180:183], 0
    v_mfma_f32_16x16x32_bf16 v[232:235], v[152:155], v[184:187], 0
    v_mfma_f32_16x16x32_bf16 v[236:239], v[152:155], v[188:191], 0
    v_mfma_f32_16x16x32_bf16 v[240:243], v[152:155], v[192:195], 0
    s_nop 1
    v_add_f32 v148, v212, v217
    s_nop 0
    v_add_f32 v149, v222, v227
    s_nop 0
    v_add_f32 v150, v228, v233
    s_nop 0
    v_add_f32 v151, v238, v243
    v_add_f32 v148, v148, v149
    v_add_f32 v150, v150, v151
    s_nop 1
    v_permlane16_swap_b32 v150, v151
    v_add_f32 v56, v148, v151
    v_add_f32 v58, v148, v151
    v_mov_b32 v57, s4
    v_mov_b32 v59, s4
    v_permlane32_swap_b32 v56, v58
    s_cmp_ge_u32 s9, 28
    s_cbranch_scc1 L_NOHP
    s_mov_b64 exec, 0xffff
    s_cmp_lg_u32 s93, 0
    s_cbranch_scc1 LOC_52
    buffer_store_dwordx4 v[56:59], v2, s[32:35], s20 offen sc1
    s_branch LOCD_53
LOC_52:
    buffer_store_dwordx4 v[56:59], v2, s[32:35], s20 offen
LOCD_53:
    s_mov_b64 exec, -1
L_NOHP:
    v_add_u32 v60, s20, v2
    s_waitcnt lgkmcnt(0)
    s_bitcmp1_b32 s21, 2
    s_cselect_b32 s17, s71, s70
    s_cselect_b32 s18, s69, s68
    s_cmp_lg_u32 s3, 7
    s_cbranch_scc1 L_NOFZ
    s_cmp_lg_u32 s2, 0
    s_cbranch_scc1 L_NONON
    v_mov_b32 v6, s4
    s_mov_b64 exec, 1
    buffer_store_dword v6, v3, s[32:35], 0 offen sc1
    s_mov_b64 exec, -1
L_NONON:
    s_lshr_b32 s96, s21, 3
    s_and_b32 s97, s21, 1
    s_lshl1_add_u32 s19, s96, s97
    s_lshr_b32 s96, s21, 2
    s_lshl_b32 s97, s96, 1
    s_lshl3_add_u32 s98, s12, s97
    s_and_b32 s99, s21, 1
    s_add_u32 s96, s98, s99
    s_mul_i32 s97, s96, 7168
    s_add_u32 s20, s97, 22020096
    s_lshl_b32 s96, s17, 11
    s_lshl_b32 s97, s12, 7
    s_add_u32 s98, s96, s97
    s_lshl_b32 s99, s19, 5
    s_add_u32 s82, s98, s99
    v_and_b32 v10, 1, v1
    v_lshlrev_b32 v10, 2, v10
    v_bfe_u32 v9, v1, 2, 1
    v_lshl_add_u32 v10, v9, 3, v10
    v_bfe_u32 v9, v1, 1, 1
    v_lshl_add_u32 v10, v9, 4, v10
    s_lshl_b32 s96, s19, 5
    s_add_u32 s13, s96, 139264
    v_add_u32 v5, s13, v10
    ds_read_b32 v74, v5
    s_lshr_b32 s96, s17, 7
    s_bfe_u32 s97, s18, 65538
    s_lshl1_add_u32 s98, s96, s97
    s_lshl_b32 s99, s98, 14
    s_lshl_b32 s96, s12, 8
    s_add_u32 s97, s99, s96
    s_lshl_b32 s98, s19, 6
    s_add_u32 s99, s97, s98
    s_add_u32 s68, s99, 33554432
    s_add_u32 s69, s68, 4096
    v_and_b32 v11, 1, v1
    v_lshlrev_b32 v11, 3, v11
    v_bfe_u32 v9, v1, 2, 1
    v_lshl_add_u32 v11, v9, 4, v11
    v_bfe_u32 v9, v1, 1, 1
    v_lshl_add_u32 v11, v9, 5, v11
    buffer_load_dwordx2 v[20:21], v11, s[32:35], s68 offen sc1
    buffer_load_dwordx2 v[72:73], v11, s[32:35], s69 offen sc1
    s_and_b32 s13, s18, s6
    s_ashr_i32 s15, s13, 31
    s_andn2_b32 s15, 0x7fff0000, s15
    s_or_b32 s15, s15, 0x80000000
    s_xor_b32 s13, s13, s15
    v_mov_b32 v75, s13
    v_mul_f32 v75, s7, v75
    v_exp_f32 v75, -v75
    s_nop 0
    v_add_f32 v75, 1.0, v75
    v_rcp_f32 v75, v75
    s_nop 0
    v_cvt_pk_bf16_f32 v75, 0, v75
L_NOFZ:
    s_cmp_lt_u32 s9, 28
    s_cbranch_scc1 L_HSEC
    s_branch L_GSEC
L_HSEC:
    s_cmp_lt_u32 s3, 4
    s_cbranch_scc1 L_HW
    s_branch L_NOH
L_HW:
    s_lshl_b32 s96, s3, 8
    s_add_u32 s13, s96, s14
    v_lshrrev_b32 v4, 4, v1
    v_lshlrev_b32 v4, 11, v4
    v_and_b32 v9, 15, v1
    v_lshl_add_u32 v4, v9, 4, v4
    s_lshl_b32 s96, s3, 5
    s_add_u32 s15, s96, 138752
    v_lshrrev_b32 v5, 5, v1
    v_lshl_add_u32 v5, v5, 7, s15
    v_bfe_u32 v9, v1, 2, 1
    v_lshl_add_u32 v5, v9, 4, v5
    v_bfe_u32 v9, v1, 1, 1
    v_lshl_add_u32 v5, v9, 3, v5
    v_bfe_u32 v9, v1, 3, 1
    v_lshl_add_u32 v5, v9, 2, v5
    v_and_b32 v9, 1, v1
    v_lshl_add_u32 v5, v9, 1, v5
    s_cmp_lg_u32 s93, 0
    s_cbranch_scc1 L_HLOC
SPOLL_54:
    s_load_dword s24, s[32:33], s13 offset:1276 glc
    s_load_dword s25, s[32:33], s13 offset:3324 glc
    s_load_dword s26, s[32:33], s13 offset:5372 glc
    s_load_dword s27, s[32:33], s13 offset:7420 glc
SCHK_55:
    s_add_u32 s5, s5, 1
    s_cmp_ge_u32 s5, 300000
    s_waitcnt lgkmcnt(0)
    s_cbranch_scc1 SDONE_56
    s_cmp_lg_u32 s24, s4
    s_cbranch_scc1 SPOLL_54
    s_cmp_lg_u32 s25, s4
    s_cbranch_scc1 SPOLL_54
    s_cmp_lg_u32 s26, s4
    s_cbranch_scc1 SPOLL_54
    s_cmp_lg_u32 s27, s4
    s_cbranch_scc1 SPOLL_54
SDONE_56:
L_HLOC:
    buffer_load_dwordx4 v[212:215], v4, s[32:35], s13 offen sc1
    buffer_load_dwordx4 v[216:219], v4, s[32:35], s13 offen offset:1024 sc1
    s_waitcnt vmcnt(0)
    v_bitop3_b32 v6, v213, v215, s4 bitop3:0x7e
    v_bitop3_b32 v6, v6, v217, s4 bitop3:0xf6
    v_bitop3_b32 v6, v6, v219, s4 bitop3:0xf6
    v_cmp_ne_u32 vcc, 0, v6
    s_cbranch_vccz TOK_58
POLL_59:
    buffer_load_dwordx4 v[212:215], v4, s[32:35], s13 offen sc1
    buffer_load_dwordx4 v[216:219], v4, s[32:35], s13 offen offset:1024 sc1
    s_waitcnt vmcnt(0)
    v_bitop3_b32 v6, v213, v215, s4 bitop3:0x7e
    v_bitop3_b32 v6, v6, v217, s4 bitop3:0xf6
    v_bitop3_b32 v6, v6, v219, s4 bitop3:0xf6
    v_cmp_ne_u32 vcc, 0, v6
    s_cbranch_vccz PDONE_60
    s_add_u32 s5, s5, 1
    s_cmp_lt_u32 s5, 300000
    s_cbranch_scc1 POLL_59
PDONE_60:
TOK_58:
    v_permlane32_swap_b32 v212, v214
    v_permlane32_swap_b32 v216, v218
    v_add_f32 v212, v212, v214
    v_add_f32 v216, v216, v218
    v_mov_b32 v214, v212
    v_mov_b32 v218, v216
    s_nop 0
    v_permlane16_swap_b32 v212, v214
    v_permlane16_swap_b32 v216, v218
    v_add_f32 v212, v212, v214
    v_add_f32 v216, v216, v218
    v_cvt_pk_bf16_f32 v212, 0, v212
    v_cvt_pk_bf16_f32 v216, 0, v216
    v_mul_f32 v6, s7, v212
    v_exp_f32 v6, -v6
    s_nop 0
    v_add_f32 v6, 1.0, v6
    v_rcp_f32 v6, v6
    s_nop 0
    v_mul_f32 v212, v212, v6
    v_cvt_pk_bf16_f32 v212, 0, v212
    v_mul_f32 v212, v212, v216
    v_cvt_pk_bf16_f32 v212, v212, v212
    ds_write_b16 v5, v212
L_NOH:
    v_bfe_u32 v4, v1, 2, 1
    v_lshlrev_b32 v4, 7, v4
    v_lshrrev_b32 v9, 5, v1
    v_lshl_add_u32 v4, v9, 4, v4
    v_add_u32 v4, 138752, v4
    v_lshrrev_b32 v5, 4, v1
    v_mul_u32_u24 v5, 7168, v5
    v_and_b32 v9, 7, v1
    v_lshl_add_u32 v5, v9, 4, v5
    v_and_b32 v6, 1, v1
    v_lshlrev_b32 v6, 18, v6
    v_bfe_u32 v9, v1, 1, 1
    v_lshl_add_u32 v6, v9, 13, v6
    s_lshl3_add_u32 s96, s75, s3
    s_mul_i32 s97, s96, 28672
    s_lshl_b32 s98, s74, 7
    s_add_u32 s99, s97, s98
    s_add_u32 s13, s99, 22020096
    s_lshr_b32 s96, s9, 2
    s_and_b32 s97, s75, 1
    s_lshr_b32 s98, s3, 1
    s_lshl2_add_u32 s99, s97, s98
    s_and_b32 s97, s3, 1
    s_lshl_b32 s98, s97, 2
    s_lshl3_add_u32 s97, s99, s98
    s_lshr_b32 s99, s75, 1
    s_add_u32 s98, s97, s99
    s_lshl_b32 s97, s98, 12
    s_lshl_b32 s99, s8, 6
    s_add_u32 s98, s97, s99
    s_lshl2_add_u32 s97, s96, s98
    s_add_u32 s99, s97, 1048576
    s_add_u32 s14, s99, 3072
    s_waitcnt vmcnt(0)
    s_waitcnt lgkmcnt(0)
    s_barrier
    ds_read_b128 v[212:215], v4
    ds_read_b64_tr_b16 v[196:197], v45
    ds_read_b64_tr_b16 v[198:199], v45 offset:1024
    ds_read_b128 v[216:219], v4 offset:32
    ds_read_b64_tr_b16 v[200:201], v45 offset:8192
    ds_read_b64_tr_b16 v[202:203], v45 offset:9216
    ds_read_b128 v[220:223], v4 offset:64
    ds_read_b64_tr_b16 v[204:205], v45 offset:16384
    ds_read_b64_tr_b16 v[206:207], v45 offset:17408
    ds_read_b128 v[224:227], v4 offset:96
    ds_read_b64_tr_b16 v[208:209], v45 offset:24576
    ds_read_b64_tr_b16 v[210:211], v45 offset:25600
    s_waitcnt lgkmcnt(9)
    v_mfma_f32_32x32x16_bf16 v[228:243], v[212:215], v[196:199], 0
    s_waitcnt lgkmcnt(6)
    v_mfma_f32_32x32x16_bf16 v[228:243], v[216:219], v[200:203], v[228:243]
    s_waitcnt lgkmcnt(3)
    v_mfma_f32_32x32x16_bf16 v[228:243], v[220:223], v[204:207], v[228:243]
    s_waitcnt lgkmcnt(0)
    v_mfma_f32_32x32x16_bf16 v[228:243], v[224:227], v[208:211], v[228:243]
    s_nop 11
    v_mov_b32_dpp v230, v228 row_ror:8 row_mask:0xf bank_mask:0xf
    v_mov_b32 v229, s4
    v_mov_b32 v231, s4
    s_mov_b32 exec_lo, 0x00ff00ff
    s_mov_b32 exec_hi, 0x00ff00ff
    buffer_store_dwordx4 v[228:231], v5, s[32:35], s13 offen sc1
    s_mov_b64 exec, 15
    buffer_store_dword v229, v6, s[32:35], s14 offen sc1
    s_mov_b64 exec, -1
    s_waitcnt lgkmcnt(0)
L_GSEC:
    s_lshl_b32 s96, s21, 7
    s_lshl4_add_u32 s13, s3, s96
    v_lshrrev_b32 v22, 3, v1
    v_lshl_add_u32 v22, v22, 0, s13
    s_lshl_b32 s96, s13, 11
    s_lshl_b32 s97, s12, 7
    s_add_u32 s15, s96, s97
    s_add_u32 s16, s15, 16384
    v_lshrrev_b32 v25, 3, v1
    v_lshlrev_b32 v25, 11, v25
    v_and_b32 v9, 7, v1
    v_lshl_add_u32 v25, v9, 4, v25
    v_cmp_ne_u32 vcc, s70, v22
    v_cmp_ne_u32 s[22:23], s71, v22
    s_nop 0
    s_and_b64 exec, vcc, s[22:23]
    buffer_store_dwordx4 v[140:143], v25, s[64:67], s15 offen sc1
    s_mov_b64 exec, -1
    v_add_u32 v22, 8, v22
    v_cmp_ne_u32 vcc, s70, v22
    v_cmp_ne_u32 s[22:23], s71, v22
    s_nop 0
    s_and_b64 exec, vcc, s[22:23]
    buffer_store_dwordx4 v[144:147], v25, s[64:67], s16 offen sc1
    s_mov_b64 exec, -1
    s_cmp_lt_u32 s9, 16
    s_cbranch_scc1 L_GF
    s_cmp_ge_u32 s9, 28
    s_cbranch_scc1 L_FIN
    s_waitcnt vmcnt(0)
    s_mov_b64 exec, 0xffff
    buffer_store_dwordx4 v[56:59], v60, s[32:35], 0 offen sc1
    s_mov_b64 exec, -1
    s_branch L_FIN
L_GF:
SPOLL_61:
    s_load_dwordx8 s[24:31], s[32:33], s92 offset:3072 glc
SCHK_62:
    s_add_u32 s5, s5, 1
    s_cmp_ge_u32 s5, 300000
    s_waitcnt lgkmcnt(0)
    s_cbranch_scc1 SDONE_63
    s_cmp_lg_u32 s24, s4
    s_cbranch_scc1 SPOLL_61
    s_cmp_lg_u32 s25, s4
    s_cbranch_scc1 SPOLL_61
    s_cmp_lg_u32 s26, s4
    s_cbranch_scc1 SPOLL_61
    s_cmp_lg_u32 s27, s4
    s_cbranch_scc1 SPOLL_61
    s_cmp_lg_u32 s28, s4
    s_cbranch_scc1 SPOLL_61
    s_cmp_lg_u32 s29, s4
    s_cbranch_scc1 SPOLL_61
    s_cmp_lg_u32 s30, s4
    s_cbranch_scc1 SPOLL_61
SDONE_63:
    s_barrier
    s_cmp_eq_u32 s3, 7
    s_cbranch_scc1 L_G7
    s_barrier
    s_mov_b64 exec, 0xffff
    buffer_store_dwordx4 v[56:59], v60, s[32:35], 0 offen sc1
    s_mov_b64 exec, -1
    s_branch L_FIN
L_G7:
    s_cmp_lg_u32 s3, 7
    s_cbranch_scc1 L_FIN
    s_add_u32 s13, s20, 4096
POLL_64:
    buffer_load_dwordx4 v[212:215], v2, s[32:35], s20 offen sc1
    buffer_load_dwordx4 v[216:219], v2, s[32:35], s20 offen offset:1024 sc1
    buffer_load_dwordx4 v[220:223], v2, s[32:35], s20 offen offset:2048 sc1
    buffer_load_dwordx4 v[224:227], v2, s[32:35], s20 offen offset:3072 sc1
    buffer_load_dwordx4 v[148:151], v2, s[32:35], s13 offen sc1
    buffer_load_dwordx4 v[152:155], v2, s[32:35], s13 offen offset:1024 sc1
    buffer_load_dwordx4 v[156:159], v2, s[32:35], s13 offen offset:2048 sc1
    s_waitcnt vmcnt(0)
    v_bitop3_b32 v4, v213, v215, s4 bitop3:0x7e
    v_bitop3_b32 v4, v4, v217, s4 bitop3:0xf6
    v_bitop3_b32 v4, v4, v219, s4 bitop3:0xf6
    v_bitop3_b32 v4, v4, v221, s4 bitop3:0xf6
    v_bitop3_b32 v4, v4, v223, s4 bitop3:0xf6
    v_bitop3_b32 v4, v4, v225, s4 bitop3:0xf6
    v_bitop3_b32 v4, v4, v227, s4 bitop3:0xf6
    v_bitop3_b32 v4, v4, v149, s4 bitop3:0xf6
    v_bitop3_b32 v4, v4, v151, s4 bitop3:0xf6
    v_bitop3_b32 v4, v4, v153, s4 bitop3:0xf6
    v_bitop3_b32 v4, v4, v155, s4 bitop3:0xf6
    v_bitop3_b32 v4, v4, v157, s4 bitop3:0xf6
    v_bitop3_b32 v4, v4, v159, s4 bitop3:0xf6
    v_cmp_ne_u32 vcc, 0, v4
    s_cbranch_vccz PDONE_65
    s_add_u32 s5, s5, 1
    s_cmp_lt_u32 s5, 300000
    s_cbranch_scc1 POLL_64
PDONE_65:
    v_bitop3_b32 v4, v21, v73, s4 bitop3:0x7e
    v_cmp_ne_u32 vcc, 0, v4
    s_cbranch_vccz TOK_66
POLL_67:
    buffer_load_dwordx2 v[20:21], v11, s[32:35], s68 offen sc1
    buffer_load_dwordx2 v[72:73], v11, s[32:35], s69 offen sc1
    s_waitcnt vmcnt(0)
    v_bitop3_b32 v4, v21, v73, s4 bitop3:0x7e
    v_cmp_ne_u32 vcc, 0, v4
    s_cbranch_vccz PDONE_68
    s_add_u32 s5, s5, 1
    s_cmp_lt_u32 s5, 300000
    s_cbranch_scc1 POLL_67
PDONE_68:
TOK_66:
    s_barrier
    v_add_f32 v212, v212, v216
    v_add_f32 v214, v214, v218
    v_add_f32 v220, v220, v224
    v_add_f32 v222, v222, v226
    v_add_f32 v148, v148, v152
    v_add_f32 v150, v150, v154
    v_add_f32 v212, v212, v220
    v_add_f32 v214, v214, v222
    v_add_f32 v148, v148, v156
    v_add_f32 v150, v150, v158
    v_add_f32 v212, v212, v148
    v_add_f32 v214, v214, v150
    v_mov_b32 v213, v214
    v_add_f32_dpp v212, v212, v212 row_ror:8 row_mask:0xf bank_mask:0xf
    s_nop 0
    v_add_f32_dpp v213, v213, v213 row_ror:8 row_mask:0xf bank_mask:0xf
    v_mov_b32 v214, v212
    v_mov_b32 v215, v213
    s_nop 0
    v_permlane16_swap_b32 v212, v214
    v_permlane16_swap_b32 v213, v215
    v_pk_add_f32 v[212:213], v[212:213], v[214:215]
    v_mov_b32 v214, v212
    v_mov_b32 v215, v213
    s_nop 0
    v_permlane32_swap_b32 v212, v214
    v_permlane32_swap_b32 v213, v215
    v_pk_add_f32 v[212:213], v[212:213], v[214:215]
    s_nop 1
    v_mov_b32_dpp v214, v212 quad_perm:[0,2,0,2] row_mask:0xf bank_mask:0xf
    v_mov_b32_dpp v215, v212 quad_perm:[1,3,1,3] row_mask:0xf bank_mask:0xf
    v_mov_b32_dpp v212, v213 quad_perm:[0,2,0,2] row_mask:0xf bank_mask:0xf
    v_mov_b32_dpp v213, v213 quad_perm:[1,3,1,3] row_mask:0xf bank_mask:0xf
    s_mov_b32 exec_lo, 0x33333333
    v_mov_b32 v212, v214
    v_mov_b32 v213, v215
    s_mov_b32 exec_lo, -1
    v_cvt_pk_bf16_f32 v212, 0, v212
    v_cvt_pk_bf16_f32 v213, 0, v213
    v_pk_mul_f32 v[212:213], v[212:213], v[74:75] op_sel:[0,1]
    v_lshlrev_b32 v4, 16, v20
    v_and_b32 v5, s6, v20
    v_cvt_pk_bf16_f32 v212, 0, v212
    v_cvt_pk_bf16_f32 v213, 0, v213
    v_pk_add_f32 v[212:213], v[212:213], v[4:5]
    v_lshlrev_b32 v4, 16, v74
    v_and_b32 v5, s6, v74
    v_cvt_pk_bf16_f32 v212, 0, v212
    v_cvt_pk_bf16_f32 v213, 0, v213
    v_pk_mul_f32 v[212:213], v[212:213], v[4:5]
    v_lshlrev_b32 v4, 16, v72
    v_and_b32 v5, s6, v72
    v_cvt_pk_bf16_f32 v212, 0, v212
    v_cvt_pk_bf16_f32 v213, 0, v213
    v_pk_add_f32 v[212:213], v[212:213], v[4:5]
    v_cvt_pk_bf16_f32 v212, v212, v213
    s_mov_b64 exec, 0xff
    buffer_store_dword v212, v10, s[64:67], s82 offen sc1
    s_mov_b64 exec, -1
    s_mov_b64 exec, 0xffff
    buffer_store_dwordx4 v[56:59], v60, s[32:35], 0 offen sc1
    s_mov_b64 exec, -1
L_FIN:
L_END:
    s_endpgm
.p2align 10
.fill 768, 4, 0xbf800000
.section .rodata,"a"
.p2align 6
.amdhsa_kernel adaLN_cond__linear_kernel_hedgehog__moe_arch_mod__prompt_kernel
  .amdhsa_next_free_vgpr 256
  .amdhsa_next_free_sgpr 102
  .amdhsa_accum_offset 256
  .amdhsa_group_segment_fixed_size 0
  .amdhsa_kernarg_size 112
  .amdhsa_user_sgpr_count 2
  .amdhsa_user_sgpr_kernarg_segment_ptr 1
  .amdhsa_system_sgpr_workgroup_id_x 1
  .amdhsa_float_denorm_mode_32 3
  .amdhsa_float_denorm_mode_16_64 3
.end_amdhsa_kernel
```

```asm
; @launch grid=(256,1,1) block=(512,1,1) lds=163840
.amdgcn_target "amdgcn-amd-amdhsa--gfx950"
.text
.globl adaLN_cond__linear_kernel_hedgehog__moe_arch_mod__prompt_kernel
.p2align 8
.type adaLN_cond__linear_kernel_hedgehog__moe_arch_mod__prompt_kernel,@function
adaLN_cond__linear_kernel_hedgehog__moe_arch_mod__prompt_kernel:
    s_load_dwordx16 s[68:83], s[0:1], 0
    s_load_dwordx8 s[84:91], s[0:1], 64
    s_load_dwordx2 s[32:33], s[0:1], 104
    s_load_dwordx2 s[30:31], s[0:1], 96
    s_cmp_ge_u32 s2, 256
    s_cbranch_scc1 L_END
    v_lshrrev_b32 v4, 6, v0
    v_and_b32 v1, 63, v0
    v_mov_b32 v3, 0
    v_readfirstlane_b32 s3, v4
    v_lshlrev_b32 v2, 4, v1
    s_and_b32 s8, s2, 7
    s_lshr_b32 s9, s2, 3
    s_lshl2_add_u32 s96, s8, s3
    s_lshl_b32 s15, s96, 6
    s_mul_i32 s96, s15, 6144
    s_xor_b32 s97, s9, 1
    s_lshl_b32 s98, s97, 7
    s_add_u32 s13, s96, s98
    v_lshrrev_b32 v60, 3, v1
    v_mul_u32_u24 v60, 49152, v60
    v_and_b32 v9, 7, v1
    v_lshl_add_u32 v60, v9, 4, v60
    v_lshrrev_b32 v61, 3, v1
    v_lshl_add_u32 v61, v61, 3, s15
    s_lshl_b32 s96, s8, 5
    s_add_u32 s97, s96, s9
    s_lshl2_add_u32 s98, s97, s3
    s_sub_u32 s99, s98, 4
    s_lshl_b32 s16, s99, 12
    s_mov_b32 s50, 12582912
    s_mov_b32 s51, 0x20000
    s_mov_b32 s38, 4194304
    s_mov_b32 s39, 0x20000
    s_mov_b32 s34, 268435456
    s_mov_b32 s35, 0x20000
    s_getreg_b32 s94, hwreg(HW_REG_XCC_ID, 0, 3)
    s_getpc_b64 s[22:23]
    s_mul_i32 s96, s9, 7
    s_add_u32 s97, s96, s3
    s_lshl_b32 s19, s97, 7
    v_lshrrev_b32 v10, 5, v1
    v_mul_u32_u24 v10, 28672, v10
    v_add_u32 v10, s19, v10
    v_min_u32 v10, 45056, v10
    s_cmp_ge_u32 s3, 4
    s_waitcnt lgkmcnt(0)
    s_mov_b64 s[48:49], s[88:89]
    s_mov_b64 s[36:37], s[68:69]
    s_load_dword s4, s[32:33], 0
    s_cbranch_scc1 L_FS
    global_load_dwordx2 v[96:97], v61, s[86:87]
    buffer_load_dwordx4 v[80:83], v60, s[48:51], s13 offen nt
    s_add_u32 s13, s13, 12288
    buffer_load_dwordx4 v[84:87], v60, s[48:51], s13 offen nt
    s_add_u32 s13, s13, 12288
    buffer_load_dwordx4 v[88:91], v60, s[48:51], s13 offen nt
    s_add_u32 s13, s13, 12288
    buffer_load_dwordx4 v[92:95], v60, s[48:51], s13 offen nt
    s_barrier
    s_barrier
    s_and_b32 s22, s22, 0xfffffc00
    global_load_dword v78, v10, s[22:23]
    s_mov_b32 s42, 6291456
    s_mov_b32 s43, 0x20000
    s_mov_b32 s46, 2097152
    s_mov_b32 s47, 0x20000
    s_mov_b32 s54, 7340032
    s_mov_b32 s55, 0x20000
    s_mov_b32 s58, 7340032
    s_mov_b32 s59, 0x20000
    s_mov_b32 s62, 7340032
    s_mov_b32 s63, 0x20000
    s_mov_b32 s66, 4194304
    s_mov_b32 s67, 0x20000
    s_mov_b64 s[40:41], s[70:71]
    s_mov_b64 s[44:45], s[74:75]
    s_mov_b64 s[52:53], s[80:81]
    s_mov_b64 s[56:57], s[82:83]
    s_mov_b64 s[60:61], s[84:85]
    s_mov_b64 s[64:65], s[90:91]
    s_mov_b32 s5, 0
    s_mov_b32 s6, 0xffff0000
    s_mov_b32 s7, 0x3fb8aa3b
    s_lshr_b32 s76, s3, 2
    v_bfe_u32 v6, v1, 4, 1
    v_lshlrev_b32 v6, 6, v6
    v_and_b32 v62, 7, v1
    v_lshlrev_b32 v62, 4, v62
    v_xor_b32 v62, v62, v6
    v_lshrrev_b32 v6, 3, v1
    v_mul_u32_u24 v6, 6144, v6
    v_add_u32 v62, v62, v6
    v_lshlrev_b32 v63, 3, v1
    v_and_b32 v64, 31, v1
    v_lshlrev_b32 v64, 5, v64
    v_add_u32 v64, 149760, v64
    s_and_b32 s96, s3, 3
    s_lshl2_add_u32 s13, s96, 149760
    v_lshrrev_b32 v65, 4, v1
    v_lshl_add_u32 v65, v65, 5, s13
    v_and_b32 v9, 7, v1
    v_lshl_add_u32 v65, v9, 7, v65
    v_bfe_u32 v9, v1, 3, 1
    v_lshl_add_u32 v65, v9, 4, v65
    s_and_b32 s96, s8, 6
    s_and_b32 s97, s8, 1
    s_lshr_b32 s98, s9, 4
    s_lshl1_add_u32 s99, s97, s98
    s_lshl_b32 s97, s99, 6
    s_add_u32 s98, s96, s97
    s_lshl3_add_u32 s99, s3, s98
    s_lshl_b32 s96, s99, 10
    s_and_b32 s97, s9, 15
    s_lshl_b32 s98, s97, 6
    s_add_u32 s99, s96, s98
    s_add_u32 s14, s99, 262144
    s_xor_b32 s96, s9, 1
    s_and_b32 s97, s96, 15
    s_lshl4_add_u32 s98, s3, s97
    s_lshr_b32 s99, s9, 4
    s_lshl1_add_u32 s96, s98, s99
    s_lshl3_add_u32 s97, s96, s8
    s_lshl_b32 s98, s97, 9
    s_add_u32 s13, s98, 524288
    s_lshr_b32 s96, s9, 4
    s_xor_b32 s97, s9, 1
    s_and_b32 s98, s97, 7
    s_lshl_b32 s99, s3, 1
    s_lshl3_add_u32 s97, s98, s99
    s_bfe_u32 s98, s9, 65539
    s_add_u32 s99, s97, s98
    s_lshl_b32 s97, s99, 9
    s_lshl_b32 s98, s8, 6
    s_add_u32 s99, s97, s98
    s_lshl2_add_u32 s97, s96, s99
    s_add_u32 s15, s97, 2097152
    v_and_b32 v10, 3, v1
    v_lshlrev_b32 v10, 15, v10
    s_waitcnt vmcnt(5)
    v_lshlrev_b32 v98, 16, v97
    v_and_b32 v99, s6, v97
    v_and_b32 v97, s6, v96
    v_lshlrev_b32 v96, 16, v96
    v_mul_f32 v4, s7, v96
    v_exp_f32 v4, -v4
    s_nop 0
    v_add_f32 v4, 1.0, v4
    v_rcp_f32 v4, v4
    s_nop 0
    v_mul_f32 v96, v96, v4
    v_cvt_pk_bf16_f32 v96, 0, v96
    v_mul_f32 v5, s7, v97
    v_exp_f32 v5, -v5
    s_nop 0
    v_add_f32 v5, 1.0, v5
    v_rcp_f32 v5, v5
    s_nop 0
    v_mul_f32 v97, v97, v5
    v_cvt_pk_bf16_f32 v97, 0, v97
    v_mul_f32 v4, s7, v98
    v_exp_f32 v4, -v4
    s_nop 0
    v_add_f32 v4, 1.0, v4
    v_rcp_f32 v4, v4
    s_nop 0
    v_mul_f32 v98, v98, v4
    v_cvt_pk_bf16_f32 v98, 0, v98
    v_mul_f32 v5, s7, v99
    v_exp_f32 v5, -v5
    s_nop 0
    v_add_f32 v5, 1.0, v5
    v_rcp_f32 v5, v5
    s_nop 0
    v_mul_f32 v99, v99, v5
    v_cvt_pk_bf16_f32 v99, 0, v99
    s_waitcnt vmcnt(4)
    v_lshlrev_b32 v4, 16, v80
    v_and_b32 v5, s6, v80
    v_pk_mul_f32 v[20:21], v[4:5], v[96:97] op_sel:[0,0] op_sel_hi:[1,0]
    v_lshlrev_b32 v6, 16, v81
    v_and_b32 v7, s6, v81
    v_pk_mul_f32 v[22:23], v[6:7], v[96:97] op_sel:[0,0] op_sel_hi:[1,0]
    v_lshlrev_b32 v4, 16, v82
    v_and_b32 v5, s6, v82
    v_pk_mul_f32 v[24:25], v[4:5], v[96:97] op_sel:[0,0] op_sel_hi:[1,0]
    v_lshlrev_b32 v6, 16, v83
    v_and_b32 v7, s6, v83
    v_pk_mul_f32 v[26:27], v[6:7], v[96:97] op_sel:[0,0] op_sel_hi:[1,0]
    s_waitcnt vmcnt(3)
    v_lshlrev_b32 v4, 16, v84
    v_and_b32 v5, s6, v84
    v_pk_fma_f32 v[20:21], v[4:5], v[96:97], v[20:21] op_sel:[0,1,0] op_sel_hi:[1,1,1]
    v_lshlrev_b32 v6, 16, v85
    v_and_b32 v7, s6, v85
    v_pk_fma_f32 v[22:23], v[6:7], v[96:97], v[22:23] op_sel:[0,1,0] op_sel_hi:[1,1,1]
    v_lshlrev_b32 v4, 16, v86
    v_and_b32 v5, s6, v86
    v_pk_fma_f32 v[24:25], v[4:5], v[96:97], v[24:25] op_sel:[0,1,0] op_sel_hi:[1,1,1]
    v_lshlrev_b32 v6, 16, v87
    v_and_b32 v7, s6, v87
    v_pk_fma_f32 v[26:27], v[6:7], v[96:97], v[26:27] op_sel:[0,1,0] op_sel_hi:[1,1,1]
    s_waitcnt vmcnt(2)
    v_lshlrev_b32 v4, 16, v88
    v_and_b32 v5, s6, v88
    v_pk_fma_f32 v[20:21], v[4:5], v[98:99], v[20:21] op_sel:[0,0,0] op_sel_hi:[1,0,1]
    v_lshlrev_b32 v6, 16, v89
    v_and_b32 v7, s6, v89
    v_pk_fma_f32 v[22:23], v[6:7], v[98:99], v[22:23] op_sel:[0,0,0] op_sel_hi:[1,0,1]
    v_lshlrev_b32 v4, 16, v90
    v_and_b32 v5, s6, v90
    v_pk_fma_f32 v[24:25], v[4:5], v[98:99], v[24:25] op_sel:[0,0,0] op_sel_hi:[1,0,1]
    v_lshlrev_b32 v6, 16, v91
    v_and_b32 v7, s6, v91
    v_pk_fma_f32 v[26:27], v[6:7], v[98:99], v[26:27] op_sel:[0,0,0] op_sel_hi:[1,0,1]
    s_waitcnt vmcnt(1)
    v_lshlrev_b32 v4, 16, v92
    v_and_b32 v5, s6, v92
    v_pk_fma_f32 v[20:21], v[4:5], v[98:99], v[20:21] op_sel:[0,1,0] op_sel_hi:[1,1,1]
    v_lshlrev_b32 v6, 16, v93
    v_and_b32 v7, s6, v93
    v_pk_fma_f32 v[22:23], v[6:7], v[98:99], v[22:23] op_sel:[0,1,0] op_sel_hi:[1,1,1]
    v_lshlrev_b32 v4, 16, v94
    v_and_b32 v5, s6, v94
    v_pk_fma_f32 v[24:25], v[4:5], v[98:99], v[24:25] op_sel:[0,1,0] op_sel_hi:[1,1,1]
    v_lshlrev_b32 v6, 16, v95
    v_and_b32 v7, s6, v95
    v_pk_fma_f32 v[26:27], v[6:7], v[98:99], v[26:27] op_sel:[0,1,0] op_sel_hi:[1,1,1]
    v_permlane32_swap_b32 v20, v24
    v_permlane32_swap_b32 v21, v25
    v_permlane32_swap_b32 v22, v26
    v_permlane32_swap_b32 v23, v27
    v_add_f32 v20, v20, v24
    v_add_f32 v21, v21, v25
    v_add_f32 v22, v22, v26
    v_add_f32 v23, v23, v27
    s_nop 0
    v_permlane16_swap_b32 v20, v22
    v_permlane16_swap_b32 v21, v23
    v_add_f32 v20, v20, v22
    v_add_f32 v21, v21, v23
    s_nop 0
    v_add_f32_dpp v20, v20, v20 row_ror:8 row_mask:0xf bank_mask:0xf
    v_add_f32_dpp v21, v21, v21 row_ror:8 row_mask:0xf bank_mask:0xf
    s_nop 1
    v_mov_b32_dpp v20, v21 quad_perm:[0,1,2,3] row_mask:0xf bank_mask:0xc
    ds_write_b32 v65, v20
    s_waitcnt lgkmcnt(0)
    s_barrier
    s_mul_i32 s4, s4, 0x9e3779b1
    s_add_u32 s4, s4, 0x7f4a7c15
    ds_read_b128 v[20:23], v64 offset:0
    ds_read_b128 v[24:27], v64 offset:16
    s_waitcnt lgkmcnt(0)
    v_add_f32 v20, v20, v22
    v_add_f32 v21, v21, v23
    v_add_f32 v24, v24, v26
    v_add_f32 v25, v25, v27
    v_add_f32 v20, v20, v21
    v_add_f32 v22, v24, v25
    v_mov_b32 v21, s4
    v_mov_b32 v23, s4
    s_mov_b32 exec_hi, 0
    buffer_store_dwordx4 v[20:23], v2, s[32:35], s13 offen sc1
    s_mov_b64 exec, 15
    buffer_store_dword v21, v10, s[32:35], s15 offen sc1
    s_mov_b64 exec, -1
    v_and_b32 v5, 3, v1
    v_lshlrev_b32 v5, 4, v5
    v_add_u32 v5, 151808, v5
    v_and_b32 v4, 3, v1
    v_lshlrev_b32 v4, 4, v4
    v_bfe_u32 v9, v1, 2, 1
    v_lshl_add_u32 v4, v9, 10, v4
    v_and_b32 v11, 31, v1
    v_lshlrev_b32 v11, 11, v11
    v_lshrrev_b32 v9, 5, v1
    v_lshl_add_u32 v11, v9, 5, v11
    v_and_b32 v6, 1, v1
    v_lshlrev_b32 v6, 9, v6
    v_bfe_u32 v9, v1, 1, 1
    v_lshl_add_u32 v6, v9, 8, v6
    s_and_b32 s96, s9, 3
    s_and_b32 s97, s8, 6
    s_and_b32 s98, s8, 1
    s_lshr_b32 s99, s9, 4
    s_lshl1_add_u32 s98, s98, s99
    s_lshl_b32 s99, s98, 6
    s_add_u32 s98, s97, s99
    s_lshl3_add_u32 s97, s3, s98
    s_lshl_b32 s99, s97, 9
    s_bfe_u32 s98, s9, 131074
    s_lshl_b32 s97, s98, 6
    s_add_u32 s98, s99, s97
    s_lshl2_add_u32 s99, s96, s98
    s_add_u32 s97, s99, 16
    s_add_u32 s15, s97, 2097152
    s_branch L_FJ
L_FS:
    s_barrier
    buffer_load_dwordx4 v[80:83], v2, s[36:39], s16 offen
    buffer_load_dwordx4 v[84:87], v2, s[36:39], s16 offen offset:1024
    buffer_load_dwordx4 v[88:91], v2, s[36:39], s16 offen offset:2048
    buffer_load_dwordx4 v[92:95], v2, s[36:39], s16 offen offset:3072
    s_lshl2_add_u32 s96, s2, s3
    s_sub_u32 s97, s96, 4
    s_lshl_b32 s98, s97, 7
    s_add_u32 s17, s98, 2097152
    s_load_dword s24, s[32:33], s17 offset:0 glc
    s_load_dword s25, s[32:33], s17 offset:64 glc
    s_lshl_b32 s96, s2, 5
    s_add_u32 s97, s96, s3
    s_sub_u32 s98, s97, 4
    s_lshl_b32 s99, s98, 7
    s_add_u32 s17, s99, 1048576
    s_load_dword s24, s[32:33], s17 offset:0 glc
    s_load_dword s25, s[32:33], s17 offset:64 glc
    s_lshl_b32 s19, s94, 5
    v_mov_b32 v78, 1
    v_mov_b32 v79, s19
    s_barrier
    s_cmp_lg_u32 s3, 7
    s_cbranch_scc1 L_NOTK
    s_mov_b64 exec, 1
    global_atomic_add v78, v79, v78, s[30:31] sc0 sc1
    s_mov_b64 exec, -1
    s_branch L_TK0
L_NOTK:
    s_and_b32 s22, s22, 0xfffffc00
    global_load_dword v78, v10, s[22:23]
L_TK0:
    s_mov_b32 s42, 6291456
    s_mov_b32 s43, 0x20000
    s_mov_b32 s46, 2097152
    s_mov_b32 s47, 0x20000
    s_mov_b32 s54, 7340032
    s_mov_b32 s55, 0x20000
    s_mov_b32 s58, 7340032
    s_mov_b32 s59, 0x20000
    s_mov_b32 s62, 7340032
    s_mov_b32 s63, 0x20000
    s_mov_b32 s66, 4194304
    s_mov_b32 s67, 0x20000
    s_mov_b64 s[40:41], s[70:71]
    s_mov_b64 s[44:45], s[74:75]
    s_mov_b64 s[52:53], s[80:81]
    s_mov_b64 s[56:57], s[82:83]
    s_mov_b64 s[60:61], s[84:85]
    s_mov_b64 s[64:65], s[90:91]
    s_mov_b32 s5, 0
    s_mov_b32 s6, 0xffff0000
    s_mov_b32 s7, 0x3fb8aa3b
    s_lshr_b32 s76, s3, 2
    v_bfe_u32 v6, v1, 4, 1
    v_lshlrev_b32 v6, 6, v6
    v_and_b32 v62, 7, v1
    v_lshlrev_b32 v62, 4, v62
    v_xor_b32 v62, v62, v6
    v_lshrrev_b32 v6, 3, v1
    v_mul_u32_u24 v6, 6144, v6
    v_add_u32 v62, v62, v6
    v_lshlrev_b32 v63, 3, v1
    v_and_b32 v64, 31, v1
    v_lshlrev_b32 v64, 5, v64
    v_add_u32 v64, 149760, v64
    s_and_b32 s96, s3, 3
    s_lshl2_add_u32 s13, s96, 149760
    v_lshrrev_b32 v65, 4, v1
    v_lshl_add_u32 v65, v65, 5, s13
    v_and_b32 v9, 7, v1
    v_lshl_add_u32 v65, v9, 7, v65
    v_bfe_u32 v9, v1, 3, 1
    v_lshl_add_u32 v65, v9, 4, v65
    s_and_b32 s96, s8, 6
    s_and_b32 s97, s8, 1
    s_lshr_b32 s98, s9, 4
    s_lshl1_add_u32 s99, s97, s98
    s_lshl_b32 s97, s99, 6
    s_add_u32 s98, s96, s97
    s_lshl3_add_u32 s99, s3, s98
    s_lshl_b32 s96, s99, 10
    s_and_b32 s97, s9, 15
    s_lshl_b32 s98, s97, 6
    s_add_u32 s99, s96, s98
    s_add_u32 s14, s99, 262144
    s_sub_u32 s96, s3, 4
    s_lshl4_add_u32 s13, s96, 151808
    v_lshrrev_b32 v10, 5, v1
    v_lshl_add_u32 v10, v10, 3, s13
    v_and_b32 v5, 3, v1
    v_lshlrev_b32 v5, 4, v5
    v_add_u32 v5, 151808, v5
    v_and_b32 v4, 3, v1
    v_lshlrev_b32 v4, 4, v4
    v_bfe_u32 v9, v1, 2, 1
    v_lshl_add_u32 v4, v9, 10, v4
    v_and_b32 v11, 31, v1
    v_lshlrev_b32 v11, 11, v11
    v_lshrrev_b32 v9, 5, v1
    v_lshl_add_u32 v11, v9, 5, v11
    v_and_b32 v6, 1, v1
    v_lshlrev_b32 v6, 9, v6
    v_bfe_u32 v9, v1, 1, 1
    v_lshl_add_u32 v6, v9, 8, v6
    s_and_b32 s96, s9, 3
    s_and_b32 s97, s8, 6
    s_and_b32 s98, s8, 1
    s_lshr_b32 s99, s9, 4
    s_lshl1_add_u32 s98, s98, s99
    s_lshl_b32 s99, s98, 6
    s_add_u32 s98, s97, s99
    s_lshl3_add_u32 s97, s3, s98
    s_lshl_b32 s99, s97, 9
    s_bfe_u32 s98, s9, 131074
    s_lshl_b32 s97, s98, 6
    s_add_u32 s98, s99, s97
    s_lshl2_add_u32 s99, s96, s98
    s_add_u32 s97, s99, 16
    s_add_u32 s15, s97, 2097152
    s_barrier
    s_waitcnt vmcnt(1)
    s_waitcnt lgkmcnt(0)
    s_mul_i32 s4, s4, 0x9e3779b1
    s_add_u32 s4, s4, 0x7f4a7c15
    v_mov_b32 v104, 0x3f803f80
    v_dot2_f32_bf16 v100, v80, v104, 0
    v_dot2_f32_bf16 v102, v80, v80, 0
    v_dot2_f32_bf16 v101, v88, v104, 0
    v_dot2_f32_bf16 v103, v88, v88, 0
    v_dot2_f32_bf16 v100, v81, v104, v100
    v_dot2_f32_bf16 v102, v81, v81, v102
    v_dot2_f32_bf16 v101, v89, v104, v101
    v_dot2_f32_bf16 v103, v89, v89, v103
    v_dot2_f32_bf16 v100, v82, v104, v100
    v_dot2_f32_bf16 v102, v82, v82, v102
    v_dot2_f32_bf16 v101, v90, v104, v101
    v_dot2_f32_bf16 v103, v90, v90, v103
    v_dot2_f32_bf16 v100, v83, v104, v100
    v_dot2_f32_bf16 v102, v83, v83, v102
    v_dot2_f32_bf16 v101, v91, v104, v101
    v_dot2_f32_bf16 v103, v91, v91, v103
    v_dot2_f32_bf16 v100, v84, v104, v100
    v_dot2_f32_bf16 v102, v84, v84, v102
    v_dot2_f32_bf16 v101, v92, v104, v101
    v_dot2_f32_bf16 v103, v92, v92, v103
    v_dot2_f32_bf16 v100, v85, v104, v100
    v_dot2_f32_bf16 v102, v85, v85, v102
    v_dot2_f32_bf16 v101, v93, v104, v101
    v_dot2_f32_bf16 v103, v93, v93, v103
    v_dot2_f32_bf16 v100, v86, v104, v100
    v_dot2_f32_bf16 v102, v86, v86, v102
    v_dot2_f32_bf16 v101, v94, v104, v101
    v_dot2_f32_bf16 v103, v94, v94, v103
    v_dot2_f32_bf16 v100, v87, v104, v100
    v_dot2_f32_bf16 v102, v87, v87, v102
    v_dot2_f32_bf16 v101, v95, v104, v101
    v_dot2_f32_bf16 v103, v95, v95, v103
    s_nop 1
    v_permlane32_swap_b32 v100, v101
    v_permlane32_swap_b32 v102, v103
    v_add_f32 v100, v100, v101
    v_add_f32 v102, v102, v103
    s_nop 1
    v_permlane16_swap_b32 v100, v102
    v_add_f32 v100, v100, v102
    s_nop 1
    v_add_f32_dpp v100, v100, v100 quad_perm:[1,0,3,2] row_mask:0xf bank_mask:0xf
    s_nop 1
    v_add_f32_dpp v100, v100, v100 quad_perm:[2,3,0,1] row_mask:0xf bank_mask:0xf
    s_nop 1
    v_add_f32_dpp v100, v100, v100 row_half_mirror row_mask:0xf bank_mask:0xf
    s_nop 1
    v_add_f32_dpp v100, v100, v100 row_ror:8 row_mask:0xf bank_mask:0xf
    v_mul_f32 v102, 0x3a800000, v100
    v_mul_f32 v100, 0x3a800000, v100
    s_nop 1
    v_permlane16_swap_b32 v100, v102
    v_fma_f32 v117, -v100, v100, v102
    v_cvt_pk_bf16_f32 v116, 0, v100
    v_max_f32 v117, 0, v117
    v_cvt_pk_bf16_f32 v117, 0, v117
    v_add_f32 v117, 0x3727c5ac, v117
    v_cvt_pk_bf16_f32 v117, 0, v117
    v_sqrt_f32 v117, v117
    s_nop 0
    v_cvt_pk_bf16_f32 v117, 0, v117
    v_lshrrev_b32 v116, 16, v116
    v_or_b32 v116, v116, v117
    v_mov_b32 v117, s4
    ds_write_b64 v10, v[116:117]
L_FJ:
    s_waitcnt lgkmcnt(0)
    s_barrier
    ds_read_b128 v[116:119], v5
    s_waitcnt lgkmcnt(0)
    s_mov_b64 exec, 0xff
    buffer_store_dwordx4 v[116:119], v4, s[32:35], s14 offen sc1
    s_mov_b64 exec, 15
    buffer_store_dword v117, v6, s[32:35], s15 offen sc1
    s_mov_b64 exec, -1
    s_cmp_lg_u32 s3, 7
    s_cbranch_scc1 L_NOTK2
    s_mov_b32 s13, 0
    s_waitcnt vmcnt(2)
L_TK:
    v_readfirstlane_b32 s15, v78
    s_nop 0
    s_cmp_lt_u32 s15, 32
    s_cbranch_scc1 L_TKOK
    v_mov_b32 v78, s4
    s_mov_b64 exec, 1
    buffer_store_dword v78, v3, s[32:35], 0 offen offset:256 sc1
    s_mov_b64 exec, -1
    s_add_u32 s13, s13, 1
    s_cmp_lt_u32 s13, 8
    s_cbranch_scc0 L_TKNO
    s_add_u32 s94, s94, 1
    s_and_b32 s94, s94, 7
    s_lshl_b32 s19, s94, 5
    v_mov_b32 v78, 1
    v_mov_b32 v79, s19
    s_mov_b64 exec, 1
    global_atomic_add v78, v79, v78, s[30:31] sc0 sc1
    s_mov_b64 exec, -1
    s_waitcnt vmcnt(0)
    s_branch L_TK
L_TKNO:
    s_and_b32 s94, s2, 7
    s_lshr_b32 s15, s2, 3
L_TKOK:
    s_lshl3_add_u32 s15, s15, s94
    v_mov_b32 v78, s15
    ds_write_b32 v5, v78 offset:64
L_NOTK2:
    s_waitcnt lgkmcnt(0)
    s_barrier
    ds_read_b32 v120, v5 offset:64
    s_waitcnt lgkmcnt(0)
    v_readfirstlane_b32 s2, v120
    s_nop 0
    s_lshl3_add_u32 s96, s2, s3
    s_lshl_b32 s97, s96, 6
    s_add_u32 s15, s97, 2097152
    s_load_dwordx8 s[24:31], s[32:33], s15 offset:0 glc
    s_and_b32 s8, s2, 7
    s_lshr_b32 s9, s2, 3
    s_and_b32 s96, s8, 1
    s_and_b32 s97, s9, 7
    s_lshl3_add_u32 s12, s96, s97
    s_lshr_b32 s96, s8, 1
    s_lshr_b32 s97, s9, 3
    s_lshl2_add_u32 s21, s96, s97
    s_and_b32 s96, s3, 3
    s_lshl2_add_u32 s94, s21, s96
    s_lshl1_add_u32 s95, s12, s76
    s_lshl_b32 s96, s94, 16
    s_lshl_b32 s97, s95, 6
    s_add_u32 s18, s96, s97
    buffer_load_dwordx4 v[12:15], v11, s[36:39], s18 offen
    buffer_load_dwordx4 v[16:19], v11, s[36:39], s18 offen offset:16
    s_lshr_b32 s96, s8, 1
    s_lshl4_add_u32 s97, s96, s12
    s_lshl4_add_u32 s98, s97, s3
    s_lshl_b32 s99, s98, 9
    s_add_u32 s13, s99, 524288
    s_and_b32 s96, s3, 3
    s_lshl2_add_u32 s97, s2, s96
    s_lshl_b32 s98, s97, 8
    s_add_u32 s14, s98, 262144
    s_and_b32 s10, s9, 15
    s_lshr_b32 s96, s8, 2
    s_and_b32 s97, s8, 1
    s_lshl1_add_u32 s98, s96, s97
    s_and_b32 s99, s8, 2
    s_lshl2_add_u32 s96, s98, s99
    s_lshr_b32 s97, s9, 4
    s_add_u32 s11, s96, s97
    s_and_b32 s85, s9, 12
    s_lshl_b32 s96, s2, 6
    s_add_u32 s97, s96, s3
    s_lshl_b32 s98, s97, 6
    s_add_u32 s92, s98, 1048576
    s_lshr_b32 s96, s9, 4
    s_xor_b32 s77, s76, s96
    s_lshr_b32 s96, s9, 3
    s_xor_b32 s97, s96, s9
    s_and_b32 s98, s97, 1
    s_lshl2_add_u32 s83, s98, 8
    s_mul_i32 s96, s8, 7
    s_lshr_b32 s97, s9, 2
    s_add_u32 s74, s96, s97
    s_and_b32 s75, s9, 3
    v_and_b32 v8, 31, v1
    v_lshlrev_b32 v8, 3, v8
    v_and_b32 v4, 31, v1
    v_lshlrev_b32 v4, 4, v4
    v_lshrrev_b32 v9, 5, v1
    v_lshl_add_u32 v4, v9, 12, v4
    s_lshl2_add_u32 s16, s3, 152320
    v_lshl_add_u32 v5, v1, 6, s16
    s_lshl_b32 s96, s76, 10
    s_add_u32 s16, s96, 152320
    v_and_b32 v6, 15, v1
    v_lshl_add_u32 v6, v6, 5, s16
    v_lshrrev_b32 v9, 5, v1
    v_lshl_add_u32 v6, v9, 9, v6
    s_branch SCHK_2
SPOLL_1:
    s_load_dwordx8 s[24:31], s[32:33], s15 offset:0 glc
SCHK_2:
    s_add_u32 s5, s5, 1
    s_cmp_ge_u32 s5, 300000
    s_waitcnt lgkmcnt(0)
    s_cbranch_scc1 SDONE_3
    s_cmp_lg_u32 s24, s4
    s_cbranch_scc1 SPOLL_1
    s_cmp_lg_u32 s25, s4
    s_cbranch_scc1 SPOLL_1
    s_cmp_lg_u32 s28, s4
    s_cbranch_scc1 SPOLL_1
    s_cmp_lg_u32 s29, s4
    s_cbranch_scc1 SPOLL_1
    s_cmp_lg_u32 s30, s4
    s_cbranch_scc1 SPOLL_1
    s_cmp_lg_u32 s31, s4
    s_cbranch_scc1 SPOLL_1
SDONE_3:
    buffer_load_dwordx4 v[120:123], v4, s[32:35], s13 offen sc1
    buffer_load_dwordx2 v[116:117], v8, s[32:35], s14 offen sc1
    s_barrier
    s_lshl_b32 s96, s11, 12
    s_lshl_b32 s97, s3, 9
    s_add_u32 s16, s96, s97
    v_add_u32 v10, s16, v2
    s_lshl_b32 s96, s3, 9
    s_add_u32 m0, s96, 156416
    s_mov_b32 exec_hi, 0
    global_load_lds_dwordx4 v10, s[72:73]
    s_mov_b32 exec_hi, -1
    s_and_b32 s20, s9, 3
    s_add_u32 s96, s20, s85
    s_and_b32 s97, s96, 15
    s_lshl3_add_u32 s98, s97, s3
    s_mul_i32 s99, s98, 49152
    s_lshl_b32 s96, s11, 7
    s_add_u32 s82, s99, s96
    s_mul_i32 s96, s20, 24960
    s_lshr_b32 s97, s3, 1
    s_mul_i32 s98, s97, 2080
    s_add_u32 s99, s96, s98
    s_and_b32 s97, s3, 1
    s_mul_i32 s96, s97, 1056
    s_add_u32 s20, s99, s96
    s_mov_b32 m0, s20
    s_nop 0
    buffer_load_dwordx4 v62, s[40:43], s82 offen lds
    s_add_u32 s82, s82, 2048
    s_add_u32 m0, s20, 8320
    s_nop 0
    buffer_load_dwordx4 v62, s[40:43], s82 offen lds
    s_add_u32 s82, s82, 2048
    s_add_u32 m0, s20, 16640
    s_nop 0
    buffer_load_dwordx4 v62, s[40:43], s82 offen lds
    s_lshl4_add_u32 s96, s21, s12
    s_and_b32 s97, s3, 3
    s_lshl2_add_u32 s98, s96, s97
    s_lshl1_add_u32 s99, s98, s76
    s_lshl_b32 s96, s99, 11
    s_add_u32 s17, s96, 4194304
    v_and_b32 v10, 15, v1
    v_lshlrev_b32 v10, 4, v10
    v_bfe_u32 v9, v1, 4, 1
    v_lshl_add_u32 v10, v9, 10, v10
    v_lshrrev_b32 v9, 5, v1
    v_lshl_add_u32 v10, v9, 9, v10
    s_lshl_b32 s96, s3, 8
    s_add_u32 s16, s96, 160512
    v_and_b32 v124, 15, v1
    v_lshl_add_u32 v124, v124, 2, s16
    v_lshrrev_b32 v9, 5, v1
    v_lshl_add_u32 v124, v9, 6, v124
    v_lshrrev_b32 v125, 5, v1
    v_lshl_add_u32 v125, v125, 6, s16
    s_waitcnt vmcnt(5)
    v_bitop3_b32 v7, v121, v123, s4 bitop3:0x7e
    v_cmp_ne_u32 vcc, 0, v7
    s_cbranch_vccz TOK_5
POLL_6:
    buffer_load_dwordx4 v[120:123], v4, s[32:35], s13 offen sc1
    s_waitcnt vmcnt(0)
    v_bitop3_b32 v7, v121, v123, s4 bitop3:0x7e
    v_cmp_ne_u32 vcc, 0, v7
    s_cbranch_vccz PDONE_7
    s_add_u32 s5, s5, 1
    s_cmp_lt_u32 s5, 300000
    s_cbranch_scc1 POLL_6
PDONE_7:
TOK_5:
    ds_write2_b32 v5, v120, v122 offset0:0 offset1:8
    v_lshlrev_b32 v100, 16, v12
    v_and_b32 v101, s6, v12
    v_lshlrev_b32 v102, 16, v13
    v_and_b32 v103, s6, v13
    v_lshlrev_b32 v104, 16, v14
    v_and_b32 v105, s6, v14
    v_lshlrev_b32 v106, 16, v15
    v_and_b32 v107, s6, v15
    v_lshlrev_b32 v108, 16, v16
    v_and_b32 v109, s6, v16
    v_lshlrev_b32 v110, 16, v17
    v_and_b32 v111, s6, v17
    v_lshlrev_b32 v112, 16, v18
    v_and_b32 v113, s6, v18
    v_lshlrev_b32 v114, 16, v19
    v_and_b32 v115, s6, v19
    s_waitcnt lgkmcnt(0)
    s_barrier
    ds_read_b128 v[88:91], v6 offset:2048
    ds_read_b128 v[92:95], v6 offset:2064
    ds_read_b128 v[80:83], v6
    ds_read_b128 v[84:87], v6 offset:16
    s_waitcnt vmcnt(4)
    v_cmp_ne_u32 vcc, s4, v117
    s_cbranch_vccz TOK_8
POLL_9:
    buffer_load_dwordx2 v[116:117], v8, s[32:35], s14 offen sc1
    s_waitcnt vmcnt(0)
    v_cmp_ne_u32 vcc, s4, v117
    s_cbranch_vccz PDONE_10
    s_add_u32 s5, s5, 1
    s_cmp_lt_u32 s5, 300000
    s_cbranch_scc1 POLL_9
PDONE_10:
TOK_8:
    v_lshlrev_b32 v117, 16, v116
    v_and_b32 v116, s6, v116
    v_rcp_f32 v116, v116
    s_nop 0
    v_pk_add_f32 v[100:101], v[100:101], v[116:117] op_sel:[0,1] neg_lo:[0,1] neg_hi:[0,1]
    v_pk_add_f32 v[102:103], v[102:103], v[116:117] op_sel:[0,1] neg_lo:[0,1] neg_hi:[0,1]
    v_pk_add_f32 v[104:105], v[104:105], v[116:117] op_sel:[0,1] neg_lo:[0,1] neg_hi:[0,1]
    v_pk_add_f32 v[106:107], v[106:107], v[116:117] op_sel:[0,1] neg_lo:[0,1] neg_hi:[0,1]
    v_pk_add_f32 v[108:109], v[108:109], v[116:117] op_sel:[0,1] neg_lo:[0,1] neg_hi:[0,1]
    v_pk_add_f32 v[110:111], v[110:111], v[116:117] op_sel:[0,1] neg_lo:[0,1] neg_hi:[0,1]
    v_pk_add_f32 v[112:113], v[112:113], v[116:117] op_sel:[0,1] neg_lo:[0,1] neg_hi:[0,1]
    v_pk_add_f32 v[114:115], v[114:115], v[116:117] op_sel:[0,1] neg_lo:[0,1] neg_hi:[0,1]
    s_waitcnt lgkmcnt(2)
    v_pk_add_f32 v[88:89], v[88:89], v[90:91]
    v_pk_add_f32 v[92:93], v[92:93], v[94:95]
    v_pk_add_f32 v[88:89], v[88:89], v[92:93]
    v_add_f32 v88, v88, v89
    v_cvt_pk_bf16_f32 v88, 0, v88
    s_waitcnt lgkmcnt(0)
    v_pk_add_f32 v[80:81], v[80:81], v[82:83]
    v_pk_add_f32 v[84:85], v[84:85], v[86:87]
    v_pk_add_f32 v[80:81], v[80:81], v[84:85]
    v_add_f32 v80, v80, v81
    v_add_f32 v88, 1.0, v88
    v_cvt_pk_bf16_f32 v88, 0, v88
    v_cvt_pk_bf16_f32 v80, 0, v80
    ds_write2_b32 v124, v88, v80 offset0:0 offset1:32
    ds_read_b128 v[136:139], v125
    ds_read_b128 v[140:143], v125 offset:16
    ds_read_b128 v[144:147], v125 offset:32
    ds_read_b128 v[148:151], v125 offset:48
    ds_read_b128 v[152:155], v125 offset:128
    ds_read_b128 v[156:159], v125 offset:144
    ds_read_b128 v[160:163], v125 offset:160
    ds_read_b128 v[164:167], v125 offset:176
    v_cvt_pk_bf16_f32 v100, 0, v100
    v_cvt_pk_bf16_f32 v101, 0, v101
    v_cvt_pk_bf16_f32 v102, 0, v102
    v_cvt_pk_bf16_f32 v103, 0, v103
    v_cvt_pk_bf16_f32 v104, 0, v104
    v_cvt_pk_bf16_f32 v105, 0, v105
    v_cvt_pk_bf16_f32 v106, 0, v106
    v_cvt_pk_bf16_f32 v107, 0, v107
    v_pk_mul_f32 v[100:101], v[100:101], v[116:117] op_sel_hi:[1,0]
    v_pk_mul_f32 v[102:103], v[102:103], v[116:117] op_sel_hi:[1,0]
    v_pk_mul_f32 v[104:105], v[104:105], v[116:117] op_sel_hi:[1,0]
    v_pk_mul_f32 v[106:107], v[106:107], v[116:117] op_sel_hi:[1,0]
    v_cvt_pk_bf16_f32 v100, 0, v100
    v_cvt_pk_bf16_f32 v101, 0, v101
    v_cvt_pk_bf16_f32 v102, 0, v102
    v_cvt_pk_bf16_f32 v103, 0, v103
    v_cvt_pk_bf16_f32 v104, 0, v104
    v_cvt_pk_bf16_f32 v105, 0, v105
    v_cvt_pk_bf16_f32 v106, 0, v106
    v_cvt_pk_bf16_f32 v107, 0, v107
    v_cvt_pk_bf16_f32 v108, 0, v108
    v_cvt_pk_bf16_f32 v109, 0, v109
    v_cvt_pk_bf16_f32 v110, 0, v110
    v_cvt_pk_bf16_f32 v111, 0, v111
    v_cvt_pk_bf16_f32 v112, 0, v112
    v_cvt_pk_bf16_f32 v113, 0, v113
    v_cvt_pk_bf16_f32 v114, 0, v114
    v_cvt_pk_bf16_f32 v115, 0, v115
    v_pk_mul_f32 v[108:109], v[108:109], v[116:117] op_sel_hi:[1,0]
    v_pk_mul_f32 v[110:111], v[110:111], v[116:117] op_sel_hi:[1,0]
    v_pk_mul_f32 v[112:113], v[112:113], v[116:117] op_sel_hi:[1,0]
    v_pk_mul_f32 v[114:115], v[114:115], v[116:117] op_sel_hi:[1,0]
    v_cvt_pk_bf16_f32 v108, 0, v108
    v_cvt_pk_bf16_f32 v109, 0, v109
    v_cvt_pk_bf16_f32 v110, 0, v110
    v_cvt_pk_bf16_f32 v111, 0, v111
    v_cvt_pk_bf16_f32 v112, 0, v112
    v_cvt_pk_bf16_f32 v113, 0, v113
    v_cvt_pk_bf16_f32 v114, 0, v114
    v_cvt_pk_bf16_f32 v115, 0, v115
    s_waitcnt lgkmcnt(6)
    v_pk_mul_f32 v[100:101], v[100:101], v[136:137]
    v_pk_mul_f32 v[102:103], v[102:103], v[138:139]
    v_pk_mul_f32 v[104:105], v[104:105], v[140:141]
    v_pk_mul_f32 v[106:107], v[106:107], v[142:143]
    v_cvt_pk_bf16_f32 v100, 0, v100
    v_cvt_pk_bf16_f32 v101, 0, v101
    v_cvt_pk_bf16_f32 v102, 0, v102
    v_cvt_pk_bf16_f32 v103, 0, v103
    v_cvt_pk_bf16_f32 v104, 0, v104
    v_cvt_pk_bf16_f32 v105, 0, v105
    v_cvt_pk_bf16_f32 v106, 0, v106
    v_cvt_pk_bf16_f32 v107, 0, v107
    s_waitcnt lgkmcnt(2)
    v_pk_add_f32 v[100:101], v[100:101], v[152:153]
    v_pk_add_f32 v[102:103], v[102:103], v[154:155]
    v_pk_add_f32 v[104:105], v[104:105], v[156:157]
    v_pk_add_f32 v[106:107], v[106:107], v[158:159]
    v_cvt_pk_bf16_f32 v128, v100, v101
    v_cvt_pk_bf16_f32 v129, v102, v103
    v_cvt_pk_bf16_f32 v130, v104, v105
    v_cvt_pk_bf16_f32 v131, v106, v107
    buffer_store_dwordx4 v[128:131], v10, s[32:35], s17 offen sc1
    v_pk_mul_f32 v[108:109], v[108:109], v[144:145]
    v_pk_mul_f32 v[110:111], v[110:111], v[146:147]
    v_pk_mul_f32 v[112:113], v[112:113], v[148:149]
    v_pk_mul_f32 v[114:115], v[114:115], v[150:151]
    v_cvt_pk_bf16_f32 v108, 0, v108
    v_cvt_pk_bf16_f32 v109, 0, v109
    v_cvt_pk_bf16_f32 v110, 0, v110
    v_cvt_pk_bf16_f32 v111, 0, v111
    v_cvt_pk_bf16_f32 v112, 0, v112
    v_cvt_pk_bf16_f32 v113, 0, v113
    v_cvt_pk_bf16_f32 v114, 0, v114
    v_cvt_pk_bf16_f32 v115, 0, v115
    s_waitcnt lgkmcnt(0)
    v_pk_add_f32 v[108:109], v[108:109], v[160:161]
    v_pk_add_f32 v[110:111], v[110:111], v[162:163]
    v_pk_add_f32 v[112:113], v[112:113], v[164:165]
    v_pk_add_f32 v[114:115], v[114:115], v[166:167]
    v_cvt_pk_bf16_f32 v132, v108, v109
    v_cvt_pk_bf16_f32 v133, v110, v111
    v_cvt_pk_bf16_f32 v134, v112, v113
    v_cvt_pk_bf16_f32 v135, v114, v115
    buffer_store_dwordx4 v[132:135], v10, s[32:35], s17 offen offset:256 sc1
    v_lshrrev_b32 v66, 5, v1
    v_mul_u32_u24 v66, 2080, v66
    v_bfe_u32 v9, v1, 2, 2
    v_lshl_add_u32 v66, v9, 7, v66
    v_bfe_u32 v9, v1, 3, 1
    v_lshl_add_u32 v66, v9, 6, v66
    v_and_b32 v9, 3, v1
    v_lshl_add_u32 v66, v9, 3, v66
    v_bfe_u32 v67, v1, 4, 1
    v_mul_u32_u24 v67, 1056, v67
    v_bfe_u32 v68, v1, 3, 1
    v_lshlrev_b32 v68, 7, v68
    v_add_u32 v66, v66, v67
    v_sub_u32 v67, v66, v68
    v_add_u32 v67, 64, v67
    v_add_u32 v68, 49920, v66
    v_add_u32 v69, 49920, v67
    v_add_u32 v70, 99840, v66
    v_add_u32 v71, 99840, v67
    s_lshl_b32 s96, s76, 11
    s_add_u32 s14, s96, 156416
    v_bfe_u32 v4, v1, 2, 2
    v_lshl_add_u32 v4, v4, 6, s14
    v_bfe_u32 v9, v1, 4, 1
    v_lshl_add_u32 v4, v9, 5, v4
    v_and_b32 v9, 3, v1
    v_lshl_add_u32 v4, v9, 3, v4
    v_lshrrev_b32 v9, 5, v1
    v_lshl_add_u32 v4, v9, 9, v4
    v_and_b32 v5, 7, v1
    v_lshlrev_b32 v5, 12, v5
    v_bfe_u32 v9, v1, 3, 1
    v_lshl_add_u32 v5, v9, 19, v5
    s_and_b32 s96, s12, 1
    s_lshl_b32 s97, s21, 15
    s_lshr_b32 s98, s12, 1
    s_lshl_b32 s99, s98, 6
    s_add_u32 s98, s97, s99
    s_lshl2_add_u32 s97, s96, s98
    s_add_u32 s13, s97, 1048576
    v_bfe_u32 v6, v1, 4, 1
    v_lshlrev_b32 v6, 6, v6
    v_lshrrev_b32 v9, 5, v1
    v_lshl_add_u32 v6, v9, 4, v6
    v_and_b32 v74, 7, v1
    v_lshlrev_b32 v74, 4, v74
    v_xor_b32 v74, v74, v6
    v_lshrrev_b32 v6, 3, v1
    v_lshlrev_b32 v6, 11, v6
    v_add_u32 v74, v74, v6
    s_and_b32 s96, s3, 2
    s_lshl_b32 s14, s96, 5
    v_bfe_u32 v6, v1, 4, 1
    v_lshl_add_u32 v6, v6, 5, s14
    v_and_b32 v72, 7, v1
    v_lshlrev_b32 v72, 4, v72
    v_xor_b32 v72, v72, v6
    v_lshrrev_b32 v6, 3, v1
    v_mul_u32_u24 v6, 7168, v6
    v_add_u32 v72, v72, v6
    s_and_b32 s96, s3, 1
    s_lshl_b32 s14, s96, 7
    v_lshrrev_b32 v6, 5, v1
    v_lshl_add_u32 v6, v6, 6, s14
    v_and_b32 v73, 31, v1
    v_lshlrev_b32 v73, 4, v73
    v_lshrrev_b32 v9, 5, v1
    v_lshl_add_u32 v73, v9, 11, v73
    v_xor_b32 v73, v73, v6
    s_lshl3_add_u32 s96, s75, s3
    s_mul_i32 s97, s96, 229376
    s_lshl_b32 s98, s74, 7
    s_add_u32 s80, s97, s98
    s_lshl3_add_u32 s96, s74, s3
    s_lshl_b32 s97, s96, 14
    s_lshl_b32 s98, s75, 9
    s_add_u32 s81, s97, s98
    s_lshr_b32 s96, s9, 2
    s_add_u32 s90, s96, 1
    s_cmp_ge_u32 s90, 7
    s_cselect_b32 s90, 4294967290, 1
    s_cmp_ge_u32 s9, 28
    s_cselect_b32 s54, 0, s54
    s_cselect_b32 s58, 0, s58
    s_cselect_b32 s62, 0, s62
    s_waitcnt vmcnt(0)
    s_barrier
    s_cmp_lg_u32 s3, 0
    s_cbranch_scc1 L_PB
    v_mov_b32 v6, s4
    s_mov_b32 exec_hi, 0
    s_mov_b32 exec_lo, 65535
    buffer_store_dword v6, v5, s[32:35], s13 offen sc1
    s_mov_b64 exec, -1
L_PB:
    s_and_b32 s20, s9, 3
    s_cmp_le_u32 s20, 0
    s_cselect_b32 s20, 1, 0
    s_add_u32 s96, s20, s85
    s_and_b32 s97, s96, 15
    s_lshl3_add_u32 s98, s97, s3
    s_mul_i32 s99, s98, 49152
    s_lshl_b32 s96, s11, 7
    s_add_u32 s82, s99, s96
    s_mul_i32 s96, s20, 24960
    s_lshr_b32 s97, s3, 1
    s_mul_i32 s98, s97, 2080
    s_add_u32 s99, s96, s98
    s_and_b32 s97, s3, 1
    s_mul_i32 s96, s97, 1056
    s_add_u32 s20, s99, s96
    s_mov_b32 m0, s20
    s_nop 0
    buffer_load_dwordx4 v62, s[40:43], s82 offen lds
    s_add_u32 s82, s82, 2048
    s_add_u32 m0, s20, 8320
    s_nop 0
    buffer_load_dwordx4 v62, s[40:43], s82 offen lds
    s_add_u32 s82, s82, 2048
    s_add_u32 m0, s20, 16640
    s_nop 0
    buffer_load_dwordx4 v62, s[40:43], s82 offen lds
    s_and_b32 s20, s9, 3
    s_cmp_le_u32 s20, 1
    s_cselect_b32 s20, 2, 1
    s_add_u32 s96, s20, s85
    s_and_b32 s97, s96, 15
    s_lshl3_add_u32 s98, s97, s3
    s_mul_i32 s99, s98, 49152
    s_lshl_b32 s96, s11, 7
    s_add_u32 s82, s99, s96
    s_mul_i32 s96, s20, 24960
    s_lshr_b32 s97, s3, 1
    s_mul_i32 s98, s97, 2080
    s_add_u32 s99, s96, s98
    s_and_b32 s97, s3, 1
    s_mul_i32 s96, s97, 1056
    s_add_u32 s20, s99, s96
    s_mov_b32 m0, s20
    s_nop 0
    buffer_load_dwordx4 v62, s[40:43], s82 offen lds
    s_add_u32 s82, s82, 2048
    s_add_u32 m0, s20, 8320
    s_nop 0
    buffer_load_dwordx4 v62, s[40:43], s82 offen lds
    s_add_u32 s82, s82, 2048
    s_add_u32 m0, s20, 16640
    s_nop 0
    buffer_load_dwordx4 v62, s[40:43], s82 offen lds
    ds_read_b64_tr_b16 v[28:29], v4
    ds_read_b64_tr_b16 v[30:31], v4 offset:256
    ds_read_b64_tr_b16 v[32:33], v4 offset:1024
    ds_read_b64_tr_b16 v[34:35], v4 offset:1280
    s_lshl_b32 s96, s10, 6
    s_add_u32 s97, s96, s3
    s_lshl_b32 s98, s97, 12
    s_add_u32 s15, s98, 4194304
    s_and_b32 s96, s3, 3
    s_lshl_b32 s97, s96, 12
    s_add_u32 s13, s97, 147456
    v_add_u32 v76, s13, v2
    v_and_b32 v77, 15, v1
    v_lshl_add_u32 v77, v77, 4, s13
    v_lshrrev_b32 v9, 5, v1
    v_lshl_add_u32 v77, v9, 9, v77
    v_bfe_u32 v9, v1, 4, 1
    v_lshl_add_u32 v77, v9, 3, v77
    s_and_b32 s96, s3, 3
    s_lshl_b32 s97, s96, 10
    s_add_u32 s13, s97, 32768
    v_and_b32 v78, 15, v1
    v_lshl_add_u32 v78, v78, 5, s13
    v_lshrrev_b32 v9, 4, v1
    v_lshl_add_u32 v78, v9, 3, v78
    s_and_b32 s96, s3, 3
    s_lshl_b32 s97, s96, 10
    s_lshl_b32 s98, s76, 14
    s_add_u32 s13, s97, s98
    v_and_b32 v75, 31, v1
    v_lshl_add_u32 v75, v75, 5, s13
    v_lshrrev_b32 v9, 5, v1
    v_lshl_add_u32 v75, v9, 4, v75
    s_lshl_b32 s84, s3, 14
    s_lshr_b32 s96, s9, 4
    s_lshl_b32 s97, s96, 20
    s_lshl_b32 s98, s12, 7
    s_add_u32 s88, s97, s98
    s_lshl_b32 s89, s3, 10
    s_load_dwordx2 s[24:25], s[32:33], s92 offset:0 glc
    s_and_b32 s20, s9, 3
    s_cmp_le_u32 s20, 2
    s_cselect_b32 s20, 3, 2
    s_add_u32 s96, s20, s85
    s_and_b32 s97, s96, 15
    s_lshl3_add_u32 s98, s97, s3
    s_mul_i32 s99, s98, 49152
    s_lshl_b32 s96, s11, 7
    s_add_u32 s82, s99, s96
    s_mul_i32 s96, s20, 24960
    s_lshr_b32 s97, s3, 1
    s_mul_i32 s98, s97, 2080
    s_add_u32 s99, s96, s98
    s_and_b32 s97, s3, 1
    s_mul_i32 s96, s97, 1056
    s_add_u32 s20, s99, s96
    s_mov_b32 m0, s20
    s_nop 0
    buffer_load_dwordx4 v62, s[40:43], s82 offen lds
    s_add_u32 s82, s82, 2048
    s_add_u32 m0, s20, 8320
    s_nop 0
    buffer_load_dwordx4 v62, s[40:43], s82 offen lds
    s_add_u32 s82, s82, 2048
    s_add_u32 m0, s20, 16640
    s_nop 0
    buffer_load_dwordx4 v62, s[40:43], s82 offen lds
    s_add_u32 s96, s85, 4
    s_and_b32 s97, s96, 15
    s_lshl3_add_u32 s98, s97, s3
    s_mul_i32 s99, s98, 49152
    s_lshl_b32 s96, s11, 7
    s_add_u32 s82, s99, s96
    s_lshr_b32 s96, s3, 1
    s_mul_i32 s97, s96, 2080
    s_and_b32 s98, s3, 1
    s_mul_i32 s99, s98, 1056
    s_add_u32 s96, s97, s99
    s_add_u32 s20, s96, 99840
    s_mov_b32 m0, s20
    s_nop 0
    buffer_load_dwordx4 v62, s[40:43], s82 offen lds
    s_add_u32 s82, s82, 2048
    s_add_u32 m0, s20, 8320
    s_nop 0
    buffer_load_dwordx4 v62, s[40:43], s82 offen lds
    s_add_u32 s82, s82, 2048
    s_add_u32 m0, s20, 16640
    s_nop 0
    buffer_load_dwordx4 v62, s[40:43], s82 offen lds
    s_branch SCHK_12
SPOLL_11:
    s_load_dwordx2 s[24:25], s[32:33], s92 offset:0 glc
SCHK_12:
    s_add_u32 s5, s5, 1
    s_cmp_ge_u32 s5, 300000
    s_waitcnt lgkmcnt(0)
    s_cbranch_scc1 SDONE_13
    s_cmp_lg_u32 s24, s4
    s_cbranch_scc1 SPOLL_11
    s_cmp_lg_u32 s25, s4
    s_cbranch_scc1 SPOLL_11
SDONE_13:
    s_waitcnt vmcnt(9)
    s_barrier
    s_cmp_ge_u32 s3, 4
    s_cbranch_scc1 L_HELP
    s_setprio 2
    s_and_b32 s96, s85, 15
    s_lshl_b32 s97, s96, 14
    s_add_u32 s16, s97, s15
    buffer_load_dwordx4 v[176:179], v2, s[32:35], s16 offen sc1
    buffer_load_dwordx4 v[180:183], v2, s[32:35], s16 offen offset:1024 sc1
    ds_read_b64_tr_b16 v[224:225], v67 offset:8320
    ds_read_b64_tr_b16 v[226:227], v67 offset:8832
    ds_read_b64_tr_b16 v[228:229], v67 offset:8352
    ds_read_b64_tr_b16 v[230:231], v67 offset:8864
    ds_read_b64_tr_b16 v[232:233], v66 offset:8320
    ds_read_b64_tr_b16 v[234:235], v66 offset:8832
    ds_read_b64_tr_b16 v[236:237], v66 offset:8352
    ds_read_b64_tr_b16 v[238:239], v66 offset:8864
    ds_read_b64_tr_b16 v[240:241], v66
    ds_read_b64_tr_b16 v[242:243], v66 offset:512
    ds_read_b64_tr_b16 v[244:245], v66 offset:32
    ds_read_b64_tr_b16 v[246:247], v66 offset:544
    buffer_load_dwordx4 v[184:187], v2, s[32:35], s16 offen offset:2048 sc1
    buffer_load_dwordx4 v[188:191], v2, s[32:35], s16 offen offset:3072 sc1
    s_waitcnt lgkmcnt(8)
    s_waitcnt vmcnt(3)
    v_mfma_f32_16x16x32_bf16 v[128:131], v[224:227], v[176:179], 0
    ds_read_b64_tr_b16 v[248:249], v67
    s_waitcnt vmcnt(2)
    v_mfma_f32_16x16x32_bf16 v[132:135], v[224:227], v[180:183], 0
    ds_read_b64_tr_b16 v[250:251], v67 offset:512
    s_add_u32 s96, s85, 1
    s_and_b32 s97, s96, 15
    s_lshl_b32 s98, s97, 14
    s_add_u32 s16, s98, s15
    buffer_load_dwordx4 v[192:195], v2, s[32:35], s16 offen sc1
    v_mfma_f32_16x16x32_bf16 v[136:139], v[228:231], v[176:179], 0
    ds_read_b64_tr_b16 v[224:225], v67 offset:32
    v_mfma_f32_16x16x32_bf16 v[140:143], v[228:231], v[180:183], 0
    ds_read_b64_tr_b16 v[226:227], v67 offset:544
    s_waitcnt lgkmcnt(8)
    v_mfma_f32_16x16x32_bf16 v[112:115], v[232:235], v[176:179], 0
    ds_read_b64_tr_b16 v[228:229], v66 offset:16640
    v_mfma_f32_16x16x32_bf16 v[116:119], v[232:235], v[180:183], 0
    ds_read_b64_tr_b16 v[230:231], v66 offset:17152
    v_mfma_f32_16x16x32_bf16 v[120:123], v[236:239], v[176:179], 0
    ds_read_b64_tr_b16 v[232:233], v66 offset:16672
    v_mfma_f32_16x16x32_bf16 v[124:127], v[236:239], v[180:183], 0
    ds_read_b64_tr_b16 v[234:235], v66 offset:17184
    buffer_load_dwordx4 v[196:199], v2, s[32:35], s16 offen offset:1024 sc1
    s_waitcnt lgkmcnt(8)
    v_mfma_f32_16x16x32_bf16 v[80:83], v[240:243], v[176:179], 0
    ds_read_b64_tr_b16 v[236:237], v67 offset:16640
    v_mfma_f32_16x16x32_bf16 v[84:87], v[240:243], v[180:183], 0
    ds_read_b64_tr_b16 v[238:239], v67 offset:17152
    v_mfma_f32_16x16x32_bf16 v[88:91], v[244:247], v[176:179], 0
    ds_read_b64_tr_b16 v[240:241], v67 offset:16672
    v_mfma_f32_16x16x32_bf16 v[92:95], v[244:247], v[180:183], 0
    ds_read_b64_tr_b16 v[242:243], v67 offset:17184
    s_waitcnt lgkmcnt(8)
    v_mfma_f32_16x16x32_bf16 v[96:99], v[248:251], v[176:179], 0
    ds_read_b64_tr_b16 v[244:245], v67 offset:12480
    v_mfma_f32_16x16x32_bf16 v[100:103], v[248:251], v[180:183], 0
    ds_read_b64_tr_b16 v[246:247], v67 offset:12992
    buffer_load_dwordx4 v[200:203], v2, s[32:35], s16 offen offset:2048 sc1
    v_mfma_f32_16x16x32_bf16 v[104:107], v[224:227], v[176:179], 0
    ds_read_b64_tr_b16 v[248:249], v67 offset:12512
    v_mfma_f32_16x16x32_bf16 v[108:111], v[224:227], v[180:183], 0
    ds_read_b64_tr_b16 v[250:251], v67 offset:13024
    s_waitcnt lgkmcnt(8)
    v_mfma_f32_16x16x32_bf16 v[144:147], v[228:231], v[176:179], 0
    ds_read_b64_tr_b16 v[224:225], v66 offset:12480
    v_mfma_f32_16x16x32_bf16 v[148:151], v[228:231], v[180:183], 0
    ds_read_b64_tr_b16 v[226:227], v66 offset:12992
    v_mfma_f32_16x16x32_bf16 v[152:155], v[232:235], v[176:179], 0
    ds_read_b64_tr_b16 v[228:229], v66 offset:12512
    v_mfma_f32_16x16x32_bf16 v[156:159], v[232:235], v[180:183], 0
    ds_read_b64_tr_b16 v[230:231], v66 offset:13024
    buffer_load_dwordx4 v[204:207], v2, s[32:35], s16 offen offset:3072 sc1
    s_waitcnt lgkmcnt(8)
    v_mfma_f32_16x16x32_bf16 v[160:163], v[236:239], v[176:179], 0
    ds_read_b64_tr_b16 v[232:233], v66 offset:4160
    v_mfma_f32_16x16x32_bf16 v[164:167], v[236:239], v[180:183], 0
    ds_read_b64_tr_b16 v[234:235], v66 offset:4672
    v_mfma_f32_16x16x32_bf16 v[168:171], v[240:243], v[176:179], 0
    ds_read_b64_tr_b16 v[236:237], v66 offset:4192
    v_mfma_f32_16x16x32_bf16 v[172:175], v[240:243], v[180:183], 0
    ds_read_b64_tr_b16 v[238:239], v66 offset:4704
    s_waitcnt lgkmcnt(8)
    s_waitcnt vmcnt(5)
    v_mfma_f32_16x16x32_bf16 v[128:131], v[244:247], v[184:187], v[128:131]
    ds_read_b64_tr_b16 v[240:241], v67 offset:4160
    s_waitcnt vmcnt(4)
    v_mfma_f32_16x16x32_bf16 v[132:135], v[244:247], v[188:191], v[132:135]
    ds_read_b64_tr_b16 v[242:243], v67 offset:4672
    s_add_u32 s96, s85, 2
    s_and_b32 s97, s96, 15
    s_lshl_b32 s98, s97, 14
    s_add_u32 s16, s98, s15
    buffer_load_dwordx4 v[208:211], v2, s[32:35], s16 offen sc1
    v_mfma_f32_16x16x32_bf16 v[136:139], v[248:251], v[184:187], v[136:139]
    ds_read_b64_tr_b16 v[244:245], v67 offset:4192
    v_mfma_f32_16x16x32_bf16 v[140:143], v[248:251], v[188:191], v[140:143]
    ds_read_b64_tr_b16 v[246:247], v67 offset:4704
    s_waitcnt lgkmcnt(8)
    v_mfma_f32_16x16x32_bf16 v[112:115], v[224:227], v[184:187], v[112:115]
    ds_read_b64_tr_b16 v[248:249], v66 offset:20800
    v_mfma_f32_16x16x32_bf16 v[116:119], v[224:227], v[188:191], v[116:119]
    ds_read_b64_tr_b16 v[250:251], v66 offset:21312
    v_mfma_f32_16x16x32_bf16 v[120:123], v[228:231], v[184:187], v[120:123]
    ds_read_b64_tr_b16 v[224:225], v66 offset:20832
    v_mfma_f32_16x16x32_bf16 v[124:127], v[228:231], v[188:191], v[124:127]
    ds_read_b64_tr_b16 v[226:227], v66 offset:21344
    buffer_load_dwordx4 v[212:215], v2, s[32:35], s16 offen offset:1024 sc1
    s_waitcnt lgkmcnt(8)
    v_mfma_f32_16x16x32_bf16 v[80:83], v[232:235], v[184:187], v[80:83]
    ds_read_b64_tr_b16 v[228:229], v67 offset:20800
    v_mfma_f32_16x16x32_bf16 v[84:87], v[232:235], v[188:191], v[84:87]
    ds_read_b64_tr_b16 v[230:231], v67 offset:21312
    v_mfma_f32_16x16x32_bf16 v[88:91], v[236:239], v[184:187], v[88:91]
    ds_read_b64_tr_b16 v[232:233], v67 offset:20832
    v_mfma_f32_16x16x32_bf16 v[92:95], v[236:239], v[188:191], v[92:95]
    ds_read_b64_tr_b16 v[234:235], v67 offset:21344
    s_waitcnt lgkmcnt(8)
    v_mfma_f32_16x16x32_bf16 v[96:99], v[240:243], v[184:187], v[96:99]
    s_barrier
    ds_read_b64_tr_b16 v[236:237], v67 offset:33280
    v_mfma_f32_16x16x32_bf16 v[100:103], v[240:243], v[188:191], v[100:103]
    ds_read_b64_tr_b16 v[238:239], v67 offset:33792
    buffer_load_dwordx4 v[216:219], v2, s[32:35], s16 offen offset:2048 sc1
    v_mfma_f32_16x16x32_bf16 v[104:107], v[244:247], v[184:187], v[104:107]
    ds_read_b64_tr_b16 v[240:241], v67 offset:33312
    v_mfma_f32_16x16x32_bf16 v[108:111], v[244:247], v[188:191], v[108:111]
    ds_read_b64_tr_b16 v[242:243], v67 offset:33824
    s_waitcnt lgkmcnt(8)
    v_mfma_f32_16x16x32_bf16 v[144:147], v[248:251], v[184:187], v[144:147]
    ds_read_b64_tr_b16 v[244:245], v66 offset:33280
    v_mfma_f32_16x16x32_bf16 v[148:151], v[248:251], v[188:191], v[148:151]
    ds_read_b64_tr_b16 v[246:247], v66 offset:33792
    v_mfma_f32_16x16x32_bf16 v[152:155], v[224:227], v[184:187], v[152:155]
    ds_read_b64_tr_b16 v[248:249], v66 offset:33312
    v_mfma_f32_16x16x32_bf16 v[156:159], v[224:227], v[188:191], v[156:159]
    ds_read_b64_tr_b16 v[250:251], v66 offset:33824
    buffer_load_dwordx4 v[220:223], v2, s[32:35], s16 offen offset:3072 sc1
    s_waitcnt lgkmcnt(8)
    v_mfma_f32_16x16x32_bf16 v[160:163], v[228:231], v[184:187], v[160:163]
    ds_read_b64_tr_b16 v[224:225], v66 offset:24960
    v_mfma_f32_16x16x32_bf16 v[164:167], v[228:231], v[188:191], v[164:167]
    ds_read_b64_tr_b16 v[226:227], v66 offset:25472
    v_mfma_f32_16x16x32_bf16 v[168:171], v[232:235], v[184:187], v[168:171]
    ds_read_b64_tr_b16 v[228:229], v66 offset:24992
    v_mfma_f32_16x16x32_bf16 v[172:175], v[232:235], v[188:191], v[172:175]
    ds_read_b64_tr_b16 v[230:231], v66 offset:25504
    s_waitcnt lgkmcnt(8)
    s_waitcnt vmcnt(6)
    v_mfma_f32_16x16x32_bf16 v[128:131], v[236:239], v[192:195], v[128:131]
    ds_read_b64_tr_b16 v[232:233], v67 offset:24960
    v_mfma_f32_16x16x32_bf16 v[132:135], v[236:239], v[196:199], v[132:135]
    ds_read_b64_tr_b16 v[234:235], v67 offset:25472
    s_add_u32 s96, s85, 3
    s_and_b32 s97, s96, 15
    s_lshl_b32 s98, s97, 14
    s_add_u32 s16, s98, s15
    buffer_load_dwordx4 v[36:39], v2, s[32:35], s16 offen sc1
    v_mfma_f32_16x16x32_bf16 v[136:139], v[240:243], v[192:195], v[136:139]
    ds_read_b64_tr_b16 v[236:237], v67 offset:24992
    v_mfma_f32_16x16x32_bf16 v[140:143], v[240:243], v[196:199], v[140:143]
    ds_read_b64_tr_b16 v[238:239], v67 offset:25504
    s_waitcnt lgkmcnt(8)
    v_mfma_f32_16x16x32_bf16 v[112:115], v[244:247], v[192:195], v[112:115]
    ds_read_b64_tr_b16 v[240:241], v66 offset:41600
    v_mfma_f32_16x16x32_bf16 v[116:119], v[244:247], v[196:199], v[116:119]
    ds_read_b64_tr_b16 v[242:243], v66 offset:42112
    v_mfma_f32_16x16x32_bf16 v[120:123], v[248:251], v[192:195], v[120:123]
    ds_read_b64_tr_b16 v[244:245], v66 offset:41632
    v_mfma_f32_16x16x32_bf16 v[124:127], v[248:251], v[196:199], v[124:127]
    ds_read_b64_tr_b16 v[246:247], v66 offset:42144
    buffer_load_dwordx4 v[176:179], v2, s[32:35], s16 offen offset:1024 sc1
    s_waitcnt lgkmcnt(8)
    v_mfma_f32_16x16x32_bf16 v[80:83], v[224:227], v[192:195], v[80:83]
    ds_read_b64_tr_b16 v[248:249], v67 offset:41600
    v_mfma_f32_16x16x32_bf16 v[84:87], v[224:227], v[196:199], v[84:87]
    ds_read_b64_tr_b16 v[250:251], v67 offset:42112
    v_mfma_f32_16x16x32_bf16 v[88:91], v[228:231], v[192:195], v[88:91]
    ds_read_b64_tr_b16 v[224:225], v67 offset:41632
    v_mfma_f32_16x16x32_bf16 v[92:95], v[228:231], v[196:199], v[92:95]
    ds_read_b64_tr_b16 v[226:227], v67 offset:42144
    s_waitcnt lgkmcnt(8)
    v_mfma_f32_16x16x32_bf16 v[96:99], v[232:235], v[192:195], v[96:99]
    ds_read_b64_tr_b16 v[228:229], v67 offset:37440
    v_mfma_f32_16x16x32_bf16 v[100:103], v[232:235], v[196:199], v[100:103]
    ds_read_b64_tr_b16 v[230:231], v67 offset:37952
    buffer_load_dwordx4 v[180:183], v2, s[32:35], s16 offen offset:2048 sc1
    v_mfma_f32_16x16x32_bf16 v[104:107], v[236:239], v[192:195], v[104:107]
    ds_read_b64_tr_b16 v[232:233], v67 offset:37472
    v_mfma_f32_16x16x32_bf16 v[108:111], v[236:239], v[196:199], v[108:111]
    ds_read_b64_tr_b16 v[234:235], v67 offset:37984
    s_waitcnt lgkmcnt(8)
    v_mfma_f32_16x16x32_bf16 v[144:147], v[240:243], v[192:195], v[144:147]
    ds_read_b64_tr_b16 v[236:237], v66 offset:37440
    v_mfma_f32_16x16x32_bf16 v[148:151], v[240:243], v[196:199], v[148:151]
    ds_read_b64_tr_b16 v[238:239], v66 offset:37952
    v_mfma_f32_16x16x32_bf16 v[152:155], v[244:247], v[192:195], v[152:155]
    ds_read_b64_tr_b16 v[240:241], v66 offset:37472
    v_mfma_f32_16x16x32_bf16 v[156:159], v[244:247], v[196:199], v[156:159]
    ds_read_b64_tr_b16 v[242:243], v66 offset:37984
    buffer_load_dwordx4 v[184:187], v2, s[32:35], s16 offen offset:3072 sc1
    s_waitcnt lgkmcnt(8)
    v_mfma_f32_16x16x32_bf16 v[160:163], v[248:251], v[192:195], v[160:163]
    ds_read_b64_tr_b16 v[244:245], v66 offset:29120
    v_mfma_f32_16x16x32_bf16 v[164:167], v[248:251], v[196:199], v[164:167]
    ds_read_b64_tr_b16 v[246:247], v66 offset:29632
    v_mfma_f32_16x16x32_bf16 v[168:171], v[224:227], v[192:195], v[168:171]
    ds_read_b64_tr_b16 v[248:249], v66 offset:29152
    v_mfma_f32_16x16x32_bf16 v[172:175], v[224:227], v[196:199], v[172:175]
    ds_read_b64_tr_b16 v[250:251], v66 offset:29664
    s_waitcnt lgkmcnt(8)
    s_waitcnt vmcnt(8)
    v_mfma_f32_16x16x32_bf16 v[128:131], v[228:231], v[200:203], v[128:131]
    ds_read_b64_tr_b16 v[224:225], v67 offset:29120
    v_mfma_f32_16x16x32_bf16 v[132:135], v[228:231], v[204:207], v[132:135]
    ds_read_b64_tr_b16 v[226:227], v67 offset:29632
    s_add_u32 s96, s85, 4
    s_and_b32 s97, s96, 15
    s_lshl_b32 s98, s97, 14
    s_add_u32 s16, s98, s15
    buffer_load_dwordx4 v[188:191], v2, s[32:35], s16 offen sc1
    v_mfma_f32_16x16x32_bf16 v[136:139], v[232:235], v[200:203], v[136:139]
    ds_read_b64_tr_b16 v[228:229], v67 offset:29152
    v_mfma_f32_16x16x32_bf16 v[140:143], v[232:235], v[204:207], v[140:143]
    ds_read_b64_tr_b16 v[230:231], v67 offset:29664
    s_waitcnt lgkmcnt(8)
    v_mfma_f32_16x16x32_bf16 v[112:115], v[236:239], v[200:203], v[112:115]
    ds_read_b64_tr_b16 v[232:233], v66 offset:45760
    v_mfma_f32_16x16x32_bf16 v[116:119], v[236:239], v[204:207], v[116:119]
    ds_read_b64_tr_b16 v[234:235], v66 offset:46272
    v_mfma_f32_16x16x32_bf16 v[120:123], v[240:243], v[200:203], v[120:123]
    ds_read_b64_tr_b16 v[236:237], v66 offset:45792
    v_mfma_f32_16x16x32_bf16 v[124:127], v[240:243], v[204:207], v[124:127]
    ds_read_b64_tr_b16 v[238:239], v66 offset:46304
    buffer_load_dwordx4 v[192:195], v2, s[32:35], s16 offen offset:1024 sc1
    s_waitcnt lgkmcnt(8)
    v_mfma_f32_16x16x32_bf16 v[80:83], v[244:247], v[200:203], v[80:83]
    ds_read_b64_tr_b16 v[240:241], v67 offset:45760
    v_mfma_f32_16x16x32_bf16 v[84:87], v[244:247], v[204:207], v[84:87]
    ds_read_b64_tr_b16 v[242:243], v67 offset:46272
    v_mfma_f32_16x16x32_bf16 v[88:91], v[248:251], v[200:203], v[88:91]
    ds_read_b64_tr_b16 v[244:245], v67 offset:45792
    v_mfma_f32_16x16x32_bf16 v[92:95], v[248:251], v[204:207], v[92:95]
    ds_read_b64_tr_b16 v[246:247], v67 offset:46304
    s_waitcnt lgkmcnt(8)
    v_mfma_f32_16x16x32_bf16 v[96:99], v[224:227], v[200:203], v[96:99]
    s_barrier
    ds_read_b64_tr_b16 v[248:249], v69 offset:8320
    v_mfma_f32_16x16x32_bf16 v[100:103], v[224:227], v[204:207], v[100:103]
    ds_read_b64_tr_b16 v[250:251], v69 offset:8832
    buffer_load_dwordx4 v[196:199], v2, s[32:35], s16 offen offset:2048 sc1
    v_mfma_f32_16x16x32_bf16 v[104:107], v[228:231], v[200:203], v[104:107]
    ds_read_b64_tr_b16 v[224:225], v69 offset:8352
    v_mfma_f32_16x16x32_bf16 v[108:111], v[228:231], v[204:207], v[108:111]
    ds_read_b64_tr_b16 v[226:227], v69 offset:8864
    s_waitcnt lgkmcnt(8)
    v_mfma_f32_16x16x32_bf16 v[144:147], v[232:235], v[200:203], v[144:147]
    ds_read_b64_tr_b16 v[228:229], v68 offset:8320
    v_mfma_f32_16x16x32_bf16 v[148:151], v[232:235], v[204:207], v[148:151]
    ds_read_b64_tr_b16 v[230:231], v68 offset:8832
    v_mfma_f32_16x16x32_bf16 v[152:155], v[236:239], v[200:203], v[152:155]
    ds_read_b64_tr_b16 v[232:233], v68 offset:8352
    v_mfma_f32_16x16x32_bf16 v[156:159], v[236:239], v[204:207], v[156:159]
    ds_read_b64_tr_b16 v[234:235], v68 offset:8864
    s_waitcnt lgkmcnt(8)
    v_mfma_f32_16x16x32_bf16 v[160:163], v[240:243], v[200:203], v[160:163]
    ds_read_b64_tr_b16 v[236:237], v68
    v_mfma_f32_16x16x32_bf16 v[164:167], v[240:243], v[204:207], v[164:167]
    ds_read_b64_tr_b16 v[238:239], v68 offset:512
    v_mfma_f32_16x16x32_bf16 v[168:171], v[244:247], v[200:203], v[168:171]
    ds_read_b64_tr_b16 v[240:241], v68 offset:32
    v_mfma_f32_16x16x32_bf16 v[172:175], v[244:247], v[204:207], v[172:175]
    ds_read_b64_tr_b16 v[242:243], v68 offset:544
    s_waitcnt lgkmcnt(8)
    s_waitcnt vmcnt(9)
    v_mfma_f32_16x16x32_bf16 v[128:131], v[248:251], v[208:211], v[128:131]
    ds_read_b64_tr_b16 v[244:245], v69
    v_mfma_f32_16x16x32_bf16 v[132:135], v[248:251], v[212:215], v[132:135]
    ds_read_b64_tr_b16 v[246:247], v69 offset:512
    buffer_load_dwordx4 v[200:203], v2, s[32:35], s16 offen offset:3072 sc1
    v_mfma_f32_16x16x32_bf16 v[136:139], v[224:227], v[208:211], v[136:139]
    ds_read_b64_tr_b16 v[248:249], v69 offset:32
    v_mfma_f32_16x16x32_bf16 v[140:143], v[224:227], v[212:215], v[140:143]
    ds_read_b64_tr_b16 v[250:251], v69 offset:544
    s_waitcnt lgkmcnt(8)
    v_mfma_f32_16x16x32_bf16 v[112:115], v[228:231], v[208:211], v[112:115]
    ds_read_b64_tr_b16 v[224:225], v68 offset:16640
    v_mfma_f32_16x16x32_bf16 v[116:119], v[228:231], v[212:215], v[116:119]
    ds_read_b64_tr_b16 v[226:227], v68 offset:17152
    v_mfma_f32_16x16x32_bf16 v[120:123], v[232:235], v[208:211], v[120:123]
    ds_read_b64_tr_b16 v[228:229], v68 offset:16672
    v_mfma_f32_16x16x32_bf16 v[124:127], v[232:235], v[212:215], v[124:127]
    ds_read_b64_tr_b16 v[230:231], v68 offset:17184
    s_add_u32 s96, s85, 5
    s_and_b32 s97, s96, 15
    s_lshl_b32 s98, s97, 14
    s_add_u32 s16, s98, s15
    buffer_load_dwordx4 v[204:207], v2, s[32:35], s16 offen sc1
    s_waitcnt lgkmcnt(8)
    v_mfma_f32_16x16x32_bf16 v[80:83], v[236:239], v[208:211], v[80:83]
    ds_read_b64_tr_b16 v[232:233], v69 offset:16640
    v_mfma_f32_16x16x32_bf16 v[84:87], v[236:239], v[212:215], v[84:87]
    ds_read_b64_tr_b16 v[234:235], v69 offset:17152
    v_mfma_f32_16x16x32_bf16 v[88:91], v[240:243], v[208:211], v[88:91]
    ds_read_b64_tr_b16 v[236:237], v69 offset:16672
    v_mfma_f32_16x16x32_bf16 v[92:95], v[240:243], v[212:215], v[92:95]
    ds_read_b64_tr_b16 v[238:239], v69 offset:17184
    s_waitcnt lgkmcnt(8)
    v_mfma_f32_16x16x32_bf16 v[96:99], v[244:247], v[208:211], v[96:99]
    ds_read_b64_tr_b16 v[240:241], v69 offset:12480
    v_mfma_f32_16x16x32_bf16 v[100:103], v[244:247], v[212:215], v[100:103]
    ds_read_b64_tr_b16 v[242:243], v69 offset:12992
    v_mfma_f32_16x16x32_bf16 v[104:107], v[248:251], v[208:211], v[104:107]
    ds_read_b64_tr_b16 v[244:245], v69 offset:12512
    v_mfma_f32_16x16x32_bf16 v[108:111], v[248:251], v[212:215], v[108:111]
    ds_read_b64_tr_b16 v[246:247], v69 offset:13024
    s_waitcnt lgkmcnt(8)
    v_mfma_f32_16x16x32_bf16 v[144:147], v[224:227], v[208:211], v[144:147]
    ds_read_b64_tr_b16 v[248:249], v68 offset:12480
    v_mfma_f32_16x16x32_bf16 v[148:151], v[224:227], v[212:215], v[148:151]
    ds_read_b64_tr_b16 v[250:251], v68 offset:12992
    v_mfma_f32_16x16x32_bf16 v[152:155], v[228:231], v[208:211], v[152:155]
    ds_read_b64_tr_b16 v[224:225], v68 offset:12512
    v_mfma_f32_16x16x32_bf16 v[156:159], v[228:231], v[212:215], v[156:159]
    ds_read_b64_tr_b16 v[226:227], v68 offset:13024
    s_waitcnt lgkmcnt(8)
    v_mfma_f32_16x16x32_bf16 v[160:163], v[232:235], v[208:211], v[160:163]
    ds_read_b64_tr_b16 v[228:229], v68 offset:4160
    v_mfma_f32_16x16x32_bf16 v[164:167], v[232:235], v[212:215], v[164:167]
    ds_read_b64_tr_b16 v[230:231], v68 offset:4672
    v_mfma_f32_16x16x32_bf16 v[168:171], v[236:239], v[208:211], v[168:171]
    ds_read_b64_tr_b16 v[232:233], v68 offset:4192
    v_mfma_f32_16x16x32_bf16 v[172:175], v[236:239], v[212:215], v[172:175]
    ds_read_b64_tr_b16 v[234:235], v68 offset:4704
    s_waitcnt lgkmcnt(8)
    s_waitcnt vmcnt(9)
    v_mfma_f32_16x16x32_bf16 v[128:131], v[240:243], v[216:219], v[128:131]
    ds_read_b64_tr_b16 v[236:237], v69 offset:4160
    v_mfma_f32_16x16x32_bf16 v[132:135], v[240:243], v[220:223], v[132:135]
    ds_read_b64_tr_b16 v[238:239], v69 offset:4672
    buffer_load_dwordx4 v[208:211], v2, s[32:35], s16 offen offset:1024 sc1
    v_mfma_f32_16x16x32_bf16 v[136:139], v[244:247], v[216:219], v[136:139]
    ds_read_b64_tr_b16 v[240:241], v69 offset:4192
    v_mfma_f32_16x16x32_bf16 v[140:143], v[244:247], v[220:223], v[140:143]
    ds_read_b64_tr_b16 v[242:243], v69 offset:4704
    s_waitcnt lgkmcnt(8)
    v_mfma_f32_16x16x32_bf16 v[112:115], v[248:251], v[216:219], v[112:115]
    ds_read_b64_tr_b16 v[244:245], v68 offset:20800
    v_mfma_f32_16x16x32_bf16 v[116:119], v[248:251], v[220:223], v[116:119]
    ds_read_b64_tr_b16 v[246:247], v68 offset:21312
    v_mfma_f32_16x16x32_bf16 v[120:123], v[224:227], v[216:219], v[120:123]
    ds_read_b64_tr_b16 v[248:249], v68 offset:20832
    v_mfma_f32_16x16x32_bf16 v[124:127], v[224:227], v[220:223], v[124:127]
    ds_read_b64_tr_b16 v[250:251], v68 offset:21344
    buffer_load_dwordx4 v[212:215], v2, s[32:35], s16 offen offset:2048 sc1
    s_waitcnt lgkmcnt(8)
    v_mfma_f32_16x16x32_bf16 v[80:83], v[228:231], v[216:219], v[80:83]
    ds_read_b64_tr_b16 v[224:225], v69 offset:20800
    v_mfma_f32_16x16x32_bf16 v[84:87], v[228:231], v[220:223], v[84:87]
    ds_read_b64_tr_b16 v[226:227], v69 offset:21312
    v_mfma_f32_16x16x32_bf16 v[88:91], v[232:235], v[216:219], v[88:91]
    ds_read_b64_tr_b16 v[228:229], v69 offset:20832
    v_mfma_f32_16x16x32_bf16 v[92:95], v[232:235], v[220:223], v[92:95]
    ds_read_b64_tr_b16 v[230:231], v69 offset:21344
    s_waitcnt lgkmcnt(8)
    v_mfma_f32_16x16x32_bf16 v[96:99], v[236:239], v[216:219], v[96:99]
    s_barrier
    ds_read_b64_tr_b16 v[232:233], v69 offset:33280
    v_mfma_f32_16x16x32_bf16 v[100:103], v[236:239], v[220:223], v[100:103]
    ds_read_b64_tr_b16 v[234:235], v69 offset:33792
    v_mfma_f32_16x16x32_bf16 v[104:107], v[240:243], v[216:219], v[104:107]
    ds_read_b64_tr_b16 v[236:237], v69 offset:33312
    v_mfma_f32_16x16x32_bf16 v[108:111], v[240:243], v[220:223], v[108:111]
    ds_read_b64_tr_b16 v[238:239], v69 offset:33824
    s_waitcnt lgkmcnt(8)
    v_mfma_f32_16x16x32_bf16 v[144:147], v[244:247], v[216:219], v[144:147]
    ds_read_b64_tr_b16 v[240:241], v68 offset:33280
    v_mfma_f32_16x16x32_bf16 v[148:151], v[244:247], v[220:223], v[148:151]
    ds_read_b64_tr_b16 v[242:243], v68 offset:33792
    v_mfma_f32_16x16x32_bf16 v[152:155], v[248:251], v[216:219], v[152:155]
    ds_read_b64_tr_b16 v[244:245], v68 offset:33312
    v_mfma_f32_16x16x32_bf16 v[156:159], v[248:251], v[220:223], v[156:159]
    ds_read_b64_tr_b16 v[246:247], v68 offset:33824
    s_waitcnt lgkmcnt(8)
    v_mfma_f32_16x16x32_bf16 v[160:163], v[224:227], v[216:219], v[160:163]
    ds_read_b64_tr_b16 v[248:249], v68 offset:24960
    v_mfma_f32_16x16x32_bf16 v[164:167], v[224:227], v[220:223], v[164:167]
    ds_read_b64_tr_b16 v[250:251], v68 offset:25472
    v_mfma_f32_16x16x32_bf16 v[168:171], v[228:231], v[216:219], v[168:171]
    ds_read_b64_tr_b16 v[224:225], v68 offset:24992
    v_mfma_f32_16x16x32_bf16 v[172:175], v[228:231], v[220:223], v[172:175]
    ds_read_b64_tr_b16 v[226:227], v68 offset:25504
    s_waitcnt lgkmcnt(8)
    s_waitcnt vmcnt(9)
    v_mfma_f32_16x16x32_bf16 v[128:131], v[232:235], v[36:39], v[128:131]
    ds_read_b64_tr_b16 v[228:229], v69 offset:24960
    v_mfma_f32_16x16x32_bf16 v[132:135], v[232:235], v[176:179], v[132:135]
    ds_read_b64_tr_b16 v[230:231], v69 offset:25472
    buffer_load_dwordx4 v[216:219], v2, s[32:35], s16 offen offset:3072 sc1
    v_mfma_f32_16x16x32_bf16 v[136:139], v[236:239], v[36:39], v[136:139]
    ds_read_b64_tr_b16 v[232:233], v69 offset:24992
    v_mfma_f32_16x16x32_bf16 v[140:143], v[236:239], v[176:179], v[140:143]
    ds_read_b64_tr_b16 v[234:235], v69 offset:25504
    s_waitcnt lgkmcnt(8)
    v_mfma_f32_16x16x32_bf16 v[112:115], v[240:243], v[36:39], v[112:115]
    ds_read_b64_tr_b16 v[236:237], v68 offset:41600
    v_mfma_f32_16x16x32_bf16 v[116:119], v[240:243], v[176:179], v[116:119]
    ds_read_b64_tr_b16 v[238:239], v68 offset:42112
    v_mfma_f32_16x16x32_bf16 v[120:123], v[244:247], v[36:39], v[120:123]
    ds_read_b64_tr_b16 v[240:241], v68 offset:41632
    v_mfma_f32_16x16x32_bf16 v[124:127], v[244:247], v[176:179], v[124:127]
    ds_read_b64_tr_b16 v[242:243], v68 offset:42144
    s_add_u32 s96, s85, 6
    s_and_b32 s97, s96, 15
    s_lshl_b32 s98, s97, 14
    s_add_u32 s16, s98, s15
    buffer_load_dwordx4 v[220:223], v2, s[32:35], s16 offen sc1
    s_waitcnt lgkmcnt(8)
    v_mfma_f32_16x16x32_bf16 v[80:83], v[248:251], v[36:39], v[80:83]
    ds_read_b64_tr_b16 v[244:245], v69 offset:41600
    v_mfma_f32_16x16x32_bf16 v[84:87], v[248:251], v[176:179], v[84:87]
    ds_read_b64_tr_b16 v[246:247], v69 offset:42112
    v_mfma_f32_16x16x32_bf16 v[88:91], v[224:227], v[36:39], v[88:91]
    ds_read_b64_tr_b16 v[248:249], v69 offset:41632
    v_mfma_f32_16x16x32_bf16 v[92:95], v[224:227], v[176:179], v[92:95]
    ds_read_b64_tr_b16 v[250:251], v69 offset:42144
    s_waitcnt lgkmcnt(8)
    v_mfma_f32_16x16x32_bf16 v[96:99], v[228:231], v[36:39], v[96:99]
    ds_read_b64_tr_b16 v[224:225], v69 offset:37440
    v_mfma_f32_16x16x32_bf16 v[100:103], v[228:231], v[176:179], v[100:103]
    ds_read_b64_tr_b16 v[226:227], v69 offset:37952
    v_mfma_f32_16x16x32_bf16 v[104:107], v[232:235], v[36:39], v[104:107]
    ds_read_b64_tr_b16 v[228:229], v69 offset:37472
    v_mfma_f32_16x16x32_bf16 v[108:111], v[232:235], v[176:179], v[108:111]
    ds_read_b64_tr_b16 v[230:231], v69 offset:37984
    s_waitcnt lgkmcnt(8)
    v_mfma_f32_16x16x32_bf16 v[144:147], v[236:239], v[36:39], v[144:147]
    ds_read_b64_tr_b16 v[232:233], v68 offset:37440
    v_mfma_f32_16x16x32_bf16 v[148:151], v[236:239], v[176:179], v[148:151]
    ds_read_b64_tr_b16 v[234:235], v68 offset:37952
    v_mfma_f32_16x16x32_bf16 v[152:155], v[240:243], v[36:39], v[152:155]
    ds_read_b64_tr_b16 v[236:237], v68 offset:37472
    v_mfma_f32_16x16x32_bf16 v[156:159], v[240:243], v[176:179], v[156:159]
    ds_read_b64_tr_b16 v[238:239], v68 offset:37984
    s_waitcnt lgkmcnt(8)
    v_mfma_f32_16x16x32_bf16 v[160:163], v[244:247], v[36:39], v[160:163]
    ds_read_b64_tr_b16 v[240:241], v68 offset:29120
    v_mfma_f32_16x16x32_bf16 v[164:167], v[244:247], v[176:179], v[164:167]
    ds_read_b64_tr_b16 v[242:243], v68 offset:29632
    v_mfma_f32_16x16x32_bf16 v[168:171], v[248:251], v[36:39], v[168:171]
    ds_read_b64_tr_b16 v[244:245], v68 offset:29152
    v_mfma_f32_16x16x32_bf16 v[172:175], v[248:251], v[176:179], v[172:175]
    ds_read_b64_tr_b16 v[246:247], v68 offset:29664
    s_waitcnt lgkmcnt(8)
    s_waitcnt vmcnt(9)
    v_mfma_f32_16x16x32_bf16 v[128:131], v[224:227], v[180:183], v[128:131]
    ds_read_b64_tr_b16 v[248:249], v69 offset:29120
    v_mfma_f32_16x16x32_bf16 v[132:135], v[224:227], v[184:187], v[132:135]
    ds_read_b64_tr_b16 v[250:251], v69 offset:29632
    buffer_load_dwordx4 v[36:39], v2, s[32:35], s16 offen offset:1024 sc1
    v_mfma_f32_16x16x32_bf16 v[136:139], v[228:231], v[180:183], v[136:139]
    ds_read_b64_tr_b16 v[224:225], v69 offset:29152
    v_mfma_f32_16x16x32_bf16 v[140:143], v[228:231], v[184:187], v[140:143]
    ds_read_b64_tr_b16 v[226:227], v69 offset:29664
    s_waitcnt lgkmcnt(8)
    v_mfma_f32_16x16x32_bf16 v[112:115], v[232:235], v[180:183], v[112:115]
    ds_read_b64_tr_b16 v[228:229], v68 offset:45760
    v_mfma_f32_16x16x32_bf16 v[116:119], v[232:235], v[184:187], v[116:119]
    ds_read_b64_tr_b16 v[230:231], v68 offset:46272
    v_mfma_f32_16x16x32_bf16 v[120:123], v[236:239], v[180:183], v[120:123]
    ds_read_b64_tr_b16 v[232:233], v68 offset:45792
    v_mfma_f32_16x16x32_bf16 v[124:127], v[236:239], v[184:187], v[124:127]
    ds_read_b64_tr_b16 v[234:235], v68 offset:46304
    buffer_load_dwordx4 v[176:179], v2, s[32:35], s16 offen offset:2048 sc1
    s_waitcnt lgkmcnt(8)
    v_mfma_f32_16x16x32_bf16 v[80:83], v[240:243], v[180:183], v[80:83]
    ds_read_b64_tr_b16 v[236:237], v69 offset:45760
    v_mfma_f32_16x16x32_bf16 v[84:87], v[240:243], v[184:187], v[84:87]
    ds_read_b64_tr_b16 v[238:239], v69 offset:46272
    v_mfma_f32_16x16x32_bf16 v[88:91], v[244:247], v[180:183], v[88:91]
    ds_read_b64_tr_b16 v[240:241], v69 offset:45792
    v_mfma_f32_16x16x32_bf16 v[92:95], v[244:247], v[184:187], v[92:95]
    ds_read_b64_tr_b16 v[242:243], v69 offset:46304
    s_waitcnt lgkmcnt(8)
    v_mfma_f32_16x16x32_bf16 v[96:99], v[248:251], v[180:183], v[96:99]
    s_barrier
    ds_read_b64_tr_b16 v[244:245], v71 offset:8320
    v_mfma_f32_16x16x32_bf16 v[100:103], v[248:251], v[184:187], v[100:103]
    ds_read_b64_tr_b16 v[246:247], v71 offset:8832
    v_mfma_f32_16x16x32_bf16 v[104:107], v[224:227], v[180:183], v[104:107]
    ds_read_b64_tr_b16 v[248:249], v71 offset:8352
    v_mfma_f32_16x16x32_bf16 v[108:111], v[224:227], v[184:187], v[108:111]
    ds_read_b64_tr_b16 v[250:251], v71 offset:8864
    s_waitcnt lgkmcnt(8)
    v_mfma_f32_16x16x32_bf16 v[144:147], v[228:231], v[180:183], v[144:147]
    ds_read_b64_tr_b16 v[224:225], v70 offset:8320
    v_mfma_f32_16x16x32_bf16 v[148:151], v[228:231], v[184:187], v[148:151]
    ds_read_b64_tr_b16 v[226:227], v70 offset:8832
    v_mfma_f32_16x16x32_bf16 v[152:155], v[232:235], v[180:183], v[152:155]
    ds_read_b64_tr_b16 v[228:229], v70 offset:8352
    v_mfma_f32_16x16x32_bf16 v[156:159], v[232:235], v[184:187], v[156:159]
    ds_read_b64_tr_b16 v[230:231], v70 offset:8864
    s_waitcnt lgkmcnt(8)
    v_mfma_f32_16x16x32_bf16 v[160:163], v[236:239], v[180:183], v[160:163]
    ds_read_b64_tr_b16 v[232:233], v70
    v_mfma_f32_16x16x32_bf16 v[164:167], v[236:239], v[184:187], v[164:167]
    ds_read_b64_tr_b16 v[234:235], v70 offset:512
    v_mfma_f32_16x16x32_bf16 v[168:171], v[240:243], v[180:183], v[168:171]
    ds_read_b64_tr_b16 v[236:237], v70 offset:32
    v_mfma_f32_16x16x32_bf16 v[172:175], v[240:243], v[184:187], v[172:175]
    ds_read_b64_tr_b16 v[238:239], v70 offset:544
    s_waitcnt lgkmcnt(8)
    s_waitcnt vmcnt(9)
    v_mfma_f32_16x16x32_bf16 v[128:131], v[244:247], v[188:191], v[128:131]
    ds_read_b64_tr_b16 v[240:241], v71
    v_mfma_f32_16x16x32_bf16 v[132:135], v[244:247], v[192:195], v[132:135]
    ds_read_b64_tr_b16 v[242:243], v71 offset:512
    buffer_load_dwordx4 v[180:183], v2, s[32:35], s16 offen offset:3072 sc1
    v_mfma_f32_16x16x32_bf16 v[136:139], v[248:251], v[188:191], v[136:139]
    ds_read_b64_tr_b16 v[244:245], v71 offset:32
    v_mfma_f32_16x16x32_bf16 v[140:143], v[248:251], v[192:195], v[140:143]
    ds_read_b64_tr_b16 v[246:247], v71 offset:544
    s_waitcnt lgkmcnt(8)
    v_mfma_f32_16x16x32_bf16 v[112:115], v[224:227], v[188:191], v[112:115]
    ds_read_b64_tr_b16 v[248:249], v70 offset:16640
    v_mfma_f32_16x16x32_bf16 v[116:119], v[224:227], v[192:195], v[116:119]
    ds_read_b64_tr_b16 v[250:251], v70 offset:17152
    v_mfma_f32_16x16x32_bf16 v[120:123], v[228:231], v[188:191], v[120:123]
    ds_read_b64_tr_b16 v[224:225], v70 offset:16672
    v_mfma_f32_16x16x32_bf16 v[124:127], v[228:231], v[192:195], v[124:127]
    ds_read_b64_tr_b16 v[226:227], v70 offset:17184
    s_add_u32 s96, s85, 7
    s_and_b32 s97, s96, 15
    s_lshl_b32 s98, s97, 14
    s_add_u32 s16, s98, s15
    buffer_load_dwordx4 v[184:187], v2, s[32:35], s16 offen sc1
    s_waitcnt lgkmcnt(8)
    v_mfma_f32_16x16x32_bf16 v[80:83], v[232:235], v[188:191], v[80:83]
    ds_read_b64_tr_b16 v[228:229], v71 offset:16640
    v_mfma_f32_16x16x32_bf16 v[84:87], v[232:235], v[192:195], v[84:87]
    ds_read_b64_tr_b16 v[230:231], v71 offset:17152
    v_mfma_f32_16x16x32_bf16 v[88:91], v[236:239], v[188:191], v[88:91]
    ds_read_b64_tr_b16 v[232:233], v71 offset:16672
    v_mfma_f32_16x16x32_bf16 v[92:95], v[236:239], v[192:195], v[92:95]
    ds_read_b64_tr_b16 v[234:235], v71 offset:17184
    s_waitcnt lgkmcnt(8)
    v_mfma_f32_16x16x32_bf16 v[96:99], v[240:243], v[188:191], v[96:99]
    ds_read_b64_tr_b16 v[236:237], v71 offset:12480
    v_mfma_f32_16x16x32_bf16 v[100:103], v[240:243], v[192:195], v[100:103]
    ds_read_b64_tr_b16 v[238:239], v71 offset:12992
    v_mfma_f32_16x16x32_bf16 v[104:107], v[244:247], v[188:191], v[104:107]
    ds_read_b64_tr_b16 v[240:241], v71 offset:12512
    v_mfma_f32_16x16x32_bf16 v[108:111], v[244:247], v[192:195], v[108:111]
    ds_read_b64_tr_b16 v[242:243], v71 offset:13024
    s_waitcnt lgkmcnt(8)
    v_mfma_f32_16x16x32_bf16 v[144:147], v[248:251], v[188:191], v[144:147]
    ds_read_b64_tr_b16 v[244:245], v70 offset:12480
    v_mfma_f32_16x16x32_bf16 v[148:151], v[248:251], v[192:195], v[148:151]
    ds_read_b64_tr_b16 v[246:247], v70 offset:12992
    v_mfma_f32_16x16x32_bf16 v[152:155], v[224:227], v[188:191], v[152:155]
    ds_read_b64_tr_b16 v[248:249], v70 offset:12512
    v_mfma_f32_16x16x32_bf16 v[156:159], v[224:227], v[192:195], v[156:159]
    ds_read_b64_tr_b16 v[250:251], v70 offset:13024
    s_waitcnt lgkmcnt(8)
    v_mfma_f32_16x16x32_bf16 v[160:163], v[228:231], v[188:191], v[160:163]
    ds_read_b64_tr_b16 v[224:225], v70 offset:4160
    v_mfma_f32_16x16x32_bf16 v[164:167], v[228:231], v[192:195], v[164:167]
    ds_read_b64_tr_b16 v[226:227], v70 offset:4672
    v_mfma_f32_16x16x32_bf16 v[168:171], v[232:235], v[188:191], v[168:171]
    ds_read_b64_tr_b16 v[228:229], v70 offset:4192
    v_mfma_f32_16x16x32_bf16 v[172:175], v[232:235], v[192:195], v[172:175]
    ds_read_b64_tr_b16 v[230:231], v70 offset:4704
    s_waitcnt lgkmcnt(8)
    s_waitcnt vmcnt(9)
    v_mfma_f32_16x16x32_bf16 v[128:131], v[236:239], v[196:199], v[128:131]
    ds_read_b64_tr_b16 v[232:233], v71 offset:4160
    v_mfma_f32_16x16x32_bf16 v[132:135], v[236:239], v[200:203], v[132:135]
    ds_read_b64_tr_b16 v[234:235], v71 offset:4672
    buffer_load_dwordx4 v[188:191], v2, s[32:35], s16 offen offset:1024 sc1
    v_mfma_f32_16x16x32_bf16 v[136:139], v[240:243], v[196:199], v[136:139]
    ds_read_b64_tr_b16 v[236:237], v71 offset:4192
    v_mfma_f32_16x16x32_bf16 v[140:143], v[240:243], v[200:203], v[140:143]
    ds_read_b64_tr_b16 v[238:239], v71 offset:4704
    s_waitcnt lgkmcnt(8)
    v_mfma_f32_16x16x32_bf16 v[112:115], v[244:247], v[196:199], v[112:115]
    ds_read_b64_tr_b16 v[240:241], v70 offset:20800
    v_mfma_f32_16x16x32_bf16 v[116:119], v[244:247], v[200:203], v[116:119]
    ds_read_b64_tr_b16 v[242:243], v70 offset:21312
    v_mfma_f32_16x16x32_bf16 v[120:123], v[248:251], v[196:199], v[120:123]
    ds_read_b64_tr_b16 v[244:245], v70 offset:20832
    v_mfma_f32_16x16x32_bf16 v[124:127], v[248:251], v[200:203], v[124:127]
    ds_read_b64_tr_b16 v[246:247], v70 offset:21344
    buffer_load_dwordx4 v[192:195], v2, s[32:35], s16 offen offset:2048 sc1
    s_waitcnt lgkmcnt(8)
    v_mfma_f32_16x16x32_bf16 v[80:83], v[224:227], v[196:199], v[80:83]
    ds_read_b64_tr_b16 v[248:249], v71 offset:20800
    v_mfma_f32_16x16x32_bf16 v[84:87], v[224:227], v[200:203], v[84:87]
    ds_read_b64_tr_b16 v[250:251], v71 offset:21312
    v_mfma_f32_16x16x32_bf16 v[88:91], v[228:231], v[196:199], v[88:91]
    ds_read_b64_tr_b16 v[224:225], v71 offset:20832
    v_mfma_f32_16x16x32_bf16 v[92:95], v[228:231], v[200:203], v[92:95]
    ds_read_b64_tr_b16 v[226:227], v71 offset:21344
    s_waitcnt lgkmcnt(8)
    v_mfma_f32_16x16x32_bf16 v[96:99], v[232:235], v[196:199], v[96:99]
    s_barrier
    ds_read_b64_tr_b16 v[228:229], v71 offset:33280
    v_mfma_f32_16x16x32_bf16 v[100:103], v[232:235], v[200:203], v[100:103]
    ds_read_b64_tr_b16 v[230:231], v71 offset:33792
    v_mfma_f32_16x16x32_bf16 v[104:107], v[236:239], v[196:199], v[104:107]
    ds_read_b64_tr_b16 v[232:233], v71 offset:33312
    v_mfma_f32_16x16x32_bf16 v[108:111], v[236:239], v[200:203], v[108:111]
    ds_read_b64_tr_b16 v[234:235], v71 offset:33824
    s_waitcnt lgkmcnt(8)
    v_mfma_f32_16x16x32_bf16 v[144:147], v[240:243], v[196:199], v[144:147]
    ds_read_b64_tr_b16 v[236:237], v70 offset:33280
    v_mfma_f32_16x16x32_bf16 v[148:151], v[240:243], v[200:203], v[148:151]
    ds_read_b64_tr_b16 v[238:239], v70 offset:33792
    v_mfma_f32_16x16x32_bf16 v[152:155], v[244:247], v[196:199], v[152:155]
    ds_read_b64_tr_b16 v[240:241], v70 offset:33312
    v_mfma_f32_16x16x32_bf16 v[156:159], v[244:247], v[200:203], v[156:159]
    ds_read_b64_tr_b16 v[242:243], v70 offset:33824
    s_waitcnt lgkmcnt(8)
    v_mfma_f32_16x16x32_bf16 v[160:163], v[248:251], v[196:199], v[160:163]
    ds_read_b64_tr_b16 v[244:245], v70 offset:24960
    v_mfma_f32_16x16x32_bf16 v[164:167], v[248:251], v[200:203], v[164:167]
    ds_read_b64_tr_b16 v[246:247], v70 offset:25472
    v_mfma_f32_16x16x32_bf16 v[168:171], v[224:227], v[196:199], v[168:171]
    ds_read_b64_tr_b16 v[248:249], v70 offset:24992
    v_mfma_f32_16x16x32_bf16 v[172:175], v[224:227], v[200:203], v[172:175]
    ds_read_b64_tr_b16 v[250:251], v70 offset:25504
    s_waitcnt lgkmcnt(8)
    s_waitcnt vmcnt(9)
    v_mfma_f32_16x16x32_bf16 v[128:131], v[228:231], v[204:207], v[128:131]
    ds_read_b64_tr_b16 v[224:225], v71 offset:24960
    v_mfma_f32_16x16x32_bf16 v[132:135], v[228:231], v[208:211], v[132:135]
    ds_read_b64_tr_b16 v[226:227], v71 offset:25472
    buffer_load_dwordx4 v[196:199], v2, s[32:35], s16 offen offset:3072 sc1
    v_mfma_f32_16x16x32_bf16 v[136:139], v[232:235], v[204:207], v[136:139]
    ds_read_b64_tr_b16 v[228:229], v71 offset:24992
    v_mfma_f32_16x16x32_bf16 v[140:143], v[232:235], v[208:211], v[140:143]
    ds_read_b64_tr_b16 v[230:231], v71 offset:25504
    s_waitcnt lgkmcnt(8)
    v_mfma_f32_16x16x32_bf16 v[112:115], v[236:239], v[204:207], v[112:115]
    ds_read_b64_tr_b16 v[232:233], v70 offset:41600
    v_mfma_f32_16x16x32_bf16 v[116:119], v[236:239], v[208:211], v[116:119]
    ds_read_b64_tr_b16 v[234:235], v70 offset:42112
    v_mfma_f32_16x16x32_bf16 v[120:123], v[240:243], v[204:207], v[120:123]
    ds_read_b64_tr_b16 v[236:237], v70 offset:41632
    v_mfma_f32_16x16x32_bf16 v[124:127], v[240:243], v[208:211], v[124:127]
    ds_read_b64_tr_b16 v[238:239], v70 offset:42144
    s_add_u32 s96, s85, 8
    s_and_b32 s97, s96, 15
    s_lshl_b32 s98, s97, 14
    s_add_u32 s16, s98, s15
    buffer_load_dwordx4 v[200:203], v2, s[32:35], s16 offen sc1
    s_waitcnt lgkmcnt(8)
    v_mfma_f32_16x16x32_bf16 v[80:83], v[244:247], v[204:207], v[80:83]
    ds_read_b64_tr_b16 v[240:241], v71 offset:41600
    v_mfma_f32_16x16x32_bf16 v[84:87], v[244:247], v[208:211], v[84:87]
    ds_read_b64_tr_b16 v[242:243], v71 offset:42112
    v_mfma_f32_16x16x32_bf16 v[88:91], v[248:251], v[204:207], v[88:91]
    ds_read_b64_tr_b16 v[244:245], v71 offset:41632
    v_mfma_f32_16x16x32_bf16 v[92:95], v[248:251], v[208:211], v[92:95]
    ds_read_b64_tr_b16 v[246:247], v71 offset:42144
    s_waitcnt lgkmcnt(8)
    v_mfma_f32_16x16x32_bf16 v[96:99], v[224:227], v[204:207], v[96:99]
    ds_read_b64_tr_b16 v[248:249], v71 offset:37440
    v_mfma_f32_16x16x32_bf16 v[100:103], v[224:227], v[208:211], v[100:103]
    ds_read_b64_tr_b16 v[250:251], v71 offset:37952
    v_mfma_f32_16x16x32_bf16 v[104:107], v[228:231], v[204:207], v[104:107]
    ds_read_b64_tr_b16 v[224:225], v71 offset:37472
    v_mfma_f32_16x16x32_bf16 v[108:111], v[228:231], v[208:211], v[108:111]
    ds_read_b64_tr_b16 v[226:227], v71 offset:37984
    s_waitcnt lgkmcnt(8)
    v_mfma_f32_16x16x32_bf16 v[144:147], v[232:235], v[204:207], v[144:147]
    ds_read_b64_tr_b16 v[228:229], v70 offset:37440
    v_mfma_f32_16x16x32_bf16 v[148:151], v[232:235], v[208:211], v[148:151]
    ds_read_b64_tr_b16 v[230:231], v70 offset:37952
    v_mfma_f32_16x16x32_bf16 v[152:155], v[236:239], v[204:207], v[152:155]
    ds_read_b64_tr_b16 v[232:233], v70 offset:37472
    v_mfma_f32_16x16x32_bf16 v[156:159], v[236:239], v[208:211], v[156:159]
    ds_read_b64_tr_b16 v[234:235], v70 offset:37984
    s_waitcnt lgkmcnt(8)
    v_mfma_f32_16x16x32_bf16 v[160:163], v[240:243], v[204:207], v[160:163]
    ds_read_b64_tr_b16 v[236:237], v70 offset:29120
    v_mfma_f32_16x16x32_bf16 v[164:167], v[240:243], v[208:211], v[164:167]
    ds_read_b64_tr_b16 v[238:239], v70 offset:29632
    v_mfma_f32_16x16x32_bf16 v[168:171], v[244:247], v[204:207], v[168:171]
    ds_read_b64_tr_b16 v[240:241], v70 offset:29152
    v_mfma_f32_16x16x32_bf16 v[172:175], v[244:247], v[208:211], v[172:175]
    ds_read_b64_tr_b16 v[242:243], v70 offset:29664
    s_waitcnt lgkmcnt(8)
    s_waitcnt vmcnt(9)
    v_mfma_f32_16x16x32_bf16 v[128:131], v[248:251], v[212:215], v[128:131]
    ds_read_b64_tr_b16 v[244:245], v71 offset:29120
    v_mfma_f32_16x16x32_bf16 v[132:135], v[248:251], v[216:219], v[132:135]
    ds_read_b64_tr_b16 v[246:247], v71 offset:29632
    buffer_load_dwordx4 v[204:207], v2, s[32:35], s16 offen offset:1024 sc1
    v_mfma_f32_16x16x32_bf16 v[136:139], v[224:227], v[212:215], v[136:139]
    ds_read_b64_tr_b16 v[248:249], v71 offset:29152
    v_mfma_f32_16x16x32_bf16 v[140:143], v[224:227], v[216:219], v[140:143]
    ds_read_b64_tr_b16 v[250:251], v71 offset:29664
    s_waitcnt lgkmcnt(8)
    v_mfma_f32_16x16x32_bf16 v[112:115], v[228:231], v[212:215], v[112:115]
    ds_read_b64_tr_b16 v[224:225], v70 offset:45760
    v_mfma_f32_16x16x32_bf16 v[116:119], v[228:231], v[216:219], v[116:119]
    ds_read_b64_tr_b16 v[226:227], v70 offset:46272
    v_mfma_f32_16x16x32_bf16 v[120:123], v[232:235], v[212:215], v[120:123]
    ds_read_b64_tr_b16 v[228:229], v70 offset:45792
    v_mfma_f32_16x16x32_bf16 v[124:127], v[232:235], v[216:219], v[124:127]
    ds_read_b64_tr_b16 v[230:231], v70 offset:46304
    buffer_load_dwordx4 v[208:211], v2, s[32:35], s16 offen offset:2048 sc1
    s_waitcnt lgkmcnt(8)
    v_mfma_f32_16x16x32_bf16 v[80:83], v[236:239], v[212:215], v[80:83]
    ds_read_b64_tr_b16 v[232:233], v71 offset:45760
    v_mfma_f32_16x16x32_bf16 v[84:87], v[236:239], v[216:219], v[84:87]
    ds_read_b64_tr_b16 v[234:235], v71 offset:46272
    v_mfma_f32_16x16x32_bf16 v[88:91], v[240:243], v[212:215], v[88:91]
    ds_read_b64_tr_b16 v[236:237], v71 offset:45792
    v_mfma_f32_16x16x32_bf16 v[92:95], v[240:243], v[216:219], v[92:95]
    ds_read_b64_tr_b16 v[238:239], v71 offset:46304
    s_waitcnt lgkmcnt(8)
    v_mfma_f32_16x16x32_bf16 v[96:99], v[244:247], v[212:215], v[96:99]
    s_barrier
    ds_read_b64_tr_b16 v[240:241], v67 offset:8320
    v_mfma_f32_16x16x32_bf16 v[100:103], v[244:247], v[216:219], v[100:103]
    ds_read_b64_tr_b16 v[242:243], v67 offset:8832
    v_mfma_f32_16x16x32_bf16 v[104:107], v[248:251], v[212:215], v[104:107]
    ds_read_b64_tr_b16 v[244:245], v67 offset:8352
    v_mfma_f32_16x16x32_bf16 v[108:111], v[248:251], v[216:219], v[108:111]
    ds_read_b64_tr_b16 v[246:247], v67 offset:8864
    s_waitcnt lgkmcnt(8)
    v_mfma_f32_16x16x32_bf16 v[144:147], v[224:227], v[212:215], v[144:147]
    ds_read_b64_tr_b16 v[248:249], v66 offset:8320
    v_mfma_f32_16x16x32_bf16 v[148:151], v[224:227], v[216:219], v[148:151]
    ds_read_b64_tr_b16 v[250:251], v66 offset:8832
    v_mfma_f32_16x16x32_bf16 v[152:155], v[228:231], v[212:215], v[152:155]
    ds_read_b64_tr_b16 v[224:225], v66 offset:8352
    v_mfma_f32_16x16x32_bf16 v[156:159], v[228:231], v[216:219], v[156:159]
    ds_read_b64_tr_b16 v[226:227], v66 offset:8864
    s_waitcnt lgkmcnt(8)
    v_mfma_f32_16x16x32_bf16 v[160:163], v[232:235], v[212:215], v[160:163]
    ds_read_b64_tr_b16 v[228:229], v66
    v_mfma_f32_16x16x32_bf16 v[164:167], v[232:235], v[216:219], v[164:167]
    ds_read_b64_tr_b16 v[230:231], v66 offset:512
    v_mfma_f32_16x16x32_bf16 v[168:171], v[236:239], v[212:215], v[168:171]
    ds_read_b64_tr_b16 v[232:233], v66 offset:32
    v_mfma_f32_16x16x32_bf16 v[172:175], v[236:239], v[216:219], v[172:175]
    ds_read_b64_tr_b16 v[234:235], v66 offset:544
    s_waitcnt lgkmcnt(8)
    s_waitcnt vmcnt(9)
    v_mfma_f32_16x16x32_bf16 v[128:131], v[240:243], v[220:223], v[128:131]
    ds_read_b64_tr_b16 v[236:237], v67
    v_mfma_f32_16x16x32_bf16 v[132:135], v[240:243], v[36:39], v[132:135]
    ds_read_b64_tr_b16 v[238:239], v67 offset:512
    buffer_load_dwordx4 v[212:215], v2, s[32:35], s16 offen offset:3072 sc1
    v_mfma_f32_16x16x32_bf16 v[136:139], v[244:247], v[220:223], v[136:139]
    ds_read_b64_tr_b16 v[240:241], v67 offset:32
    v_mfma_f32_16x16x32_bf16 v[140:143], v[244:247], v[36:39], v[140:143]
    ds_read_b64_tr_b16 v[242:243], v67 offset:544
    s_waitcnt lgkmcnt(8)
    v_mfma_f32_16x16x32_bf16 v[112:115], v[248:251], v[220:223], v[112:115]
    ds_read_b64_tr_b16 v[244:245], v66 offset:16640
    v_mfma_f32_16x16x32_bf16 v[116:119], v[248:251], v[36:39], v[116:119]
    ds_read_b64_tr_b16 v[246:247], v66 offset:17152
    v_mfma_f32_16x16x32_bf16 v[120:123], v[224:227], v[220:223], v[120:123]
    ds_read_b64_tr_b16 v[248:249], v66 offset:16672
    v_mfma_f32_16x16x32_bf16 v[124:127], v[224:227], v[36:39], v[124:127]
    ds_read_b64_tr_b16 v[250:251], v66 offset:17184
    s_add_u32 s96, s85, 9
    s_and_b32 s97, s96, 15
    s_lshl_b32 s98, s97, 14
    s_add_u32 s16, s98, s15
    buffer_load_dwordx4 v[216:219], v2, s[32:35], s16 offen sc1
    s_waitcnt lgkmcnt(8)
    v_mfma_f32_16x16x32_bf16 v[80:83], v[228:231], v[220:223], v[80:83]
    ds_read_b64_tr_b16 v[224:225], v67 offset:16640
    v_mfma_f32_16x16x32_bf16 v[84:87], v[228:231], v[36:39], v[84:87]
    ds_read_b64_tr_b16 v[226:227], v67 offset:17152
    v_mfma_f32_16x16x32_bf16 v[88:91], v[232:235], v[220:223], v[88:91]
    ds_read_b64_tr_b16 v[228:229], v67 offset:16672
    v_mfma_f32_16x16x32_bf16 v[92:95], v[232:235], v[36:39], v[92:95]
    ds_read_b64_tr_b16 v[230:231], v67 offset:17184
    s_waitcnt lgkmcnt(8)
    v_mfma_f32_16x16x32_bf16 v[96:99], v[236:239], v[220:223], v[96:99]
    ds_read_b64_tr_b16 v[232:233], v67 offset:12480
    v_mfma_f32_16x16x32_bf16 v[100:103], v[236:239], v[36:39], v[100:103]
    ds_read_b64_tr_b16 v[234:235], v67 offset:12992
    v_mfma_f32_16x16x32_bf16 v[104:107], v[240:243], v[220:223], v[104:107]
    ds_read_b64_tr_b16 v[236:237], v67 offset:12512
    v_mfma_f32_16x16x32_bf16 v[108:111], v[240:243], v[36:39], v[108:111]
    ds_read_b64_tr_b16 v[238:239], v67 offset:13024
    s_waitcnt lgkmcnt(8)
    v_mfma_f32_16x16x32_bf16 v[144:147], v[244:247], v[220:223], v[144:147]
    ds_read_b64_tr_b16 v[240:241], v66 offset:12480
    v_mfma_f32_16x16x32_bf16 v[148:151], v[244:247], v[36:39], v[148:151]
    ds_read_b64_tr_b16 v[242:243], v66 offset:12992
    v_mfma_f32_16x16x32_bf16 v[152:155], v[248:251], v[220:223], v[152:155]
    ds_read_b64_tr_b16 v[244:245], v66 offset:12512
    v_mfma_f32_16x16x32_bf16 v[156:159], v[248:251], v[36:39], v[156:159]
    ds_read_b64_tr_b16 v[246:247], v66 offset:13024
    s_waitcnt lgkmcnt(8)
    v_mfma_f32_16x16x32_bf16 v[160:163], v[224:227], v[220:223], v[160:163]
    ds_read_b64_tr_b16 v[248:249], v66 offset:4160
    v_mfma_f32_16x16x32_bf16 v[164:167], v[224:227], v[36:39], v[164:167]
    ds_read_b64_tr_b16 v[250:251], v66 offset:4672
    v_mfma_f32_16x16x32_bf16 v[168:171], v[228:231], v[220:223], v[168:171]
    ds_read_b64_tr_b16 v[224:225], v66 offset:4192
    v_mfma_f32_16x16x32_bf16 v[172:175], v[228:231], v[36:39], v[172:175]
    ds_read_b64_tr_b16 v[226:227], v66 offset:4704
    s_waitcnt lgkmcnt(8)
    s_waitcnt vmcnt(9)
    v_mfma_f32_16x16x32_bf16 v[128:131], v[232:235], v[176:179], v[128:131]
    ds_read_b64_tr_b16 v[228:229], v67 offset:4160
    v_mfma_f32_16x16x32_bf16 v[132:135], v[232:235], v[180:183], v[132:135]
    ds_read_b64_tr_b16 v[230:231], v67 offset:4672
    buffer_load_dwordx4 v[220:223], v2, s[32:35], s16 offen offset:1024 sc1
    v_mfma_f32_16x16x32_bf16 v[136:139], v[236:239], v[176:179], v[136:139]
    ds_read_b64_tr_b16 v[232:233], v67 offset:4192
    v_mfma_f32_16x16x32_bf16 v[140:143], v[236:239], v[180:183], v[140:143]
    ds_read_b64_tr_b16 v[234:235], v67 offset:4704
    s_waitcnt lgkmcnt(8)
    v_mfma_f32_16x16x32_bf16 v[112:115], v[240:243], v[176:179], v[112:115]
    ds_read_b64_tr_b16 v[236:237], v66 offset:20800
    v_mfma_f32_16x16x32_bf16 v[116:119], v[240:243], v[180:183], v[116:119]
    ds_read_b64_tr_b16 v[238:239], v66 offset:21312
    v_mfma_f32_16x16x32_bf16 v[120:123], v[244:247], v[176:179], v[120:123]
    ds_read_b64_tr_b16 v[240:241], v66 offset:20832
    v_mfma_f32_16x16x32_bf16 v[124:127], v[244:247], v[180:183], v[124:127]
    ds_read_b64_tr_b16 v[242:243], v66 offset:21344
    buffer_load_dwordx4 v[36:39], v2, s[32:35], s16 offen offset:2048 sc1
    s_waitcnt lgkmcnt(8)
    v_mfma_f32_16x16x32_bf16 v[80:83], v[248:251], v[176:179], v[80:83]
    ds_read_b64_tr_b16 v[244:245], v67 offset:20800
    v_mfma_f32_16x16x32_bf16 v[84:87], v[248:251], v[180:183], v[84:87]
    ds_read_b64_tr_b16 v[246:247], v67 offset:21312
    v_mfma_f32_16x16x32_bf16 v[88:91], v[224:227], v[176:179], v[88:91]
    ds_read_b64_tr_b16 v[248:249], v67 offset:20832
    v_mfma_f32_16x16x32_bf16 v[92:95], v[224:227], v[180:183], v[92:95]
    ds_read_b64_tr_b16 v[250:251], v67 offset:21344
    s_waitcnt lgkmcnt(8)
    v_mfma_f32_16x16x32_bf16 v[96:99], v[228:231], v[176:179], v[96:99]
    s_barrier
    ds_read_b64_tr_b16 v[224:225], v67 offset:33280
    v_mfma_f32_16x16x32_bf16 v[100:103], v[228:231], v[180:183], v[100:103]
    ds_read_b64_tr_b16 v[226:227], v67 offset:33792
    v_mfma_f32_16x16x32_bf16 v[104:107], v[232:235], v[176:179], v[104:107]
    ds_read_b64_tr_b16 v[228:229], v67 offset:33312
    v_mfma_f32_16x16x32_bf16 v[108:111], v[232:235], v[180:183], v[108:111]
    ds_read_b64_tr_b16 v[230:231], v67 offset:33824
    s_waitcnt lgkmcnt(8)
    v_mfma_f32_16x16x32_bf16 v[144:147], v[236:239], v[176:179], v[144:147]
    ds_read_b64_tr_b16 v[232:233], v66 offset:33280
    v_mfma_f32_16x16x32_bf16 v[148:151], v[236:239], v[180:183], v[148:151]
    ds_read_b64_tr_b16 v[234:235], v66 offset:33792
    v_mfma_f32_16x16x32_bf16 v[152:155], v[240:243], v[176:179], v[152:155]
    ds_read_b64_tr_b16 v[236:237], v66 offset:33312
    v_mfma_f32_16x16x32_bf16 v[156:159], v[240:243], v[180:183], v[156:159]
    ds_read_b64_tr_b16 v[238:239], v66 offset:33824
    s_waitcnt lgkmcnt(8)
    v_mfma_f32_16x16x32_bf16 v[160:163], v[244:247], v[176:179], v[160:163]
    ds_read_b64_tr_b16 v[240:241], v66 offset:24960
    v_mfma_f32_16x16x32_bf16 v[164:167], v[244:247], v[180:183], v[164:167]
    ds_read_b64_tr_b16 v[242:243], v66 offset:25472
    v_mfma_f32_16x16x32_bf16 v[168:171], v[248:251], v[176:179], v[168:171]
    ds_read_b64_tr_b16 v[244:245], v66 offset:24992
    v_mfma_f32_16x16x32_bf16 v[172:175], v[248:251], v[180:183], v[172:175]
    ds_read_b64_tr_b16 v[246:247], v66 offset:25504
    s_waitcnt lgkmcnt(8)
    s_waitcnt vmcnt(9)
    v_mfma_f32_16x16x32_bf16 v[128:131], v[224:227], v[184:187], v[128:131]
    ds_read_b64_tr_b16 v[248:249], v67 offset:24960
    v_mfma_f32_16x16x32_bf16 v[132:135], v[224:227], v[188:191], v[132:135]
    ds_read_b64_tr_b16 v[250:251], v67 offset:25472
    buffer_load_dwordx4 v[176:179], v2, s[32:35], s16 offen offset:3072 sc1
    v_mfma_f32_16x16x32_bf16 v[136:139], v[228:231], v[184:187], v[136:139]
    ds_read_b64_tr_b16 v[224:225], v67 offset:24992
    v_mfma_f32_16x16x32_bf16 v[140:143], v[228:231], v[188:191], v[140:143]
    ds_read_b64_tr_b16 v[226:227], v67 offset:25504
    s_waitcnt lgkmcnt(8)
    v_mfma_f32_16x16x32_bf16 v[112:115], v[232:235], v[184:187], v[112:115]
    ds_read_b64_tr_b16 v[228:229], v66 offset:41600
    v_mfma_f32_16x16x32_bf16 v[116:119], v[232:235], v[188:191], v[116:119]
    ds_read_b64_tr_b16 v[230:231], v66 offset:42112
    v_mfma_f32_16x16x32_bf16 v[120:123], v[236:239], v[184:187], v[120:123]
    ds_read_b64_tr_b16 v[232:233], v66 offset:41632
    v_mfma_f32_16x16x32_bf16 v[124:127], v[236:239], v[188:191], v[124:127]
    ds_read_b64_tr_b16 v[234:235], v66 offset:42144
    s_add_u32 s96, s85, 10
    s_and_b32 s97, s96, 15
    s_lshl_b32 s98, s97, 14
    s_add_u32 s16, s98, s15
    buffer_load_dwordx4 v[180:183], v2, s[32:35], s16 offen sc1
    s_waitcnt lgkmcnt(8)
    v_mfma_f32_16x16x32_bf16 v[80:83], v[240:243], v[184:187], v[80:83]
    ds_read_b64_tr_b16 v[236:237], v67 offset:41600
    v_mfma_f32_16x16x32_bf16 v[84:87], v[240:243], v[188:191], v[84:87]
    ds_read_b64_tr_b16 v[238:239], v67 offset:42112
    v_mfma_f32_16x16x32_bf16 v[88:91], v[244:247], v[184:187], v[88:91]
    ds_read_b64_tr_b16 v[240:241], v67 offset:41632
    v_mfma_f32_16x16x32_bf16 v[92:95], v[244:247], v[188:191], v[92:95]
    ds_read_b64_tr_b16 v[242:243], v67 offset:42144
    s_waitcnt lgkmcnt(8)
    v_mfma_f32_16x16x32_bf16 v[96:99], v[248:251], v[184:187], v[96:99]
    ds_read_b64_tr_b16 v[244:245], v67 offset:37440
    v_mfma_f32_16x16x32_bf16 v[100:103], v[248:251], v[188:191], v[100:103]
    ds_read_b64_tr_b16 v[246:247], v67 offset:37952
    v_mfma_f32_16x16x32_bf16 v[104:107], v[224:227], v[184:187], v[104:107]
    ds_read_b64_tr_b16 v[248:249], v67 offset:37472
    v_mfma_f32_16x16x32_bf16 v[108:111], v[224:227], v[188:191], v[108:111]
    ds_read_b64_tr_b16 v[250:251], v67 offset:37984
    s_waitcnt lgkmcnt(8)
    v_mfma_f32_16x16x32_bf16 v[144:147], v[228:231], v[184:187], v[144:147]
    ds_read_b64_tr_b16 v[224:225], v66 offset:37440
    v_mfma_f32_16x16x32_bf16 v[148:151], v[228:231], v[188:191], v[148:151]
    ds_read_b64_tr_b16 v[226:227], v66 offset:37952
    v_mfma_f32_16x16x32_bf16 v[152:155], v[232:235], v[184:187], v[152:155]
    ds_read_b64_tr_b16 v[228:229], v66 offset:37472
    v_mfma_f32_16x16x32_bf16 v[156:159], v[232:235], v[188:191], v[156:159]
    ds_read_b64_tr_b16 v[230:231], v66 offset:37984
    s_waitcnt lgkmcnt(8)
    v_mfma_f32_16x16x32_bf16 v[160:163], v[236:239], v[184:187], v[160:163]
    ds_read_b64_tr_b16 v[232:233], v66 offset:29120
    v_mfma_f32_16x16x32_bf16 v[164:167], v[236:239], v[188:191], v[164:167]
    ds_read_b64_tr_b16 v[234:235], v66 offset:29632
    v_mfma_f32_16x16x32_bf16 v[168:171], v[240:243], v[184:187], v[168:171]
    ds_read_b64_tr_b16 v[236:237], v66 offset:29152
    v_mfma_f32_16x16x32_bf16 v[172:175], v[240:243], v[188:191], v[172:175]
    ds_read_b64_tr_b16 v[238:239], v66 offset:29664
    s_waitcnt lgkmcnt(8)
    s_waitcnt vmcnt(9)
    v_mfma_f32_16x16x32_bf16 v[128:131], v[244:247], v[192:195], v[128:131]
    ds_read_b64_tr_b16 v[240:241], v67 offset:29120
    v_mfma_f32_16x16x32_bf16 v[132:135], v[244:247], v[196:199], v[132:135]
    ds_read_b64_tr_b16 v[242:243], v67 offset:29632
    buffer_load_dwordx4 v[184:187], v2, s[32:35], s16 offen offset:1024 sc1
    v_mfma_f32_16x16x32_bf16 v[136:139], v[248:251], v[192:195], v[136:139]
    ds_read_b64_tr_b16 v[244:245], v67 offset:29152
    v_mfma_f32_16x16x32_bf16 v[140:143], v[248:251], v[196:199], v[140:143]
    ds_read_b64_tr_b16 v[246:247], v67 offset:29664
    s_waitcnt lgkmcnt(8)
    v_mfma_f32_16x16x32_bf16 v[112:115], v[224:227], v[192:195], v[112:115]
    ds_read_b64_tr_b16 v[248:249], v66 offset:45760
    v_mfma_f32_16x16x32_bf16 v[116:119], v[224:227], v[196:199], v[116:119]
    ds_read_b64_tr_b16 v[250:251], v66 offset:46272
    v_mfma_f32_16x16x32_bf16 v[120:123], v[228:231], v[192:195], v[120:123]
    ds_read_b64_tr_b16 v[224:225], v66 offset:45792
    v_mfma_f32_16x16x32_bf16 v[124:127], v[228:231], v[196:199], v[124:127]
    ds_read_b64_tr_b16 v[226:227], v66 offset:46304
    buffer_load_dwordx4 v[188:191], v2, s[32:35], s16 offen offset:2048 sc1
    s_waitcnt lgkmcnt(8)
    v_mfma_f32_16x16x32_bf16 v[80:83], v[232:235], v[192:195], v[80:83]
    ds_read_b64_tr_b16 v[228:229], v67 offset:45760
    v_mfma_f32_16x16x32_bf16 v[84:87], v[232:235], v[196:199], v[84:87]
    ds_read_b64_tr_b16 v[230:231], v67 offset:46272
    v_mfma_f32_16x16x32_bf16 v[88:91], v[236:239], v[192:195], v[88:91]
    ds_read_b64_tr_b16 v[232:233], v67 offset:45792
    v_mfma_f32_16x16x32_bf16 v[92:95], v[236:239], v[196:199], v[92:95]
    ds_read_b64_tr_b16 v[234:235], v67 offset:46304
    s_waitcnt lgkmcnt(8)
    v_mfma_f32_16x16x32_bf16 v[96:99], v[240:243], v[192:195], v[96:99]
    s_barrier
    ds_read_b64_tr_b16 v[236:237], v69 offset:8320
    v_mfma_f32_16x16x32_bf16 v[100:103], v[240:243], v[196:199], v[100:103]
    ds_read_b64_tr_b16 v[238:239], v69 offset:8832
    v_mfma_f32_16x16x32_bf16 v[104:107], v[244:247], v[192:195], v[104:107]
    ds_read_b64_tr_b16 v[240:241], v69 offset:8352
    v_mfma_f32_16x16x32_bf16 v[108:111], v[244:247], v[196:199], v[108:111]
    ds_read_b64_tr_b16 v[242:243], v69 offset:8864
    s_waitcnt lgkmcnt(8)
    v_mfma_f32_16x16x32_bf16 v[144:147], v[248:251], v[192:195], v[144:147]
    ds_read_b64_tr_b16 v[244:245], v68 offset:8320
    v_mfma_f32_16x16x32_bf16 v[148:151], v[248:251], v[196:199], v[148:151]
    ds_read_b64_tr_b16 v[246:247], v68 offset:8832
    v_mfma_f32_16x16x32_bf16 v[152:155], v[224:227], v[192:195], v[152:155]
    ds_read_b64_tr_b16 v[248:249], v68 offset:8352
    v_mfma_f32_16x16x32_bf16 v[156:159], v[224:227], v[196:199], v[156:159]
    ds_read_b64_tr_b16 v[250:251], v68 offset:8864
    s_waitcnt lgkmcnt(8)
    v_mfma_f32_16x16x32_bf16 v[160:163], v[228:231], v[192:195], v[160:163]
    ds_read_b64_tr_b16 v[224:225], v68
    v_mfma_f32_16x16x32_bf16 v[164:167], v[228:231], v[196:199], v[164:167]
    ds_read_b64_tr_b16 v[226:227], v68 offset:512
    v_mfma_f32_16x16x32_bf16 v[168:171], v[232:235], v[192:195], v[168:171]
    ds_read_b64_tr_b16 v[228:229], v68 offset:32
    v_mfma_f32_16x16x32_bf16 v[172:175], v[232:235], v[196:199], v[172:175]
    ds_read_b64_tr_b16 v[230:231], v68 offset:544
    s_waitcnt lgkmcnt(8)
    s_waitcnt vmcnt(9)
    v_mfma_f32_16x16x32_bf16 v[128:131], v[236:239], v[200:203], v[128:131]
    ds_read_b64_tr_b16 v[232:233], v69
    v_mfma_f32_16x16x32_bf16 v[132:135], v[236:239], v[204:207], v[132:135]
    ds_read_b64_tr_b16 v[234:235], v69 offset:512
    buffer_load_dwordx4 v[192:195], v2, s[32:35], s16 offen offset:3072 sc1
    v_mfma_f32_16x16x32_bf16 v[136:139], v[240:243], v[200:203], v[136:139]
    ds_read_b64_tr_b16 v[236:237], v69 offset:32
    v_mfma_f32_16x16x32_bf16 v[140:143], v[240:243], v[204:207], v[140:143]
    ds_read_b64_tr_b16 v[238:239], v69 offset:544
    s_waitcnt lgkmcnt(8)
    v_mfma_f32_16x16x32_bf16 v[112:115], v[244:247], v[200:203], v[112:115]
    ds_read_b64_tr_b16 v[240:241], v68 offset:16640
    v_mfma_f32_16x16x32_bf16 v[116:119], v[244:247], v[204:207], v[116:119]
    ds_read_b64_tr_b16 v[242:243], v68 offset:17152
    v_mfma_f32_16x16x32_bf16 v[120:123], v[248:251], v[200:203], v[120:123]
    ds_read_b64_tr_b16 v[244:245], v68 offset:16672
    v_mfma_f32_16x16x32_bf16 v[124:127], v[248:251], v[204:207], v[124:127]
    ds_read_b64_tr_b16 v[246:247], v68 offset:17184
    s_add_u32 s96, s85, 11
    s_and_b32 s97, s96, 15
    s_lshl_b32 s98, s97, 14
    s_add_u32 s16, s98, s15
    buffer_load_dwordx4 v[196:199], v2, s[32:35], s16 offen sc1
    s_waitcnt lgkmcnt(8)
    v_mfma_f32_16x16x32_bf16 v[80:83], v[224:227], v[200:203], v[80:83]
    ds_read_b64_tr_b16 v[248:249], v69 offset:16640
    v_mfma_f32_16x16x32_bf16 v[84:87], v[224:227], v[204:207], v[84:87]
    ds_read_b64_tr_b16 v[250:251], v69 offset:17152
    v_mfma_f32_16x16x32_bf16 v[88:91], v[228:231], v[200:203], v[88:91]
    ds_read_b64_tr_b16 v[224:225], v69 offset:16672
    v_mfma_f32_16x16x32_bf16 v[92:95], v[228:231], v[204:207], v[92:95]
    ds_read_b64_tr_b16 v[226:227], v69 offset:17184
    s_waitcnt lgkmcnt(8)
    v_mfma_f32_16x16x32_bf16 v[96:99], v[232:235], v[200:203], v[96:99]
    ds_read_b64_tr_b16 v[228:229], v69 offset:12480
    v_mfma_f32_16x16x32_bf16 v[100:103], v[232:235], v[204:207], v[100:103]
    ds_read_b64_tr_b16 v[230:231], v69 offset:12992
    v_mfma_f32_16x16x32_bf16 v[104:107], v[236:239], v[200:203], v[104:107]
    ds_read_b64_tr_b16 v[232:233], v69 offset:12512
    v_mfma_f32_16x16x32_bf16 v[108:111], v[236:239], v[204:207], v[108:111]
    ds_read_b64_tr_b16 v[234:235], v69 offset:13024
    s_waitcnt lgkmcnt(8)
    v_mfma_f32_16x16x32_bf16 v[144:147], v[240:243], v[200:203], v[144:147]
    ds_read_b64_tr_b16 v[236:237], v68 offset:12480
    v_mfma_f32_16x16x32_bf16 v[148:151], v[240:243], v[204:207], v[148:151]
    ds_read_b64_tr_b16 v[238:239], v68 offset:12992
    v_mfma_f32_16x16x32_bf16 v[152:155], v[244:247], v[200:203], v[152:155]
    ds_read_b64_tr_b16 v[240:241], v68 offset:12512
    v_mfma_f32_16x16x32_bf16 v[156:159], v[244:247], v[204:207], v[156:159]
    ds_read_b64_tr_b16 v[242:243], v68 offset:13024
    s_waitcnt lgkmcnt(8)
    v_mfma_f32_16x16x32_bf16 v[160:163], v[248:251], v[200:203], v[160:163]
    ds_read_b64_tr_b16 v[244:245], v68 offset:4160
    v_mfma_f32_16x16x32_bf16 v[164:167], v[248:251], v[204:207], v[164:167]
    ds_read_b64_tr_b16 v[246:247], v68 offset:4672
    v_mfma_f32_16x16x32_bf16 v[168:171], v[224:227], v[200:203], v[168:171]
    ds_read_b64_tr_b16 v[248:249], v68 offset:4192
    v_mfma_f32_16x16x32_bf16 v[172:175], v[224:227], v[204:207], v[172:175]
    ds_read_b64_tr_b16 v[250:251], v68 offset:4704
    s_waitcnt lgkmcnt(8)
    s_waitcnt vmcnt(9)
    v_mfma_f32_16x16x32_bf16 v[128:131], v[228:231], v[208:211], v[128:131]
    ds_read_b64_tr_b16 v[224:225], v69 offset:4160
    v_mfma_f32_16x16x32_bf16 v[132:135], v[228:231], v[212:215], v[132:135]
    ds_read_b64_tr_b16 v[226:227], v69 offset:4672
    buffer_load_dwordx4 v[200:203], v2, s[32:35], s16 offen offset:1024 sc1
    v_mfma_f32_16x16x32_bf16 v[136:139], v[232:235], v[208:211], v[136:139]
    ds_read_b64_tr_b16 v[228:229], v69 offset:4192
    v_mfma_f32_16x16x32_bf16 v[140:143], v[232:235], v[212:215], v[140:143]
    ds_read_b64_tr_b16 v[230:231], v69 offset:4704
    s_waitcnt lgkmcnt(8)
    v_mfma_f32_16x16x32_bf16 v[112:115], v[236:239], v[208:211], v[112:115]
    ds_read_b64_tr_b16 v[232:233], v68 offset:20800
    v_mfma_f32_16x16x32_bf16 v[116:119], v[236:239], v[212:215], v[116:119]
    ds_read_b64_tr_b16 v[234:235], v68 offset:21312
    v_mfma_f32_16x16x32_bf16 v[120:123], v[240:243], v[208:211], v[120:123]
    ds_read_b64_tr_b16 v[236:237], v68 offset:20832
    v_mfma_f32_16x16x32_bf16 v[124:127], v[240:243], v[212:215], v[124:127]
    ds_read_b64_tr_b16 v[238:239], v68 offset:21344
    buffer_load_dwordx4 v[204:207], v2, s[32:35], s16 offen offset:2048 sc1
    s_waitcnt lgkmcnt(8)
    v_mfma_f32_16x16x32_bf16 v[80:83], v[244:247], v[208:211], v[80:83]
    ds_read_b64_tr_b16 v[240:241], v69 offset:20800
    v_mfma_f32_16x16x32_bf16 v[84:87], v[244:247], v[212:215], v[84:87]
    ds_read_b64_tr_b16 v[242:243], v69 offset:21312
    v_mfma_f32_16x16x32_bf16 v[88:91], v[248:251], v[208:211], v[88:91]
    ds_read_b64_tr_b16 v[244:245], v69 offset:20832
    v_mfma_f32_16x16x32_bf16 v[92:95], v[248:251], v[212:215], v[92:95]
    ds_read_b64_tr_b16 v[246:247], v69 offset:21344
    s_waitcnt lgkmcnt(8)
    v_mfma_f32_16x16x32_bf16 v[96:99], v[224:227], v[208:211], v[96:99]
    s_barrier
    ds_read_b64_tr_b16 v[248:249], v69 offset:33280
    v_mfma_f32_16x16x32_bf16 v[100:103], v[224:227], v[212:215], v[100:103]
    ds_read_b64_tr_b16 v[250:251], v69 offset:33792
    v_mfma_f32_16x16x32_bf16 v[104:107], v[228:231], v[208:211], v[104:107]
    ds_read_b64_tr_b16 v[224:225], v69 offset:33312
    v_mfma_f32_16x16x32_bf16 v[108:111], v[228:231], v[212:215], v[108:111]
    ds_read_b64_tr_b16 v[226:227], v69 offset:33824
    s_waitcnt lgkmcnt(8)
    v_mfma_f32_16x16x32_bf16 v[144:147], v[232:235], v[208:211], v[144:147]
    ds_read_b64_tr_b16 v[228:229], v68 offset:33280
    v_mfma_f32_16x16x32_bf16 v[148:151], v[232:235], v[212:215], v[148:151]
    ds_read_b64_tr_b16 v[230:231], v68 offset:33792
    v_mfma_f32_16x16x32_bf16 v[152:155], v[236:239], v[208:211], v[152:155]
    ds_read_b64_tr_b16 v[232:233], v68 offset:33312
    v_mfma_f32_16x16x32_bf16 v[156:159], v[236:239], v[212:215], v[156:159]
    ds_read_b64_tr_b16 v[234:235], v68 offset:33824
    s_waitcnt lgkmcnt(8)
    v_mfma_f32_16x16x32_bf16 v[160:163], v[240:243], v[208:211], v[160:163]
    ds_read_b64_tr_b16 v[236:237], v68 offset:24960
    v_mfma_f32_16x16x32_bf16 v[164:167], v[240:243], v[212:215], v[164:167]
    ds_read_b64_tr_b16 v[238:239], v68 offset:25472
    v_mfma_f32_16x16x32_bf16 v[168:171], v[244:247], v[208:211], v[168:171]
    ds_read_b64_tr_b16 v[240:241], v68 offset:24992
    v_mfma_f32_16x16x32_bf16 v[172:175], v[244:247], v[212:215], v[172:175]
    ds_read_b64_tr_b16 v[242:243], v68 offset:25504
    s_waitcnt lgkmcnt(8)
    s_waitcnt vmcnt(9)
    v_mfma_f32_16x16x32_bf16 v[128:131], v[248:251], v[216:219], v[128:131]
    ds_read_b64_tr_b16 v[244:245], v69 offset:24960
    v_mfma_f32_16x16x32_bf16 v[132:135], v[248:251], v[220:223], v[132:135]
    ds_read_b64_tr_b16 v[246:247], v69 offset:25472
    buffer_load_dwordx4 v[208:211], v2, s[32:35], s16 offen offset:3072 sc1
    v_mfma_f32_16x16x32_bf16 v[136:139], v[224:227], v[216:219], v[136:139]
    ds_read_b64_tr_b16 v[248:249], v69 offset:24992
    v_mfma_f32_16x16x32_bf16 v[140:143], v[224:227], v[220:223], v[140:143]
    ds_read_b64_tr_b16 v[250:251], v69 offset:25504
    s_waitcnt lgkmcnt(8)
    v_mfma_f32_16x16x32_bf16 v[112:115], v[228:231], v[216:219], v[112:115]
    ds_read_b64_tr_b16 v[224:225], v68 offset:41600
    v_mfma_f32_16x16x32_bf16 v[116:119], v[228:231], v[220:223], v[116:119]
    ds_read_b64_tr_b16 v[226:227], v68 offset:42112
    v_mfma_f32_16x16x32_bf16 v[120:123], v[232:235], v[216:219], v[120:123]
    ds_read_b64_tr_b16 v[228:229], v68 offset:41632
    v_mfma_f32_16x16x32_bf16 v[124:127], v[232:235], v[220:223], v[124:127]
    ds_read_b64_tr_b16 v[230:231], v68 offset:42144
    s_add_u32 s96, s85, 12
    s_and_b32 s97, s96, 15
    s_lshl_b32 s98, s97, 14
    s_add_u32 s16, s98, s15
    buffer_load_dwordx4 v[212:215], v2, s[32:35], s16 offen sc1
    s_waitcnt lgkmcnt(8)
    v_mfma_f32_16x16x32_bf16 v[80:83], v[236:239], v[216:219], v[80:83]
    ds_read_b64_tr_b16 v[232:233], v69 offset:41600
    v_mfma_f32_16x16x32_bf16 v[84:87], v[236:239], v[220:223], v[84:87]
    ds_read_b64_tr_b16 v[234:235], v69 offset:42112
    v_mfma_f32_16x16x32_bf16 v[88:91], v[240:243], v[216:219], v[88:91]
    ds_read_b64_tr_b16 v[236:237], v69 offset:41632
    v_mfma_f32_16x16x32_bf16 v[92:95], v[240:243], v[220:223], v[92:95]
    ds_read_b64_tr_b16 v[238:239], v69 offset:42144
    s_waitcnt lgkmcnt(8)
    v_mfma_f32_16x16x32_bf16 v[96:99], v[244:247], v[216:219], v[96:99]
    ds_read_b64_tr_b16 v[240:241], v69 offset:37440
    v_mfma_f32_16x16x32_bf16 v[100:103], v[244:247], v[220:223], v[100:103]
    ds_read_b64_tr_b16 v[242:243], v69 offset:37952
    v_mfma_f32_16x16x32_bf16 v[104:107], v[248:251], v[216:219], v[104:107]
    ds_read_b64_tr_b16 v[244:245], v69 offset:37472
    v_mfma_f32_16x16x32_bf16 v[108:111], v[248:251], v[220:223], v[108:111]
    ds_read_b64_tr_b16 v[246:247], v69 offset:37984
    s_waitcnt lgkmcnt(8)
    v_mfma_f32_16x16x32_bf16 v[144:147], v[224:227], v[216:219], v[144:147]
    ds_read_b64_tr_b16 v[248:249], v68 offset:37440
    v_mfma_f32_16x16x32_bf16 v[148:151], v[224:227], v[220:223], v[148:151]
    ds_read_b64_tr_b16 v[250:251], v68 offset:37952
    v_mfma_f32_16x16x32_bf16 v[152:155], v[228:231], v[216:219], v[152:155]
    ds_read_b64_tr_b16 v[224:225], v68 offset:37472
    v_mfma_f32_16x16x32_bf16 v[156:159], v[228:231], v[220:223], v[156:159]
    ds_read_b64_tr_b16 v[226:227], v68 offset:37984
    s_waitcnt lgkmcnt(8)
    v_mfma_f32_16x16x32_bf16 v[160:163], v[232:235], v[216:219], v[160:163]
    ds_read_b64_tr_b16 v[228:229], v68 offset:29120
    v_mfma_f32_16x16x32_bf16 v[164:167], v[232:235], v[220:223], v[164:167]
    ds_read_b64_tr_b16 v[230:231], v68 offset:29632
    v_mfma_f32_16x16x32_bf16 v[168:171], v[236:239], v[216:219], v[168:171]
    ds_read_b64_tr_b16 v[232:233], v68 offset:29152
    v_mfma_f32_16x16x32_bf16 v[172:175], v[236:239], v[220:223], v[172:175]
    ds_read_b64_tr_b16 v[234:235], v68 offset:29664
    s_waitcnt lgkmcnt(8)
    s_waitcnt vmcnt(9)
    v_mfma_f32_16x16x32_bf16 v[128:131], v[240:243], v[36:39], v[128:131]
    ds_read_b64_tr_b16 v[236:237], v69 offset:29120
    v_mfma_f32_16x16x32_bf16 v[132:135], v[240:243], v[176:179], v[132:135]
    ds_read_b64_tr_b16 v[238:239], v69 offset:29632
    buffer_load_dwordx4 v[216:219], v2, s[32:35], s16 offen offset:1024 sc1
    v_mfma_f32_16x16x32_bf16 v[136:139], v[244:247], v[36:39], v[136:139]
    ds_read_b64_tr_b16 v[240:241], v69 offset:29152
    v_mfma_f32_16x16x32_bf16 v[140:143], v[244:247], v[176:179], v[140:143]
    ds_read_b64_tr_b16 v[242:243], v69 offset:29664
    s_waitcnt lgkmcnt(8)
    v_mfma_f32_16x16x32_bf16 v[112:115], v[248:251], v[36:39], v[112:115]
    ds_read_b64_tr_b16 v[244:245], v68 offset:45760
    v_mfma_f32_16x16x32_bf16 v[116:119], v[248:251], v[176:179], v[116:119]
    ds_read_b64_tr_b16 v[246:247], v68 offset:46272
    v_mfma_f32_16x16x32_bf16 v[120:123], v[224:227], v[36:39], v[120:123]
    ds_read_b64_tr_b16 v[248:249], v68 offset:45792
    v_mfma_f32_16x16x32_bf16 v[124:127], v[224:227], v[176:179], v[124:127]
    ds_read_b64_tr_b16 v[250:251], v68 offset:46304
    buffer_load_dwordx4 v[220:223], v2, s[32:35], s16 offen offset:2048 sc1
    s_waitcnt lgkmcnt(8)
    v_mfma_f32_16x16x32_bf16 v[80:83], v[228:231], v[36:39], v[80:83]
    ds_read_b64_tr_b16 v[224:225], v69 offset:45760
    v_mfma_f32_16x16x32_bf16 v[84:87], v[228:231], v[176:179], v[84:87]
    ds_read_b64_tr_b16 v[226:227], v69 offset:46272
    v_mfma_f32_16x16x32_bf16 v[88:91], v[232:235], v[36:39], v[88:91]
    ds_read_b64_tr_b16 v[228:229], v69 offset:45792
    v_mfma_f32_16x16x32_bf16 v[92:95], v[232:235], v[176:179], v[92:95]
    ds_read_b64_tr_b16 v[230:231], v69 offset:46304
    s_waitcnt lgkmcnt(8)
    v_mfma_f32_16x16x32_bf16 v[96:99], v[236:239], v[36:39], v[96:99]
    s_barrier
    ds_read_b64_tr_b16 v[232:233], v71 offset:8320
    v_mfma_f32_16x16x32_bf16 v[100:103], v[236:239], v[176:179], v[100:103]
    ds_read_b64_tr_b16 v[234:235], v71 offset:8832
    v_mfma_f32_16x16x32_bf16 v[104:107], v[240:243], v[36:39], v[104:107]
    ds_read_b64_tr_b16 v[236:237], v71 offset:8352
    v_mfma_f32_16x16x32_bf16 v[108:111], v[240:243], v[176:179], v[108:111]
    ds_read_b64_tr_b16 v[238:239], v71 offset:8864
    s_waitcnt lgkmcnt(8)
    v_mfma_f32_16x16x32_bf16 v[144:147], v[244:247], v[36:39], v[144:147]
    ds_read_b64_tr_b16 v[240:241], v70 offset:8320
    v_mfma_f32_16x16x32_bf16 v[148:151], v[244:247], v[176:179], v[148:151]
    ds_read_b64_tr_b16 v[242:243], v70 offset:8832
    v_mfma_f32_16x16x32_bf16 v[152:155], v[248:251], v[36:39], v[152:155]
    ds_read_b64_tr_b16 v[244:245], v70 offset:8352
    v_mfma_f32_16x16x32_bf16 v[156:159], v[248:251], v[176:179], v[156:159]
    ds_read_b64_tr_b16 v[246:247], v70 offset:8864
    s_waitcnt lgkmcnt(8)
    v_mfma_f32_16x16x32_bf16 v[160:163], v[224:227], v[36:39], v[160:163]
    ds_read_b64_tr_b16 v[248:249], v70
    v_mfma_f32_16x16x32_bf16 v[164:167], v[224:227], v[176:179], v[164:167]
    ds_read_b64_tr_b16 v[250:251], v70 offset:512
    v_mfma_f32_16x16x32_bf16 v[168:171], v[228:231], v[36:39], v[168:171]
    ds_read_b64_tr_b16 v[224:225], v70 offset:32
    v_mfma_f32_16x16x32_bf16 v[172:175], v[228:231], v[176:179], v[172:175]
    ds_read_b64_tr_b16 v[226:227], v70 offset:544
    s_waitcnt lgkmcnt(8)
    s_waitcnt vmcnt(9)
    v_mfma_f32_16x16x32_bf16 v[128:131], v[232:235], v[180:183], v[128:131]
    ds_read_b64_tr_b16 v[228:229], v71
    v_mfma_f32_16x16x32_bf16 v[132:135], v[232:235], v[184:187], v[132:135]
    ds_read_b64_tr_b16 v[230:231], v71 offset:512
    buffer_load_dwordx4 v[36:39], v2, s[32:35], s16 offen offset:3072 sc1
    v_mfma_f32_16x16x32_bf16 v[136:139], v[236:239], v[180:183], v[136:139]
    ds_read_b64_tr_b16 v[232:233], v71 offset:32
    v_mfma_f32_16x16x32_bf16 v[140:143], v[236:239], v[184:187], v[140:143]
    ds_read_b64_tr_b16 v[234:235], v71 offset:544
    s_waitcnt lgkmcnt(8)
    v_mfma_f32_16x16x32_bf16 v[112:115], v[240:243], v[180:183], v[112:115]
    ds_read_b64_tr_b16 v[236:237], v70 offset:16640
    v_mfma_f32_16x16x32_bf16 v[116:119], v[240:243], v[184:187], v[116:119]
    ds_read_b64_tr_b16 v[238:239], v70 offset:17152
    v_mfma_f32_16x16x32_bf16 v[120:123], v[244:247], v[180:183], v[120:123]
    ds_read_b64_tr_b16 v[240:241], v70 offset:16672
    v_mfma_f32_16x16x32_bf16 v[124:127], v[244:247], v[184:187], v[124:127]
    ds_read_b64_tr_b16 v[242:243], v70 offset:17184
    s_add_u32 s96, s85, 13
    s_and_b32 s97, s96, 15
    s_lshl_b32 s98, s97, 14
    s_add_u32 s16, s98, s15
    buffer_load_dwordx4 v[176:179], v2, s[32:35], s16 offen sc1
    s_waitcnt lgkmcnt(8)
    v_mfma_f32_16x16x32_bf16 v[80:83], v[248:251], v[180:183], v[80:83]
    ds_read_b64_tr_b16 v[244:245], v71 offset:16640
    v_mfma_f32_16x16x32_bf16 v[84:87], v[248:251], v[184:187], v[84:87]
    ds_read_b64_tr_b16 v[246:247], v71 offset:17152
    v_mfma_f32_16x16x32_bf16 v[88:91], v[224:227], v[180:183], v[88:91]
    ds_read_b64_tr_b16 v[248:249], v71 offset:16672
    v_mfma_f32_16x16x32_bf16 v[92:95], v[224:227], v[184:187], v[92:95]
    ds_read_b64_tr_b16 v[250:251], v71 offset:17184
    s_waitcnt lgkmcnt(8)
    v_mfma_f32_16x16x32_bf16 v[96:99], v[228:231], v[180:183], v[96:99]
    ds_read_b64_tr_b16 v[224:225], v71 offset:12480
    v_mfma_f32_16x16x32_bf16 v[100:103], v[228:231], v[184:187], v[100:103]
    ds_read_b64_tr_b16 v[226:227], v71 offset:12992
    v_mfma_f32_16x16x32_bf16 v[104:107], v[232:235], v[180:183], v[104:107]
    ds_read_b64_tr_b16 v[228:229], v71 offset:12512
    v_mfma_f32_16x16x32_bf16 v[108:111], v[232:235], v[184:187], v[108:111]
    ds_read_b64_tr_b16 v[230:231], v71 offset:13024
    s_waitcnt lgkmcnt(8)
    v_mfma_f32_16x16x32_bf16 v[144:147], v[236:239], v[180:183], v[144:147]
    ds_read_b64_tr_b16 v[232:233], v70 offset:12480
    v_mfma_f32_16x16x32_bf16 v[148:151], v[236:239], v[184:187], v[148:151]
    ds_read_b64_tr_b16 v[234:235], v70 offset:12992
    v_mfma_f32_16x16x32_bf16 v[152:155], v[240:243], v[180:183], v[152:155]
    ds_read_b64_tr_b16 v[236:237], v70 offset:12512
    v_mfma_f32_16x16x32_bf16 v[156:159], v[240:243], v[184:187], v[156:159]
    ds_read_b64_tr_b16 v[238:239], v70 offset:13024
    s_waitcnt lgkmcnt(8)
    v_mfma_f32_16x16x32_bf16 v[160:163], v[244:247], v[180:183], v[160:163]
    ds_read_b64_tr_b16 v[240:241], v70 offset:4160
    v_mfma_f32_16x16x32_bf16 v[164:167], v[244:247], v[184:187], v[164:167]
    ds_read_b64_tr_b16 v[242:243], v70 offset:4672
    v_mfma_f32_16x16x32_bf16 v[168:171], v[248:251], v[180:183], v[168:171]
    ds_read_b64_tr_b16 v[244:245], v70 offset:4192
    v_mfma_f32_16x16x32_bf16 v[172:175], v[248:251], v[184:187], v[172:175]
    ds_read_b64_tr_b16 v[246:247], v70 offset:4704
    s_waitcnt lgkmcnt(8)
    s_waitcnt vmcnt(9)
    v_mfma_f32_16x16x32_bf16 v[128:131], v[224:227], v[188:191], v[128:131]
    ds_read_b64_tr_b16 v[248:249], v71 offset:4160
    v_mfma_f32_16x16x32_bf16 v[132:135], v[224:227], v[192:195], v[132:135]
    ds_read_b64_tr_b16 v[250:251], v71 offset:4672
    buffer_load_dwordx4 v[180:183], v2, s[32:35], s16 offen offset:1024 sc1
    v_mfma_f32_16x16x32_bf16 v[136:139], v[228:231], v[188:191], v[136:139]
    ds_read_b64_tr_b16 v[224:225], v71 offset:4192
    v_mfma_f32_16x16x32_bf16 v[140:143], v[228:231], v[192:195], v[140:143]
    ds_read_b64_tr_b16 v[226:227], v71 offset:4704
    s_waitcnt lgkmcnt(8)
    v_mfma_f32_16x16x32_bf16 v[112:115], v[232:235], v[188:191], v[112:115]
    ds_read_b64_tr_b16 v[228:229], v70 offset:20800
    v_mfma_f32_16x16x32_bf16 v[116:119], v[232:235], v[192:195], v[116:119]
    ds_read_b64_tr_b16 v[230:231], v70 offset:21312
    v_mfma_f32_16x16x32_bf16 v[120:123], v[236:239], v[188:191], v[120:123]
    ds_read_b64_tr_b16 v[232:233], v70 offset:20832
    v_mfma_f32_16x16x32_bf16 v[124:127], v[236:239], v[192:195], v[124:127]
    ds_read_b64_tr_b16 v[234:235], v70 offset:21344
    buffer_load_dwordx4 v[184:187], v2, s[32:35], s16 offen offset:2048 sc1
    s_waitcnt lgkmcnt(8)
    v_mfma_f32_16x16x32_bf16 v[80:83], v[240:243], v[188:191], v[80:83]
    ds_read_b64_tr_b16 v[236:237], v71 offset:20800
    v_mfma_f32_16x16x32_bf16 v[84:87], v[240:243], v[192:195], v[84:87]
    ds_read_b64_tr_b16 v[238:239], v71 offset:21312
    v_mfma_f32_16x16x32_bf16 v[88:91], v[244:247], v[188:191], v[88:91]
    ds_read_b64_tr_b16 v[240:241], v71 offset:20832
    v_mfma_f32_16x16x32_bf16 v[92:95], v[244:247], v[192:195], v[92:95]
    ds_read_b64_tr_b16 v[242:243], v71 offset:21344
    s_waitcnt lgkmcnt(8)
    v_mfma_f32_16x16x32_bf16 v[96:99], v[248:251], v[188:191], v[96:99]
    s_barrier
    ds_read_b64_tr_b16 v[244:245], v71 offset:33280
    v_mfma_f32_16x16x32_bf16 v[100:103], v[248:251], v[192:195], v[100:103]
    ds_read_b64_tr_b16 v[246:247], v71 offset:33792
    v_mfma_f32_16x16x32_bf16 v[104:107], v[224:227], v[188:191], v[104:107]
    ds_read_b64_tr_b16 v[248:249], v71 offset:33312
    v_mfma_f32_16x16x32_bf16 v[108:111], v[224:227], v[192:195], v[108:111]
    ds_read_b64_tr_b16 v[250:251], v71 offset:33824
    s_waitcnt lgkmcnt(8)
    v_mfma_f32_16x16x32_bf16 v[144:147], v[228:231], v[188:191], v[144:147]
    ds_read_b64_tr_b16 v[224:225], v70 offset:33280
    v_mfma_f32_16x16x32_bf16 v[148:151], v[228:231], v[192:195], v[148:151]
    ds_read_b64_tr_b16 v[226:227], v70 offset:33792
    v_mfma_f32_16x16x32_bf16 v[152:155], v[232:235], v[188:191], v[152:155]
    ds_read_b64_tr_b16 v[228:229], v70 offset:33312
    v_mfma_f32_16x16x32_bf16 v[156:159], v[232:235], v[192:195], v[156:159]
    ds_read_b64_tr_b16 v[230:231], v70 offset:33824
    s_waitcnt lgkmcnt(8)
    v_mfma_f32_16x16x32_bf16 v[160:163], v[236:239], v[188:191], v[160:163]
    ds_read_b64_tr_b16 v[232:233], v70 offset:24960
    v_mfma_f32_16x16x32_bf16 v[164:167], v[236:239], v[192:195], v[164:167]
    ds_read_b64_tr_b16 v[234:235], v70 offset:25472
    v_mfma_f32_16x16x32_bf16 v[168:171], v[240:243], v[188:191], v[168:171]
    ds_read_b64_tr_b16 v[236:237], v70 offset:24992
    v_mfma_f32_16x16x32_bf16 v[172:175], v[240:243], v[192:195], v[172:175]
    ds_read_b64_tr_b16 v[238:239], v70 offset:25504
    s_waitcnt lgkmcnt(8)
    s_waitcnt vmcnt(9)
    v_mfma_f32_16x16x32_bf16 v[128:131], v[244:247], v[196:199], v[128:131]
    ds_read_b64_tr_b16 v[240:241], v71 offset:24960
    v_mfma_f32_16x16x32_bf16 v[132:135], v[244:247], v[200:203], v[132:135]
    ds_read_b64_tr_b16 v[242:243], v71 offset:25472
    buffer_load_dwordx4 v[188:191], v2, s[32:35], s16 offen offset:3072 sc1
    v_mfma_f32_16x16x32_bf16 v[136:139], v[248:251], v[196:199], v[136:139]
    ds_read_b64_tr_b16 v[244:245], v71 offset:24992
    v_mfma_f32_16x16x32_bf16 v[140:143], v[248:251], v[200:203], v[140:143]
    ds_read_b64_tr_b16 v[246:247], v71 offset:25504
    s_waitcnt lgkmcnt(8)
    v_mfma_f32_16x16x32_bf16 v[112:115], v[224:227], v[196:199], v[112:115]
    ds_read_b64_tr_b16 v[248:249], v70 offset:41600
    v_mfma_f32_16x16x32_bf16 v[116:119], v[224:227], v[200:203], v[116:119]
    ds_read_b64_tr_b16 v[250:251], v70 offset:42112
    v_mfma_f32_16x16x32_bf16 v[120:123], v[228:231], v[196:199], v[120:123]
    ds_read_b64_tr_b16 v[224:225], v70 offset:41632
    v_mfma_f32_16x16x32_bf16 v[124:127], v[228:231], v[200:203], v[124:127]
    ds_read_b64_tr_b16 v[226:227], v70 offset:42144
    s_add_u32 s96, s85, 14
    s_and_b32 s97, s96, 15
    s_lshl_b32 s98, s97, 14
    s_add_u32 s16, s98, s15
    buffer_load_dwordx4 v[192:195], v2, s[32:35], s16 offen sc1
    s_waitcnt lgkmcnt(8)
    v_mfma_f32_16x16x32_bf16 v[80:83], v[232:235], v[196:199], v[80:83]
    ds_read_b64_tr_b16 v[228:229], v71 offset:41600
    v_mfma_f32_16x16x32_bf16 v[84:87], v[232:235], v[200:203], v[84:87]
    ds_read_b64_tr_b16 v[230:231], v71 offset:42112
    v_mfma_f32_16x16x32_bf16 v[88:91], v[236:239], v[196:199], v[88:91]
    ds_read_b64_tr_b16 v[232:233], v71 offset:41632
    v_mfma_f32_16x16x32_bf16 v[92:95], v[236:239], v[200:203], v[92:95]
    ds_read_b64_tr_b16 v[234:235], v71 offset:42144
    s_waitcnt lgkmcnt(8)
    v_mfma_f32_16x16x32_bf16 v[96:99], v[240:243], v[196:199], v[96:99]
    ds_read_b64_tr_b16 v[236:237], v71 offset:37440
    v_mfma_f32_16x16x32_bf16 v[100:103], v[240:243], v[200:203], v[100:103]
    ds_read_b64_tr_b16 v[238:239], v71 offset:37952
    v_mfma_f32_16x16x32_bf16 v[104:107], v[244:247], v[196:199], v[104:107]
    ds_read_b64_tr_b16 v[240:241], v71 offset:37472
    v_mfma_f32_16x16x32_bf16 v[108:111], v[244:247], v[200:203], v[108:111]
    ds_read_b64_tr_b16 v[242:243], v71 offset:37984
    s_waitcnt lgkmcnt(8)
    v_mfma_f32_16x16x32_bf16 v[144:147], v[248:251], v[196:199], v[144:147]
    ds_read_b64_tr_b16 v[244:245], v70 offset:37440
    v_mfma_f32_16x16x32_bf16 v[148:151], v[248:251], v[200:203], v[148:151]
    ds_read_b64_tr_b16 v[246:247], v70 offset:37952
    v_mfma_f32_16x16x32_bf16 v[152:155], v[224:227], v[196:199], v[152:155]
    ds_read_b64_tr_b16 v[248:249], v70 offset:37472
    v_mfma_f32_16x16x32_bf16 v[156:159], v[224:227], v[200:203], v[156:159]
    ds_read_b64_tr_b16 v[250:251], v70 offset:37984
    s_waitcnt lgkmcnt(8)
    v_mfma_f32_16x16x32_bf16 v[160:163], v[228:231], v[196:199], v[160:163]
    ds_read_b64_tr_b16 v[224:225], v70 offset:29120
    v_mfma_f32_16x16x32_bf16 v[164:167], v[228:231], v[200:203], v[164:167]
    ds_read_b64_tr_b16 v[226:227], v70 offset:29632
    v_mfma_f32_16x16x32_bf16 v[168:171], v[232:235], v[196:199], v[168:171]
    ds_read_b64_tr_b16 v[228:229], v70 offset:29152
    v_mfma_f32_16x16x32_bf16 v[172:175], v[232:235], v[200:203], v[172:175]
    ds_read_b64_tr_b16 v[230:231], v70 offset:29664
    s_waitcnt lgkmcnt(8)
    s_waitcnt vmcnt(9)
    v_mfma_f32_16x16x32_bf16 v[128:131], v[236:239], v[204:207], v[128:131]
    ds_read_b64_tr_b16 v[232:233], v71 offset:29120
    v_mfma_f32_16x16x32_bf16 v[132:135], v[236:239], v[208:211], v[132:135]
    ds_read_b64_tr_b16 v[234:235], v71 offset:29632
    buffer_load_dwordx4 v[196:199], v2, s[32:35], s16 offen offset:1024 sc1
    v_mfma_f32_16x16x32_bf16 v[136:139], v[240:243], v[204:207], v[136:139]
    ds_read_b64_tr_b16 v[236:237], v71 offset:29152
    v_mfma_f32_16x16x32_bf16 v[140:143], v[240:243], v[208:211], v[140:143]
    ds_read_b64_tr_b16 v[238:239], v71 offset:29664
    s_waitcnt lgkmcnt(8)
    v_mfma_f32_16x16x32_bf16 v[112:115], v[244:247], v[204:207], v[112:115]
    ds_read_b64_tr_b16 v[240:241], v70 offset:45760
    v_mfma_f32_16x16x32_bf16 v[116:119], v[244:247], v[208:211], v[116:119]
    ds_read_b64_tr_b16 v[242:243], v70 offset:46272
    v_mfma_f32_16x16x32_bf16 v[120:123], v[248:251], v[204:207], v[120:123]
    ds_read_b64_tr_b16 v[244:245], v70 offset:45792
    v_mfma_f32_16x16x32_bf16 v[124:127], v[248:251], v[208:211], v[124:127]
    ds_read_b64_tr_b16 v[246:247], v70 offset:46304
    buffer_load_dwordx4 v[200:203], v2, s[32:35], s16 offen offset:2048 sc1
    s_waitcnt lgkmcnt(8)
    v_mfma_f32_16x16x32_bf16 v[80:83], v[224:227], v[204:207], v[80:83]
    ds_read_b64_tr_b16 v[248:249], v71 offset:45760
    v_mfma_f32_16x16x32_bf16 v[84:87], v[224:227], v[208:211], v[84:87]
    ds_read_b64_tr_b16 v[250:251], v71 offset:46272
    v_mfma_f32_16x16x32_bf16 v[88:91], v[228:231], v[204:207], v[88:91]
    ds_read_b64_tr_b16 v[224:225], v71 offset:45792
    v_mfma_f32_16x16x32_bf16 v[92:95], v[228:231], v[208:211], v[92:95]
    ds_read_b64_tr_b16 v[226:227], v71 offset:46304
    s_waitcnt lgkmcnt(8)
    v_mfma_f32_16x16x32_bf16 v[96:99], v[232:235], v[204:207], v[96:99]
    s_barrier
    ds_read_b64_tr_b16 v[228:229], v67 offset:8320
    v_mfma_f32_16x16x32_bf16 v[100:103], v[232:235], v[208:211], v[100:103]
    ds_read_b64_tr_b16 v[230:231], v67 offset:8832
    v_mfma_f32_16x16x32_bf16 v[104:107], v[236:239], v[204:207], v[104:107]
    ds_read_b64_tr_b16 v[232:233], v67 offset:8352
    v_mfma_f32_16x16x32_bf16 v[108:111], v[236:239], v[208:211], v[108:111]
    ds_read_b64_tr_b16 v[234:235], v67 offset:8864
    s_waitcnt lgkmcnt(8)
    v_mfma_f32_16x16x32_bf16 v[144:147], v[240:243], v[204:207], v[144:147]
    ds_read_b64_tr_b16 v[236:237], v66 offset:8320
    v_mfma_f32_16x16x32_bf16 v[148:151], v[240:243], v[208:211], v[148:151]
    ds_read_b64_tr_b16 v[238:239], v66 offset:8832
    v_mfma_f32_16x16x32_bf16 v[152:155], v[244:247], v[204:207], v[152:155]
    ds_read_b64_tr_b16 v[240:241], v66 offset:8352
    v_mfma_f32_16x16x32_bf16 v[156:159], v[244:247], v[208:211], v[156:159]
    ds_read_b64_tr_b16 v[242:243], v66 offset:8864
    s_waitcnt lgkmcnt(8)
    v_mfma_f32_16x16x32_bf16 v[160:163], v[248:251], v[204:207], v[160:163]
    ds_read_b64_tr_b16 v[244:245], v66
    v_mfma_f32_16x16x32_bf16 v[164:167], v[248:251], v[208:211], v[164:167]
    ds_read_b64_tr_b16 v[246:247], v66 offset:512
    v_mfma_f32_16x16x32_bf16 v[168:171], v[224:227], v[204:207], v[168:171]
    ds_read_b64_tr_b16 v[248:249], v66 offset:32
    v_mfma_f32_16x16x32_bf16 v[172:175], v[224:227], v[208:211], v[172:175]
    ds_read_b64_tr_b16 v[250:251], v66 offset:544
    s_waitcnt lgkmcnt(8)
    s_waitcnt vmcnt(9)
    v_mfma_f32_16x16x32_bf16 v[128:131], v[228:231], v[212:215], v[128:131]
    ds_read_b64_tr_b16 v[224:225], v67
    v_mfma_f32_16x16x32_bf16 v[132:135], v[228:231], v[216:219], v[132:135]
    ds_read_b64_tr_b16 v[226:227], v67 offset:512
    buffer_load_dwordx4 v[204:207], v2, s[32:35], s16 offen offset:3072 sc1
    v_mfma_f32_16x16x32_bf16 v[136:139], v[232:235], v[212:215], v[136:139]
    ds_read_b64_tr_b16 v[228:229], v67 offset:32
    v_mfma_f32_16x16x32_bf16 v[140:143], v[232:235], v[216:219], v[140:143]
    ds_read_b64_tr_b16 v[230:231], v67 offset:544
    s_waitcnt lgkmcnt(8)
    v_mfma_f32_16x16x32_bf16 v[112:115], v[236:239], v[212:215], v[112:115]
    ds_read_b64_tr_b16 v[232:233], v66 offset:16640
    v_mfma_f32_16x16x32_bf16 v[116:119], v[236:239], v[216:219], v[116:119]
    ds_read_b64_tr_b16 v[234:235], v66 offset:17152
    v_mfma_f32_16x16x32_bf16 v[120:123], v[240:243], v[212:215], v[120:123]
    ds_read_b64_tr_b16 v[236:237], v66 offset:16672
    v_mfma_f32_16x16x32_bf16 v[124:127], v[240:243], v[216:219], v[124:127]
    ds_read_b64_tr_b16 v[238:239], v66 offset:17184
    s_add_u32 s96, s85, 15
    s_and_b32 s97, s96, 15
    s_lshl_b32 s98, s97, 14
    s_add_u32 s16, s98, s15
    buffer_load_dwordx4 v[208:211], v2, s[32:35], s16 offen sc1
    s_waitcnt lgkmcnt(8)
    v_mfma_f32_16x16x32_bf16 v[80:83], v[244:247], v[212:215], v[80:83]
    ds_read_b64_tr_b16 v[240:241], v67 offset:16640
    v_mfma_f32_16x16x32_bf16 v[84:87], v[244:247], v[216:219], v[84:87]
    ds_read_b64_tr_b16 v[242:243], v67 offset:17152
    v_mfma_f32_16x16x32_bf16 v[88:91], v[248:251], v[212:215], v[88:91]
    ds_read_b64_tr_b16 v[244:245], v67 offset:16672
    v_mfma_f32_16x16x32_bf16 v[92:95], v[248:251], v[216:219], v[92:95]
    ds_read_b64_tr_b16 v[246:247], v67 offset:17184
    s_waitcnt lgkmcnt(8)
    v_mfma_f32_16x16x32_bf16 v[96:99], v[224:227], v[212:215], v[96:99]
    ds_read_b64_tr_b16 v[248:249], v67 offset:12480
    v_mfma_f32_16x16x32_bf16 v[100:103], v[224:227], v[216:219], v[100:103]
    ds_read_b64_tr_b16 v[250:251], v67 offset:12992
    v_mfma_f32_16x16x32_bf16 v[104:107], v[228:231], v[212:215], v[104:107]
    ds_read_b64_tr_b16 v[224:225], v67 offset:12512
    v_mfma_f32_16x16x32_bf16 v[108:111], v[228:231], v[216:219], v[108:111]
    ds_read_b64_tr_b16 v[226:227], v67 offset:13024
    s_waitcnt lgkmcnt(8)
    v_mfma_f32_16x16x32_bf16 v[144:147], v[232:235], v[212:215], v[144:147]
    ds_read_b64_tr_b16 v[228:229], v66 offset:12480
    v_mfma_f32_16x16x32_bf16 v[148:151], v[232:235], v[216:219], v[148:151]
    ds_read_b64_tr_b16 v[230:231], v66 offset:12992
    v_mfma_f32_16x16x32_bf16 v[152:155], v[236:239], v[212:215], v[152:155]
    ds_read_b64_tr_b16 v[232:233], v66 offset:12512
    v_mfma_f32_16x16x32_bf16 v[156:159], v[236:239], v[216:219], v[156:159]
    ds_read_b64_tr_b16 v[234:235], v66 offset:13024
    s_waitcnt lgkmcnt(8)
    v_mfma_f32_16x16x32_bf16 v[160:163], v[240:243], v[212:215], v[160:163]
    ds_read_b64_tr_b16 v[236:237], v66 offset:4160
    v_mfma_f32_16x16x32_bf16 v[164:167], v[240:243], v[216:219], v[164:167]
    ds_read_b64_tr_b16 v[238:239], v66 offset:4672
    v_mfma_f32_16x16x32_bf16 v[168:171], v[244:247], v[212:215], v[168:171]
    ds_read_b64_tr_b16 v[240:241], v66 offset:4192
    v_mfma_f32_16x16x32_bf16 v[172:175], v[244:247], v[216:219], v[172:175]
    ds_read_b64_tr_b16 v[242:243], v66 offset:4704
    s_waitcnt lgkmcnt(8)
    s_waitcnt vmcnt(9)
    v_mfma_f32_16x16x32_bf16 v[128:131], v[248:251], v[220:223], v[128:131]
    ds_read_b64_tr_b16 v[244:245], v67 offset:4160
    v_mfma_f32_16x16x32_bf16 v[132:135], v[248:251], v[36:39], v[132:135]
    ds_read_b64_tr_b16 v[246:247], v67 offset:4672
    buffer_load_dwordx4 v[212:215], v2, s[32:35], s16 offen offset:1024 sc1
    v_mfma_f32_16x16x32_bf16 v[136:139], v[224:227], v[220:223], v[136:139]
    ds_read_b64_tr_b16 v[248:249], v67 offset:4192
    v_mfma_f32_16x16x32_bf16 v[140:143], v[224:227], v[36:39], v[140:143]
    ds_read_b64_tr_b16 v[250:251], v67 offset:4704
    s_waitcnt lgkmcnt(8)
    v_mfma_f32_16x16x32_bf16 v[112:115], v[228:231], v[220:223], v[112:115]
    ds_read_b64_tr_b16 v[224:225], v66 offset:20800
    v_mfma_f32_16x16x32_bf16 v[116:119], v[228:231], v[36:39], v[116:119]
    ds_read_b64_tr_b16 v[226:227], v66 offset:21312
    v_mfma_f32_16x16x32_bf16 v[120:123], v[232:235], v[220:223], v[120:123]
    ds_read_b64_tr_b16 v[228:229], v66 offset:20832
    v_mfma_f32_16x16x32_bf16 v[124:127], v[232:235], v[36:39], v[124:127]
    ds_read_b64_tr_b16 v[230:231], v66 offset:21344
    buffer_load_dwordx4 v[216:219], v2, s[32:35], s16 offen offset:2048 sc1
    s_waitcnt lgkmcnt(8)
    v_mfma_f32_16x16x32_bf16 v[80:83], v[236:239], v[220:223], v[80:83]
    ds_read_b64_tr_b16 v[232:233], v67 offset:20800
    v_mfma_f32_16x16x32_bf16 v[84:87], v[236:239], v[36:39], v[84:87]
    ds_read_b64_tr_b16 v[234:235], v67 offset:21312
    v_mfma_f32_16x16x32_bf16 v[88:91], v[240:243], v[220:223], v[88:91]
    ds_read_b64_tr_b16 v[236:237], v67 offset:20832
    v_mfma_f32_16x16x32_bf16 v[92:95], v[240:243], v[36:39], v[92:95]
    ds_read_b64_tr_b16 v[238:239], v67 offset:21344
    s_waitcnt lgkmcnt(8)
    v_mfma_f32_16x16x32_bf16 v[96:99], v[244:247], v[220:223], v[96:99]
    s_barrier
    ds_read_b64_tr_b16 v[240:241], v67 offset:33280
    v_mfma_f32_16x16x32_bf16 v[100:103], v[244:247], v[36:39], v[100:103]
    ds_read_b64_tr_b16 v[242:243], v67 offset:33792
    v_mfma_f32_16x16x32_bf16 v[104:107], v[248:251], v[220:223], v[104:107]
    ds_read_b64_tr_b16 v[244:245], v67 offset:33312
    v_mfma_f32_16x16x32_bf16 v[108:111], v[248:251], v[36:39], v[108:111]
    ds_read_b64_tr_b16 v[246:247], v67 offset:33824
    s_waitcnt lgkmcnt(8)
    v_mfma_f32_16x16x32_bf16 v[144:147], v[224:227], v[220:223], v[144:147]
    ds_read_b64_tr_b16 v[248:249], v66 offset:33280
    v_mfma_f32_16x16x32_bf16 v[148:151], v[224:227], v[36:39], v[148:151]
    ds_read_b64_tr_b16 v[250:251], v66 offset:33792
    v_mfma_f32_16x16x32_bf16 v[152:155], v[228:231], v[220:223], v[152:155]
    ds_read_b64_tr_b16 v[224:225], v66 offset:33312
    v_mfma_f32_16x16x32_bf16 v[156:159], v[228:231], v[36:39], v[156:159]
    ds_read_b64_tr_b16 v[226:227], v66 offset:33824
    s_waitcnt lgkmcnt(8)
    v_mfma_f32_16x16x32_bf16 v[160:163], v[232:235], v[220:223], v[160:163]
    ds_read_b64_tr_b16 v[228:229], v66 offset:24960
    v_mfma_f32_16x16x32_bf16 v[164:167], v[232:235], v[36:39], v[164:167]
    ds_read_b64_tr_b16 v[230:231], v66 offset:25472
    v_mfma_f32_16x16x32_bf16 v[168:171], v[236:239], v[220:223], v[168:171]
    ds_read_b64_tr_b16 v[232:233], v66 offset:24992
    v_mfma_f32_16x16x32_bf16 v[172:175], v[236:239], v[36:39], v[172:175]
    ds_read_b64_tr_b16 v[234:235], v66 offset:25504
    s_waitcnt lgkmcnt(8)
    s_waitcnt vmcnt(9)
    v_mfma_f32_16x16x32_bf16 v[128:131], v[240:243], v[176:179], v[128:131]
    ds_read_b64_tr_b16 v[236:237], v67 offset:24960
    v_mfma_f32_16x16x32_bf16 v[132:135], v[240:243], v[180:183], v[132:135]
    ds_read_b64_tr_b16 v[238:239], v67 offset:25472
    buffer_load_dwordx4 v[220:223], v2, s[32:35], s16 offen offset:3072 sc1
    s_barrier
    v_mfma_f32_16x16x32_bf16 v[136:139], v[244:247], v[176:179], v[136:139]
    ds_read_b64_tr_b16 v[240:241], v67 offset:24992
    v_mfma_f32_16x16x32_bf16 v[140:143], v[244:247], v[180:183], v[140:143]
    ds_read_b64_tr_b16 v[242:243], v67 offset:25504
    s_waitcnt lgkmcnt(8)
    v_mfma_f32_16x16x32_bf16 v[112:115], v[248:251], v[176:179], v[112:115]
    ds_read_b64_tr_b16 v[244:245], v66 offset:41600
    v_mfma_f32_16x16x32_bf16 v[116:119], v[248:251], v[180:183], v[116:119]
    ds_read_b64_tr_b16 v[246:247], v66 offset:42112
    v_mfma_f32_16x16x32_bf16 v[120:123], v[224:227], v[176:179], v[120:123]
    ds_read_b64_tr_b16 v[248:249], v66 offset:41632
    v_mfma_f32_16x16x32_bf16 v[124:127], v[224:227], v[180:183], v[124:127]
    ds_read_b64_tr_b16 v[250:251], v66 offset:42144
    s_waitcnt lgkmcnt(8)
    v_mfma_f32_16x16x32_bf16 v[80:83], v[228:231], v[176:179], v[80:83]
    ds_read_b64_tr_b16 v[224:225], v67 offset:41600
    v_mfma_f32_16x16x32_bf16 v[84:87], v[228:231], v[180:183], v[84:87]
    ds_read_b64_tr_b16 v[226:227], v67 offset:42112
    v_mfma_f32_16x16x32_bf16 v[88:91], v[232:235], v[176:179], v[88:91]
    ds_read_b64_tr_b16 v[228:229], v67 offset:41632
    v_mfma_f32_16x16x32_bf16 v[92:95], v[232:235], v[180:183], v[92:95]
    ds_read_b64_tr_b16 v[230:231], v67 offset:42144
    s_waitcnt lgkmcnt(8)
    v_mfma_f32_16x16x32_bf16 v[96:99], v[236:239], v[176:179], v[96:99]
    ds_read_b64_tr_b16 v[232:233], v67 offset:37440
    v_mfma_f32_16x16x32_bf16 v[100:103], v[236:239], v[180:183], v[100:103]
    ds_read_b64_tr_b16 v[234:235], v67 offset:37952
    v_mfma_f32_16x16x32_bf16 v[104:107], v[240:243], v[176:179], v[104:107]
    ds_read_b64_tr_b16 v[236:237], v67 offset:37472
    v_mfma_f32_16x16x32_bf16 v[108:111], v[240:243], v[180:183], v[108:111]
    ds_read_b64_tr_b16 v[238:239], v67 offset:37984
    s_waitcnt lgkmcnt(8)
    v_mfma_f32_16x16x32_bf16 v[144:147], v[244:247], v[176:179], v[144:147]
    ds_read_b64_tr_b16 v[240:241], v66 offset:37440
    v_mfma_f32_16x16x32_bf16 v[148:151], v[244:247], v[180:183], v[148:151]
    ds_read_b64_tr_b16 v[242:243], v66 offset:37952
    v_mfma_f32_16x16x32_bf16 v[152:155], v[248:251], v[176:179], v[152:155]
    ds_read_b64_tr_b16 v[244:245], v66 offset:37472
    v_mfma_f32_16x16x32_bf16 v[156:159], v[248:251], v[180:183], v[156:159]
    ds_read_b64_tr_b16 v[246:247], v66 offset:37984
    s_waitcnt lgkmcnt(8)
    v_mfma_f32_16x16x32_bf16 v[160:163], v[224:227], v[176:179], v[160:163]
    ds_read_b64_tr_b16 v[248:249], v66 offset:29120
    v_mfma_f32_16x16x32_bf16 v[164:167], v[224:227], v[180:183], v[164:167]
    ds_read_b64_tr_b16 v[250:251], v66 offset:29632
    v_mfma_f32_16x16x32_bf16 v[168:171], v[228:231], v[176:179], v[168:171]
    ds_read_b64_tr_b16 v[224:225], v66 offset:29152
    v_mfma_f32_16x16x32_bf16 v[172:175], v[228:231], v[180:183], v[172:175]
    ds_read_b64_tr_b16 v[226:227], v66 offset:29664
    s_waitcnt lgkmcnt(8)
    s_waitcnt vmcnt(8)
    v_mfma_f32_16x16x32_bf16 v[128:131], v[232:235], v[184:187], v[128:131]
    ds_read_b64_tr_b16 v[228:229], v67 offset:29120
    v_mfma_f32_16x16x32_bf16 v[132:135], v[232:235], v[188:191], v[132:135]
    ds_read_b64_tr_b16 v[230:231], v67 offset:29632
    v_mfma_f32_16x16x32_bf16 v[136:139], v[236:239], v[184:187], v[136:139]
    ds_read_b64_tr_b16 v[232:233], v67 offset:29152
    v_mfma_f32_16x16x32_bf16 v[140:143], v[236:239], v[188:191], v[140:143]
    ds_read_b64_tr_b16 v[234:235], v67 offset:29664
    s_waitcnt lgkmcnt(8)
    v_mfma_f32_16x16x32_bf16 v[112:115], v[240:243], v[184:187], v[112:115]
    ds_read_b64_tr_b16 v[236:237], v66 offset:45760
    v_mfma_f32_16x16x32_bf16 v[116:119], v[240:243], v[188:191], v[116:119]
    ds_read_b64_tr_b16 v[238:239], v66 offset:46272
    v_mfma_f32_16x16x32_bf16 v[120:123], v[244:247], v[184:187], v[120:123]
    ds_read_b64_tr_b16 v[240:241], v66 offset:45792
    v_mfma_f32_16x16x32_bf16 v[124:127], v[244:247], v[188:191], v[124:127]
    ds_read_b64_tr_b16 v[242:243], v66 offset:46304
    s_waitcnt lgkmcnt(8)
    v_mfma_f32_16x16x32_bf16 v[80:83], v[248:251], v[184:187], v[80:83]
    ds_read_b64_tr_b16 v[244:245], v67 offset:45760
    v_mfma_f32_16x16x32_bf16 v[84:87], v[248:251], v[188:191], v[84:87]
    ds_read_b64_tr_b16 v[246:247], v67 offset:46272
    v_mfma_f32_16x16x32_bf16 v[88:91], v[224:227], v[184:187], v[88:91]
    ds_read_b64_tr_b16 v[248:249], v67 offset:45792
    v_mfma_f32_16x16x32_bf16 v[92:95], v[224:227], v[188:191], v[92:95]
    ds_read_b64_tr_b16 v[250:251], v67 offset:46304
    s_waitcnt lgkmcnt(8)
    v_mfma_f32_16x16x32_bf16 v[96:99], v[228:231], v[184:187], v[96:99]
    s_barrier
    ds_read_b64_tr_b16 v[224:225], v69 offset:8320
    v_mfma_f32_16x16x32_bf16 v[100:103], v[228:231], v[188:191], v[100:103]
    ds_read_b64_tr_b16 v[226:227], v69 offset:8832
    v_mfma_f32_16x16x32_bf16 v[104:107], v[232:235], v[184:187], v[104:107]
    ds_read_b64_tr_b16 v[228:229], v69 offset:8352
    v_mfma_f32_16x16x32_bf16 v[108:111], v[232:235], v[188:191], v[108:111]
    ds_read_b64_tr_b16 v[230:231], v69 offset:8864
    s_waitcnt lgkmcnt(8)
    v_mfma_f32_16x16x32_bf16 v[144:147], v[236:239], v[184:187], v[144:147]
    ds_read_b64_tr_b16 v[232:233], v68 offset:8320
    v_mfma_f32_16x16x32_bf16 v[148:151], v[236:239], v[188:191], v[148:151]
    ds_read_b64_tr_b16 v[234:235], v68 offset:8832
    v_mfma_f32_16x16x32_bf16 v[152:155], v[240:243], v[184:187], v[152:155]
    ds_read_b64_tr_b16 v[236:237], v68 offset:8352
    v_mfma_f32_16x16x32_bf16 v[156:159], v[240:243], v[188:191], v[156:159]
    ds_read_b64_tr_b16 v[238:239], v68 offset:8864
    s_waitcnt lgkmcnt(8)
    v_mfma_f32_16x16x32_bf16 v[160:163], v[244:247], v[184:187], v[160:163]
    ds_read_b64_tr_b16 v[240:241], v68
    v_mfma_f32_16x16x32_bf16 v[164:167], v[244:247], v[188:191], v[164:167]
    ds_read_b64_tr_b16 v[242:243], v68 offset:512
    v_mfma_f32_16x16x32_bf16 v[168:171], v[248:251], v[184:187], v[168:171]
    ds_read_b64_tr_b16 v[244:245], v68 offset:32
    v_mfma_f32_16x16x32_bf16 v[172:175], v[248:251], v[188:191], v[172:175]
    ds_read_b64_tr_b16 v[246:247], v68 offset:544
    s_waitcnt lgkmcnt(8)
    s_waitcnt vmcnt(6)
    v_mfma_f32_16x16x32_bf16 v[128:131], v[224:227], v[192:195], v[128:131]
    ds_read_b64_tr_b16 v[248:249], v69
    v_mfma_f32_16x16x32_bf16 v[132:135], v[224:227], v[196:199], v[132:135]
    ds_read_b64_tr_b16 v[250:251], v69 offset:512
    v_mfma_f32_16x16x32_bf16 v[136:139], v[228:231], v[192:195], v[136:139]
    ds_read_b64_tr_b16 v[224:225], v69 offset:32
    v_mfma_f32_16x16x32_bf16 v[140:143], v[228:231], v[196:199], v[140:143]
    ds_read_b64_tr_b16 v[226:227], v69 offset:544
    s_waitcnt lgkmcnt(8)
    v_mfma_f32_16x16x32_bf16 v[112:115], v[232:235], v[192:195], v[112:115]
    ds_read_b64_tr_b16 v[228:229], v68 offset:16640
    v_mfma_f32_16x16x32_bf16 v[116:119], v[232:235], v[196:199], v[116:119]
    ds_read_b64_tr_b16 v[230:231], v68 offset:17152
    v_mfma_f32_16x16x32_bf16 v[120:123], v[236:239], v[192:195], v[120:123]
    ds_read_b64_tr_b16 v[232:233], v68 offset:16672
    v_mfma_f32_16x16x32_bf16 v[124:127], v[236:239], v[196:199], v[124:127]
    ds_read_b64_tr_b16 v[234:235], v68 offset:17184
    s_waitcnt lgkmcnt(8)
    v_mfma_f32_16x16x32_bf16 v[80:83], v[240:243], v[192:195], v[80:83]
    ds_read_b64_tr_b16 v[236:237], v69 offset:16640
    v_mfma_f32_16x16x32_bf16 v[84:87], v[240:243], v[196:199], v[84:87]
    ds_read_b64_tr_b16 v[238:239], v69 offset:17152
    v_mfma_f32_16x16x32_bf16 v[88:91], v[244:247], v[192:195], v[88:91]
    ds_read_b64_tr_b16 v[240:241], v69 offset:16672
    v_mfma_f32_16x16x32_bf16 v[92:95], v[244:247], v[196:199], v[92:95]
    ds_read_b64_tr_b16 v[242:243], v69 offset:17184
    s_waitcnt lgkmcnt(8)
    v_mfma_f32_16x16x32_bf16 v[96:99], v[248:251], v[192:195], v[96:99]
    ds_read_b64_tr_b16 v[244:245], v69 offset:12480
    v_mfma_f32_16x16x32_bf16 v[100:103], v[248:251], v[196:199], v[100:103]
    ds_read_b64_tr_b16 v[246:247], v69 offset:12992
    v_mfma_f32_16x16x32_bf16 v[104:107], v[224:227], v[192:195], v[104:107]
    ds_read_b64_tr_b16 v[248:249], v69 offset:12512
    v_mfma_f32_16x16x32_bf16 v[108:111], v[224:227], v[196:199], v[108:111]
    ds_read_b64_tr_b16 v[250:251], v69 offset:13024
    s_waitcnt lgkmcnt(8)
    v_mfma_f32_16x16x32_bf16 v[144:147], v[228:231], v[192:195], v[144:147]
    ds_read_b64_tr_b16 v[224:225], v68 offset:12480
    v_mfma_f32_16x16x32_bf16 v[148:151], v[228:231], v[196:199], v[148:151]
    ds_read_b64_tr_b16 v[226:227], v68 offset:12992
    v_mfma_f32_16x16x32_bf16 v[152:155], v[232:235], v[192:195], v[152:155]
    ds_read_b64_tr_b16 v[228:229], v68 offset:12512
    v_mfma_f32_16x16x32_bf16 v[156:159], v[232:235], v[196:199], v[156:159]
    ds_read_b64_tr_b16 v[230:231], v68 offset:13024
    s_waitcnt lgkmcnt(8)
    v_mfma_f32_16x16x32_bf16 v[160:163], v[236:239], v[192:195], v[160:163]
    ds_read_b64_tr_b16 v[232:233], v68 offset:4160
    v_mfma_f32_16x16x32_bf16 v[164:167], v[236:239], v[196:199], v[164:167]
    ds_read_b64_tr_b16 v[234:235], v68 offset:4672
    v_mfma_f32_16x16x32_bf16 v[168:171], v[240:243], v[192:195], v[168:171]
    ds_read_b64_tr_b16 v[236:237], v68 offset:4192
    v_mfma_f32_16x16x32_bf16 v[172:175], v[240:243], v[196:199], v[172:175]
    ds_read_b64_tr_b16 v[238:239], v68 offset:4704
    s_waitcnt lgkmcnt(8)
    s_waitcnt vmcnt(4)
    v_mfma_f32_16x16x32_bf16 v[128:131], v[244:247], v[200:203], v[128:131]
    ds_read_b64_tr_b16 v[240:241], v69 offset:4160
    v_mfma_f32_16x16x32_bf16 v[132:135], v[244:247], v[204:207], v[132:135]
    ds_read_b64_tr_b16 v[242:243], v69 offset:4672
    v_mfma_f32_16x16x32_bf16 v[136:139], v[248:251], v[200:203], v[136:139]
    ds_read_b64_tr_b16 v[244:245], v69 offset:4192
    v_mfma_f32_16x16x32_bf16 v[140:143], v[248:251], v[204:207], v[140:143]
    ds_read_b64_tr_b16 v[246:247], v69 offset:4704
    s_waitcnt lgkmcnt(8)
    v_mfma_f32_16x16x32_bf16 v[112:115], v[224:227], v[200:203], v[112:115]
    ds_read_b64_tr_b16 v[248:249], v68 offset:20800
    v_mfma_f32_16x16x32_bf16 v[116:119], v[224:227], v[204:207], v[116:119]
    ds_read_b64_tr_b16 v[250:251], v68 offset:21312
    v_mfma_f32_16x16x32_bf16 v[120:123], v[228:231], v[200:203], v[120:123]
    ds_read_b64_tr_b16 v[224:225], v68 offset:20832
    v_mfma_f32_16x16x32_bf16 v[124:127], v[228:231], v[204:207], v[124:127]
    ds_read_b64_tr_b16 v[226:227], v68 offset:21344
    s_waitcnt lgkmcnt(8)
    v_mfma_f32_16x16x32_bf16 v[80:83], v[232:235], v[200:203], v[80:83]
    ds_read_b64_tr_b16 v[228:229], v69 offset:20800
    v_mfma_f32_16x16x32_bf16 v[84:87], v[232:235], v[204:207], v[84:87]
    ds_read_b64_tr_b16 v[230:231], v69 offset:21312
    v_mfma_f32_16x16x32_bf16 v[88:91], v[236:239], v[200:203], v[88:91]
    ds_read_b64_tr_b16 v[232:233], v69 offset:20832
    v_mfma_f32_16x16x32_bf16 v[92:95], v[236:239], v[204:207], v[92:95]
    ds_read_b64_tr_b16 v[234:235], v69 offset:21344
    s_waitcnt lgkmcnt(8)
    v_mfma_f32_16x16x32_bf16 v[96:99], v[240:243], v[200:203], v[96:99]
    ds_read_b64_tr_b16 v[236:237], v69 offset:33280
    v_mfma_f32_16x16x32_bf16 v[100:103], v[240:243], v[204:207], v[100:103]
    ds_read_b64_tr_b16 v[238:239], v69 offset:33792
    v_mfma_f32_16x16x32_bf16 v[104:107], v[244:247], v[200:203], v[104:107]
    ds_read_b64_tr_b16 v[240:241], v69 offset:33312
    v_mfma_f32_16x16x32_bf16 v[108:111], v[244:247], v[204:207], v[108:111]
    ds_read_b64_tr_b16 v[242:243], v69 offset:33824
    s_waitcnt lgkmcnt(8)
    v_mfma_f32_16x16x32_bf16 v[144:147], v[248:251], v[200:203], v[144:147]
    ds_read_b64_tr_b16 v[244:245], v68 offset:33280
    v_mfma_f32_16x16x32_bf16 v[148:151], v[248:251], v[204:207], v[148:151]
    ds_read_b64_tr_b16 v[246:247], v68 offset:33792
    v_mfma_f32_16x16x32_bf16 v[152:155], v[224:227], v[200:203], v[152:155]
    ds_read_b64_tr_b16 v[248:249], v68 offset:33312
    v_mfma_f32_16x16x32_bf16 v[156:159], v[224:227], v[204:207], v[156:159]
    ds_read_b64_tr_b16 v[250:251], v68 offset:33824
    s_waitcnt lgkmcnt(8)
    v_mfma_f32_16x16x32_bf16 v[160:163], v[228:231], v[200:203], v[160:163]
    ds_read_b64_tr_b16 v[224:225], v68 offset:24960
    v_mfma_f32_16x16x32_bf16 v[164:167], v[228:231], v[204:207], v[164:167]
    ds_read_b64_tr_b16 v[226:227], v68 offset:25472
    v_mfma_f32_16x16x32_bf16 v[168:171], v[232:235], v[200:203], v[168:171]
    ds_read_b64_tr_b16 v[228:229], v68 offset:24992
    v_mfma_f32_16x16x32_bf16 v[172:175], v[232:235], v[204:207], v[172:175]
    ds_read_b64_tr_b16 v[230:231], v68 offset:25504
    s_waitcnt lgkmcnt(8)
    s_waitcnt vmcnt(2)
    v_mfma_f32_16x16x32_bf16 v[128:131], v[236:239], v[208:211], v[128:131]
    ds_read_b64_tr_b16 v[232:233], v69 offset:24960
    v_mfma_f32_16x16x32_bf16 v[132:135], v[236:239], v[212:215], v[132:135]
    ds_read_b64_tr_b16 v[234:235], v69 offset:25472
    v_mfma_f32_16x16x32_bf16 v[136:139], v[240:243], v[208:211], v[136:139]
    ds_read_b64_tr_b16 v[236:237], v69 offset:24992
    v_mfma_f32_16x16x32_bf16 v[140:143], v[240:243], v[212:215], v[140:143]
    ds_read_b64_tr_b16 v[238:239], v69 offset:25504
    s_waitcnt lgkmcnt(8)
    v_mfma_f32_16x16x32_bf16 v[112:115], v[244:247], v[208:211], v[112:115]
    ds_read_b64_tr_b16 v[240:241], v68 offset:41600
    v_mfma_f32_16x16x32_bf16 v[116:119], v[244:247], v[212:215], v[116:119]
    ds_read_b64_tr_b16 v[242:243], v68 offset:42112
    v_mfma_f32_16x16x32_bf16 v[120:123], v[248:251], v[208:211], v[120:123]
    ds_read_b64_tr_b16 v[244:245], v68 offset:41632
    v_mfma_f32_16x16x32_bf16 v[124:127], v[248:251], v[212:215], v[124:127]
    ds_read_b64_tr_b16 v[246:247], v68 offset:42144
    s_waitcnt lgkmcnt(8)
    v_mfma_f32_16x16x32_bf16 v[80:83], v[224:227], v[208:211], v[80:83]
    ds_read_b64_tr_b16 v[248:249], v69 offset:41600
    v_mfma_f32_16x16x32_bf16 v[84:87], v[224:227], v[212:215], v[84:87]
    ds_read_b64_tr_b16 v[250:251], v69 offset:42112
    v_mfma_f32_16x16x32_bf16 v[88:91], v[228:231], v[208:211], v[88:91]
    ds_read_b64_tr_b16 v[224:225], v69 offset:41632
    v_mfma_f32_16x16x32_bf16 v[92:95], v[228:231], v[212:215], v[92:95]
    ds_read_b64_tr_b16 v[226:227], v69 offset:42144
    s_waitcnt lgkmcnt(8)
    v_mfma_f32_16x16x32_bf16 v[96:99], v[232:235], v[208:211], v[96:99]
    ds_read_b64_tr_b16 v[228:229], v69 offset:37440
    v_mfma_f32_16x16x32_bf16 v[100:103], v[232:235], v[212:215], v[100:103]
    ds_read_b64_tr_b16 v[230:231], v69 offset:37952
    v_mfma_f32_16x16x32_bf16 v[104:107], v[236:239], v[208:211], v[104:107]
    ds_read_b64_tr_b16 v[232:233], v69 offset:37472
    v_mfma_f32_16x16x32_bf16 v[108:111], v[236:239], v[212:215], v[108:111]
    ds_read_b64_tr_b16 v[234:235], v69 offset:37984
    s_waitcnt lgkmcnt(8)
    v_mfma_f32_16x16x32_bf16 v[144:147], v[240:243], v[208:211], v[144:147]
    ds_read_b64_tr_b16 v[236:237], v68 offset:37440
    v_mfma_f32_16x16x32_bf16 v[148:151], v[240:243], v[212:215], v[148:151]
    ds_read_b64_tr_b16 v[238:239], v68 offset:37952
    v_mfma_f32_16x16x32_bf16 v[152:155], v[244:247], v[208:211], v[152:155]
    ds_read_b64_tr_b16 v[240:241], v68 offset:37472
    v_mfma_f32_16x16x32_bf16 v[156:159], v[244:247], v[212:215], v[156:159]
    ds_read_b64_tr_b16 v[242:243], v68 offset:37984
    s_waitcnt lgkmcnt(8)
    v_mfma_f32_16x16x32_bf16 v[160:163], v[248:251], v[208:211], v[160:163]
    ds_read_b64_tr_b16 v[244:245], v68 offset:29120
    v_mfma_f32_16x16x32_bf16 v[164:167], v[248:251], v[212:215], v[164:167]
    ds_read_b64_tr_b16 v[246:247], v68 offset:29632
    v_mfma_f32_16x16x32_bf16 v[168:171], v[224:227], v[208:211], v[168:171]
    ds_read_b64_tr_b16 v[248:249], v68 offset:29152
    v_mfma_f32_16x16x32_bf16 v[172:175], v[224:227], v[212:215], v[172:175]
    ds_read_b64_tr_b16 v[250:251], v68 offset:29664
    s_waitcnt lgkmcnt(8)
    s_waitcnt vmcnt(0)
    v_mfma_f32_16x16x32_bf16 v[128:131], v[228:231], v[216:219], v[128:131]
    ds_read_b64_tr_b16 v[224:225], v69 offset:29120
    v_mfma_f32_16x16x32_bf16 v[132:135], v[228:231], v[220:223], v[132:135]
    ds_read_b64_tr_b16 v[226:227], v69 offset:29632
    v_mfma_f32_16x16x32_bf16 v[136:139], v[232:235], v[216:219], v[136:139]
    ds_read_b64_tr_b16 v[228:229], v69 offset:29152
    v_mfma_f32_16x16x32_bf16 v[140:143], v[232:235], v[220:223], v[140:143]
    ds_read_b64_tr_b16 v[230:231], v69 offset:29664
    s_waitcnt lgkmcnt(8)
    v_mfma_f32_16x16x32_bf16 v[112:115], v[236:239], v[216:219], v[112:115]
    ds_read_b64_tr_b16 v[232:233], v68 offset:45760
    v_mfma_f32_16x16x32_bf16 v[116:119], v[236:239], v[220:223], v[116:119]
    ds_read_b64_tr_b16 v[234:235], v68 offset:46272
    v_mfma_f32_16x16x32_bf16 v[120:123], v[240:243], v[216:219], v[120:123]
    ds_read_b64_tr_b16 v[236:237], v68 offset:45792
    v_mfma_f32_16x16x32_bf16 v[124:127], v[240:243], v[220:223], v[124:127]
    ds_read_b64_tr_b16 v[238:239], v68 offset:46304
    s_waitcnt lgkmcnt(8)
    v_mfma_f32_16x16x32_bf16 v[80:83], v[244:247], v[216:219], v[80:83]
    ds_read_b64_tr_b16 v[240:241], v69 offset:45760
    v_mfma_f32_16x16x32_bf16 v[84:87], v[244:247], v[220:223], v[84:87]
    ds_read_b64_tr_b16 v[242:243], v69 offset:46272
    v_mfma_f32_16x16x32_bf16 v[88:91], v[248:251], v[216:219], v[88:91]
    ds_read_b64_tr_b16 v[244:245], v69 offset:45792
    v_mfma_f32_16x16x32_bf16 v[92:95], v[248:251], v[220:223], v[92:95]
    ds_read_b64_tr_b16 v[246:247], v69 offset:46304
    s_waitcnt lgkmcnt(8)
    v_mfma_f32_16x16x32_bf16 v[96:99], v[224:227], v[216:219], v[96:99]
    v_mfma_f32_16x16x32_bf16 v[100:103], v[224:227], v[220:223], v[100:103]
    v_mfma_f32_16x16x32_bf16 v[104:107], v[228:231], v[216:219], v[104:107]
    v_mfma_f32_16x16x32_bf16 v[108:111], v[228:231], v[220:223], v[108:111]
    s_waitcnt lgkmcnt(4)
    v_mfma_f32_16x16x32_bf16 v[144:147], v[232:235], v[216:219], v[144:147]
    v_mfma_f32_16x16x32_bf16 v[148:151], v[232:235], v[220:223], v[148:151]
    v_mfma_f32_16x16x32_bf16 v[152:155], v[236:239], v[216:219], v[152:155]
    v_mfma_f32_16x16x32_bf16 v[156:159], v[236:239], v[220:223], v[156:159]
    s_waitcnt lgkmcnt(0)
    v_mfma_f32_16x16x32_bf16 v[160:163], v[240:243], v[216:219], v[160:163]
    v_mfma_f32_16x16x32_bf16 v[164:167], v[240:243], v[220:223], v[164:167]
    v_mfma_f32_16x16x32_bf16 v[168:171], v[244:247], v[216:219], v[168:171]
    v_mfma_f32_16x16x32_bf16 v[172:175], v[244:247], v[220:223], v[172:175]
    v_cvt_pk_bf16_f32 v52, v128, v129
    v_cvt_pk_bf16_f32 v53, v130, v131
    v_cvt_pk_bf16_f32 v54, v132, v133
    v_cvt_pk_bf16_f32 v55, v134, v135
    v_cvt_pk_bf16_f32 v56, v136, v137
    v_cvt_pk_bf16_f32 v57, v138, v139
    v_cvt_pk_bf16_f32 v58, v140, v141
    v_cvt_pk_bf16_f32 v59, v142, v143
    ds_write_b64 v77, v[52:53]
    ds_write_b64 v77, v[54:55] offset:256
    ds_write_b64 v77, v[56:57] offset:1024
    ds_write_b64 v77, v[58:59] offset:1280
    s_waitcnt lgkmcnt(0)
    s_barrier
    s_setprio 0
    v_cvt_pk_bf16_f32 v36, v112, v113
    v_cvt_pk_bf16_f32 v37, v114, v115
    v_cvt_pk_bf16_f32 v38, v116, v117
    v_cvt_pk_bf16_f32 v39, v118, v119
    v_cvt_pk_bf16_f32 v40, v120, v121
    v_cvt_pk_bf16_f32 v41, v122, v123
    v_cvt_pk_bf16_f32 v42, v124, v125
    v_cvt_pk_bf16_f32 v43, v126, v127
    v_permlane16_swap_b32 v36, v38
    v_permlane16_swap_b32 v37, v39
    v_permlane16_swap_b32 v40, v42
    v_permlane16_swap_b32 v41, v43
    v_mfma_f32_32x32x16_bf16 v[112:127], v[28:31], v[36:39], 0
    s_nop 0
    v_mfma_f32_32x32x16_bf16 v[112:127], v[32:35], v[40:43], v[112:127]
    v_cvt_pk_bf16_f32 v52, v144, v145
    v_cvt_pk_bf16_f32 v53, v146, v147
    v_cvt_pk_bf16_f32 v54, v148, v149
    v_cvt_pk_bf16_f32 v55, v150, v151
    v_cvt_pk_bf16_f32 v56, v152, v153
    v_cvt_pk_bf16_f32 v57, v154, v155
    v_cvt_pk_bf16_f32 v58, v156, v157
    v_cvt_pk_bf16_f32 v59, v158, v159
    ds_write_b64 v78, v[52:53]
    ds_write_b64 v78, v[54:55] offset:512
    ds_write_b64 v78, v[56:57] offset:4096
    ds_write_b64 v78, v[58:59] offset:4608
    v_cvt_pk_bf16_f32 v44, v160, v161
    v_cvt_pk_bf16_f32 v45, v162, v163
    v_cvt_pk_bf16_f32 v46, v164, v165
    v_cvt_pk_bf16_f32 v47, v166, v167
    v_cvt_pk_bf16_f32 v48, v168, v169
    v_cvt_pk_bf16_f32 v49, v170, v171
    v_cvt_pk_bf16_f32 v50, v172, v173
    v_cvt_pk_bf16_f32 v51, v174, v175
    ds_write_b64 v78, v[44:45] offset:8192
    ds_write_b64 v78, v[46:47] offset:8704
    ds_write_b64 v78, v[48:49] offset:12288
    ds_write_b64 v78, v[50:51] offset:12800
    v_cvt_pk_bf16_f32 v36, v96, v97
    v_cvt_pk_bf16_f32 v37, v98, v99
    v_cvt_pk_bf16_f32 v38, v100, v101
    v_cvt_pk_bf16_f32 v39, v102, v103
    v_cvt_pk_bf16_f32 v40, v104, v105
    v_cvt_pk_bf16_f32 v41, v106, v107
    v_cvt_pk_bf16_f32 v42, v108, v109
    v_cvt_pk_bf16_f32 v43, v110, v111
    ds_write_b64 v77, v[36:37] offset:2048
    ds_write_b64 v77, v[38:39] offset:2304
    ds_write_b64 v77, v[40:41] offset:3072
    ds_write_b64 v77, v[42:43] offset:3328
    v_cvt_pk_bf16_f32 v44, v80, v81
    v_cvt_pk_bf16_f32 v45, v82, v83
    v_cvt_pk_bf16_f32 v46, v84, v85
    v_cvt_pk_bf16_f32 v47, v86, v87
    v_cvt_pk_bf16_f32 v48, v88, v89
    v_cvt_pk_bf16_f32 v49, v90, v91
    v_cvt_pk_bf16_f32 v50, v92, v93
    v_cvt_pk_bf16_f32 v51, v94, v95
    v_permlane16_swap_b32 v44, v46
    v_permlane16_swap_b32 v45, v47
    v_permlane16_swap_b32 v48, v50
    v_permlane16_swap_b32 v49, v51
    s_branch L_JOIN
L_HELP:
    s_add_u32 s96, s85, 5
    s_and_b32 s97, s96, 15
    s_lshl3_add_u32 s98, s97, s3
    s_sub_u32 s99, s98, 4
    s_mul_i32 s96, s99, 49152
    s_lshl_b32 s97, s11, 7
    s_add_u32 s82, s96, s97
    s_sub_u32 s96, s3, 4
    s_lshr_b32 s97, s96, 1
    s_mul_i32 s98, s97, 2080
    s_sub_u32 s99, s3, 4
    s_and_b32 s96, s99, 1
    s_mul_i32 s97, s96, 1056
    s_add_u32 s99, s98, s97
    s_add_u32 s20, s99, 124800
    s_mov_b32 m0, s20
    s_nop 0
    buffer_load_dwordx4 v62, s[40:43], s82 offen lds
    s_add_u32 s82, s82, 2048
    s_add_u32 m0, s20, 8320
    s_nop 0
    buffer_load_dwordx4 v62, s[40:43], s82 offen lds
    s_add_u32 s82, s82, 2048
    s_add_u32 m0, s20, 16640
    s_nop 0
    buffer_load_dwordx4 v62, s[40:43], s82 offen lds
    s_add_u32 s96, s85, 5
    s_and_b32 s97, s96, 15
    s_lshl3_add_u32 s98, s97, s3
    s_mul_i32 s99, s98, 49152
    s_lshl_b32 s96, s11, 7
    s_add_u32 s82, s99, s96
    s_lshr_b32 s96, s3, 1
    s_mul_i32 s97, s96, 2080
    s_and_b32 s98, s3, 1
    s_mul_i32 s99, s98, 1056
    s_add_u32 s96, s97, s99
    s_add_u32 s20, s96, 124800
    s_mov_b32 m0, s20
    s_nop 0
    buffer_load_dwordx4 v62, s[40:43], s82 offen lds
    s_add_u32 s82, s82, 2048
    s_add_u32 m0, s20, 8320
    s_nop 0
    buffer_load_dwordx4 v62, s[40:43], s82 offen lds
    s_add_u32 s82, s82, 2048
    s_add_u32 m0, s20, 16640
    s_nop 0
    buffer_load_dwordx4 v62, s[40:43], s82 offen lds
    s_and_b32 s96, s9, 3
    s_lshl2_add_u32 s97, s96, s3
    s_sub_u32 s98, s97, 4
    s_lshl_b32 s13, s98, 7
    v_lshrrev_b32 v61, 3, v1
    v_lshl_add_u32 v61, v61, 4, s13
    v_lshrrev_b32 v60, 3, v1
    v_mul_u32_u24 v60, 98304, v60
    v_and_b32 v9, 7, v1
    v_lshl_add_u32 v60, v9, 4, v60
    s_mul_i32 s96, s13, 6144
    s_bfe_u32 s97, s9, 131074
    s_lshl_b32 s98, s8, 1
    s_lshl4_add_u32 s99, s97, s98
    s_lshr_b32 s97, s9, 4
    s_add_u32 s98, s99, s97
    s_lshl_b32 s99, s98, 7
    s_add_u32 s97, s96, s99
    s_add_u32 s17, s97, 4096
    global_load_dwordx4 v[120:123], v61, s[86:87]
    s_waitcnt vmcnt(13)
    s_barrier
    buffer_load_dwordx4 v[80:83], v60, s[48:51], s17 offen nt
    s_add_u32 s17, s17, 12288
    buffer_load_dwordx4 v[84:87], v60, s[48:51], s17 offen nt
    s_add_u32 s17, s17, 12288
    s_waitcnt lgkmcnt(0)
    s_load_dword s24, s[32:33], s92 offset:512 glc
    s_load_dword s25, s[32:33], s92 offset:256 glc
    s_load_dword s26, s[32:33], s92 offset:1024 glc
    s_load_dword s27, s[32:33], s92 offset:768 glc
    s_waitcnt vmcnt(12)
    s_barrier
    s_add_u32 s96, s85, 6
    s_and_b32 s97, s96, 15
    s_lshl3_add_u32 s98, s97, s3
    s_sub_u32 s99, s98, 4
    s_mul_i32 s96, s99, 49152
    s_lshl_b32 s97, s11, 7
    s_add_u32 s82, s96, s97
    s_sub_u32 s96, s3, 4
    s_lshr_b32 s97, s96, 1
    s_mul_i32 s98, s97, 2080
    s_sub_u32 s99, s3, 4
    s_and_b32 s96, s99, 1
    s_mul_i32 s97, s96, 1056
    s_add_u32 s20, s98, s97
    s_mov_b32 m0, s20
    s_nop 0
    buffer_load_dwordx4 v62, s[40:43], s82 offen lds
    s_add_u32 s82, s82, 2048
    s_add_u32 m0, s20, 8320
    s_nop 0
    buffer_load_dwordx4 v62, s[40:43], s82 offen lds
    s_add_u32 s82, s82, 2048
    s_add_u32 m0, s20, 16640
    s_nop 0
    buffer_load_dwordx4 v62, s[40:43], s82 offen lds
    s_add_u32 s96, s85, 6
    s_and_b32 s97, s96, 15
    s_lshl3_add_u32 s98, s97, s3
    s_mul_i32 s99, s98, 49152
    s_lshl_b32 s96, s11, 7
    s_add_u32 s82, s99, s96
    s_lshr_b32 s96, s3, 1
    s_mul_i32 s97, s96, 2080
    s_and_b32 s98, s3, 1
    s_mul_i32 s99, s98, 1056
    s_add_u32 s20, s97, s99
    s_mov_b32 m0, s20
    s_nop 0
    buffer_load_dwordx4 v62, s[40:43], s82 offen lds
    s_add_u32 s82, s82, 2048
    s_add_u32 m0, s20, 8320
    s_nop 0
    buffer_load_dwordx4 v62, s[40:43], s82 offen lds
    s_add_u32 s82, s82, 2048
    s_add_u32 m0, s20, 16640
    s_nop 0
    buffer_load_dwordx4 v62, s[40:43], s82 offen lds
    s_waitcnt vmcnt(8)
    v_lshlrev_b32 v112, 16, v120
    v_mul_f32 v4, s7, v112
    v_exp_f32 v4, -v4
    s_nop 0
    v_add_f32 v4, 1.0, v4
    v_rcp_f32 v4, v4
    s_nop 0
    v_mul_f32 v112, v112, v4
    v_cvt_pk_bf16_f32 v112, 0, v112
    v_and_b32 v113, s6, v120
    v_mul_f32 v5, s7, v113
    v_exp_f32 v5, -v5
    s_nop 0
    v_add_f32 v5, 1.0, v5
    v_rcp_f32 v5, v5
    s_nop 0
    v_mul_f32 v113, v113, v5
    v_cvt_pk_bf16_f32 v113, 0, v113
    v_lshlrev_b32 v114, 16, v121
    v_mul_f32 v4, s7, v114
    v_exp_f32 v4, -v4
    s_nop 0
    v_add_f32 v4, 1.0, v4
    v_rcp_f32 v4, v4
    s_nop 0
    v_mul_f32 v114, v114, v4
    v_cvt_pk_bf16_f32 v114, 0, v114
    v_and_b32 v115, s6, v121
    v_mul_f32 v5, s7, v115
    v_exp_f32 v5, -v5
    s_nop 0
    v_add_f32 v5, 1.0, v5
    v_rcp_f32 v5, v5
    s_nop 0
    v_mul_f32 v115, v115, v5
    v_cvt_pk_bf16_f32 v115, 0, v115
    s_barrier
    s_add_u32 s96, s85, 7
    s_and_b32 s97, s96, 15
    s_lshl3_add_u32 s98, s97, s3
    s_sub_u32 s99, s98, 4
    s_mul_i32 s96, s99, 49152
    s_lshl_b32 s97, s11, 7
    s_add_u32 s82, s96, s97
    s_sub_u32 s96, s3, 4
    s_lshr_b32 s97, s96, 1
    s_mul_i32 s98, s97, 2080
    s_sub_u32 s99, s3, 4
    s_and_b32 s96, s99, 1
    s_mul_i32 s97, s96, 1056
    s_add_u32 s99, s98, s97
    s_add_u32 s20, s99, 24960
    s_mov_b32 m0, s20
    s_nop 0
    buffer_load_dwordx4 v62, s[40:43], s82 offen lds
    s_add_u32 s82, s82, 2048
    s_add_u32 m0, s20, 8320
    s_nop 0
    buffer_load_dwordx4 v62, s[40:43], s82 offen lds
    s_add_u32 s82, s82, 2048
    s_add_u32 m0, s20, 16640
    s_nop 0
    buffer_load_dwordx4 v62, s[40:43], s82 offen lds
    buffer_load_dwordx4 v[88:91], v60, s[48:51], s17 offen nt
    s_add_u32 s17, s17, 12288
    buffer_load_dwordx4 v[92:95], v60, s[48:51], s17 offen nt
    s_add_u32 s17, s17, 12288
    s_barrier
    s_add_u32 s96, s85, 7
    s_and_b32 s97, s96, 15
    s_lshl3_add_u32 s98, s97, s3
    s_mul_i32 s99, s98, 49152
    s_lshl_b32 s96, s11, 7
    s_add_u32 s82, s99, s96
    s_lshr_b32 s96, s3, 1
    s_mul_i32 s97, s96, 2080
    s_and_b32 s98, s3, 1
    s_mul_i32 s99, s98, 1056
    s_add_u32 s96, s97, s99
    s_add_u32 s20, s96, 24960
    s_mov_b32 m0, s20
    s_nop 0
    buffer_load_dwordx4 v62, s[40:43], s82 offen lds
    s_add_u32 s82, s82, 2048
    s_add_u32 m0, s20, 8320
    s_nop 0
    buffer_load_dwordx4 v62, s[40:43], s82 offen lds
    s_add_u32 s82, s82, 2048
    s_add_u32 m0, s20, 16640
    s_nop 0
    buffer_load_dwordx4 v62, s[40:43], s82 offen lds
    s_add_u32 s96, s85, 8
    s_and_b32 s97, s96, 15
    s_lshl3_add_u32 s98, s97, s3
    s_sub_u32 s99, s98, 4
    s_mul_i32 s96, s99, 49152
    s_lshl_b32 s97, s11, 7
    s_add_u32 s82, s96, s97
    s_sub_u32 s96, s3, 4
    s_lshr_b32 s97, s96, 1
    s_mul_i32 s98, s97, 2080
    s_sub_u32 s99, s3, 4
    s_and_b32 s96, s99, 1
    s_mul_i32 s97, s96, 1056
    s_add_u32 s99, s98, s97
    s_add_u32 s20, s99, 49920
    s_mov_b32 m0, s20
    s_nop 0
    buffer_load_dwordx4 v62, s[40:43], s82 offen lds
    s_add_u32 s82, s82, 2048
    s_add_u32 m0, s20, 8320
    s_nop 0
    buffer_load_dwordx4 v62, s[40:43], s82 offen lds
    s_add_u32 s82, s82, 2048
    s_add_u32 m0, s20, 16640
    s_nop 0
    buffer_load_dwordx4 v62, s[40:43], s82 offen lds
    v_lshlrev_b32 v116, 16, v122
    v_mul_f32 v4, s7, v116
    v_exp_f32 v4, -v4
    s_nop 0
    v_add_f32 v4, 1.0, v4
    v_rcp_f32 v4, v4
    s_nop 0
    v_mul_f32 v116, v116, v4
    v_cvt_pk_bf16_f32 v116, 0, v116
    v_and_b32 v117, s6, v122
    v_mul_f32 v5, s7, v117
    v_exp_f32 v5, -v5
    s_nop 0
    v_add_f32 v5, 1.0, v5
    v_rcp_f32 v5, v5
    s_nop 0
    v_mul_f32 v117, v117, v5
    v_cvt_pk_bf16_f32 v117, 0, v117
    v_lshlrev_b32 v118, 16, v123
    v_mul_f32 v4, s7, v118
    v_exp_f32 v4, -v4
    s_nop 0
    v_add_f32 v4, 1.0, v4
    v_rcp_f32 v4, v4
    s_nop 0
    v_mul_f32 v118, v118, v4
    v_cvt_pk_bf16_f32 v118, 0, v118
    v_and_b32 v119, s6, v123
    v_mul_f32 v5, s7, v119
    v_exp_f32 v5, -v5
    s_nop 0
    v_add_f32 v5, 1.0, v5
    v_rcp_f32 v5, v5
    s_nop 0
    v_mul_f32 v119, v119, v5
    v_cvt_pk_bf16_f32 v119, 0, v119
    s_waitcnt lgkmcnt(0)
    s_load_dword s24, s[32:33], s92 offset:1536 glc
    s_load_dword s25, s[32:33], s92 offset:1280 glc
    s_load_dword s26, s[32:33], s92 offset:2048 glc
    s_load_dword s27, s[32:33], s92 offset:1792 glc
    s_barrier
    s_add_u32 s96, s85, 8
    s_and_b32 s97, s96, 15
    s_lshl3_add_u32 s98, s97, s3
    s_mul_i32 s99, s98, 49152
    s_lshl_b32 s96, s11, 7
    s_add_u32 s82, s99, s96
    s_lshr_b32 s96, s3, 1
    s_mul_i32 s97, s96, 2080
    s_and_b32 s98, s3, 1
    s_mul_i32 s99, s98, 1056
    s_add_u32 s96, s97, s99
    s_add_u32 s20, s96, 49920
    s_mov_b32 m0, s20
    s_nop 0
    buffer_load_dwordx4 v62, s[40:43], s82 offen lds
    s_add_u32 s82, s82, 2048
    s_add_u32 m0, s20, 8320
    s_nop 0
    buffer_load_dwordx4 v62, s[40:43], s82 offen lds
    s_add_u32 s82, s82, 2048
    s_add_u32 m0, s20, 16640
    s_nop 0
    buffer_load_dwordx4 v62, s[40:43], s82 offen lds
    buffer_load_dwordx4 v[96:99], v60, s[48:51], s17 offen nt
    s_add_u32 s17, s17, 12288
    buffer_load_dwordx4 v[100:103], v60, s[48:51], s17 offen nt
    s_add_u32 s17, s17, 12288
    s_waitcnt vmcnt(16)
    s_barrier
    s_add_u32 s96, s85, 9
    s_and_b32 s97, s96, 15
    s_lshl3_add_u32 s98, s97, s3
    s_sub_u32 s99, s98, 4
    s_mul_i32 s96, s99, 49152
    s_lshl_b32 s97, s11, 7
    s_add_u32 s82, s96, s97
    s_sub_u32 s96, s3, 4
    s_lshr_b32 s97, s96, 1
    s_mul_i32 s98, s97, 2080
    s_sub_u32 s99, s3, 4
    s_and_b32 s96, s99, 1
    s_mul_i32 s97, s96, 1056
    s_add_u32 s99, s98, s97
    s_add_u32 s20, s99, 74880
    s_mov_b32 m0, s20
    s_nop 0
    buffer_load_dwordx4 v62, s[40:43], s82 offen lds
    s_add_u32 s82, s82, 2048
    s_add_u32 m0, s20, 8320
    s_nop 0
    buffer_load_dwordx4 v62, s[40:43], s82 offen lds
    s_add_u32 s82, s82, 2048
    s_add_u32 m0, s20, 16640
    s_nop 0
    buffer_load_dwordx4 v62, s[40:43], s82 offen lds
    s_add_u32 s96, s85, 9
    s_and_b32 s97, s96, 15
    s_lshl3_add_u32 s98, s97, s3
    s_mul_i32 s99, s98, 49152
    s_lshl_b32 s96, s11, 7
    s_add_u32 s82, s99, s96
    s_lshr_b32 s96, s3, 1
    s_mul_i32 s97, s96, 2080
    s_and_b32 s98, s3, 1
    s_mul_i32 s99, s98, 1056
    s_add_u32 s96, s97, s99
    s_add_u32 s20, s96, 74880
    s_mov_b32 m0, s20
    s_nop 0
    buffer_load_dwordx4 v62, s[40:43], s82 offen lds
    s_add_u32 s82, s82, 2048
    s_add_u32 m0, s20, 8320
    s_nop 0
    buffer_load_dwordx4 v62, s[40:43], s82 offen lds
    s_add_u32 s82, s82, 2048
    s_add_u32 m0, s20, 16640
    s_nop 0
    buffer_load_dwordx4 v62, s[40:43], s82 offen lds
    v_lshlrev_b32 v4, 16, v80
    v_and_b32 v5, s6, v80
    v_mul_f32 v20, v4, v112
    v_mul_f32 v21, v5, v112
    v_lshlrev_b32 v6, 16, v81
    v_and_b32 v7, s6, v81
    v_mul_f32 v22, v6, v112
    v_mul_f32 v23, v7, v112
    v_lshlrev_b32 v4, 16, v82
    v_and_b32 v5, s6, v82
    v_mul_f32 v24, v4, v112
    v_mul_f32 v25, v5, v112
    v_lshlrev_b32 v6, 16, v83
    v_and_b32 v7, s6, v83
    v_mul_f32 v26, v6, v112
    v_mul_f32 v27, v7, v112
    s_waitcnt vmcnt(14)
    s_barrier
    s_add_u32 s96, s85, 10
    s_and_b32 s97, s96, 15
    s_lshl3_add_u32 s98, s97, s3
    s_sub_u32 s99, s98, 4
    s_mul_i32 s96, s99, 49152
    s_lshl_b32 s97, s11, 7
    s_add_u32 s82, s96, s97
    s_sub_u32 s96, s3, 4
    s_lshr_b32 s97, s96, 1
    s_mul_i32 s98, s97, 2080
    s_sub_u32 s99, s3, 4
    s_and_b32 s96, s99, 1
    s_mul_i32 s97, s96, 1056
    s_add_u32 s99, s98, s97
    s_add_u32 s20, s99, 99840
    s_mov_b32 m0, s20
    s_nop 0
    buffer_load_dwordx4 v62, s[40:43], s82 offen lds
    s_add_u32 s82, s82, 2048
    s_add_u32 m0, s20, 8320
    s_nop 0
    buffer_load_dwordx4 v62, s[40:43], s82 offen lds
    s_add_u32 s82, s82, 2048
    s_add_u32 m0, s20, 16640
    s_nop 0
    buffer_load_dwordx4 v62, s[40:43], s82 offen lds
    buffer_load_dwordx4 v[104:107], v60, s[48:51], s17 offen nt
    s_add_u32 s17, s17, 12288
    buffer_load_dwordx4 v[108:111], v60, s[48:51], s17 offen nt
    s_lshl2_add_u32 s96, s74, s75
    s_lshl_b32 s97, s96, 11
    s_and_b32 s98, s3, 1
    s_lshl_b32 s99, s98, 10
    s_add_u32 s96, s97, s99
    s_add_u32 s13, s96, 20971520
    s_lshl4_add_u32 s96, s21, s12
    s_lshl_b32 s97, s96, 11
    s_and_b32 s98, s3, 1
    s_lshl_b32 s99, s98, 10
    s_add_u32 s96, s97, s99
    s_add_u32 s14, s96, 12582912
    buffer_load_dwordx4 v[124:127], v2, s[32:35], s13 offen
    s_waitcnt lgkmcnt(0)
    s_load_dword s24, s[32:33], s92 offset:2560 glc
    s_load_dword s25, s[32:33], s92 offset:2304 glc
    s_load_dword s26, s[32:33], s92 offset:3072 glc
    s_load_dword s27, s[32:33], s92 offset:2816 glc
    s_load_dword s28, s[32:33], s92 offset:3584 glc
    s_load_dword s29, s[32:33], s92 offset:3328 glc
    s_waitcnt vmcnt(14)
    s_barrier
    s_add_u32 s96, s85, 10
    s_and_b32 s97, s96, 15
    s_lshl3_add_u32 s98, s97, s3
    s_mul_i32 s99, s98, 49152
    s_lshl_b32 s96, s11, 7
    s_add_u32 s82, s99, s96
    s_lshr_b32 s96, s3, 1
    s_mul_i32 s97, s96, 2080
    s_and_b32 s98, s3, 1
    s_mul_i32 s99, s98, 1056
    s_add_u32 s96, s97, s99
    s_add_u32 s20, s96, 99840
    s_mov_b32 m0, s20
    s_nop 0
    buffer_load_dwordx4 v62, s[40:43], s82 offen lds
    s_add_u32 s82, s82, 2048
    s_add_u32 m0, s20, 8320
    s_nop 0
    buffer_load_dwordx4 v62, s[40:43], s82 offen lds
    s_add_u32 s82, s82, 2048
    s_add_u32 m0, s20, 16640
    s_nop 0
    buffer_load_dwordx4 v62, s[40:43], s82 offen lds
    s_add_u32 s96, s85, 11
    s_and_b32 s97, s96, 15
    s_lshl3_add_u32 s98, s97, s3
    s_sub_u32 s99, s98, 4
    s_mul_i32 s96, s99, 49152
    s_lshl_b32 s97, s11, 7
    s_add_u32 s82, s96, s97
    s_sub_u32 s96, s3, 4
    s_lshr_b32 s97, s96, 1
    s_mul_i32 s98, s97, 2080
    s_sub_u32 s99, s3, 4
    s_and_b32 s96, s99, 1
    s_mul_i32 s97, s96, 1056
    s_add_u32 s99, s98, s97
    s_add_u32 s20, s99, 124800
    s_mov_b32 m0, s20
    s_nop 0
    buffer_load_dwordx4 v62, s[40:43], s82 offen lds
    s_add_u32 s82, s82, 2048
    s_add_u32 m0, s20, 8320
    s_nop 0
    buffer_load_dwordx4 v62, s[40:43], s82 offen lds
    s_add_u32 s82, s82, 2048
    s_add_u32 m0, s20, 16640
    s_nop 0
    buffer_load_dwordx4 v62, s[40:43], s82 offen lds
    v_lshlrev_b32 v4, 16, v84
    v_and_b32 v5, s6, v84
    v_fmac_f32 v20, v4, v113
    v_fmac_f32 v21, v5, v113
    v_lshlrev_b32 v6, 16, v85
    v_and_b32 v7, s6, v85
    v_fmac_f32 v22, v6, v113
    v_fmac_f32 v23, v7, v113
    v_lshlrev_b32 v4, 16, v86
    v_and_b32 v5, s6, v86
    v_fmac_f32 v24, v4, v113
    v_fmac_f32 v25, v5, v113
    v_lshlrev_b32 v6, 16, v87
    v_and_b32 v7, s6, v87
    v_fmac_f32 v26, v6, v113
    v_fmac_f32 v27, v7, v113
    s_waitcnt vmcnt(12)
    s_barrier
    s_add_u32 s96, s85, 11
    s_and_b32 s97, s96, 15
    s_lshl3_add_u32 s98, s97, s3
    s_mul_i32 s99, s98, 49152
    s_lshl_b32 s96, s11, 7
    s_add_u32 s82, s99, s96
    s_lshr_b32 s96, s3, 1
    s_mul_i32 s97, s96, 2080
    s_and_b32 s98, s3, 1
    s_mul_i32 s99, s98, 1056
    s_add_u32 s96, s97, s99
    s_add_u32 s20, s96, 124800
    s_mov_b32 m0, s20
    s_nop 0
    buffer_load_dwordx4 v62, s[40:43], s82 offen lds
    s_add_u32 s82, s82, 2048
    s_add_u32 m0, s20, 8320
    s_nop 0
    buffer_load_dwordx4 v62, s[40:43], s82 offen lds
    s_add_u32 s82, s82, 2048
    s_add_u32 m0, s20, 16640
    s_nop 0
    buffer_load_dwordx4 v62, s[40:43], s82 offen lds
    s_add_u32 s96, s85, 12
    s_and_b32 s97, s96, 15
    s_lshl3_add_u32 s98, s97, s3
    s_sub_u32 s99, s98, 4
    s_mul_i32 s96, s99, 49152
    s_lshl_b32 s97, s11, 7
    s_add_u32 s82, s96, s97
    s_sub_u32 s96, s3, 4
    s_lshr_b32 s97, s96, 1
    s_mul_i32 s98, s97, 2080
    s_sub_u32 s99, s3, 4
    s_and_b32 s96, s99, 1
    s_mul_i32 s97, s96, 1056
    s_add_u32 s20, s98, s97
    s_mov_b32 m0, s20
    s_nop 0
    buffer_load_dwordx4 v62, s[40:43], s82 offen lds
    s_add_u32 s82, s82, 2048
    s_add_u32 m0, s20, 8320
    s_nop 0
    buffer_load_dwordx4 v62, s[40:43], s82 offen lds
    s_add_u32 s82, s82, 2048
    s_add_u32 m0, s20, 16640
    s_nop 0
    buffer_load_dwordx4 v62, s[40:43], s82 offen lds
    v_lshlrev_b32 v4, 16, v88
    v_and_b32 v5, s6, v88
    v_fmac_f32 v20, v4, v114
    v_fmac_f32 v21, v5, v114
    v_lshlrev_b32 v6, 16, v89
    v_and_b32 v7, s6, v89
    v_fmac_f32 v22, v6, v114
    v_fmac_f32 v23, v7, v114
    v_lshlrev_b32 v4, 16, v90
    v_and_b32 v5, s6, v90
    v_fmac_f32 v24, v4, v114
    v_fmac_f32 v25, v5, v114
    v_lshlrev_b32 v6, 16, v91
    v_and_b32 v7, s6, v91
    v_fmac_f32 v26, v6, v114
    v_fmac_f32 v27, v7, v114
    s_waitcnt vmcnt(9)
    s_barrier
    s_add_u32 s96, s85, 12
    s_and_b32 s97, s96, 15
    s_lshl3_add_u32 s98, s97, s3
    s_mul_i32 s99, s98, 49152
    s_lshl_b32 s96, s11, 7
    s_add_u32 s82, s99, s96
    s_lshr_b32 s96, s3, 1
    s_mul_i32 s97, s96, 2080
    s_and_b32 s98, s3, 1
    s_mul_i32 s99, s98, 1056
    s_add_u32 s20, s97, s99
    s_mov_b32 m0, s20
    s_nop 0
    buffer_load_dwordx4 v62, s[40:43], s82 offen lds
    s_add_u32 s82, s82, 2048
    s_add_u32 m0, s20, 8320
    s_nop 0
    buffer_load_dwordx4 v62, s[40:43], s82 offen lds
    s_add_u32 s82, s82, 2048
    s_add_u32 m0, s20, 16640
    s_nop 0
    buffer_load_dwordx4 v62, s[40:43], s82 offen lds
    s_add_u32 s96, s85, 13
    s_and_b32 s97, s96, 15
    s_lshl3_add_u32 s98, s97, s3
    s_sub_u32 s99, s98, 4
    s_mul_i32 s96, s99, 49152
    s_lshl_b32 s97, s11, 7
    s_add_u32 s82, s96, s97
    s_sub_u32 s96, s3, 4
    s_lshr_b32 s97, s96, 1
    s_mul_i32 s98, s97, 2080
    s_sub_u32 s99, s3, 4
    s_and_b32 s96, s99, 1
    s_mul_i32 s97, s96, 1056
    s_add_u32 s99, s98, s97
    s_add_u32 s20, s99, 24960
    s_mov_b32 m0, s20
    s_nop 0
    buffer_load_dwordx4 v62, s[40:43], s82 offen lds
    s_add_u32 s82, s82, 2048
    s_add_u32 m0, s20, 8320
    s_nop 0
    buffer_load_dwordx4 v62, s[40:43], s82 offen lds
    s_add_u32 s82, s82, 2048
    s_add_u32 m0, s20, 16640
    s_nop 0
    buffer_load_dwordx4 v62, s[40:43], s82 offen lds
    v_lshlrev_b32 v4, 16, v92
    v_and_b32 v5, s6, v92
    v_fmac_f32 v20, v4, v115
    v_fmac_f32 v21, v5, v115
    v_lshlrev_b32 v6, 16, v93
    v_and_b32 v7, s6, v93
    v_fmac_f32 v22, v6, v115
    v_fmac_f32 v23, v7, v115
    v_lshlrev_b32 v4, 16, v94
    v_and_b32 v5, s6, v94
    v_fmac_f32 v24, v4, v115
    v_fmac_f32 v25, v5, v115
    v_lshlrev_b32 v6, 16, v95
    v_and_b32 v7, s6, v95
    v_fmac_f32 v26, v6, v115
    v_fmac_f32 v27, v7, v115
    s_waitcnt vmcnt(9)
    s_barrier
    s_add_u32 s96, s85, 13
    s_and_b32 s97, s96, 15
    s_lshl3_add_u32 s98, s97, s3
    s_mul_i32 s99, s98, 49152
    s_lshl_b32 s96, s11, 7
    s_add_u32 s82, s99, s96
    s_lshr_b32 s96, s3, 1
    s_mul_i32 s97, s96, 2080
    s_and_b32 s98, s3, 1
    s_mul_i32 s99, s98, 1056
    s_add_u32 s96, s97, s99
    s_add_u32 s20, s96, 24960
    s_mov_b32 m0, s20
    s_nop 0
    buffer_load_dwordx4 v62, s[40:43], s82 offen lds
    s_add_u32 s82, s82, 2048
    s_add_u32 m0, s20, 8320
    s_nop 0
    buffer_load_dwordx4 v62, s[40:43], s82 offen lds
    s_add_u32 s82, s82, 2048
    s_add_u32 m0, s20, 16640
    s_nop 0
    buffer_load_dwordx4 v62, s[40:43], s82 offen lds
    s_add_u32 s96, s85, 14
    s_and_b32 s97, s96, 15
    s_lshl3_add_u32 s98, s97, s3
    s_sub_u32 s99, s98, 4
    s_mul_i32 s96, s99, 49152
    s_lshl_b32 s97, s11, 7
    s_add_u32 s82, s96, s97
    s_sub_u32 s96, s3, 4
    s_lshr_b32 s97, s96, 1
    s_mul_i32 s98, s97, 2080
    s_sub_u32 s99, s3, 4
    s_and_b32 s96, s99, 1
    s_mul_i32 s97, s96, 1056
    s_add_u32 s99, s98, s97
    s_add_u32 s20, s99, 49920
    s_mov_b32 m0, s20
    s_nop 0
    buffer_load_dwordx4 v62, s[40:43], s82 offen lds
    s_add_u32 s82, s82, 2048
    s_add_u32 m0, s20, 8320
    s_nop 0
    buffer_load_dwordx4 v62, s[40:43], s82 offen lds
    s_add_u32 s82, s82, 2048
    s_add_u32 m0, s20, 16640
    s_nop 0
    buffer_load_dwordx4 v62, s[40:43], s82 offen lds
    v_lshlrev_b32 v4, 16, v96
    v_and_b32 v5, s6, v96
    v_fmac_f32 v20, v4, v116
    v_fmac_f32 v21, v5, v116
    v_lshlrev_b32 v6, 16, v97
    v_and_b32 v7, s6, v97
    v_fmac_f32 v22, v6, v116
    v_fmac_f32 v23, v7, v116
    v_lshlrev_b32 v4, 16, v98
    v_and_b32 v5, s6, v98
    v_fmac_f32 v24, v4, v116
    v_fmac_f32 v25, v5, v116
    v_lshlrev_b32 v6, 16, v99
    v_and_b32 v7, s6, v99
    v_fmac_f32 v26, v6, v116
    v_fmac_f32 v27, v7, v116
    v_lshlrev_b32 v4, 16, v100
    v_and_b32 v5, s6, v100
    v_fmac_f32 v20, v4, v117
    v_fmac_f32 v21, v5, v117
    v_lshlrev_b32 v6, 16, v101
    v_and_b32 v7, s6, v101
    v_fmac_f32 v22, v6, v117
    v_fmac_f32 v23, v7, v117
    v_lshlrev_b32 v4, 16, v102
    v_and_b32 v5, s6, v102
    v_fmac_f32 v24, v4, v117
    v_fmac_f32 v25, v5, v117
    v_lshlrev_b32 v6, 16, v103
    v_and_b32 v7, s6, v103
    v_fmac_f32 v26, v6, v117
    v_fmac_f32 v27, v7, v117
    s_waitcnt vmcnt(9)
    s_barrier
    s_add_u32 s96, s85, 14
    s_and_b32 s97, s96, 15
    s_lshl3_add_u32 s98, s97, s3
    s_mul_i32 s99, s98, 49152
    s_lshl_b32 s96, s11, 7
    s_add_u32 s82, s99, s96
    s_lshr_b32 s96, s3, 1
    s_mul_i32 s97, s96, 2080
    s_and_b32 s98, s3, 1
    s_mul_i32 s99, s98, 1056
    s_add_u32 s96, s97, s99
    s_add_u32 s20, s96, 49920
    s_mov_b32 m0, s20
    s_nop 0
    buffer_load_dwordx4 v62, s[40:43], s82 offen lds
    s_add_u32 s82, s82, 2048
    s_add_u32 m0, s20, 8320
    s_nop 0
    buffer_load_dwordx4 v62, s[40:43], s82 offen lds
    s_add_u32 s82, s82, 2048
    s_add_u32 m0, s20, 16640
    s_nop 0
    buffer_load_dwordx4 v62, s[40:43], s82 offen lds
    s_add_u32 s96, s85, 15
    s_and_b32 s97, s96, 15
    s_lshl3_add_u32 s98, s97, s3
    s_sub_u32 s99, s98, 4
    s_mul_i32 s96, s99, 49152
    s_lshl_b32 s97, s11, 7
    s_add_u32 s82, s96, s97
    s_sub_u32 s96, s3, 4
    s_lshr_b32 s97, s96, 1
    s_mul_i32 s98, s97, 2080
    s_sub_u32 s99, s3, 4
    s_and_b32 s96, s99, 1
    s_mul_i32 s97, s96, 1056
    s_add_u32 s99, s98, s97
    s_add_u32 s20, s99, 74880
    s_mov_b32 m0, s20
    s_nop 0
    buffer_load_dwordx4 v62, s[40:43], s82 offen lds
    s_add_u32 s82, s82, 2048
    s_add_u32 m0, s20, 8320
    s_nop 0
    buffer_load_dwordx4 v62, s[40:43], s82 offen lds
    s_add_u32 s82, s82, 2048
    s_add_u32 m0, s20, 16640
    s_nop 0
    buffer_load_dwordx4 v62, s[40:43], s82 offen lds
    v_lshlrev_b32 v4, 16, v104
    v_and_b32 v5, s6, v104
    v_fmac_f32 v20, v4, v118
    v_fmac_f32 v21, v5, v118
    v_lshlrev_b32 v6, 16, v105
    v_and_b32 v7, s6, v105
    v_fmac_f32 v22, v6, v118
    v_fmac_f32 v23, v7, v118
    v_lshlrev_b32 v4, 16, v106
    v_and_b32 v5, s6, v106
    v_fmac_f32 v24, v4, v118
    v_fmac_f32 v25, v5, v118
    v_lshlrev_b32 v6, 16, v107
    v_and_b32 v7, s6, v107
    v_fmac_f32 v26, v6, v118
    v_fmac_f32 v27, v7, v118
    v_lshlrev_b32 v4, 16, v108
    v_and_b32 v5, s6, v108
    v_fmac_f32 v20, v4, v119
    v_fmac_f32 v21, v5, v119
    v_lshlrev_b32 v6, 16, v109
    v_and_b32 v7, s6, v109
    v_fmac_f32 v22, v6, v119
    v_fmac_f32 v23, v7, v119
    v_lshlrev_b32 v4, 16, v110
    v_and_b32 v5, s6, v110
    v_fmac_f32 v24, v4, v119
    v_fmac_f32 v25, v5, v119
    v_lshlrev_b32 v6, 16, v111
    v_and_b32 v7, s6, v111
    v_fmac_f32 v26, v6, v119
    v_fmac_f32 v27, v7, v119
    s_waitcnt vmcnt(9)
    s_barrier
    s_add_u32 s96, s85, 15
    s_and_b32 s97, s96, 15
    s_lshl3_add_u32 s98, s97, s3
    s_mul_i32 s99, s98, 49152
    s_lshl_b32 s96, s11, 7
    s_add_u32 s82, s99, s96
    s_lshr_b32 s96, s3, 1
    s_mul_i32 s97, s96, 2080
    s_and_b32 s98, s3, 1
    s_mul_i32 s99, s98, 1056
    s_add_u32 s96, s97, s99
    s_add_u32 s20, s96, 74880
    s_mov_b32 m0, s20
    s_nop 0
    buffer_load_dwordx4 v62, s[40:43], s82 offen lds
    s_add_u32 s82, s82, 2048
    s_add_u32 m0, s20, 8320
    s_nop 0
    buffer_load_dwordx4 v62, s[40:43], s82 offen lds
    s_add_u32 s82, s82, 2048
    s_add_u32 m0, s20, 16640
    s_nop 0
    buffer_load_dwordx4 v62, s[40:43], s82 offen lds
    s_lshl_b32 s13, s12, 7
    v_and_b32 v4, 31, v1
    v_lshl_add_u32 v4, v4, 2, s13
    global_load_dword v104, v4, s[78:79]
    v_permlane32_swap_b32 v20, v24
    v_permlane32_swap_b32 v21, v25
    v_permlane32_swap_b32 v22, v26
    v_permlane32_swap_b32 v23, v27
    v_add_f32 v20, v20, v24
    v_add_f32 v21, v21, v25
    v_add_f32 v22, v22, v26
    v_add_f32 v23, v23, v27
    s_nop 0
    v_permlane16_swap_b32 v20, v22
    v_permlane16_swap_b32 v21, v23
    v_add_f32 v20, v20, v22
    v_add_f32 v21, v21, v23
    s_nop 0
    v_add_f32_dpp v20, v20, v20 row_ror:8 row_mask:0xf bank_mask:0xf
    v_add_f32_dpp v21, v21, v21 row_ror:8 row_mask:0xf bank_mask:0xf
    s_nop 1
    v_mov_b32_dpp v20, v21 quad_perm:[0,1,2,3] row_mask:0xf bank_mask:0xc
    ds_write_b32 v65, v20 offset:1024
    s_waitcnt lgkmcnt(0)
    s_barrier
    s_waitcnt vmcnt(7)
    s_waitcnt vmcnt(1)
    s_barrier
    s_cmp_lg_u32 s3, 4
    s_cbranch_scc1 L_M2F
    s_bfe_u32 s96, s9, 131074
    s_lshl_b32 s97, s8, 1
    s_lshl4_add_u32 s98, s96, s97
    s_lshr_b32 s99, s9, 4
    s_add_u32 s96, s98, s99
    s_and_b32 s97, s9, 3
    s_lshl2_add_u32 s98, s96, s97
    s_lshl_b32 s99, s98, 9
    s_add_u32 s13, s99, 131072
    ds_read_b128 v[20:23], v64 offset:1024
    ds_read_b128 v[24:27], v64 offset:1040
    s_waitcnt lgkmcnt(0)
    v_add_f32 v20, v20, v22
    v_add_f32 v21, v21, v23
    v_add_f32 v24, v24, v26
    v_add_f32 v25, v25, v27
    v_add_f32 v20, v20, v21
    v_add_f32 v22, v24, v25
    v_mov_b32 v21, s4
    v_mov_b32 v23, s4
    s_mov_b32 exec_hi, 0
    buffer_store_dwordx4 v[20:23], v2, s[32:35], s13 offen sc1
    s_mov_b32 exec_hi, -1
L_M2F:
    s_lshl4_add_u32 s96, s11, s10
    s_lshl_b32 s97, s96, 10
    s_and_b32 s98, s3, 3
    s_lshl_b32 s99, s98, 8
    s_add_u32 s96, s97, s99
    s_add_u32 s13, s96, 29360128
    s_lshl_b32 s96, s11, 7
    s_add_u32 s14, s96, 32768
    v_lshlrev_b32 v60, 7, v1
    s_mov_b64 exec, 3
    buffer_load_dword v60, v60, s[32:35], s13 offen
    buffer_load_dword v61, v3, s[32:35], s14 offen
    s_mov_b64 exec, -1
    s_add_u32 s96, s84, 1114112
    s_and_b32 s97, s96, 1048575
    s_lshl_b32 s98, s83, 16
    s_xor_b32 s99, s97, s98
    s_xor_b32 s96, s88, 1048576
    s_add_u32 s13, s99, s96
    s_add_u32 m0, s89, 102400
    s_nop 0
    buffer_load_dwordx4 v74, s[44:47], s13 offen lds
    s_add_u32 s96, s84, 1179648
    s_and_b32 s97, s96, 1048575
    s_lshl_b32 s98, s83, 16
    s_xor_b32 s99, s97, s98
    s_xor_b32 s96, s88, 1048576
    s_add_u32 s13, s99, s96
    s_add_u32 m0, s89, 106496
    s_nop 0
    buffer_load_dwordx4 v74, s[44:47], s13 offen lds
    s_add_u32 s96, s84, 1245184
    s_and_b32 s97, s96, 1048575
    s_lshl_b32 s98, s83, 16
    s_xor_b32 s99, s97, s98
    s_xor_b32 s96, s88, 1048576
    s_add_u32 s13, s99, s96
    s_add_u32 m0, s89, 110592
    s_nop 0
    buffer_load_dwordx4 v74, s[44:47], s13 offen lds
    s_add_u32 s96, s84, 1310720
    s_and_b32 s97, s96, 1048575
    s_lshl_b32 s98, s83, 16
    s_xor_b32 s99, s97, s98
    s_xor_b32 s96, s88, 1048576
    s_add_u32 s13, s99, s96
    s_add_u32 m0, s89, 114688
    s_nop 0
    buffer_load_dwordx4 v74, s[44:47], s13 offen lds
    s_add_u32 s96, s84, 1376256
    s_and_b32 s97, s96, 1048575
    s_lshl_b32 s98, s83, 16
    s_xor_b32 s99, s97, s98
    s_xor_b32 s96, s88, 1048576
    s_add_u32 s13, s99, s96
    s_add_u32 m0, s89, 118784
    s_nop 0
    buffer_load_dwordx4 v74, s[44:47], s13 offen lds
    s_add_u32 s96, s84, 1441792
    s_and_b32 s97, s96, 1048575
    s_lshl_b32 s98, s83, 16
    s_xor_b32 s99, s97, s98
    s_xor_b32 s96, s88, 1048576
    s_add_u32 s13, s99, s96
    s_add_u32 m0, s89, 122880
    s_nop 0
    buffer_load_dwordx4 v74, s[44:47], s13 offen lds
    s_add_u32 s96, s84, 1507328
    s_and_b32 s97, s96, 1048575
    s_lshl_b32 s98, s83, 16
    s_xor_b32 s99, s97, s98
    s_xor_b32 s96, s88, 1048576
    s_add_u32 s13, s99, s96
    s_add_u32 m0, s89, 126976
    s_nop 0
    buffer_load_dwordx4 v74, s[44:47], s13 offen lds
    s_add_u32 s96, s84, 1572864
    s_and_b32 s97, s96, 1048575
    s_lshl_b32 s98, s83, 16
    s_xor_b32 s99, s97, s98
    s_xor_b32 s96, s88, 1048576
    s_add_u32 s13, s99, s96
    s_add_u32 m0, s89, 131072
    s_nop 0
    buffer_load_dwordx4 v74, s[44:47], s13 offen lds
    s_mov_b32 s13, s80
    buffer_load_dwordx4 v[176:179], v72, s[52:55], s13 offen nt
    s_add_u32 s13, s80, 4294049792
    buffer_load_dwordx4 v[180:183], v72, s[52:55], s13 offen nt
    s_lshl_b32 s96, s90, 7
    s_add_u32 s13, s96, s80
    buffer_load_dwordx4 v[184:187], v72, s[56:59], s13 offen nt
    s_lshl_b32 s96, s90, 7
    s_add_u32 s97, s96, s80
    s_add_u32 s13, s97, 4294049792
    buffer_load_dwordx4 v[188:191], v72, s[56:59], s13 offen nt
    s_add_u32 s13, s80, 57344
    buffer_load_dwordx4 v[192:195], v72, s[52:55], s13 offen nt
    s_add_u32 s13, s80, 4294107136
    buffer_load_dwordx4 v[196:199], v72, s[52:55], s13 offen nt
    s_lshl_b32 s96, s90, 7
    s_add_u32 s97, s96, s80
    s_add_u32 s13, s97, 57344
    buffer_load_dwordx4 v[200:203], v72, s[56:59], s13 offen nt
    s_lshl_b32 s96, s90, 7
    s_add_u32 s97, s96, s80
    s_add_u32 s13, s97, 4294107136
    buffer_load_dwordx4 v[204:207], v72, s[56:59], s13 offen nt
    s_waitcnt lgkmcnt(0)
    s_barrier
    ds_read_b128 v[36:39], v76
    ds_read_b128 v[40:43], v76 offset:1024
    s_waitcnt lgkmcnt(0)
    v_mfma_f32_32x32x16_bf16 v[112:127], v[28:31], v[36:39], 0
    v_mfma_f32_32x32x16_bf16 v[112:127], v[32:35], v[40:43], v[112:127]
    s_add_u32 s13, s80, 114688
    buffer_load_dwordx4 v[208:211], v72, s[52:55], s13 offen nt
    s_add_u32 s13, s80, 4294164480
    buffer_load_dwordx4 v[212:215], v72, s[52:55], s13 offen nt
    s_lshl_b32 s96, s90, 7
    s_add_u32 s97, s96, s80
    s_add_u32 s13, s97, 114688
    buffer_load_dwordx4 v[216:219], v72, s[56:59], s13 offen nt
    s_lshl_b32 s96, s90, 7
    s_add_u32 s97, s96, s80
    s_add_u32 s13, s97, 4294164480
    buffer_load_dwordx4 v[220:223], v72, s[56:59], s13 offen nt
L_JOIN:
    s_lshl_b32 s13, s3, 12
    v_add_u32 v20, s13, v63
    s_lshl_b32 s96, s76, 13
    s_add_u32 s13, s96, 32768
    v_add_u32 v21, s13, v63
    s_lshl3_add_u32 s96, s11, s3
    s_lshl_b32 s97, s96, 5
    s_add_u32 s98, s97, s10
    s_lshl_b32 s99, s98, 10
    s_add_u32 s13, s99, 25165824
    s_add_u32 s15, s13, 16384
    s_lshl3_add_u32 s96, s11, s3
    s_lshl_b32 s97, s96, 10
    s_add_u32 s16, s97, 21495808
    s_lshl_b32 s96, s10, 6
    s_add_u32 s14, s96, s16
    v_cvt_pk_bf16_f32 v112, 0, v112
    v_cvt_pk_bf16_f32 v113, 0, v113
    v_cvt_pk_bf16_f32 v114, 0, v114
    v_cvt_pk_bf16_f32 v115, 0, v115
    v_cvt_pk_bf16_f32 v116, 0, v116
    v_cvt_pk_bf16_f32 v117, 0, v117
    v_cvt_pk_bf16_f32 v118, 0, v118
    v_cvt_pk_bf16_f32 v119, 0, v119
    v_cvt_pk_bf16_f32 v120, 0, v120
    v_cvt_pk_bf16_f32 v121, 0, v121
    v_cvt_pk_bf16_f32 v122, 0, v122
    v_cvt_pk_bf16_f32 v123, 0, v123
    v_cvt_pk_bf16_f32 v124, 0, v124
    v_cvt_pk_bf16_f32 v125, 0, v125
    v_cvt_pk_bf16_f32 v126, 0, v126
    v_cvt_pk_bf16_f32 v127, 0, v127
    v_max3_f32 v4, v112, v113, v114
    v_min3_f32 v5, v112, v113, v114
    v_max3_f32 v4, v4, v115, v116
    v_min3_f32 v5, v5, v115, v116
    v_max3_f32 v4, v4, v117, v118
    v_min3_f32 v5, v5, v117, v118
    v_max3_f32 v4, v4, v119, v120
    v_min3_f32 v5, v5, v119, v120
    v_max3_f32 v4, v4, v121, v122
    v_min3_f32 v5, v5, v121, v122
    v_max3_f32 v4, v4, v123, v124
    v_min3_f32 v5, v5, v123, v124
    v_max3_f32 v4, v4, v125, v126
    v_min3_f32 v5, v5, v125, v126
    v_max_f32 v6, v4, v127
    v_min_f32 v7, v5, v127
    v_max_f32 v4, v4, v127
    v_min_f32 v5, v5, v127
    s_nop 0
    v_permlane32_swap_b32 v4, v6
    v_permlane32_swap_b32 v5, v7
    v_max_f32 v4, v4, v6
    v_min_f32 v5, v5, v7
    v_pk_mul_f32 v[4:5], v[4:5], s[6:7] op_sel:[0,1]
    v_pk_fma_f32 v[128:129], v[112:113], s[6:7], v[4:5] op_sel:[0,1,0] op_sel_hi:[1,1,0] neg_lo:[0,0,1] neg_hi:[0,0,1]
    v_pk_fma_f32 v[112:113], v[112:113], s[6:7], v[4:5] op_sel:[0,1,1] neg_lo:[1,0,0] neg_hi:[1,0,0]
    v_pk_fma_f32 v[130:131], v[114:115], s[6:7], v[4:5] op_sel:[0,1,0] op_sel_hi:[1,1,0] neg_lo:[0,0,1] neg_hi:[0,0,1]
    v_pk_fma_f32 v[114:115], v[114:115], s[6:7], v[4:5] op_sel:[0,1,1] neg_lo:[1,0,0] neg_hi:[1,0,0]
    v_pk_fma_f32 v[132:133], v[116:117], s[6:7], v[4:5] op_sel:[0,1,0] op_sel_hi:[1,1,0] neg_lo:[0,0,1] neg_hi:[0,0,1]
    v_pk_fma_f32 v[116:117], v[116:117], s[6:7], v[4:5] op_sel:[0,1,1] neg_lo:[1,0,0] neg_hi:[1,0,0]
    v_pk_fma_f32 v[134:135], v[118:119], s[6:7], v[4:5] op_sel:[0,1,0] op_sel_hi:[1,1,0] neg_lo:[0,0,1] neg_hi:[0,0,1]
    v_pk_fma_f32 v[118:119], v[118:119], s[6:7], v[4:5] op_sel:[0,1,1] neg_lo:[1,0,0] neg_hi:[1,0,0]
    v_pk_fma_f32 v[136:137], v[120:121], s[6:7], v[4:5] op_sel:[0,1,0] op_sel_hi:[1,1,0] neg_lo:[0,0,1] neg_hi:[0,0,1]
    v_pk_fma_f32 v[120:121], v[120:121], s[6:7], v[4:5] op_sel:[0,1,1] neg_lo:[1,0,0] neg_hi:[1,0,0]
    v_pk_fma_f32 v[138:139], v[122:123], s[6:7], v[4:5] op_sel:[0,1,0] op_sel_hi:[1,1,0] neg_lo:[0,0,1] neg_hi:[0,0,1]
    v_pk_fma_f32 v[122:123], v[122:123], s[6:7], v[4:5] op_sel:[0,1,1] neg_lo:[1,0,0] neg_hi:[1,0,0]
    v_pk_fma_f32 v[140:141], v[124:125], s[6:7], v[4:5] op_sel:[0,1,0] op_sel_hi:[1,1,0] neg_lo:[0,0,1] neg_hi:[0,0,1]
    v_pk_fma_f32 v[124:125], v[124:125], s[6:7], v[4:5] op_sel:[0,1,1] neg_lo:[1,0,0] neg_hi:[1,0,0]
    v_pk_fma_f32 v[142:143], v[126:127], s[6:7], v[4:5] op_sel:[0,1,0] op_sel_hi:[1,1,0] neg_lo:[0,0,1] neg_hi:[0,0,1]
    v_pk_fma_f32 v[126:127], v[126:127], s[6:7], v[4:5] op_sel:[0,1,1] neg_lo:[1,0,0] neg_hi:[1,0,0]
    v_exp_f32 v128, v128
    v_exp_f32 v112, v112
    v_exp_f32 v129, v129
    v_exp_f32 v113, v113
    v_exp_f32 v130, v130
    v_exp_f32 v114, v114
    v_exp_f32 v131, v131
    v_exp_f32 v115, v115
    v_exp_f32 v132, v132
    v_exp_f32 v116, v116
    v_exp_f32 v133, v133
    v_exp_f32 v117, v117
    v_exp_f32 v134, v134
    v_exp_f32 v118, v118
    v_exp_f32 v135, v135
    v_exp_f32 v119, v119
    v_exp_f32 v136, v136
    v_exp_f32 v120, v120
    v_exp_f32 v137, v137
    v_exp_f32 v121, v121
    v_exp_f32 v138, v138
    v_exp_f32 v122, v122
    v_exp_f32 v139, v139
    v_exp_f32 v123, v123
    v_exp_f32 v140, v140
    v_exp_f32 v124, v124
    v_exp_f32 v141, v141
    v_exp_f32 v125, v125
    v_exp_f32 v142, v142
    v_exp_f32 v126, v126
    v_exp_f32 v143, v143
    v_exp_f32 v127, v127
    v_pk_add_f32 v[8:9], v[128:129], v[130:131]
    v_pk_add_f32 v[10:11], v[112:113], v[114:115]
    v_pk_add_f32 v[8:9], v[8:9], v[132:133]
    v_pk_add_f32 v[10:11], v[10:11], v[116:117]
    v_pk_add_f32 v[8:9], v[8:9], v[134:135]
    v_pk_add_f32 v[10:11], v[10:11], v[118:119]
    v_pk_add_f32 v[8:9], v[8:9], v[136:137]
    v_pk_add_f32 v[10:11], v[10:11], v[120:121]
    v_pk_add_f32 v[8:9], v[8:9], v[138:139]
    v_pk_add_f32 v[10:11], v[10:11], v[122:123]
    v_pk_add_f32 v[8:9], v[8:9], v[140:141]
    v_pk_add_f32 v[10:11], v[10:11], v[124:125]
    v_pk_add_f32 v[8:9], v[8:9], v[142:143]
    v_pk_add_f32 v[10:11], v[10:11], v[126:127]
    v_add_f32 v6, v8, v9
    v_add_f32 v7, v10, v11
    v_add_f32 v4, v8, v9
    v_add_f32 v5, v10, v11
    s_nop 0
    v_permlane32_swap_b32 v4, v6
    v_permlane32_swap_b32 v5, v7
    v_pk_add_f32 v[4:5], v[4:5], v[6:7]
    v_rcp_f32 v4, v4
    v_rcp_f32 v5, v5
    s_nop 0
    v_pk_mul_f32 v[128:129], v[128:129], v[4:5] op_sel_hi:[1,0]
    v_pk_mul_f32 v[112:113], v[112:113], v[4:5] op_sel:[0,1]
    v_pk_mul_f32 v[130:131], v[130:131], v[4:5] op_sel_hi:[1,0]
    v_pk_mul_f32 v[114:115], v[114:115], v[4:5] op_sel:[0,1]
    v_pk_mul_f32 v[132:133], v[132:133], v[4:5] op_sel_hi:[1,0]
    v_pk_mul_f32 v[116:117], v[116:117], v[4:5] op_sel:[0,1]
    v_pk_mul_f32 v[134:135], v[134:135], v[4:5] op_sel_hi:[1,0]
    v_pk_mul_f32 v[118:119], v[118:119], v[4:5] op_sel:[0,1]
    v_pk_mul_f32 v[136:137], v[136:137], v[4:5] op_sel_hi:[1,0]
    v_pk_mul_f32 v[120:121], v[120:121], v[4:5] op_sel:[0,1]
    v_pk_mul_f32 v[138:139], v[138:139], v[4:5] op_sel_hi:[1,0]
    v_pk_mul_f32 v[122:123], v[122:123], v[4:5] op_sel:[0,1]
    v_pk_mul_f32 v[140:141], v[140:141], v[4:5] op_sel_hi:[1,0]
    v_pk_mul_f32 v[124:125], v[124:125], v[4:5] op_sel:[0,1]
    v_pk_mul_f32 v[142:143], v[142:143], v[4:5] op_sel_hi:[1,0]
    v_pk_mul_f32 v[126:127], v[126:127], v[4:5] op_sel:[0,1]
    v_cvt_pk_bf16_f32 v80, v128, v129
    v_cvt_pk_bf16_f32 v88, v112, v113
    v_cvt_pk_bf16_f32 v81, v130, v131
    v_cvt_pk_bf16_f32 v89, v114, v115
    v_cvt_pk_bf16_f32 v82, v132, v133
    v_cvt_pk_bf16_f32 v90, v116, v117
    v_cvt_pk_bf16_f32 v83, v134, v135
    v_cvt_pk_bf16_f32 v91, v118, v119
    v_cvt_pk_bf16_f32 v84, v136, v137
    v_cvt_pk_bf16_f32 v92, v120, v121
    v_cvt_pk_bf16_f32 v85, v138, v139
    v_cvt_pk_bf16_f32 v93, v122, v123
    v_cvt_pk_bf16_f32 v86, v140, v141
    v_cvt_pk_bf16_f32 v94, v124, v125
    v_cvt_pk_bf16_f32 v87, v142, v143
    v_cvt_pk_bf16_f32 v95, v126, v127
    ds_write_b128 v75, v[80:83]
    ds_write_b128 v75, v[84:87] offset:4096
    ds_write_b128 v75, v[88:91] offset:8192
    ds_write_b128 v75, v[92:95] offset:12288
    v_mov_b32 v36, 0x3f803f80
    v_mov_b32 v37, 0x3f803f80
    v_mov_b32 v38, 0x3f803f80
    v_mov_b32 v39, 0x3f803f80
    s_waitcnt lgkmcnt(0)
    s_barrier
    ds_read_b64_tr_b16 v[128:129], v20
    ds_read_b64_tr_b16 v[130:131], v20 offset:512
    ds_read_b64_tr_b16 v[144:145], v21
    ds_read_b64_tr_b16 v[146:147], v21 offset:512
    ds_read_b64_tr_b16 v[148:149], v21 offset:4096
    ds_read_b64_tr_b16 v[150:151], v21 offset:4608
    ds_read_b64_tr_b16 v[132:133], v20 offset:1024
    ds_read_b64_tr_b16 v[134:135], v20 offset:1536
    ds_read_b64_tr_b16 v[152:153], v21 offset:1024
    ds_read_b64_tr_b16 v[154:155], v21 offset:1536
    ds_read_b64_tr_b16 v[156:157], v21 offset:5120
    ds_read_b64_tr_b16 v[158:159], v21 offset:5632
    ds_read_b64_tr_b16 v[136:137], v20 offset:2048
    ds_read_b64_tr_b16 v[138:139], v20 offset:2560
    ds_read_b64_tr_b16 v[160:161], v21 offset:2048
    ds_read_b64_tr_b16 v[162:163], v21 offset:2560
    ds_read_b64_tr_b16 v[164:165], v21 offset:6144
    ds_read_b64_tr_b16 v[166:167], v21 offset:6656
    s_waitcnt lgkmcnt(12)
    v_mfma_f32_16x16x32_bf16 v[52:55], v[128:131], v[144:147], 0
    v_mfma_f32_16x16x32_bf16 v[56:59], v[128:131], v[148:151], 0
    v_mfma_f32_16x16x32_bf16 v[40:43], v[128:131], v[36:39], 0
    ds_read_b64_tr_b16 v[140:141], v20 offset:3072
    ds_read_b64_tr_b16 v[142:143], v20 offset:3584
    ds_read_b64_tr_b16 v[168:169], v21 offset:3072
    ds_read_b64_tr_b16 v[170:171], v21 offset:3584
    ds_read_b64_tr_b16 v[172:173], v21 offset:7168
    ds_read_b64_tr_b16 v[174:175], v21 offset:7680
    s_waitcnt lgkmcnt(12)
    v_mfma_f32_16x16x32_bf16 v[52:55], v[132:135], v[152:155], v[52:55]
    v_mfma_f32_16x16x32_bf16 v[56:59], v[132:135], v[156:159], v[56:59]
    v_mfma_f32_16x16x32_bf16 v[40:43], v[132:135], v[36:39], v[40:43]
    v_and_b32 v75, 15, v1
    v_lshlrev_b32 v75, 15, v75
    s_and_b32 s96, s10, 1
    s_and_b32 s97, s2, 135
    s_lshl_b32 s98, s97, 12
    s_lshr_b32 s99, s10, 1
    s_lshl_b32 s97, s99, 6
    s_add_u32 s99, s98, s97
    s_lshl2_add_u32 s98, s96, s99
    s_add_u32 s97, s98, 1048576
    s_add_u32 s17, s97, 512
    s_waitcnt lgkmcnt(6)
    v_mfma_f32_16x16x32_bf16 v[52:55], v[136:139], v[160:163], v[52:55]
    v_mfma_f32_16x16x32_bf16 v[56:59], v[136:139], v[164:167], v[56:59]
    v_mfma_f32_16x16x32_bf16 v[40:43], v[136:139], v[36:39], v[40:43]
    s_waitcnt lgkmcnt(0)
    v_mfma_f32_16x16x32_bf16 v[52:55], v[140:143], v[168:171], v[52:55]
    v_mfma_f32_16x16x32_bf16 v[56:59], v[140:143], v[172:175], v[56:59]
    v_mfma_f32_16x16x32_bf16 v[40:43], v[140:143], v[36:39], v[40:43]
    s_cmp_lt_u32 s3, 4
    s_cbranch_scc1 L_NOQX
    ds_read_b128 v[44:47], v76 offset:2048
    ds_read_b128 v[48:51], v76 offset:3072
L_NOQX:
    s_nop 3
    buffer_store_dwordx4 v[52:55], v2, s[32:35], s13 offen sc1
    buffer_store_dwordx4 v[56:59], v2, s[32:35], s15 offen sc1
    v_lshlrev_b32 v4, 6, v1
    ds_bpermute_b32 v40, v4, v40
    ds_bpermute_b32 v41, v4, v41
    ds_bpermute_b32 v42, v4, v42
    ds_bpermute_b32 v43, v4, v43
    s_waitcnt lgkmcnt(0)
    s_mov_b64 exec, 15
    buffer_store_dwordx4 v[40:43], v2, s[32:35], s14 offen sc1
    s_mov_b64 exec, -1
    s_waitcnt lgkmcnt(0)
    v_mfma_f32_32x32x16_bf16 v[112:127], v[28:31], v[44:47], 0
    v_mfma_f32_32x32x16_bf16 v[112:127], v[32:35], v[48:51], v[112:127]
    v_lshrrev_b32 v22, 3, v1
    v_lshlrev_b32 v22, 10, v22
    v_and_b32 v9, 7, v1
    v_lshl_add_u32 v22, v9, 4, v22
    s_nop 7
    v_cvt_pk_bf16_f32 v112, 0, v112
    v_cvt_pk_bf16_f32 v113, 0, v113
    v_cvt_pk_bf16_f32 v114, 0, v114
    v_cvt_pk_bf16_f32 v115, 0, v115
    v_cvt_pk_bf16_f32 v116, 0, v116
    v_cvt_pk_bf16_f32 v117, 0, v117
    v_cvt_pk_bf16_f32 v118, 0, v118
    v_cvt_pk_bf16_f32 v119, 0, v119
    v_cvt_pk_bf16_f32 v120, 0, v120
    v_cvt_pk_bf16_f32 v121, 0, v121
    v_cvt_pk_bf16_f32 v122, 0, v122
    v_cvt_pk_bf16_f32 v123, 0, v123
    v_cvt_pk_bf16_f32 v124, 0, v124
    v_cvt_pk_bf16_f32 v125, 0, v125
    v_cvt_pk_bf16_f32 v126, 0, v126
    v_cvt_pk_bf16_f32 v127, 0, v127
    v_max3_f32 v52, v112, v113, v114
    v_min3_f32 v53, v112, v113, v114
    v_max3_f32 v52, v52, v115, v116
    v_min3_f32 v53, v53, v115, v116
    v_max3_f32 v52, v52, v117, v118
    v_min3_f32 v53, v53, v117, v118
    v_max3_f32 v52, v52, v119, v120
    v_min3_f32 v53, v53, v119, v120
    v_max3_f32 v52, v52, v121, v122
    v_min3_f32 v53, v53, v121, v122
    v_max3_f32 v52, v52, v123, v124
    v_min3_f32 v53, v53, v123, v124
    v_max3_f32 v52, v52, v125, v126
    v_min3_f32 v53, v53, v125, v126
    v_max_f32 v54, v52, v127
    v_min_f32 v55, v53, v127
    v_max_f32 v52, v52, v127
    v_min_f32 v53, v53, v127
    s_nop 0
    v_permlane32_swap_b32 v52, v54
    v_permlane32_swap_b32 v53, v55
    v_max_f32 v52, v52, v54
    v_min_f32 v53, v53, v55
    v_pk_mul_f32 v[52:53], v[52:53], s[6:7] op_sel:[0,1]
    v_pk_fma_f32 v[128:129], v[112:113], s[6:7], v[52:53] op_sel:[0,1,0] op_sel_hi:[1,1,0] neg_lo:[0,0,1] neg_hi:[0,0,1]
    v_pk_fma_f32 v[112:113], v[112:113], s[6:7], v[52:53] op_sel:[0,1,1] neg_lo:[1,0,0] neg_hi:[1,0,0]
    v_pk_fma_f32 v[130:131], v[114:115], s[6:7], v[52:53] op_sel:[0,1,0] op_sel_hi:[1,1,0] neg_lo:[0,0,1] neg_hi:[0,0,1]
    v_pk_fma_f32 v[114:115], v[114:115], s[6:7], v[52:53] op_sel:[0,1,1] neg_lo:[1,0,0] neg_hi:[1,0,0]
    v_pk_fma_f32 v[132:133], v[116:117], s[6:7], v[52:53] op_sel:[0,1,0] op_sel_hi:[1,1,0] neg_lo:[0,0,1] neg_hi:[0,0,1]
    v_pk_fma_f32 v[116:117], v[116:117], s[6:7], v[52:53] op_sel:[0,1,1] neg_lo:[1,0,0] neg_hi:[1,0,0]
    v_pk_fma_f32 v[134:135], v[118:119], s[6:7], v[52:53] op_sel:[0,1,0] op_sel_hi:[1,1,0] neg_lo:[0,0,1] neg_hi:[0,0,1]
    v_pk_fma_f32 v[118:119], v[118:119], s[6:7], v[52:53] op_sel:[0,1,1] neg_lo:[1,0,0] neg_hi:[1,0,0]
    v_pk_fma_f32 v[136:137], v[120:121], s[6:7], v[52:53] op_sel:[0,1,0] op_sel_hi:[1,1,0] neg_lo:[0,0,1] neg_hi:[0,0,1]
    v_pk_fma_f32 v[120:121], v[120:121], s[6:7], v[52:53] op_sel:[0,1,1] neg_lo:[1,0,0] neg_hi:[1,0,0]
    v_pk_fma_f32 v[138:139], v[122:123], s[6:7], v[52:53] op_sel:[0,1,0] op_sel_hi:[1,1,0] neg_lo:[0,0,1] neg_hi:[0,0,1]
    v_pk_fma_f32 v[122:123], v[122:123], s[6:7], v[52:53] op_sel:[0,1,1] neg_lo:[1,0,0] neg_hi:[1,0,0]
    v_pk_fma_f32 v[140:141], v[124:125], s[6:7], v[52:53] op_sel:[0,1,0] op_sel_hi:[1,1,0] neg_lo:[0,0,1] neg_hi:[0,0,1]
    v_pk_fma_f32 v[124:125], v[124:125], s[6:7], v[52:53] op_sel:[0,1,1] neg_lo:[1,0,0] neg_hi:[1,0,0]
    v_pk_fma_f32 v[142:143], v[126:127], s[6:7], v[52:53] op_sel:[0,1,0] op_sel_hi:[1,1,0] neg_lo:[0,0,1] neg_hi:[0,0,1]
    v_pk_fma_f32 v[126:127], v[126:127], s[6:7], v[52:53] op_sel:[0,1,1] neg_lo:[1,0,0] neg_hi:[1,0,0]
    v_exp_f32 v128, v128
    v_exp_f32 v112, v112
    v_exp_f32 v129, v129
    s_lshl_b32 s96, s11, 7
    s_add_u32 s18, s96, 32768
    s_lshl3_add_u32 s14, s10, s18
    v_and_b32 v23, 15, v1
    v_lshlrev_b32 v23, 3, v23
    s_waitcnt vmcnt(0)
    s_barrier
    s_cmp_lg_u32 s3, 0
    s_cbranch_scc1 L_PC
    v_mov_b32 v21, s4
    s_mov_b32 exec_hi, 0
    s_mov_b32 exec_lo, 65535
    buffer_store_dword v21, v75, s[32:35], s17 offen sc1
    s_mov_b64 exec, -1
L_PC:
    s_cmp_lt_u32 s3, 4
    s_cbranch_scc1 L_NOM
    v_and_b32 v105, 31, v1
    v_lshlrev_b32 v105, 4, v105
    v_lshrrev_b32 v9, 5, v1
    v_lshl_add_u32 v105, v9, 9, v105
    s_and_b32 s96, s3, 3
    s_lshl4_add_u32 s97, s96, s12
    s_lshl_b32 s98, s97, 11
    s_add_u32 s20, s98, 131072
    buffer_load_dwordx4 v[96:99], v105, s[32:35], s20 offen sc1
    buffer_load_dwordx4 v[100:103], v105, s[32:35], s20 offen offset:1024 sc1
L_NOM:
    s_lshl4_add_u32 s96, s11, s10
    s_lshl_b32 s97, s96, 14
    s_lshl_b32 s98, s3, 7
    s_add_u32 s99, s97, s98
    s_add_u32 s13, s99, 25165824
    s_lshl4_add_u32 s96, s11, s10
    s_lshl_b32 s97, s96, 10
    s_lshl_b32 s98, s3, 7
    s_add_u32 s99, s97, s98
    s_add_u32 s15, s99, 29360128
    s_add_u32 s17, s17, 3072
    s_load_dwordx2 s[24:25], s[32:33], s92 offset:512 glc
    s_add_u32 s96, s84, 262144
    s_and_b32 s97, s96, 1048575
    s_lshl_b32 s98, s83, 16
    s_xor_b32 s99, s97, s98
    s_add_u32 s19, s99, s88
    s_add_u32 m0, s89, 49152
    s_nop 0
    buffer_load_dwordx4 v74, s[44:47], s19 offen lds
    v_exp_f32 v113, v113
    v_exp_f32 v130, v130
    v_exp_f32 v114, v114
    v_exp_f32 v131, v131
    v_exp_f32 v115, v115
    v_exp_f32 v132, v132
    v_exp_f32 v116, v116
    v_exp_f32 v133, v133
    v_exp_f32 v117, v117
    v_exp_f32 v134, v134
    s_add_u32 s96, s84, 393216
    s_and_b32 s97, s96, 1048575
    s_lshl_b32 s98, s83, 16
    s_xor_b32 s99, s97, s98
    s_add_u32 s19, s99, s88
    s_add_u32 m0, s89, 57344
    s_nop 0
    buffer_load_dwordx4 v74, s[44:47], s19 offen lds
    v_exp_f32 v118, v118
    v_exp_f32 v135, v135
    v_exp_f32 v119, v119
    v_exp_f32 v136, v136
    v_exp_f32 v120, v120
    v_exp_f32 v137, v137
    v_exp_f32 v121, v121
    v_exp_f32 v138, v138
    v_exp_f32 v122, v122
    s_add_u32 s96, s84, 524288
    s_and_b32 s97, s96, 1048575
    s_lshl_b32 s98, s83, 16
    s_xor_b32 s99, s97, s98
    s_add_u32 s19, s99, s88
    s_add_u32 m0, s89, 65536
    s_nop 0
    buffer_load_dwordx4 v74, s[44:47], s19 offen lds
    v_exp_f32 v139, v139
    v_exp_f32 v123, v123
    v_exp_f32 v140, v140
    v_exp_f32 v124, v124
    v_exp_f32 v141, v141
    v_exp_f32 v125, v125
    v_exp_f32 v142, v142
    v_exp_f32 v126, v126
    v_exp_f32 v143, v143
    v_exp_f32 v127, v127
    s_add_u32 s96, s84, 655360
    s_and_b32 s97, s96, 1048575
    s_lshl_b32 s98, s83, 16
    s_xor_b32 s99, s97, s98
    s_add_u32 s19, s99, s88
    s_add_u32 m0, s89, 73728
    s_nop 0
    buffer_load_dwordx4 v74, s[44:47], s19 offen lds
    v_pk_add_f32 v[56:57], v[128:129], v[130:131]
    v_pk_add_f32 v[58:59], v[112:113], v[114:115]
    v_pk_add_f32 v[56:57], v[56:57], v[132:133]
    v_pk_add_f32 v[58:59], v[58:59], v[116:117]
    v_pk_add_f32 v[56:57], v[56:57], v[134:135]
    v_pk_add_f32 v[58:59], v[58:59], v[118:119]
    v_pk_add_f32 v[56:57], v[56:57], v[136:137]
    v_pk_add_f32 v[58:59], v[58:59], v[120:121]
    v_pk_add_f32 v[56:57], v[56:57], v[138:139]
    s_add_u32 s96, s84, 786432
    s_and_b32 s97, s96, 1048575
    s_lshl_b32 s98, s83, 16
    s_xor_b32 s99, s97, s98
    s_add_u32 s19, s99, s88
    s_add_u32 m0, s89, 81920
    s_nop 0
    buffer_load_dwordx4 v74, s[44:47], s19 offen lds
    v_pk_add_f32 v[58:59], v[58:59], v[122:123]
    v_pk_add_f32 v[56:57], v[56:57], v[140:141]
    v_pk_add_f32 v[58:59], v[58:59], v[124:125]
    v_pk_add_f32 v[56:57], v[56:57], v[142:143]
    v_pk_add_f32 v[58:59], v[58:59], v[126:127]
    v_add_f32 v54, v56, v57
    v_add_f32 v55, v58, v59
    v_add_f32 v52, v56, v57
    v_add_f32 v53, v58, v59
    s_nop 0
    v_permlane32_swap_b32 v52, v54
    s_add_u32 s96, s84, 917504
    s_and_b32 s97, s96, 1048575
    s_lshl_b32 s98, s83, 16
    s_xor_b32 s99, s97, s98
    s_add_u32 s19, s99, s88
    s_add_u32 m0, s89, 90112
    s_nop 0
    buffer_load_dwordx4 v74, s[44:47], s19 offen lds
    v_permlane32_swap_b32 v53, v55
    v_pk_add_f32 v[52:53], v[52:53], v[54:55]
    v_rcp_f32 v52, v52
    v_rcp_f32 v53, v53
    s_nop 0
    v_pk_mul_f32 v[128:129], v[128:129], v[52:53] op_sel_hi:[1,0]
    v_pk_mul_f32 v[112:113], v[112:113], v[52:53] op_sel:[0,1]
    v_pk_mul_f32 v[130:131], v[130:131], v[52:53] op_sel_hi:[1,0]
    v_pk_mul_f32 v[114:115], v[114:115], v[52:53] op_sel:[0,1]
    v_pk_mul_f32 v[132:133], v[132:133], v[52:53] op_sel_hi:[1,0]
    s_cmp_lt_u32 s3, 4
    s_cbranch_scc1 L_NOG
    s_waitcnt vmcnt(6)
    v_bitop3_b32 v4, v97, v99, s4 bitop3:0x7e
    v_bitop3_b32 v4, v4, v101, s4 bitop3:0xf6
    v_bitop3_b32 v4, v4, v103, s4 bitop3:0xf6
    v_cmp_ne_u32 vcc, 0, v4
    s_cbranch_vccz TOK_17
POLL_18:
    buffer_load_dwordx4 v[96:99], v105, s[32:35], s20 offen sc1
    buffer_load_dwordx4 v[100:103], v105, s[32:35], s20 offen offset:1024 sc1
    s_waitcnt vmcnt(0)
    v_bitop3_b32 v4, v97, v99, s4 bitop3:0x7e
    v_bitop3_b32 v4, v4, v101, s4 bitop3:0xf6
    v_bitop3_b32 v4, v4, v103, s4 bitop3:0xf6
    v_cmp_ne_u32 vcc, 0, v4
    s_cbranch_vccz PDONE_19
    s_add_u32 s5, s5, 1
    s_cmp_lt_u32 s5, 300000
    s_cbranch_scc1 POLL_18
PDONE_19:
TOK_17:
    s_and_b32 s96, s3, 3
    s_lshl_b32 s97, s96, 7
    s_add_u32 s14, s97, 12288
    v_and_b32 v4, 31, v1
    v_lshl_add_u32 v4, v4, 2, s14
    s_and_b32 s82, s3, 3
    v_add_f32 v96, v96, v100
    v_add_f32 v97, v98, v102
    v_mov_b32 v98, v96
    v_mov_b32 v99, v97
    s_cmp_eq_u32 s82, 2
    s_cselect_b32 s91, 1.0, 0
    v_permlane32_swap_b32 v96, v98
    v_permlane32_swap_b32 v97, v99
    v_pk_add_f32 v[96:97], v[96:97], v[98:99]
    v_cvt_pk_bf16_f32 v96, 0, v96
    v_cvt_pk_bf16_f32 v97, 0, v97
    v_add_f32 v96, s91, v96
    v_add_f32 v97, s91, v97
    v_cvt_pk_bf16_f32 v98, v96, v97
    ds_write_b32 v4, v98
    s_cbranch_scc0 L_NOG
    v_lshlrev_b32 v96, 16, v98
    v_and_b32 v97, s6, v98
    v_lshlrev_b32 v100, 16, v104
    v_and_b32 v101, s6, v104
    v_pk_mul_f32 v[100:101], v[100:101], v[96:97]
    v_cvt_pk_bf16_f32 v102, v100, v101
    v_lshlrev_b32 v96, 16, v102
    v_and_b32 v97, s6, v102
    v_pk_add_f32 v[96:97], v[100:101], v[96:97] neg_lo:[0,1] neg_hi:[0,1]
    v_cvt_pk_bf16_f32 v103, v96, v97
    v_add_f32 v96, v100, v101
    ds_write2_b32 v4, v102, v103 offset0:64 offset1:96
    ds_write_b32 v4, v104 offset:512
    v_add_f32_dpp v96, v96, v96 quad_perm:[1,0,3,2] row_mask:0xf bank_mask:0xf
    s_nop 1
    v_add_f32_dpp v96, v96, v96 quad_perm:[2,3,0,1] row_mask:0xf bank_mask:0xf
    s_nop 1
    v_add_f32_dpp v96, v96, v96 row_half_mirror row_mask:0xf bank_mask:0xf
    s_nop 1
    v_add_f32_dpp v96, v96, v96 row_ror:8 row_mask:0xf bank_mask:0xf
    s_lshl4_add_u32 s96, s21, s12
    s_lshl_b32 s97, s96, 6
    s_add_u32 s14, s97, 65536
    v_mov_b32 v98, v96
    v_mov_b32 v97, s4
    s_nop 0
    v_permlane16_swap_b32 v96, v98
    v_add_f32 v96, v96, v98
    v_mov_b32 v99, s4
    s_mov_b64 exec, 15
    buffer_store_dwordx4 v[96:99], v2, s[32:35], s14 offen sc1
    s_mov_b64 exec, -1
L_NOG:
    s_branch SCHK_15
SPOLL_14:
    s_load_dwordx2 s[24:25], s[32:33], s92 offset:512 glc
SCHK_15:
    s_add_u32 s5, s5, 1
    s_cmp_ge_u32 s5, 300000
    s_waitcnt lgkmcnt(0)
    s_cbranch_scc1 SDONE_16
    s_cmp_lg_u32 s24, s4
    s_cbranch_scc1 SPOLL_14
    s_cmp_lg_u32 s25, s4
    s_cbranch_scc1 SPOLL_14
SDONE_16:
    s_barrier
    s_add_u32 s18, s13, 8192
    buffer_load_dword v24, v3, s[32:35], 0 offen offset:256 sc1
    buffer_load_dwordx4 v[144:147], v22, s[32:35], s13 offen sc1
    buffer_load_dwordx4 v[148:151], v22, s[32:35], s18 offen sc1
    buffer_load_dwordx4 v[160:163], v2, s[32:35], s16 offen sc1
    s_lshl_b32 s96, s3, 5
    s_add_u32 s14, s96, 8192
    v_and_b32 v6, 3, v1
    v_lshl_add_u32 v6, v6, 3, s14
    v_lshrrev_b32 v9, 5, v1
    v_lshl_add_u32 v6, v9, 2, v6
    s_lshl_b32 s14, s3, 10
    v_and_b32 v5, 15, v1
    v_lshl_add_u32 v5, v5, 4, s14
    v_lshrrev_b32 v9, 5, v1
    v_lshl_add_u32 v5, v9, 9, v5
    v_bfe_u32 v9, v1, 4, 1
    v_lshl_add_u32 v5, v9, 3, v5
    s_lshl_b32 s96, s76, 7
    s_add_u32 s14, s96, 8192
    v_lshrrev_b32 v7, 5, v1
    v_lshl_add_u32 v7, v7, 4, s14
    s_lshl_b32 s14, s76, 12
    v_add_u32 v20, s14, v2
    v_pk_mul_f32 v[116:117], v[116:117], v[52:53] op_sel:[0,1]
    v_pk_mul_f32 v[134:135], v[134:135], v[52:53] op_sel_hi:[1,0]
    v_pk_mul_f32 v[118:119], v[118:119], v[52:53] op_sel:[0,1]
    v_pk_mul_f32 v[136:137], v[136:137], v[52:53] op_sel_hi:[1,0]
    v_pk_mul_f32 v[120:121], v[120:121], v[52:53] op_sel:[0,1]
    v_pk_mul_f32 v[138:139], v[138:139], v[52:53] op_sel_hi:[1,0]
    v_pk_mul_f32 v[122:123], v[122:123], v[52:53] op_sel:[0,1]
    v_pk_mul_f32 v[140:141], v[140:141], v[52:53] op_sel_hi:[1,0]
    v_pk_mul_f32 v[124:125], v[124:125], v[52:53] op_sel:[0,1]
    v_pk_mul_f32 v[142:143], v[142:143], v[52:53] op_sel_hi:[1,0]
    v_pk_mul_f32 v[126:127], v[126:127], v[52:53] op_sel:[0,1]
    v_cvt_pk_bf16_f32 v80, v128, v129
    v_cvt_pk_bf16_f32 v88, v112, v113
    v_cvt_pk_bf16_f32 v81, v130, v131
    v_cvt_pk_bf16_f32 v89, v114, v115
    v_cvt_pk_bf16_f32 v82, v132, v133
    v_cvt_pk_bf16_f32 v90, v116, v117
    v_cvt_pk_bf16_f32 v83, v134, v135
    v_cvt_pk_bf16_f32 v91, v118, v119
    v_cvt_pk_bf16_f32 v84, v136, v137
    v_cvt_pk_bf16_f32 v92, v120, v121
    v_cvt_pk_bf16_f32 v85, v138, v139
    v_cvt_pk_bf16_f32 v93, v122, v123
    v_cvt_pk_bf16_f32 v86, v140, v141
    v_cvt_pk_bf16_f32 v94, v124, v125
    v_cvt_pk_bf16_f32 v87, v142, v143
    v_cvt_pk_bf16_f32 v95, v126, v127
    s_waitcnt vmcnt(1)
    v_cmp_eq_u32 vcc, s4, v24
    s_nop 0
    s_cmp_eq_u32 vcc_lo, 0
    s_cselect_b32 s93, 1, 0
    v_pk_add_f32 v[144:145], v[144:145], v[148:149]
    v_pk_add_f32 v[146:147], v[146:147], v[150:151]
    s_nop 1
    v_permlane32_swap_b32 v144, v146
    v_permlane32_swap_b32 v145, v147
    v_pk_add_f32 v[144:145], v[144:145], v[146:147]
    s_nop 1
    v_add_f32_dpp v144, v144, v144 row_ror:8 row_mask:0xf bank_mask:0xf
    v_add_f32_dpp v145, v145, v145 row_ror:8 row_mask:0xf bank_mask:0xf
    v_mov_b32 v146, v144
    v_mov_b32 v147, v145
    s_nop 0
    v_permlane16_swap_b32 v144, v146
    v_permlane16_swap_b32 v145, v147
    v_pk_add_f32 v[144:145], v[144:145], v[146:147]
    v_cvt_pk_bf16_f32 v144, v144, v145
    v_mov_b32 v224, v144
    v_mov_b32 v226, v144
    v_mov_b32 v225, s4
    v_mov_b32 v227, s4
    v_permlane32_swap_b32 v224, v226
    v_add_u32 v228, s15, v2
    s_mov_b64 exec, 0xff
    s_cmp_lg_u32 s93, 0
    s_cbranch_scc1 LOC_20
    buffer_store_dwordx4 v[224:227], v2, s[32:35], s15 offen sc1
    s_branch LOCD_21
LOC_20:
    buffer_store_dwordx4 v[224:227], v2, s[32:35], s15 offen
LOCD_21:
    s_mov_b64 exec, -1
    s_cbranch_scc1 L_PC2
    s_barrier
    s_cmp_lg_u32 s3, 0
    s_cbranch_scc1 L_PC2
    v_mov_b32 v21, s4
    s_mov_b32 exec_hi, 0
    s_mov_b32 exec_lo, 65535
    buffer_store_dword v21, v75, s[32:35], s17 offen sc1
    s_mov_b64 exec, -1
L_PC2:
    s_lshl3_add_u32 s96, s11, s3
    s_lshl_b32 s97, s96, 11
    s_add_u32 s13, s97, 29360128
    s_waitcnt vmcnt(0)
    v_permlane32_swap_b32 v160, v162
    v_permlane32_swap_b32 v161, v163
    v_pk_add_f32 v[160:161], v[160:161], v[162:163]
    s_nop 1
    v_add_f32_dpp v160, v160, v160 row_ror:4 row_mask:0xf bank_mask:0xf
    v_add_f32_dpp v161, v161, v161 row_ror:4 row_mask:0xf bank_mask:0xf
    s_nop 0
    v_add_f32_dpp v160, v160, v160 row_ror:8 row_mask:0xf bank_mask:0xf
    v_add_f32_dpp v161, v161, v161 row_ror:8 row_mask:0xf bank_mask:0xf
    v_mov_b32 v162, v160
    v_mov_b32 v163, v161
    s_nop 0
    v_permlane16_swap_b32 v160, v162
    v_permlane16_swap_b32 v161, v163
    v_pk_add_f32 v[160:161], v[160:161], v[162:163]
    v_cvt_pk_bf16_f32 v160, v160, v161
    ds_write_b32 v6, v160
    s_cmp_lg_u32 s93, 0
    s_cbranch_scc1 L_C2L
SPOLL_22:
    s_load_dwordx2 s[24:25], s[32:33], s92 offset:3584 glc
SCHK_23:
    s_add_u32 s5, s5, 1
    s_cmp_ge_u32 s5, 300000
    s_waitcnt lgkmcnt(0)
    s_cbranch_scc1 SDONE_24
    s_cmp_lg_u32 s24, s4
    s_cbranch_scc1 SPOLL_22
    s_cmp_lg_u32 s25, s4
    s_cbranch_scc1 SPOLL_22
SDONE_24:
L_C2L:
    buffer_load_dwordx4 v[152:155], v2, s[32:35], s13 offen sc1
    buffer_load_dwordx4 v[156:159], v2, s[32:35], s13 offen offset:1024 sc1
    s_waitcnt vmcnt(0)
    v_bitop3_b32 v4, v153, v155, s4 bitop3:0x7e
    v_bitop3_b32 v4, v4, v157, s4 bitop3:0xf6
    v_bitop3_b32 v4, v4, v159, s4 bitop3:0xf6
    v_cmp_ne_u32 vcc, 0, v4
    s_cbranch_vccz TOK_26
POLL_27:
    buffer_load_dwordx4 v[152:155], v2, s[32:35], s13 offen sc1
    buffer_load_dwordx4 v[156:159], v2, s[32:35], s13 offen offset:1024 sc1
    s_waitcnt vmcnt(0)
    v_bitop3_b32 v4, v153, v155, s4 bitop3:0x7e
    v_bitop3_b32 v4, v4, v157, s4 bitop3:0xf6
    v_bitop3_b32 v4, v4, v159, s4 bitop3:0xf6
    v_cmp_ne_u32 vcc, 0, v4
    s_cbranch_vccz PDONE_28
    s_add_u32 s5, s5, 1
    s_cmp_lt_u32 s5, 300000
    s_cbranch_scc1 POLL_27
PDONE_28:
TOK_26:
    ds_write2_b32 v5, v152, v154 offset0:0 offset1:1
    ds_write2_b32 v5, v156, v158 offset0:64 offset1:65
    s_waitcnt lgkmcnt(0)
    s_barrier
    ds_read_b128 v[160:163], v7
    ds_read_b128 v[164:167], v7 offset:32
    ds_read_b128 v[168:171], v7 offset:64
    ds_read_b128 v[172:175], v7 offset:96
    ds_read_b128 v[144:147], v20
    ds_read_b128 v[148:151], v20 offset:1024
    ds_read_b128 v[152:155], v20 offset:2048
    ds_read_b128 v[156:159], v20 offset:3072
    s_waitcnt lgkmcnt(7)
    v_mfma_f32_32x32x16_bf16 v[128:143], v[160:163], v[80:83], 0
    s_waitcnt lgkmcnt(6)
    v_mfma_f32_32x32x16_bf16 v[128:143], v[164:167], v[84:87], v[128:143]
    s_waitcnt lgkmcnt(5)
    v_mfma_f32_32x32x16_bf16 v[128:143], v[168:171], v[88:91], v[128:143]
    s_waitcnt lgkmcnt(4)
    v_mfma_f32_32x32x16_bf16 v[128:143], v[172:175], v[92:95], v[128:143]
    s_waitcnt lgkmcnt(3)
    v_mfma_f32_32x32x16_bf16 v[112:127], v[144:147], v[80:83], 0
    s_waitcnt lgkmcnt(2)
    v_mfma_f32_32x32x16_bf16 v[112:127], v[148:151], v[84:87], v[112:127]
    s_waitcnt lgkmcnt(1)
    v_mfma_f32_32x32x16_bf16 v[112:127], v[152:155], v[88:91], v[112:127]
    s_waitcnt lgkmcnt(0)
    v_mfma_f32_32x32x16_bf16 v[112:127], v[156:159], v[92:95], v[112:127]
    s_lshl_b32 s96, s76, 6
    s_add_u32 s18, s96, 12288
    v_and_b32 v67, 7, v1
    v_lshl_add_u32 v67, v67, 2, s18
    v_lshrrev_b32 v9, 5, v1
    v_lshl_add_u32 v67, v9, 5, v67
    ds_read_b32 v64, v67
    ds_read_b32 v65, v67 offset:512
    ds_read_b32 v66, v67 offset:640
    ds_read_b32 v68, v67 offset:128
    ds_read_b32 v69, v67 offset:256
    ds_read_b32 v70, v67 offset:384
    ds_read_b32 v71, v67 offset:768
    s_add_u32 s96, s84, 1048576
    s_and_b32 s97, s96, 1048575
    s_lshl_b32 s98, s83, 16
    s_xor_b32 s99, s97, s98
    s_xor_b32 s96, s88, 1048576
    s_add_u32 s19, s99, s96
    s_add_u32 m0, s89, 98304
    s_nop 0
    buffer_load_dwordx4 v74, s[44:47], s19 offen lds
    s_add_u32 s96, s84, 1703936
    s_and_b32 s97, s96, 1048575
    s_lshl_b32 s98, s83, 16
    s_xor_b32 s99, s97, s98
    s_xor_b32 s96, s88, 1048576
    s_add_u32 s19, s99, s96
    s_add_u32 m0, s89, 139264
    s_nop 0
    buffer_load_dwordx4 v74, s[44:47], s19 offen lds
    s_add_u32 s96, s84, 1835008
    s_and_b32 s97, s96, 1048575
    s_lshl_b32 s98, s83, 16
    s_xor_b32 s99, s97, s98
    s_xor_b32 s96, s88, 1048576
    s_add_u32 s19, s99, s96
    s_add_u32 m0, s89, 147456
    s_nop 0
    buffer_load_dwordx4 v74, s[44:47], s19 offen lds
    s_and_b32 s96, s3, 3
    s_lshl2_add_u32 s97, s10, s96
    s_lshl4_add_u32 s98, s97, s11
    s_lshl1_add_u32 s99, s98, s76
    s_lshl_b32 s96, s99, 11
    s_add_u32 s13, s96, 8388608
    v_and_b32 v8, 15, v1
    v_lshlrev_b32 v8, 4, v8
    v_bfe_u32 v9, v1, 4, 1
    v_lshl_add_u32 v8, v9, 10, v8
    v_lshrrev_b32 v9, 5, v1
    v_lshl_add_u32 v8, v9, 8, v8
    v_cvt_pk_bf16_f32 v128, 0, v128
    v_add_f32 v128, 0x358637bd, v128
    v_cvt_pk_bf16_f32 v128, 0, v128
    v_rcp_f32 v128, v128
    v_cvt_pk_bf16_f32 v112, 0, v112
    v_cvt_pk_bf16_f32 v113, 0, v113
    v_cvt_pk_bf16_f32 v114, 0, v114
    v_cvt_pk_bf16_f32 v115, 0, v115
    v_cvt_pk_bf16_f32 v116, 0, v116
    v_cvt_pk_bf16_f32 v117, 0, v117
    v_cvt_pk_bf16_f32 v118, 0, v118
    v_cvt_pk_bf16_f32 v119, 0, v119
    v_pk_mul_f32 v[112:113], v[112:113], v[128:129] op_sel_hi:[1,0]
    v_pk_mul_f32 v[114:115], v[114:115], v[128:129] op_sel_hi:[1,0]
    v_pk_mul_f32 v[116:117], v[116:117], v[128:129] op_sel_hi:[1,0]
    v_pk_mul_f32 v[118:119], v[118:119], v[128:129] op_sel_hi:[1,0]
    v_cvt_pk_bf16_f32 v44, v112, v113
    v_cvt_pk_bf16_f32 v45, v114, v115
    v_cvt_pk_bf16_f32 v46, v116, v117
    v_cvt_pk_bf16_f32 v47, v118, v119
    buffer_store_dwordx4 v[44:47], v8, s[32:35], s13 offen sc1
    v_cvt_pk_bf16_f32 v120, 0, v120
    v_cvt_pk_bf16_f32 v121, 0, v121
    v_cvt_pk_bf16_f32 v122, 0, v122
    v_cvt_pk_bf16_f32 v123, 0, v123
    v_cvt_pk_bf16_f32 v124, 0, v124
    v_cvt_pk_bf16_f32 v125, 0, v125
    v_cvt_pk_bf16_f32 v126, 0, v126
    v_cvt_pk_bf16_f32 v127, 0, v127
    v_pk_mul_f32 v[120:121], v[120:121], v[128:129] op_sel_hi:[1,0]
    v_pk_mul_f32 v[122:123], v[122:123], v[128:129] op_sel_hi:[1,0]
    v_pk_mul_f32 v[124:125], v[124:125], v[128:129] op_sel_hi:[1,0]
    v_pk_mul_f32 v[126:127], v[126:127], v[128:129] op_sel_hi:[1,0]
    v_cvt_pk_bf16_f32 v48, v120, v121
    v_cvt_pk_bf16_f32 v49, v122, v123
    v_cvt_pk_bf16_f32 v50, v124, v125
    v_cvt_pk_bf16_f32 v51, v126, v127
    buffer_store_dwordx4 v[48:51], v8, s[32:35], s13 offen offset:512 sc1
    s_mul_i32 s96, s76, 65600
    s_add_u32 s17, s96, 32768
    v_lshrrev_b32 v20, 5, v1
    v_lshlrev_b32 v20, 11, v20
    v_bfe_u32 v9, v1, 4, 1
    v_lshl_add_u32 v20, v9, 9, v20
    v_bfe_u32 v9, v1, 2, 2
    v_lshl_add_u32 v20, v9, 7, v20
    v_bfe_u32 v9, v1, 3, 1
    v_lshl_add_u32 v20, v9, 6, v20
    v_bfe_u32 v9, v1, 1, 1
    v_lshl_add_u32 v20, v9, 5, v20
    v_bfe_u32 v9, v1, 4, 1
    v_lshl_add_u32 v20, v9, 4, v20
    v_and_b32 v9, 1, v1
    v_lshl_add_u32 v20, v9, 3, v20
    v_xor_b32 v20, s17, v20
    v_xor_b32 v21, 16, v20
    v_xor_b32 v22, 64, v20
    v_xor_b32 v23, 80, v20
    v_and_b32 v5, 7, v1
    v_lshlrev_b32 v5, 15, v5
    v_bfe_u32 v9, v1, 3, 1
    v_lshl_add_u32 v5, v9, 12, v5
    s_lshr_b32 s96, s11, 2
    s_xor_b32 s97, s96, 1
    s_and_b32 s98, s97, 1
    s_lshr_b32 s99, s10, 2
    s_and_b32 s96, s10, 3
    s_lshl_b32 s97, s96, 6
    s_lshl1_add_u32 s96, s99, s97
    s_lshl_b32 s99, s96, 12
    s_lshr_b32 s97, s11, 3
    s_and_b32 s96, s11, 3
    s_lshl2_add_u32 s97, s97, s96
    s_lshl_b32 s96, s97, 6
    s_add_u32 s97, s99, s96
    s_lshl2_add_u32 s99, s98, s97
    s_add_u32 s96, s99, 1048576
    s_add_u32 s15, s96, 1024
    v_mov_b32 v52, 0x10000
    v_mov_b32 v53, s6
    v_lshlrev_b32 v28, 16, v12
    v_and_b32 v29, s6, v12
    v_lshlrev_b32 v30, 16, v13
    v_and_b32 v31, s6, v13
    v_lshlrev_b32 v32, 16, v14
    v_and_b32 v33, s6, v14
    v_lshlrev_b32 v34, 16, v15
    v_and_b32 v35, s6, v15
    v_lshlrev_b32 v36, 16, v16
    v_and_b32 v37, s6, v16
    v_lshlrev_b32 v38, 16, v17
    v_and_b32 v39, s6, v17
    v_lshlrev_b32 v40, 16, v18
    v_and_b32 v41, s6, v18
    v_lshlrev_b32 v42, 16, v19
    v_and_b32 v43, s6, v19
    s_waitcnt lgkmcnt(0)
    v_mul_u32_u24_dpp v76, v64, v52 row_newbcast:0 row_mask:0xf bank_mask:0xf
    v_and_b32_dpp v77, v64, v53 row_newbcast:0 row_mask:0xf bank_mask:0xf
    v_mul_u32_u24_dpp v78, v64, v52 row_newbcast:1 row_mask:0xf bank_mask:0xf
    v_and_b32_dpp v79, v64, v53 row_newbcast:1 row_mask:0xf bank_mask:0xf
    v_mul_u32_u24_dpp v80, v64, v52 row_newbcast:2 row_mask:0xf bank_mask:0xf
    v_and_b32_dpp v81, v64, v53 row_newbcast:2 row_mask:0xf bank_mask:0xf
    v_mul_u32_u24_dpp v82, v64, v52 row_newbcast:3 row_mask:0xf bank_mask:0xf
    v_and_b32_dpp v83, v64, v53 row_newbcast:3 row_mask:0xf bank_mask:0xf
    v_mul_u32_u24_dpp v84, v64, v52 row_newbcast:4 row_mask:0xf bank_mask:0xf
    v_and_b32_dpp v85, v64, v53 row_newbcast:4 row_mask:0xf bank_mask:0xf
    v_mul_u32_u24_dpp v86, v64, v52 row_newbcast:5 row_mask:0xf bank_mask:0xf
    v_and_b32_dpp v87, v64, v53 row_newbcast:5 row_mask:0xf bank_mask:0xf
    v_mul_u32_u24_dpp v88, v64, v52 row_newbcast:6 row_mask:0xf bank_mask:0xf
    v_and_b32_dpp v89, v64, v53 row_newbcast:6 row_mask:0xf bank_mask:0xf
    v_mul_u32_u24_dpp v90, v64, v52 row_newbcast:7 row_mask:0xf bank_mask:0xf
    v_and_b32_dpp v91, v64, v53 row_newbcast:7 row_mask:0xf bank_mask:0xf
    s_lshl1_add_u32 s96, s94, s77
    s_lshl_b32 s97, s96, 15
    s_add_u32 s19, s97, 8388608
    v_and_b32 v25, 15, v1
    v_lshlrev_b32 v25, 6, v25
    s_waitcnt vmcnt(0)
    s_waitcnt lgkmcnt(0)
    s_barrier
    s_cmp_lg_u32 s3, 0
    s_cbranch_scc1 L_PD
    v_mov_b32 v6, s4
    s_mov_b32 exec_hi, 0
    s_mov_b32 exec_lo, 65535
    buffer_store_dword v6, v5, s[32:35], s15 offen sc1
    s_mov_b64 exec, -1
L_PD:
    s_add_u32 s96, s84, 1966080
    s_and_b32 s97, s96, 1048575
    s_lshl_b32 s98, s83, 16
    s_xor_b32 s99, s97, s98
    s_xor_b32 s96, s88, 1048576
    s_add_u32 s13, s99, s96
    s_add_u32 m0, s89, 155648
    s_nop 0
    buffer_load_dwordx4 v74, s[44:47], s13 offen lds
    s_and_b32 s96, s84, 1048575
    s_lshl_b32 s97, s83, 16
    s_xor_b32 s98, s96, s97
    s_add_u32 s13, s98, s88
    s_add_u32 m0, s89, 32768
    s_nop 0
    buffer_load_dwordx4 v74, s[44:47], s13 offen lds
    s_add_u32 s96, s84, 131072
    s_and_b32 s97, s96, 1048575
    s_lshl_b32 s98, s83, 16
    s_xor_b32 s99, s97, s98
    s_add_u32 s13, s99, s88
    s_add_u32 m0, s89, 40960
    s_nop 0
    buffer_load_dwordx4 v74, s[44:47], s13 offen lds
    s_load_dwordx2 s[24:25], s[32:33], s92 offset:1024 glc
    v_mov_b32_dpp v92, v65 row_newbcast:0 row_mask:0xf bank_mask:0xf
    v_mov_b32_dpp v93, v65 row_newbcast:1 row_mask:0xf bank_mask:0xf
    v_mov_b32_dpp v94, v65 row_newbcast:2 row_mask:0xf bank_mask:0xf
    v_mov_b32_dpp v95, v65 row_newbcast:3 row_mask:0xf bank_mask:0xf
    v_mov_b32_dpp v96, v65 row_newbcast:4 row_mask:0xf bank_mask:0xf
    v_mov_b32_dpp v97, v65 row_newbcast:5 row_mask:0xf bank_mask:0xf
    v_mov_b32_dpp v98, v65 row_newbcast:6 row_mask:0xf bank_mask:0xf
    v_mov_b32_dpp v99, v65 row_newbcast:7 row_mask:0xf bank_mask:0xf
    v_mov_b32_dpp v100, v66 row_newbcast:0 row_mask:0xf bank_mask:0xf
    v_mov_b32_dpp v101, v66 row_newbcast:1 row_mask:0xf bank_mask:0xf
    v_mov_b32_dpp v102, v66 row_newbcast:2 row_mask:0xf bank_mask:0xf
    v_mov_b32_dpp v103, v66 row_newbcast:3 row_mask:0xf bank_mask:0xf
    v_mov_b32_dpp v104, v66 row_newbcast:4 row_mask:0xf bank_mask:0xf
    v_mov_b32_dpp v105, v66 row_newbcast:5 row_mask:0xf bank_mask:0xf
    v_mov_b32_dpp v106, v66 row_newbcast:6 row_mask:0xf bank_mask:0xf
    v_mov_b32_dpp v107, v66 row_newbcast:7 row_mask:0xf bank_mask:0xf
    v_and_b32 v4, 3, v1
    v_cmp_eq_u32 vcc, 1, v4
    v_cmp_eq_u32 s[22:23], 0, v4
    v_mov_b32 v5, 0x3f803f80
    v_cndmask_b32 v92, v100, v92, vcc
    v_cndmask_b32 v93, v101, v93, vcc
    v_cndmask_b32 v94, v102, v94, vcc
    v_cndmask_b32 v95, v103, v95, vcc
    v_cndmask_b32 v96, v104, v96, vcc
    v_cndmask_b32 v97, v105, v97, vcc
    v_cndmask_b32 v98, v106, v98, vcc
    v_cndmask_b32 v99, v107, v99, vcc
    v_cndmask_b32 v92, v92, v5, s[22:23]
    v_cndmask_b32 v93, v93, v5, s[22:23]
    v_cndmask_b32 v94, v94, v5, s[22:23]
    v_cndmask_b32 v95, v95, v5, s[22:23]
    v_cndmask_b32 v96, v96, v5, s[22:23]
    v_cndmask_b32 v97, v97, v5, s[22:23]
    v_cndmask_b32 v98, v98, v5, s[22:23]
    v_cndmask_b32 v99, v99, v5, s[22:23]
    s_lshl_b32 s13, s3, 12
    v_add_u32 v4, s13, v2
    s_xor_b32 s96, s3, 4
    s_lshl_b32 s13, s96, 12
    v_and_b32 v5, 15, v1
    v_lshl_add_u32 v5, v5, 4, s13
    v_bfe_u32 v9, v1, 4, 1
    v_lshl_add_u32 v5, v9, 10, v5
    v_lshrrev_b32 v9, 5, v1
    v_lshl_add_u32 v5, v9, 9, v5
    s_lshl_b32 s96, s76, 11
    s_and_b32 s97, s3, 3
    s_lshl_b32 s98, s97, 9
    s_add_u32 s99, s96, s98
    s_add_u32 s13, s99, 131072
    v_and_b32 v6, 31, v1
    v_lshl_add_u32 v6, v6, 4, s13
    v_lshrrev_b32 v9, 5, v1
    v_lshl_add_u32 v6, v9, 3, v6
    s_lshl_b32 s96, s76, 6
    s_add_u32 s13, s96, 139008
    v_and_b32 v7, 7, v1
    v_lshl_add_u32 v7, v7, 2, s13
    v_lshrrev_b32 v9, 5, v1
    v_lshl_add_u32 v7, v9, 5, v7
    v_add_u32 v8, 131072, v2
    v_and_b32 v10, 7, v1
    v_lshlrev_b32 v10, 15, v10
    v_bfe_u32 v9, v1, 3, 1
    v_lshl_add_u32 v10, v9, 12, v10
    s_lshl_b32 s96, s21, 15
    s_lshl_b32 s97, s3, 8
    s_add_u32 s98, s96, s97
    s_add_u32 s17, s98, 12582912
    v_and_b32 v44, 15, v1
    v_lshlrev_b32 v44, 4, v44
    v_lshrrev_b32 v9, 4, v1
    v_lshl_add_u32 v44, v9, 11, v44
    s_lshl4_add_u32 s96, s21, s12
    s_lshl_b32 s97, s96, 11
    s_add_u32 s14, s97, 12582912
    s_and_b32 s96, s12, 1
    s_lshr_b32 s97, s21, 2
    s_and_b32 s98, s21, 3
    s_lshl_b32 s99, s98, 6
    s_lshl1_add_u32 s98, s97, s99
    s_lshl_b32 s97, s98, 12
    s_lshr_b32 s99, s12, 1
    s_lshl_b32 s98, s99, 6
    s_add_u32 s99, s97, s98
    s_lshl2_add_u32 s97, s96, s99
    s_add_u32 s98, s97, 1048576
    s_add_u32 s16, s98, 1536
    s_waitcnt vmcnt(0)
    s_branch SCHK_30
SPOLL_29:
    s_load_dwordx2 s[24:25], s[32:33], s92 offset:1024 glc
SCHK_30:
    s_add_u32 s5, s5, 1
    s_cmp_ge_u32 s5, 300000
    s_waitcnt lgkmcnt(0)
    s_cbranch_scc1 SDONE_31
    s_cmp_lg_u32 s24, s4
    s_cbranch_scc1 SPOLL_29
SDONE_31:
    s_barrier
    s_cmp_lt_u32 s3, 4
    s_cbranch_scc1 L_P2
    s_setprio 1
L_P2:
    s_lshl_b32 s96, s21, 10
    s_add_u32 s18, s96, 65536
    s_lshl_b32 s96, s83, 11
    s_add_u32 s20, s96, s19
    buffer_load_dwordx4 v[140:143], v2, s[32:35], s20 offen sc1
    buffer_load_dwordx4 v[144:147], v2, s[32:35], s20 offen offset:1024 sc1
    ds_read_b64_tr_b16 v[232:233], v22
    ds_read_b64_tr_b16 v[234:235], v22 offset:1024
    ds_read_b64_tr_b16 v[236:237], v23
    ds_read_b64_tr_b16 v[238:239], v23 offset:1024
    ds_read_b64_tr_b16 v[240:241], v20
    ds_read_b64_tr_b16 v[242:243], v20 offset:1024
    ds_read_b64_tr_b16 v[244:245], v21
    ds_read_b64_tr_b16 v[246:247], v21 offset:1024
    s_xor_b32 s96, s83, 1
    s_lshl_b32 s97, s96, 11
    s_add_u32 s20, s97, s19
    buffer_load_dwordx4 v[148:151], v2, s[32:35], s20 offen sc1
    buffer_load_dwordx4 v[152:155], v2, s[32:35], s20 offen offset:1024 sc1
    s_xor_b32 s96, s83, 2
    s_lshl_b32 s97, s96, 11
    s_add_u32 s20, s97, s19
    buffer_load_dwordx4 v[156:159], v2, s[32:35], s20 offen sc1
    buffer_load_dwordx4 v[160:163], v2, s[32:35], s20 offen offset:1024 sc1
    s_waitcnt lgkmcnt(6)
    s_waitcnt vmcnt(5)
    v_mfma_f32_16x16x32_bf16 v[124:127], v[232:235], v[140:143], 0
    ds_read_b64_tr_b16 v[248:249], v22 offset:4096
    s_waitcnt vmcnt(4)
    v_mfma_f32_16x16x32_bf16 v[128:131], v[232:235], v[144:147], 0
    ds_read_b64_tr_b16 v[250:251], v22 offset:5120
    s_xor_b32 s96, s83, 3
    s_lshl_b32 s97, s96, 11
    s_add_u32 s20, s97, s19
    buffer_load_dwordx4 v[164:167], v2, s[32:35], s20 offen sc1
    s_waitcnt lgkmcnt(6)
    v_mfma_f32_16x16x32_bf16 v[132:135], v[236:239], v[140:143], 0
    ds_read_b64_tr_b16 v[232:233], v23 offset:4096
    v_mfma_f32_16x16x32_bf16 v[136:139], v[236:239], v[144:147], 0
    ds_read_b64_tr_b16 v[234:235], v23 offset:5120
    buffer_load_dwordx4 v[168:171], v2, s[32:35], s20 offen offset:1024 sc1
    s_waitcnt lgkmcnt(6)
    v_mfma_f32_16x16x32_bf16 v[108:111], v[240:243], v[140:143], 0
    ds_read_b64_tr_b16 v[236:237], v20 offset:4096
    v_mfma_f32_16x16x32_bf16 v[112:115], v[240:243], v[144:147], 0
    ds_read_b64_tr_b16 v[238:239], v20 offset:5120
    s_waitcnt lgkmcnt(6)
    v_mfma_f32_16x16x32_bf16 v[116:119], v[244:247], v[140:143], 0
    ds_read_b64_tr_b16 v[240:241], v21 offset:4096
    v_mfma_f32_16x16x32_bf16 v[120:123], v[244:247], v[144:147], 0
    ds_read_b64_tr_b16 v[242:243], v21 offset:5120
    s_waitcnt lgkmcnt(6)
    s_waitcnt vmcnt(4)
    v_mfma_f32_16x16x32_bf16 v[124:127], v[248:251], v[148:151], v[124:127]
    ds_read_b64_tr_b16 v[244:245], v22 offset:8192
    v_mfma_f32_16x16x32_bf16 v[128:131], v[248:251], v[152:155], v[128:131]
    ds_read_b64_tr_b16 v[246:247], v22 offset:9216
    s_xor_b32 s96, s83, 4
    s_lshl_b32 s97, s96, 11
    s_add_u32 s20, s97, s19
    buffer_load_dwordx4 v[140:143], v2, s[32:35], s20 offen sc1
    s_waitcnt lgkmcnt(6)
    v_mfma_f32_16x16x32_bf16 v[132:135], v[232:235], v[148:151], v[132:135]
    ds_read_b64_tr_b16 v[248:249], v23 offset:8192
    v_mfma_f32_16x16x32_bf16 v[136:139], v[232:235], v[152:155], v[136:139]
    ds_read_b64_tr_b16 v[250:251], v23 offset:9216
    buffer_load_dwordx4 v[144:147], v2, s[32:35], s20 offen offset:1024 sc1
    s_waitcnt lgkmcnt(6)
    v_mfma_f32_16x16x32_bf16 v[108:111], v[236:239], v[148:151], v[108:111]
    ds_read_b64_tr_b16 v[232:233], v20 offset:8192
    v_mfma_f32_16x16x32_bf16 v[112:115], v[236:239], v[152:155], v[112:115]
    ds_read_b64_tr_b16 v[234:235], v20 offset:9216
    s_waitcnt lgkmcnt(6)
    v_mfma_f32_16x16x32_bf16 v[116:119], v[240:243], v[148:151], v[116:119]
    ds_read_b64_tr_b16 v[236:237], v21 offset:8192
    v_mfma_f32_16x16x32_bf16 v[120:123], v[240:243], v[152:155], v[120:123]
    ds_read_b64_tr_b16 v[238:239], v21 offset:9216
    s_waitcnt lgkmcnt(6)
    s_waitcnt vmcnt(4)
    v_mfma_f32_16x16x32_bf16 v[124:127], v[244:247], v[156:159], v[124:127]
    ds_read_b64_tr_b16 v[240:241], v22 offset:12288
    v_mfma_f32_16x16x32_bf16 v[128:131], v[244:247], v[160:163], v[128:131]
    ds_read_b64_tr_b16 v[242:243], v22 offset:13312
    s_xor_b32 s96, s83, 5
    s_lshl_b32 s97, s96, 11
    s_add_u32 s20, s97, s19
    buffer_load_dwordx4 v[148:151], v2, s[32:35], s20 offen sc1
    s_waitcnt lgkmcnt(6)
    v_mfma_f32_16x16x32_bf16 v[132:135], v[248:251], v[156:159], v[132:135]
    ds_read_b64_tr_b16 v[244:245], v23 offset:12288
    v_mfma_f32_16x16x32_bf16 v[136:139], v[248:251], v[160:163], v[136:139]
    ds_read_b64_tr_b16 v[246:247], v23 offset:13312
    buffer_load_dwordx4 v[152:155], v2, s[32:35], s20 offen offset:1024 sc1
    s_waitcnt lgkmcnt(6)
    v_mfma_f32_16x16x32_bf16 v[108:111], v[232:235], v[156:159], v[108:111]
    ds_read_b64_tr_b16 v[248:249], v20 offset:12288
    v_mfma_f32_16x16x32_bf16 v[112:115], v[232:235], v[160:163], v[112:115]
    ds_read_b64_tr_b16 v[250:251], v20 offset:13312
    s_waitcnt lgkmcnt(6)
    v_mfma_f32_16x16x32_bf16 v[116:119], v[236:239], v[156:159], v[116:119]
    ds_read_b64_tr_b16 v[232:233], v21 offset:12288
    v_mfma_f32_16x16x32_bf16 v[120:123], v[236:239], v[160:163], v[120:123]
    ds_read_b64_tr_b16 v[234:235], v21 offset:13312
    s_waitcnt lgkmcnt(6)
    s_waitcnt vmcnt(4)
    v_mfma_f32_16x16x32_bf16 v[124:127], v[240:243], v[164:167], v[124:127]
    ds_read_b64_tr_b16 v[236:237], v22 offset:16384
    v_mfma_f32_16x16x32_bf16 v[128:131], v[240:243], v[168:171], v[128:131]
    ds_read_b64_tr_b16 v[238:239], v22 offset:17408
    s_xor_b32 s96, s83, 6
    s_lshl_b32 s97, s96, 11
    s_add_u32 s20, s97, s19
    buffer_load_dwordx4 v[156:159], v2, s[32:35], s20 offen sc1
    s_waitcnt lgkmcnt(6)
    v_mfma_f32_16x16x32_bf16 v[132:135], v[244:247], v[164:167], v[132:135]
    ds_read_b64_tr_b16 v[240:241], v23 offset:16384
    v_mfma_f32_16x16x32_bf16 v[136:139], v[244:247], v[168:171], v[136:139]
    ds_read_b64_tr_b16 v[242:243], v23 offset:17408
    buffer_load_dwordx4 v[160:163], v2, s[32:35], s20 offen offset:1024 sc1
    s_waitcnt lgkmcnt(6)
    v_mfma_f32_16x16x32_bf16 v[108:111], v[248:251], v[164:167], v[108:111]
    ds_read_b64_tr_b16 v[244:245], v20 offset:16384
    v_mfma_f32_16x16x32_bf16 v[112:115], v[248:251], v[168:171], v[112:115]
    ds_read_b64_tr_b16 v[246:247], v20 offset:17408
    s_waitcnt lgkmcnt(6)
    v_mfma_f32_16x16x32_bf16 v[116:119], v[232:235], v[164:167], v[116:119]
    ds_read_b64_tr_b16 v[248:249], v21 offset:16384
    v_mfma_f32_16x16x32_bf16 v[120:123], v[232:235], v[168:171], v[120:123]
    ds_read_b64_tr_b16 v[250:251], v21 offset:17408
    s_waitcnt lgkmcnt(6)
    s_waitcnt vmcnt(4)
    v_mfma_f32_16x16x32_bf16 v[124:127], v[236:239], v[140:143], v[124:127]
    ds_read_b64_tr_b16 v[232:233], v22 offset:20480
    v_mfma_f32_16x16x32_bf16 v[128:131], v[236:239], v[144:147], v[128:131]
    ds_read_b64_tr_b16 v[234:235], v22 offset:21504
    s_xor_b32 s96, s83, 7
    s_lshl_b32 s97, s96, 11
    s_add_u32 s20, s97, s19
    buffer_load_dwordx4 v[164:167], v2, s[32:35], s20 offen sc1
    s_waitcnt lgkmcnt(6)
    v_mfma_f32_16x16x32_bf16 v[132:135], v[240:243], v[140:143], v[132:135]
    ds_read_b64_tr_b16 v[236:237], v23 offset:20480
    v_mfma_f32_16x16x32_bf16 v[136:139], v[240:243], v[144:147], v[136:139]
    ds_read_b64_tr_b16 v[238:239], v23 offset:21504
    buffer_load_dwordx4 v[168:171], v2, s[32:35], s20 offen offset:1024 sc1
    s_waitcnt lgkmcnt(6)
    v_mfma_f32_16x16x32_bf16 v[108:111], v[244:247], v[140:143], v[108:111]
    ds_read_b64_tr_b16 v[240:241], v20 offset:20480
    v_mfma_f32_16x16x32_bf16 v[112:115], v[244:247], v[144:147], v[112:115]
    ds_read_b64_tr_b16 v[242:243], v20 offset:21504
    s_setprio 0
    s_waitcnt lgkmcnt(6)
    v_mfma_f32_16x16x32_bf16 v[116:119], v[248:251], v[140:143], v[116:119]
    ds_read_b64_tr_b16 v[244:245], v21 offset:20480
    v_mfma_f32_16x16x32_bf16 v[120:123], v[248:251], v[144:147], v[120:123]
    ds_read_b64_tr_b16 v[246:247], v21 offset:21504
    s_waitcnt lgkmcnt(6)
    s_waitcnt vmcnt(4)
    v_mfma_f32_16x16x32_bf16 v[124:127], v[232:235], v[148:151], v[124:127]
    ds_read_b64_tr_b16 v[248:249], v22 offset:24576
    v_mfma_f32_16x16x32_bf16 v[128:131], v[232:235], v[152:155], v[128:131]
    ds_read_b64_tr_b16 v[250:251], v22 offset:25600
    s_cmp_eq_u32 s25, s4
    s_cbranch_scc1 L_D2
SPOLL_32:
    s_load_dwordx2 s[24:25], s[32:33], s92 offset:1024 glc
SCHK_33:
    s_add_u32 s5, s5, 1
    s_cmp_ge_u32 s5, 300000
    s_waitcnt lgkmcnt(0)
    s_cbranch_scc1 SDONE_34
    s_cmp_lg_u32 s25, s4
    s_cbranch_scc1 SPOLL_32
SDONE_34:
L_D2:
    s_barrier
    s_xor_b32 s96, s83, 8
    s_lshl_b32 s97, s96, 11
    s_add_u32 s20, s97, s19
    buffer_load_dwordx4 v[140:143], v2, s[32:35], s20 offen sc1
    s_waitcnt lgkmcnt(6)
    v_mfma_f32_16x16x32_bf16 v[132:135], v[236:239], v[148:151], v[132:135]
    ds_read_b64_tr_b16 v[232:233], v23 offset:24576
    v_mfma_f32_16x16x32_bf16 v[136:139], v[236:239], v[152:155], v[136:139]
    ds_read_b64_tr_b16 v[234:235], v23 offset:25600
    buffer_load_dwordx4 v[144:147], v2, s[32:35], s20 offen offset:1024 sc1
    s_waitcnt lgkmcnt(6)
    v_mfma_f32_16x16x32_bf16 v[108:111], v[240:243], v[148:151], v[108:111]
    ds_read_b64_tr_b16 v[236:237], v20 offset:24576
    v_mfma_f32_16x16x32_bf16 v[112:115], v[240:243], v[152:155], v[112:115]
    ds_read_b64_tr_b16 v[238:239], v20 offset:25600
    s_waitcnt lgkmcnt(6)
    v_mfma_f32_16x16x32_bf16 v[116:119], v[244:247], v[148:151], v[116:119]
    ds_read_b64_tr_b16 v[240:241], v21 offset:24576
    v_mfma_f32_16x16x32_bf16 v[120:123], v[244:247], v[152:155], v[120:123]
    ds_read_b64_tr_b16 v[242:243], v21 offset:25600
    s_waitcnt lgkmcnt(6)
    s_waitcnt vmcnt(4)
    v_mfma_f32_16x16x32_bf16 v[124:127], v[248:251], v[156:159], v[124:127]
    ds_read_b64_tr_b16 v[244:245], v22 offset:28672
    v_mfma_f32_16x16x32_bf16 v[128:131], v[248:251], v[160:163], v[128:131]
    ds_read_b64_tr_b16 v[246:247], v22 offset:29696
    s_xor_b32 s96, s83, 9
    s_lshl_b32 s97, s96, 11
    s_add_u32 s20, s97, s19
    buffer_load_dwordx4 v[148:151], v2, s[32:35], s20 offen sc1
    s_waitcnt lgkmcnt(6)
    v_mfma_f32_16x16x32_bf16 v[132:135], v[232:235], v[156:159], v[132:135]
    ds_read_b64_tr_b16 v[248:249], v23 offset:28672
    v_mfma_f32_16x16x32_bf16 v[136:139], v[232:235], v[160:163], v[136:139]
    ds_read_b64_tr_b16 v[250:251], v23 offset:29696
    buffer_load_dwordx4 v[152:155], v2, s[32:35], s20 offen offset:1024 sc1
    s_waitcnt lgkmcnt(6)
    v_mfma_f32_16x16x32_bf16 v[108:111], v[236:239], v[156:159], v[108:111]
    ds_read_b64_tr_b16 v[232:233], v20 offset:28672
    v_mfma_f32_16x16x32_bf16 v[112:115], v[236:239], v[160:163], v[112:115]
    ds_read_b64_tr_b16 v[234:235], v20 offset:29696
    s_waitcnt lgkmcnt(6)
    v_mfma_f32_16x16x32_bf16 v[116:119], v[240:243], v[156:159], v[116:119]
    ds_read_b64_tr_b16 v[236:237], v21 offset:28672
    v_mfma_f32_16x16x32_bf16 v[120:123], v[240:243], v[160:163], v[120:123]
    ds_read_b64_tr_b16 v[238:239], v21 offset:29696
    s_waitcnt lgkmcnt(6)
    s_waitcnt vmcnt(4)
    v_mfma_f32_16x16x32_bf16 v[124:127], v[244:247], v[164:167], v[124:127]
    ds_read_b64_tr_b16 v[240:241], v22 offset:32768
    v_mfma_f32_16x16x32_bf16 v[128:131], v[244:247], v[168:171], v[128:131]
    ds_read_b64_tr_b16 v[242:243], v22 offset:33792
    s_xor_b32 s96, s83, 10
    s_lshl_b32 s97, s96, 11
    s_add_u32 s20, s97, s19
    buffer_load_dwordx4 v[156:159], v2, s[32:35], s20 offen sc1
    s_waitcnt lgkmcnt(6)
    v_mfma_f32_16x16x32_bf16 v[132:135], v[248:251], v[164:167], v[132:135]
    ds_read_b64_tr_b16 v[244:245], v23 offset:32768
    v_mfma_f32_16x16x32_bf16 v[136:139], v[248:251], v[168:171], v[136:139]
    ds_read_b64_tr_b16 v[246:247], v23 offset:33792
    buffer_load_dwordx4 v[160:163], v2, s[32:35], s20 offen offset:1024 sc1
    s_waitcnt lgkmcnt(6)
    v_mfma_f32_16x16x32_bf16 v[108:111], v[232:235], v[164:167], v[108:111]
    ds_read_b64_tr_b16 v[248:249], v20 offset:32768
    v_mfma_f32_16x16x32_bf16 v[112:115], v[232:235], v[168:171], v[112:115]
    ds_read_b64_tr_b16 v[250:251], v20 offset:33792
    s_waitcnt lgkmcnt(6)
    v_mfma_f32_16x16x32_bf16 v[116:119], v[236:239], v[164:167], v[116:119]
    ds_read_b64_tr_b16 v[232:233], v21 offset:32768
    v_mfma_f32_16x16x32_bf16 v[120:123], v[236:239], v[168:171], v[120:123]
    ds_read_b64_tr_b16 v[234:235], v21 offset:33792
    s_waitcnt lgkmcnt(6)
    s_waitcnt vmcnt(4)
    v_mfma_f32_16x16x32_bf16 v[124:127], v[240:243], v[140:143], v[124:127]
    ds_read_b64_tr_b16 v[236:237], v22 offset:36864
    v_mfma_f32_16x16x32_bf16 v[128:131], v[240:243], v[144:147], v[128:131]
    ds_read_b64_tr_b16 v[238:239], v22 offset:37888
    s_xor_b32 s96, s83, 11
    s_lshl_b32 s97, s96, 11
    s_add_u32 s20, s97, s19
    buffer_load_dwordx4 v[164:167], v2, s[32:35], s20 offen sc1
    s_waitcnt lgkmcnt(6)
    v_mfma_f32_16x16x32_bf16 v[132:135], v[244:247], v[140:143], v[132:135]
    ds_read_b64_tr_b16 v[240:241], v23 offset:36864
    v_mfma_f32_16x16x32_bf16 v[136:139], v[244:247], v[144:147], v[136:139]
    ds_read_b64_tr_b16 v[242:243], v23 offset:37888
    buffer_load_dwordx4 v[168:171], v2, s[32:35], s20 offen offset:1024 sc1
    s_waitcnt lgkmcnt(6)
    v_mfma_f32_16x16x32_bf16 v[108:111], v[248:251], v[140:143], v[108:111]
    ds_read_b64_tr_b16 v[244:245], v20 offset:36864
    v_mfma_f32_16x16x32_bf16 v[112:115], v[248:251], v[144:147], v[112:115]
    ds_read_b64_tr_b16 v[246:247], v20 offset:37888
    s_waitcnt lgkmcnt(6)
    v_mfma_f32_16x16x32_bf16 v[116:119], v[232:235], v[140:143], v[116:119]
    ds_read_b64_tr_b16 v[248:249], v21 offset:36864
    v_mfma_f32_16x16x32_bf16 v[120:123], v[232:235], v[144:147], v[120:123]
    ds_read_b64_tr_b16 v[250:251], v21 offset:37888
    s_waitcnt lgkmcnt(6)
    s_waitcnt vmcnt(4)
    v_mfma_f32_16x16x32_bf16 v[124:127], v[236:239], v[148:151], v[124:127]
    ds_read_b64_tr_b16 v[232:233], v22 offset:40960
    v_mfma_f32_16x16x32_bf16 v[128:131], v[236:239], v[152:155], v[128:131]
    ds_read_b64_tr_b16 v[234:235], v22 offset:41984
    s_xor_b32 s96, s83, 12
    s_lshl_b32 s97, s96, 11
    s_add_u32 s20, s97, s19
    buffer_load_dwordx4 v[140:143], v2, s[32:35], s20 offen sc1
    s_waitcnt lgkmcnt(6)
    v_mfma_f32_16x16x32_bf16 v[132:135], v[240:243], v[148:151], v[132:135]
    ds_read_b64_tr_b16 v[236:237], v23 offset:40960
    v_mfma_f32_16x16x32_bf16 v[136:139], v[240:243], v[152:155], v[136:139]
    ds_read_b64_tr_b16 v[238:239], v23 offset:41984
    buffer_load_dwordx4 v[144:147], v2, s[32:35], s20 offen offset:1024 sc1
    s_waitcnt lgkmcnt(6)
    v_mfma_f32_16x16x32_bf16 v[108:111], v[244:247], v[148:151], v[108:111]
    ds_read_b64_tr_b16 v[240:241], v20 offset:40960
    v_mfma_f32_16x16x32_bf16 v[112:115], v[244:247], v[152:155], v[112:115]
    ds_read_b64_tr_b16 v[242:243], v20 offset:41984
    s_waitcnt lgkmcnt(6)
    v_mfma_f32_16x16x32_bf16 v[116:119], v[248:251], v[148:151], v[116:119]
    ds_read_b64_tr_b16 v[244:245], v21 offset:40960
    v_mfma_f32_16x16x32_bf16 v[120:123], v[248:251], v[152:155], v[120:123]
    ds_read_b64_tr_b16 v[246:247], v21 offset:41984
    s_waitcnt lgkmcnt(6)
    s_waitcnt vmcnt(4)
    v_mfma_f32_16x16x32_bf16 v[124:127], v[232:235], v[156:159], v[124:127]
    ds_read_b64_tr_b16 v[248:249], v22 offset:45056
    v_mfma_f32_16x16x32_bf16 v[128:131], v[232:235], v[160:163], v[128:131]
    ds_read_b64_tr_b16 v[250:251], v22 offset:46080
    s_xor_b32 s96, s83, 13
    s_lshl_b32 s97, s96, 11
    s_add_u32 s20, s97, s19
    buffer_load_dwordx4 v[148:151], v2, s[32:35], s20 offen sc1
    s_waitcnt lgkmcnt(6)
    v_mfma_f32_16x16x32_bf16 v[132:135], v[236:239], v[156:159], v[132:135]
    ds_read_b64_tr_b16 v[232:233], v23 offset:45056
    v_mfma_f32_16x16x32_bf16 v[136:139], v[236:239], v[160:163], v[136:139]
    ds_read_b64_tr_b16 v[234:235], v23 offset:46080
    buffer_load_dwordx4 v[152:155], v2, s[32:35], s20 offen offset:1024 sc1
    s_waitcnt lgkmcnt(6)
    v_mfma_f32_16x16x32_bf16 v[108:111], v[240:243], v[156:159], v[108:111]
    ds_read_b64_tr_b16 v[236:237], v20 offset:45056
    v_mfma_f32_16x16x32_bf16 v[112:115], v[240:243], v[160:163], v[112:115]
    ds_read_b64_tr_b16 v[238:239], v20 offset:46080
    s_waitcnt lgkmcnt(6)
    v_mfma_f32_16x16x32_bf16 v[116:119], v[244:247], v[156:159], v[116:119]
    ds_read_b64_tr_b16 v[240:241], v21 offset:45056
    v_mfma_f32_16x16x32_bf16 v[120:123], v[244:247], v[160:163], v[120:123]
    ds_read_b64_tr_b16 v[242:243], v21 offset:46080
    s_waitcnt lgkmcnt(6)
    s_waitcnt vmcnt(4)
    v_mfma_f32_16x16x32_bf16 v[124:127], v[248:251], v[164:167], v[124:127]
    ds_read_b64_tr_b16 v[244:245], v22 offset:49152
    v_mfma_f32_16x16x32_bf16 v[128:131], v[248:251], v[168:171], v[128:131]
    ds_read_b64_tr_b16 v[246:247], v22 offset:50176
    s_xor_b32 s96, s83, 14
    s_lshl_b32 s97, s96, 11
    s_add_u32 s20, s97, s19
    buffer_load_dwordx4 v[156:159], v2, s[32:35], s20 offen sc1
    s_waitcnt lgkmcnt(6)
    v_mfma_f32_16x16x32_bf16 v[132:135], v[232:235], v[164:167], v[132:135]
    ds_read_b64_tr_b16 v[248:249], v23 offset:49152
    v_mfma_f32_16x16x32_bf16 v[136:139], v[232:235], v[168:171], v[136:139]
    ds_read_b64_tr_b16 v[250:251], v23 offset:50176
    buffer_load_dwordx4 v[160:163], v2, s[32:35], s20 offen offset:1024 sc1
    s_waitcnt lgkmcnt(6)
    v_mfma_f32_16x16x32_bf16 v[108:111], v[236:239], v[164:167], v[108:111]
    ds_read_b64_tr_b16 v[232:233], v20 offset:49152
    v_mfma_f32_16x16x32_bf16 v[112:115], v[236:239], v[168:171], v[112:115]
    ds_read_b64_tr_b16 v[234:235], v20 offset:50176
    s_waitcnt lgkmcnt(6)
    v_mfma_f32_16x16x32_bf16 v[116:119], v[240:243], v[164:167], v[116:119]
    ds_read_b64_tr_b16 v[236:237], v21 offset:49152
    v_mfma_f32_16x16x32_bf16 v[120:123], v[240:243], v[168:171], v[120:123]
    ds_read_b64_tr_b16 v[238:239], v21 offset:50176
    s_waitcnt lgkmcnt(6)
    s_waitcnt vmcnt(4)
    v_mfma_f32_16x16x32_bf16 v[124:127], v[244:247], v[140:143], v[124:127]
    ds_read_b64_tr_b16 v[240:241], v22 offset:53248
    v_mfma_f32_16x16x32_bf16 v[128:131], v[244:247], v[144:147], v[128:131]
    ds_read_b64_tr_b16 v[242:243], v22 offset:54272
    s_xor_b32 s96, s83, 15
    s_lshl_b32 s97, s96, 11
    s_add_u32 s20, s97, s19
    buffer_load_dwordx4 v[164:167], v2, s[32:35], s20 offen sc1
    s_waitcnt lgkmcnt(6)
    v_mfma_f32_16x16x32_bf16 v[132:135], v[248:251], v[140:143], v[132:135]
    ds_read_b64_tr_b16 v[244:245], v23 offset:53248
    v_mfma_f32_16x16x32_bf16 v[136:139], v[248:251], v[144:147], v[136:139]
    ds_read_b64_tr_b16 v[246:247], v23 offset:54272
    buffer_load_dwordx4 v[168:171], v2, s[32:35], s20 offen offset:1024 sc1
    buffer_load_dwordx2 v[26:27], v25, s[32:35], s18 offen sc1
    s_waitcnt lgkmcnt(6)
    v_mfma_f32_16x16x32_bf16 v[108:111], v[232:235], v[140:143], v[108:111]
    ds_read_b64_tr_b16 v[248:249], v20 offset:53248
    v_mfma_f32_16x16x32_bf16 v[112:115], v[232:235], v[144:147], v[112:115]
    ds_read_b64_tr_b16 v[250:251], v20 offset:54272
    s_waitcnt lgkmcnt(6)
    v_mfma_f32_16x16x32_bf16 v[116:119], v[236:239], v[140:143], v[116:119]
    ds_read_b64_tr_b16 v[232:233], v21 offset:53248
    v_mfma_f32_16x16x32_bf16 v[120:123], v[236:239], v[144:147], v[120:123]
    ds_read_b64_tr_b16 v[234:235], v21 offset:54272
    s_waitcnt lgkmcnt(6)
    s_waitcnt vmcnt(5)
    v_mfma_f32_16x16x32_bf16 v[124:127], v[240:243], v[148:151], v[124:127]
    ds_read_b64_tr_b16 v[236:237], v22 offset:57344
    v_mfma_f32_16x16x32_bf16 v[128:131], v[240:243], v[152:155], v[128:131]
    ds_read_b64_tr_b16 v[238:239], v22 offset:58368
    s_waitcnt lgkmcnt(6)
    v_mfma_f32_16x16x32_bf16 v[132:135], v[244:247], v[148:151], v[132:135]
    ds_read_b64_tr_b16 v[240:241], v23 offset:57344
    v_mfma_f32_16x16x32_bf16 v[136:139], v[244:247], v[152:155], v[136:139]
    ds_read_b64_tr_b16 v[242:243], v23 offset:58368
    s_waitcnt lgkmcnt(6)
    v_mfma_f32_16x16x32_bf16 v[108:111], v[248:251], v[148:151], v[108:111]
    ds_read_b64_tr_b16 v[244:245], v20 offset:57344
    v_mfma_f32_16x16x32_bf16 v[112:115], v[248:251], v[152:155], v[112:115]
    ds_read_b64_tr_b16 v[246:247], v20 offset:58368
    s_waitcnt lgkmcnt(6)
    v_mfma_f32_16x16x32_bf16 v[116:119], v[232:235], v[148:151], v[116:119]
    ds_read_b64_tr_b16 v[248:249], v21 offset:57344
    v_mfma_f32_16x16x32_bf16 v[120:123], v[232:235], v[152:155], v[120:123]
    ds_read_b64_tr_b16 v[250:251], v21 offset:58368
    s_waitcnt lgkmcnt(6)
    s_waitcnt vmcnt(3)
    v_mfma_f32_16x16x32_bf16 v[124:127], v[236:239], v[156:159], v[124:127]
    ds_read_b64_tr_b16 v[232:233], v22 offset:61440
    v_mfma_f32_16x16x32_bf16 v[128:131], v[236:239], v[160:163], v[128:131]
    ds_read_b64_tr_b16 v[234:235], v22 offset:62464
    s_waitcnt lgkmcnt(6)
    v_mfma_f32_16x16x32_bf16 v[132:135], v[240:243], v[156:159], v[132:135]
    ds_read_b64_tr_b16 v[236:237], v23 offset:61440
    v_mfma_f32_16x16x32_bf16 v[136:139], v[240:243], v[160:163], v[136:139]
    ds_read_b64_tr_b16 v[238:239], v23 offset:62464
    s_waitcnt lgkmcnt(6)
    v_mfma_f32_16x16x32_bf16 v[108:111], v[244:247], v[156:159], v[108:111]
    ds_read_b64_tr_b16 v[240:241], v20 offset:61440
    v_mfma_f32_16x16x32_bf16 v[112:115], v[244:247], v[160:163], v[112:115]
    ds_read_b64_tr_b16 v[242:243], v20 offset:62464
    s_waitcnt lgkmcnt(6)
    v_mfma_f32_16x16x32_bf16 v[116:119], v[248:251], v[156:159], v[116:119]
    ds_read_b64_tr_b16 v[244:245], v21 offset:61440
    v_mfma_f32_16x16x32_bf16 v[120:123], v[248:251], v[160:163], v[120:123]
    ds_read_b64_tr_b16 v[246:247], v21 offset:62464
    s_waitcnt lgkmcnt(6)
    s_waitcnt vmcnt(1)
    v_mfma_f32_16x16x32_bf16 v[124:127], v[232:235], v[164:167], v[124:127]
    v_mfma_f32_16x16x32_bf16 v[128:131], v[232:235], v[168:171], v[128:131]
    s_waitcnt lgkmcnt(4)
    v_mfma_f32_16x16x32_bf16 v[132:135], v[236:239], v[164:167], v[132:135]
    v_mfma_f32_16x16x32_bf16 v[136:139], v[236:239], v[168:171], v[136:139]
    s_waitcnt lgkmcnt(2)
    v_mfma_f32_16x16x32_bf16 v[108:111], v[240:243], v[164:167], v[108:111]
    v_mfma_f32_16x16x32_bf16 v[112:115], v[240:243], v[168:171], v[112:115]
    s_waitcnt lgkmcnt(0)
    v_mfma_f32_16x16x32_bf16 v[116:119], v[244:247], v[164:167], v[116:119]
    v_mfma_f32_16x16x32_bf16 v[120:123], v[244:247], v[168:171], v[120:123]
    s_setprio 0
    ds_write_b128 v4, v[124:127]
    ds_write_b128 v4, v[128:131] offset:1024
    ds_write_b128 v4, v[132:135] offset:2048
    ds_write_b128 v4, v[136:139] offset:3072
    v_permlane16_swap_b32 v108, v112
    v_permlane16_swap_b32 v109, v113
    v_permlane16_swap_b32 v110, v114
    v_permlane16_swap_b32 v111, v115
    v_permlane16_swap_b32 v116, v120
    v_permlane16_swap_b32 v117, v121
    v_permlane16_swap_b32 v118, v122
    v_permlane16_swap_b32 v119, v123
    s_waitcnt lgkmcnt(0)
    s_barrier
    ds_read_b128 v[124:127], v5
    ds_read_b128 v[128:131], v5 offset:256
    ds_read_b128 v[132:135], v5 offset:2048
    ds_read_b128 v[136:139], v5 offset:2304
    s_add_u32 s15, s80, 172032
    s_lshl2_add_u32 m0, s89, 35840
    s_nop 0
    buffer_load_dwordx4 v72, s[52:55], s15 offen nt lds
    s_lshl_b32 s96, s90, 7
    s_add_u32 s97, s96, s80
    s_add_u32 s15, s97, 172032
    s_lshl2_add_u32 m0, s89, 68608
    s_nop 0
    buffer_load_dwordx4 v72, s[56:59], s15 offen nt lds
    s_mov_b32 s15, s81
    s_lshl2_add_u32 m0, s89, 98304
    s_nop 0
    buffer_load_dwordx4 v73, s[60:63], s15 offen nt lds
    s_waitcnt lgkmcnt(3)
    v_pk_add_f32 v[108:109], v[108:109], v[124:125]
    v_pk_add_f32 v[110:111], v[110:111], v[126:127]
    s_waitcnt lgkmcnt(2)
    v_pk_add_f32 v[112:113], v[112:113], v[128:129]
    v_pk_add_f32 v[114:115], v[114:115], v[130:131]
    v_cvt_pk_bf16_f32 v108, 0, v108
    v_cvt_pk_bf16_f32 v109, 0, v109
    v_cvt_pk_bf16_f32 v110, 0, v110
    v_cvt_pk_bf16_f32 v111, 0, v111
    v_cvt_pk_bf16_f32 v112, 0, v112
    v_cvt_pk_bf16_f32 v113, 0, v113
    v_cvt_pk_bf16_f32 v114, 0, v114
    v_cvt_pk_bf16_f32 v115, 0, v115
    v_pk_mul_f32 v[108:109], v[108:109], v[76:77]
    v_pk_mul_f32 v[110:111], v[110:111], v[78:79]
    v_pk_mul_f32 v[112:113], v[112:113], v[80:81]
    v_pk_mul_f32 v[114:115], v[114:115], v[82:83]
    v_cvt_pk_bf16_f32 v108, 0, v108
    v_cvt_pk_bf16_f32 v109, 0, v109
    v_cvt_pk_bf16_f32 v110, 0, v110
    v_cvt_pk_bf16_f32 v111, 0, v111
    v_cvt_pk_bf16_f32 v112, 0, v112
    v_cvt_pk_bf16_f32 v113, 0, v113
    v_cvt_pk_bf16_f32 v114, 0, v114
    v_cvt_pk_bf16_f32 v115, 0, v115
    v_pk_add_f32 v[108:109], v[108:109], v[28:29]
    v_pk_add_f32 v[110:111], v[110:111], v[30:31]
    v_pk_add_f32 v[112:113], v[112:113], v[32:33]
    v_pk_add_f32 v[114:115], v[114:115], v[34:35]
    v_cvt_pk_bf16_f32 v12, v108, v109
    v_cvt_pk_bf16_f32 v13, v110, v111
    v_cvt_pk_bf16_f32 v14, v112, v113
    v_cvt_pk_bf16_f32 v15, v114, v115
    s_waitcnt lgkmcnt(1)
    v_pk_add_f32 v[116:117], v[116:117], v[132:133]
    v_pk_add_f32 v[118:119], v[118:119], v[134:135]
    s_waitcnt lgkmcnt(0)
    v_pk_add_f32 v[120:121], v[120:121], v[136:137]
    v_pk_add_f32 v[122:123], v[122:123], v[138:139]
    v_cvt_pk_bf16_f32 v116, 0, v116
    v_cvt_pk_bf16_f32 v117, 0, v117
    v_cvt_pk_bf16_f32 v118, 0, v118
    v_cvt_pk_bf16_f32 v119, 0, v119
    v_cvt_pk_bf16_f32 v120, 0, v120
    v_cvt_pk_bf16_f32 v121, 0, v121
    v_cvt_pk_bf16_f32 v122, 0, v122
    v_cvt_pk_bf16_f32 v123, 0, v123
    v_pk_mul_f32 v[116:117], v[116:117], v[84:85]
    v_pk_mul_f32 v[118:119], v[118:119], v[86:87]
    v_pk_mul_f32 v[120:121], v[120:121], v[88:89]
    v_pk_mul_f32 v[122:123], v[122:123], v[90:91]
    v_cvt_pk_bf16_f32 v116, 0, v116
    v_cvt_pk_bf16_f32 v117, 0, v117
    v_cvt_pk_bf16_f32 v118, 0, v118
    v_cvt_pk_bf16_f32 v119, 0, v119
    v_cvt_pk_bf16_f32 v120, 0, v120
    v_cvt_pk_bf16_f32 v121, 0, v121
    v_cvt_pk_bf16_f32 v122, 0, v122
    v_cvt_pk_bf16_f32 v123, 0, v123
    v_pk_add_f32 v[116:117], v[116:117], v[36:37]
    v_pk_add_f32 v[118:119], v[118:119], v[38:39]
    v_pk_add_f32 v[120:121], v[120:121], v[40:41]
    v_pk_add_f32 v[122:123], v[122:123], v[42:43]
    v_cvt_pk_bf16_f32 v16, v116, v117
    v_cvt_pk_bf16_f32 v17, v118, v119
    v_cvt_pk_bf16_f32 v18, v120, v121
    v_cvt_pk_bf16_f32 v19, v122, v123
    v_mfma_f32_32x32x16_bf16 v[124:139], v[92:95], v[12:15], 0
    s_nop 0
    v_mfma_f32_32x32x16_bf16 v[124:139], v[96:99], v[16:19], v[124:139]
    v_dot2_f32_bf16 v232, v12, v12, 0
    v_dot2_f32_bf16 v233, v13, v13, 0
    v_dot2_f32_bf16 v232, v14, v14, v232
    v_dot2_f32_bf16 v233, v15, v15, v233
    v_dot2_f32_bf16 v232, v16, v16, v232
    v_dot2_f32_bf16 v233, v17, v17, v233
    v_dot2_f32_bf16 v232, v18, v18, v232
    v_dot2_f32_bf16 v233, v19, v19, v233
    s_nop 2
    v_add_f32 v234, v232, v233
    v_add_f32 v232, v232, v233
    s_nop 1
    v_permlane32_swap_b32 v232, v234
    s_mov_b32 exec_lo, 0
    v_add_f32 v124, v232, v234
    v_mov_b32 v125, v126
    s_mov_b32 exec_lo, -1
    ds_write_b64 v6, v[124:125]
    ds_write_b32 v7, v68
    ds_write_b32 v7, v69 offset:128
    ds_write_b32 v7, v70 offset:256
    ds_write_b32 v7, v71 offset:384
    s_waitcnt lgkmcnt(0)
    s_barrier
    s_cmp_lg_u32 s3, 0
    s_cbranch_scc1 L_PE
    s_setprio 3
    ds_read_b128 v[124:127], v8 offset:0
    ds_read_b128 v[128:131], v8 offset:2048
    ds_read_b128 v[132:135], v8 offset:1024
    ds_read_b128 v[136:139], v8 offset:3072
    s_waitcnt lgkmcnt(2)
    v_pk_add_f32 v[124:125], v[124:125], v[128:129]
    v_pk_add_f32 v[126:127], v[126:127], v[130:131]
    v_add_f32 v125, v125, v127
    v_mov_b32 v127, s4
    s_waitcnt lgkmcnt(0)
    v_pk_add_f32 v[132:133], v[132:133], v[136:137]
    v_pk_add_f32 v[134:135], v[134:135], v[138:139]
    v_add_f32 v133, v133, v135
    v_mov_b32 v135, s4
    buffer_store_dwordx4 v[124:127], v2, s[32:35], s14 offen sc1
    buffer_store_dwordx4 v[132:135], v2, s[32:35], s14 offen offset:1024 sc1
    s_mov_b64 exec, 0xffff
    buffer_store_dword v127, v10, s[32:35], s16 offen sc1
    s_setprio 0
    s_mov_b64 exec, -1
L_PE:
    s_load_dwordx2 s[24:25], s[32:33], s92 offset:1536 glc
    s_and_b32 s96, s3, 3
    s_mul_i32 s97, s96, 4608
    s_lshl_b32 s98, s76, 6
    s_add_u32 s16, s97, s98
    v_and_b32 v23, 31, v1
    v_mul_u32_u24 v23, 144, v23
    v_lshrrev_b32 v9, 5, v1
    v_lshl_add_u32 v23, v9, 5, v23
    v_add_u32 v23, s16, v23
    ds_write_b128 v23, v[12:15]
    ds_write_b128 v23, v[16:19] offset:16
    v_add_u32 v23, 139776, v23
    s_lshl3_add_u32 s96, s21, s3
    s_lshl_b32 s97, s96, 5
    s_sub_u32 s15, 4094, s97
    v_and_b32 v22, 15, v1
    v_lshlrev_b32 v22, 1, v22
    v_sub_u32 v22, s15, v22
    s_lshl_b32 s96, s3, 7
    s_add_u32 s15, s96, 135168
    v_and_b32 v8, 15, v1
    v_lshl_add_u32 v8, v8, 3, s15
    s_and_b32 s96, s3, 3
    s_lshl_b32 s97, s96, 8
    s_add_u32 s15, s97, 135168
    v_and_b32 v10, 31, v1
    v_lshl_add_u32 v10, v10, 3, s15
    v_and_b32 v11, 7, v1
    v_lshlrev_b32 v11, 3, v11
    v_add_u32 v11, 136192, v11
    s_waitcnt vmcnt(3)
    v_cmp_ne_u32 vcc, s4, v27
    s_cbranch_vccz TOK_38
POLL_39:
    buffer_load_dwordx2 v[26:27], v25, s[32:35], s18 offen sc1
    s_waitcnt vmcnt(0)
    v_cmp_ne_u32 vcc, s4, v27
    s_cbranch_vccz PDONE_40
    s_add_u32 s5, s5, 1
    s_cmp_lt_u32 s5, 300000
    s_cbranch_scc1 POLL_39
PDONE_40:
TOK_38:
    v_add_f32_dpp v26, v26, v26 quad_perm:[1,0,3,2] row_mask:0xf bank_mask:0xf
    s_nop 1
    v_add_f32_dpp v26, v26, v26 quad_perm:[2,3,0,1] row_mask:0xf bank_mask:0xf
    s_nop 1
    v_add_f32_dpp v26, v26, v26 row_half_mirror row_mask:0xf bank_mask:0xf
    s_nop 1
    v_add_f32_dpp v26, v26, v26 row_ror:8 row_mask:0xf bank_mask:0xf
    s_cmp_lg_u32 s3, 1
    s_cbranch_scc1 L_NOCT
    v_and_b32 v5, 15, v1
    v_lshlrev_b32 v5, 3, v5
    v_add_u32 v5, 139008, v5
    ds_read_b64 v[150:151], v5
    ds_read_b64 v[154:155], v5 offset:128
    ds_read_b64 v[156:157], v5 offset:384
    s_waitcnt lgkmcnt(0)
    v_lshlrev_b32 v148, 16, v150
    v_and_b32 v149, s6, v150
    v_lshlrev_b32 v150, 16, v151
    v_and_b32 v151, s6, v151
    v_lshlrev_b32 v152, 16, v154
    v_and_b32 v153, s6, v154
    v_lshlrev_b32 v154, 16, v155
    v_and_b32 v155, s6, v155
L_NOCT:
    s_lshl3_add_u32 s15, s3, 136192
    v_mov_b32 v5, s15
    v_and_b32 v6, 3, v1
    v_lshlrev_b32 v6, 18, v6
    v_bfe_u32 v9, v1, 2, 2
    v_lshl_add_u32 v6, v9, 13, v6
    s_and_b32 s96, s21, 1
    s_and_b32 s97, s12, 7
    s_lshr_b32 s98, s12, 3
    s_lshl3_add_u32 s99, s97, s98
    s_lshl_b32 s97, s99, 12
    s_lshr_b32 s98, s21, 1
    s_lshl_b32 s99, s98, 6
    s_add_u32 s98, s97, s99
    s_lshl4_add_u32 s97, s96, s98
    s_add_u32 s99, s97, 1048576
    s_add_u32 s14, s99, 2560
    s_cmp_lt_u32 s3, 4
    s_cbranch_scc1 L_NOST
    s_sub_u32 s96, s3, 4
    s_lshl_b32 s97, s96, 12
    s_add_u32 s13, s97, 32768
    v_add_u32 v4, s13, v2
    v_add_u32 v7, 65536, v4
    ds_write_b128 v4, v[176:179] offset:16384
    ds_write_b128 v4, v[180:183]
    ds_write_b128 v4, v[184:187] offset:49152
    ds_write_b128 v4, v[188:191] offset:32768
    ds_write_b128 v4, v[192:195] offset:17408
    ds_write_b128 v4, v[196:199] offset:1024
    ds_write_b128 v4, v[200:203] offset:50176
    ds_write_b128 v4, v[204:207] offset:33792
    ds_write_b128 v4, v[208:211] offset:18432
    ds_write_b128 v4, v[212:215] offset:2048
    ds_write_b128 v4, v[216:219] offset:51200
    ds_write_b128 v4, v[220:223] offset:34816
L_NOST:
    s_branch SCHK_36
SPOLL_35:
    s_load_dwordx2 s[24:25], s[32:33], s92 offset:1536 glc
SCHK_36:
    s_add_u32 s5, s5, 1
    s_cmp_ge_u32 s5, 300000
    s_waitcnt lgkmcnt(0)
    s_cbranch_scc1 SDONE_37
    s_cmp_lg_u32 s24, s4
    s_cbranch_scc1 SPOLL_35
    s_cmp_lg_u32 s25, s4
    s_cbranch_scc1 SPOLL_35
SDONE_37:
    s_barrier
    s_mov_b32 s13, s17
    buffer_load_dwordx4 v[124:127], v44, s[32:35], s13 offen sc1
    s_add_u32 s13, s17, 8192
    buffer_load_dwordx4 v[128:131], v44, s[32:35], s13 offen sc1
    s_add_u32 s13, s17, 16384
    buffer_load_dwordx4 v[132:135], v44, s[32:35], s13 offen sc1
    s_add_u32 s13, s17, 24576
    buffer_load_dwordx4 v[136:139], v44, s[32:35], s13 offen sc1
    v_lshlrev_b32 v28, 16, v12
    v_and_b32 v29, s6, v12
    v_lshlrev_b32 v30, 16, v13
    v_and_b32 v31, s6, v13
    v_lshlrev_b32 v32, 16, v14
    v_and_b32 v33, s6, v14
    v_lshlrev_b32 v34, 16, v15
    v_and_b32 v35, s6, v15
    v_lshlrev_b32 v36, 16, v16
    v_and_b32 v37, s6, v16
    v_lshlrev_b32 v38, 16, v17
    v_and_b32 v39, s6, v17
    v_lshlrev_b32 v40, 16, v18
    v_and_b32 v41, s6, v18
    v_lshlrev_b32 v42, 16, v19
    v_and_b32 v43, s6, v19
    v_mul_u32_u24_dpp v92, v68, v52 row_newbcast:0 row_mask:0xf bank_mask:0xf
    v_and_b32_dpp v93, v68, v53 row_newbcast:0 row_mask:0xf bank_mask:0xf
    v_mul_u32_u24_dpp v94, v68, v52 row_newbcast:1 row_mask:0xf bank_mask:0xf
    v_and_b32_dpp v95, v68, v53 row_newbcast:1 row_mask:0xf bank_mask:0xf
    v_mul_u32_u24_dpp v96, v68, v52 row_newbcast:2 row_mask:0xf bank_mask:0xf
    v_and_b32_dpp v97, v68, v53 row_newbcast:2 row_mask:0xf bank_mask:0xf
    v_mul_u32_u24_dpp v98, v68, v52 row_newbcast:3 row_mask:0xf bank_mask:0xf
    v_and_b32_dpp v99, v68, v53 row_newbcast:3 row_mask:0xf bank_mask:0xf
    v_mul_u32_u24_dpp v100, v68, v52 row_newbcast:4 row_mask:0xf bank_mask:0xf
    v_and_b32_dpp v101, v68, v53 row_newbcast:4 row_mask:0xf bank_mask:0xf
    v_mul_u32_u24_dpp v102, v68, v52 row_newbcast:5 row_mask:0xf bank_mask:0xf
    v_and_b32_dpp v103, v68, v53 row_newbcast:5 row_mask:0xf bank_mask:0xf
    v_mul_u32_u24_dpp v104, v68, v52 row_newbcast:6 row_mask:0xf bank_mask:0xf
    v_and_b32_dpp v105, v68, v53 row_newbcast:6 row_mask:0xf bank_mask:0xf
    v_mul_u32_u24_dpp v106, v68, v52 row_newbcast:7 row_mask:0xf bank_mask:0xf
    v_and_b32_dpp v107, v68, v53 row_newbcast:7 row_mask:0xf bank_mask:0xf
    v_mul_u32_u24_dpp v108, v69, v52 row_newbcast:0 row_mask:0xf bank_mask:0xf
    v_and_b32_dpp v109, v69, v53 row_newbcast:0 row_mask:0xf bank_mask:0xf
    v_mul_u32_u24_dpp v110, v69, v52 row_newbcast:1 row_mask:0xf bank_mask:0xf
    v_and_b32_dpp v111, v69, v53 row_newbcast:1 row_mask:0xf bank_mask:0xf
    v_mul_u32_u24_dpp v112, v69, v52 row_newbcast:2 row_mask:0xf bank_mask:0xf
    v_and_b32_dpp v113, v69, v53 row_newbcast:2 row_mask:0xf bank_mask:0xf
    v_mul_u32_u24_dpp v114, v69, v52 row_newbcast:3 row_mask:0xf bank_mask:0xf
    v_and_b32_dpp v115, v69, v53 row_newbcast:3 row_mask:0xf bank_mask:0xf
    v_mul_u32_u24_dpp v116, v69, v52 row_newbcast:4 row_mask:0xf bank_mask:0xf
    v_and_b32_dpp v117, v69, v53 row_newbcast:4 row_mask:0xf bank_mask:0xf
    v_mul_u32_u24_dpp v118, v69, v52 row_newbcast:5 row_mask:0xf bank_mask:0xf
    v_and_b32_dpp v119, v69, v53 row_newbcast:5 row_mask:0xf bank_mask:0xf
    v_mul_u32_u24_dpp v120, v69, v52 row_newbcast:6 row_mask:0xf bank_mask:0xf
    v_and_b32_dpp v121, v69, v53 row_newbcast:6 row_mask:0xf bank_mask:0xf
    v_mul_u32_u24_dpp v122, v69, v52 row_newbcast:7 row_mask:0xf bank_mask:0xf
    v_and_b32_dpp v123, v69, v53 row_newbcast:7 row_mask:0xf bank_mask:0xf
    s_waitcnt vmcnt(0)
    v_bitop3_b32 v4, v127, v131, s4 bitop3:0x7e
    v_bitop3_b32 v4, v4, v135, s4 bitop3:0xf6
    v_bitop3_b32 v4, v4, v139, s4 bitop3:0xf6
    v_cmp_ne_u32 vcc, 0, v4
    s_cbranch_vccz TOK_42
POLL_43:
    s_mov_b32 s13, s17
    buffer_load_dwordx4 v[124:127], v44, s[32:35], s13 offen sc1
    s_add_u32 s13, s17, 8192
    buffer_load_dwordx4 v[128:131], v44, s[32:35], s13 offen sc1
    s_add_u32 s13, s17, 16384
    buffer_load_dwordx4 v[132:135], v44, s[32:35], s13 offen sc1
    s_add_u32 s13, s17, 24576
    buffer_load_dwordx4 v[136:139], v44, s[32:35], s13 offen sc1
    s_waitcnt vmcnt(0)
    v_bitop3_b32 v4, v127, v131, s4 bitop3:0x7e
    v_bitop3_b32 v4, v4, v135, s4 bitop3:0xf6
    v_bitop3_b32 v4, v4, v139, s4 bitop3:0xf6
    v_cmp_ne_u32 vcc, 0, v4
    s_cbranch_vccz PDONE_44
    s_add_u32 s5, s5, 1
    s_cmp_lt_u32 s5, 300000
    s_cbranch_scc1 POLL_43
PDONE_44:
TOK_42:
    v_pk_add_f32 v[124:125], v[124:125], v[128:129]
    v_pk_add_f32 v[132:133], v[132:133], v[136:137]
    v_add_f32 v126, v126, v130
    v_add_f32 v134, v134, v138
    v_pk_add_f32 v[124:125], v[124:125], v[132:133]
    v_add_f32 v126, v126, v134
    v_mov_b32 v127, v125
    s_nop 0
    v_permlane32_swap_b32 v124, v126
    v_permlane32_swap_b32 v125, v127
    v_add_f32 v124, v124, v126
    v_add_f32 v125, v125, v127
    s_nop 1
    v_permlane16_swap_b32 v124, v125
    v_add_f32 v127, v124, v125
    v_add_f32 v124, v124, v125
    s_nop 1
    v_permlane16_swap_b32 v124, v127
    v_mul_f32 v126, 0x3a800000, v124
    v_mul_f32 v124, 0x3a800000, v124
    s_nop 1
    v_permlane32_swap_b32 v124, v126
    v_fma_f32 v21, -v124, v124, v126
    v_cvt_pk_bf16_f32 v20, 0, v124
    v_max_f32 v21, 0, v21
    v_cvt_pk_bf16_f32 v21, 0, v21
    v_add_f32 v21, 0x3727c5ac, v21
    v_cvt_pk_bf16_f32 v21, 0, v21
    v_sqrt_f32 v21, v21
    s_nop 0
    v_cvt_pk_bf16_f32 v21, 0, v21
    v_rcp_f32 v21, v21
    v_fma_f32 v127, -v20, v26, v127
    v_mul_f32 v127, v127, v21
    ds_write_b64 v8, v[20:21]
    s_movk_i32 s13, 0xfff
    v_ashrrev_i32 v124, 31, v127
    v_or_b32 v124, 0x80000000, v124
    v_xor_b32 v124, v124, v127
    v_bfi_b32 v48, s13, v22, v124
    s_nop 1
    v_min_u32_dpp v49, v48, v48 row_ror:8 row_mask:0xf bank_mask:0xf
    v_max_u32_dpp v48, v48, v48 row_ror:8 row_mask:0xf bank_mask:0xf
    s_nop 1
    v_min_u32_dpp v50, v48, v48 row_ror:4 row_mask:0xf bank_mask:0xf
    v_max_u32_dpp v49, v49, v49 row_ror:4 row_mask:0xf bank_mask:0xf
    v_max_u32_dpp v48, v48, v48 row_ror:4 row_mask:0xf bank_mask:0xf
    v_max_u32 v49, v49, v50
    s_nop 0
    v_min_u32_dpp v50, v48, v48 row_ror:2 row_mask:0xf bank_mask:0xf
    v_max_u32_dpp v49, v49, v49 row_ror:2 row_mask:0xf bank_mask:0xf
    v_max_u32_dpp v48, v48, v48 row_ror:2 row_mask:0xf bank_mask:0xf
    v_max_u32 v49, v49, v50
    s_nop 0
    v_min_u32_dpp v50, v48, v48 row_ror:1 row_mask:0xf bank_mask:0xf
    v_max_u32_dpp v49, v49, v49 row_ror:1 row_mask:0xf bank_mask:0xf
    v_max_u32_dpp v48, v48, v48 row_ror:1 row_mask:0xf bank_mask:0xf
    v_max_u32 v49, v49, v50
    ds_write_b64 v5, v[48:49]
    s_lshl2_add_u32 s96, s74, s75
    s_lshl_b32 s97, s96, 11
    s_lshl_b32 s98, s3, 8
    s_add_u32 s99, s97, s98
    s_add_u32 s15, s99, 20971520
    v_lshlrev_b32 v44, 7, v1
    s_mov_b64 exec, 3
    buffer_load_dword v44, v44, s[32:35], s15 offen
    s_mov_b64 exec, -1
    s_add_u32 s15, s81, 4096
    s_lshl2_add_u32 m0, s89, 99328
    s_nop 0
    buffer_load_dwordx4 v73, s[60:63], s15 offen nt lds
    s_waitcnt lgkmcnt(0)
    s_barrier
    s_cmp_ge_u32 s3, 2
    s_cbranch_scc1 L_PR1
    s_setprio 3
L_PR1:
    ds_read_b64 v[48:49], v11
    ds_read_b64 v[20:21], v10
    s_waitcnt lgkmcnt(1)
    v_min_u32_dpp v50, v48, v48 quad_perm:[1,0,3,2] row_mask:0xf bank_mask:0xf
    v_max_u32_dpp v49, v49, v49 quad_perm:[1,0,3,2] row_mask:0xf bank_mask:0xf
    v_max_u32_dpp v48, v48, v48 quad_perm:[1,0,3,2] row_mask:0xf bank_mask:0xf
    v_max_u32 v49, v49, v50
    s_nop 0
    v_min_u32_dpp v50, v48, v48 quad_perm:[2,3,0,1] row_mask:0xf bank_mask:0xf
    v_max_u32_dpp v49, v49, v49 quad_perm:[2,3,0,1] row_mask:0xf bank_mask:0xf
    v_max_u32_dpp v48, v48, v48 quad_perm:[2,3,0,1] row_mask:0xf bank_mask:0xf
    v_max_u32 v49, v49, v50
    s_nop 0
    v_min_u32_dpp v50, v48, v48 row_half_mirror row_mask:0xf bank_mask:0xf
    v_max_u32_dpp v49, v49, v49 row_half_mirror row_mask:0xf bank_mask:0xf
    v_max_u32_dpp v48, v48, v48 row_half_mirror row_mask:0xf bank_mask:0xf
    v_max_u32 v49, v49, v50
    v_or_b32 v50, 1, v49
    v_mov_b32 v49, s4
    v_mov_b32 v51, s4
    s_cmp_lg_u32 s3, 0
    s_cbranch_scc1 L_NOF
    s_mov_b64 exec, 0xffff
    buffer_store_dwordx4 v[48:51], v6, s[32:35], s14 offen sc1
    s_mov_b64 exec, -1
L_NOF:
    s_cmp_lg_u32 s3, 1
    s_cbranch_scc1 L_NOC
    v_and_b32 v4, 16, v1
    v_cmp_eq_u32 vcc, 0, v4
    s_nop 1
    v_cndmask_b32 v4, v50, v48, vcc
    v_not_b32 v4, v4
    v_bfe_u32 v4, v4, 1, 7
    v_lshlrev_b32 v6, 3, v4
    v_mul_u32_u24 v4, 144, v4
    v_add_u32 v6, 135168, v6
    v_and_b32 v5, 15, v1
    v_lshlrev_b32 v5, 3, v5
    v_add_u32 v4, v4, v5
    ds_read_b64 v[128:129], v6
    ds_read_b64 v[124:125], v4 offset:0
    v_and_b32 v6, 15, v1
    v_lshlrev_b32 v6, 4, v6
    v_bfe_u32 v9, v1, 4, 1
    v_lshl_add_u32 v6, v9, 14, v6
    v_lshrrev_b32 v9, 5, v1
    v_lshl_add_u32 v6, v9, 12, v6
    v_bfe_u32 v7, v1, 4, 1
    v_lshlrev_b32 v7, 14, v7
    v_and_b32 v9, 3, v1
    v_lshl_add_u32 v7, v9, 4, v7
    s_lshl_b32 s96, s21, 15
    s_lshl_b32 s97, s12, 8
    s_add_u32 s98, s96, s97
    s_add_u32 s13, s98, 33554432
    s_lshl_b32 s96, s21, 15
    s_lshl_b32 s97, s12, 6
    s_add_u32 s98, s96, s97
    s_add_u32 s99, s98, 8192
    s_add_u32 s16, s99, 33554432
    v_mov_b32 v127, s4
    s_waitcnt lgkmcnt(0)
    v_lshlrev_b32 v132, 16, v124
    v_and_b32 v133, s6, v124
    v_lshlrev_b32 v134, 16, v125
    v_and_b32 v135, s6, v125
    v_pk_add_f32 v[132:133], v[132:133], v[128:129] op_sel_hi:[1,0] neg_lo:[0,1] neg_hi:[0,1]
    v_pk_add_f32 v[134:135], v[134:135], v[128:129] op_sel_hi:[1,0] neg_lo:[0,1] neg_hi:[0,1]
    v_cvt_pk_bf16_f32 v132, 0, v132
    v_cvt_pk_bf16_f32 v133, 0, v133
    v_cvt_pk_bf16_f32 v134, 0, v134
    v_cvt_pk_bf16_f32 v135, 0, v135
    v_pk_mul_f32 v[132:133], v[132:133], v[128:129] op_sel:[0,1]
    v_pk_mul_f32 v[134:135], v[134:135], v[128:129] op_sel:[0,1]
    v_cvt_pk_bf16_f32 v132, 0, v132
    v_cvt_pk_bf16_f32 v133, 0, v133
    v_cvt_pk_bf16_f32 v134, 0, v134
    v_cvt_pk_bf16_f32 v135, 0, v135
    v_pk_mul_f32 v[132:133], v[132:133], v[152:153]
    v_pk_mul_f32 v[134:135], v[134:135], v[154:155]
    v_cvt_pk_bf16_f32 v132, 0, v132
    v_cvt_pk_bf16_f32 v133, 0, v133
    v_cvt_pk_bf16_f32 v134, 0, v134
    v_cvt_pk_bf16_f32 v135, 0, v135
    v_pk_add_f32 v[132:133], v[132:133], v[148:149]
    v_pk_add_f32 v[134:135], v[134:135], v[150:151]
    v_mov_b32 v126, v125
    v_mov_b32 v125, s4
    s_mov_b32 exec_hi, 0
    v_cvt_pk_bf16_f32 v124, v132, v133
    v_cvt_pk_bf16_f32 v126, v134, v135
    s_mov_b32 exec_hi, -1
    v_dot2_f32_bf16 v128, v124, v156, 0
    v_mov_b32 v129, s4
    v_dot2_f32_bf16 v128, v126, v157, v128
    buffer_store_dwordx4 v[124:127], v6, s[32:35], s13 offen sc1
    s_nop 1
    v_add_f32_dpp v128, v128, v128 quad_perm:[1,0,3,2] row_mask:0xf bank_mask:0xf
    s_nop 1
    v_add_f32_dpp v128, v128, v128 quad_perm:[2,3,0,1] row_mask:0xf bank_mask:0xf
    s_nop 1
    v_add_f32_dpp v128, v128, v128 row_half_mirror row_mask:0xf bank_mask:0xf
    s_nop 1
    v_add_f32_dpp v128, v128, v128 row_ror:8 row_mask:0xf bank_mask:0xf
    v_mov_b32 v130, v128
    v_mov_b32 v131, s4
    s_mov_b64 exec, 0xf000f
    buffer_store_dwordx4 v[128:131], v7, s[32:35], s16 offen sc1
    s_mov_b64 exec, -1
L_NOC:
    s_waitcnt lgkmcnt(0)
    s_setprio 0
    s_mov_b64 exec, 0xff
    buffer_store_dwordx4 v[224:227], v228, s[32:35], 0 offen sc1
    s_mov_b64 exec, -1
    s_add_u32 s13, s81, 8192
    s_lshl2_add_u32 m0, s89, 100352
    s_nop 0
    buffer_load_dwordx4 v73, s[60:63], s13 offen nt lds
    s_load_dwordx8 s[24:31], s[32:33], s92 offset:2560 glc
    v_pk_add_f32 v[76:77], v[28:29], v[20:21] op_sel_hi:[1,0] neg_lo:[0,1] neg_hi:[0,1]
    v_pk_add_f32 v[78:79], v[30:31], v[20:21] op_sel_hi:[1,0] neg_lo:[0,1] neg_hi:[0,1]
    v_pk_add_f32 v[80:81], v[32:33], v[20:21] op_sel_hi:[1,0] neg_lo:[0,1] neg_hi:[0,1]
    v_pk_add_f32 v[82:83], v[34:35], v[20:21] op_sel_hi:[1,0] neg_lo:[0,1] neg_hi:[0,1]
    v_pk_add_f32 v[84:85], v[36:37], v[20:21] op_sel_hi:[1,0] neg_lo:[0,1] neg_hi:[0,1]
    v_pk_add_f32 v[86:87], v[38:39], v[20:21] op_sel_hi:[1,0] neg_lo:[0,1] neg_hi:[0,1]
    v_pk_add_f32 v[88:89], v[40:41], v[20:21] op_sel_hi:[1,0] neg_lo:[0,1] neg_hi:[0,1]
    v_pk_add_f32 v[90:91], v[42:43], v[20:21] op_sel_hi:[1,0] neg_lo:[0,1] neg_hi:[0,1]
    v_cvt_pk_bf16_f32 v76, 0, v76
    v_cvt_pk_bf16_f32 v77, 0, v77
    v_cvt_pk_bf16_f32 v78, 0, v78
    v_cvt_pk_bf16_f32 v79, 0, v79
    v_cvt_pk_bf16_f32 v80, 0, v80
    v_cvt_pk_bf16_f32 v81, 0, v81
    v_cvt_pk_bf16_f32 v82, 0, v82
    v_cvt_pk_bf16_f32 v83, 0, v83
    v_cvt_pk_bf16_f32 v84, 0, v84
    v_cvt_pk_bf16_f32 v85, 0, v85
    v_cvt_pk_bf16_f32 v86, 0, v86
    v_cvt_pk_bf16_f32 v87, 0, v87
    v_cvt_pk_bf16_f32 v88, 0, v88
    v_cvt_pk_bf16_f32 v89, 0, v89
    v_cvt_pk_bf16_f32 v90, 0, v90
    v_cvt_pk_bf16_f32 v91, 0, v91
    v_pk_mul_f32 v[76:77], v[76:77], v[20:21] op_sel:[0,1]
    v_pk_mul_f32 v[78:79], v[78:79], v[20:21] op_sel:[0,1]
    v_pk_mul_f32 v[80:81], v[80:81], v[20:21] op_sel:[0,1]
    v_pk_mul_f32 v[82:83], v[82:83], v[20:21] op_sel:[0,1]
    v_pk_mul_f32 v[84:85], v[84:85], v[20:21] op_sel:[0,1]
    v_pk_mul_f32 v[86:87], v[86:87], v[20:21] op_sel:[0,1]
    v_pk_mul_f32 v[88:89], v[88:89], v[20:21] op_sel:[0,1]
    v_pk_mul_f32 v[90:91], v[90:91], v[20:21] op_sel:[0,1]
    v_cvt_pk_bf16_f32 v76, 0, v76
    v_cvt_pk_bf16_f32 v77, 0, v77
    v_cvt_pk_bf16_f32 v78, 0, v78
    v_cvt_pk_bf16_f32 v79, 0, v79
    v_cvt_pk_bf16_f32 v80, 0, v80
    v_cvt_pk_bf16_f32 v81, 0, v81
    v_cvt_pk_bf16_f32 v82, 0, v82
    v_cvt_pk_bf16_f32 v83, 0, v83
    v_cvt_pk_bf16_f32 v84, 0, v84
    v_cvt_pk_bf16_f32 v85, 0, v85
    v_cvt_pk_bf16_f32 v86, 0, v86
    v_cvt_pk_bf16_f32 v87, 0, v87
    v_cvt_pk_bf16_f32 v88, 0, v88
    v_cvt_pk_bf16_f32 v89, 0, v89
    v_cvt_pk_bf16_f32 v90, 0, v90
    v_cvt_pk_bf16_f32 v91, 0, v91
    v_pk_mul_f32 v[76:77], v[76:77], v[108:109]
    v_pk_mul_f32 v[78:79], v[78:79], v[110:111]
    v_pk_mul_f32 v[80:81], v[80:81], v[112:113]
    v_pk_mul_f32 v[82:83], v[82:83], v[114:115]
    v_pk_mul_f32 v[84:85], v[84:85], v[116:117]
    v_pk_mul_f32 v[86:87], v[86:87], v[118:119]
    v_pk_mul_f32 v[88:89], v[88:89], v[120:121]
    v_pk_mul_f32 v[90:91], v[90:91], v[122:123]
    v_cvt_pk_bf16_f32 v76, 0, v76
    v_cvt_pk_bf16_f32 v77, 0, v77
    v_cvt_pk_bf16_f32 v78, 0, v78
    v_cvt_pk_bf16_f32 v79, 0, v79
    v_cvt_pk_bf16_f32 v80, 0, v80
    v_cvt_pk_bf16_f32 v81, 0, v81
    v_cvt_pk_bf16_f32 v82, 0, v82
    v_cvt_pk_bf16_f32 v83, 0, v83
    v_cvt_pk_bf16_f32 v84, 0, v84
    v_cvt_pk_bf16_f32 v85, 0, v85
    v_cvt_pk_bf16_f32 v86, 0, v86
    v_cvt_pk_bf16_f32 v87, 0, v87
    v_cvt_pk_bf16_f32 v88, 0, v88
    v_cvt_pk_bf16_f32 v89, 0, v89
    v_cvt_pk_bf16_f32 v90, 0, v90
    v_cvt_pk_bf16_f32 v91, 0, v91
    v_pk_add_f32 v[76:77], v[76:77], v[92:93]
    v_pk_add_f32 v[78:79], v[78:79], v[94:95]
    v_pk_add_f32 v[80:81], v[80:81], v[96:97]
    v_pk_add_f32 v[82:83], v[82:83], v[98:99]
    v_pk_add_f32 v[84:85], v[84:85], v[100:101]
    v_pk_add_f32 v[86:87], v[86:87], v[102:103]
    v_pk_add_f32 v[88:89], v[88:89], v[104:105]
    v_pk_add_f32 v[90:91], v[90:91], v[106:107]
    v_cvt_pk_bf16_f32 v76, 0, v76
    v_cvt_pk_bf16_f32 v77, 0, v77
    v_cvt_pk_bf16_f32 v78, 0, v78
    v_cvt_pk_bf16_f32 v79, 0, v79
    v_cvt_pk_bf16_f32 v80, 0, v80
    v_cvt_pk_bf16_f32 v81, 0, v81
    v_cvt_pk_bf16_f32 v82, 0, v82
    v_cvt_pk_bf16_f32 v83, 0, v83
    v_cvt_pk_bf16_f32 v84, 0, v84
    v_cvt_pk_bf16_f32 v85, 0, v85
    v_cvt_pk_bf16_f32 v86, 0, v86
    v_cvt_pk_bf16_f32 v87, 0, v87
    v_cvt_pk_bf16_f32 v88, 0, v88
    v_cvt_pk_bf16_f32 v89, 0, v89
    v_cvt_pk_bf16_f32 v90, 0, v90
    v_cvt_pk_bf16_f32 v91, 0, v91
    s_lshr_b32 s96, s3, 2
    s_lshl_b32 s97, s96, 15
    s_and_b32 s98, s3, 3
    s_lshl_b32 s99, s98, 5
    s_add_u32 s96, s97, s99
    s_add_u32 s13, s96, 32768
    v_lshrrev_b32 v24, 4, v1
    v_lshlrev_b32 v24, 13, v24
    v_bfe_u32 v9, v1, 2, 2
    v_lshl_add_u32 v24, v9, 7, v24
    v_bfe_u32 v9, v1, 3, 2
    v_lshl_add_u32 v24, v9, 5, v24
    v_and_b32 v9, 3, v1
    v_lshl_add_u32 v24, v9, 3, v24
    v_xor_b32 v24, s13, v24
    s_lshl_b32 s13, s3, 6
    v_bfe_u32 v45, v1, 2, 1
    v_lshlrev_b32 v45, 9, v45
    v_bfe_u32 v9, v1, 3, 1
    v_lshl_add_u32 v45, v9, 12, v45
    v_lshrrev_b32 v9, 5, v1
    v_lshl_add_u32 v45, v9, 11, v45
    v_bfe_u32 v9, v1, 2, 2
    v_lshl_add_u32 v45, v9, 6, v45
    v_bfe_u32 v9, v1, 4, 1
    v_lshl_add_u32 v45, v9, 5, v45
    v_and_b32 v9, 3, v1
    v_lshl_add_u32 v45, v9, 3, v45
    v_xor_b32 v45, s13, v45
    v_add_u32 v45, 98304, v45
    v_and_b32 v46, 7, v1
    v_lshlrev_b32 v46, 4, v46
    v_lshrrev_b32 v9, 4, v1
    v_lshl_add_u32 v46, v9, 7, v46
    v_add_u32 v46, 136704, v46
    s_lshl_b32 s13, s75, 10
    v_add_u32 v54, s13, v2
    v_and_b32 v55, 15, v1
    v_lshlrev_b32 v55, 6, v55
    v_add_u32 v55, 8192, v55
    s_lshl_b32 s96, s74, 13
    s_add_u32 s84, s96, 20971520
    s_mul_i32 s96, s90, s76
    s_lshl_b32 s97, s96, 13
    s_lshl3_add_u32 s98, s75, s3
    s_lshl_b32 s99, s98, 8
    s_add_u32 s96, s97, s99
    s_add_u32 s20, s96, s84
    s_lshl4_add_u32 s13, s3, 136256
    v_mov_b32 v4, s13
    v_and_b32 v5, 7, v1
    v_lshlrev_b32 v5, 4, v5
    v_add_u32 v5, 136256, v5
    v_and_b32 v8, 8, v1
    v_cmp_eq_u32 s[22:23], 0, v8
    s_branch SCHK_46
SPOLL_45:
    s_load_dwordx8 s[24:31], s[32:33], s92 offset:2560 glc
SCHK_46:
    s_add_u32 s5, s5, 1
    s_cmp_ge_u32 s5, 300000
    s_waitcnt lgkmcnt(0)
    s_cbranch_scc1 SDONE_47
    s_cmp_lg_u32 s25, s4
    s_cbranch_scc1 SPOLL_45
    s_cmp_lg_u32 s27, s4
    s_cbranch_scc1 SPOLL_45
    s_cmp_lg_u32 s29, s4
    s_cbranch_scc1 SPOLL_45
    s_cmp_lg_u32 s31, s4
    s_cbranch_scc1 SPOLL_45
SDONE_47:
    s_min_u32 s25, s24, s28
    s_max_u32 s24, s24, s28
    s_max_u32 s27, s26, s30
    s_min_u32 s26, s26, s30
    s_max_u32 s28, s25, s27
    s_min_u32 s25, s25, s27
    v_mov_b32 v148, s24
    v_mov_b32 v151, s26
    v_mov_b32 v149, s28
    v_mov_b32 v150, s25
    ds_write_b128 v4, v[148:151]
    s_waitcnt lgkmcnt(0)
    s_barrier
    s_cmp_lt_u32 s3, 4
    s_cbranch_scc1 L_CSEL
    ds_read_b64_tr_b16 v[164:165], v24
    ds_read_b64_tr_b16 v[166:167], v24 offset:512
    ds_read_b64_tr_b16 v[168:169], v24 offset:1024
    ds_read_b64_tr_b16 v[170:171], v24 offset:1536
    ds_read_b64_tr_b16 v[172:173], v24 offset:2048
    ds_read_b64_tr_b16 v[174:175], v24 offset:2560
    ds_read_b64_tr_b16 v[176:177], v24 offset:3072
    ds_read_b64_tr_b16 v[178:179], v24 offset:3584
    ds_read_b64_tr_b16 v[180:181], v24 offset:4096
    ds_read_b64_tr_b16 v[182:183], v24 offset:4608
    ds_read_b64_tr_b16 v[184:185], v24 offset:5120
    ds_read_b64_tr_b16 v[186:187], v24 offset:5632
    ds_read_b64_tr_b16 v[188:189], v24 offset:6144
    ds_read_b64_tr_b16 v[190:191], v24 offset:6656
    ds_read_b64_tr_b16 v[192:193], v24 offset:7168
    ds_read_b64_tr_b16 v[194:195], v24 offset:7680
    v_mul_u32_u24_dpp v92, v70, v52 row_newbcast:0 row_mask:0xf bank_mask:0xf
    v_and_b32_dpp v93, v70, v53 row_newbcast:0 row_mask:0xf bank_mask:0xf
    v_mul_u32_u24_dpp v94, v70, v52 row_newbcast:1 row_mask:0xf bank_mask:0xf
    v_and_b32_dpp v95, v70, v53 row_newbcast:1 row_mask:0xf bank_mask:0xf
    v_mul_u32_u24_dpp v96, v70, v52 row_newbcast:2 row_mask:0xf bank_mask:0xf
    v_and_b32_dpp v97, v70, v53 row_newbcast:2 row_mask:0xf bank_mask:0xf
    v_mul_u32_u24_dpp v98, v70, v52 row_newbcast:3 row_mask:0xf bank_mask:0xf
    v_and_b32_dpp v99, v70, v53 row_newbcast:3 row_mask:0xf bank_mask:0xf
    v_mul_u32_u24_dpp v100, v70, v52 row_newbcast:4 row_mask:0xf bank_mask:0xf
    v_and_b32_dpp v101, v70, v53 row_newbcast:4 row_mask:0xf bank_mask:0xf
    v_mul_u32_u24_dpp v102, v70, v52 row_newbcast:5 row_mask:0xf bank_mask:0xf
    v_and_b32_dpp v103, v70, v53 row_newbcast:5 row_mask:0xf bank_mask:0xf
    v_mul_u32_u24_dpp v104, v70, v52 row_newbcast:6 row_mask:0xf bank_mask:0xf
    v_and_b32_dpp v105, v70, v53 row_newbcast:6 row_mask:0xf bank_mask:0xf
    v_mul_u32_u24_dpp v106, v70, v52 row_newbcast:7 row_mask:0xf bank_mask:0xf
    v_and_b32_dpp v107, v70, v53 row_newbcast:7 row_mask:0xf bank_mask:0xf
    v_pk_mul_f32 v[76:77], v[76:77], v[92:93]
    v_pk_mul_f32 v[78:79], v[78:79], v[94:95]
    v_pk_mul_f32 v[80:81], v[80:81], v[96:97]
    v_pk_mul_f32 v[82:83], v[82:83], v[98:99]
    v_pk_mul_f32 v[84:85], v[84:85], v[100:101]
    v_pk_mul_f32 v[86:87], v[86:87], v[102:103]
    v_pk_mul_f32 v[88:89], v[88:89], v[104:105]
    v_pk_mul_f32 v[90:91], v[90:91], v[106:107]
    v_cvt_pk_bf16_f32 v76, 0, v76
    v_cvt_pk_bf16_f32 v77, 0, v77
    v_cvt_pk_bf16_f32 v78, 0, v78
    v_cvt_pk_bf16_f32 v79, 0, v79
    v_cvt_pk_bf16_f32 v80, 0, v80
    v_cvt_pk_bf16_f32 v81, 0, v81
    v_cvt_pk_bf16_f32 v82, 0, v82
    v_cvt_pk_bf16_f32 v83, 0, v83
    v_cvt_pk_bf16_f32 v84, 0, v84
    v_cvt_pk_bf16_f32 v85, 0, v85
    v_cvt_pk_bf16_f32 v86, 0, v86
    v_cvt_pk_bf16_f32 v87, 0, v87
    v_cvt_pk_bf16_f32 v88, 0, v88
    v_cvt_pk_bf16_f32 v89, 0, v89
    v_cvt_pk_bf16_f32 v90, 0, v90
    v_cvt_pk_bf16_f32 v91, 0, v91
    v_pk_add_f32 v[76:77], v[76:77], v[28:29]
    v_pk_add_f32 v[78:79], v[78:79], v[30:31]
    v_pk_add_f32 v[80:81], v[80:81], v[32:33]
    v_pk_add_f32 v[82:83], v[82:83], v[34:35]
    v_pk_add_f32 v[84:85], v[84:85], v[36:37]
    v_pk_add_f32 v[86:87], v[86:87], v[38:39]
    v_pk_add_f32 v[88:89], v[88:89], v[40:41]
    v_pk_add_f32 v[90:91], v[90:91], v[42:43]
    v_cvt_pk_bf16_f32 v140, v76, v77
    v_cvt_pk_bf16_f32 v141, v78, v79
    v_cvt_pk_bf16_f32 v142, v80, v81
    v_cvt_pk_bf16_f32 v143, v82, v83
    v_cvt_pk_bf16_f32 v144, v84, v85
    v_cvt_pk_bf16_f32 v145, v86, v87
    v_cvt_pk_bf16_f32 v146, v88, v89
    v_cvt_pk_bf16_f32 v147, v90, v91
    ds_write_b128 v23, v[140:143]
    ds_write_b128 v23, v[144:147] offset:16
    s_mul_i32 s96, s3, 2304
    s_add_u32 s16, s96, 139776
    v_lshrrev_b32 v23, 3, v1
    v_mul_u32_u24 v23, 144, v23
    v_and_b32 v9, 7, v1
    v_lshl_add_u32 v23, v9, 4, v23
    v_add_u32 v23, s16, v23
    s_add_u32 s13, s81, 12288
    s_lshl2_add_u32 m0, s89, 101376
    s_nop 0
    buffer_load_dwordx4 v73, s[60:63], s13 offen nt lds
    s_branch L_CSELD
L_CSEL:
    s_setprio 3
    ds_read_b128 v[148:151], v5
    s_lshl_b32 s96, s3, 9
    s_add_u32 s13, s96, 136704
    v_add_u32 v6, s13, v63
    s_lshl2_add_u32 s13, s3, 136384
    v_mov_b32 v7, s13
    s_waitcnt lgkmcnt(0)
    v_max_u32_dpp v152, v151, v148 quad_perm:[1,0,3,2] row_mask:0xf bank_mask:0xf
    v_max_u32_dpp v153, v150, v149 quad_perm:[1,0,3,2] row_mask:0xf bank_mask:0xf
    v_max_u32_dpp v154, v149, v150 quad_perm:[1,0,3,2] row_mask:0xf bank_mask:0xf
    v_max_u32_dpp v155, v148, v151 quad_perm:[1,0,3,2] row_mask:0xf bank_mask:0xf
    v_max_u32 v156, v152, v154
    v_max_u32 v157, v153, v155
    v_min_u32 v158, v152, v154
    v_min_u32 v159, v153, v155
    v_max_u32 v148, v156, v157
    v_min_u32 v149, v156, v157
    v_max_u32 v150, v158, v159
    v_min_u32 v151, v158, v159
    s_nop 1
    v_max_u32_dpp v152, v151, v148 quad_perm:[2,3,0,1] row_mask:0xf bank_mask:0xf
    v_max_u32_dpp v153, v150, v149 quad_perm:[2,3,0,1] row_mask:0xf bank_mask:0xf
    v_max_u32_dpp v154, v149, v150 quad_perm:[2,3,0,1] row_mask:0xf bank_mask:0xf
    v_max_u32_dpp v155, v148, v151 quad_perm:[2,3,0,1] row_mask:0xf bank_mask:0xf
    v_max_u32 v156, v152, v154
    v_max_u32 v157, v153, v155
    v_min_u32 v158, v152, v154
    v_min_u32 v159, v153, v155
    v_max_u32 v148, v156, v157
    v_min_u32 v149, v156, v157
    v_max_u32 v150, v158, v159
    v_min_u32 v151, v158, v159
    s_nop 1
    v_max_u32_dpp v152, v151, v148 row_half_mirror row_mask:0xf bank_mask:0xf
    v_max_u32_dpp v153, v150, v149 row_half_mirror row_mask:0xf bank_mask:0xf
    v_max_u32_dpp v154, v149, v150 row_half_mirror row_mask:0xf bank_mask:0xf
    v_max_u32_dpp v155, v148, v151 row_half_mirror row_mask:0xf bank_mask:0xf
    v_readfirstlane_b32 s24, v152
    v_readfirstlane_b32 s25, v153
    v_readfirstlane_b32 s26, v154
    v_readfirstlane_b32 s27, v155
    s_bitcmp1_b32 s3, 0
    s_cselect_b32 s24, s25, s24
    s_cselect_b32 s26, s27, s26
    s_bitcmp1_b32 s3, 1
    s_cselect_b32 s24, s26, s24
    s_and_b32 s15, s24, 4095
    s_lshr_b32 s96, s15, 8
    s_sub_u32 s97, 15, s96
    s_and_b32 s98, s15, 1
    s_lshl1_add_u32 s99, s97, s98
    s_lshl_b32 s96, s99, 14
    s_add_u32 s13, s96, 33554432
    buffer_load_dwordx2 v[152:153], v55, s[32:35], s13 offen sc1
    buffer_load_dwordx4 v[148:151], v54, s[32:35], s13 offen sc1
    s_setprio 0
    s_add_u32 s16, s81, 12288
    s_lshl2_add_u32 m0, s89, 101376
    s_nop 0
    buffer_load_dwordx4 v73, s[60:63], s16 offen nt lds
    ds_read_b64_tr_b16 v[164:165], v24
    ds_read_b64_tr_b16 v[166:167], v24 offset:512
    ds_read_b64_tr_b16 v[168:169], v24 offset:1024
    ds_read_b64_tr_b16 v[170:171], v24 offset:1536
    ds_read_b64_tr_b16 v[172:173], v24 offset:2048
    ds_read_b64_tr_b16 v[174:175], v24 offset:2560
    ds_read_b64_tr_b16 v[176:177], v24 offset:3072
    ds_read_b64_tr_b16 v[178:179], v24 offset:3584
    ds_read_b64_tr_b16 v[180:181], v24 offset:4096
    ds_read_b64_tr_b16 v[182:183], v24 offset:4608
    ds_read_b64_tr_b16 v[184:185], v24 offset:5120
    ds_read_b64_tr_b16 v[186:187], v24 offset:5632
    ds_read_b64_tr_b16 v[188:189], v24 offset:6144
    ds_read_b64_tr_b16 v[190:191], v24 offset:6656
    ds_read_b64_tr_b16 v[192:193], v24 offset:7168
    ds_read_b64_tr_b16 v[194:195], v24 offset:7680
    v_mul_u32_u24_dpp v92, v70, v52 row_newbcast:0 row_mask:0xf bank_mask:0xf
    v_and_b32_dpp v93, v70, v53 row_newbcast:0 row_mask:0xf bank_mask:0xf
    v_mul_u32_u24_dpp v94, v70, v52 row_newbcast:1 row_mask:0xf bank_mask:0xf
    v_and_b32_dpp v95, v70, v53 row_newbcast:1 row_mask:0xf bank_mask:0xf
    v_mul_u32_u24_dpp v96, v70, v52 row_newbcast:2 row_mask:0xf bank_mask:0xf
    v_and_b32_dpp v97, v70, v53 row_newbcast:2 row_mask:0xf bank_mask:0xf
    v_mul_u32_u24_dpp v98, v70, v52 row_newbcast:3 row_mask:0xf bank_mask:0xf
    v_and_b32_dpp v99, v70, v53 row_newbcast:3 row_mask:0xf bank_mask:0xf
    v_mul_u32_u24_dpp v100, v70, v52 row_newbcast:4 row_mask:0xf bank_mask:0xf
    v_and_b32_dpp v101, v70, v53 row_newbcast:4 row_mask:0xf bank_mask:0xf
    v_mul_u32_u24_dpp v102, v70, v52 row_newbcast:5 row_mask:0xf bank_mask:0xf
    v_and_b32_dpp v103, v70, v53 row_newbcast:5 row_mask:0xf bank_mask:0xf
    v_mul_u32_u24_dpp v104, v70, v52 row_newbcast:6 row_mask:0xf bank_mask:0xf
    v_and_b32_dpp v105, v70, v53 row_newbcast:6 row_mask:0xf bank_mask:0xf
    v_mul_u32_u24_dpp v106, v70, v52 row_newbcast:7 row_mask:0xf bank_mask:0xf
    v_and_b32_dpp v107, v70, v53 row_newbcast:7 row_mask:0xf bank_mask:0xf
    v_pk_mul_f32 v[76:77], v[76:77], v[92:93]
    v_pk_mul_f32 v[78:79], v[78:79], v[94:95]
    v_pk_mul_f32 v[80:81], v[80:81], v[96:97]
    v_pk_mul_f32 v[82:83], v[82:83], v[98:99]
    v_pk_mul_f32 v[84:85], v[84:85], v[100:101]
    v_pk_mul_f32 v[86:87], v[86:87], v[102:103]
    v_pk_mul_f32 v[88:89], v[88:89], v[104:105]
    v_pk_mul_f32 v[90:91], v[90:91], v[106:107]
    v_cvt_pk_bf16_f32 v76, 0, v76
    v_cvt_pk_bf16_f32 v77, 0, v77
    v_cvt_pk_bf16_f32 v78, 0, v78
    v_cvt_pk_bf16_f32 v79, 0, v79
    v_cvt_pk_bf16_f32 v80, 0, v80
    v_cvt_pk_bf16_f32 v81, 0, v81
    v_cvt_pk_bf16_f32 v82, 0, v82
    v_cvt_pk_bf16_f32 v83, 0, v83
    v_cvt_pk_bf16_f32 v84, 0, v84
    v_cvt_pk_bf16_f32 v85, 0, v85
    v_cvt_pk_bf16_f32 v86, 0, v86
    v_cvt_pk_bf16_f32 v87, 0, v87
    v_cvt_pk_bf16_f32 v88, 0, v88
    v_cvt_pk_bf16_f32 v89, 0, v89
    v_cvt_pk_bf16_f32 v90, 0, v90
    v_cvt_pk_bf16_f32 v91, 0, v91
    v_pk_add_f32 v[76:77], v[76:77], v[28:29]
    v_pk_add_f32 v[78:79], v[78:79], v[30:31]
    v_pk_add_f32 v[80:81], v[80:81], v[32:33]
    v_pk_add_f32 v[82:83], v[82:83], v[34:35]
    v_pk_add_f32 v[84:85], v[84:85], v[36:37]
    v_pk_add_f32 v[86:87], v[86:87], v[38:39]
    v_pk_add_f32 v[88:89], v[88:89], v[40:41]
    v_pk_add_f32 v[90:91], v[90:91], v[42:43]
    v_cvt_pk_bf16_f32 v140, v76, v77
    v_cvt_pk_bf16_f32 v141, v78, v79
    v_cvt_pk_bf16_f32 v142, v80, v81
    v_cvt_pk_bf16_f32 v143, v82, v83
    v_cvt_pk_bf16_f32 v144, v84, v85
    v_cvt_pk_bf16_f32 v145, v86, v87
    v_cvt_pk_bf16_f32 v146, v88, v89
    v_cvt_pk_bf16_f32 v147, v90, v91
    ds_write_b128 v23, v[140:143]
    ds_write_b128 v23, v[144:147] offset:16
    s_mul_i32 s96, s3, 2304
    s_add_u32 s16, s96, 139776
    v_lshrrev_b32 v23, 3, v1
    v_mul_u32_u24 v23, 144, v23
    v_and_b32 v9, 7, v1
    v_lshl_add_u32 v23, v9, 4, v23
    v_add_u32 v23, s16, v23
    s_lshl2_add_u32 s15, s15, s3
    s_waitcnt vmcnt(1)
    v_bitop3_b32 v8, v149, v151, s4 bitop3:0x7e
    v_bitop3_b32 v8, v8, v153, s4 bitop3:0xf6
    v_cmp_ne_u32 vcc, 0, v8
    s_cbranch_vccz TOK_49
POLL_50:
    buffer_load_dwordx2 v[152:153], v55, s[32:35], s13 offen sc1
    buffer_load_dwordx4 v[148:151], v54, s[32:35], s13 offen sc1
    s_waitcnt vmcnt(0)
    v_bitop3_b32 v8, v149, v151, s4 bitop3:0x7e
    v_bitop3_b32 v8, v8, v153, s4 bitop3:0xf6
    v_cmp_ne_u32 vcc, 0, v8
    s_cbranch_vccz PDONE_51
    s_add_u32 s5, s5, 1
    s_cmp_lt_u32 s5, 300000
    s_cbranch_scc1 POLL_50
PDONE_51:
TOK_49:
    s_setprio 3
    ds_write2_b32 v6, v148, v150 offset0:0 offset1:1
    v_add_f32_dpp v152, v152, v152 quad_perm:[1,0,3,2] row_mask:0xf bank_mask:0xf
    s_nop 1
    v_add_f32_dpp v152, v152, v152 quad_perm:[2,3,0,1] row_mask:0xf bank_mask:0xf
    s_nop 1
    v_add_f32_dpp v152, v152, v152 row_half_mirror row_mask:0xf bank_mask:0xf
    s_nop 1
    v_add_f32_dpp v152, v152, v152 row_ror:8 row_mask:0xf bank_mask:0xf
    v_cvt_pk_bf16_f32 v152, 0, v152
    v_ashrrev_i32 v153, 31, v152
    v_or_b32 v153, 0x80000000, v153
    v_xor_b32 v152, v152, v153
    v_and_b32 v152, s6, v152
    v_or_b32 v152, s15, v152
    ds_write_b32 v7, v152
    s_setprio 0
L_CSELD:
    v_mov_b32 v4, 136384
    s_waitcnt lgkmcnt(0)
    s_barrier
    ds_read_b128 v[148:151], v4
    s_waitcnt lgkmcnt(0)
    v_max_u32 v152, v148, v149
    v_max_u32 v153, v150, v151
    v_min_u32 v154, v148, v149
    v_min_u32 v155, v150, v151
    v_min_u32 v149, v152, v153
    v_max_u32 v148, v152, v153
    v_max3_u32 v149, v149, v154, v155
    v_cndmask_b32 v4, v149, v148, s[22:23]
    v_readfirstlane_b32 s68, v148
    v_and_b32 v4, 3, v4
    v_readfirstlane_b32 s69, v149
    v_lshl_add_u32 v4, v4, 9, v46
    ds_read_b128 v[152:155], v4
    ds_read_b128 v[140:143], v23
    ds_read_b128 v[144:147], v23 offset:1152
    s_bfe_u32 s70, s68, 720899
    s_bfe_u32 s71, s69, 720899
    s_sub_u32 s70, 2047, s70
    s_sub_u32 s71, 2047, s71
    s_waitcnt lgkmcnt(2)
    v_mfma_f32_16x16x32_bf16 v[212:215], v[152:155], v[164:167], 0
    v_mfma_f32_16x16x32_bf16 v[216:219], v[152:155], v[168:171], 0
    v_mfma_f32_16x16x32_bf16 v[220:223], v[152:155], v[172:175], 0
    v_mfma_f32_16x16x32_bf16 v[224:227], v[152:155], v[176:179], 0
    v_mfma_f32_16x16x32_bf16 v[228:231], v[152:155], v[180:183], 0
    v_mfma_f32_16x16x32_bf16 v[232:235], v[152:155], v[184:187], 0
    v_mfma_f32_16x16x32_bf16 v[236:239], v[152:155], v[188:191], 0
    v_mfma_f32_16x16x32_bf16 v[240:243], v[152:155], v[192:195], 0
    s_nop 1
    v_add_f32 v148, v212, v217
    s_nop 0
    v_add_f32 v149, v222, v227
    s_nop 0
    v_add_f32 v150, v228, v233
    s_nop 0
    v_add_f32 v151, v238, v243
    v_add_f32 v148, v148, v149
    v_add_f32 v150, v150, v151
    s_nop 1
    v_permlane16_swap_b32 v150, v151
    v_add_f32 v56, v148, v151
    v_add_f32 v58, v148, v151
    v_mov_b32 v57, s4
    v_mov_b32 v59, s4
    v_permlane32_swap_b32 v56, v58
    s_cmp_ge_u32 s9, 28
    s_cbranch_scc1 L_NOHP
    s_mov_b64 exec, 0xffff
    s_cmp_lg_u32 s93, 0
    s_cbranch_scc1 LOC_52
    buffer_store_dwordx4 v[56:59], v2, s[32:35], s20 offen sc1
    s_branch LOCD_53
LOC_52:
    buffer_store_dwordx4 v[56:59], v2, s[32:35], s20 offen
LOCD_53:
    s_mov_b64 exec, -1
L_NOHP:
    v_add_u32 v60, s20, v2
    s_waitcnt lgkmcnt(0)
    s_bitcmp1_b32 s21, 2
    s_cselect_b32 s17, s71, s70
    s_cselect_b32 s18, s69, s68
    s_cmp_lg_u32 s3, 7
    s_cbranch_scc1 L_NOFZ
    s_cmp_lg_u32 s2, 0
    s_cbranch_scc1 L_NONON
    v_mov_b32 v6, s4
    s_mov_b64 exec, 1
    buffer_store_dword v6, v3, s[32:35], 0 offen sc1
    s_mov_b64 exec, -1
L_NONON:
    s_lshr_b32 s96, s21, 3
    s_and_b32 s97, s21, 1
    s_lshl1_add_u32 s19, s96, s97
    s_lshr_b32 s96, s21, 2
    s_lshl_b32 s97, s96, 1
    s_lshl3_add_u32 s98, s12, s97
    s_and_b32 s99, s21, 1
    s_add_u32 s96, s98, s99
    s_mul_i32 s97, s96, 7168
    s_add_u32 s20, s97, 22020096
    s_lshl_b32 s96, s17, 11
    s_lshl_b32 s97, s12, 7
    s_add_u32 s98, s96, s97
    s_lshl_b32 s99, s19, 5
    s_add_u32 s82, s98, s99
    v_and_b32 v10, 1, v1
    v_lshlrev_b32 v10, 2, v10
    v_bfe_u32 v9, v1, 2, 1
    v_lshl_add_u32 v10, v9, 3, v10
    v_bfe_u32 v9, v1, 1, 1
    v_lshl_add_u32 v10, v9, 4, v10
    s_lshl_b32 s96, s19, 5
    s_add_u32 s13, s96, 139264
    v_add_u32 v5, s13, v10
    ds_read_b32 v74, v5
    s_lshr_b32 s96, s17, 7
    s_bfe_u32 s97, s18, 65538
    s_lshl1_add_u32 s98, s96, s97
    s_lshl_b32 s99, s98, 14
    s_lshl_b32 s96, s12, 8
    s_add_u32 s97, s99, s96
    s_lshl_b32 s98, s19, 6
    s_add_u32 s99, s97, s98
    s_add_u32 s68, s99, 33554432
    s_add_u32 s69, s68, 4096
    v_and_b32 v11, 1, v1
    v_lshlrev_b32 v11, 3, v11
    v_bfe_u32 v9, v1, 2, 1
    v_lshl_add_u32 v11, v9, 4, v11
    v_bfe_u32 v9, v1, 1, 1
    v_lshl_add_u32 v11, v9, 5, v11
    buffer_load_dwordx2 v[20:21], v11, s[32:35], s68 offen sc1
    buffer_load_dwordx2 v[72:73], v11, s[32:35], s69 offen sc1
    s_and_b32 s13, s18, s6
    s_ashr_i32 s15, s13, 31
    s_andn2_b32 s15, 0x7fff0000, s15
    s_or_b32 s15, s15, 0x80000000
    s_xor_b32 s13, s13, s15
    v_mov_b32 v75, s13
    v_mul_f32 v75, s7, v75
    v_exp_f32 v75, -v75
    s_nop 0
    v_add_f32 v75, 1.0, v75
    v_rcp_f32 v75, v75
    s_nop 0
    v_cvt_pk_bf16_f32 v75, 0, v75
L_NOFZ:
    s_cmp_lt_u32 s9, 28
    s_cbranch_scc1 L_HSEC
    s_branch L_GSEC
L_HSEC:
    s_cmp_lt_u32 s3, 4
    s_cbranch_scc1 L_HW
    v_bfe_u32 v25, v1, 2, 1
    v_lshlrev_b32 v25, 7, v25
    v_lshrrev_b32 v9, 5, v1
    v_lshl_add_u32 v25, v9, 4, v25
    v_add_u32 v25, 138752, v25
    v_lshrrev_b32 v26, 4, v1
    v_mul_u32_u24 v26, 7168, v26
    v_and_b32 v9, 7, v1
    v_lshl_add_u32 v26, v9, 4, v26
    v_and_b32 v27, 1, v1
    v_lshlrev_b32 v27, 18, v27
    v_bfe_u32 v9, v1, 1, 1
    v_lshl_add_u32 v27, v9, 13, v27
    s_lshl3_add_u32 s96, s75, s3
    s_mul_i32 s97, s96, 28672
    s_lshl_b32 s98, s74, 7
    s_add_u32 s99, s97, s98
    s_add_u32 s84, s99, 22020096
    s_lshr_b32 s96, s9, 2
    s_and_b32 s97, s75, 1
    s_lshr_b32 s98, s3, 1
    s_lshl2_add_u32 s99, s97, s98
    s_and_b32 s97, s3, 1
    s_lshl_b32 s98, s97, 2
    s_lshl3_add_u32 s97, s99, s98
    s_lshr_b32 s99, s75, 1
    s_add_u32 s98, s97, s99
    s_lshl_b32 s97, s98, 12
    s_lshl_b32 s99, s8, 6
    s_add_u32 s98, s97, s99
    s_lshl2_add_u32 s97, s96, s98
    s_add_u32 s99, s97, 1048576
    s_add_u32 s85, s99, 3072
    s_branch L_NOH
L_HW:
    s_lshl_b32 s96, s3, 8
    s_add_u32 s13, s96, s84
    v_lshrrev_b32 v4, 4, v1
    v_lshlrev_b32 v4, 11, v4
    v_and_b32 v9, 15, v1
    v_lshl_add_u32 v4, v9, 4, v4
    s_lshl_b32 s96, s3, 5
    s_add_u32 s15, s96, 138752
    v_lshrrev_b32 v5, 5, v1
    v_lshl_add_u32 v5, v5, 7, s15
    v_bfe_u32 v9, v1, 2, 1
    v_lshl_add_u32 v5, v9, 4, v5
    v_bfe_u32 v9, v1, 1, 1
    v_lshl_add_u32 v5, v9, 3, v5
    v_bfe_u32 v9, v1, 3, 1
    v_lshl_add_u32 v5, v9, 2, v5
    v_and_b32 v9, 1, v1
    v_lshl_add_u32 v5, v9, 1, v5
    s_cmp_lg_u32 s93, 0
    s_cbranch_scc1 L_HLOC
SPOLL_54:
    s_load_dword s24, s[32:33], s13 offset:1276 glc
    s_load_dword s25, s[32:33], s13 offset:3324 glc
    s_load_dword s26, s[32:33], s13 offset:5372 glc
    s_load_dword s27, s[32:33], s13 offset:7420 glc
SCHK_55:
    s_add_u32 s5, s5, 1
    s_cmp_ge_u32 s5, 300000
    s_waitcnt lgkmcnt(0)
    s_cbranch_scc1 SDONE_56
    s_cmp_lg_u32 s24, s4
    s_cbranch_scc1 SPOLL_54
    s_cmp_lg_u32 s25, s4
    s_cbranch_scc1 SPOLL_54
    s_cmp_lg_u32 s26, s4
    s_cbranch_scc1 SPOLL_54
    s_cmp_lg_u32 s27, s4
    s_cbranch_scc1 SPOLL_54
SDONE_56:
L_HLOC:
    buffer_load_dwordx4 v[212:215], v4, s[32:35], s13 offen sc1
    buffer_load_dwordx4 v[216:219], v4, s[32:35], s13 offen offset:1024 sc1
    v_bfe_u32 v25, v1, 2, 1
    v_lshlrev_b32 v25, 7, v25
    v_lshrrev_b32 v9, 5, v1
    v_lshl_add_u32 v25, v9, 4, v25
    v_add_u32 v25, 138752, v25
    v_lshrrev_b32 v26, 4, v1
    v_mul_u32_u24 v26, 7168, v26
    v_and_b32 v9, 7, v1
    v_lshl_add_u32 v26, v9, 4, v26
    v_and_b32 v27, 1, v1
    v_lshlrev_b32 v27, 18, v27
    v_bfe_u32 v9, v1, 1, 1
    v_lshl_add_u32 v27, v9, 13, v27
    s_lshl3_add_u32 s96, s75, s3
    s_mul_i32 s97, s96, 28672
    s_lshl_b32 s98, s74, 7
    s_add_u32 s99, s97, s98
    s_add_u32 s84, s99, 22020096
    s_lshr_b32 s96, s9, 2
    s_and_b32 s97, s75, 1
    s_lshr_b32 s98, s3, 1
    s_lshl2_add_u32 s99, s97, s98
    s_and_b32 s97, s3, 1
    s_lshl_b32 s98, s97, 2
    s_lshl3_add_u32 s97, s99, s98
    s_lshr_b32 s99, s75, 1
    s_add_u32 s98, s97, s99
    s_lshl_b32 s97, s98, 12
    s_lshl_b32 s99, s8, 6
    s_add_u32 s98, s97, s99
    s_lshl2_add_u32 s97, s96, s98
    s_add_u32 s99, s97, 1048576
    s_add_u32 s85, s99, 3072
    s_waitcnt vmcnt(0)
    v_bitop3_b32 v6, v213, v215, s4 bitop3:0x7e
    v_bitop3_b32 v6, v6, v217, s4 bitop3:0xf6
    v_bitop3_b32 v6, v6, v219, s4 bitop3:0xf6
    v_cmp_ne_u32 vcc, 0, v6
    s_cbranch_vccz TOK_58
POLL_59:
    buffer_load_dwordx4 v[212:215], v4, s[32:35], s13 offen sc1
    buffer_load_dwordx4 v[216:219], v4, s[32:35], s13 offen offset:1024 sc1
    s_waitcnt vmcnt(0)
    v_bitop3_b32 v6, v213, v215, s4 bitop3:0x7e
    v_bitop3_b32 v6, v6, v217, s4 bitop3:0xf6
    v_bitop3_b32 v6, v6, v219, s4 bitop3:0xf6
    v_cmp_ne_u32 vcc, 0, v6
    s_cbranch_vccz PDONE_60
    s_add_u32 s5, s5, 1
    s_cmp_lt_u32 s5, 300000
    s_cbranch_scc1 POLL_59
PDONE_60:
TOK_58:
    v_permlane32_swap_b32 v212, v214
    v_permlane32_swap_b32 v216, v218
    v_add_f32 v212, v212, v214
    v_add_f32 v216, v216, v218
    v_mov_b32 v214, v212
    v_mov_b32 v218, v216
    s_nop 0
    v_permlane16_swap_b32 v212, v214
    v_permlane16_swap_b32 v216, v218
    v_add_f32 v212, v212, v214
    v_add_f32 v216, v216, v218
    v_cvt_pk_bf16_f32 v212, 0, v212
    v_cvt_pk_bf16_f32 v216, 0, v216
    v_mul_f32 v6, s7, v212
    v_exp_f32 v6, -v6
    s_nop 0
    v_add_f32 v6, 1.0, v6
    v_rcp_f32 v6, v6
    s_nop 0
    v_mul_f32 v212, v212, v6
    v_cvt_pk_bf16_f32 v212, 0, v212
    v_mul_f32 v212, v212, v216
    v_cvt_pk_bf16_f32 v212, v212, v212
    ds_write_b16 v5, v212
L_NOH:
    s_waitcnt vmcnt(0)
    s_waitcnt lgkmcnt(0)
    s_barrier
    ds_read_b128 v[212:215], v25
    ds_read_b64_tr_b16 v[196:197], v45
    ds_read_b64_tr_b16 v[198:199], v45 offset:1024
    ds_read_b128 v[216:219], v25 offset:32
    ds_read_b64_tr_b16 v[200:201], v45 offset:8192
    ds_read_b64_tr_b16 v[202:203], v45 offset:9216
    ds_read_b128 v[220:223], v25 offset:64
    ds_read_b64_tr_b16 v[204:205], v45 offset:16384
    ds_read_b64_tr_b16 v[206:207], v45 offset:17408
    ds_read_b128 v[224:227], v25 offset:96
    ds_read_b64_tr_b16 v[208:209], v45 offset:24576
    ds_read_b64_tr_b16 v[210:211], v45 offset:25600
    s_waitcnt lgkmcnt(9)
    v_mfma_f32_32x32x16_bf16 v[228:243], v[212:215], v[196:199], 0
    s_waitcnt lgkmcnt(6)
    v_mfma_f32_32x32x16_bf16 v[228:243], v[216:219], v[200:203], v[228:243]
    s_waitcnt lgkmcnt(3)
    v_mfma_f32_32x32x16_bf16 v[228:243], v[220:223], v[204:207], v[228:243]
    s_waitcnt lgkmcnt(0)
    v_mfma_f32_32x32x16_bf16 v[228:243], v[224:227], v[208:211], v[228:243]
    s_nop 11
    v_mov_b32_dpp v230, v228 row_ror:8 row_mask:0xf bank_mask:0xf
    v_mov_b32 v229, s4
    v_mov_b32 v231, s4
    s_mov_b32 exec_lo, 0x00ff00ff
    s_mov_b32 exec_hi, 0x00ff00ff
    buffer_store_dwordx4 v[228:231], v26, s[32:35], s84 offen sc1
    s_mov_b64 exec, 15
    buffer_store_dword v229, v27, s[32:35], s85 offen sc1
    s_mov_b64 exec, -1
    s_waitcnt lgkmcnt(0)
L_GSEC:
    s_lshl_b32 s96, s21, 7
    s_lshl4_add_u32 s13, s3, s96
    v_lshrrev_b32 v22, 3, v1
    v_lshl_add_u32 v22, v22, 0, s13
    s_lshl_b32 s96, s13, 11
    s_lshl_b32 s97, s12, 7
    s_add_u32 s15, s96, s97
    s_add_u32 s16, s15, 16384
    v_lshrrev_b32 v47, 3, v1
    v_lshlrev_b32 v47, 11, v47
    v_and_b32 v9, 7, v1
    v_lshl_add_u32 v47, v9, 4, v47
    v_cmp_ne_u32 vcc, s70, v22
    v_cmp_ne_u32 s[22:23], s71, v22
    s_nop 0
    s_and_b64 exec, vcc, s[22:23]
    buffer_store_dwordx4 v[140:143], v47, s[64:67], s15 offen sc1
    s_mov_b64 exec, -1
    v_add_u32 v22, 8, v22
    v_cmp_ne_u32 vcc, s70, v22
    v_cmp_ne_u32 s[22:23], s71, v22
    s_nop 0
    s_and_b64 exec, vcc, s[22:23]
    buffer_store_dwordx4 v[144:147], v47, s[64:67], s16 offen sc1
    s_mov_b64 exec, -1
    s_cmp_lt_u32 s9, 16
    s_cbranch_scc1 L_GF
    s_cmp_ge_u32 s9, 28
    s_cbranch_scc1 L_FIN
    s_waitcnt vmcnt(0)
    s_mov_b64 exec, 0xffff
    buffer_store_dwordx4 v[56:59], v60, s[32:35], 0 offen sc1
    s_mov_b64 exec, -1
    s_branch L_FIN
L_GF:
SPOLL_61:
    s_load_dwordx8 s[24:31], s[32:33], s92 offset:3072 glc
SCHK_62:
    s_add_u32 s5, s5, 1
    s_cmp_ge_u32 s5, 300000
    s_waitcnt lgkmcnt(0)
    s_cbranch_scc1 SDONE_63
    s_cmp_lg_u32 s24, s4
    s_cbranch_scc1 SPOLL_61
    s_cmp_lg_u32 s25, s4
    s_cbranch_scc1 SPOLL_61
    s_cmp_lg_u32 s26, s4
    s_cbranch_scc1 SPOLL_61
    s_cmp_lg_u32 s27, s4
    s_cbranch_scc1 SPOLL_61
    s_cmp_lg_u32 s28, s4
    s_cbranch_scc1 SPOLL_61
    s_cmp_lg_u32 s29, s4
    s_cbranch_scc1 SPOLL_61
    s_cmp_lg_u32 s30, s4
    s_cbranch_scc1 SPOLL_61
SDONE_63:
    s_barrier
    s_cmp_eq_u32 s3, 7
    s_cbranch_scc1 L_G7
    s_barrier
    s_mov_b64 exec, 0xffff
    buffer_store_dwordx4 v[56:59], v60, s[32:35], 0 offen sc1
    s_mov_b64 exec, -1
    s_branch L_FIN
L_G7:
    s_cmp_lg_u32 s3, 7
    s_cbranch_scc1 L_FIN
    s_add_u32 s13, s20, 4096
    buffer_load_dwordx4 v[212:215], v2, s[32:35], s20 offen sc1
    buffer_load_dwordx4 v[216:219], v2, s[32:35], s20 offen offset:1024 sc1
    buffer_load_dwordx4 v[220:223], v2, s[32:35], s20 offen offset:2048 sc1
    buffer_load_dwordx4 v[224:227], v2, s[32:35], s20 offen offset:3072 sc1
    buffer_load_dwordx4 v[148:151], v2, s[32:35], s13 offen sc1
    buffer_load_dwordx4 v[152:155], v2, s[32:35], s13 offen offset:1024 sc1
    buffer_load_dwordx4 v[156:159], v2, s[32:35], s13 offen offset:2048 sc1
    s_waitcnt vmcnt(7)
    v_bitop3_b32 v4, v21, v73, s4 bitop3:0x7e
    v_cmp_ne_u32 vcc, 0, v4
    s_cbranch_vccz TOK_65
POLL_66:
    buffer_load_dwordx2 v[20:21], v11, s[32:35], s68 offen sc1
    buffer_load_dwordx2 v[72:73], v11, s[32:35], s69 offen sc1
    s_waitcnt vmcnt(0)
    v_bitop3_b32 v4, v21, v73, s4 bitop3:0x7e
    v_cmp_ne_u32 vcc, 0, v4
    s_cbranch_vccz PDONE_67
    s_add_u32 s5, s5, 1
    s_cmp_lt_u32 s5, 300000
    s_cbranch_scc1 POLL_66
PDONE_67:
TOK_65:
    v_lshlrev_b32 v244, 16, v20
    v_and_b32 v245, s6, v20
    v_lshlrev_b32 v246, 16, v74
    v_and_b32 v247, s6, v74
    v_lshlrev_b32 v248, 16, v72
    v_and_b32 v249, s6, v72
    s_waitcnt vmcnt(0)
    v_bitop3_b32 v4, v213, v215, s4 bitop3:0x7e
    v_bitop3_b32 v4, v4, v217, s4 bitop3:0xf6
    v_bitop3_b32 v4, v4, v219, s4 bitop3:0xf6
    v_bitop3_b32 v4, v4, v221, s4 bitop3:0xf6
    v_bitop3_b32 v4, v4, v223, s4 bitop3:0xf6
    v_bitop3_b32 v4, v4, v225, s4 bitop3:0xf6
    v_bitop3_b32 v4, v4, v227, s4 bitop3:0xf6
    v_bitop3_b32 v4, v4, v149, s4 bitop3:0xf6
    v_bitop3_b32 v4, v4, v151, s4 bitop3:0xf6
    v_bitop3_b32 v4, v4, v153, s4 bitop3:0xf6
    v_bitop3_b32 v4, v4, v155, s4 bitop3:0xf6
    v_bitop3_b32 v4, v4, v157, s4 bitop3:0xf6
    v_bitop3_b32 v4, v4, v159, s4 bitop3:0xf6
    v_cmp_ne_u32 vcc, 0, v4
    s_cbranch_vccz TOK_68
POLL_69:
    buffer_load_dwordx4 v[212:215], v2, s[32:35], s20 offen sc1
    buffer_load_dwordx4 v[216:219], v2, s[32:35], s20 offen offset:1024 sc1
    buffer_load_dwordx4 v[220:223], v2, s[32:35], s20 offen offset:2048 sc1
    buffer_load_dwordx4 v[224:227], v2, s[32:35], s20 offen offset:3072 sc1
    buffer_load_dwordx4 v[148:151], v2, s[32:35], s13 offen sc1
    buffer_load_dwordx4 v[152:155], v2, s[32:35], s13 offen offset:1024 sc1
    buffer_load_dwordx4 v[156:159], v2, s[32:35], s13 offen offset:2048 sc1
    s_waitcnt vmcnt(0)
    v_bitop3_b32 v4, v213, v215, s4 bitop3:0x7e
    v_bitop3_b32 v4, v4, v217, s4 bitop3:0xf6
    v_bitop3_b32 v4, v4, v219, s4 bitop3:0xf6
    v_bitop3_b32 v4, v4, v221, s4 bitop3:0xf6
    v_bitop3_b32 v4, v4, v223, s4 bitop3:0xf6
    v_bitop3_b32 v4, v4, v225, s4 bitop3:0xf6
    v_bitop3_b32 v4, v4, v227, s4 bitop3:0xf6
    v_bitop3_b32 v4, v4, v149, s4 bitop3:0xf6
    v_bitop3_b32 v4, v4, v151, s4 bitop3:0xf6
    v_bitop3_b32 v4, v4, v153, s4 bitop3:0xf6
    v_bitop3_b32 v4, v4, v155, s4 bitop3:0xf6
    v_bitop3_b32 v4, v4, v157, s4 bitop3:0xf6
    v_bitop3_b32 v4, v4, v159, s4 bitop3:0xf6
    v_cmp_ne_u32 vcc, 0, v4
    s_cbranch_vccz PDONE_70
    s_add_u32 s5, s5, 1
    s_cmp_lt_u32 s5, 300000
    s_cbranch_scc1 POLL_69
PDONE_70:
TOK_68:
    s_barrier
    v_add_f32 v212, v212, v216
    v_add_f32 v214, v214, v218
    v_add_f32 v220, v220, v224
    v_add_f32 v222, v222, v226
    v_add_f32 v148, v148, v152
    v_add_f32 v150, v150, v154
    v_add_f32 v212, v212, v220
    v_add_f32 v214, v214, v222
    v_add_f32 v148, v148, v156
    v_add_f32 v150, v150, v158
    v_add_f32 v212, v212, v148
    v_add_f32 v214, v214, v150
    v_mov_b32 v213, v214
    v_add_f32_dpp v212, v212, v212 row_ror:8 row_mask:0xf bank_mask:0xf
    s_nop 0
    v_add_f32_dpp v213, v213, v213 row_ror:8 row_mask:0xf bank_mask:0xf
    v_mov_b32 v214, v212
    v_mov_b32 v215, v213
    s_nop 0
    v_permlane16_swap_b32 v212, v214
    v_permlane16_swap_b32 v213, v215
    v_pk_add_f32 v[212:213], v[212:213], v[214:215]
    v_mov_b32 v214, v212
    v_mov_b32 v215, v213
    s_nop 0
    v_permlane32_swap_b32 v212, v214
    v_permlane32_swap_b32 v213, v215
    v_pk_add_f32 v[212:213], v[212:213], v[214:215]
    s_nop 1
    v_mov_b32_dpp v214, v212 quad_perm:[0,2,0,2] row_mask:0xf bank_mask:0xf
    v_mov_b32_dpp v215, v212 quad_perm:[1,3,1,3] row_mask:0xf bank_mask:0xf
    v_mov_b32_dpp v212, v213 quad_perm:[0,2,0,2] row_mask:0xf bank_mask:0xf
    v_mov_b32_dpp v213, v213 quad_perm:[1,3,1,3] row_mask:0xf bank_mask:0xf
    s_mov_b32 exec_lo, 0x33333333
    v_mov_b32 v212, v214
    v_mov_b32 v213, v215
    s_mov_b32 exec_lo, -1
    v_cvt_pk_bf16_f32 v212, 0, v212
    v_cvt_pk_bf16_f32 v213, 0, v213
    v_pk_mul_f32 v[212:213], v[212:213], v[74:75] op_sel:[0,1]
    v_cvt_pk_bf16_f32 v212, 0, v212
    v_cvt_pk_bf16_f32 v213, 0, v213
    v_pk_add_f32 v[212:213], v[212:213], v[244:245]
    v_cvt_pk_bf16_f32 v212, 0, v212
    v_cvt_pk_bf16_f32 v213, 0, v213
    v_pk_mul_f32 v[212:213], v[212:213], v[246:247]
    v_cvt_pk_bf16_f32 v212, 0, v212
    v_cvt_pk_bf16_f32 v213, 0, v213
    v_pk_add_f32 v[212:213], v[212:213], v[248:249]
    v_cvt_pk_bf16_f32 v212, v212, v213
    s_mov_b64 exec, 0xff
    buffer_store_dword v212, v10, s[64:67], s82 offen sc1
    s_mov_b64 exec, -1
    s_mov_b64 exec, 0xffff
    buffer_store_dwordx4 v[56:59], v60, s[32:35], 0 offen sc1
    s_mov_b64 exec, -1
L_FIN:
L_END:
    s_endpgm
.p2align 10
.fill 768, 4, 0xbf800000
.section .rodata,"a"
.p2align 6
.amdhsa_kernel adaLN_cond__linear_kernel_hedgehog__moe_arch_mod__prompt_kernel
  .amdhsa_next_free_vgpr 256
  .amdhsa_next_free_sgpr 102
  .amdhsa_accum_offset 256
  .amdhsa_group_segment_fixed_size 0
  .amdhsa_kernarg_size 112
  .amdhsa_user_sgpr_count 2
  .amdhsa_user_sgpr_kernarg_segment_ptr 1
  .amdhsa_system_sgpr_workgroup_id_x 1
  .amdhsa_float_denorm_mode_32 3
  .amdhsa_float_denorm_mode_16_64 3
.end_amdhsa_kernel
```

```asm
; @launch grid=(256,1,1) block=(512,1,1) lds=163840
.amdgcn_target "amdgcn-amd-amdhsa--gfx950"
.text
.globl adaLN_cond__linear_kernel_hedgehog__moe_arch_mod__prompt_kernel
.p2align 8
.type adaLN_cond__linear_kernel_hedgehog__moe_arch_mod__prompt_kernel,@function
adaLN_cond__linear_kernel_hedgehog__moe_arch_mod__prompt_kernel:
    s_load_dwordx16 s[68:83], s[0:1], 0
    s_load_dwordx8 s[84:91], s[0:1], 64
    s_load_dwordx2 s[32:33], s[0:1], 104
    s_load_dwordx2 s[30:31], s[0:1], 96
    s_cmp_ge_u32 s2, 256
    s_cbranch_scc1 L_END
    v_lshrrev_b32 v4, 6, v0
    v_and_b32 v1, 63, v0
    v_mov_b32 v3, 0
    v_readfirstlane_b32 s3, v4
    v_lshlrev_b32 v2, 4, v1
    s_and_b32 s8, s2, 7
    s_lshr_b32 s9, s2, 3
    s_lshl2_add_u32 s96, s8, s3
    s_lshl_b32 s15, s96, 6
    s_mul_i32 s96, s15, 6144
    s_xor_b32 s97, s9, 1
    s_lshl_b32 s98, s97, 7
    s_add_u32 s13, s96, s98
    v_lshrrev_b32 v60, 3, v1
    v_mul_u32_u24 v60, 49152, v60
    v_and_b32 v9, 7, v1
    v_lshl_add_u32 v60, v9, 4, v60
    v_lshrrev_b32 v61, 3, v1
    v_lshl_add_u32 v61, v61, 3, s15
    s_lshl_b32 s96, s8, 5
    s_add_u32 s97, s96, s9
    s_lshl2_add_u32 s98, s97, s3
    s_sub_u32 s99, s98, 4
    s_lshl_b32 s16, s99, 12
    s_mov_b32 s50, 12582912
    s_mov_b32 s51, 0x20000
    s_mov_b32 s38, 4194304
    s_mov_b32 s39, 0x20000
    s_mov_b32 s34, 268435456
    s_mov_b32 s35, 0x20000
    s_getreg_b32 s94, hwreg(HW_REG_XCC_ID, 0, 3)
    s_getpc_b64 s[22:23]
    s_mul_i32 s96, s9, 7
    s_add_u32 s97, s96, s3
    s_lshl_b32 s19, s97, 7
    v_lshrrev_b32 v10, 5, v1
    v_mul_u32_u24 v10, 28672, v10
    v_add_u32 v10, s19, v10
    v_min_u32 v10, 45056, v10
    s_cmp_ge_u32 s3, 4
    s_waitcnt lgkmcnt(0)
    s_mov_b64 s[48:49], s[88:89]
    s_mov_b64 s[36:37], s[68:69]
    s_load_dword s4, s[32:33], 0
    s_cbranch_scc1 L_FS
    global_load_dwordx2 v[96:97], v61, s[86:87]
    buffer_load_dwordx4 v[80:83], v60, s[48:51], s13 offen nt
    s_add_u32 s13, s13, 12288
    buffer_load_dwordx4 v[84:87], v60, s[48:51], s13 offen nt
    s_add_u32 s13, s13, 12288
    buffer_load_dwordx4 v[88:91], v60, s[48:51], s13 offen nt
    s_add_u32 s13, s13, 12288
    buffer_load_dwordx4 v[92:95], v60, s[48:51], s13 offen nt
    s_barrier
    s_barrier
    s_and_b32 s22, s22, 0xfffffc00
    global_load_dword v78, v10, s[22:23]
    s_mov_b32 s42, 6291456
    s_mov_b32 s43, 0x20000
    s_mov_b32 s46, 2097152
    s_mov_b32 s47, 0x20000
    s_mov_b32 s54, 7340032
    s_mov_b32 s55, 0x20000
    s_mov_b32 s58, 7340032
    s_mov_b32 s59, 0x20000
    s_mov_b32 s62, 7340032
    s_mov_b32 s63, 0x20000
    s_mov_b32 s66, 4194304
    s_mov_b32 s67, 0x20000
    s_mov_b64 s[40:41], s[70:71]
    s_mov_b64 s[44:45], s[74:75]
    s_mov_b64 s[52:53], s[80:81]
    s_mov_b64 s[56:57], s[82:83]
    s_mov_b64 s[60:61], s[84:85]
    s_mov_b64 s[64:65], s[90:91]
    s_mov_b32 s5, 0
    s_mov_b32 s6, 0xffff0000
    s_mov_b32 s7, 0x3fb8aa3b
    s_lshr_b32 s76, s3, 2
    v_bfe_u32 v6, v1, 4, 1
    v_lshlrev_b32 v6, 6, v6
    v_and_b32 v62, 7, v1
    v_lshlrev_b32 v62, 4, v62
    v_xor_b32 v62, v62, v6
    v_lshrrev_b32 v6, 3, v1
    v_mul_u32_u24 v6, 6144, v6
    v_add_u32 v62, v62, v6
    v_lshlrev_b32 v63, 3, v1
    v_and_b32 v64, 31, v1
    v_lshlrev_b32 v64, 5, v64
    v_add_u32 v64, 149760, v64
    s_and_b32 s96, s3, 3
    s_lshl2_add_u32 s13, s96, 149760
    v_lshrrev_b32 v65, 4, v1
    v_lshl_add_u32 v65, v65, 5, s13
    v_and_b32 v9, 7, v1
    v_lshl_add_u32 v65, v9, 7, v65
    v_bfe_u32 v9, v1, 3, 1
    v_lshl_add_u32 v65, v9, 4, v65
    s_and_b32 s96, s8, 6
    s_and_b32 s97, s8, 1
    s_lshr_b32 s98, s9, 4
    s_lshl1_add_u32 s99, s97, s98
    s_lshl_b32 s97, s99, 6
    s_add_u32 s98, s96, s97
    s_lshl3_add_u32 s99, s3, s98
    s_lshl_b32 s96, s99, 10
    s_and_b32 s97, s9, 15
    s_lshl_b32 s98, s97, 6
    s_add_u32 s99, s96, s98
    s_add_u32 s14, s99, 262144
    s_xor_b32 s96, s9, 1
    s_and_b32 s97, s96, 15
    s_lshl4_add_u32 s98, s3, s97
    s_lshr_b32 s99, s9, 4
    s_lshl1_add_u32 s96, s98, s99
    s_lshl3_add_u32 s97, s96, s8
    s_lshl_b32 s98, s97, 9
    s_add_u32 s13, s98, 524288
    s_lshr_b32 s96, s9, 4
    s_xor_b32 s97, s9, 1
    s_and_b32 s98, s97, 7
    s_lshl_b32 s99, s3, 1
    s_lshl3_add_u32 s97, s98, s99
    s_bfe_u32 s98, s9, 65539
    s_add_u32 s99, s97, s98
    s_lshl_b32 s97, s99, 9
    s_lshl_b32 s98, s8, 6
    s_add_u32 s99, s97, s98
    s_lshl2_add_u32 s97, s96, s99
    s_add_u32 s15, s97, 2097152
    v_and_b32 v10, 3, v1
    v_lshlrev_b32 v10, 15, v10
    s_waitcnt vmcnt(5)
    v_lshlrev_b32 v98, 16, v97
    v_and_b32 v99, s6, v97
    v_and_b32 v97, s6, v96
    v_lshlrev_b32 v96, 16, v96
    v_mul_f32 v4, s7, v96
    v_exp_f32 v4, -v4
    s_nop 0
    v_add_f32 v4, 1.0, v4
    v_rcp_f32 v4, v4
    s_nop 0
    v_mul_f32 v96, v96, v4
    v_cvt_pk_bf16_f32 v96, 0, v96
    v_mul_f32 v5, s7, v97
    v_exp_f32 v5, -v5
    s_nop 0
    v_add_f32 v5, 1.0, v5
    v_rcp_f32 v5, v5
    s_nop 0
    v_mul_f32 v97, v97, v5
    v_cvt_pk_bf16_f32 v97, 0, v97
    v_mul_f32 v4, s7, v98
    v_exp_f32 v4, -v4
    s_nop 0
    v_add_f32 v4, 1.0, v4
    v_rcp_f32 v4, v4
    s_nop 0
    v_mul_f32 v98, v98, v4
    v_cvt_pk_bf16_f32 v98, 0, v98
    v_mul_f32 v5, s7, v99
    v_exp_f32 v5, -v5
    s_nop 0
    v_add_f32 v5, 1.0, v5
    v_rcp_f32 v5, v5
    s_nop 0
    v_mul_f32 v99, v99, v5
    v_cvt_pk_bf16_f32 v99, 0, v99
    s_waitcnt vmcnt(4)
    v_lshlrev_b32 v4, 16, v80
    v_and_b32 v5, s6, v80
    v_pk_mul_f32 v[20:21], v[4:5], v[96:97] op_sel:[0,0] op_sel_hi:[1,0]
    v_lshlrev_b32 v6, 16, v81
    v_and_b32 v7, s6, v81
    v_pk_mul_f32 v[22:23], v[6:7], v[96:97] op_sel:[0,0] op_sel_hi:[1,0]
    v_lshlrev_b32 v4, 16, v82
    v_and_b32 v5, s6, v82
    v_pk_mul_f32 v[24:25], v[4:5], v[96:97] op_sel:[0,0] op_sel_hi:[1,0]
    v_lshlrev_b32 v6, 16, v83
    v_and_b32 v7, s6, v83
    v_pk_mul_f32 v[26:27], v[6:7], v[96:97] op_sel:[0,0] op_sel_hi:[1,0]
    s_waitcnt vmcnt(3)
    v_lshlrev_b32 v4, 16, v84
    v_and_b32 v5, s6, v84
    v_pk_fma_f32 v[20:21], v[4:5], v[96:97], v[20:21] op_sel:[0,1,0] op_sel_hi:[1,1,1]
    v_lshlrev_b32 v6, 16, v85
    v_and_b32 v7, s6, v85
    v_pk_fma_f32 v[22:23], v[6:7], v[96:97], v[22:23] op_sel:[0,1,0] op_sel_hi:[1,1,1]
    v_lshlrev_b32 v4, 16, v86
    v_and_b32 v5, s6, v86
    v_pk_fma_f32 v[24:25], v[4:5], v[96:97], v[24:25] op_sel:[0,1,0] op_sel_hi:[1,1,1]
    v_lshlrev_b32 v6, 16, v87
    v_and_b32 v7, s6, v87
    v_pk_fma_f32 v[26:27], v[6:7], v[96:97], v[26:27] op_sel:[0,1,0] op_sel_hi:[1,1,1]
    s_waitcnt vmcnt(2)
    v_lshlrev_b32 v4, 16, v88
    v_and_b32 v5, s6, v88
    v_pk_fma_f32 v[20:21], v[4:5], v[98:99], v[20:21] op_sel:[0,0,0] op_sel_hi:[1,0,1]
    v_lshlrev_b32 v6, 16, v89
    v_and_b32 v7, s6, v89
    v_pk_fma_f32 v[22:23], v[6:7], v[98:99], v[22:23] op_sel:[0,0,0] op_sel_hi:[1,0,1]
    v_lshlrev_b32 v4, 16, v90
    v_and_b32 v5, s6, v90
    v_pk_fma_f32 v[24:25], v[4:5], v[98:99], v[24:25] op_sel:[0,0,0] op_sel_hi:[1,0,1]
    v_lshlrev_b32 v6, 16, v91
    v_and_b32 v7, s6, v91
    v_pk_fma_f32 v[26:27], v[6:7], v[98:99], v[26:27] op_sel:[0,0,0] op_sel_hi:[1,0,1]
    s_waitcnt vmcnt(1)
    v_lshlrev_b32 v4, 16, v92
    v_and_b32 v5, s6, v92
    v_pk_fma_f32 v[20:21], v[4:5], v[98:99], v[20:21] op_sel:[0,1,0] op_sel_hi:[1,1,1]
    v_lshlrev_b32 v6, 16, v93
    v_and_b32 v7, s6, v93
    v_pk_fma_f32 v[22:23], v[6:7], v[98:99], v[22:23] op_sel:[0,1,0] op_sel_hi:[1,1,1]
    v_lshlrev_b32 v4, 16, v94
    v_and_b32 v5, s6, v94
    v_pk_fma_f32 v[24:25], v[4:5], v[98:99], v[24:25] op_sel:[0,1,0] op_sel_hi:[1,1,1]
    v_lshlrev_b32 v6, 16, v95
    v_and_b32 v7, s6, v95
    v_pk_fma_f32 v[26:27], v[6:7], v[98:99], v[26:27] op_sel:[0,1,0] op_sel_hi:[1,1,1]
    v_permlane32_swap_b32 v20, v24
    v_permlane32_swap_b32 v21, v25
    v_permlane32_swap_b32 v22, v26
    v_permlane32_swap_b32 v23, v27
    v_add_f32 v20, v20, v24
    v_add_f32 v21, v21, v25
    v_add_f32 v22, v22, v26
    v_add_f32 v23, v23, v27
    s_nop 0
    v_permlane16_swap_b32 v20, v22
    v_permlane16_swap_b32 v21, v23
    v_add_f32 v20, v20, v22
    v_add_f32 v21, v21, v23
    s_nop 0
    v_add_f32_dpp v20, v20, v20 row_ror:8 row_mask:0xf bank_mask:0xf
    v_add_f32_dpp v21, v21, v21 row_ror:8 row_mask:0xf bank_mask:0xf
    s_nop 1
    v_mov_b32_dpp v20, v21 quad_perm:[0,1,2,3] row_mask:0xf bank_mask:0xc
    ds_write_b32 v65, v20
    s_waitcnt lgkmcnt(0)
    s_barrier
    s_mul_i32 s4, s4, 0x9e3779b1
    s_add_u32 s4, s4, 0x7f4a7c15
    ds_read_b128 v[20:23], v64 offset:0
    ds_read_b128 v[24:27], v64 offset:16
    s_waitcnt lgkmcnt(0)
    v_add_f32 v20, v20, v22
    v_add_f32 v21, v21, v23
    v_add_f32 v24, v24, v26
    v_add_f32 v25, v25, v27
    v_add_f32 v20, v20, v21
    v_add_f32 v22, v24, v25
    v_mov_b32 v21, s4
    v_mov_b32 v23, s4
    s_mov_b32 exec_hi, 0
    buffer_store_dwordx4 v[20:23], v2, s[32:35], s13 offen sc1
    s_mov_b64 exec, 15
    buffer_store_dword v21, v10, s[32:35], s15 offen sc1
    s_mov_b64 exec, -1
    v_and_b32 v5, 3, v1
    v_lshlrev_b32 v5, 4, v5
    v_add_u32 v5, 151808, v5
    v_and_b32 v4, 3, v1
    v_lshlrev_b32 v4, 4, v4
    v_bfe_u32 v9, v1, 2, 1
    v_lshl_add_u32 v4, v9, 10, v4
    v_and_b32 v11, 31, v1
    v_lshlrev_b32 v11, 11, v11
    v_lshrrev_b32 v9, 5, v1
    v_lshl_add_u32 v11, v9, 5, v11
    v_and_b32 v6, 1, v1
    v_lshlrev_b32 v6, 9, v6
    v_bfe_u32 v9, v1, 1, 1
    v_lshl_add_u32 v6, v9, 8, v6
    s_and_b32 s96, s9, 3
    s_and_b32 s97, s8, 6
    s_and_b32 s98, s8, 1
    s_lshr_b32 s99, s9, 4
    s_lshl1_add_u32 s98, s98, s99
    s_lshl_b32 s99, s98, 6
    s_add_u32 s98, s97, s99
    s_lshl3_add_u32 s97, s3, s98
    s_lshl_b32 s99, s97, 9
    s_bfe_u32 s98, s9, 131074
    s_lshl_b32 s97, s98, 6
    s_add_u32 s98, s99, s97
    s_lshl2_add_u32 s99, s96, s98
    s_add_u32 s97, s99, 16
    s_add_u32 s15, s97, 2097152
    s_branch L_FJ
L_FS:
    s_barrier
    buffer_load_dwordx4 v[80:83], v2, s[36:39], s16 offen
    buffer_load_dwordx4 v[84:87], v2, s[36:39], s16 offen offset:1024
    buffer_load_dwordx4 v[88:91], v2, s[36:39], s16 offen offset:2048
    buffer_load_dwordx4 v[92:95], v2, s[36:39], s16 offen offset:3072
    s_lshl2_add_u32 s96, s2, s3
    s_sub_u32 s97, s96, 4
    s_lshl_b32 s98, s97, 7
    s_add_u32 s17, s98, 2097152
    s_load_dword s24, s[32:33], s17 offset:0 glc
    s_load_dword s25, s[32:33], s17 offset:64 glc
    s_lshl_b32 s96, s2, 5
    s_add_u32 s97, s96, s3
    s_sub_u32 s98, s97, 4
    s_lshl_b32 s99, s98, 7
    s_add_u32 s17, s99, 1048576
    s_load_dword s24, s[32:33], s17 offset:0 glc
    s_load_dword s25, s[32:33], s17 offset:64 glc
    s_lshl_b32 s19, s94, 5
    v_mov_b32 v78, 1
    v_mov_b32 v79, s19
    s_barrier
    s_cmp_lg_u32 s3, 7
    s_cbranch_scc1 L_NOTK
    s_mov_b64 exec, 1
    global_atomic_add v78, v79, v78, s[30:31] sc0 sc1
    s_mov_b64 exec, -1
    s_branch L_TK0
L_NOTK:
    s_and_b32 s22, s22, 0xfffffc00
    global_load_dword v78, v10, s[22:23]
L_TK0:
    s_mov_b32 s42, 6291456
    s_mov_b32 s43, 0x20000
    s_mov_b32 s46, 2097152
    s_mov_b32 s47, 0x20000
    s_mov_b32 s54, 7340032
    s_mov_b32 s55, 0x20000
    s_mov_b32 s58, 7340032
    s_mov_b32 s59, 0x20000
    s_mov_b32 s62, 7340032
    s_mov_b32 s63, 0x20000
    s_mov_b32 s66, 4194304
    s_mov_b32 s67, 0x20000
    s_mov_b64 s[40:41], s[70:71]
    s_mov_b64 s[44:45], s[74:75]
    s_mov_b64 s[52:53], s[80:81]
    s_mov_b64 s[56:57], s[82:83]
    s_mov_b64 s[60:61], s[84:85]
    s_mov_b64 s[64:65], s[90:91]
    s_mov_b32 s5, 0
    s_mov_b32 s6, 0xffff0000
    s_mov_b32 s7, 0x3fb8aa3b
    s_lshr_b32 s76, s3, 2
    v_bfe_u32 v6, v1, 4, 1
    v_lshlrev_b32 v6, 6, v6
    v_and_b32 v62, 7, v1
    v_lshlrev_b32 v62, 4, v62
    v_xor_b32 v62, v62, v6
    v_lshrrev_b32 v6, 3, v1
    v_mul_u32_u24 v6, 6144, v6
    v_add_u32 v62, v62, v6
    v_lshlrev_b32 v63, 3, v1
    v_and_b32 v64, 31, v1
    v_lshlrev_b32 v64, 5, v64
    v_add_u32 v64, 149760, v64
    s_and_b32 s96, s3, 3
    s_lshl2_add_u32 s13, s96, 149760
    v_lshrrev_b32 v65, 4, v1
    v_lshl_add_u32 v65, v65, 5, s13
    v_and_b32 v9, 7, v1
    v_lshl_add_u32 v65, v9, 7, v65
    v_bfe_u32 v9, v1, 3, 1
    v_lshl_add_u32 v65, v9, 4, v65
    s_and_b32 s96, s8, 6
    s_and_b32 s97, s8, 1
    s_lshr_b32 s98, s9, 4
    s_lshl1_add_u32 s99, s97, s98
    s_lshl_b32 s97, s99, 6
    s_add_u32 s98, s96, s97
    s_lshl3_add_u32 s99, s3, s98
    s_lshl_b32 s96, s99, 10
    s_and_b32 s97, s9, 15
    s_lshl_b32 s98, s97, 6
    s_add_u32 s99, s96, s98
    s_add_u32 s14, s99, 262144
    s_sub_u32 s96, s3, 4
    s_lshl4_add_u32 s13, s96, 151808
    v_lshrrev_b32 v10, 5, v1
    v_lshl_add_u32 v10, v10, 3, s13
    v_and_b32 v5, 3, v1
    v_lshlrev_b32 v5, 4, v5
    v_add_u32 v5, 151808, v5
    v_and_b32 v4, 3, v1
    v_lshlrev_b32 v4, 4, v4
    v_bfe_u32 v9, v1, 2, 1
    v_lshl_add_u32 v4, v9, 10, v4
    v_and_b32 v11, 31, v1
    v_lshlrev_b32 v11, 11, v11
    v_lshrrev_b32 v9, 5, v1
    v_lshl_add_u32 v11, v9, 5, v11
    v_and_b32 v6, 1, v1
    v_lshlrev_b32 v6, 9, v6
    v_bfe_u32 v9, v1, 1, 1
    v_lshl_add_u32 v6, v9, 8, v6
    s_and_b32 s96, s9, 3
    s_and_b32 s97, s8, 6
    s_and_b32 s98, s8, 1
    s_lshr_b32 s99, s9, 4
    s_lshl1_add_u32 s98, s98, s99
    s_lshl_b32 s99, s98, 6
    s_add_u32 s98, s97, s99
    s_lshl3_add_u32 s97, s3, s98
    s_lshl_b32 s99, s97, 9
    s_bfe_u32 s98, s9, 131074
    s_lshl_b32 s97, s98, 6
    s_add_u32 s98, s99, s97
    s_lshl2_add_u32 s99, s96, s98
    s_add_u32 s97, s99, 16
    s_add_u32 s15, s97, 2097152
    s_barrier
    s_waitcnt vmcnt(1)
    s_waitcnt lgkmcnt(0)
    s_mul_i32 s4, s4, 0x9e3779b1
    s_add_u32 s4, s4, 0x7f4a7c15
    v_mov_b32 v104, 0x3f803f80
    v_dot2_f32_bf16 v100, v80, v104, 0
    v_dot2_f32_bf16 v102, v80, v80, 0
    v_dot2_f32_bf16 v101, v88, v104, 0
    v_dot2_f32_bf16 v103, v88, v88, 0
    v_dot2_f32_bf16 v100, v81, v104, v100
    v_dot2_f32_bf16 v102, v81, v81, v102
    v_dot2_f32_bf16 v101, v89, v104, v101
    v_dot2_f32_bf16 v103, v89, v89, v103
    v_dot2_f32_bf16 v100, v82, v104, v100
    v_dot2_f32_bf16 v102, v82, v82, v102
    v_dot2_f32_bf16 v101, v90, v104, v101
    v_dot2_f32_bf16 v103, v90, v90, v103
    v_dot2_f32_bf16 v100, v83, v104, v100
    v_dot2_f32_bf16 v102, v83, v83, v102
    v_dot2_f32_bf16 v101, v91, v104, v101
    v_dot2_f32_bf16 v103, v91, v91, v103
    v_dot2_f32_bf16 v100, v84, v104, v100
    v_dot2_f32_bf16 v102, v84, v84, v102
    v_dot2_f32_bf16 v101, v92, v104, v101
    v_dot2_f32_bf16 v103, v92, v92, v103
    v_dot2_f32_bf16 v100, v85, v104, v100
    v_dot2_f32_bf16 v102, v85, v85, v102
    v_dot2_f32_bf16 v101, v93, v104, v101
    v_dot2_f32_bf16 v103, v93, v93, v103
    v_dot2_f32_bf16 v100, v86, v104, v100
    v_dot2_f32_bf16 v102, v86, v86, v102
    v_dot2_f32_bf16 v101, v94, v104, v101
    v_dot2_f32_bf16 v103, v94, v94, v103
    v_dot2_f32_bf16 v100, v87, v104, v100
    v_dot2_f32_bf16 v102, v87, v87, v102
    v_dot2_f32_bf16 v101, v95, v104, v101
    v_dot2_f32_bf16 v103, v95, v95, v103
    s_nop 1
    v_permlane32_swap_b32 v100, v101
    v_permlane32_swap_b32 v102, v103
    v_add_f32 v100, v100, v101
    v_add_f32 v102, v102, v103
    s_nop 1
    v_permlane16_swap_b32 v100, v102
    v_add_f32 v100, v100, v102
    s_nop 1
    v_add_f32_dpp v100, v100, v100 quad_perm:[1,0,3,2] row_mask:0xf bank_mask:0xf
    s_nop 1
    v_add_f32_dpp v100, v100, v100 quad_perm:[2,3,0,1] row_mask:0xf bank_mask:0xf
    s_nop 1
    v_add_f32_dpp v100, v100, v100 row_half_mirror row_mask:0xf bank_mask:0xf
    s_nop 1
    v_add_f32_dpp v100, v100, v100 row_ror:8 row_mask:0xf bank_mask:0xf
    v_mul_f32 v102, 0x3a800000, v100
    v_mul_f32 v100, 0x3a800000, v100
    s_nop 1
    v_permlane16_swap_b32 v100, v102
    v_fma_f32 v117, -v100, v100, v102
    v_cvt_pk_bf16_f32 v116, 0, v100
    v_max_f32 v117, 0, v117
    v_cvt_pk_bf16_f32 v117, 0, v117
    v_add_f32 v117, 0x3727c5ac, v117
    v_cvt_pk_bf16_f32 v117, 0, v117
    v_sqrt_f32 v117, v117
    s_nop 0
    v_cvt_pk_bf16_f32 v117, 0, v117
    v_lshrrev_b32 v116, 16, v116
    v_or_b32 v116, v116, v117
    v_mov_b32 v117, s4
    ds_write_b64 v10, v[116:117]
L_FJ:
    s_waitcnt lgkmcnt(0)
    s_barrier
    ds_read_b128 v[116:119], v5
    s_waitcnt lgkmcnt(0)
    s_mov_b64 exec, 0xff
    buffer_store_dwordx4 v[116:119], v4, s[32:35], s14 offen sc1
    s_mov_b64 exec, 15
    buffer_store_dword v117, v6, s[32:35], s15 offen sc1
    s_mov_b64 exec, -1
    s_cmp_lg_u32 s3, 7
    s_cbranch_scc1 L_NOTK2
    s_mov_b32 s13, 0
    s_waitcnt vmcnt(2)
L_TK:
    v_readfirstlane_b32 s15, v78
    s_nop 0
    s_cmp_lt_u32 s15, 32
    s_cbranch_scc1 L_TKOK
    v_mov_b32 v78, s4
    s_mov_b64 exec, 1
    buffer_store_dword v78, v3, s[32:35], 0 offen offset:256 sc1
    s_mov_b64 exec, -1
    s_add_u32 s13, s13, 1
    s_cmp_lt_u32 s13, 8
    s_cbranch_scc0 L_TKNO
    s_add_u32 s94, s94, 1
    s_and_b32 s94, s94, 7
    s_lshl_b32 s19, s94, 5
    v_mov_b32 v78, 1
    v_mov_b32 v79, s19
    s_mov_b64 exec, 1
    global_atomic_add v78, v79, v78, s[30:31] sc0 sc1
    s_mov_b64 exec, -1
    s_waitcnt vmcnt(0)
    s_branch L_TK
L_TKNO:
    s_and_b32 s94, s2, 7
    s_lshr_b32 s15, s2, 3
L_TKOK:
    s_lshl3_add_u32 s15, s15, s94
    v_mov_b32 v78, s15
    ds_write_b32 v5, v78 offset:64
L_NOTK2:
    s_waitcnt lgkmcnt(0)
    s_barrier
    ds_read_b32 v120, v5 offset:64
    s_waitcnt lgkmcnt(0)
    v_readfirstlane_b32 s2, v120
    s_nop 0
    s_lshl3_add_u32 s96, s2, s3
    s_lshl_b32 s97, s96, 6
    s_add_u32 s15, s97, 2097152
    s_load_dwordx8 s[24:31], s[32:33], s15 offset:0 glc
    s_and_b32 s8, s2, 7
    s_lshr_b32 s9, s2, 3
    s_and_b32 s96, s8, 1
    s_and_b32 s97, s9, 7
    s_lshl3_add_u32 s12, s96, s97
    s_lshr_b32 s96, s8, 1
    s_lshr_b32 s97, s9, 3
    s_lshl2_add_u32 s21, s96, s97
    s_and_b32 s96, s3, 3
    s_lshl2_add_u32 s94, s21, s96
    s_lshl1_add_u32 s95, s12, s76
    s_lshl_b32 s96, s94, 16
    s_lshl_b32 s97, s95, 6
    s_add_u32 s18, s96, s97
    buffer_load_dwordx4 v[12:15], v11, s[36:39], s18 offen
    buffer_load_dwordx4 v[16:19], v11, s[36:39], s18 offen offset:16
    s_lshr_b32 s96, s8, 1
    s_lshl4_add_u32 s97, s96, s12
    s_lshl4_add_u32 s98, s97, s3
    s_lshl_b32 s99, s98, 9
    s_add_u32 s13, s99, 524288
    s_and_b32 s96, s3, 3
    s_lshl2_add_u32 s97, s2, s96
    s_lshl_b32 s98, s97, 8
    s_add_u32 s14, s98, 262144
    s_and_b32 s10, s9, 15
    s_lshr_b32 s96, s8, 2
    s_and_b32 s97, s8, 1
    s_lshl1_add_u32 s98, s96, s97
    s_and_b32 s99, s8, 2
    s_lshl2_add_u32 s96, s98, s99
    s_lshr_b32 s97, s9, 4
    s_add_u32 s11, s96, s97
    s_and_b32 s85, s9, 12
    s_lshl_b32 s96, s2, 6
    s_add_u32 s97, s96, s3
    s_lshl_b32 s98, s97, 6
    s_add_u32 s92, s98, 1048576
    s_lshr_b32 s96, s9, 4
    s_xor_b32 s77, s76, s96
    s_lshr_b32 s96, s9, 3
    s_xor_b32 s97, s96, s9
    s_and_b32 s98, s97, 1
    s_lshl2_add_u32 s83, s98, 8
    s_mul_i32 s96, s8, 7
    s_lshr_b32 s97, s9, 2
    s_add_u32 s74, s96, s97
    s_and_b32 s75, s9, 3
    v_and_b32 v8, 31, v1
    v_lshlrev_b32 v8, 3, v8
    v_and_b32 v4, 31, v1
    v_lshlrev_b32 v4, 4, v4
    v_lshrrev_b32 v9, 5, v1
    v_lshl_add_u32 v4, v9, 12, v4
    s_lshl2_add_u32 s16, s3, 152320
    v_lshl_add_u32 v5, v1, 6, s16
    s_lshl_b32 s96, s76, 10
    s_add_u32 s16, s96, 152320
    v_and_b32 v6, 15, v1
    v_lshl_add_u32 v6, v6, 5, s16
    v_lshrrev_b32 v9, 5, v1
    v_lshl_add_u32 v6, v9, 9, v6
    s_branch SCHK_2
SPOLL_1:
    s_load_dwordx8 s[24:31], s[32:33], s15 offset:0 glc
SCHK_2:
    s_add_u32 s5, s5, 1
    s_cmp_ge_u32 s5, 300000
    s_waitcnt lgkmcnt(0)
    s_cbranch_scc1 SDONE_3
    s_cmp_lg_u32 s24, s4
    s_cbranch_scc1 SPOLL_1
    s_cmp_lg_u32 s25, s4
    s_cbranch_scc1 SPOLL_1
    s_cmp_lg_u32 s28, s4
    s_cbranch_scc1 SPOLL_1
    s_cmp_lg_u32 s29, s4
    s_cbranch_scc1 SPOLL_1
    s_cmp_lg_u32 s30, s4
    s_cbranch_scc1 SPOLL_1
    s_cmp_lg_u32 s31, s4
    s_cbranch_scc1 SPOLL_1
SDONE_3:
    buffer_load_dwordx4 v[120:123], v4, s[32:35], s13 offen sc1
    buffer_load_dwordx2 v[116:117], v8, s[32:35], s14 offen sc1
    s_barrier
    s_lshl_b32 s96, s11, 12
    s_lshl_b32 s97, s3, 9
    s_add_u32 s16, s96, s97
    v_add_u32 v10, s16, v2
    s_lshl_b32 s96, s3, 9
    s_add_u32 m0, s96, 156416
    s_mov_b32 exec_hi, 0
    global_load_lds_dwordx4 v10, s[72:73]
    s_mov_b32 exec_hi, -1
    s_and_b32 s20, s9, 3
    s_add_u32 s96, s20, s85
    s_and_b32 s97, s96, 15
    s_lshl3_add_u32 s98, s97, s3
    s_mul_i32 s99, s98, 49152
    s_lshl_b32 s96, s11, 7
    s_add_u32 s82, s99, s96
    s_mul_i32 s96, s20, 24960
    s_lshr_b32 s97, s3, 1
    s_mul_i32 s98, s97, 2080
    s_add_u32 s99, s96, s98
    s_and_b32 s97, s3, 1
    s_mul_i32 s96, s97, 1056
    s_add_u32 s20, s99, s96
    s_mov_b32 m0, s20
    s_nop 0
    buffer_load_dwordx4 v62, s[40:43], s82 offen lds
    s_add_u32 s82, s82, 2048
    s_add_u32 m0, s20, 8320
    s_nop 0
    buffer_load_dwordx4 v62, s[40:43], s82 offen lds
    s_add_u32 s82, s82, 2048
    s_add_u32 m0, s20, 16640
    s_nop 0
    buffer_load_dwordx4 v62, s[40:43], s82 offen lds
    s_lshl4_add_u32 s96, s21, s12
    s_and_b32 s97, s3, 3
    s_lshl2_add_u32 s98, s96, s97
    s_lshl1_add_u32 s99, s98, s76
    s_lshl_b32 s96, s99, 11
    s_add_u32 s17, s96, 4194304
    v_and_b32 v10, 15, v1
    v_lshlrev_b32 v10, 4, v10
    v_bfe_u32 v9, v1, 4, 1
    v_lshl_add_u32 v10, v9, 10, v10
    v_lshrrev_b32 v9, 5, v1
    v_lshl_add_u32 v10, v9, 9, v10
    s_lshl_b32 s96, s3, 8
    s_add_u32 s16, s96, 160512
    v_and_b32 v124, 15, v1
    v_lshl_add_u32 v124, v124, 2, s16
    v_lshrrev_b32 v9, 5, v1
    v_lshl_add_u32 v124, v9, 6, v124
    v_lshrrev_b32 v125, 5, v1
    v_lshl_add_u32 v125, v125, 6, s16
    s_waitcnt vmcnt(5)
    v_bitop3_b32 v7, v121, v123, s4 bitop3:0x7e
    v_cmp_ne_u32 vcc, 0, v7
    s_cbranch_vccz TOK_5
POLL_6:
    buffer_load_dwordx4 v[120:123], v4, s[32:35], s13 offen sc1
    s_waitcnt vmcnt(0)
    v_bitop3_b32 v7, v121, v123, s4 bitop3:0x7e
    v_cmp_ne_u32 vcc, 0, v7
    s_cbranch_vccz PDONE_7
    s_add_u32 s5, s5, 1
    s_cmp_lt_u32 s5, 300000
    s_cbranch_scc1 POLL_6
PDONE_7:
TOK_5:
    ds_write2_b32 v5, v120, v122 offset0:0 offset1:8
    v_lshlrev_b32 v100, 16, v12
    v_and_b32 v101, s6, v12
    v_lshlrev_b32 v102, 16, v13
    v_and_b32 v103, s6, v13
    v_lshlrev_b32 v104, 16, v14
    v_and_b32 v105, s6, v14
    v_lshlrev_b32 v106, 16, v15
    v_and_b32 v107, s6, v15
    v_lshlrev_b32 v108, 16, v16
    v_and_b32 v109, s6, v16
    v_lshlrev_b32 v110, 16, v17
    v_and_b32 v111, s6, v17
    v_lshlrev_b32 v112, 16, v18
    v_and_b32 v113, s6, v18
    v_lshlrev_b32 v114, 16, v19
    v_and_b32 v115, s6, v19
    s_waitcnt lgkmcnt(0)
    s_barrier
    ds_read_b128 v[88:91], v6 offset:2048
    ds_read_b128 v[92:95], v6 offset:2064
    ds_read_b128 v[80:83], v6
    ds_read_b128 v[84:87], v6 offset:16
    s_waitcnt vmcnt(4)
    v_cmp_ne_u32 vcc, s4, v117
    s_cbranch_vccz TOK_8
POLL_9:
    buffer_load_dwordx2 v[116:117], v8, s[32:35], s14 offen sc1
    s_waitcnt vmcnt(0)
    v_cmp_ne_u32 vcc, s4, v117
    s_cbranch_vccz PDONE_10
    s_add_u32 s5, s5, 1
    s_cmp_lt_u32 s5, 300000
    s_cbranch_scc1 POLL_9
PDONE_10:
TOK_8:
    v_lshlrev_b32 v117, 16, v116
    v_and_b32 v116, s6, v116
    v_rcp_f32 v116, v116
    s_nop 0
    v_pk_add_f32 v[100:101], v[100:101], v[116:117] op_sel:[0,1] neg_lo:[0,1] neg_hi:[0,1]
    v_pk_add_f32 v[102:103], v[102:103], v[116:117] op_sel:[0,1] neg_lo:[0,1] neg_hi:[0,1]
    v_pk_add_f32 v[104:105], v[104:105], v[116:117] op_sel:[0,1] neg_lo:[0,1] neg_hi:[0,1]
    v_pk_add_f32 v[106:107], v[106:107], v[116:117] op_sel:[0,1] neg_lo:[0,1] neg_hi:[0,1]
    v_pk_add_f32 v[108:109], v[108:109], v[116:117] op_sel:[0,1] neg_lo:[0,1] neg_hi:[0,1]
    v_pk_add_f32 v[110:111], v[110:111], v[116:117] op_sel:[0,1] neg_lo:[0,1] neg_hi:[0,1]
    v_pk_add_f32 v[112:113], v[112:113], v[116:117] op_sel:[0,1] neg_lo:[0,1] neg_hi:[0,1]
    v_pk_add_f32 v[114:115], v[114:115], v[116:117] op_sel:[0,1] neg_lo:[0,1] neg_hi:[0,1]
    s_waitcnt lgkmcnt(2)
    v_pk_add_f32 v[88:89], v[88:89], v[90:91]
    v_pk_add_f32 v[92:93], v[92:93], v[94:95]
    v_pk_add_f32 v[88:89], v[88:89], v[92:93]
    v_add_f32 v88, v88, v89
    v_cvt_pk_bf16_f32 v88, 0, v88
    s_waitcnt lgkmcnt(0)
    v_pk_add_f32 v[80:81], v[80:81], v[82:83]
    v_pk_add_f32 v[84:85], v[84:85], v[86:87]
    v_pk_add_f32 v[80:81], v[80:81], v[84:85]
    v_add_f32 v80, v80, v81
    v_add_f32 v88, 1.0, v88
    v_cvt_pk_bf16_f32 v88, 0, v88
    v_cvt_pk_bf16_f32 v80, 0, v80
    ds_write2_b32 v124, v88, v80 offset0:0 offset1:32
    ds_read_b128 v[136:139], v125
    ds_read_b128 v[140:143], v125 offset:16
    ds_read_b128 v[144:147], v125 offset:32
    ds_read_b128 v[148:151], v125 offset:48
    ds_read_b128 v[152:155], v125 offset:128
    ds_read_b128 v[156:159], v125 offset:144
    ds_read_b128 v[160:163], v125 offset:160
    ds_read_b128 v[164:167], v125 offset:176
    v_cvt_pk_bf16_f32 v100, 0, v100
    v_cvt_pk_bf16_f32 v101, 0, v101
    v_cvt_pk_bf16_f32 v102, 0, v102
    v_cvt_pk_bf16_f32 v103, 0, v103
    v_cvt_pk_bf16_f32 v104, 0, v104
    v_cvt_pk_bf16_f32 v105, 0, v105
    v_cvt_pk_bf16_f32 v106, 0, v106
    v_cvt_pk_bf16_f32 v107, 0, v107
    v_pk_mul_f32 v[100:101], v[100:101], v[116:117] op_sel_hi:[1,0]
    v_pk_mul_f32 v[102:103], v[102:103], v[116:117] op_sel_hi:[1,0]
    v_pk_mul_f32 v[104:105], v[104:105], v[116:117] op_sel_hi:[1,0]
    v_pk_mul_f32 v[106:107], v[106:107], v[116:117] op_sel_hi:[1,0]
    v_cvt_pk_bf16_f32 v100, 0, v100
    v_cvt_pk_bf16_f32 v101, 0, v101
    v_cvt_pk_bf16_f32 v102, 0, v102
    v_cvt_pk_bf16_f32 v103, 0, v103
    v_cvt_pk_bf16_f32 v104, 0, v104
    v_cvt_pk_bf16_f32 v105, 0, v105
    v_cvt_pk_bf16_f32 v106, 0, v106
    v_cvt_pk_bf16_f32 v107, 0, v107
    v_cvt_pk_bf16_f32 v108, 0, v108
    v_cvt_pk_bf16_f32 v109, 0, v109
    v_cvt_pk_bf16_f32 v110, 0, v110
    v_cvt_pk_bf16_f32 v111, 0, v111
    v_cvt_pk_bf16_f32 v112, 0, v112
    v_cvt_pk_bf16_f32 v113, 0, v113
    v_cvt_pk_bf16_f32 v114, 0, v114
    v_cvt_pk_bf16_f32 v115, 0, v115
    v_pk_mul_f32 v[108:109], v[108:109], v[116:117] op_sel_hi:[1,0]
    v_pk_mul_f32 v[110:111], v[110:111], v[116:117] op_sel_hi:[1,0]
    v_pk_mul_f32 v[112:113], v[112:113], v[116:117] op_sel_hi:[1,0]
    v_pk_mul_f32 v[114:115], v[114:115], v[116:117] op_sel_hi:[1,0]
    v_cvt_pk_bf16_f32 v108, 0, v108
    v_cvt_pk_bf16_f32 v109, 0, v109
    v_cvt_pk_bf16_f32 v110, 0, v110
    v_cvt_pk_bf16_f32 v111, 0, v111
    v_cvt_pk_bf16_f32 v112, 0, v112
    v_cvt_pk_bf16_f32 v113, 0, v113
    v_cvt_pk_bf16_f32 v114, 0, v114
    v_cvt_pk_bf16_f32 v115, 0, v115
    s_waitcnt lgkmcnt(6)
    v_pk_mul_f32 v[100:101], v[100:101], v[136:137]
    v_pk_mul_f32 v[102:103], v[102:103], v[138:139]
    v_pk_mul_f32 v[104:105], v[104:105], v[140:141]
    v_pk_mul_f32 v[106:107], v[106:107], v[142:143]
    v_cvt_pk_bf16_f32 v100, 0, v100
    v_cvt_pk_bf16_f32 v101, 0, v101
    v_cvt_pk_bf16_f32 v102, 0, v102
    v_cvt_pk_bf16_f32 v103, 0, v103
    v_cvt_pk_bf16_f32 v104, 0, v104
    v_cvt_pk_bf16_f32 v105, 0, v105
    v_cvt_pk_bf16_f32 v106, 0, v106
    v_cvt_pk_bf16_f32 v107, 0, v107
    s_waitcnt lgkmcnt(2)
    v_pk_add_f32 v[100:101], v[100:101], v[152:153]
    v_pk_add_f32 v[102:103], v[102:103], v[154:155]
    v_pk_add_f32 v[104:105], v[104:105], v[156:157]
    v_pk_add_f32 v[106:107], v[106:107], v[158:159]
    v_cvt_pk_bf16_f32 v128, v100, v101
    v_cvt_pk_bf16_f32 v129, v102, v103
    v_cvt_pk_bf16_f32 v130, v104, v105
    v_cvt_pk_bf16_f32 v131, v106, v107
    buffer_store_dwordx4 v[128:131], v10, s[32:35], s17 offen sc1
    v_pk_mul_f32 v[108:109], v[108:109], v[144:145]
    v_pk_mul_f32 v[110:111], v[110:111], v[146:147]
    v_pk_mul_f32 v[112:113], v[112:113], v[148:149]
    v_pk_mul_f32 v[114:115], v[114:115], v[150:151]
    v_cvt_pk_bf16_f32 v108, 0, v108
    v_cvt_pk_bf16_f32 v109, 0, v109
    v_cvt_pk_bf16_f32 v110, 0, v110
    v_cvt_pk_bf16_f32 v111, 0, v111
    v_cvt_pk_bf16_f32 v112, 0, v112
    v_cvt_pk_bf16_f32 v113, 0, v113
    v_cvt_pk_bf16_f32 v114, 0, v114
    v_cvt_pk_bf16_f32 v115, 0, v115
    s_waitcnt lgkmcnt(0)
    v_pk_add_f32 v[108:109], v[108:109], v[160:161]
    v_pk_add_f32 v[110:111], v[110:111], v[162:163]
    v_pk_add_f32 v[112:113], v[112:113], v[164:165]
    v_pk_add_f32 v[114:115], v[114:115], v[166:167]
    v_cvt_pk_bf16_f32 v132, v108, v109
    v_cvt_pk_bf16_f32 v133, v110, v111
    v_cvt_pk_bf16_f32 v134, v112, v113
    v_cvt_pk_bf16_f32 v135, v114, v115
    buffer_store_dwordx4 v[132:135], v10, s[32:35], s17 offen offset:256 sc1
    v_lshrrev_b32 v66, 5, v1
    v_mul_u32_u24 v66, 2080, v66
    v_bfe_u32 v9, v1, 2, 2
    v_lshl_add_u32 v66, v9, 7, v66
    v_bfe_u32 v9, v1, 3, 1
    v_lshl_add_u32 v66, v9, 6, v66
    v_and_b32 v9, 3, v1
    v_lshl_add_u32 v66, v9, 3, v66
    v_bfe_u32 v67, v1, 4, 1
    v_mul_u32_u24 v67, 1056, v67
    v_bfe_u32 v68, v1, 3, 1
    v_lshlrev_b32 v68, 7, v68
    v_add_u32 v66, v66, v67
    v_sub_u32 v67, v66, v68
    v_add_u32 v67, 64, v67
    v_add_u32 v68, 49920, v66
    v_add_u32 v69, 49920, v67
    v_add_u32 v70, 99840, v66
    v_add_u32 v71, 99840, v67
    s_lshl_b32 s96, s76, 11
    s_add_u32 s14, s96, 156416
    v_bfe_u32 v4, v1, 2, 2
    v_lshl_add_u32 v4, v4, 6, s14
    v_bfe_u32 v9, v1, 4, 1
    v_lshl_add_u32 v4, v9, 5, v4
    v_and_b32 v9, 3, v1
    v_lshl_add_u32 v4, v9, 3, v4
    v_lshrrev_b32 v9, 5, v1
    v_lshl_add_u32 v4, v9, 9, v4
    v_and_b32 v5, 7, v1
    v_lshlrev_b32 v5, 12, v5
    v_bfe_u32 v9, v1, 3, 1
    v_lshl_add_u32 v5, v9, 19, v5
    s_and_b32 s96, s12, 1
    s_lshl_b32 s97, s21, 15
    s_lshr_b32 s98, s12, 1
    s_lshl_b32 s99, s98, 6
    s_add_u32 s98, s97, s99
    s_lshl2_add_u32 s97, s96, s98
    s_add_u32 s13, s97, 1048576
    v_bfe_u32 v6, v1, 4, 1
    v_lshlrev_b32 v6, 6, v6
    v_lshrrev_b32 v9, 5, v1
    v_lshl_add_u32 v6, v9, 4, v6
    v_and_b32 v74, 7, v1
    v_lshlrev_b32 v74, 4, v74
    v_xor_b32 v74, v74, v6
    v_lshrrev_b32 v6, 3, v1
    v_lshlrev_b32 v6, 11, v6
    v_add_u32 v74, v74, v6
    s_and_b32 s96, s3, 2
    s_lshl_b32 s14, s96, 5
    v_bfe_u32 v6, v1, 4, 1
    v_lshl_add_u32 v6, v6, 5, s14
    v_and_b32 v72, 7, v1
    v_lshlrev_b32 v72, 4, v72
    v_xor_b32 v72, v72, v6
    v_lshrrev_b32 v6, 3, v1
    v_mul_u32_u24 v6, 7168, v6
    v_add_u32 v72, v72, v6
    s_and_b32 s96, s3, 1
    s_lshl_b32 s14, s96, 7
    v_lshrrev_b32 v6, 5, v1
    v_lshl_add_u32 v6, v6, 6, s14
    v_and_b32 v73, 31, v1
    v_lshlrev_b32 v73, 4, v73
    v_lshrrev_b32 v9, 5, v1
    v_lshl_add_u32 v73, v9, 11, v73
    v_xor_b32 v73, v73, v6
    s_lshl3_add_u32 s96, s75, s3
    s_mul_i32 s97, s96, 229376
    s_lshl_b32 s98, s74, 7
    s_add_u32 s80, s97, s98
    s_lshl3_add_u32 s96, s74, s3
    s_lshl_b32 s97, s96, 14
    s_lshl_b32 s98, s75, 9
    s_add_u32 s81, s97, s98
    s_lshr_b32 s96, s9, 2
    s_add_u32 s90, s96, 1
    s_cmp_ge_u32 s90, 7
    s_cselect_b32 s90, 4294967290, 1
    s_cmp_ge_u32 s9, 28
    s_cselect_b32 s54, 0, s54
    s_cselect_b32 s58, 0, s58
    s_cselect_b32 s62, 0, s62
    s_waitcnt vmcnt(0)
    s_barrier
    s_cmp_lg_u32 s3, 0
    s_cbranch_scc1 L_PB
    v_mov_b32 v6, s4
    s_mov_b32 exec_hi, 0
    s_mov_b32 exec_lo, 65535
    buffer_store_dword v6, v5, s[32:35], s13 offen sc1
    s_mov_b64 exec, -1
L_PB:
    s_and_b32 s20, s9, 3
    s_cmp_le_u32 s20, 0
    s_cselect_b32 s20, 1, 0
    s_add_u32 s96, s20, s85
    s_and_b32 s97, s96, 15
    s_lshl3_add_u32 s98, s97, s3
    s_mul_i32 s99, s98, 49152
    s_lshl_b32 s96, s11, 7
    s_add_u32 s82, s99, s96
    s_mul_i32 s96, s20, 24960
    s_lshr_b32 s97, s3, 1
    s_mul_i32 s98, s97, 2080
    s_add_u32 s99, s96, s98
    s_and_b32 s97, s3, 1
    s_mul_i32 s96, s97, 1056
    s_add_u32 s20, s99, s96
    s_mov_b32 m0, s20
    s_nop 0
    buffer_load_dwordx4 v62, s[40:43], s82 offen lds
    s_add_u32 s82, s82, 2048
    s_add_u32 m0, s20, 8320
    s_nop 0
    buffer_load_dwordx4 v62, s[40:43], s82 offen lds
    s_add_u32 s82, s82, 2048
    s_add_u32 m0, s20, 16640
    s_nop 0
    buffer_load_dwordx4 v62, s[40:43], s82 offen lds
    s_and_b32 s20, s9, 3
    s_cmp_le_u32 s20, 1
    s_cselect_b32 s20, 2, 1
    s_add_u32 s96, s20, s85
    s_and_b32 s97, s96, 15
    s_lshl3_add_u32 s98, s97, s3
    s_mul_i32 s99, s98, 49152
    s_lshl_b32 s96, s11, 7
    s_add_u32 s82, s99, s96
    s_mul_i32 s96, s20, 24960
    s_lshr_b32 s97, s3, 1
    s_mul_i32 s98, s97, 2080
    s_add_u32 s99, s96, s98
    s_and_b32 s97, s3, 1
    s_mul_i32 s96, s97, 1056
    s_add_u32 s20, s99, s96
    s_mov_b32 m0, s20
    s_nop 0
    buffer_load_dwordx4 v62, s[40:43], s82 offen lds
    s_add_u32 s82, s82, 2048
    s_add_u32 m0, s20, 8320
    s_nop 0
    buffer_load_dwordx4 v62, s[40:43], s82 offen lds
    s_add_u32 s82, s82, 2048
    s_add_u32 m0, s20, 16640
    s_nop 0
    buffer_load_dwordx4 v62, s[40:43], s82 offen lds
    ds_read_b64_tr_b16 v[28:29], v4
    ds_read_b64_tr_b16 v[30:31], v4 offset:256
    ds_read_b64_tr_b16 v[32:33], v4 offset:1024
    ds_read_b64_tr_b16 v[34:35], v4 offset:1280
    s_lshl_b32 s96, s10, 6
    s_add_u32 s97, s96, s3
    s_lshl_b32 s98, s97, 12
    s_add_u32 s15, s98, 4194304
    s_and_b32 s96, s3, 3
    s_lshl_b32 s97, s96, 12
    s_add_u32 s13, s97, 147456
    v_add_u32 v76, s13, v2
    v_and_b32 v77, 15, v1
    v_lshl_add_u32 v77, v77, 4, s13
    v_lshrrev_b32 v9, 5, v1
    v_lshl_add_u32 v77, v9, 9, v77
    v_bfe_u32 v9, v1, 4, 1
    v_lshl_add_u32 v77, v9, 3, v77
    s_and_b32 s96, s3, 3
    s_lshl_b32 s97, s96, 10
    s_add_u32 s13, s97, 32768
    v_and_b32 v78, 15, v1
    v_lshl_add_u32 v78, v78, 5, s13
    v_lshrrev_b32 v9, 4, v1
    v_lshl_add_u32 v78, v9, 3, v78
    s_and_b32 s96, s3, 3
    s_lshl_b32 s97, s96, 10
    s_lshl_b32 s98, s76, 14
    s_add_u32 s13, s97, s98
    v_and_b32 v75, 31, v1
    v_lshl_add_u32 v75, v75, 5, s13
    v_lshrrev_b32 v9, 5, v1
    v_lshl_add_u32 v75, v9, 4, v75
    s_lshl_b32 s84, s3, 14
    s_lshr_b32 s96, s9, 4
    s_lshl_b32 s97, s96, 20
    s_lshl_b32 s98, s12, 7
    s_add_u32 s88, s97, s98
    s_lshl_b32 s89, s3, 10
    s_load_dwordx2 s[24:25], s[32:33], s92 offset:0 glc
    s_and_b32 s20, s9, 3
    s_cmp_le_u32 s20, 2
    s_cselect_b32 s20, 3, 2
    s_add_u32 s96, s20, s85
    s_and_b32 s97, s96, 15
    s_lshl3_add_u32 s98, s97, s3
    s_mul_i32 s99, s98, 49152
    s_lshl_b32 s96, s11, 7
    s_add_u32 s82, s99, s96
    s_mul_i32 s96, s20, 24960
    s_lshr_b32 s97, s3, 1
    s_mul_i32 s98, s97, 2080
    s_add_u32 s99, s96, s98
    s_and_b32 s97, s3, 1
    s_mul_i32 s96, s97, 1056
    s_add_u32 s20, s99, s96
    s_mov_b32 m0, s20
    s_nop 0
    buffer_load_dwordx4 v62, s[40:43], s82 offen lds
    s_add_u32 s82, s82, 2048
    s_add_u32 m0, s20, 8320
    s_nop 0
    buffer_load_dwordx4 v62, s[40:43], s82 offen lds
    s_add_u32 s82, s82, 2048
    s_add_u32 m0, s20, 16640
    s_nop 0
    buffer_load_dwordx4 v62, s[40:43], s82 offen lds
    s_add_u32 s96, s85, 4
    s_and_b32 s97, s96, 15
    s_lshl3_add_u32 s98, s97, s3
    s_mul_i32 s99, s98, 49152
    s_lshl_b32 s96, s11, 7
    s_add_u32 s82, s99, s96
    s_lshr_b32 s96, s3, 1
    s_mul_i32 s97, s96, 2080
    s_and_b32 s98, s3, 1
    s_mul_i32 s99, s98, 1056
    s_add_u32 s96, s97, s99
    s_add_u32 s20, s96, 99840
    s_mov_b32 m0, s20
    s_nop 0
    buffer_load_dwordx4 v62, s[40:43], s82 offen lds
    s_add_u32 s82, s82, 2048
    s_add_u32 m0, s20, 8320
    s_nop 0
    buffer_load_dwordx4 v62, s[40:43], s82 offen lds
    s_add_u32 s82, s82, 2048
    s_add_u32 m0, s20, 16640
    s_nop 0
    buffer_load_dwordx4 v62, s[40:43], s82 offen lds
    s_branch SCHK_12
SPOLL_11:
    s_load_dwordx2 s[24:25], s[32:33], s92 offset:0 glc
SCHK_12:
    s_add_u32 s5, s5, 1
    s_cmp_ge_u32 s5, 300000
    s_waitcnt lgkmcnt(0)
    s_cbranch_scc1 SDONE_13
    s_cmp_lg_u32 s24, s4
    s_cbranch_scc1 SPOLL_11
    s_cmp_lg_u32 s25, s4
    s_cbranch_scc1 SPOLL_11
SDONE_13:
    s_waitcnt vmcnt(9)
    s_barrier
    s_cmp_ge_u32 s3, 4
    s_cbranch_scc1 L_HELP
    s_setprio 2
    s_and_b32 s96, s85, 15
    s_lshl_b32 s97, s96, 14
    s_add_u32 s16, s97, s15
    buffer_load_dwordx4 v[176:179], v2, s[32:35], s16 offen sc1
    buffer_load_dwordx4 v[180:183], v2, s[32:35], s16 offen offset:1024 sc1
    ds_read_b64_tr_b16 v[224:225], v67 offset:8320
    ds_read_b64_tr_b16 v[226:227], v67 offset:8832
    ds_read_b64_tr_b16 v[228:229], v67 offset:8352
    ds_read_b64_tr_b16 v[230:231], v67 offset:8864
    ds_read_b64_tr_b16 v[232:233], v66 offset:8320
    ds_read_b64_tr_b16 v[234:235], v66 offset:8832
    ds_read_b64_tr_b16 v[236:237], v66 offset:8352
    ds_read_b64_tr_b16 v[238:239], v66 offset:8864
    ds_read_b64_tr_b16 v[240:241], v66
    ds_read_b64_tr_b16 v[242:243], v66 offset:512
    ds_read_b64_tr_b16 v[244:245], v66 offset:32
    ds_read_b64_tr_b16 v[246:247], v66 offset:544
    buffer_load_dwordx4 v[184:187], v2, s[32:35], s16 offen offset:2048 sc1
    buffer_load_dwordx4 v[188:191], v2, s[32:35], s16 offen offset:3072 sc1
    s_waitcnt lgkmcnt(8)
    s_waitcnt vmcnt(3)
    v_mfma_f32_16x16x32_bf16 v[128:131], v[224:227], v[176:179], 0
    ds_read_b64_tr_b16 v[248:249], v67
    s_waitcnt vmcnt(2)
    v_mfma_f32_16x16x32_bf16 v[132:135], v[224:227], v[180:183], 0
    ds_read_b64_tr_b16 v[250:251], v67 offset:512
    s_add_u32 s96, s85, 1
    s_and_b32 s97, s96, 15
    s_lshl_b32 s98, s97, 14
    s_add_u32 s16, s98, s15
    buffer_load_dwordx4 v[192:195], v2, s[32:35], s16 offen sc1
    v_mfma_f32_16x16x32_bf16 v[136:139], v[228:231], v[176:179], 0
    ds_read_b64_tr_b16 v[224:225], v67 offset:32
    v_mfma_f32_16x16x32_bf16 v[140:143], v[228:231], v[180:183], 0
    ds_read_b64_tr_b16 v[226:227], v67 offset:544
    s_waitcnt lgkmcnt(8)
    v_mfma_f32_16x16x32_bf16 v[112:115], v[232:235], v[176:179], 0
    ds_read_b64_tr_b16 v[228:229], v66 offset:16640
    v_mfma_f32_16x16x32_bf16 v[116:119], v[232:235], v[180:183], 0
    ds_read_b64_tr_b16 v[230:231], v66 offset:17152
    v_mfma_f32_16x16x32_bf16 v[120:123], v[236:239], v[176:179], 0
    ds_read_b64_tr_b16 v[232:233], v66 offset:16672
    v_mfma_f32_16x16x32_bf16 v[124:127], v[236:239], v[180:183], 0
    ds_read_b64_tr_b16 v[234:235], v66 offset:17184
    buffer_load_dwordx4 v[196:199], v2, s[32:35], s16 offen offset:1024 sc1
    s_waitcnt lgkmcnt(8)
    v_mfma_f32_16x16x32_bf16 v[80:83], v[240:243], v[176:179], 0
    ds_read_b64_tr_b16 v[236:237], v67 offset:16640
    v_mfma_f32_16x16x32_bf16 v[84:87], v[240:243], v[180:183], 0
    ds_read_b64_tr_b16 v[238:239], v67 offset:17152
    v_mfma_f32_16x16x32_bf16 v[88:91], v[244:247], v[176:179], 0
    ds_read_b64_tr_b16 v[240:241], v67 offset:16672
    v_mfma_f32_16x16x32_bf16 v[92:95], v[244:247], v[180:183], 0
    ds_read_b64_tr_b16 v[242:243], v67 offset:17184
    s_waitcnt lgkmcnt(8)
    v_mfma_f32_16x16x32_bf16 v[96:99], v[248:251], v[176:179], 0
    ds_read_b64_tr_b16 v[244:245], v67 offset:12480
    v_mfma_f32_16x16x32_bf16 v[100:103], v[248:251], v[180:183], 0
    ds_read_b64_tr_b16 v[246:247], v67 offset:12992
    buffer_load_dwordx4 v[200:203], v2, s[32:35], s16 offen offset:2048 sc1
    v_mfma_f32_16x16x32_bf16 v[104:107], v[224:227], v[176:179], 0
    ds_read_b64_tr_b16 v[248:249], v67 offset:12512
    v_mfma_f32_16x16x32_bf16 v[108:111], v[224:227], v[180:183], 0
    ds_read_b64_tr_b16 v[250:251], v67 offset:13024
    s_waitcnt lgkmcnt(8)
    v_mfma_f32_16x16x32_bf16 v[144:147], v[228:231], v[176:179], 0
    ds_read_b64_tr_b16 v[224:225], v66 offset:12480
    v_mfma_f32_16x16x32_bf16 v[148:151], v[228:231], v[180:183], 0
    ds_read_b64_tr_b16 v[226:227], v66 offset:12992
    v_mfma_f32_16x16x32_bf16 v[152:155], v[232:235], v[176:179], 0
    ds_read_b64_tr_b16 v[228:229], v66 offset:12512
    v_mfma_f32_16x16x32_bf16 v[156:159], v[232:235], v[180:183], 0
    ds_read_b64_tr_b16 v[230:231], v66 offset:13024
    buffer_load_dwordx4 v[204:207], v2, s[32:35], s16 offen offset:3072 sc1
    s_waitcnt lgkmcnt(8)
    v_mfma_f32_16x16x32_bf16 v[160:163], v[236:239], v[176:179], 0
    ds_read_b64_tr_b16 v[232:233], v66 offset:4160
    v_mfma_f32_16x16x32_bf16 v[164:167], v[236:239], v[180:183], 0
    ds_read_b64_tr_b16 v[234:235], v66 offset:4672
    v_mfma_f32_16x16x32_bf16 v[168:171], v[240:243], v[176:179], 0
    ds_read_b64_tr_b16 v[236:237], v66 offset:4192
    v_mfma_f32_16x16x32_bf16 v[172:175], v[240:243], v[180:183], 0
    ds_read_b64_tr_b16 v[238:239], v66 offset:4704
    s_waitcnt lgkmcnt(8)
    s_waitcnt vmcnt(5)
    v_mfma_f32_16x16x32_bf16 v[128:131], v[244:247], v[184:187], v[128:131]
    ds_read_b64_tr_b16 v[240:241], v67 offset:4160
    s_waitcnt vmcnt(4)
    v_mfma_f32_16x16x32_bf16 v[132:135], v[244:247], v[188:191], v[132:135]
    ds_read_b64_tr_b16 v[242:243], v67 offset:4672
    s_add_u32 s96, s85, 2
    s_and_b32 s97, s96, 15
    s_lshl_b32 s98, s97, 14
    s_add_u32 s16, s98, s15
    buffer_load_dwordx4 v[208:211], v2, s[32:35], s16 offen sc1
    v_mfma_f32_16x16x32_bf16 v[136:139], v[248:251], v[184:187], v[136:139]
    ds_read_b64_tr_b16 v[244:245], v67 offset:4192
    v_mfma_f32_16x16x32_bf16 v[140:143], v[248:251], v[188:191], v[140:143]
    ds_read_b64_tr_b16 v[246:247], v67 offset:4704
    s_waitcnt lgkmcnt(8)
    v_mfma_f32_16x16x32_bf16 v[112:115], v[224:227], v[184:187], v[112:115]
    ds_read_b64_tr_b16 v[248:249], v66 offset:20800
    v_mfma_f32_16x16x32_bf16 v[116:119], v[224:227], v[188:191], v[116:119]
    ds_read_b64_tr_b16 v[250:251], v66 offset:21312
    v_mfma_f32_16x16x32_bf16 v[120:123], v[228:231], v[184:187], v[120:123]
    ds_read_b64_tr_b16 v[224:225], v66 offset:20832
    v_mfma_f32_16x16x32_bf16 v[124:127], v[228:231], v[188:191], v[124:127]
    ds_read_b64_tr_b16 v[226:227], v66 offset:21344
    buffer_load_dwordx4 v[212:215], v2, s[32:35], s16 offen offset:1024 sc1
    s_waitcnt lgkmcnt(8)
    v_mfma_f32_16x16x32_bf16 v[80:83], v[232:235], v[184:187], v[80:83]
    ds_read_b64_tr_b16 v[228:229], v67 offset:20800
    v_mfma_f32_16x16x32_bf16 v[84:87], v[232:235], v[188:191], v[84:87]
    ds_read_b64_tr_b16 v[230:231], v67 offset:21312
    v_mfma_f32_16x16x32_bf16 v[88:91], v[236:239], v[184:187], v[88:91]
    ds_read_b64_tr_b16 v[232:233], v67 offset:20832
    v_mfma_f32_16x16x32_bf16 v[92:95], v[236:239], v[188:191], v[92:95]
    ds_read_b64_tr_b16 v[234:235], v67 offset:21344
    s_waitcnt lgkmcnt(8)
    v_mfma_f32_16x16x32_bf16 v[96:99], v[240:243], v[184:187], v[96:99]
    s_barrier
    ds_read_b64_tr_b16 v[236:237], v67 offset:33280
    v_mfma_f32_16x16x32_bf16 v[100:103], v[240:243], v[188:191], v[100:103]
    ds_read_b64_tr_b16 v[238:239], v67 offset:33792
    buffer_load_dwordx4 v[216:219], v2, s[32:35], s16 offen offset:2048 sc1
    v_mfma_f32_16x16x32_bf16 v[104:107], v[244:247], v[184:187], v[104:107]
    ds_read_b64_tr_b16 v[240:241], v67 offset:33312
    v_mfma_f32_16x16x32_bf16 v[108:111], v[244:247], v[188:191], v[108:111]
    ds_read_b64_tr_b16 v[242:243], v67 offset:33824
    s_waitcnt lgkmcnt(8)
    v_mfma_f32_16x16x32_bf16 v[144:147], v[248:251], v[184:187], v[144:147]
    ds_read_b64_tr_b16 v[244:245], v66 offset:33280
    v_mfma_f32_16x16x32_bf16 v[148:151], v[248:251], v[188:191], v[148:151]
    ds_read_b64_tr_b16 v[246:247], v66 offset:33792
    v_mfma_f32_16x16x32_bf16 v[152:155], v[224:227], v[184:187], v[152:155]
    ds_read_b64_tr_b16 v[248:249], v66 offset:33312
    v_mfma_f32_16x16x32_bf16 v[156:159], v[224:227], v[188:191], v[156:159]
    ds_read_b64_tr_b16 v[250:251], v66 offset:33824
    buffer_load_dwordx4 v[220:223], v2, s[32:35], s16 offen offset:3072 sc1
    s_waitcnt lgkmcnt(8)
    v_mfma_f32_16x16x32_bf16 v[160:163], v[228:231], v[184:187], v[160:163]
    ds_read_b64_tr_b16 v[224:225], v66 offset:24960
    v_mfma_f32_16x16x32_bf16 v[164:167], v[228:231], v[188:191], v[164:167]
    ds_read_b64_tr_b16 v[226:227], v66 offset:25472
    v_mfma_f32_16x16x32_bf16 v[168:171], v[232:235], v[184:187], v[168:171]
    ds_read_b64_tr_b16 v[228:229], v66 offset:24992
    v_mfma_f32_16x16x32_bf16 v[172:175], v[232:235], v[188:191], v[172:175]
    ds_read_b64_tr_b16 v[230:231], v66 offset:25504
    s_waitcnt lgkmcnt(8)
    s_waitcnt vmcnt(6)
    v_mfma_f32_16x16x32_bf16 v[128:131], v[236:239], v[192:195], v[128:131]
    ds_read_b64_tr_b16 v[232:233], v67 offset:24960
    v_mfma_f32_16x16x32_bf16 v[132:135], v[236:239], v[196:199], v[132:135]
    ds_read_b64_tr_b16 v[234:235], v67 offset:25472
    s_add_u32 s96, s85, 3
    s_and_b32 s97, s96, 15
    s_lshl_b32 s98, s97, 14
    s_add_u32 s16, s98, s15
    buffer_load_dwordx4 v[36:39], v2, s[32:35], s16 offen sc1
    v_mfma_f32_16x16x32_bf16 v[136:139], v[240:243], v[192:195], v[136:139]
    ds_read_b64_tr_b16 v[236:237], v67 offset:24992
    v_mfma_f32_16x16x32_bf16 v[140:143], v[240:243], v[196:199], v[140:143]
    ds_read_b64_tr_b16 v[238:239], v67 offset:25504
    s_waitcnt lgkmcnt(8)
    v_mfma_f32_16x16x32_bf16 v[112:115], v[244:247], v[192:195], v[112:115]
    ds_read_b64_tr_b16 v[240:241], v66 offset:41600
    v_mfma_f32_16x16x32_bf16 v[116:119], v[244:247], v[196:199], v[116:119]
    ds_read_b64_tr_b16 v[242:243], v66 offset:42112
    v_mfma_f32_16x16x32_bf16 v[120:123], v[248:251], v[192:195], v[120:123]
    ds_read_b64_tr_b16 v[244:245], v66 offset:41632
    v_mfma_f32_16x16x32_bf16 v[124:127], v[248:251], v[196:199], v[124:127]
    ds_read_b64_tr_b16 v[246:247], v66 offset:42144
    buffer_load_dwordx4 v[176:179], v2, s[32:35], s16 offen offset:1024 sc1
    s_waitcnt lgkmcnt(8)
    v_mfma_f32_16x16x32_bf16 v[80:83], v[224:227], v[192:195], v[80:83]
    ds_read_b64_tr_b16 v[248:249], v67 offset:41600
    v_mfma_f32_16x16x32_bf16 v[84:87], v[224:227], v[196:199], v[84:87]
    ds_read_b64_tr_b16 v[250:251], v67 offset:42112
    v_mfma_f32_16x16x32_bf16 v[88:91], v[228:231], v[192:195], v[88:91]
    ds_read_b64_tr_b16 v[224:225], v67 offset:41632
    v_mfma_f32_16x16x32_bf16 v[92:95], v[228:231], v[196:199], v[92:95]
    ds_read_b64_tr_b16 v[226:227], v67 offset:42144
    s_waitcnt lgkmcnt(8)
    v_mfma_f32_16x16x32_bf16 v[96:99], v[232:235], v[192:195], v[96:99]
    ds_read_b64_tr_b16 v[228:229], v67 offset:37440
    v_mfma_f32_16x16x32_bf16 v[100:103], v[232:235], v[196:199], v[100:103]
    ds_read_b64_tr_b16 v[230:231], v67 offset:37952
    buffer_load_dwordx4 v[180:183], v2, s[32:35], s16 offen offset:2048 sc1
    v_mfma_f32_16x16x32_bf16 v[104:107], v[236:239], v[192:195], v[104:107]
    ds_read_b64_tr_b16 v[232:233], v67 offset:37472
    v_mfma_f32_16x16x32_bf16 v[108:111], v[236:239], v[196:199], v[108:111]
    ds_read_b64_tr_b16 v[234:235], v67 offset:37984
    s_waitcnt lgkmcnt(8)
    v_mfma_f32_16x16x32_bf16 v[144:147], v[240:243], v[192:195], v[144:147]
    ds_read_b64_tr_b16 v[236:237], v66 offset:37440
    v_mfma_f32_16x16x32_bf16 v[148:151], v[240:243], v[196:199], v[148:151]
    ds_read_b64_tr_b16 v[238:239], v66 offset:37952
    v_mfma_f32_16x16x32_bf16 v[152:155], v[244:247], v[192:195], v[152:155]
    ds_read_b64_tr_b16 v[240:241], v66 offset:37472
    v_mfma_f32_16x16x32_bf16 v[156:159], v[244:247], v[196:199], v[156:159]
    ds_read_b64_tr_b16 v[242:243], v66 offset:37984
    buffer_load_dwordx4 v[184:187], v2, s[32:35], s16 offen offset:3072 sc1
    s_waitcnt lgkmcnt(8)
    v_mfma_f32_16x16x32_bf16 v[160:163], v[248:251], v[192:195], v[160:163]
    ds_read_b64_tr_b16 v[244:245], v66 offset:29120
    v_mfma_f32_16x16x32_bf16 v[164:167], v[248:251], v[196:199], v[164:167]
    ds_read_b64_tr_b16 v[246:247], v66 offset:29632
    v_mfma_f32_16x16x32_bf16 v[168:171], v[224:227], v[192:195], v[168:171]
    ds_read_b64_tr_b16 v[248:249], v66 offset:29152
    v_mfma_f32_16x16x32_bf16 v[172:175], v[224:227], v[196:199], v[172:175]
    ds_read_b64_tr_b16 v[250:251], v66 offset:29664
    s_waitcnt lgkmcnt(8)
    s_waitcnt vmcnt(8)
    v_mfma_f32_16x16x32_bf16 v[128:131], v[228:231], v[200:203], v[128:131]
    ds_read_b64_tr_b16 v[224:225], v67 offset:29120
    v_mfma_f32_16x16x32_bf16 v[132:135], v[228:231], v[204:207], v[132:135]
    ds_read_b64_tr_b16 v[226:227], v67 offset:29632
    s_add_u32 s96, s85, 4
    s_and_b32 s97, s96, 15
    s_lshl_b32 s98, s97, 14
    s_add_u32 s16, s98, s15
    buffer_load_dwordx4 v[188:191], v2, s[32:35], s16 offen sc1
    v_mfma_f32_16x16x32_bf16 v[136:139], v[232:235], v[200:203], v[136:139]
    ds_read_b64_tr_b16 v[228:229], v67 offset:29152
    v_mfma_f32_16x16x32_bf16 v[140:143], v[232:235], v[204:207], v[140:143]
    ds_read_b64_tr_b16 v[230:231], v67 offset:29664
    s_waitcnt lgkmcnt(8)
    v_mfma_f32_16x16x32_bf16 v[112:115], v[236:239], v[200:203], v[112:115]
    ds_read_b64_tr_b16 v[232:233], v66 offset:45760
    v_mfma_f32_16x16x32_bf16 v[116:119], v[236:239], v[204:207], v[116:119]
    ds_read_b64_tr_b16 v[234:235], v66 offset:46272
    v_mfma_f32_16x16x32_bf16 v[120:123], v[240:243], v[200:203], v[120:123]
    ds_read_b64_tr_b16 v[236:237], v66 offset:45792
    v_mfma_f32_16x16x32_bf16 v[124:127], v[240:243], v[204:207], v[124:127]
    ds_read_b64_tr_b16 v[238:239], v66 offset:46304
    buffer_load_dwordx4 v[192:195], v2, s[32:35], s16 offen offset:1024 sc1
    s_waitcnt lgkmcnt(8)
    v_mfma_f32_16x16x32_bf16 v[80:83], v[244:247], v[200:203], v[80:83]
    ds_read_b64_tr_b16 v[240:241], v67 offset:45760
    v_mfma_f32_16x16x32_bf16 v[84:87], v[244:247], v[204:207], v[84:87]
    ds_read_b64_tr_b16 v[242:243], v67 offset:46272
    v_mfma_f32_16x16x32_bf16 v[88:91], v[248:251], v[200:203], v[88:91]
    ds_read_b64_tr_b16 v[244:245], v67 offset:45792
    v_mfma_f32_16x16x32_bf16 v[92:95], v[248:251], v[204:207], v[92:95]
    ds_read_b64_tr_b16 v[246:247], v67 offset:46304
    s_waitcnt lgkmcnt(8)
    v_mfma_f32_16x16x32_bf16 v[96:99], v[224:227], v[200:203], v[96:99]
    s_barrier
    ds_read_b64_tr_b16 v[248:249], v69 offset:8320
    v_mfma_f32_16x16x32_bf16 v[100:103], v[224:227], v[204:207], v[100:103]
    ds_read_b64_tr_b16 v[250:251], v69 offset:8832
    buffer_load_dwordx4 v[196:199], v2, s[32:35], s16 offen offset:2048 sc1
    v_mfma_f32_16x16x32_bf16 v[104:107], v[228:231], v[200:203], v[104:107]
    ds_read_b64_tr_b16 v[224:225], v69 offset:8352
    v_mfma_f32_16x16x32_bf16 v[108:111], v[228:231], v[204:207], v[108:111]
    ds_read_b64_tr_b16 v[226:227], v69 offset:8864
    s_waitcnt lgkmcnt(8)
    v_mfma_f32_16x16x32_bf16 v[144:147], v[232:235], v[200:203], v[144:147]
    ds_read_b64_tr_b16 v[228:229], v68 offset:8320
    v_mfma_f32_16x16x32_bf16 v[148:151], v[232:235], v[204:207], v[148:151]
    ds_read_b64_tr_b16 v[230:231], v68 offset:8832
    v_mfma_f32_16x16x32_bf16 v[152:155], v[236:239], v[200:203], v[152:155]
    ds_read_b64_tr_b16 v[232:233], v68 offset:8352
    v_mfma_f32_16x16x32_bf16 v[156:159], v[236:239], v[204:207], v[156:159]
    ds_read_b64_tr_b16 v[234:235], v68 offset:8864
    s_waitcnt lgkmcnt(8)
    v_mfma_f32_16x16x32_bf16 v[160:163], v[240:243], v[200:203], v[160:163]
    ds_read_b64_tr_b16 v[236:237], v68
    v_mfma_f32_16x16x32_bf16 v[164:167], v[240:243], v[204:207], v[164:167]
    ds_read_b64_tr_b16 v[238:239], v68 offset:512
    v_mfma_f32_16x16x32_bf16 v[168:171], v[244:247], v[200:203], v[168:171]
    ds_read_b64_tr_b16 v[240:241], v68 offset:32
    v_mfma_f32_16x16x32_bf16 v[172:175], v[244:247], v[204:207], v[172:175]
    ds_read_b64_tr_b16 v[242:243], v68 offset:544
    s_waitcnt lgkmcnt(8)
    s_waitcnt vmcnt(9)
    v_mfma_f32_16x16x32_bf16 v[128:131], v[248:251], v[208:211], v[128:131]
    ds_read_b64_tr_b16 v[244:245], v69
    v_mfma_f32_16x16x32_bf16 v[132:135], v[248:251], v[212:215], v[132:135]
    ds_read_b64_tr_b16 v[246:247], v69 offset:512
    buffer_load_dwordx4 v[200:203], v2, s[32:35], s16 offen offset:3072 sc1
    v_mfma_f32_16x16x32_bf16 v[136:139], v[224:227], v[208:211], v[136:139]
    ds_read_b64_tr_b16 v[248:249], v69 offset:32
    v_mfma_f32_16x16x32_bf16 v[140:143], v[224:227], v[212:215], v[140:143]
    ds_read_b64_tr_b16 v[250:251], v69 offset:544
    s_waitcnt lgkmcnt(8)
    v_mfma_f32_16x16x32_bf16 v[112:115], v[228:231], v[208:211], v[112:115]
    ds_read_b64_tr_b16 v[224:225], v68 offset:16640
    v_mfma_f32_16x16x32_bf16 v[116:119], v[228:231], v[212:215], v[116:119]
    ds_read_b64_tr_b16 v[226:227], v68 offset:17152
    v_mfma_f32_16x16x32_bf16 v[120:123], v[232:235], v[208:211], v[120:123]
    ds_read_b64_tr_b16 v[228:229], v68 offset:16672
    v_mfma_f32_16x16x32_bf16 v[124:127], v[232:235], v[212:215], v[124:127]
    ds_read_b64_tr_b16 v[230:231], v68 offset:17184
    s_add_u32 s96, s85, 5
    s_and_b32 s97, s96, 15
    s_lshl_b32 s98, s97, 14
    s_add_u32 s16, s98, s15
    buffer_load_dwordx4 v[204:207], v2, s[32:35], s16 offen sc1
    s_waitcnt lgkmcnt(8)
    v_mfma_f32_16x16x32_bf16 v[80:83], v[236:239], v[208:211], v[80:83]
    ds_read_b64_tr_b16 v[232:233], v69 offset:16640
    v_mfma_f32_16x16x32_bf16 v[84:87], v[236:239], v[212:215], v[84:87]
    ds_read_b64_tr_b16 v[234:235], v69 offset:17152
    v_mfma_f32_16x16x32_bf16 v[88:91], v[240:243], v[208:211], v[88:91]
    ds_read_b64_tr_b16 v[236:237], v69 offset:16672
    v_mfma_f32_16x16x32_bf16 v[92:95], v[240:243], v[212:215], v[92:95]
    ds_read_b64_tr_b16 v[238:239], v69 offset:17184
    s_waitcnt lgkmcnt(8)
    v_mfma_f32_16x16x32_bf16 v[96:99], v[244:247], v[208:211], v[96:99]
    ds_read_b64_tr_b16 v[240:241], v69 offset:12480
    v_mfma_f32_16x16x32_bf16 v[100:103], v[244:247], v[212:215], v[100:103]
    ds_read_b64_tr_b16 v[242:243], v69 offset:12992
    v_mfma_f32_16x16x32_bf16 v[104:107], v[248:251], v[208:211], v[104:107]
    ds_read_b64_tr_b16 v[244:245], v69 offset:12512
    v_mfma_f32_16x16x32_bf16 v[108:111], v[248:251], v[212:215], v[108:111]
    ds_read_b64_tr_b16 v[246:247], v69 offset:13024
    s_waitcnt lgkmcnt(8)
    v_mfma_f32_16x16x32_bf16 v[144:147], v[224:227], v[208:211], v[144:147]
    ds_read_b64_tr_b16 v[248:249], v68 offset:12480
    v_mfma_f32_16x16x32_bf16 v[148:151], v[224:227], v[212:215], v[148:151]
    ds_read_b64_tr_b16 v[250:251], v68 offset:12992
    v_mfma_f32_16x16x32_bf16 v[152:155], v[228:231], v[208:211], v[152:155]
    ds_read_b64_tr_b16 v[224:225], v68 offset:12512
    v_mfma_f32_16x16x32_bf16 v[156:159], v[228:231], v[212:215], v[156:159]
    ds_read_b64_tr_b16 v[226:227], v68 offset:13024
    s_waitcnt lgkmcnt(8)
    v_mfma_f32_16x16x32_bf16 v[160:163], v[232:235], v[208:211], v[160:163]
    ds_read_b64_tr_b16 v[228:229], v68 offset:4160
    v_mfma_f32_16x16x32_bf16 v[164:167], v[232:235], v[212:215], v[164:167]
    ds_read_b64_tr_b16 v[230:231], v68 offset:4672
    v_mfma_f32_16x16x32_bf16 v[168:171], v[236:239], v[208:211], v[168:171]
    ds_read_b64_tr_b16 v[232:233], v68 offset:4192
    v_mfma_f32_16x16x32_bf16 v[172:175], v[236:239], v[212:215], v[172:175]
    ds_read_b64_tr_b16 v[234:235], v68 offset:4704
    s_waitcnt lgkmcnt(8)
    s_waitcnt vmcnt(9)
    v_mfma_f32_16x16x32_bf16 v[128:131], v[240:243], v[216:219], v[128:131]
    ds_read_b64_tr_b16 v[236:237], v69 offset:4160
    v_mfma_f32_16x16x32_bf16 v[132:135], v[240:243], v[220:223], v[132:135]
    ds_read_b64_tr_b16 v[238:239], v69 offset:4672
    buffer_load_dwordx4 v[208:211], v2, s[32:35], s16 offen offset:1024 sc1
    v_mfma_f32_16x16x32_bf16 v[136:139], v[244:247], v[216:219], v[136:139]
    ds_read_b64_tr_b16 v[240:241], v69 offset:4192
    v_mfma_f32_16x16x32_bf16 v[140:143], v[244:247], v[220:223], v[140:143]
    ds_read_b64_tr_b16 v[242:243], v69 offset:4704
    s_waitcnt lgkmcnt(8)
    v_mfma_f32_16x16x32_bf16 v[112:115], v[248:251], v[216:219], v[112:115]
    ds_read_b64_tr_b16 v[244:245], v68 offset:20800
    v_mfma_f32_16x16x32_bf16 v[116:119], v[248:251], v[220:223], v[116:119]
    ds_read_b64_tr_b16 v[246:247], v68 offset:21312
    v_mfma_f32_16x16x32_bf16 v[120:123], v[224:227], v[216:219], v[120:123]
    ds_read_b64_tr_b16 v[248:249], v68 offset:20832
    v_mfma_f32_16x16x32_bf16 v[124:127], v[224:227], v[220:223], v[124:127]
    ds_read_b64_tr_b16 v[250:251], v68 offset:21344
    buffer_load_dwordx4 v[212:215], v2, s[32:35], s16 offen offset:2048 sc1
    s_waitcnt lgkmcnt(8)
    v_mfma_f32_16x16x32_bf16 v[80:83], v[228:231], v[216:219], v[80:83]
    ds_read_b64_tr_b16 v[224:225], v69 offset:20800
    v_mfma_f32_16x16x32_bf16 v[84:87], v[228:231], v[220:223], v[84:87]
    ds_read_b64_tr_b16 v[226:227], v69 offset:21312
    v_mfma_f32_16x16x32_bf16 v[88:91], v[232:235], v[216:219], v[88:91]
    ds_read_b64_tr_b16 v[228:229], v69 offset:20832
    v_mfma_f32_16x16x32_bf16 v[92:95], v[232:235], v[220:223], v[92:95]
    ds_read_b64_tr_b16 v[230:231], v69 offset:21344
    s_waitcnt lgkmcnt(8)
    v_mfma_f32_16x16x32_bf16 v[96:99], v[236:239], v[216:219], v[96:99]
    s_barrier
    ds_read_b64_tr_b16 v[232:233], v69 offset:33280
    v_mfma_f32_16x16x32_bf16 v[100:103], v[236:239], v[220:223], v[100:103]
    ds_read_b64_tr_b16 v[234:235], v69 offset:33792
    v_mfma_f32_16x16x32_bf16 v[104:107], v[240:243], v[216:219], v[104:107]
    ds_read_b64_tr_b16 v[236:237], v69 offset:33312
    v_mfma_f32_16x16x32_bf16 v[108:111], v[240:243], v[220:223], v[108:111]
    ds_read_b64_tr_b16 v[238:239], v69 offset:33824
    s_waitcnt lgkmcnt(8)
    v_mfma_f32_16x16x32_bf16 v[144:147], v[244:247], v[216:219], v[144:147]
    ds_read_b64_tr_b16 v[240:241], v68 offset:33280
    v_mfma_f32_16x16x32_bf16 v[148:151], v[244:247], v[220:223], v[148:151]
    ds_read_b64_tr_b16 v[242:243], v68 offset:33792
    v_mfma_f32_16x16x32_bf16 v[152:155], v[248:251], v[216:219], v[152:155]
    ds_read_b64_tr_b16 v[244:245], v68 offset:33312
    v_mfma_f32_16x16x32_bf16 v[156:159], v[248:251], v[220:223], v[156:159]
    ds_read_b64_tr_b16 v[246:247], v68 offset:33824
    s_waitcnt lgkmcnt(8)
    v_mfma_f32_16x16x32_bf16 v[160:163], v[224:227], v[216:219], v[160:163]
    ds_read_b64_tr_b16 v[248:249], v68 offset:24960
    v_mfma_f32_16x16x32_bf16 v[164:167], v[224:227], v[220:223], v[164:167]
    ds_read_b64_tr_b16 v[250:251], v68 offset:25472
    v_mfma_f32_16x16x32_bf16 v[168:171], v[228:231], v[216:219], v[168:171]
    ds_read_b64_tr_b16 v[224:225], v68 offset:24992
    v_mfma_f32_16x16x32_bf16 v[172:175], v[228:231], v[220:223], v[172:175]
    ds_read_b64_tr_b16 v[226:227], v68 offset:25504
    s_waitcnt lgkmcnt(8)
    s_waitcnt vmcnt(9)
    v_mfma_f32_16x16x32_bf16 v[128:131], v[232:235], v[36:39], v[128:131]
    ds_read_b64_tr_b16 v[228:229], v69 offset:24960
    v_mfma_f32_16x16x32_bf16 v[132:135], v[232:235], v[176:179], v[132:135]
    ds_read_b64_tr_b16 v[230:231], v69 offset:25472
    buffer_load_dwordx4 v[216:219], v2, s[32:35], s16 offen offset:3072 sc1
    v_mfma_f32_16x16x32_bf16 v[136:139], v[236:239], v[36:39], v[136:139]
    ds_read_b64_tr_b16 v[232:233], v69 offset:24992
    v_mfma_f32_16x16x32_bf16 v[140:143], v[236:239], v[176:179], v[140:143]
    ds_read_b64_tr_b16 v[234:235], v69 offset:25504
    s_waitcnt lgkmcnt(8)
    v_mfma_f32_16x16x32_bf16 v[112:115], v[240:243], v[36:39], v[112:115]
    ds_read_b64_tr_b16 v[236:237], v68 offset:41600
    v_mfma_f32_16x16x32_bf16 v[116:119], v[240:243], v[176:179], v[116:119]
    ds_read_b64_tr_b16 v[238:239], v68 offset:42112
    v_mfma_f32_16x16x32_bf16 v[120:123], v[244:247], v[36:39], v[120:123]
    ds_read_b64_tr_b16 v[240:241], v68 offset:41632
    v_mfma_f32_16x16x32_bf16 v[124:127], v[244:247], v[176:179], v[124:127]
    ds_read_b64_tr_b16 v[242:243], v68 offset:42144
    s_add_u32 s96, s85, 6
    s_and_b32 s97, s96, 15
    s_lshl_b32 s98, s97, 14
    s_add_u32 s16, s98, s15
    buffer_load_dwordx4 v[220:223], v2, s[32:35], s16 offen sc1
    s_waitcnt lgkmcnt(8)
    v_mfma_f32_16x16x32_bf16 v[80:83], v[248:251], v[36:39], v[80:83]
    ds_read_b64_tr_b16 v[244:245], v69 offset:41600
    v_mfma_f32_16x16x32_bf16 v[84:87], v[248:251], v[176:179], v[84:87]
    ds_read_b64_tr_b16 v[246:247], v69 offset:42112
    v_mfma_f32_16x16x32_bf16 v[88:91], v[224:227], v[36:39], v[88:91]
    ds_read_b64_tr_b16 v[248:249], v69 offset:41632
    v_mfma_f32_16x16x32_bf16 v[92:95], v[224:227], v[176:179], v[92:95]
    ds_read_b64_tr_b16 v[250:251], v69 offset:42144
    s_waitcnt lgkmcnt(8)
    v_mfma_f32_16x16x32_bf16 v[96:99], v[228:231], v[36:39], v[96:99]
    ds_read_b64_tr_b16 v[224:225], v69 offset:37440
    v_mfma_f32_16x16x32_bf16 v[100:103], v[228:231], v[176:179], v[100:103]
    ds_read_b64_tr_b16 v[226:227], v69 offset:37952
    v_mfma_f32_16x16x32_bf16 v[104:107], v[232:235], v[36:39], v[104:107]
    ds_read_b64_tr_b16 v[228:229], v69 offset:37472
    v_mfma_f32_16x16x32_bf16 v[108:111], v[232:235], v[176:179], v[108:111]
    ds_read_b64_tr_b16 v[230:231], v69 offset:37984
    s_waitcnt lgkmcnt(8)
    v_mfma_f32_16x16x32_bf16 v[144:147], v[236:239], v[36:39], v[144:147]
    ds_read_b64_tr_b16 v[232:233], v68 offset:37440
    v_mfma_f32_16x16x32_bf16 v[148:151], v[236:239], v[176:179], v[148:151]
    ds_read_b64_tr_b16 v[234:235], v68 offset:37952
    v_mfma_f32_16x16x32_bf16 v[152:155], v[240:243], v[36:39], v[152:155]
    ds_read_b64_tr_b16 v[236:237], v68 offset:37472
    v_mfma_f32_16x16x32_bf16 v[156:159], v[240:243], v[176:179], v[156:159]
    ds_read_b64_tr_b16 v[238:239], v68 offset:37984
    s_waitcnt lgkmcnt(8)
    v_mfma_f32_16x16x32_bf16 v[160:163], v[244:247], v[36:39], v[160:163]
    ds_read_b64_tr_b16 v[240:241], v68 offset:29120
    v_mfma_f32_16x16x32_bf16 v[164:167], v[244:247], v[176:179], v[164:167]
    ds_read_b64_tr_b16 v[242:243], v68 offset:29632
    v_mfma_f32_16x16x32_bf16 v[168:171], v[248:251], v[36:39], v[168:171]
    ds_read_b64_tr_b16 v[244:245], v68 offset:29152
    v_mfma_f32_16x16x32_bf16 v[172:175], v[248:251], v[176:179], v[172:175]
    ds_read_b64_tr_b16 v[246:247], v68 offset:29664
    s_waitcnt lgkmcnt(8)
    s_waitcnt vmcnt(9)
    v_mfma_f32_16x16x32_bf16 v[128:131], v[224:227], v[180:183], v[128:131]
    ds_read_b64_tr_b16 v[248:249], v69 offset:29120
    v_mfma_f32_16x16x32_bf16 v[132:135], v[224:227], v[184:187], v[132:135]
    ds_read_b64_tr_b16 v[250:251], v69 offset:29632
    buffer_load_dwordx4 v[36:39], v2, s[32:35], s16 offen offset:1024 sc1
    v_mfma_f32_16x16x32_bf16 v[136:139], v[228:231], v[180:183], v[136:139]
    ds_read_b64_tr_b16 v[224:225], v69 offset:29152
    v_mfma_f32_16x16x32_bf16 v[140:143], v[228:231], v[184:187], v[140:143]
    ds_read_b64_tr_b16 v[226:227], v69 offset:29664
    s_waitcnt lgkmcnt(8)
    v_mfma_f32_16x16x32_bf16 v[112:115], v[232:235], v[180:183], v[112:115]
    ds_read_b64_tr_b16 v[228:229], v68 offset:45760
    v_mfma_f32_16x16x32_bf16 v[116:119], v[232:235], v[184:187], v[116:119]
    ds_read_b64_tr_b16 v[230:231], v68 offset:46272
    v_mfma_f32_16x16x32_bf16 v[120:123], v[236:239], v[180:183], v[120:123]
    ds_read_b64_tr_b16 v[232:233], v68 offset:45792
    v_mfma_f32_16x16x32_bf16 v[124:127], v[236:239], v[184:187], v[124:127]
    ds_read_b64_tr_b16 v[234:235], v68 offset:46304
    buffer_load_dwordx4 v[176:179], v2, s[32:35], s16 offen offset:2048 sc1
    s_waitcnt lgkmcnt(8)
    v_mfma_f32_16x16x32_bf16 v[80:83], v[240:243], v[180:183], v[80:83]
    ds_read_b64_tr_b16 v[236:237], v69 offset:45760
    v_mfma_f32_16x16x32_bf16 v[84:87], v[240:243], v[184:187], v[84:87]
    ds_read_b64_tr_b16 v[238:239], v69 offset:46272
    v_mfma_f32_16x16x32_bf16 v[88:91], v[244:247], v[180:183], v[88:91]
    ds_read_b64_tr_b16 v[240:241], v69 offset:45792
    v_mfma_f32_16x16x32_bf16 v[92:95], v[244:247], v[184:187], v[92:95]
    ds_read_b64_tr_b16 v[242:243], v69 offset:46304
    s_waitcnt lgkmcnt(8)
    v_mfma_f32_16x16x32_bf16 v[96:99], v[248:251], v[180:183], v[96:99]
    s_barrier
    ds_read_b64_tr_b16 v[244:245], v71 offset:8320
    v_mfma_f32_16x16x32_bf16 v[100:103], v[248:251], v[184:187], v[100:103]
    ds_read_b64_tr_b16 v[246:247], v71 offset:8832
    v_mfma_f32_16x16x32_bf16 v[104:107], v[224:227], v[180:183], v[104:107]
    ds_read_b64_tr_b16 v[248:249], v71 offset:8352
    v_mfma_f32_16x16x32_bf16 v[108:111], v[224:227], v[184:187], v[108:111]
    ds_read_b64_tr_b16 v[250:251], v71 offset:8864
    s_waitcnt lgkmcnt(8)
    v_mfma_f32_16x16x32_bf16 v[144:147], v[228:231], v[180:183], v[144:147]
    ds_read_b64_tr_b16 v[224:225], v70 offset:8320
    v_mfma_f32_16x16x32_bf16 v[148:151], v[228:231], v[184:187], v[148:151]
    ds_read_b64_tr_b16 v[226:227], v70 offset:8832
    v_mfma_f32_16x16x32_bf16 v[152:155], v[232:235], v[180:183], v[152:155]
    ds_read_b64_tr_b16 v[228:229], v70 offset:8352
    v_mfma_f32_16x16x32_bf16 v[156:159], v[232:235], v[184:187], v[156:159]
    ds_read_b64_tr_b16 v[230:231], v70 offset:8864
    s_waitcnt lgkmcnt(8)
    v_mfma_f32_16x16x32_bf16 v[160:163], v[236:239], v[180:183], v[160:163]
    ds_read_b64_tr_b16 v[232:233], v70
    v_mfma_f32_16x16x32_bf16 v[164:167], v[236:239], v[184:187], v[164:167]
    ds_read_b64_tr_b16 v[234:235], v70 offset:512
    v_mfma_f32_16x16x32_bf16 v[168:171], v[240:243], v[180:183], v[168:171]
    ds_read_b64_tr_b16 v[236:237], v70 offset:32
    v_mfma_f32_16x16x32_bf16 v[172:175], v[240:243], v[184:187], v[172:175]
    ds_read_b64_tr_b16 v[238:239], v70 offset:544
    s_waitcnt lgkmcnt(8)
    s_waitcnt vmcnt(9)
    v_mfma_f32_16x16x32_bf16 v[128:131], v[244:247], v[188:191], v[128:131]
    ds_read_b64_tr_b16 v[240:241], v71
    v_mfma_f32_16x16x32_bf16 v[132:135], v[244:247], v[192:195], v[132:135]
    ds_read_b64_tr_b16 v[242:243], v71 offset:512
    buffer_load_dwordx4 v[180:183], v2, s[32:35], s16 offen offset:3072 sc1
    v_mfma_f32_16x16x32_bf16 v[136:139], v[248:251], v[188:191], v[136:139]
    ds_read_b64_tr_b16 v[244:245], v71 offset:32
    v_mfma_f32_16x16x32_bf16 v[140:143], v[248:251], v[192:195], v[140:143]
    ds_read_b64_tr_b16 v[246:247], v71 offset:544
    s_waitcnt lgkmcnt(8)
    v_mfma_f32_16x16x32_bf16 v[112:115], v[224:227], v[188:191], v[112:115]
    ds_read_b64_tr_b16 v[248:249], v70 offset:16640
    v_mfma_f32_16x16x32_bf16 v[116:119], v[224:227], v[192:195], v[116:119]
    ds_read_b64_tr_b16 v[250:251], v70 offset:17152
    v_mfma_f32_16x16x32_bf16 v[120:123], v[228:231], v[188:191], v[120:123]
    ds_read_b64_tr_b16 v[224:225], v70 offset:16672
    v_mfma_f32_16x16x32_bf16 v[124:127], v[228:231], v[192:195], v[124:127]
    ds_read_b64_tr_b16 v[226:227], v70 offset:17184
    s_add_u32 s96, s85, 7
    s_and_b32 s97, s96, 15
    s_lshl_b32 s98, s97, 14
    s_add_u32 s16, s98, s15
    buffer_load_dwordx4 v[184:187], v2, s[32:35], s16 offen sc1
    s_waitcnt lgkmcnt(8)
    v_mfma_f32_16x16x32_bf16 v[80:83], v[232:235], v[188:191], v[80:83]
    ds_read_b64_tr_b16 v[228:229], v71 offset:16640
    v_mfma_f32_16x16x32_bf16 v[84:87], v[232:235], v[192:195], v[84:87]
    ds_read_b64_tr_b16 v[230:231], v71 offset:17152
    v_mfma_f32_16x16x32_bf16 v[88:91], v[236:239], v[188:191], v[88:91]
    ds_read_b64_tr_b16 v[232:233], v71 offset:16672
    v_mfma_f32_16x16x32_bf16 v[92:95], v[236:239], v[192:195], v[92:95]
    ds_read_b64_tr_b16 v[234:235], v71 offset:17184
    s_waitcnt lgkmcnt(8)
    v_mfma_f32_16x16x32_bf16 v[96:99], v[240:243], v[188:191], v[96:99]
    ds_read_b64_tr_b16 v[236:237], v71 offset:12480
    v_mfma_f32_16x16x32_bf16 v[100:103], v[240:243], v[192:195], v[100:103]
    ds_read_b64_tr_b16 v[238:239], v71 offset:12992
    v_mfma_f32_16x16x32_bf16 v[104:107], v[244:247], v[188:191], v[104:107]
    ds_read_b64_tr_b16 v[240:241], v71 offset:12512
    v_mfma_f32_16x16x32_bf16 v[108:111], v[244:247], v[192:195], v[108:111]
    ds_read_b64_tr_b16 v[242:243], v71 offset:13024
    s_waitcnt lgkmcnt(8)
    v_mfma_f32_16x16x32_bf16 v[144:147], v[248:251], v[188:191], v[144:147]
    ds_read_b64_tr_b16 v[244:245], v70 offset:12480
    v_mfma_f32_16x16x32_bf16 v[148:151], v[248:251], v[192:195], v[148:151]
    ds_read_b64_tr_b16 v[246:247], v70 offset:12992
    v_mfma_f32_16x16x32_bf16 v[152:155], v[224:227], v[188:191], v[152:155]
    ds_read_b64_tr_b16 v[248:249], v70 offset:12512
    v_mfma_f32_16x16x32_bf16 v[156:159], v[224:227], v[192:195], v[156:159]
    ds_read_b64_tr_b16 v[250:251], v70 offset:13024
    s_waitcnt lgkmcnt(8)
    v_mfma_f32_16x16x32_bf16 v[160:163], v[228:231], v[188:191], v[160:163]
    ds_read_b64_tr_b16 v[224:225], v70 offset:4160
    v_mfma_f32_16x16x32_bf16 v[164:167], v[228:231], v[192:195], v[164:167]
    ds_read_b64_tr_b16 v[226:227], v70 offset:4672
    v_mfma_f32_16x16x32_bf16 v[168:171], v[232:235], v[188:191], v[168:171]
    ds_read_b64_tr_b16 v[228:229], v70 offset:4192
    v_mfma_f32_16x16x32_bf16 v[172:175], v[232:235], v[192:195], v[172:175]
    ds_read_b64_tr_b16 v[230:231], v70 offset:4704
    s_waitcnt lgkmcnt(8)
    s_waitcnt vmcnt(9)
    v_mfma_f32_16x16x32_bf16 v[128:131], v[236:239], v[196:199], v[128:131]
    ds_read_b64_tr_b16 v[232:233], v71 offset:4160
    v_mfma_f32_16x16x32_bf16 v[132:135], v[236:239], v[200:203], v[132:135]
    ds_read_b64_tr_b16 v[234:235], v71 offset:4672
    buffer_load_dwordx4 v[188:191], v2, s[32:35], s16 offen offset:1024 sc1
    v_mfma_f32_16x16x32_bf16 v[136:139], v[240:243], v[196:199], v[136:139]
    ds_read_b64_tr_b16 v[236:237], v71 offset:4192
    v_mfma_f32_16x16x32_bf16 v[140:143], v[240:243], v[200:203], v[140:143]
    ds_read_b64_tr_b16 v[238:239], v71 offset:4704
    s_waitcnt lgkmcnt(8)
    v_mfma_f32_16x16x32_bf16 v[112:115], v[244:247], v[196:199], v[112:115]
    ds_read_b64_tr_b16 v[240:241], v70 offset:20800
    v_mfma_f32_16x16x32_bf16 v[116:119], v[244:247], v[200:203], v[116:119]
    ds_read_b64_tr_b16 v[242:243], v70 offset:21312
    v_mfma_f32_16x16x32_bf16 v[120:123], v[248:251], v[196:199], v[120:123]
    ds_read_b64_tr_b16 v[244:245], v70 offset:20832
    v_mfma_f32_16x16x32_bf16 v[124:127], v[248:251], v[200:203], v[124:127]
    ds_read_b64_tr_b16 v[246:247], v70 offset:21344
    buffer_load_dwordx4 v[192:195], v2, s[32:35], s16 offen offset:2048 sc1
    s_waitcnt lgkmcnt(8)
    v_mfma_f32_16x16x32_bf16 v[80:83], v[224:227], v[196:199], v[80:83]
    ds_read_b64_tr_b16 v[248:249], v71 offset:20800
    v_mfma_f32_16x16x32_bf16 v[84:87], v[224:227], v[200:203], v[84:87]
    ds_read_b64_tr_b16 v[250:251], v71 offset:21312
    v_mfma_f32_16x16x32_bf16 v[88:91], v[228:231], v[196:199], v[88:91]
    ds_read_b64_tr_b16 v[224:225], v71 offset:20832
    v_mfma_f32_16x16x32_bf16 v[92:95], v[228:231], v[200:203], v[92:95]
    ds_read_b64_tr_b16 v[226:227], v71 offset:21344
    s_waitcnt lgkmcnt(8)
    v_mfma_f32_16x16x32_bf16 v[96:99], v[232:235], v[196:199], v[96:99]
    s_barrier
    ds_read_b64_tr_b16 v[228:229], v71 offset:33280
    v_mfma_f32_16x16x32_bf16 v[100:103], v[232:235], v[200:203], v[100:103]
    ds_read_b64_tr_b16 v[230:231], v71 offset:33792
    v_mfma_f32_16x16x32_bf16 v[104:107], v[236:239], v[196:199], v[104:107]
    ds_read_b64_tr_b16 v[232:233], v71 offset:33312
    v_mfma_f32_16x16x32_bf16 v[108:111], v[236:239], v[200:203], v[108:111]
    ds_read_b64_tr_b16 v[234:235], v71 offset:33824
    s_waitcnt lgkmcnt(8)
    v_mfma_f32_16x16x32_bf16 v[144:147], v[240:243], v[196:199], v[144:147]
    ds_read_b64_tr_b16 v[236:237], v70 offset:33280
    v_mfma_f32_16x16x32_bf16 v[148:151], v[240:243], v[200:203], v[148:151]
    ds_read_b64_tr_b16 v[238:239], v70 offset:33792
    v_mfma_f32_16x16x32_bf16 v[152:155], v[244:247], v[196:199], v[152:155]
    ds_read_b64_tr_b16 v[240:241], v70 offset:33312
    v_mfma_f32_16x16x32_bf16 v[156:159], v[244:247], v[200:203], v[156:159]
    ds_read_b64_tr_b16 v[242:243], v70 offset:33824
    s_waitcnt lgkmcnt(8)
    v_mfma_f32_16x16x32_bf16 v[160:163], v[248:251], v[196:199], v[160:163]
    ds_read_b64_tr_b16 v[244:245], v70 offset:24960
    v_mfma_f32_16x16x32_bf16 v[164:167], v[248:251], v[200:203], v[164:167]
    ds_read_b64_tr_b16 v[246:247], v70 offset:25472
    v_mfma_f32_16x16x32_bf16 v[168:171], v[224:227], v[196:199], v[168:171]
    ds_read_b64_tr_b16 v[248:249], v70 offset:24992
    v_mfma_f32_16x16x32_bf16 v[172:175], v[224:227], v[200:203], v[172:175]
    ds_read_b64_tr_b16 v[250:251], v70 offset:25504
    s_waitcnt lgkmcnt(8)
    s_waitcnt vmcnt(9)
    v_mfma_f32_16x16x32_bf16 v[128:131], v[228:231], v[204:207], v[128:131]
    ds_read_b64_tr_b16 v[224:225], v71 offset:24960
    v_mfma_f32_16x16x32_bf16 v[132:135], v[228:231], v[208:211], v[132:135]
    ds_read_b64_tr_b16 v[226:227], v71 offset:25472
    buffer_load_dwordx4 v[196:199], v2, s[32:35], s16 offen offset:3072 sc1
    v_mfma_f32_16x16x32_bf16 v[136:139], v[232:235], v[204:207], v[136:139]
    ds_read_b64_tr_b16 v[228:229], v71 offset:24992
    v_mfma_f32_16x16x32_bf16 v[140:143], v[232:235], v[208:211], v[140:143]
    ds_read_b64_tr_b16 v[230:231], v71 offset:25504
    s_waitcnt lgkmcnt(8)
    v_mfma_f32_16x16x32_bf16 v[112:115], v[236:239], v[204:207], v[112:115]
    ds_read_b64_tr_b16 v[232:233], v70 offset:41600
    v_mfma_f32_16x16x32_bf16 v[116:119], v[236:239], v[208:211], v[116:119]
    ds_read_b64_tr_b16 v[234:235], v70 offset:42112
    v_mfma_f32_16x16x32_bf16 v[120:123], v[240:243], v[204:207], v[120:123]
    ds_read_b64_tr_b16 v[236:237], v70 offset:41632
    v_mfma_f32_16x16x32_bf16 v[124:127], v[240:243], v[208:211], v[124:127]
    ds_read_b64_tr_b16 v[238:239], v70 offset:42144
    s_add_u32 s96, s85, 8
    s_and_b32 s97, s96, 15
    s_lshl_b32 s98, s97, 14
    s_add_u32 s16, s98, s15
    buffer_load_dwordx4 v[200:203], v2, s[32:35], s16 offen sc1
    s_waitcnt lgkmcnt(8)
    v_mfma_f32_16x16x32_bf16 v[80:83], v[244:247], v[204:207], v[80:83]
    ds_read_b64_tr_b16 v[240:241], v71 offset:41600
    v_mfma_f32_16x16x32_bf16 v[84:87], v[244:247], v[208:211], v[84:87]
    ds_read_b64_tr_b16 v[242:243], v71 offset:42112
    v_mfma_f32_16x16x32_bf16 v[88:91], v[248:251], v[204:207], v[88:91]
    ds_read_b64_tr_b16 v[244:245], v71 offset:41632
    v_mfma_f32_16x16x32_bf16 v[92:95], v[248:251], v[208:211], v[92:95]
    ds_read_b64_tr_b16 v[246:247], v71 offset:42144
    s_waitcnt lgkmcnt(8)
    v_mfma_f32_16x16x32_bf16 v[96:99], v[224:227], v[204:207], v[96:99]
    ds_read_b64_tr_b16 v[248:249], v71 offset:37440
    v_mfma_f32_16x16x32_bf16 v[100:103], v[224:227], v[208:211], v[100:103]
    ds_read_b64_tr_b16 v[250:251], v71 offset:37952
    v_mfma_f32_16x16x32_bf16 v[104:107], v[228:231], v[204:207], v[104:107]
    ds_read_b64_tr_b16 v[224:225], v71 offset:37472
    v_mfma_f32_16x16x32_bf16 v[108:111], v[228:231], v[208:211], v[108:111]
    ds_read_b64_tr_b16 v[226:227], v71 offset:37984
    s_waitcnt lgkmcnt(8)
    v_mfma_f32_16x16x32_bf16 v[144:147], v[232:235], v[204:207], v[144:147]
    ds_read_b64_tr_b16 v[228:229], v70 offset:37440
    v_mfma_f32_16x16x32_bf16 v[148:151], v[232:235], v[208:211], v[148:151]
    ds_read_b64_tr_b16 v[230:231], v70 offset:37952
    v_mfma_f32_16x16x32_bf16 v[152:155], v[236:239], v[204:207], v[152:155]
    ds_read_b64_tr_b16 v[232:233], v70 offset:37472
    v_mfma_f32_16x16x32_bf16 v[156:159], v[236:239], v[208:211], v[156:159]
    ds_read_b64_tr_b16 v[234:235], v70 offset:37984
    s_waitcnt lgkmcnt(8)
    v_mfma_f32_16x16x32_bf16 v[160:163], v[240:243], v[204:207], v[160:163]
    ds_read_b64_tr_b16 v[236:237], v70 offset:29120
    v_mfma_f32_16x16x32_bf16 v[164:167], v[240:243], v[208:211], v[164:167]
    ds_read_b64_tr_b16 v[238:239], v70 offset:29632
    v_mfma_f32_16x16x32_bf16 v[168:171], v[244:247], v[204:207], v[168:171]
    ds_read_b64_tr_b16 v[240:241], v70 offset:29152
    v_mfma_f32_16x16x32_bf16 v[172:175], v[244:247], v[208:211], v[172:175]
    ds_read_b64_tr_b16 v[242:243], v70 offset:29664
    s_waitcnt lgkmcnt(8)
    s_waitcnt vmcnt(9)
    v_mfma_f32_16x16x32_bf16 v[128:131], v[248:251], v[212:215], v[128:131]
    ds_read_b64_tr_b16 v[244:245], v71 offset:29120
    v_mfma_f32_16x16x32_bf16 v[132:135], v[248:251], v[216:219], v[132:135]
    ds_read_b64_tr_b16 v[246:247], v71 offset:29632
    buffer_load_dwordx4 v[204:207], v2, s[32:35], s16 offen offset:1024 sc1
    v_mfma_f32_16x16x32_bf16 v[136:139], v[224:227], v[212:215], v[136:139]
    ds_read_b64_tr_b16 v[248:249], v71 offset:29152
    v_mfma_f32_16x16x32_bf16 v[140:143], v[224:227], v[216:219], v[140:143]
    ds_read_b64_tr_b16 v[250:251], v71 offset:29664
    s_waitcnt lgkmcnt(8)
    v_mfma_f32_16x16x32_bf16 v[112:115], v[228:231], v[212:215], v[112:115]
    ds_read_b64_tr_b16 v[224:225], v70 offset:45760
    v_mfma_f32_16x16x32_bf16 v[116:119], v[228:231], v[216:219], v[116:119]
    ds_read_b64_tr_b16 v[226:227], v70 offset:46272
    v_mfma_f32_16x16x32_bf16 v[120:123], v[232:235], v[212:215], v[120:123]
    ds_read_b64_tr_b16 v[228:229], v70 offset:45792
    v_mfma_f32_16x16x32_bf16 v[124:127], v[232:235], v[216:219], v[124:127]
    ds_read_b64_tr_b16 v[230:231], v70 offset:46304
    buffer_load_dwordx4 v[208:211], v2, s[32:35], s16 offen offset:2048 sc1
    s_waitcnt lgkmcnt(8)
    v_mfma_f32_16x16x32_bf16 v[80:83], v[236:239], v[212:215], v[80:83]
    ds_read_b64_tr_b16 v[232:233], v71 offset:45760
    v_mfma_f32_16x16x32_bf16 v[84:87], v[236:239], v[216:219], v[84:87]
    ds_read_b64_tr_b16 v[234:235], v71 offset:46272
    v_mfma_f32_16x16x32_bf16 v[88:91], v[240:243], v[212:215], v[88:91]
    ds_read_b64_tr_b16 v[236:237], v71 offset:45792
    v_mfma_f32_16x16x32_bf16 v[92:95], v[240:243], v[216:219], v[92:95]
    ds_read_b64_tr_b16 v[238:239], v71 offset:46304
    s_waitcnt lgkmcnt(8)
    v_mfma_f32_16x16x32_bf16 v[96:99], v[244:247], v[212:215], v[96:99]
    s_barrier
    ds_read_b64_tr_b16 v[240:241], v67 offset:8320
    v_mfma_f32_16x16x32_bf16 v[100:103], v[244:247], v[216:219], v[100:103]
    ds_read_b64_tr_b16 v[242:243], v67 offset:8832
    v_mfma_f32_16x16x32_bf16 v[104:107], v[248:251], v[212:215], v[104:107]
    ds_read_b64_tr_b16 v[244:245], v67 offset:8352
    v_mfma_f32_16x16x32_bf16 v[108:111], v[248:251], v[216:219], v[108:111]
    ds_read_b64_tr_b16 v[246:247], v67 offset:8864
    s_waitcnt lgkmcnt(8)
    v_mfma_f32_16x16x32_bf16 v[144:147], v[224:227], v[212:215], v[144:147]
    ds_read_b64_tr_b16 v[248:249], v66 offset:8320
    v_mfma_f32_16x16x32_bf16 v[148:151], v[224:227], v[216:219], v[148:151]
    ds_read_b64_tr_b16 v[250:251], v66 offset:8832
    v_mfma_f32_16x16x32_bf16 v[152:155], v[228:231], v[212:215], v[152:155]
    ds_read_b64_tr_b16 v[224:225], v66 offset:8352
    v_mfma_f32_16x16x32_bf16 v[156:159], v[228:231], v[216:219], v[156:159]
    ds_read_b64_tr_b16 v[226:227], v66 offset:8864
    s_waitcnt lgkmcnt(8)
    v_mfma_f32_16x16x32_bf16 v[160:163], v[232:235], v[212:215], v[160:163]
    ds_read_b64_tr_b16 v[228:229], v66
    v_mfma_f32_16x16x32_bf16 v[164:167], v[232:235], v[216:219], v[164:167]
    ds_read_b64_tr_b16 v[230:231], v66 offset:512
    v_mfma_f32_16x16x32_bf16 v[168:171], v[236:239], v[212:215], v[168:171]
    ds_read_b64_tr_b16 v[232:233], v66 offset:32
    v_mfma_f32_16x16x32_bf16 v[172:175], v[236:239], v[216:219], v[172:175]
    ds_read_b64_tr_b16 v[234:235], v66 offset:544
    s_waitcnt lgkmcnt(8)
    s_waitcnt vmcnt(9)
    v_mfma_f32_16x16x32_bf16 v[128:131], v[240:243], v[220:223], v[128:131]
    ds_read_b64_tr_b16 v[236:237], v67
    v_mfma_f32_16x16x32_bf16 v[132:135], v[240:243], v[36:39], v[132:135]
    ds_read_b64_tr_b16 v[238:239], v67 offset:512
    buffer_load_dwordx4 v[212:215], v2, s[32:35], s16 offen offset:3072 sc1
    v_mfma_f32_16x16x32_bf16 v[136:139], v[244:247], v[220:223], v[136:139]
    ds_read_b64_tr_b16 v[240:241], v67 offset:32
    v_mfma_f32_16x16x32_bf16 v[140:143], v[244:247], v[36:39], v[140:143]
    ds_read_b64_tr_b16 v[242:243], v67 offset:544
    s_waitcnt lgkmcnt(8)
    v_mfma_f32_16x16x32_bf16 v[112:115], v[248:251], v[220:223], v[112:115]
    ds_read_b64_tr_b16 v[244:245], v66 offset:16640
    v_mfma_f32_16x16x32_bf16 v[116:119], v[248:251], v[36:39], v[116:119]
    ds_read_b64_tr_b16 v[246:247], v66 offset:17152
    v_mfma_f32_16x16x32_bf16 v[120:123], v[224:227], v[220:223], v[120:123]
    ds_read_b64_tr_b16 v[248:249], v66 offset:16672
    v_mfma_f32_16x16x32_bf16 v[124:127], v[224:227], v[36:39], v[124:127]
    ds_read_b64_tr_b16 v[250:251], v66 offset:17184
    s_add_u32 s96, s85, 9
    s_and_b32 s97, s96, 15
    s_lshl_b32 s98, s97, 14
    s_add_u32 s16, s98, s15
    buffer_load_dwordx4 v[216:219], v2, s[32:35], s16 offen sc1
    s_waitcnt lgkmcnt(8)
    v_mfma_f32_16x16x32_bf16 v[80:83], v[228:231], v[220:223], v[80:83]
    ds_read_b64_tr_b16 v[224:225], v67 offset:16640
    v_mfma_f32_16x16x32_bf16 v[84:87], v[228:231], v[36:39], v[84:87]
    ds_read_b64_tr_b16 v[226:227], v67 offset:17152
    v_mfma_f32_16x16x32_bf16 v[88:91], v[232:235], v[220:223], v[88:91]
    ds_read_b64_tr_b16 v[228:229], v67 offset:16672
    v_mfma_f32_16x16x32_bf16 v[92:95], v[232:235], v[36:39], v[92:95]
    ds_read_b64_tr_b16 v[230:231], v67 offset:17184
    s_waitcnt lgkmcnt(8)
    v_mfma_f32_16x16x32_bf16 v[96:99], v[236:239], v[220:223], v[96:99]
    ds_read_b64_tr_b16 v[232:233], v67 offset:12480
    v_mfma_f32_16x16x32_bf16 v[100:103], v[236:239], v[36:39], v[100:103]
    ds_read_b64_tr_b16 v[234:235], v67 offset:12992
    v_mfma_f32_16x16x32_bf16 v[104:107], v[240:243], v[220:223], v[104:107]
    ds_read_b64_tr_b16 v[236:237], v67 offset:12512
    v_mfma_f32_16x16x32_bf16 v[108:111], v[240:243], v[36:39], v[108:111]
    ds_read_b64_tr_b16 v[238:239], v67 offset:13024
    s_waitcnt lgkmcnt(8)
    v_mfma_f32_16x16x32_bf16 v[144:147], v[244:247], v[220:223], v[144:147]
    ds_read_b64_tr_b16 v[240:241], v66 offset:12480
    v_mfma_f32_16x16x32_bf16 v[148:151], v[244:247], v[36:39], v[148:151]
    ds_read_b64_tr_b16 v[242:243], v66 offset:12992
    v_mfma_f32_16x16x32_bf16 v[152:155], v[248:251], v[220:223], v[152:155]
    ds_read_b64_tr_b16 v[244:245], v66 offset:12512
    v_mfma_f32_16x16x32_bf16 v[156:159], v[248:251], v[36:39], v[156:159]
    ds_read_b64_tr_b16 v[246:247], v66 offset:13024
    s_waitcnt lgkmcnt(8)
    v_mfma_f32_16x16x32_bf16 v[160:163], v[224:227], v[220:223], v[160:163]
    ds_read_b64_tr_b16 v[248:249], v66 offset:4160
    v_mfma_f32_16x16x32_bf16 v[164:167], v[224:227], v[36:39], v[164:167]
    ds_read_b64_tr_b16 v[250:251], v66 offset:4672
    v_mfma_f32_16x16x32_bf16 v[168:171], v[228:231], v[220:223], v[168:171]
    ds_read_b64_tr_b16 v[224:225], v66 offset:4192
    v_mfma_f32_16x16x32_bf16 v[172:175], v[228:231], v[36:39], v[172:175]
    ds_read_b64_tr_b16 v[226:227], v66 offset:4704
    s_waitcnt lgkmcnt(8)
    s_waitcnt vmcnt(9)
    v_mfma_f32_16x16x32_bf16 v[128:131], v[232:235], v[176:179], v[128:131]
    ds_read_b64_tr_b16 v[228:229], v67 offset:4160
    v_mfma_f32_16x16x32_bf16 v[132:135], v[232:235], v[180:183], v[132:135]
    ds_read_b64_tr_b16 v[230:231], v67 offset:4672
    buffer_load_dwordx4 v[220:223], v2, s[32:35], s16 offen offset:1024 sc1
    v_mfma_f32_16x16x32_bf16 v[136:139], v[236:239], v[176:179], v[136:139]
    ds_read_b64_tr_b16 v[232:233], v67 offset:4192
    v_mfma_f32_16x16x32_bf16 v[140:143], v[236:239], v[180:183], v[140:143]
    ds_read_b64_tr_b16 v[234:235], v67 offset:4704
    s_waitcnt lgkmcnt(8)
    v_mfma_f32_16x16x32_bf16 v[112:115], v[240:243], v[176:179], v[112:115]
    ds_read_b64_tr_b16 v[236:237], v66 offset:20800
    v_mfma_f32_16x16x32_bf16 v[116:119], v[240:243], v[180:183], v[116:119]
    ds_read_b64_tr_b16 v[238:239], v66 offset:21312
    v_mfma_f32_16x16x32_bf16 v[120:123], v[244:247], v[176:179], v[120:123]
    ds_read_b64_tr_b16 v[240:241], v66 offset:20832
    v_mfma_f32_16x16x32_bf16 v[124:127], v[244:247], v[180:183], v[124:127]
    ds_read_b64_tr_b16 v[242:243], v66 offset:21344
    buffer_load_dwordx4 v[36:39], v2, s[32:35], s16 offen offset:2048 sc1
    s_waitcnt lgkmcnt(8)
    v_mfma_f32_16x16x32_bf16 v[80:83], v[248:251], v[176:179], v[80:83]
    ds_read_b64_tr_b16 v[244:245], v67 offset:20800
    v_mfma_f32_16x16x32_bf16 v[84:87], v[248:251], v[180:183], v[84:87]
    ds_read_b64_tr_b16 v[246:247], v67 offset:21312
    v_mfma_f32_16x16x32_bf16 v[88:91], v[224:227], v[176:179], v[88:91]
    ds_read_b64_tr_b16 v[248:249], v67 offset:20832
    v_mfma_f32_16x16x32_bf16 v[92:95], v[224:227], v[180:183], v[92:95]
    ds_read_b64_tr_b16 v[250:251], v67 offset:21344
    s_waitcnt lgkmcnt(8)
    v_mfma_f32_16x16x32_bf16 v[96:99], v[228:231], v[176:179], v[96:99]
    s_barrier
    ds_read_b64_tr_b16 v[224:225], v67 offset:33280
    v_mfma_f32_16x16x32_bf16 v[100:103], v[228:231], v[180:183], v[100:103]
    ds_read_b64_tr_b16 v[226:227], v67 offset:33792
    v_mfma_f32_16x16x32_bf16 v[104:107], v[232:235], v[176:179], v[104:107]
    ds_read_b64_tr_b16 v[228:229], v67 offset:33312
    v_mfma_f32_16x16x32_bf16 v[108:111], v[232:235], v[180:183], v[108:111]
    ds_read_b64_tr_b16 v[230:231], v67 offset:33824
    s_waitcnt lgkmcnt(8)
    v_mfma_f32_16x16x32_bf16 v[144:147], v[236:239], v[176:179], v[144:147]
    ds_read_b64_tr_b16 v[232:233], v66 offset:33280
    v_mfma_f32_16x16x32_bf16 v[148:151], v[236:239], v[180:183], v[148:151]
    ds_read_b64_tr_b16 v[234:235], v66 offset:33792
    v_mfma_f32_16x16x32_bf16 v[152:155], v[240:243], v[176:179], v[152:155]
    ds_read_b64_tr_b16 v[236:237], v66 offset:33312
    v_mfma_f32_16x16x32_bf16 v[156:159], v[240:243], v[180:183], v[156:159]
    ds_read_b64_tr_b16 v[238:239], v66 offset:33824
    s_waitcnt lgkmcnt(8)
    v_mfma_f32_16x16x32_bf16 v[160:163], v[244:247], v[176:179], v[160:163]
    ds_read_b64_tr_b16 v[240:241], v66 offset:24960
    v_mfma_f32_16x16x32_bf16 v[164:167], v[244:247], v[180:183], v[164:167]
    ds_read_b64_tr_b16 v[242:243], v66 offset:25472
    v_mfma_f32_16x16x32_bf16 v[168:171], v[248:251], v[176:179], v[168:171]
    ds_read_b64_tr_b16 v[244:245], v66 offset:24992
    v_mfma_f32_16x16x32_bf16 v[172:175], v[248:251], v[180:183], v[172:175]
    ds_read_b64_tr_b16 v[246:247], v66 offset:25504
    s_waitcnt lgkmcnt(8)
    s_waitcnt vmcnt(9)
    v_mfma_f32_16x16x32_bf16 v[128:131], v[224:227], v[184:187], v[128:131]
    ds_read_b64_tr_b16 v[248:249], v67 offset:24960
    v_mfma_f32_16x16x32_bf16 v[132:135], v[224:227], v[188:191], v[132:135]
    ds_read_b64_tr_b16 v[250:251], v67 offset:25472
    buffer_load_dwordx4 v[176:179], v2, s[32:35], s16 offen offset:3072 sc1
    v_mfma_f32_16x16x32_bf16 v[136:139], v[228:231], v[184:187], v[136:139]
    ds_read_b64_tr_b16 v[224:225], v67 offset:24992
    v_mfma_f32_16x16x32_bf16 v[140:143], v[228:231], v[188:191], v[140:143]
    ds_read_b64_tr_b16 v[226:227], v67 offset:25504
    s_waitcnt lgkmcnt(8)
    v_mfma_f32_16x16x32_bf16 v[112:115], v[232:235], v[184:187], v[112:115]
    ds_read_b64_tr_b16 v[228:229], v66 offset:41600
    v_mfma_f32_16x16x32_bf16 v[116:119], v[232:235], v[188:191], v[116:119]
    ds_read_b64_tr_b16 v[230:231], v66 offset:42112
    v_mfma_f32_16x16x32_bf16 v[120:123], v[236:239], v[184:187], v[120:123]
    ds_read_b64_tr_b16 v[232:233], v66 offset:41632
    v_mfma_f32_16x16x32_bf16 v[124:127], v[236:239], v[188:191], v[124:127]
    ds_read_b64_tr_b16 v[234:235], v66 offset:42144
    s_add_u32 s96, s85, 10
    s_and_b32 s97, s96, 15
    s_lshl_b32 s98, s97, 14
    s_add_u32 s16, s98, s15
    buffer_load_dwordx4 v[180:183], v2, s[32:35], s16 offen sc1
    s_waitcnt lgkmcnt(8)
    v_mfma_f32_16x16x32_bf16 v[80:83], v[240:243], v[184:187], v[80:83]
    ds_read_b64_tr_b16 v[236:237], v67 offset:41600
    v_mfma_f32_16x16x32_bf16 v[84:87], v[240:243], v[188:191], v[84:87]
    ds_read_b64_tr_b16 v[238:239], v67 offset:42112
    v_mfma_f32_16x16x32_bf16 v[88:91], v[244:247], v[184:187], v[88:91]
    ds_read_b64_tr_b16 v[240:241], v67 offset:41632
    v_mfma_f32_16x16x32_bf16 v[92:95], v[244:247], v[188:191], v[92:95]
    ds_read_b64_tr_b16 v[242:243], v67 offset:42144
    s_waitcnt lgkmcnt(8)
    v_mfma_f32_16x16x32_bf16 v[96:99], v[248:251], v[184:187], v[96:99]
    ds_read_b64_tr_b16 v[244:245], v67 offset:37440
    v_mfma_f32_16x16x32_bf16 v[100:103], v[248:251], v[188:191], v[100:103]
    ds_read_b64_tr_b16 v[246:247], v67 offset:37952
    v_mfma_f32_16x16x32_bf16 v[104:107], v[224:227], v[184:187], v[104:107]
    ds_read_b64_tr_b16 v[248:249], v67 offset:37472
    v_mfma_f32_16x16x32_bf16 v[108:111], v[224:227], v[188:191], v[108:111]
    ds_read_b64_tr_b16 v[250:251], v67 offset:37984
    s_waitcnt lgkmcnt(8)
    v_mfma_f32_16x16x32_bf16 v[144:147], v[228:231], v[184:187], v[144:147]
    ds_read_b64_tr_b16 v[224:225], v66 offset:37440
    v_mfma_f32_16x16x32_bf16 v[148:151], v[228:231], v[188:191], v[148:151]
    ds_read_b64_tr_b16 v[226:227], v66 offset:37952
    v_mfma_f32_16x16x32_bf16 v[152:155], v[232:235], v[184:187], v[152:155]
    ds_read_b64_tr_b16 v[228:229], v66 offset:37472
    v_mfma_f32_16x16x32_bf16 v[156:159], v[232:235], v[188:191], v[156:159]
    ds_read_b64_tr_b16 v[230:231], v66 offset:37984
    s_waitcnt lgkmcnt(8)
    v_mfma_f32_16x16x32_bf16 v[160:163], v[236:239], v[184:187], v[160:163]
    ds_read_b64_tr_b16 v[232:233], v66 offset:29120
    v_mfma_f32_16x16x32_bf16 v[164:167], v[236:239], v[188:191], v[164:167]
    ds_read_b64_tr_b16 v[234:235], v66 offset:29632
    v_mfma_f32_16x16x32_bf16 v[168:171], v[240:243], v[184:187], v[168:171]
    ds_read_b64_tr_b16 v[236:237], v66 offset:29152
    v_mfma_f32_16x16x32_bf16 v[172:175], v[240:243], v[188:191], v[172:175]
    ds_read_b64_tr_b16 v[238:239], v66 offset:29664
    s_waitcnt lgkmcnt(8)
    s_waitcnt vmcnt(9)
    v_mfma_f32_16x16x32_bf16 v[128:131], v[244:247], v[192:195], v[128:131]
    ds_read_b64_tr_b16 v[240:241], v67 offset:29120
    v_mfma_f32_16x16x32_bf16 v[132:135], v[244:247], v[196:199], v[132:135]
    ds_read_b64_tr_b16 v[242:243], v67 offset:29632
    buffer_load_dwordx4 v[184:187], v2, s[32:35], s16 offen offset:1024 sc1
    v_mfma_f32_16x16x32_bf16 v[136:139], v[248:251], v[192:195], v[136:139]
    ds_read_b64_tr_b16 v[244:245], v67 offset:29152
    v_mfma_f32_16x16x32_bf16 v[140:143], v[248:251], v[196:199], v[140:143]
    ds_read_b64_tr_b16 v[246:247], v67 offset:29664
    s_waitcnt lgkmcnt(8)
    v_mfma_f32_16x16x32_bf16 v[112:115], v[224:227], v[192:195], v[112:115]
    ds_read_b64_tr_b16 v[248:249], v66 offset:45760
    v_mfma_f32_16x16x32_bf16 v[116:119], v[224:227], v[196:199], v[116:119]
    ds_read_b64_tr_b16 v[250:251], v66 offset:46272
    v_mfma_f32_16x16x32_bf16 v[120:123], v[228:231], v[192:195], v[120:123]
    ds_read_b64_tr_b16 v[224:225], v66 offset:45792
    v_mfma_f32_16x16x32_bf16 v[124:127], v[228:231], v[196:199], v[124:127]
    ds_read_b64_tr_b16 v[226:227], v66 offset:46304
    buffer_load_dwordx4 v[188:191], v2, s[32:35], s16 offen offset:2048 sc1
    s_waitcnt lgkmcnt(8)
    v_mfma_f32_16x16x32_bf16 v[80:83], v[232:235], v[192:195], v[80:83]
    ds_read_b64_tr_b16 v[228:229], v67 offset:45760
    v_mfma_f32_16x16x32_bf16 v[84:87], v[232:235], v[196:199], v[84:87]
    ds_read_b64_tr_b16 v[230:231], v67 offset:46272
    v_mfma_f32_16x16x32_bf16 v[88:91], v[236:239], v[192:195], v[88:91]
    ds_read_b64_tr_b16 v[232:233], v67 offset:45792
    v_mfma_f32_16x16x32_bf16 v[92:95], v[236:239], v[196:199], v[92:95]
    ds_read_b64_tr_b16 v[234:235], v67 offset:46304
    s_waitcnt lgkmcnt(8)
    v_mfma_f32_16x16x32_bf16 v[96:99], v[240:243], v[192:195], v[96:99]
    s_barrier
    ds_read_b64_tr_b16 v[236:237], v69 offset:8320
    v_mfma_f32_16x16x32_bf16 v[100:103], v[240:243], v[196:199], v[100:103]
    ds_read_b64_tr_b16 v[238:239], v69 offset:8832
    v_mfma_f32_16x16x32_bf16 v[104:107], v[244:247], v[192:195], v[104:107]
    ds_read_b64_tr_b16 v[240:241], v69 offset:8352
    v_mfma_f32_16x16x32_bf16 v[108:111], v[244:247], v[196:199], v[108:111]
    ds_read_b64_tr_b16 v[242:243], v69 offset:8864
    s_waitcnt lgkmcnt(8)
    v_mfma_f32_16x16x32_bf16 v[144:147], v[248:251], v[192:195], v[144:147]
    ds_read_b64_tr_b16 v[244:245], v68 offset:8320
    v_mfma_f32_16x16x32_bf16 v[148:151], v[248:251], v[196:199], v[148:151]
    ds_read_b64_tr_b16 v[246:247], v68 offset:8832
    v_mfma_f32_16x16x32_bf16 v[152:155], v[224:227], v[192:195], v[152:155]
    ds_read_b64_tr_b16 v[248:249], v68 offset:8352
    v_mfma_f32_16x16x32_bf16 v[156:159], v[224:227], v[196:199], v[156:159]
    ds_read_b64_tr_b16 v[250:251], v68 offset:8864
    s_waitcnt lgkmcnt(8)
    v_mfma_f32_16x16x32_bf16 v[160:163], v[228:231], v[192:195], v[160:163]
    ds_read_b64_tr_b16 v[224:225], v68
    v_mfma_f32_16x16x32_bf16 v[164:167], v[228:231], v[196:199], v[164:167]
    ds_read_b64_tr_b16 v[226:227], v68 offset:512
    v_mfma_f32_16x16x32_bf16 v[168:171], v[232:235], v[192:195], v[168:171]
    ds_read_b64_tr_b16 v[228:229], v68 offset:32
    v_mfma_f32_16x16x32_bf16 v[172:175], v[232:235], v[196:199], v[172:175]
    ds_read_b64_tr_b16 v[230:231], v68 offset:544
    s_waitcnt lgkmcnt(8)
    s_waitcnt vmcnt(9)
    v_mfma_f32_16x16x32_bf16 v[128:131], v[236:239], v[200:203], v[128:131]
    ds_read_b64_tr_b16 v[232:233], v69
    v_mfma_f32_16x16x32_bf16 v[132:135], v[236:239], v[204:207], v[132:135]
    ds_read_b64_tr_b16 v[234:235], v69 offset:512
    buffer_load_dwordx4 v[192:195], v2, s[32:35], s16 offen offset:3072 sc1
    v_mfma_f32_16x16x32_bf16 v[136:139], v[240:243], v[200:203], v[136:139]
    ds_read_b64_tr_b16 v[236:237], v69 offset:32
    v_mfma_f32_16x16x32_bf16 v[140:143], v[240:243], v[204:207], v[140:143]
    ds_read_b64_tr_b16 v[238:239], v69 offset:544
    s_waitcnt lgkmcnt(8)
    v_mfma_f32_16x16x32_bf16 v[112:115], v[244:247], v[200:203], v[112:115]
    ds_read_b64_tr_b16 v[240:241], v68 offset:16640
    v_mfma_f32_16x16x32_bf16 v[116:119], v[244:247], v[204:207], v[116:119]
    ds_read_b64_tr_b16 v[242:243], v68 offset:17152
    v_mfma_f32_16x16x32_bf16 v[120:123], v[248:251], v[200:203], v[120:123]
    ds_read_b64_tr_b16 v[244:245], v68 offset:16672
    v_mfma_f32_16x16x32_bf16 v[124:127], v[248:251], v[204:207], v[124:127]
    ds_read_b64_tr_b16 v[246:247], v68 offset:17184
    s_add_u32 s96, s85, 11
    s_and_b32 s97, s96, 15
    s_lshl_b32 s98, s97, 14
    s_add_u32 s16, s98, s15
    buffer_load_dwordx4 v[196:199], v2, s[32:35], s16 offen sc1
    s_waitcnt lgkmcnt(8)
    v_mfma_f32_16x16x32_bf16 v[80:83], v[224:227], v[200:203], v[80:83]
    ds_read_b64_tr_b16 v[248:249], v69 offset:16640
    v_mfma_f32_16x16x32_bf16 v[84:87], v[224:227], v[204:207], v[84:87]
    ds_read_b64_tr_b16 v[250:251], v69 offset:17152
    v_mfma_f32_16x16x32_bf16 v[88:91], v[228:231], v[200:203], v[88:91]
    ds_read_b64_tr_b16 v[224:225], v69 offset:16672
    v_mfma_f32_16x16x32_bf16 v[92:95], v[228:231], v[204:207], v[92:95]
    ds_read_b64_tr_b16 v[226:227], v69 offset:17184
    s_waitcnt lgkmcnt(8)
    v_mfma_f32_16x16x32_bf16 v[96:99], v[232:235], v[200:203], v[96:99]
    ds_read_b64_tr_b16 v[228:229], v69 offset:12480
    v_mfma_f32_16x16x32_bf16 v[100:103], v[232:235], v[204:207], v[100:103]
    ds_read_b64_tr_b16 v[230:231], v69 offset:12992
    v_mfma_f32_16x16x32_bf16 v[104:107], v[236:239], v[200:203], v[104:107]
    ds_read_b64_tr_b16 v[232:233], v69 offset:12512
    v_mfma_f32_16x16x32_bf16 v[108:111], v[236:239], v[204:207], v[108:111]
    ds_read_b64_tr_b16 v[234:235], v69 offset:13024
    s_waitcnt lgkmcnt(8)
    v_mfma_f32_16x16x32_bf16 v[144:147], v[240:243], v[200:203], v[144:147]
    ds_read_b64_tr_b16 v[236:237], v68 offset:12480
    v_mfma_f32_16x16x32_bf16 v[148:151], v[240:243], v[204:207], v[148:151]
    ds_read_b64_tr_b16 v[238:239], v68 offset:12992
    v_mfma_f32_16x16x32_bf16 v[152:155], v[244:247], v[200:203], v[152:155]
    ds_read_b64_tr_b16 v[240:241], v68 offset:12512
    v_mfma_f32_16x16x32_bf16 v[156:159], v[244:247], v[204:207], v[156:159]
    ds_read_b64_tr_b16 v[242:243], v68 offset:13024
    s_waitcnt lgkmcnt(8)
    v_mfma_f32_16x16x32_bf16 v[160:163], v[248:251], v[200:203], v[160:163]
    ds_read_b64_tr_b16 v[244:245], v68 offset:4160
    v_mfma_f32_16x16x32_bf16 v[164:167], v[248:251], v[204:207], v[164:167]
    ds_read_b64_tr_b16 v[246:247], v68 offset:4672
    v_mfma_f32_16x16x32_bf16 v[168:171], v[224:227], v[200:203], v[168:171]
    ds_read_b64_tr_b16 v[248:249], v68 offset:4192
    v_mfma_f32_16x16x32_bf16 v[172:175], v[224:227], v[204:207], v[172:175]
    ds_read_b64_tr_b16 v[250:251], v68 offset:4704
    s_waitcnt lgkmcnt(8)
    s_waitcnt vmcnt(9)
    v_mfma_f32_16x16x32_bf16 v[128:131], v[228:231], v[208:211], v[128:131]
    ds_read_b64_tr_b16 v[224:225], v69 offset:4160
    v_mfma_f32_16x16x32_bf16 v[132:135], v[228:231], v[212:215], v[132:135]
    ds_read_b64_tr_b16 v[226:227], v69 offset:4672
    buffer_load_dwordx4 v[200:203], v2, s[32:35], s16 offen offset:1024 sc1
    v_mfma_f32_16x16x32_bf16 v[136:139], v[232:235], v[208:211], v[136:139]
    ds_read_b64_tr_b16 v[228:229], v69 offset:4192
    v_mfma_f32_16x16x32_bf16 v[140:143], v[232:235], v[212:215], v[140:143]
    ds_read_b64_tr_b16 v[230:231], v69 offset:4704
    s_waitcnt lgkmcnt(8)
    v_mfma_f32_16x16x32_bf16 v[112:115], v[236:239], v[208:211], v[112:115]
    ds_read_b64_tr_b16 v[232:233], v68 offset:20800
    v_mfma_f32_16x16x32_bf16 v[116:119], v[236:239], v[212:215], v[116:119]
    ds_read_b64_tr_b16 v[234:235], v68 offset:21312
    v_mfma_f32_16x16x32_bf16 v[120:123], v[240:243], v[208:211], v[120:123]
    ds_read_b64_tr_b16 v[236:237], v68 offset:20832
    v_mfma_f32_16x16x32_bf16 v[124:127], v[240:243], v[212:215], v[124:127]
    ds_read_b64_tr_b16 v[238:239], v68 offset:21344
    buffer_load_dwordx4 v[204:207], v2, s[32:35], s16 offen offset:2048 sc1
    s_waitcnt lgkmcnt(8)
    v_mfma_f32_16x16x32_bf16 v[80:83], v[244:247], v[208:211], v[80:83]
    ds_read_b64_tr_b16 v[240:241], v69 offset:20800
    v_mfma_f32_16x16x32_bf16 v[84:87], v[244:247], v[212:215], v[84:87]
    ds_read_b64_tr_b16 v[242:243], v69 offset:21312
    v_mfma_f32_16x16x32_bf16 v[88:91], v[248:251], v[208:211], v[88:91]
    ds_read_b64_tr_b16 v[244:245], v69 offset:20832
    v_mfma_f32_16x16x32_bf16 v[92:95], v[248:251], v[212:215], v[92:95]
    ds_read_b64_tr_b16 v[246:247], v69 offset:21344
    s_waitcnt lgkmcnt(8)
    v_mfma_f32_16x16x32_bf16 v[96:99], v[224:227], v[208:211], v[96:99]
    s_barrier
    ds_read_b64_tr_b16 v[248:249], v69 offset:33280
    v_mfma_f32_16x16x32_bf16 v[100:103], v[224:227], v[212:215], v[100:103]
    ds_read_b64_tr_b16 v[250:251], v69 offset:33792
    v_mfma_f32_16x16x32_bf16 v[104:107], v[228:231], v[208:211], v[104:107]
    ds_read_b64_tr_b16 v[224:225], v69 offset:33312
    v_mfma_f32_16x16x32_bf16 v[108:111], v[228:231], v[212:215], v[108:111]
    ds_read_b64_tr_b16 v[226:227], v69 offset:33824
    s_waitcnt lgkmcnt(8)
    v_mfma_f32_16x16x32_bf16 v[144:147], v[232:235], v[208:211], v[144:147]
    ds_read_b64_tr_b16 v[228:229], v68 offset:33280
    v_mfma_f32_16x16x32_bf16 v[148:151], v[232:235], v[212:215], v[148:151]
    ds_read_b64_tr_b16 v[230:231], v68 offset:33792
    v_mfma_f32_16x16x32_bf16 v[152:155], v[236:239], v[208:211], v[152:155]
    ds_read_b64_tr_b16 v[232:233], v68 offset:33312
    v_mfma_f32_16x16x32_bf16 v[156:159], v[236:239], v[212:215], v[156:159]
    ds_read_b64_tr_b16 v[234:235], v68 offset:33824
    s_waitcnt lgkmcnt(8)
    v_mfma_f32_16x16x32_bf16 v[160:163], v[240:243], v[208:211], v[160:163]
    ds_read_b64_tr_b16 v[236:237], v68 offset:24960
    v_mfma_f32_16x16x32_bf16 v[164:167], v[240:243], v[212:215], v[164:167]
    ds_read_b64_tr_b16 v[238:239], v68 offset:25472
    v_mfma_f32_16x16x32_bf16 v[168:171], v[244:247], v[208:211], v[168:171]
    ds_read_b64_tr_b16 v[240:241], v68 offset:24992
    v_mfma_f32_16x16x32_bf16 v[172:175], v[244:247], v[212:215], v[172:175]
    ds_read_b64_tr_b16 v[242:243], v68 offset:25504
    s_waitcnt lgkmcnt(8)
    s_waitcnt vmcnt(9)
    v_mfma_f32_16x16x32_bf16 v[128:131], v[248:251], v[216:219], v[128:131]
    ds_read_b64_tr_b16 v[244:245], v69 offset:24960
    v_mfma_f32_16x16x32_bf16 v[132:135], v[248:251], v[220:223], v[132:135]
    ds_read_b64_tr_b16 v[246:247], v69 offset:25472
    buffer_load_dwordx4 v[208:211], v2, s[32:35], s16 offen offset:3072 sc1
    v_mfma_f32_16x16x32_bf16 v[136:139], v[224:227], v[216:219], v[136:139]
    ds_read_b64_tr_b16 v[248:249], v69 offset:24992
    v_mfma_f32_16x16x32_bf16 v[140:143], v[224:227], v[220:223], v[140:143]
    ds_read_b64_tr_b16 v[250:251], v69 offset:25504
    s_waitcnt lgkmcnt(8)
    v_mfma_f32_16x16x32_bf16 v[112:115], v[228:231], v[216:219], v[112:115]
    ds_read_b64_tr_b16 v[224:225], v68 offset:41600
    v_mfma_f32_16x16x32_bf16 v[116:119], v[228:231], v[220:223], v[116:119]
    ds_read_b64_tr_b16 v[226:227], v68 offset:42112
    v_mfma_f32_16x16x32_bf16 v[120:123], v[232:235], v[216:219], v[120:123]
    ds_read_b64_tr_b16 v[228:229], v68 offset:41632
    v_mfma_f32_16x16x32_bf16 v[124:127], v[232:235], v[220:223], v[124:127]
    ds_read_b64_tr_b16 v[230:231], v68 offset:42144
    s_add_u32 s96, s85, 12
    s_and_b32 s97, s96, 15
    s_lshl_b32 s98, s97, 14
    s_add_u32 s16, s98, s15
    buffer_load_dwordx4 v[212:215], v2, s[32:35], s16 offen sc1
    s_waitcnt lgkmcnt(8)
    v_mfma_f32_16x16x32_bf16 v[80:83], v[236:239], v[216:219], v[80:83]
    ds_read_b64_tr_b16 v[232:233], v69 offset:41600
    v_mfma_f32_16x16x32_bf16 v[84:87], v[236:239], v[220:223], v[84:87]
    ds_read_b64_tr_b16 v[234:235], v69 offset:42112
    v_mfma_f32_16x16x32_bf16 v[88:91], v[240:243], v[216:219], v[88:91]
    ds_read_b64_tr_b16 v[236:237], v69 offset:41632
    v_mfma_f32_16x16x32_bf16 v[92:95], v[240:243], v[220:223], v[92:95]
    ds_read_b64_tr_b16 v[238:239], v69 offset:42144
    s_waitcnt lgkmcnt(8)
    v_mfma_f32_16x16x32_bf16 v[96:99], v[244:247], v[216:219], v[96:99]
    ds_read_b64_tr_b16 v[240:241], v69 offset:37440
    v_mfma_f32_16x16x32_bf16 v[100:103], v[244:247], v[220:223], v[100:103]
    ds_read_b64_tr_b16 v[242:243], v69 offset:37952
    v_mfma_f32_16x16x32_bf16 v[104:107], v[248:251], v[216:219], v[104:107]
    ds_read_b64_tr_b16 v[244:245], v69 offset:37472
    v_mfma_f32_16x16x32_bf16 v[108:111], v[248:251], v[220:223], v[108:111]
    ds_read_b64_tr_b16 v[246:247], v69 offset:37984
    s_waitcnt lgkmcnt(8)
    v_mfma_f32_16x16x32_bf16 v[144:147], v[224:227], v[216:219], v[144:147]
    ds_read_b64_tr_b16 v[248:249], v68 offset:37440
    v_mfma_f32_16x16x32_bf16 v[148:151], v[224:227], v[220:223], v[148:151]
    ds_read_b64_tr_b16 v[250:251], v68 offset:37952
    v_mfma_f32_16x16x32_bf16 v[152:155], v[228:231], v[216:219], v[152:155]
    ds_read_b64_tr_b16 v[224:225], v68 offset:37472
    v_mfma_f32_16x16x32_bf16 v[156:159], v[228:231], v[220:223], v[156:159]
    ds_read_b64_tr_b16 v[226:227], v68 offset:37984
    s_waitcnt lgkmcnt(8)
    v_mfma_f32_16x16x32_bf16 v[160:163], v[232:235], v[216:219], v[160:163]
    ds_read_b64_tr_b16 v[228:229], v68 offset:29120
    v_mfma_f32_16x16x32_bf16 v[164:167], v[232:235], v[220:223], v[164:167]
    ds_read_b64_tr_b16 v[230:231], v68 offset:29632
    v_mfma_f32_16x16x32_bf16 v[168:171], v[236:239], v[216:219], v[168:171]
    ds_read_b64_tr_b16 v[232:233], v68 offset:29152
    v_mfma_f32_16x16x32_bf16 v[172:175], v[236:239], v[220:223], v[172:175]
    ds_read_b64_tr_b16 v[234:235], v68 offset:29664
    s_waitcnt lgkmcnt(8)
    s_waitcnt vmcnt(9)
    v_mfma_f32_16x16x32_bf16 v[128:131], v[240:243], v[36:39], v[128:131]
    ds_read_b64_tr_b16 v[236:237], v69 offset:29120
    v_mfma_f32_16x16x32_bf16 v[132:135], v[240:243], v[176:179], v[132:135]
    ds_read_b64_tr_b16 v[238:239], v69 offset:29632
    buffer_load_dwordx4 v[216:219], v2, s[32:35], s16 offen offset:1024 sc1
    v_mfma_f32_16x16x32_bf16 v[136:139], v[244:247], v[36:39], v[136:139]
    ds_read_b64_tr_b16 v[240:241], v69 offset:29152
    v_mfma_f32_16x16x32_bf16 v[140:143], v[244:247], v[176:179], v[140:143]
    ds_read_b64_tr_b16 v[242:243], v69 offset:29664
    s_waitcnt lgkmcnt(8)
    v_mfma_f32_16x16x32_bf16 v[112:115], v[248:251], v[36:39], v[112:115]
    ds_read_b64_tr_b16 v[244:245], v68 offset:45760
    v_mfma_f32_16x16x32_bf16 v[116:119], v[248:251], v[176:179], v[116:119]
    ds_read_b64_tr_b16 v[246:247], v68 offset:46272
    v_mfma_f32_16x16x32_bf16 v[120:123], v[224:227], v[36:39], v[120:123]
    ds_read_b64_tr_b16 v[248:249], v68 offset:45792
    v_mfma_f32_16x16x32_bf16 v[124:127], v[224:227], v[176:179], v[124:127]
    ds_read_b64_tr_b16 v[250:251], v68 offset:46304
    buffer_load_dwordx4 v[220:223], v2, s[32:35], s16 offen offset:2048 sc1
    s_waitcnt lgkmcnt(8)
    v_mfma_f32_16x16x32_bf16 v[80:83], v[228:231], v[36:39], v[80:83]
    ds_read_b64_tr_b16 v[224:225], v69 offset:45760
    v_mfma_f32_16x16x32_bf16 v[84:87], v[228:231], v[176:179], v[84:87]
    ds_read_b64_tr_b16 v[226:227], v69 offset:46272
    v_mfma_f32_16x16x32_bf16 v[88:91], v[232:235], v[36:39], v[88:91]
    ds_read_b64_tr_b16 v[228:229], v69 offset:45792
    v_mfma_f32_16x16x32_bf16 v[92:95], v[232:235], v[176:179], v[92:95]
    ds_read_b64_tr_b16 v[230:231], v69 offset:46304
    s_waitcnt lgkmcnt(8)
    v_mfma_f32_16x16x32_bf16 v[96:99], v[236:239], v[36:39], v[96:99]
    s_barrier
    ds_read_b64_tr_b16 v[232:233], v71 offset:8320
    v_mfma_f32_16x16x32_bf16 v[100:103], v[236:239], v[176:179], v[100:103]
    ds_read_b64_tr_b16 v[234:235], v71 offset:8832
    v_mfma_f32_16x16x32_bf16 v[104:107], v[240:243], v[36:39], v[104:107]
    ds_read_b64_tr_b16 v[236:237], v71 offset:8352
    v_mfma_f32_16x16x32_bf16 v[108:111], v[240:243], v[176:179], v[108:111]
    ds_read_b64_tr_b16 v[238:239], v71 offset:8864
    s_waitcnt lgkmcnt(8)
    v_mfma_f32_16x16x32_bf16 v[144:147], v[244:247], v[36:39], v[144:147]
    ds_read_b64_tr_b16 v[240:241], v70 offset:8320
    v_mfma_f32_16x16x32_bf16 v[148:151], v[244:247], v[176:179], v[148:151]
    ds_read_b64_tr_b16 v[242:243], v70 offset:8832
    v_mfma_f32_16x16x32_bf16 v[152:155], v[248:251], v[36:39], v[152:155]
    ds_read_b64_tr_b16 v[244:245], v70 offset:8352
    v_mfma_f32_16x16x32_bf16 v[156:159], v[248:251], v[176:179], v[156:159]
    ds_read_b64_tr_b16 v[246:247], v70 offset:8864
    s_waitcnt lgkmcnt(8)
    v_mfma_f32_16x16x32_bf16 v[160:163], v[224:227], v[36:39], v[160:163]
    ds_read_b64_tr_b16 v[248:249], v70
    v_mfma_f32_16x16x32_bf16 v[164:167], v[224:227], v[176:179], v[164:167]
    ds_read_b64_tr_b16 v[250:251], v70 offset:512
    v_mfma_f32_16x16x32_bf16 v[168:171], v[228:231], v[36:39], v[168:171]
    ds_read_b64_tr_b16 v[224:225], v70 offset:32
    v_mfma_f32_16x16x32_bf16 v[172:175], v[228:231], v[176:179], v[172:175]
    ds_read_b64_tr_b16 v[226:227], v70 offset:544
    s_waitcnt lgkmcnt(8)
    s_waitcnt vmcnt(9)
    v_mfma_f32_16x16x32_bf16 v[128:131], v[232:235], v[180:183], v[128:131]
    ds_read_b64_tr_b16 v[228:229], v71
    v_mfma_f32_16x16x32_bf16 v[132:135], v[232:235], v[184:187], v[132:135]
    ds_read_b64_tr_b16 v[230:231], v71 offset:512
    buffer_load_dwordx4 v[36:39], v2, s[32:35], s16 offen offset:3072 sc1
    v_mfma_f32_16x16x32_bf16 v[136:139], v[236:239], v[180:183], v[136:139]
    ds_read_b64_tr_b16 v[232:233], v71 offset:32
    v_mfma_f32_16x16x32_bf16 v[140:143], v[236:239], v[184:187], v[140:143]
    ds_read_b64_tr_b16 v[234:235], v71 offset:544
    s_waitcnt lgkmcnt(8)
    v_mfma_f32_16x16x32_bf16 v[112:115], v[240:243], v[180:183], v[112:115]
    ds_read_b64_tr_b16 v[236:237], v70 offset:16640
    v_mfma_f32_16x16x32_bf16 v[116:119], v[240:243], v[184:187], v[116:119]
    ds_read_b64_tr_b16 v[238:239], v70 offset:17152
    v_mfma_f32_16x16x32_bf16 v[120:123], v[244:247], v[180:183], v[120:123]
    ds_read_b64_tr_b16 v[240:241], v70 offset:16672
    v_mfma_f32_16x16x32_bf16 v[124:127], v[244:247], v[184:187], v[124:127]
    ds_read_b64_tr_b16 v[242:243], v70 offset:17184
    s_add_u32 s96, s85, 13
    s_and_b32 s97, s96, 15
    s_lshl_b32 s98, s97, 14
    s_add_u32 s16, s98, s15
    buffer_load_dwordx4 v[176:179], v2, s[32:35], s16 offen sc1
    s_waitcnt lgkmcnt(8)
    v_mfma_f32_16x16x32_bf16 v[80:83], v[248:251], v[180:183], v[80:83]
    ds_read_b64_tr_b16 v[244:245], v71 offset:16640
    v_mfma_f32_16x16x32_bf16 v[84:87], v[248:251], v[184:187], v[84:87]
    ds_read_b64_tr_b16 v[246:247], v71 offset:17152
    v_mfma_f32_16x16x32_bf16 v[88:91], v[224:227], v[180:183], v[88:91]
    ds_read_b64_tr_b16 v[248:249], v71 offset:16672
    v_mfma_f32_16x16x32_bf16 v[92:95], v[224:227], v[184:187], v[92:95]
    ds_read_b64_tr_b16 v[250:251], v71 offset:17184
    s_waitcnt lgkmcnt(8)
    v_mfma_f32_16x16x32_bf16 v[96:99], v[228:231], v[180:183], v[96:99]
    ds_read_b64_tr_b16 v[224:225], v71 offset:12480
    v_mfma_f32_16x16x32_bf16 v[100:103], v[228:231], v[184:187], v[100:103]
    ds_read_b64_tr_b16 v[226:227], v71 offset:12992
    v_mfma_f32_16x16x32_bf16 v[104:107], v[232:235], v[180:183], v[104:107]
    ds_read_b64_tr_b16 v[228:229], v71 offset:12512
    v_mfma_f32_16x16x32_bf16 v[108:111], v[232:235], v[184:187], v[108:111]
    ds_read_b64_tr_b16 v[230:231], v71 offset:13024
    s_waitcnt lgkmcnt(8)
    v_mfma_f32_16x16x32_bf16 v[144:147], v[236:239], v[180:183], v[144:147]
    ds_read_b64_tr_b16 v[232:233], v70 offset:12480
    v_mfma_f32_16x16x32_bf16 v[148:151], v[236:239], v[184:187], v[148:151]
    ds_read_b64_tr_b16 v[234:235], v70 offset:12992
    v_mfma_f32_16x16x32_bf16 v[152:155], v[240:243], v[180:183], v[152:155]
    ds_read_b64_tr_b16 v[236:237], v70 offset:12512
    v_mfma_f32_16x16x32_bf16 v[156:159], v[240:243], v[184:187], v[156:159]
    ds_read_b64_tr_b16 v[238:239], v70 offset:13024
    s_waitcnt lgkmcnt(8)
    v_mfma_f32_16x16x32_bf16 v[160:163], v[244:247], v[180:183], v[160:163]
    ds_read_b64_tr_b16 v[240:241], v70 offset:4160
    v_mfma_f32_16x16x32_bf16 v[164:167], v[244:247], v[184:187], v[164:167]
    ds_read_b64_tr_b16 v[242:243], v70 offset:4672
    v_mfma_f32_16x16x32_bf16 v[168:171], v[248:251], v[180:183], v[168:171]
    ds_read_b64_tr_b16 v[244:245], v70 offset:4192
    v_mfma_f32_16x16x32_bf16 v[172:175], v[248:251], v[184:187], v[172:175]
    ds_read_b64_tr_b16 v[246:247], v70 offset:4704
    s_waitcnt lgkmcnt(8)
    s_waitcnt vmcnt(9)
    v_mfma_f32_16x16x32_bf16 v[128:131], v[224:227], v[188:191], v[128:131]
    ds_read_b64_tr_b16 v[248:249], v71 offset:4160
    v_mfma_f32_16x16x32_bf16 v[132:135], v[224:227], v[192:195], v[132:135]
    ds_read_b64_tr_b16 v[250:251], v71 offset:4672
    buffer_load_dwordx4 v[180:183], v2, s[32:35], s16 offen offset:1024 sc1
    v_mfma_f32_16x16x32_bf16 v[136:139], v[228:231], v[188:191], v[136:139]
    ds_read_b64_tr_b16 v[224:225], v71 offset:4192
    v_mfma_f32_16x16x32_bf16 v[140:143], v[228:231], v[192:195], v[140:143]
    ds_read_b64_tr_b16 v[226:227], v71 offset:4704
    s_waitcnt lgkmcnt(8)
    v_mfma_f32_16x16x32_bf16 v[112:115], v[232:235], v[188:191], v[112:115]
    ds_read_b64_tr_b16 v[228:229], v70 offset:20800
    v_mfma_f32_16x16x32_bf16 v[116:119], v[232:235], v[192:195], v[116:119]
    ds_read_b64_tr_b16 v[230:231], v70 offset:21312
    v_mfma_f32_16x16x32_bf16 v[120:123], v[236:239], v[188:191], v[120:123]
    ds_read_b64_tr_b16 v[232:233], v70 offset:20832
    v_mfma_f32_16x16x32_bf16 v[124:127], v[236:239], v[192:195], v[124:127]
    ds_read_b64_tr_b16 v[234:235], v70 offset:21344
    buffer_load_dwordx4 v[184:187], v2, s[32:35], s16 offen offset:2048 sc1
    s_waitcnt lgkmcnt(8)
    v_mfma_f32_16x16x32_bf16 v[80:83], v[240:243], v[188:191], v[80:83]
    ds_read_b64_tr_b16 v[236:237], v71 offset:20800
    v_mfma_f32_16x16x32_bf16 v[84:87], v[240:243], v[192:195], v[84:87]
    ds_read_b64_tr_b16 v[238:239], v71 offset:21312
    v_mfma_f32_16x16x32_bf16 v[88:91], v[244:247], v[188:191], v[88:91]
    ds_read_b64_tr_b16 v[240:241], v71 offset:20832
    v_mfma_f32_16x16x32_bf16 v[92:95], v[244:247], v[192:195], v[92:95]
    ds_read_b64_tr_b16 v[242:243], v71 offset:21344
    s_waitcnt lgkmcnt(8)
    v_mfma_f32_16x16x32_bf16 v[96:99], v[248:251], v[188:191], v[96:99]
    s_barrier
    ds_read_b64_tr_b16 v[244:245], v71 offset:33280
    v_mfma_f32_16x16x32_bf16 v[100:103], v[248:251], v[192:195], v[100:103]
    ds_read_b64_tr_b16 v[246:247], v71 offset:33792
    v_mfma_f32_16x16x32_bf16 v[104:107], v[224:227], v[188:191], v[104:107]
    ds_read_b64_tr_b16 v[248:249], v71 offset:33312
    v_mfma_f32_16x16x32_bf16 v[108:111], v[224:227], v[192:195], v[108:111]
    ds_read_b64_tr_b16 v[250:251], v71 offset:33824
    s_waitcnt lgkmcnt(8)
    v_mfma_f32_16x16x32_bf16 v[144:147], v[228:231], v[188:191], v[144:147]
    ds_read_b64_tr_b16 v[224:225], v70 offset:33280
    v_mfma_f32_16x16x32_bf16 v[148:151], v[228:231], v[192:195], v[148:151]
    ds_read_b64_tr_b16 v[226:227], v70 offset:33792
    v_mfma_f32_16x16x32_bf16 v[152:155], v[232:235], v[188:191], v[152:155]
    ds_read_b64_tr_b16 v[228:229], v70 offset:33312
    v_mfma_f32_16x16x32_bf16 v[156:159], v[232:235], v[192:195], v[156:159]
    ds_read_b64_tr_b16 v[230:231], v70 offset:33824
    s_waitcnt lgkmcnt(8)
    v_mfma_f32_16x16x32_bf16 v[160:163], v[236:239], v[188:191], v[160:163]
    ds_read_b64_tr_b16 v[232:233], v70 offset:24960
    v_mfma_f32_16x16x32_bf16 v[164:167], v[236:239], v[192:195], v[164:167]
    ds_read_b64_tr_b16 v[234:235], v70 offset:25472
    v_mfma_f32_16x16x32_bf16 v[168:171], v[240:243], v[188:191], v[168:171]
    ds_read_b64_tr_b16 v[236:237], v70 offset:24992
    v_mfma_f32_16x16x32_bf16 v[172:175], v[240:243], v[192:195], v[172:175]
    ds_read_b64_tr_b16 v[238:239], v70 offset:25504
    s_waitcnt lgkmcnt(8)
    s_waitcnt vmcnt(9)
    v_mfma_f32_16x16x32_bf16 v[128:131], v[244:247], v[196:199], v[128:131]
    ds_read_b64_tr_b16 v[240:241], v71 offset:24960
    v_mfma_f32_16x16x32_bf16 v[132:135], v[244:247], v[200:203], v[132:135]
    ds_read_b64_tr_b16 v[242:243], v71 offset:25472
    buffer_load_dwordx4 v[188:191], v2, s[32:35], s16 offen offset:3072 sc1
    v_mfma_f32_16x16x32_bf16 v[136:139], v[248:251], v[196:199], v[136:139]
    ds_read_b64_tr_b16 v[244:245], v71 offset:24992
    v_mfma_f32_16x16x32_bf16 v[140:143], v[248:251], v[200:203], v[140:143]
    ds_read_b64_tr_b16 v[246:247], v71 offset:25504
    s_waitcnt lgkmcnt(8)
    v_mfma_f32_16x16x32_bf16 v[112:115], v[224:227], v[196:199], v[112:115]
    ds_read_b64_tr_b16 v[248:249], v70 offset:41600
    v_mfma_f32_16x16x32_bf16 v[116:119], v[224:227], v[200:203], v[116:119]
    ds_read_b64_tr_b16 v[250:251], v70 offset:42112
    v_mfma_f32_16x16x32_bf16 v[120:123], v[228:231], v[196:199], v[120:123]
    ds_read_b64_tr_b16 v[224:225], v70 offset:41632
    v_mfma_f32_16x16x32_bf16 v[124:127], v[228:231], v[200:203], v[124:127]
    ds_read_b64_tr_b16 v[226:227], v70 offset:42144
    s_add_u32 s96, s85, 14
    s_and_b32 s97, s96, 15
    s_lshl_b32 s98, s97, 14
    s_add_u32 s16, s98, s15
    buffer_load_dwordx4 v[192:195], v2, s[32:35], s16 offen sc1
    s_waitcnt lgkmcnt(8)
    v_mfma_f32_16x16x32_bf16 v[80:83], v[232:235], v[196:199], v[80:83]
    ds_read_b64_tr_b16 v[228:229], v71 offset:41600
    v_mfma_f32_16x16x32_bf16 v[84:87], v[232:235], v[200:203], v[84:87]
    ds_read_b64_tr_b16 v[230:231], v71 offset:42112
    v_mfma_f32_16x16x32_bf16 v[88:91], v[236:239], v[196:199], v[88:91]
    ds_read_b64_tr_b16 v[232:233], v71 offset:41632
    v_mfma_f32_16x16x32_bf16 v[92:95], v[236:239], v[200:203], v[92:95]
    ds_read_b64_tr_b16 v[234:235], v71 offset:42144
    s_waitcnt lgkmcnt(8)
    v_mfma_f32_16x16x32_bf16 v[96:99], v[240:243], v[196:199], v[96:99]
    ds_read_b64_tr_b16 v[236:237], v71 offset:37440
    v_mfma_f32_16x16x32_bf16 v[100:103], v[240:243], v[200:203], v[100:103]
    ds_read_b64_tr_b16 v[238:239], v71 offset:37952
    v_mfma_f32_16x16x32_bf16 v[104:107], v[244:247], v[196:199], v[104:107]
    ds_read_b64_tr_b16 v[240:241], v71 offset:37472
    v_mfma_f32_16x16x32_bf16 v[108:111], v[244:247], v[200:203], v[108:111]
    ds_read_b64_tr_b16 v[242:243], v71 offset:37984
    s_waitcnt lgkmcnt(8)
    v_mfma_f32_16x16x32_bf16 v[144:147], v[248:251], v[196:199], v[144:147]
    ds_read_b64_tr_b16 v[244:245], v70 offset:37440
    v_mfma_f32_16x16x32_bf16 v[148:151], v[248:251], v[200:203], v[148:151]
    ds_read_b64_tr_b16 v[246:247], v70 offset:37952
    v_mfma_f32_16x16x32_bf16 v[152:155], v[224:227], v[196:199], v[152:155]
    ds_read_b64_tr_b16 v[248:249], v70 offset:37472
    v_mfma_f32_16x16x32_bf16 v[156:159], v[224:227], v[200:203], v[156:159]
    ds_read_b64_tr_b16 v[250:251], v70 offset:37984
    s_waitcnt lgkmcnt(8)
    v_mfma_f32_16x16x32_bf16 v[160:163], v[228:231], v[196:199], v[160:163]
    ds_read_b64_tr_b16 v[224:225], v70 offset:29120
    v_mfma_f32_16x16x32_bf16 v[164:167], v[228:231], v[200:203], v[164:167]
    ds_read_b64_tr_b16 v[226:227], v70 offset:29632
    v_mfma_f32_16x16x32_bf16 v[168:171], v[232:235], v[196:199], v[168:171]
    ds_read_b64_tr_b16 v[228:229], v70 offset:29152
    v_mfma_f32_16x16x32_bf16 v[172:175], v[232:235], v[200:203], v[172:175]
    ds_read_b64_tr_b16 v[230:231], v70 offset:29664
    s_waitcnt lgkmcnt(8)
    s_waitcnt vmcnt(9)
    v_mfma_f32_16x16x32_bf16 v[128:131], v[236:239], v[204:207], v[128:131]
    ds_read_b64_tr_b16 v[232:233], v71 offset:29120
    v_mfma_f32_16x16x32_bf16 v[132:135], v[236:239], v[208:211], v[132:135]
    ds_read_b64_tr_b16 v[234:235], v71 offset:29632
    buffer_load_dwordx4 v[196:199], v2, s[32:35], s16 offen offset:1024 sc1
    v_mfma_f32_16x16x32_bf16 v[136:139], v[240:243], v[204:207], v[136:139]
    ds_read_b64_tr_b16 v[236:237], v71 offset:29152
    v_mfma_f32_16x16x32_bf16 v[140:143], v[240:243], v[208:211], v[140:143]
    ds_read_b64_tr_b16 v[238:239], v71 offset:29664
    s_waitcnt lgkmcnt(8)
    v_mfma_f32_16x16x32_bf16 v[112:115], v[244:247], v[204:207], v[112:115]
    ds_read_b64_tr_b16 v[240:241], v70 offset:45760
    v_mfma_f32_16x16x32_bf16 v[116:119], v[244:247], v[208:211], v[116:119]
    ds_read_b64_tr_b16 v[242:243], v70 offset:46272
    v_mfma_f32_16x16x32_bf16 v[120:123], v[248:251], v[204:207], v[120:123]
    ds_read_b64_tr_b16 v[244:245], v70 offset:45792
    v_mfma_f32_16x16x32_bf16 v[124:127], v[248:251], v[208:211], v[124:127]
    ds_read_b64_tr_b16 v[246:247], v70 offset:46304
    buffer_load_dwordx4 v[200:203], v2, s[32:35], s16 offen offset:2048 sc1
    s_waitcnt lgkmcnt(8)
    v_mfma_f32_16x16x32_bf16 v[80:83], v[224:227], v[204:207], v[80:83]
    ds_read_b64_tr_b16 v[248:249], v71 offset:45760
    v_mfma_f32_16x16x32_bf16 v[84:87], v[224:227], v[208:211], v[84:87]
    ds_read_b64_tr_b16 v[250:251], v71 offset:46272
    v_mfma_f32_16x16x32_bf16 v[88:91], v[228:231], v[204:207], v[88:91]
    ds_read_b64_tr_b16 v[224:225], v71 offset:45792
    v_mfma_f32_16x16x32_bf16 v[92:95], v[228:231], v[208:211], v[92:95]
    ds_read_b64_tr_b16 v[226:227], v71 offset:46304
    s_waitcnt lgkmcnt(8)
    v_mfma_f32_16x16x32_bf16 v[96:99], v[232:235], v[204:207], v[96:99]
    s_barrier
    ds_read_b64_tr_b16 v[228:229], v67 offset:8320
    v_mfma_f32_16x16x32_bf16 v[100:103], v[232:235], v[208:211], v[100:103]
    ds_read_b64_tr_b16 v[230:231], v67 offset:8832
    v_mfma_f32_16x16x32_bf16 v[104:107], v[236:239], v[204:207], v[104:107]
    ds_read_b64_tr_b16 v[232:233], v67 offset:8352
    v_mfma_f32_16x16x32_bf16 v[108:111], v[236:239], v[208:211], v[108:111]
    ds_read_b64_tr_b16 v[234:235], v67 offset:8864
    s_waitcnt lgkmcnt(8)
    v_mfma_f32_16x16x32_bf16 v[144:147], v[240:243], v[204:207], v[144:147]
    ds_read_b64_tr_b16 v[236:237], v66 offset:8320
    v_mfma_f32_16x16x32_bf16 v[148:151], v[240:243], v[208:211], v[148:151]
    ds_read_b64_tr_b16 v[238:239], v66 offset:8832
    v_mfma_f32_16x16x32_bf16 v[152:155], v[244:247], v[204:207], v[152:155]
    ds_read_b64_tr_b16 v[240:241], v66 offset:8352
    v_mfma_f32_16x16x32_bf16 v[156:159], v[244:247], v[208:211], v[156:159]
    ds_read_b64_tr_b16 v[242:243], v66 offset:8864
    s_waitcnt lgkmcnt(8)
    v_mfma_f32_16x16x32_bf16 v[160:163], v[248:251], v[204:207], v[160:163]
    ds_read_b64_tr_b16 v[244:245], v66
    v_mfma_f32_16x16x32_bf16 v[164:167], v[248:251], v[208:211], v[164:167]
    ds_read_b64_tr_b16 v[246:247], v66 offset:512
    v_mfma_f32_16x16x32_bf16 v[168:171], v[224:227], v[204:207], v[168:171]
    ds_read_b64_tr_b16 v[248:249], v66 offset:32
    v_mfma_f32_16x16x32_bf16 v[172:175], v[224:227], v[208:211], v[172:175]
    ds_read_b64_tr_b16 v[250:251], v66 offset:544
    s_waitcnt lgkmcnt(8)
    s_waitcnt vmcnt(9)
    v_mfma_f32_16x16x32_bf16 v[128:131], v[228:231], v[212:215], v[128:131]
    ds_read_b64_tr_b16 v[224:225], v67
    v_mfma_f32_16x16x32_bf16 v[132:135], v[228:231], v[216:219], v[132:135]
    ds_read_b64_tr_b16 v[226:227], v67 offset:512
    buffer_load_dwordx4 v[204:207], v2, s[32:35], s16 offen offset:3072 sc1
    v_mfma_f32_16x16x32_bf16 v[136:139], v[232:235], v[212:215], v[136:139]
    ds_read_b64_tr_b16 v[228:229], v67 offset:32
    v_mfma_f32_16x16x32_bf16 v[140:143], v[232:235], v[216:219], v[140:143]
    ds_read_b64_tr_b16 v[230:231], v67 offset:544
    s_waitcnt lgkmcnt(8)
    v_mfma_f32_16x16x32_bf16 v[112:115], v[236:239], v[212:215], v[112:115]
    ds_read_b64_tr_b16 v[232:233], v66 offset:16640
    v_mfma_f32_16x16x32_bf16 v[116:119], v[236:239], v[216:219], v[116:119]
    ds_read_b64_tr_b16 v[234:235], v66 offset:17152
    v_mfma_f32_16x16x32_bf16 v[120:123], v[240:243], v[212:215], v[120:123]
    ds_read_b64_tr_b16 v[236:237], v66 offset:16672
    v_mfma_f32_16x16x32_bf16 v[124:127], v[240:243], v[216:219], v[124:127]
    ds_read_b64_tr_b16 v[238:239], v66 offset:17184
    s_add_u32 s96, s85, 15
    s_and_b32 s97, s96, 15
    s_lshl_b32 s98, s97, 14
    s_add_u32 s16, s98, s15
    buffer_load_dwordx4 v[208:211], v2, s[32:35], s16 offen sc1
    s_waitcnt lgkmcnt(8)
    v_mfma_f32_16x16x32_bf16 v[80:83], v[244:247], v[212:215], v[80:83]
    ds_read_b64_tr_b16 v[240:241], v67 offset:16640
    v_mfma_f32_16x16x32_bf16 v[84:87], v[244:247], v[216:219], v[84:87]
    ds_read_b64_tr_b16 v[242:243], v67 offset:17152
    v_mfma_f32_16x16x32_bf16 v[88:91], v[248:251], v[212:215], v[88:91]
    ds_read_b64_tr_b16 v[244:245], v67 offset:16672
    v_mfma_f32_16x16x32_bf16 v[92:95], v[248:251], v[216:219], v[92:95]
    ds_read_b64_tr_b16 v[246:247], v67 offset:17184
    s_waitcnt lgkmcnt(8)
    v_mfma_f32_16x16x32_bf16 v[96:99], v[224:227], v[212:215], v[96:99]
    ds_read_b64_tr_b16 v[248:249], v67 offset:12480
    v_mfma_f32_16x16x32_bf16 v[100:103], v[224:227], v[216:219], v[100:103]
    ds_read_b64_tr_b16 v[250:251], v67 offset:12992
    v_mfma_f32_16x16x32_bf16 v[104:107], v[228:231], v[212:215], v[104:107]
    ds_read_b64_tr_b16 v[224:225], v67 offset:12512
    v_mfma_f32_16x16x32_bf16 v[108:111], v[228:231], v[216:219], v[108:111]
    ds_read_b64_tr_b16 v[226:227], v67 offset:13024
    s_waitcnt lgkmcnt(8)
    v_mfma_f32_16x16x32_bf16 v[144:147], v[232:235], v[212:215], v[144:147]
    ds_read_b64_tr_b16 v[228:229], v66 offset:12480
    v_mfma_f32_16x16x32_bf16 v[148:151], v[232:235], v[216:219], v[148:151]
    ds_read_b64_tr_b16 v[230:231], v66 offset:12992
    v_mfma_f32_16x16x32_bf16 v[152:155], v[236:239], v[212:215], v[152:155]
    ds_read_b64_tr_b16 v[232:233], v66 offset:12512
    v_mfma_f32_16x16x32_bf16 v[156:159], v[236:239], v[216:219], v[156:159]
    ds_read_b64_tr_b16 v[234:235], v66 offset:13024
    s_waitcnt lgkmcnt(8)
    v_mfma_f32_16x16x32_bf16 v[160:163], v[240:243], v[212:215], v[160:163]
    ds_read_b64_tr_b16 v[236:237], v66 offset:4160
    v_mfma_f32_16x16x32_bf16 v[164:167], v[240:243], v[216:219], v[164:167]
    ds_read_b64_tr_b16 v[238:239], v66 offset:4672
    v_mfma_f32_16x16x32_bf16 v[168:171], v[244:247], v[212:215], v[168:171]
    ds_read_b64_tr_b16 v[240:241], v66 offset:4192
    v_mfma_f32_16x16x32_bf16 v[172:175], v[244:247], v[216:219], v[172:175]
    ds_read_b64_tr_b16 v[242:243], v66 offset:4704
    s_waitcnt lgkmcnt(8)
    s_waitcnt vmcnt(9)
    v_mfma_f32_16x16x32_bf16 v[128:131], v[248:251], v[220:223], v[128:131]
    ds_read_b64_tr_b16 v[244:245], v67 offset:4160
    v_mfma_f32_16x16x32_bf16 v[132:135], v[248:251], v[36:39], v[132:135]
    ds_read_b64_tr_b16 v[246:247], v67 offset:4672
    buffer_load_dwordx4 v[212:215], v2, s[32:35], s16 offen offset:1024 sc1
    v_mfma_f32_16x16x32_bf16 v[136:139], v[224:227], v[220:223], v[136:139]
    ds_read_b64_tr_b16 v[248:249], v67 offset:4192
    v_mfma_f32_16x16x32_bf16 v[140:143], v[224:227], v[36:39], v[140:143]
    ds_read_b64_tr_b16 v[250:251], v67 offset:4704
    s_waitcnt lgkmcnt(8)
    v_mfma_f32_16x16x32_bf16 v[112:115], v[228:231], v[220:223], v[112:115]
    ds_read_b64_tr_b16 v[224:225], v66 offset:20800
    v_mfma_f32_16x16x32_bf16 v[116:119], v[228:231], v[36:39], v[116:119]
    ds_read_b64_tr_b16 v[226:227], v66 offset:21312
    v_mfma_f32_16x16x32_bf16 v[120:123], v[232:235], v[220:223], v[120:123]
    ds_read_b64_tr_b16 v[228:229], v66 offset:20832
    v_mfma_f32_16x16x32_bf16 v[124:127], v[232:235], v[36:39], v[124:127]
    ds_read_b64_tr_b16 v[230:231], v66 offset:21344
    buffer_load_dwordx4 v[216:219], v2, s[32:35], s16 offen offset:2048 sc1
    s_waitcnt lgkmcnt(8)
    v_mfma_f32_16x16x32_bf16 v[80:83], v[236:239], v[220:223], v[80:83]
    ds_read_b64_tr_b16 v[232:233], v67 offset:20800
    v_mfma_f32_16x16x32_bf16 v[84:87], v[236:239], v[36:39], v[84:87]
    ds_read_b64_tr_b16 v[234:235], v67 offset:21312
    v_mfma_f32_16x16x32_bf16 v[88:91], v[240:243], v[220:223], v[88:91]
    ds_read_b64_tr_b16 v[236:237], v67 offset:20832
    v_mfma_f32_16x16x32_bf16 v[92:95], v[240:243], v[36:39], v[92:95]
    ds_read_b64_tr_b16 v[238:239], v67 offset:21344
    s_waitcnt lgkmcnt(8)
    v_mfma_f32_16x16x32_bf16 v[96:99], v[244:247], v[220:223], v[96:99]
    s_barrier
    ds_read_b64_tr_b16 v[240:241], v67 offset:33280
    v_mfma_f32_16x16x32_bf16 v[100:103], v[244:247], v[36:39], v[100:103]
    ds_read_b64_tr_b16 v[242:243], v67 offset:33792
    v_mfma_f32_16x16x32_bf16 v[104:107], v[248:251], v[220:223], v[104:107]
    ds_read_b64_tr_b16 v[244:245], v67 offset:33312
    v_mfma_f32_16x16x32_bf16 v[108:111], v[248:251], v[36:39], v[108:111]
    ds_read_b64_tr_b16 v[246:247], v67 offset:33824
    s_waitcnt lgkmcnt(8)
    v_mfma_f32_16x16x32_bf16 v[144:147], v[224:227], v[220:223], v[144:147]
    ds_read_b64_tr_b16 v[248:249], v66 offset:33280
    v_mfma_f32_16x16x32_bf16 v[148:151], v[224:227], v[36:39], v[148:151]
    ds_read_b64_tr_b16 v[250:251], v66 offset:33792
    v_mfma_f32_16x16x32_bf16 v[152:155], v[228:231], v[220:223], v[152:155]
    ds_read_b64_tr_b16 v[224:225], v66 offset:33312
    v_mfma_f32_16x16x32_bf16 v[156:159], v[228:231], v[36:39], v[156:159]
    ds_read_b64_tr_b16 v[226:227], v66 offset:33824
    s_waitcnt lgkmcnt(8)
    v_mfma_f32_16x16x32_bf16 v[160:163], v[232:235], v[220:223], v[160:163]
    ds_read_b64_tr_b16 v[228:229], v66 offset:24960
    v_mfma_f32_16x16x32_bf16 v[164:167], v[232:235], v[36:39], v[164:167]
    ds_read_b64_tr_b16 v[230:231], v66 offset:25472
    v_mfma_f32_16x16x32_bf16 v[168:171], v[236:239], v[220:223], v[168:171]
    ds_read_b64_tr_b16 v[232:233], v66 offset:24992
    v_mfma_f32_16x16x32_bf16 v[172:175], v[236:239], v[36:39], v[172:175]
    ds_read_b64_tr_b16 v[234:235], v66 offset:25504
    s_waitcnt lgkmcnt(8)
    s_waitcnt vmcnt(9)
    v_mfma_f32_16x16x32_bf16 v[128:131], v[240:243], v[176:179], v[128:131]
    ds_read_b64_tr_b16 v[236:237], v67 offset:24960
    v_mfma_f32_16x16x32_bf16 v[132:135], v[240:243], v[180:183], v[132:135]
    ds_read_b64_tr_b16 v[238:239], v67 offset:25472
    buffer_load_dwordx4 v[220:223], v2, s[32:35], s16 offen offset:3072 sc1
    s_barrier
    v_mfma_f32_16x16x32_bf16 v[136:139], v[244:247], v[176:179], v[136:139]
    ds_read_b64_tr_b16 v[240:241], v67 offset:24992
    v_mfma_f32_16x16x32_bf16 v[140:143], v[244:247], v[180:183], v[140:143]
    ds_read_b64_tr_b16 v[242:243], v67 offset:25504
    s_waitcnt lgkmcnt(8)
    v_mfma_f32_16x16x32_bf16 v[112:115], v[248:251], v[176:179], v[112:115]
    ds_read_b64_tr_b16 v[244:245], v66 offset:41600
    v_mfma_f32_16x16x32_bf16 v[116:119], v[248:251], v[180:183], v[116:119]
    ds_read_b64_tr_b16 v[246:247], v66 offset:42112
    v_mfma_f32_16x16x32_bf16 v[120:123], v[224:227], v[176:179], v[120:123]
    ds_read_b64_tr_b16 v[248:249], v66 offset:41632
    v_mfma_f32_16x16x32_bf16 v[124:127], v[224:227], v[180:183], v[124:127]
    ds_read_b64_tr_b16 v[250:251], v66 offset:42144
    s_waitcnt lgkmcnt(8)
    v_mfma_f32_16x16x32_bf16 v[80:83], v[228:231], v[176:179], v[80:83]
    ds_read_b64_tr_b16 v[224:225], v67 offset:41600
    v_mfma_f32_16x16x32_bf16 v[84:87], v[228:231], v[180:183], v[84:87]
    ds_read_b64_tr_b16 v[226:227], v67 offset:42112
    v_mfma_f32_16x16x32_bf16 v[88:91], v[232:235], v[176:179], v[88:91]
    ds_read_b64_tr_b16 v[228:229], v67 offset:41632
    v_mfma_f32_16x16x32_bf16 v[92:95], v[232:235], v[180:183], v[92:95]
    ds_read_b64_tr_b16 v[230:231], v67 offset:42144
    s_waitcnt lgkmcnt(8)
    v_mfma_f32_16x16x32_bf16 v[96:99], v[236:239], v[176:179], v[96:99]
    ds_read_b64_tr_b16 v[232:233], v67 offset:37440
    v_mfma_f32_16x16x32_bf16 v[100:103], v[236:239], v[180:183], v[100:103]
    ds_read_b64_tr_b16 v[234:235], v67 offset:37952
    v_mfma_f32_16x16x32_bf16 v[104:107], v[240:243], v[176:179], v[104:107]
    ds_read_b64_tr_b16 v[236:237], v67 offset:37472
    v_mfma_f32_16x16x32_bf16 v[108:111], v[240:243], v[180:183], v[108:111]
    ds_read_b64_tr_b16 v[238:239], v67 offset:37984
    s_waitcnt lgkmcnt(8)
    v_mfma_f32_16x16x32_bf16 v[144:147], v[244:247], v[176:179], v[144:147]
    ds_read_b64_tr_b16 v[240:241], v66 offset:37440
    v_mfma_f32_16x16x32_bf16 v[148:151], v[244:247], v[180:183], v[148:151]
    ds_read_b64_tr_b16 v[242:243], v66 offset:37952
    v_mfma_f32_16x16x32_bf16 v[152:155], v[248:251], v[176:179], v[152:155]
    ds_read_b64_tr_b16 v[244:245], v66 offset:37472
    v_mfma_f32_16x16x32_bf16 v[156:159], v[248:251], v[180:183], v[156:159]
    ds_read_b64_tr_b16 v[246:247], v66 offset:37984
    s_waitcnt lgkmcnt(8)
    v_mfma_f32_16x16x32_bf16 v[160:163], v[224:227], v[176:179], v[160:163]
    ds_read_b64_tr_b16 v[248:249], v66 offset:29120
    v_mfma_f32_16x16x32_bf16 v[164:167], v[224:227], v[180:183], v[164:167]
    ds_read_b64_tr_b16 v[250:251], v66 offset:29632
    v_mfma_f32_16x16x32_bf16 v[168:171], v[228:231], v[176:179], v[168:171]
    ds_read_b64_tr_b16 v[224:225], v66 offset:29152
    v_mfma_f32_16x16x32_bf16 v[172:175], v[228:231], v[180:183], v[172:175]
    ds_read_b64_tr_b16 v[226:227], v66 offset:29664
    s_waitcnt lgkmcnt(8)
    s_waitcnt vmcnt(8)
    v_mfma_f32_16x16x32_bf16 v[128:131], v[232:235], v[184:187], v[128:131]
    ds_read_b64_tr_b16 v[228:229], v67 offset:29120
    v_mfma_f32_16x16x32_bf16 v[132:135], v[232:235], v[188:191], v[132:135]
    ds_read_b64_tr_b16 v[230:231], v67 offset:29632
    v_mfma_f32_16x16x32_bf16 v[136:139], v[236:239], v[184:187], v[136:139]
    ds_read_b64_tr_b16 v[232:233], v67 offset:29152
    v_mfma_f32_16x16x32_bf16 v[140:143], v[236:239], v[188:191], v[140:143]
    ds_read_b64_tr_b16 v[234:235], v67 offset:29664
    s_waitcnt lgkmcnt(8)
    v_mfma_f32_16x16x32_bf16 v[112:115], v[240:243], v[184:187], v[112:115]
    ds_read_b64_tr_b16 v[236:237], v66 offset:45760
    v_mfma_f32_16x16x32_bf16 v[116:119], v[240:243], v[188:191], v[116:119]
    ds_read_b64_tr_b16 v[238:239], v66 offset:46272
    v_mfma_f32_16x16x32_bf16 v[120:123], v[244:247], v[184:187], v[120:123]
    ds_read_b64_tr_b16 v[240:241], v66 offset:45792
    v_mfma_f32_16x16x32_bf16 v[124:127], v[244:247], v[188:191], v[124:127]
    ds_read_b64_tr_b16 v[242:243], v66 offset:46304
    s_waitcnt lgkmcnt(8)
    v_mfma_f32_16x16x32_bf16 v[80:83], v[248:251], v[184:187], v[80:83]
    ds_read_b64_tr_b16 v[244:245], v67 offset:45760
    v_mfma_f32_16x16x32_bf16 v[84:87], v[248:251], v[188:191], v[84:87]
    ds_read_b64_tr_b16 v[246:247], v67 offset:46272
    v_mfma_f32_16x16x32_bf16 v[88:91], v[224:227], v[184:187], v[88:91]
    ds_read_b64_tr_b16 v[248:249], v67 offset:45792
    v_mfma_f32_16x16x32_bf16 v[92:95], v[224:227], v[188:191], v[92:95]
    ds_read_b64_tr_b16 v[250:251], v67 offset:46304
    s_waitcnt lgkmcnt(8)
    v_mfma_f32_16x16x32_bf16 v[96:99], v[228:231], v[184:187], v[96:99]
    s_barrier
    ds_read_b64_tr_b16 v[224:225], v69 offset:8320
    v_mfma_f32_16x16x32_bf16 v[100:103], v[228:231], v[188:191], v[100:103]
    ds_read_b64_tr_b16 v[226:227], v69 offset:8832
    v_mfma_f32_16x16x32_bf16 v[104:107], v[232:235], v[184:187], v[104:107]
    ds_read_b64_tr_b16 v[228:229], v69 offset:8352
    v_mfma_f32_16x16x32_bf16 v[108:111], v[232:235], v[188:191], v[108:111]
    ds_read_b64_tr_b16 v[230:231], v69 offset:8864
    s_waitcnt lgkmcnt(8)
    v_mfma_f32_16x16x32_bf16 v[144:147], v[236:239], v[184:187], v[144:147]
    ds_read_b64_tr_b16 v[232:233], v68 offset:8320
    v_mfma_f32_16x16x32_bf16 v[148:151], v[236:239], v[188:191], v[148:151]
    ds_read_b64_tr_b16 v[234:235], v68 offset:8832
    v_mfma_f32_16x16x32_bf16 v[152:155], v[240:243], v[184:187], v[152:155]
    ds_read_b64_tr_b16 v[236:237], v68 offset:8352
    v_mfma_f32_16x16x32_bf16 v[156:159], v[240:243], v[188:191], v[156:159]
    ds_read_b64_tr_b16 v[238:239], v68 offset:8864
    s_waitcnt lgkmcnt(8)
    v_mfma_f32_16x16x32_bf16 v[160:163], v[244:247], v[184:187], v[160:163]
    ds_read_b64_tr_b16 v[240:241], v68
    v_mfma_f32_16x16x32_bf16 v[164:167], v[244:247], v[188:191], v[164:167]
    ds_read_b64_tr_b16 v[242:243], v68 offset:512
    v_mfma_f32_16x16x32_bf16 v[168:171], v[248:251], v[184:187], v[168:171]
    ds_read_b64_tr_b16 v[244:245], v68 offset:32
    v_mfma_f32_16x16x32_bf16 v[172:175], v[248:251], v[188:191], v[172:175]
    ds_read_b64_tr_b16 v[246:247], v68 offset:544
    s_waitcnt lgkmcnt(8)
    s_waitcnt vmcnt(6)
    v_mfma_f32_16x16x32_bf16 v[128:131], v[224:227], v[192:195], v[128:131]
    ds_read_b64_tr_b16 v[248:249], v69
    v_mfma_f32_16x16x32_bf16 v[132:135], v[224:227], v[196:199], v[132:135]
    ds_read_b64_tr_b16 v[250:251], v69 offset:512
    v_mfma_f32_16x16x32_bf16 v[136:139], v[228:231], v[192:195], v[136:139]
    ds_read_b64_tr_b16 v[224:225], v69 offset:32
    v_mfma_f32_16x16x32_bf16 v[140:143], v[228:231], v[196:199], v[140:143]
    ds_read_b64_tr_b16 v[226:227], v69 offset:544
    s_waitcnt lgkmcnt(8)
    v_mfma_f32_16x16x32_bf16 v[112:115], v[232:235], v[192:195], v[112:115]
    ds_read_b64_tr_b16 v[228:229], v68 offset:16640
    v_mfma_f32_16x16x32_bf16 v[116:119], v[232:235], v[196:199], v[116:119]
    ds_read_b64_tr_b16 v[230:231], v68 offset:17152
    v_mfma_f32_16x16x32_bf16 v[120:123], v[236:239], v[192:195], v[120:123]
    ds_read_b64_tr_b16 v[232:233], v68 offset:16672
    v_mfma_f32_16x16x32_bf16 v[124:127], v[236:239], v[196:199], v[124:127]
    ds_read_b64_tr_b16 v[234:235], v68 offset:17184
    s_waitcnt lgkmcnt(8)
    v_mfma_f32_16x16x32_bf16 v[80:83], v[240:243], v[192:195], v[80:83]
    ds_read_b64_tr_b16 v[236:237], v69 offset:16640
    v_mfma_f32_16x16x32_bf16 v[84:87], v[240:243], v[196:199], v[84:87]
    ds_read_b64_tr_b16 v[238:239], v69 offset:17152
    v_mfma_f32_16x16x32_bf16 v[88:91], v[244:247], v[192:195], v[88:91]
    ds_read_b64_tr_b16 v[240:241], v69 offset:16672
    v_mfma_f32_16x16x32_bf16 v[92:95], v[244:247], v[196:199], v[92:95]
    ds_read_b64_tr_b16 v[242:243], v69 offset:17184
    s_waitcnt lgkmcnt(8)
    v_mfma_f32_16x16x32_bf16 v[96:99], v[248:251], v[192:195], v[96:99]
    ds_read_b64_tr_b16 v[244:245], v69 offset:12480
    v_mfma_f32_16x16x32_bf16 v[100:103], v[248:251], v[196:199], v[100:103]
    ds_read_b64_tr_b16 v[246:247], v69 offset:12992
    v_mfma_f32_16x16x32_bf16 v[104:107], v[224:227], v[192:195], v[104:107]
    ds_read_b64_tr_b16 v[248:249], v69 offset:12512
    v_mfma_f32_16x16x32_bf16 v[108:111], v[224:227], v[196:199], v[108:111]
    ds_read_b64_tr_b16 v[250:251], v69 offset:13024
    s_waitcnt lgkmcnt(8)
    v_mfma_f32_16x16x32_bf16 v[144:147], v[228:231], v[192:195], v[144:147]
    ds_read_b64_tr_b16 v[224:225], v68 offset:12480
    v_mfma_f32_16x16x32_bf16 v[148:151], v[228:231], v[196:199], v[148:151]
    ds_read_b64_tr_b16 v[226:227], v68 offset:12992
    v_mfma_f32_16x16x32_bf16 v[152:155], v[232:235], v[192:195], v[152:155]
    ds_read_b64_tr_b16 v[228:229], v68 offset:12512
    v_mfma_f32_16x16x32_bf16 v[156:159], v[232:235], v[196:199], v[156:159]
    ds_read_b64_tr_b16 v[230:231], v68 offset:13024
    s_waitcnt lgkmcnt(8)
    v_mfma_f32_16x16x32_bf16 v[160:163], v[236:239], v[192:195], v[160:163]
    ds_read_b64_tr_b16 v[232:233], v68 offset:4160
    v_mfma_f32_16x16x32_bf16 v[164:167], v[236:239], v[196:199], v[164:167]
    ds_read_b64_tr_b16 v[234:235], v68 offset:4672
    v_mfma_f32_16x16x32_bf16 v[168:171], v[240:243], v[192:195], v[168:171]
    ds_read_b64_tr_b16 v[236:237], v68 offset:4192
    v_mfma_f32_16x16x32_bf16 v[172:175], v[240:243], v[196:199], v[172:175]
    ds_read_b64_tr_b16 v[238:239], v68 offset:4704
    s_waitcnt lgkmcnt(8)
    s_waitcnt vmcnt(4)
    v_mfma_f32_16x16x32_bf16 v[128:131], v[244:247], v[200:203], v[128:131]
    ds_read_b64_tr_b16 v[240:241], v69 offset:4160
    v_mfma_f32_16x16x32_bf16 v[132:135], v[244:247], v[204:207], v[132:135]
    ds_read_b64_tr_b16 v[242:243], v69 offset:4672
    v_mfma_f32_16x16x32_bf16 v[136:139], v[248:251], v[200:203], v[136:139]
    ds_read_b64_tr_b16 v[244:245], v69 offset:4192
    v_mfma_f32_16x16x32_bf16 v[140:143], v[248:251], v[204:207], v[140:143]
    ds_read_b64_tr_b16 v[246:247], v69 offset:4704
    s_waitcnt lgkmcnt(8)
    v_mfma_f32_16x16x32_bf16 v[112:115], v[224:227], v[200:203], v[112:115]
    ds_read_b64_tr_b16 v[248:249], v68 offset:20800
    v_mfma_f32_16x16x32_bf16 v[116:119], v[224:227], v[204:207], v[116:119]
    ds_read_b64_tr_b16 v[250:251], v68 offset:21312
    v_mfma_f32_16x16x32_bf16 v[120:123], v[228:231], v[200:203], v[120:123]
    ds_read_b64_tr_b16 v[224:225], v68 offset:20832
    v_mfma_f32_16x16x32_bf16 v[124:127], v[228:231], v[204:207], v[124:127]
    ds_read_b64_tr_b16 v[226:227], v68 offset:21344
    s_waitcnt lgkmcnt(8)
    v_mfma_f32_16x16x32_bf16 v[80:83], v[232:235], v[200:203], v[80:83]
    ds_read_b64_tr_b16 v[228:229], v69 offset:20800
    v_mfma_f32_16x16x32_bf16 v[84:87], v[232:235], v[204:207], v[84:87]
    ds_read_b64_tr_b16 v[230:231], v69 offset:21312
    v_mfma_f32_16x16x32_bf16 v[88:91], v[236:239], v[200:203], v[88:91]
    ds_read_b64_tr_b16 v[232:233], v69 offset:20832
    v_mfma_f32_16x16x32_bf16 v[92:95], v[236:239], v[204:207], v[92:95]
    ds_read_b64_tr_b16 v[234:235], v69 offset:21344
    s_waitcnt lgkmcnt(8)
    v_mfma_f32_16x16x32_bf16 v[96:99], v[240:243], v[200:203], v[96:99]
    ds_read_b64_tr_b16 v[236:237], v69 offset:33280
    v_mfma_f32_16x16x32_bf16 v[100:103], v[240:243], v[204:207], v[100:103]
    ds_read_b64_tr_b16 v[238:239], v69 offset:33792
    v_mfma_f32_16x16x32_bf16 v[104:107], v[244:247], v[200:203], v[104:107]
    ds_read_b64_tr_b16 v[240:241], v69 offset:33312
    v_mfma_f32_16x16x32_bf16 v[108:111], v[244:247], v[204:207], v[108:111]
    ds_read_b64_tr_b16 v[242:243], v69 offset:33824
    s_waitcnt lgkmcnt(8)
    v_mfma_f32_16x16x32_bf16 v[144:147], v[248:251], v[200:203], v[144:147]
    ds_read_b64_tr_b16 v[244:245], v68 offset:33280
    v_mfma_f32_16x16x32_bf16 v[148:151], v[248:251], v[204:207], v[148:151]
    ds_read_b64_tr_b16 v[246:247], v68 offset:33792
    v_mfma_f32_16x16x32_bf16 v[152:155], v[224:227], v[200:203], v[152:155]
    ds_read_b64_tr_b16 v[248:249], v68 offset:33312
    v_mfma_f32_16x16x32_bf16 v[156:159], v[224:227], v[204:207], v[156:159]
    ds_read_b64_tr_b16 v[250:251], v68 offset:33824
    s_waitcnt lgkmcnt(8)
    v_mfma_f32_16x16x32_bf16 v[160:163], v[228:231], v[200:203], v[160:163]
    ds_read_b64_tr_b16 v[224:225], v68 offset:24960
    v_mfma_f32_16x16x32_bf16 v[164:167], v[228:231], v[204:207], v[164:167]
    ds_read_b64_tr_b16 v[226:227], v68 offset:25472
    v_mfma_f32_16x16x32_bf16 v[168:171], v[232:235], v[200:203], v[168:171]
    ds_read_b64_tr_b16 v[228:229], v68 offset:24992
    v_mfma_f32_16x16x32_bf16 v[172:175], v[232:235], v[204:207], v[172:175]
    ds_read_b64_tr_b16 v[230:231], v68 offset:25504
    s_waitcnt lgkmcnt(8)
    s_waitcnt vmcnt(2)
    v_mfma_f32_16x16x32_bf16 v[128:131], v[236:239], v[208:211], v[128:131]
    ds_read_b64_tr_b16 v[232:233], v69 offset:24960
    v_mfma_f32_16x16x32_bf16 v[132:135], v[236:239], v[212:215], v[132:135]
    ds_read_b64_tr_b16 v[234:235], v69 offset:25472
    v_mfma_f32_16x16x32_bf16 v[136:139], v[240:243], v[208:211], v[136:139]
    ds_read_b64_tr_b16 v[236:237], v69 offset:24992
    v_mfma_f32_16x16x32_bf16 v[140:143], v[240:243], v[212:215], v[140:143]
    ds_read_b64_tr_b16 v[238:239], v69 offset:25504
    s_waitcnt lgkmcnt(8)
    v_mfma_f32_16x16x32_bf16 v[112:115], v[244:247], v[208:211], v[112:115]
    ds_read_b64_tr_b16 v[240:241], v68 offset:41600
    v_mfma_f32_16x16x32_bf16 v[116:119], v[244:247], v[212:215], v[116:119]
    ds_read_b64_tr_b16 v[242:243], v68 offset:42112
    v_mfma_f32_16x16x32_bf16 v[120:123], v[248:251], v[208:211], v[120:123]
    ds_read_b64_tr_b16 v[244:245], v68 offset:41632
    v_mfma_f32_16x16x32_bf16 v[124:127], v[248:251], v[212:215], v[124:127]
    ds_read_b64_tr_b16 v[246:247], v68 offset:42144
    s_waitcnt lgkmcnt(8)
    v_mfma_f32_16x16x32_bf16 v[80:83], v[224:227], v[208:211], v[80:83]
    ds_read_b64_tr_b16 v[248:249], v69 offset:41600
    v_mfma_f32_16x16x32_bf16 v[84:87], v[224:227], v[212:215], v[84:87]
    ds_read_b64_tr_b16 v[250:251], v69 offset:42112
    v_mfma_f32_16x16x32_bf16 v[88:91], v[228:231], v[208:211], v[88:91]
    ds_read_b64_tr_b16 v[224:225], v69 offset:41632
    v_mfma_f32_16x16x32_bf16 v[92:95], v[228:231], v[212:215], v[92:95]
    ds_read_b64_tr_b16 v[226:227], v69 offset:42144
    s_waitcnt lgkmcnt(8)
    v_mfma_f32_16x16x32_bf16 v[96:99], v[232:235], v[208:211], v[96:99]
    ds_read_b64_tr_b16 v[228:229], v69 offset:37440
    v_mfma_f32_16x16x32_bf16 v[100:103], v[232:235], v[212:215], v[100:103]
    ds_read_b64_tr_b16 v[230:231], v69 offset:37952
    v_mfma_f32_16x16x32_bf16 v[104:107], v[236:239], v[208:211], v[104:107]
    ds_read_b64_tr_b16 v[232:233], v69 offset:37472
    v_mfma_f32_16x16x32_bf16 v[108:111], v[236:239], v[212:215], v[108:111]
    ds_read_b64_tr_b16 v[234:235], v69 offset:37984
    s_waitcnt lgkmcnt(8)
    v_mfma_f32_16x16x32_bf16 v[144:147], v[240:243], v[208:211], v[144:147]
    ds_read_b64_tr_b16 v[236:237], v68 offset:37440
    v_mfma_f32_16x16x32_bf16 v[148:151], v[240:243], v[212:215], v[148:151]
    ds_read_b64_tr_b16 v[238:239], v68 offset:37952
    v_mfma_f32_16x16x32_bf16 v[152:155], v[244:247], v[208:211], v[152:155]
    ds_read_b64_tr_b16 v[240:241], v68 offset:37472
    v_mfma_f32_16x16x32_bf16 v[156:159], v[244:247], v[212:215], v[156:159]
    ds_read_b64_tr_b16 v[242:243], v68 offset:37984
    s_waitcnt lgkmcnt(8)
    v_mfma_f32_16x16x32_bf16 v[160:163], v[248:251], v[208:211], v[160:163]
    ds_read_b64_tr_b16 v[244:245], v68 offset:29120
    v_mfma_f32_16x16x32_bf16 v[164:167], v[248:251], v[212:215], v[164:167]
    ds_read_b64_tr_b16 v[246:247], v68 offset:29632
    v_mfma_f32_16x16x32_bf16 v[168:171], v[224:227], v[208:211], v[168:171]
    ds_read_b64_tr_b16 v[248:249], v68 offset:29152
    v_mfma_f32_16x16x32_bf16 v[172:175], v[224:227], v[212:215], v[172:175]
    ds_read_b64_tr_b16 v[250:251], v68 offset:29664
    s_waitcnt lgkmcnt(8)
    s_waitcnt vmcnt(0)
    v_mfma_f32_16x16x32_bf16 v[128:131], v[228:231], v[216:219], v[128:131]
    ds_read_b64_tr_b16 v[224:225], v69 offset:29120
    v_mfma_f32_16x16x32_bf16 v[132:135], v[228:231], v[220:223], v[132:135]
    ds_read_b64_tr_b16 v[226:227], v69 offset:29632
    v_mfma_f32_16x16x32_bf16 v[136:139], v[232:235], v[216:219], v[136:139]
    ds_read_b64_tr_b16 v[228:229], v69 offset:29152
    v_mfma_f32_16x16x32_bf16 v[140:143], v[232:235], v[220:223], v[140:143]
    ds_read_b64_tr_b16 v[230:231], v69 offset:29664
    s_waitcnt lgkmcnt(8)
    v_mfma_f32_16x16x32_bf16 v[112:115], v[236:239], v[216:219], v[112:115]
    ds_read_b64_tr_b16 v[232:233], v68 offset:45760
    v_mfma_f32_16x16x32_bf16 v[116:119], v[236:239], v[220:223], v[116:119]
    ds_read_b64_tr_b16 v[234:235], v68 offset:46272
    v_mfma_f32_16x16x32_bf16 v[120:123], v[240:243], v[216:219], v[120:123]
    ds_read_b64_tr_b16 v[236:237], v68 offset:45792
    v_mfma_f32_16x16x32_bf16 v[124:127], v[240:243], v[220:223], v[124:127]
    ds_read_b64_tr_b16 v[238:239], v68 offset:46304
    s_waitcnt lgkmcnt(8)
    v_mfma_f32_16x16x32_bf16 v[80:83], v[244:247], v[216:219], v[80:83]
    ds_read_b64_tr_b16 v[240:241], v69 offset:45760
    v_mfma_f32_16x16x32_bf16 v[84:87], v[244:247], v[220:223], v[84:87]
    ds_read_b64_tr_b16 v[242:243], v69 offset:46272
    v_mfma_f32_16x16x32_bf16 v[88:91], v[248:251], v[216:219], v[88:91]
    ds_read_b64_tr_b16 v[244:245], v69 offset:45792
    v_mfma_f32_16x16x32_bf16 v[92:95], v[248:251], v[220:223], v[92:95]
    ds_read_b64_tr_b16 v[246:247], v69 offset:46304
    s_waitcnt lgkmcnt(8)
    v_mfma_f32_16x16x32_bf16 v[96:99], v[224:227], v[216:219], v[96:99]
    v_mfma_f32_16x16x32_bf16 v[100:103], v[224:227], v[220:223], v[100:103]
    v_mfma_f32_16x16x32_bf16 v[104:107], v[228:231], v[216:219], v[104:107]
    v_mfma_f32_16x16x32_bf16 v[108:111], v[228:231], v[220:223], v[108:111]
    s_waitcnt lgkmcnt(4)
    v_mfma_f32_16x16x32_bf16 v[144:147], v[232:235], v[216:219], v[144:147]
    v_mfma_f32_16x16x32_bf16 v[148:151], v[232:235], v[220:223], v[148:151]
    v_mfma_f32_16x16x32_bf16 v[152:155], v[236:239], v[216:219], v[152:155]
    v_mfma_f32_16x16x32_bf16 v[156:159], v[236:239], v[220:223], v[156:159]
    s_waitcnt lgkmcnt(0)
    v_mfma_f32_16x16x32_bf16 v[160:163], v[240:243], v[216:219], v[160:163]
    v_mfma_f32_16x16x32_bf16 v[164:167], v[240:243], v[220:223], v[164:167]
    v_mfma_f32_16x16x32_bf16 v[168:171], v[244:247], v[216:219], v[168:171]
    v_mfma_f32_16x16x32_bf16 v[172:175], v[244:247], v[220:223], v[172:175]
    v_cvt_pk_bf16_f32 v52, v128, v129
    v_cvt_pk_bf16_f32 v53, v130, v131
    v_cvt_pk_bf16_f32 v54, v132, v133
    v_cvt_pk_bf16_f32 v55, v134, v135
    v_cvt_pk_bf16_f32 v56, v136, v137
    v_cvt_pk_bf16_f32 v57, v138, v139
    v_cvt_pk_bf16_f32 v58, v140, v141
    v_cvt_pk_bf16_f32 v59, v142, v143
    ds_write_b64 v77, v[52:53]
    ds_write_b64 v77, v[54:55] offset:256
    ds_write_b64 v77, v[56:57] offset:1024
    ds_write_b64 v77, v[58:59] offset:1280
    s_waitcnt lgkmcnt(0)
    s_barrier
    s_setprio 0
    v_cvt_pk_bf16_f32 v36, v112, v113
    v_cvt_pk_bf16_f32 v37, v114, v115
    v_cvt_pk_bf16_f32 v38, v116, v117
    v_cvt_pk_bf16_f32 v39, v118, v119
    v_cvt_pk_bf16_f32 v40, v120, v121
    v_cvt_pk_bf16_f32 v41, v122, v123
    v_cvt_pk_bf16_f32 v42, v124, v125
    v_cvt_pk_bf16_f32 v43, v126, v127
    v_permlane16_swap_b32 v36, v38
    v_permlane16_swap_b32 v37, v39
    v_permlane16_swap_b32 v40, v42
    v_permlane16_swap_b32 v41, v43
    v_mfma_f32_32x32x16_bf16 v[112:127], v[28:31], v[36:39], 0
    s_nop 0
    v_mfma_f32_32x32x16_bf16 v[112:127], v[32:35], v[40:43], v[112:127]
    v_cvt_pk_bf16_f32 v52, v144, v145
    v_cvt_pk_bf16_f32 v53, v146, v147
    v_cvt_pk_bf16_f32 v54, v148, v149
    v_cvt_pk_bf16_f32 v55, v150, v151
    v_cvt_pk_bf16_f32 v56, v152, v153
    v_cvt_pk_bf16_f32 v57, v154, v155
    v_cvt_pk_bf16_f32 v58, v156, v157
    v_cvt_pk_bf16_f32 v59, v158, v159
    ds_write_b64 v78, v[52:53]
    ds_write_b64 v78, v[54:55] offset:512
    ds_write_b64 v78, v[56:57] offset:4096
    ds_write_b64 v78, v[58:59] offset:4608
    v_cvt_pk_bf16_f32 v44, v160, v161
    v_cvt_pk_bf16_f32 v45, v162, v163
    v_cvt_pk_bf16_f32 v46, v164, v165
    v_cvt_pk_bf16_f32 v47, v166, v167
    v_cvt_pk_bf16_f32 v48, v168, v169
    v_cvt_pk_bf16_f32 v49, v170, v171
    v_cvt_pk_bf16_f32 v50, v172, v173
    v_cvt_pk_bf16_f32 v51, v174, v175
    ds_write_b64 v78, v[44:45] offset:8192
    ds_write_b64 v78, v[46:47] offset:8704
    ds_write_b64 v78, v[48:49] offset:12288
    ds_write_b64 v78, v[50:51] offset:12800
    v_cvt_pk_bf16_f32 v36, v96, v97
    v_cvt_pk_bf16_f32 v37, v98, v99
    v_cvt_pk_bf16_f32 v38, v100, v101
    v_cvt_pk_bf16_f32 v39, v102, v103
    v_cvt_pk_bf16_f32 v40, v104, v105
    v_cvt_pk_bf16_f32 v41, v106, v107
    v_cvt_pk_bf16_f32 v42, v108, v109
    v_cvt_pk_bf16_f32 v43, v110, v111
    ds_write_b64 v77, v[36:37] offset:2048
    ds_write_b64 v77, v[38:39] offset:2304
    ds_write_b64 v77, v[40:41] offset:3072
    ds_write_b64 v77, v[42:43] offset:3328
    v_cvt_pk_bf16_f32 v44, v80, v81
    v_cvt_pk_bf16_f32 v45, v82, v83
    v_cvt_pk_bf16_f32 v46, v84, v85
    v_cvt_pk_bf16_f32 v47, v86, v87
    v_cvt_pk_bf16_f32 v48, v88, v89
    v_cvt_pk_bf16_f32 v49, v90, v91
    v_cvt_pk_bf16_f32 v50, v92, v93
    v_cvt_pk_bf16_f32 v51, v94, v95
    v_permlane16_swap_b32 v44, v46
    v_permlane16_swap_b32 v45, v47
    v_permlane16_swap_b32 v48, v50
    v_permlane16_swap_b32 v49, v51
    s_branch L_JOIN
L_HELP:
    s_add_u32 s96, s85, 5
    s_and_b32 s97, s96, 15
    s_lshl3_add_u32 s98, s97, s3
    s_sub_u32 s99, s98, 4
    s_mul_i32 s96, s99, 49152
    s_lshl_b32 s97, s11, 7
    s_add_u32 s82, s96, s97
    s_sub_u32 s96, s3, 4
    s_lshr_b32 s97, s96, 1
    s_mul_i32 s98, s97, 2080
    s_sub_u32 s99, s3, 4
    s_and_b32 s96, s99, 1
    s_mul_i32 s97, s96, 1056
    s_add_u32 s99, s98, s97
    s_add_u32 s20, s99, 124800
    s_mov_b32 m0, s20
    s_nop 0
    buffer_load_dwordx4 v62, s[40:43], s82 offen lds
    s_add_u32 s82, s82, 2048
    s_add_u32 m0, s20, 8320
    s_nop 0
    buffer_load_dwordx4 v62, s[40:43], s82 offen lds
    s_add_u32 s82, s82, 2048
    s_add_u32 m0, s20, 16640
    s_nop 0
    buffer_load_dwordx4 v62, s[40:43], s82 offen lds
    s_add_u32 s96, s85, 5
    s_and_b32 s97, s96, 15
    s_lshl3_add_u32 s98, s97, s3
    s_mul_i32 s99, s98, 49152
    s_lshl_b32 s96, s11, 7
    s_add_u32 s82, s99, s96
    s_lshr_b32 s96, s3, 1
    s_mul_i32 s97, s96, 2080
    s_and_b32 s98, s3, 1
    s_mul_i32 s99, s98, 1056
    s_add_u32 s96, s97, s99
    s_add_u32 s20, s96, 124800
    s_mov_b32 m0, s20
    s_nop 0
    buffer_load_dwordx4 v62, s[40:43], s82 offen lds
    s_add_u32 s82, s82, 2048
    s_add_u32 m0, s20, 8320
    s_nop 0
    buffer_load_dwordx4 v62, s[40:43], s82 offen lds
    s_add_u32 s82, s82, 2048
    s_add_u32 m0, s20, 16640
    s_nop 0
    buffer_load_dwordx4 v62, s[40:43], s82 offen lds
    s_and_b32 s96, s9, 3
    s_lshl2_add_u32 s97, s96, s3
    s_sub_u32 s98, s97, 4
    s_lshl_b32 s13, s98, 7
    v_lshrrev_b32 v61, 3, v1
    v_lshl_add_u32 v61, v61, 4, s13
    v_lshrrev_b32 v60, 3, v1
    v_mul_u32_u24 v60, 98304, v60
    v_and_b32 v9, 7, v1
    v_lshl_add_u32 v60, v9, 4, v60
    s_mul_i32 s96, s13, 6144
    s_bfe_u32 s97, s9, 131074
    s_lshl_b32 s98, s8, 1
    s_lshl4_add_u32 s99, s97, s98
    s_lshr_b32 s97, s9, 4
    s_add_u32 s98, s99, s97
    s_lshl_b32 s99, s98, 7
    s_add_u32 s97, s96, s99
    s_add_u32 s17, s97, 4096
    global_load_dwordx4 v[120:123], v61, s[86:87]
    s_waitcnt vmcnt(13)
    s_barrier
    buffer_load_dwordx4 v[80:83], v60, s[48:51], s17 offen nt
    s_add_u32 s17, s17, 12288
    buffer_load_dwordx4 v[84:87], v60, s[48:51], s17 offen nt
    s_add_u32 s17, s17, 12288
    s_waitcnt lgkmcnt(0)
    s_load_dword s24, s[32:33], s92 offset:512 glc
    s_load_dword s25, s[32:33], s92 offset:256 glc
    s_load_dword s26, s[32:33], s92 offset:1024 glc
    s_load_dword s27, s[32:33], s92 offset:768 glc
    s_waitcnt vmcnt(12)
    s_barrier
    s_add_u32 s96, s85, 6
    s_and_b32 s97, s96, 15
    s_lshl3_add_u32 s98, s97, s3
    s_sub_u32 s99, s98, 4
    s_mul_i32 s96, s99, 49152
    s_lshl_b32 s97, s11, 7
    s_add_u32 s82, s96, s97
    s_sub_u32 s96, s3, 4
    s_lshr_b32 s97, s96, 1
    s_mul_i32 s98, s97, 2080
    s_sub_u32 s99, s3, 4
    s_and_b32 s96, s99, 1
    s_mul_i32 s97, s96, 1056
    s_add_u32 s20, s98, s97
    s_mov_b32 m0, s20
    s_nop 0
    buffer_load_dwordx4 v62, s[40:43], s82 offen lds
    s_add_u32 s82, s82, 2048
    s_add_u32 m0, s20, 8320
    s_nop 0
    buffer_load_dwordx4 v62, s[40:43], s82 offen lds
    s_add_u32 s82, s82, 2048
    s_add_u32 m0, s20, 16640
    s_nop 0
    buffer_load_dwordx4 v62, s[40:43], s82 offen lds
    s_add_u32 s96, s85, 6
    s_and_b32 s97, s96, 15
    s_lshl3_add_u32 s98, s97, s3
    s_mul_i32 s99, s98, 49152
    s_lshl_b32 s96, s11, 7
    s_add_u32 s82, s99, s96
    s_lshr_b32 s96, s3, 1
    s_mul_i32 s97, s96, 2080
    s_and_b32 s98, s3, 1
    s_mul_i32 s99, s98, 1056
    s_add_u32 s20, s97, s99
    s_mov_b32 m0, s20
    s_nop 0
    buffer_load_dwordx4 v62, s[40:43], s82 offen lds
    s_add_u32 s82, s82, 2048
    s_add_u32 m0, s20, 8320
    s_nop 0
    buffer_load_dwordx4 v62, s[40:43], s82 offen lds
    s_add_u32 s82, s82, 2048
    s_add_u32 m0, s20, 16640
    s_nop 0
    buffer_load_dwordx4 v62, s[40:43], s82 offen lds
    s_waitcnt vmcnt(8)
    v_lshlrev_b32 v112, 16, v120
    v_mul_f32 v4, s7, v112
    v_exp_f32 v4, -v4
    s_nop 0
    v_add_f32 v4, 1.0, v4
    v_rcp_f32 v4, v4
    s_nop 0
    v_mul_f32 v112, v112, v4
    v_cvt_pk_bf16_f32 v112, 0, v112
    v_and_b32 v113, s6, v120
    v_mul_f32 v5, s7, v113
    v_exp_f32 v5, -v5
    s_nop 0
    v_add_f32 v5, 1.0, v5
    v_rcp_f32 v5, v5
    s_nop 0
    v_mul_f32 v113, v113, v5
    v_cvt_pk_bf16_f32 v113, 0, v113
    v_lshlrev_b32 v114, 16, v121
    v_mul_f32 v4, s7, v114
    v_exp_f32 v4, -v4
    s_nop 0
    v_add_f32 v4, 1.0, v4
    v_rcp_f32 v4, v4
    s_nop 0
    v_mul_f32 v114, v114, v4
    v_cvt_pk_bf16_f32 v114, 0, v114
    v_and_b32 v115, s6, v121
    v_mul_f32 v5, s7, v115
    v_exp_f32 v5, -v5
    s_nop 0
    v_add_f32 v5, 1.0, v5
    v_rcp_f32 v5, v5
    s_nop 0
    v_mul_f32 v115, v115, v5
    v_cvt_pk_bf16_f32 v115, 0, v115
    s_barrier
    s_add_u32 s96, s85, 7
    s_and_b32 s97, s96, 15
    s_lshl3_add_u32 s98, s97, s3
    s_sub_u32 s99, s98, 4
    s_mul_i32 s96, s99, 49152
    s_lshl_b32 s97, s11, 7
    s_add_u32 s82, s96, s97
    s_sub_u32 s96, s3, 4
    s_lshr_b32 s97, s96, 1
    s_mul_i32 s98, s97, 2080
    s_sub_u32 s99, s3, 4
    s_and_b32 s96, s99, 1
    s_mul_i32 s97, s96, 1056
    s_add_u32 s99, s98, s97
    s_add_u32 s20, s99, 24960
    s_mov_b32 m0, s20
    s_nop 0
    buffer_load_dwordx4 v62, s[40:43], s82 offen lds
    s_add_u32 s82, s82, 2048
    s_add_u32 m0, s20, 8320
    s_nop 0
    buffer_load_dwordx4 v62, s[40:43], s82 offen lds
    s_add_u32 s82, s82, 2048
    s_add_u32 m0, s20, 16640
    s_nop 0
    buffer_load_dwordx4 v62, s[40:43], s82 offen lds
    buffer_load_dwordx4 v[88:91], v60, s[48:51], s17 offen nt
    s_add_u32 s17, s17, 12288
    buffer_load_dwordx4 v[92:95], v60, s[48:51], s17 offen nt
    s_add_u32 s17, s17, 12288
    s_barrier
    s_add_u32 s96, s85, 7
    s_and_b32 s97, s96, 15
    s_lshl3_add_u32 s98, s97, s3
    s_mul_i32 s99, s98, 49152
    s_lshl_b32 s96, s11, 7
    s_add_u32 s82, s99, s96
    s_lshr_b32 s96, s3, 1
    s_mul_i32 s97, s96, 2080
    s_and_b32 s98, s3, 1
    s_mul_i32 s99, s98, 1056
    s_add_u32 s96, s97, s99
    s_add_u32 s20, s96, 24960
    s_mov_b32 m0, s20
    s_nop 0
    buffer_load_dwordx4 v62, s[40:43], s82 offen lds
    s_add_u32 s82, s82, 2048
    s_add_u32 m0, s20, 8320
    s_nop 0
    buffer_load_dwordx4 v62, s[40:43], s82 offen lds
    s_add_u32 s82, s82, 2048
    s_add_u32 m0, s20, 16640
    s_nop 0
    buffer_load_dwordx4 v62, s[40:43], s82 offen lds
    s_add_u32 s96, s85, 8
    s_and_b32 s97, s96, 15
    s_lshl3_add_u32 s98, s97, s3
    s_sub_u32 s99, s98, 4
    s_mul_i32 s96, s99, 49152
    s_lshl_b32 s97, s11, 7
    s_add_u32 s82, s96, s97
    s_sub_u32 s96, s3, 4
    s_lshr_b32 s97, s96, 1
    s_mul_i32 s98, s97, 2080
    s_sub_u32 s99, s3, 4
    s_and_b32 s96, s99, 1
    s_mul_i32 s97, s96, 1056
    s_add_u32 s99, s98, s97
    s_add_u32 s20, s99, 49920
    s_mov_b32 m0, s20
    s_nop 0
    buffer_load_dwordx4 v62, s[40:43], s82 offen lds
    s_add_u32 s82, s82, 2048
    s_add_u32 m0, s20, 8320
    s_nop 0
    buffer_load_dwordx4 v62, s[40:43], s82 offen lds
    s_add_u32 s82, s82, 2048
    s_add_u32 m0, s20, 16640
    s_nop 0
    buffer_load_dwordx4 v62, s[40:43], s82 offen lds
    v_lshlrev_b32 v116, 16, v122
    v_mul_f32 v4, s7, v116
    v_exp_f32 v4, -v4
    s_nop 0
    v_add_f32 v4, 1.0, v4
    v_rcp_f32 v4, v4
    s_nop 0
    v_mul_f32 v116, v116, v4
    v_cvt_pk_bf16_f32 v116, 0, v116
    v_and_b32 v117, s6, v122
    v_mul_f32 v5, s7, v117
    v_exp_f32 v5, -v5
    s_nop 0
    v_add_f32 v5, 1.0, v5
    v_rcp_f32 v5, v5
    s_nop 0
    v_mul_f32 v117, v117, v5
    v_cvt_pk_bf16_f32 v117, 0, v117
    v_lshlrev_b32 v118, 16, v123
    v_mul_f32 v4, s7, v118
    v_exp_f32 v4, -v4
    s_nop 0
    v_add_f32 v4, 1.0, v4
    v_rcp_f32 v4, v4
    s_nop 0
    v_mul_f32 v118, v118, v4
    v_cvt_pk_bf16_f32 v118, 0, v118
    v_and_b32 v119, s6, v123
    v_mul_f32 v5, s7, v119
    v_exp_f32 v5, -v5
    s_nop 0
    v_add_f32 v5, 1.0, v5
    v_rcp_f32 v5, v5
    s_nop 0
    v_mul_f32 v119, v119, v5
    v_cvt_pk_bf16_f32 v119, 0, v119
    s_waitcnt lgkmcnt(0)
    s_load_dword s24, s[32:33], s92 offset:1536 glc
    s_load_dword s25, s[32:33], s92 offset:1280 glc
    s_load_dword s26, s[32:33], s92 offset:2048 glc
    s_load_dword s27, s[32:33], s92 offset:1792 glc
    s_barrier
    s_add_u32 s96, s85, 8
    s_and_b32 s97, s96, 15
    s_lshl3_add_u32 s98, s97, s3
    s_mul_i32 s99, s98, 49152
    s_lshl_b32 s96, s11, 7
    s_add_u32 s82, s99, s96
    s_lshr_b32 s96, s3, 1
    s_mul_i32 s97, s96, 2080
    s_and_b32 s98, s3, 1
    s_mul_i32 s99, s98, 1056
    s_add_u32 s96, s97, s99
    s_add_u32 s20, s96, 49920
    s_mov_b32 m0, s20
    s_nop 0
    buffer_load_dwordx4 v62, s[40:43], s82 offen lds
    s_add_u32 s82, s82, 2048
    s_add_u32 m0, s20, 8320
    s_nop 0
    buffer_load_dwordx4 v62, s[40:43], s82 offen lds
    s_add_u32 s82, s82, 2048
    s_add_u32 m0, s20, 16640
    s_nop 0
    buffer_load_dwordx4 v62, s[40:43], s82 offen lds
    buffer_load_dwordx4 v[96:99], v60, s[48:51], s17 offen nt
    s_add_u32 s17, s17, 12288
    buffer_load_dwordx4 v[100:103], v60, s[48:51], s17 offen nt
    s_add_u32 s17, s17, 12288
    s_waitcnt vmcnt(16)
    s_barrier
    s_add_u32 s96, s85, 9
    s_and_b32 s97, s96, 15
    s_lshl3_add_u32 s98, s97, s3
    s_sub_u32 s99, s98, 4
    s_mul_i32 s96, s99, 49152
    s_lshl_b32 s97, s11, 7
    s_add_u32 s82, s96, s97
    s_sub_u32 s96, s3, 4
    s_lshr_b32 s97, s96, 1
    s_mul_i32 s98, s97, 2080
    s_sub_u32 s99, s3, 4
    s_and_b32 s96, s99, 1
    s_mul_i32 s97, s96, 1056
    s_add_u32 s99, s98, s97
    s_add_u32 s20, s99, 74880
    s_mov_b32 m0, s20
    s_nop 0
    buffer_load_dwordx4 v62, s[40:43], s82 offen lds
    s_add_u32 s82, s82, 2048
    s_add_u32 m0, s20, 8320
    s_nop 0
    buffer_load_dwordx4 v62, s[40:43], s82 offen lds
    s_add_u32 s82, s82, 2048
    s_add_u32 m0, s20, 16640
    s_nop 0
    buffer_load_dwordx4 v62, s[40:43], s82 offen lds
    s_add_u32 s96, s85, 9
    s_and_b32 s97, s96, 15
    s_lshl3_add_u32 s98, s97, s3
    s_mul_i32 s99, s98, 49152
    s_lshl_b32 s96, s11, 7
    s_add_u32 s82, s99, s96
    s_lshr_b32 s96, s3, 1
    s_mul_i32 s97, s96, 2080
    s_and_b32 s98, s3, 1
    s_mul_i32 s99, s98, 1056
    s_add_u32 s96, s97, s99
    s_add_u32 s20, s96, 74880
    s_mov_b32 m0, s20
    s_nop 0
    buffer_load_dwordx4 v62, s[40:43], s82 offen lds
    s_add_u32 s82, s82, 2048
    s_add_u32 m0, s20, 8320
    s_nop 0
    buffer_load_dwordx4 v62, s[40:43], s82 offen lds
    s_add_u32 s82, s82, 2048
    s_add_u32 m0, s20, 16640
    s_nop 0
    buffer_load_dwordx4 v62, s[40:43], s82 offen lds
    v_lshlrev_b32 v4, 16, v80
    v_and_b32 v5, s6, v80
    v_mul_f32 v20, v4, v112
    v_mul_f32 v21, v5, v112
    v_lshlrev_b32 v6, 16, v81
    v_and_b32 v7, s6, v81
    v_mul_f32 v22, v6, v112
    v_mul_f32 v23, v7, v112
    v_lshlrev_b32 v4, 16, v82
    v_and_b32 v5, s6, v82
    v_mul_f32 v24, v4, v112
    v_mul_f32 v25, v5, v112
    v_lshlrev_b32 v6, 16, v83
    v_and_b32 v7, s6, v83
    v_mul_f32 v26, v6, v112
    v_mul_f32 v27, v7, v112
    s_waitcnt vmcnt(14)
    s_barrier
    s_add_u32 s96, s85, 10
    s_and_b32 s97, s96, 15
    s_lshl3_add_u32 s98, s97, s3
    s_sub_u32 s99, s98, 4
    s_mul_i32 s96, s99, 49152
    s_lshl_b32 s97, s11, 7
    s_add_u32 s82, s96, s97
    s_sub_u32 s96, s3, 4
    s_lshr_b32 s97, s96, 1
    s_mul_i32 s98, s97, 2080
    s_sub_u32 s99, s3, 4
    s_and_b32 s96, s99, 1
    s_mul_i32 s97, s96, 1056
    s_add_u32 s99, s98, s97
    s_add_u32 s20, s99, 99840
    s_mov_b32 m0, s20
    s_nop 0
    buffer_load_dwordx4 v62, s[40:43], s82 offen lds
    s_add_u32 s82, s82, 2048
    s_add_u32 m0, s20, 8320
    s_nop 0
    buffer_load_dwordx4 v62, s[40:43], s82 offen lds
    s_add_u32 s82, s82, 2048
    s_add_u32 m0, s20, 16640
    s_nop 0
    buffer_load_dwordx4 v62, s[40:43], s82 offen lds
    buffer_load_dwordx4 v[104:107], v60, s[48:51], s17 offen nt
    s_add_u32 s17, s17, 12288
    buffer_load_dwordx4 v[108:111], v60, s[48:51], s17 offen nt
    s_lshl2_add_u32 s96, s74, s75
    s_lshl_b32 s97, s96, 11
    s_and_b32 s98, s3, 1
    s_lshl_b32 s99, s98, 10
    s_add_u32 s96, s97, s99
    s_add_u32 s13, s96, 20971520
    s_lshl4_add_u32 s96, s21, s12
    s_lshl_b32 s97, s96, 11
    s_and_b32 s98, s3, 1
    s_lshl_b32 s99, s98, 10
    s_add_u32 s96, s97, s99
    s_add_u32 s14, s96, 12582912
    buffer_load_dwordx4 v[124:127], v2, s[32:35], s13 offen
    s_waitcnt lgkmcnt(0)
    s_load_dword s24, s[32:33], s92 offset:2560 glc
    s_load_dword s25, s[32:33], s92 offset:2304 glc
    s_load_dword s26, s[32:33], s92 offset:3072 glc
    s_load_dword s27, s[32:33], s92 offset:2816 glc
    s_load_dword s28, s[32:33], s92 offset:3584 glc
    s_load_dword s29, s[32:33], s92 offset:3328 glc
    s_waitcnt vmcnt(14)
    s_barrier
    s_add_u32 s96, s85, 10
    s_and_b32 s97, s96, 15
    s_lshl3_add_u32 s98, s97, s3
    s_mul_i32 s99, s98, 49152
    s_lshl_b32 s96, s11, 7
    s_add_u32 s82, s99, s96
    s_lshr_b32 s96, s3, 1
    s_mul_i32 s97, s96, 2080
    s_and_b32 s98, s3, 1
    s_mul_i32 s99, s98, 1056
    s_add_u32 s96, s97, s99
    s_add_u32 s20, s96, 99840
    s_mov_b32 m0, s20
    s_nop 0
    buffer_load_dwordx4 v62, s[40:43], s82 offen lds
    s_add_u32 s82, s82, 2048
    s_add_u32 m0, s20, 8320
    s_nop 0
    buffer_load_dwordx4 v62, s[40:43], s82 offen lds
    s_add_u32 s82, s82, 2048
    s_add_u32 m0, s20, 16640
    s_nop 0
    buffer_load_dwordx4 v62, s[40:43], s82 offen lds
    s_add_u32 s96, s85, 11
    s_and_b32 s97, s96, 15
    s_lshl3_add_u32 s98, s97, s3
    s_sub_u32 s99, s98, 4
    s_mul_i32 s96, s99, 49152
    s_lshl_b32 s97, s11, 7
    s_add_u32 s82, s96, s97
    s_sub_u32 s96, s3, 4
    s_lshr_b32 s97, s96, 1
    s_mul_i32 s98, s97, 2080
    s_sub_u32 s99, s3, 4
    s_and_b32 s96, s99, 1
    s_mul_i32 s97, s96, 1056
    s_add_u32 s99, s98, s97
    s_add_u32 s20, s99, 124800
    s_mov_b32 m0, s20
    s_nop 0
    buffer_load_dwordx4 v62, s[40:43], s82 offen lds
    s_add_u32 s82, s82, 2048
    s_add_u32 m0, s20, 8320
    s_nop 0
    buffer_load_dwordx4 v62, s[40:43], s82 offen lds
    s_add_u32 s82, s82, 2048
    s_add_u32 m0, s20, 16640
    s_nop 0
    buffer_load_dwordx4 v62, s[40:43], s82 offen lds
    v_lshlrev_b32 v4, 16, v84
    v_and_b32 v5, s6, v84
    v_fmac_f32 v20, v4, v113
    v_fmac_f32 v21, v5, v113
    v_lshlrev_b32 v6, 16, v85
    v_and_b32 v7, s6, v85
    v_fmac_f32 v22, v6, v113
    v_fmac_f32 v23, v7, v113
    v_lshlrev_b32 v4, 16, v86
    v_and_b32 v5, s6, v86
    v_fmac_f32 v24, v4, v113
    v_fmac_f32 v25, v5, v113
    v_lshlrev_b32 v6, 16, v87
    v_and_b32 v7, s6, v87
    v_fmac_f32 v26, v6, v113
    v_fmac_f32 v27, v7, v113
    s_waitcnt vmcnt(12)
    s_barrier
    s_add_u32 s96, s85, 11
    s_and_b32 s97, s96, 15
    s_lshl3_add_u32 s98, s97, s3
    s_mul_i32 s99, s98, 49152
    s_lshl_b32 s96, s11, 7
    s_add_u32 s82, s99, s96
    s_lshr_b32 s96, s3, 1
    s_mul_i32 s97, s96, 2080
    s_and_b32 s98, s3, 1
    s_mul_i32 s99, s98, 1056
    s_add_u32 s96, s97, s99
    s_add_u32 s20, s96, 124800
    s_mov_b32 m0, s20
    s_nop 0
    buffer_load_dwordx4 v62, s[40:43], s82 offen lds
    s_add_u32 s82, s82, 2048
    s_add_u32 m0, s20, 8320
    s_nop 0
    buffer_load_dwordx4 v62, s[40:43], s82 offen lds
    s_add_u32 s82, s82, 2048
    s_add_u32 m0, s20, 16640
    s_nop 0
    buffer_load_dwordx4 v62, s[40:43], s82 offen lds
    s_add_u32 s96, s85, 12
    s_and_b32 s97, s96, 15
    s_lshl3_add_u32 s98, s97, s3
    s_sub_u32 s99, s98, 4
    s_mul_i32 s96, s99, 49152
    s_lshl_b32 s97, s11, 7
    s_add_u32 s82, s96, s97
    s_sub_u32 s96, s3, 4
    s_lshr_b32 s97, s96, 1
    s_mul_i32 s98, s97, 2080
    s_sub_u32 s99, s3, 4
    s_and_b32 s96, s99, 1
    s_mul_i32 s97, s96, 1056
    s_add_u32 s20, s98, s97
    s_mov_b32 m0, s20
    s_nop 0
    buffer_load_dwordx4 v62, s[40:43], s82 offen lds
    s_add_u32 s82, s82, 2048
    s_add_u32 m0, s20, 8320
    s_nop 0
    buffer_load_dwordx4 v62, s[40:43], s82 offen lds
    s_add_u32 s82, s82, 2048
    s_add_u32 m0, s20, 16640
    s_nop 0
    buffer_load_dwordx4 v62, s[40:43], s82 offen lds
    v_lshlrev_b32 v4, 16, v88
    v_and_b32 v5, s6, v88
    v_fmac_f32 v20, v4, v114
    v_fmac_f32 v21, v5, v114
    v_lshlrev_b32 v6, 16, v89
    v_and_b32 v7, s6, v89
    v_fmac_f32 v22, v6, v114
    v_fmac_f32 v23, v7, v114
    v_lshlrev_b32 v4, 16, v90
    v_and_b32 v5, s6, v90
    v_fmac_f32 v24, v4, v114
    v_fmac_f32 v25, v5, v114
    v_lshlrev_b32 v6, 16, v91
    v_and_b32 v7, s6, v91
    v_fmac_f32 v26, v6, v114
    v_fmac_f32 v27, v7, v114
    s_waitcnt vmcnt(9)
    s_barrier
    s_add_u32 s96, s85, 12
    s_and_b32 s97, s96, 15
    s_lshl3_add_u32 s98, s97, s3
    s_mul_i32 s99, s98, 49152
    s_lshl_b32 s96, s11, 7
    s_add_u32 s82, s99, s96
    s_lshr_b32 s96, s3, 1
    s_mul_i32 s97, s96, 2080
    s_and_b32 s98, s3, 1
    s_mul_i32 s99, s98, 1056
    s_add_u32 s20, s97, s99
    s_mov_b32 m0, s20
    s_nop 0
    buffer_load_dwordx4 v62, s[40:43], s82 offen lds
    s_add_u32 s82, s82, 2048
    s_add_u32 m0, s20, 8320
    s_nop 0
    buffer_load_dwordx4 v62, s[40:43], s82 offen lds
    s_add_u32 s82, s82, 2048
    s_add_u32 m0, s20, 16640
    s_nop 0
    buffer_load_dwordx4 v62, s[40:43], s82 offen lds
    s_add_u32 s96, s85, 13
    s_and_b32 s97, s96, 15
    s_lshl3_add_u32 s98, s97, s3
    s_sub_u32 s99, s98, 4
    s_mul_i32 s96, s99, 49152
    s_lshl_b32 s97, s11, 7
    s_add_u32 s82, s96, s97
    s_sub_u32 s96, s3, 4
    s_lshr_b32 s97, s96, 1
    s_mul_i32 s98, s97, 2080
    s_sub_u32 s99, s3, 4
    s_and_b32 s96, s99, 1
    s_mul_i32 s97, s96, 1056
    s_add_u32 s99, s98, s97
    s_add_u32 s20, s99, 24960
    s_mov_b32 m0, s20
    s_nop 0
    buffer_load_dwordx4 v62, s[40:43], s82 offen lds
    s_add_u32 s82, s82, 2048
    s_add_u32 m0, s20, 8320
    s_nop 0
    buffer_load_dwordx4 v62, s[40:43], s82 offen lds
    s_add_u32 s82, s82, 2048
    s_add_u32 m0, s20, 16640
    s_nop 0
    buffer_load_dwordx4 v62, s[40:43], s82 offen lds
    v_lshlrev_b32 v4, 16, v92
    v_and_b32 v5, s6, v92
    v_fmac_f32 v20, v4, v115
    v_fmac_f32 v21, v5, v115
    v_lshlrev_b32 v6, 16, v93
    v_and_b32 v7, s6, v93
    v_fmac_f32 v22, v6, v115
    v_fmac_f32 v23, v7, v115
    v_lshlrev_b32 v4, 16, v94
    v_and_b32 v5, s6, v94
    v_fmac_f32 v24, v4, v115
    v_fmac_f32 v25, v5, v115
    v_lshlrev_b32 v6, 16, v95
    v_and_b32 v7, s6, v95
    v_fmac_f32 v26, v6, v115
    v_fmac_f32 v27, v7, v115
    s_waitcnt vmcnt(9)
    s_barrier
    s_add_u32 s96, s85, 13
    s_and_b32 s97, s96, 15
    s_lshl3_add_u32 s98, s97, s3
    s_mul_i32 s99, s98, 49152
    s_lshl_b32 s96, s11, 7
    s_add_u32 s82, s99, s96
    s_lshr_b32 s96, s3, 1
    s_mul_i32 s97, s96, 2080
    s_and_b32 s98, s3, 1
    s_mul_i32 s99, s98, 1056
    s_add_u32 s96, s97, s99
    s_add_u32 s20, s96, 24960
    s_mov_b32 m0, s20
    s_nop 0
    buffer_load_dwordx4 v62, s[40:43], s82 offen lds
    s_add_u32 s82, s82, 2048
    s_add_u32 m0, s20, 8320
    s_nop 0
    buffer_load_dwordx4 v62, s[40:43], s82 offen lds
    s_add_u32 s82, s82, 2048
    s_add_u32 m0, s20, 16640
    s_nop 0
    buffer_load_dwordx4 v62, s[40:43], s82 offen lds
    s_add_u32 s96, s85, 14
    s_and_b32 s97, s96, 15
    s_lshl3_add_u32 s98, s97, s3
    s_sub_u32 s99, s98, 4
    s_mul_i32 s96, s99, 49152
    s_lshl_b32 s97, s11, 7
    s_add_u32 s82, s96, s97
    s_sub_u32 s96, s3, 4
    s_lshr_b32 s97, s96, 1
    s_mul_i32 s98, s97, 2080
    s_sub_u32 s99, s3, 4
    s_and_b32 s96, s99, 1
    s_mul_i32 s97, s96, 1056
    s_add_u32 s99, s98, s97
    s_add_u32 s20, s99, 49920
    s_mov_b32 m0, s20
    s_nop 0
    buffer_load_dwordx4 v62, s[40:43], s82 offen lds
    s_add_u32 s82, s82, 2048
    s_add_u32 m0, s20, 8320
    s_nop 0
    buffer_load_dwordx4 v62, s[40:43], s82 offen lds
    s_add_u32 s82, s82, 2048
    s_add_u32 m0, s20, 16640
    s_nop 0
    buffer_load_dwordx4 v62, s[40:43], s82 offen lds
    v_lshlrev_b32 v4, 16, v96
    v_and_b32 v5, s6, v96
    v_fmac_f32 v20, v4, v116
    v_fmac_f32 v21, v5, v116
    v_lshlrev_b32 v6, 16, v97
    v_and_b32 v7, s6, v97
    v_fmac_f32 v22, v6, v116
    v_fmac_f32 v23, v7, v116
    v_lshlrev_b32 v4, 16, v98
    v_and_b32 v5, s6, v98
    v_fmac_f32 v24, v4, v116
    v_fmac_f32 v25, v5, v116
    v_lshlrev_b32 v6, 16, v99
    v_and_b32 v7, s6, v99
    v_fmac_f32 v26, v6, v116
    v_fmac_f32 v27, v7, v116
    v_lshlrev_b32 v4, 16, v100
    v_and_b32 v5, s6, v100
    v_fmac_f32 v20, v4, v117
    v_fmac_f32 v21, v5, v117
    v_lshlrev_b32 v6, 16, v101
    v_and_b32 v7, s6, v101
    v_fmac_f32 v22, v6, v117
    v_fmac_f32 v23, v7, v117
    v_lshlrev_b32 v4, 16, v102
    v_and_b32 v5, s6, v102
    v_fmac_f32 v24, v4, v117
    v_fmac_f32 v25, v5, v117
    v_lshlrev_b32 v6, 16, v103
    v_and_b32 v7, s6, v103
    v_fmac_f32 v26, v6, v117
    v_fmac_f32 v27, v7, v117
    s_waitcnt vmcnt(9)
    s_barrier
    s_add_u32 s96, s85, 14
    s_and_b32 s97, s96, 15
    s_lshl3_add_u32 s98, s97, s3
    s_mul_i32 s99, s98, 49152
    s_lshl_b32 s96, s11, 7
    s_add_u32 s82, s99, s96
    s_lshr_b32 s96, s3, 1
    s_mul_i32 s97, s96, 2080
    s_and_b32 s98, s3, 1
    s_mul_i32 s99, s98, 1056
    s_add_u32 s96, s97, s99
    s_add_u32 s20, s96, 49920
    s_mov_b32 m0, s20
    s_nop 0
    buffer_load_dwordx4 v62, s[40:43], s82 offen lds
    s_add_u32 s82, s82, 2048
    s_add_u32 m0, s20, 8320
    s_nop 0
    buffer_load_dwordx4 v62, s[40:43], s82 offen lds
    s_add_u32 s82, s82, 2048
    s_add_u32 m0, s20, 16640
    s_nop 0
    buffer_load_dwordx4 v62, s[40:43], s82 offen lds
    s_add_u32 s96, s85, 15
    s_and_b32 s97, s96, 15
    s_lshl3_add_u32 s98, s97, s3
    s_sub_u32 s99, s98, 4
    s_mul_i32 s96, s99, 49152
    s_lshl_b32 s97, s11, 7
    s_add_u32 s82, s96, s97
    s_sub_u32 s96, s3, 4
    s_lshr_b32 s97, s96, 1
    s_mul_i32 s98, s97, 2080
    s_sub_u32 s99, s3, 4
    s_and_b32 s96, s99, 1
    s_mul_i32 s97, s96, 1056
    s_add_u32 s99, s98, s97
    s_add_u32 s20, s99, 74880
    s_mov_b32 m0, s20
    s_nop 0
    buffer_load_dwordx4 v62, s[40:43], s82 offen lds
    s_add_u32 s82, s82, 2048
    s_add_u32 m0, s20, 8320
    s_nop 0
    buffer_load_dwordx4 v62, s[40:43], s82 offen lds
    s_add_u32 s82, s82, 2048
    s_add_u32 m0, s20, 16640
    s_nop 0
    buffer_load_dwordx4 v62, s[40:43], s82 offen lds
    v_lshlrev_b32 v4, 16, v104
    v_and_b32 v5, s6, v104
    v_fmac_f32 v20, v4, v118
    v_fmac_f32 v21, v5, v118
    v_lshlrev_b32 v6, 16, v105
    v_and_b32 v7, s6, v105
    v_fmac_f32 v22, v6, v118
    v_fmac_f32 v23, v7, v118
    v_lshlrev_b32 v4, 16, v106
    v_and_b32 v5, s6, v106
    v_fmac_f32 v24, v4, v118
    v_fmac_f32 v25, v5, v118
    v_lshlrev_b32 v6, 16, v107
    v_and_b32 v7, s6, v107
    v_fmac_f32 v26, v6, v118
    v_fmac_f32 v27, v7, v118
    v_lshlrev_b32 v4, 16, v108
    v_and_b32 v5, s6, v108
    v_fmac_f32 v20, v4, v119
    v_fmac_f32 v21, v5, v119
    v_lshlrev_b32 v6, 16, v109
    v_and_b32 v7, s6, v109
    v_fmac_f32 v22, v6, v119
    v_fmac_f32 v23, v7, v119
    v_lshlrev_b32 v4, 16, v110
    v_and_b32 v5, s6, v110
    v_fmac_f32 v24, v4, v119
    v_fmac_f32 v25, v5, v119
    v_lshlrev_b32 v6, 16, v111
    v_and_b32 v7, s6, v111
    v_fmac_f32 v26, v6, v119
    v_fmac_f32 v27, v7, v119
    s_waitcnt vmcnt(9)
    s_barrier
    s_add_u32 s96, s85, 15
    s_and_b32 s97, s96, 15
    s_lshl3_add_u32 s98, s97, s3
    s_mul_i32 s99, s98, 49152
    s_lshl_b32 s96, s11, 7
    s_add_u32 s82, s99, s96
    s_lshr_b32 s96, s3, 1
    s_mul_i32 s97, s96, 2080
    s_and_b32 s98, s3, 1
    s_mul_i32 s99, s98, 1056
    s_add_u32 s96, s97, s99
    s_add_u32 s20, s96, 74880
    s_mov_b32 m0, s20
    s_nop 0
    buffer_load_dwordx4 v62, s[40:43], s82 offen lds
    s_add_u32 s82, s82, 2048
    s_add_u32 m0, s20, 8320
    s_nop 0
    buffer_load_dwordx4 v62, s[40:43], s82 offen lds
    s_add_u32 s82, s82, 2048
    s_add_u32 m0, s20, 16640
    s_nop 0
    buffer_load_dwordx4 v62, s[40:43], s82 offen lds
    s_lshl_b32 s13, s12, 7
    v_and_b32 v4, 31, v1
    v_lshl_add_u32 v4, v4, 2, s13
    global_load_dword v104, v4, s[78:79]
    v_permlane32_swap_b32 v20, v24
    v_permlane32_swap_b32 v21, v25
    v_permlane32_swap_b32 v22, v26
    v_permlane32_swap_b32 v23, v27
    v_add_f32 v20, v20, v24
    v_add_f32 v21, v21, v25
    v_add_f32 v22, v22, v26
    v_add_f32 v23, v23, v27
    s_nop 0
    v_permlane16_swap_b32 v20, v22
    v_permlane16_swap_b32 v21, v23
    v_add_f32 v20, v20, v22
    v_add_f32 v21, v21, v23
    s_nop 0
    v_add_f32_dpp v20, v20, v20 row_ror:8 row_mask:0xf bank_mask:0xf
    v_add_f32_dpp v21, v21, v21 row_ror:8 row_mask:0xf bank_mask:0xf
    s_nop 1
    v_mov_b32_dpp v20, v21 quad_perm:[0,1,2,3] row_mask:0xf bank_mask:0xc
    ds_write_b32 v65, v20 offset:1024
    s_waitcnt lgkmcnt(0)
    s_barrier
    s_waitcnt vmcnt(7)
    s_waitcnt vmcnt(1)
    s_barrier
    s_cmp_lg_u32 s3, 4
    s_cbranch_scc1 L_M2F
    s_bfe_u32 s96, s9, 131074
    s_lshl_b32 s97, s8, 1
    s_lshl4_add_u32 s98, s96, s97
    s_lshr_b32 s99, s9, 4
    s_add_u32 s96, s98, s99
    s_and_b32 s97, s9, 3
    s_lshl2_add_u32 s98, s96, s97
    s_lshl_b32 s99, s98, 9
    s_add_u32 s13, s99, 131072
    ds_read_b128 v[20:23], v64 offset:1024
    ds_read_b128 v[24:27], v64 offset:1040
    s_waitcnt lgkmcnt(0)
    v_add_f32 v20, v20, v22
    v_add_f32 v21, v21, v23
    v_add_f32 v24, v24, v26
    v_add_f32 v25, v25, v27
    v_add_f32 v20, v20, v21
    v_add_f32 v22, v24, v25
    v_mov_b32 v21, s4
    v_mov_b32 v23, s4
    s_mov_b32 exec_hi, 0
    buffer_store_dwordx4 v[20:23], v2, s[32:35], s13 offen sc1
    s_mov_b32 exec_hi, -1
L_M2F:
    s_lshl4_add_u32 s96, s11, s10
    s_lshl_b32 s97, s96, 10
    s_and_b32 s98, s3, 3
    s_lshl_b32 s99, s98, 8
    s_add_u32 s96, s97, s99
    s_add_u32 s13, s96, 29360128
    s_lshl_b32 s96, s11, 7
    s_add_u32 s14, s96, 32768
    v_lshlrev_b32 v60, 7, v1
    s_mov_b64 exec, 3
    buffer_load_dword v60, v60, s[32:35], s13 offen
    buffer_load_dword v61, v3, s[32:35], s14 offen
    s_mov_b64 exec, -1
    s_add_u32 s96, s84, 1114112
    s_and_b32 s97, s96, 1048575
    s_lshl_b32 s98, s83, 16
    s_xor_b32 s99, s97, s98
    s_xor_b32 s96, s88, 1048576
    s_add_u32 s13, s99, s96
    s_add_u32 m0, s89, 102400
    s_nop 0
    buffer_load_dwordx4 v74, s[44:47], s13 offen lds
    s_add_u32 s96, s84, 1179648
    s_and_b32 s97, s96, 1048575
    s_lshl_b32 s98, s83, 16
    s_xor_b32 s99, s97, s98
    s_xor_b32 s96, s88, 1048576
    s_add_u32 s13, s99, s96
    s_add_u32 m0, s89, 106496
    s_nop 0
    buffer_load_dwordx4 v74, s[44:47], s13 offen lds
    s_add_u32 s96, s84, 1245184
    s_and_b32 s97, s96, 1048575
    s_lshl_b32 s98, s83, 16
    s_xor_b32 s99, s97, s98
    s_xor_b32 s96, s88, 1048576
    s_add_u32 s13, s99, s96
    s_add_u32 m0, s89, 110592
    s_nop 0
    buffer_load_dwordx4 v74, s[44:47], s13 offen lds
    s_add_u32 s96, s84, 1310720
    s_and_b32 s97, s96, 1048575
    s_lshl_b32 s98, s83, 16
    s_xor_b32 s99, s97, s98
    s_xor_b32 s96, s88, 1048576
    s_add_u32 s13, s99, s96
    s_add_u32 m0, s89, 114688
    s_nop 0
    buffer_load_dwordx4 v74, s[44:47], s13 offen lds
    s_add_u32 s96, s84, 1376256
    s_and_b32 s97, s96, 1048575
    s_lshl_b32 s98, s83, 16
    s_xor_b32 s99, s97, s98
    s_xor_b32 s96, s88, 1048576
    s_add_u32 s13, s99, s96
    s_add_u32 m0, s89, 118784
    s_nop 0
    buffer_load_dwordx4 v74, s[44:47], s13 offen lds
    s_add_u32 s96, s84, 1441792
    s_and_b32 s97, s96, 1048575
    s_lshl_b32 s98, s83, 16
    s_xor_b32 s99, s97, s98
    s_xor_b32 s96, s88, 1048576
    s_add_u32 s13, s99, s96
    s_add_u32 m0, s89, 122880
    s_nop 0
    buffer_load_dwordx4 v74, s[44:47], s13 offen lds
    s_add_u32 s96, s84, 1507328
    s_and_b32 s97, s96, 1048575
    s_lshl_b32 s98, s83, 16
    s_xor_b32 s99, s97, s98
    s_xor_b32 s96, s88, 1048576
    s_add_u32 s13, s99, s96
    s_add_u32 m0, s89, 126976
    s_nop 0
    buffer_load_dwordx4 v74, s[44:47], s13 offen lds
    s_add_u32 s96, s84, 1572864
    s_and_b32 s97, s96, 1048575
    s_lshl_b32 s98, s83, 16
    s_xor_b32 s99, s97, s98
    s_xor_b32 s96, s88, 1048576
    s_add_u32 s13, s99, s96
    s_add_u32 m0, s89, 131072
    s_nop 0
    buffer_load_dwordx4 v74, s[44:47], s13 offen lds
    s_mov_b32 s13, s80
    buffer_load_dwordx4 v[176:179], v72, s[52:55], s13 offen nt
    s_add_u32 s13, s80, 4294049792
    buffer_load_dwordx4 v[180:183], v72, s[52:55], s13 offen nt
    s_lshl_b32 s96, s90, 7
    s_add_u32 s13, s96, s80
    buffer_load_dwordx4 v[184:187], v72, s[56:59], s13 offen nt
    s_lshl_b32 s96, s90, 7
    s_add_u32 s97, s96, s80
    s_add_u32 s13, s97, 4294049792
    buffer_load_dwordx4 v[188:191], v72, s[56:59], s13 offen nt
    s_add_u32 s13, s80, 57344
    buffer_load_dwordx4 v[192:195], v72, s[52:55], s13 offen nt
    s_add_u32 s13, s80, 4294107136
    buffer_load_dwordx4 v[196:199], v72, s[52:55], s13 offen nt
    s_lshl_b32 s96, s90, 7
    s_add_u32 s97, s96, s80
    s_add_u32 s13, s97, 57344
    buffer_load_dwordx4 v[200:203], v72, s[56:59], s13 offen nt
    s_lshl_b32 s96, s90, 7
    s_add_u32 s97, s96, s80
    s_add_u32 s13, s97, 4294107136
    buffer_load_dwordx4 v[204:207], v72, s[56:59], s13 offen nt
    s_waitcnt lgkmcnt(0)
    s_barrier
    ds_read_b128 v[36:39], v76
    ds_read_b128 v[40:43], v76 offset:1024
    s_waitcnt lgkmcnt(0)
    v_mfma_f32_32x32x16_bf16 v[112:127], v[28:31], v[36:39], 0
    v_mfma_f32_32x32x16_bf16 v[112:127], v[32:35], v[40:43], v[112:127]
    s_add_u32 s13, s80, 114688
    buffer_load_dwordx4 v[208:211], v72, s[52:55], s13 offen nt
    s_add_u32 s13, s80, 4294164480
    buffer_load_dwordx4 v[212:215], v72, s[52:55], s13 offen nt
    s_lshl_b32 s96, s90, 7
    s_add_u32 s97, s96, s80
    s_add_u32 s13, s97, 114688
    buffer_load_dwordx4 v[216:219], v72, s[56:59], s13 offen nt
    s_lshl_b32 s96, s90, 7
    s_add_u32 s97, s96, s80
    s_add_u32 s13, s97, 4294164480
    buffer_load_dwordx4 v[220:223], v72, s[56:59], s13 offen nt
L_JOIN:
    s_lshl_b32 s13, s3, 12
    v_add_u32 v20, s13, v63
    s_lshl_b32 s96, s76, 13
    s_add_u32 s13, s96, 32768
    v_add_u32 v21, s13, v63
    s_lshl3_add_u32 s96, s11, s3
    s_lshl_b32 s97, s96, 5
    s_add_u32 s98, s97, s10
    s_lshl_b32 s99, s98, 10
    s_add_u32 s13, s99, 25165824
    s_add_u32 s15, s13, 16384
    s_lshl3_add_u32 s96, s11, s3
    s_lshl_b32 s97, s96, 10
    s_add_u32 s16, s97, 21495808
    s_lshl_b32 s96, s10, 6
    s_add_u32 s14, s96, s16
    v_cvt_pk_bf16_f32 v112, 0, v112
    v_cvt_pk_bf16_f32 v113, 0, v113
    v_cvt_pk_bf16_f32 v114, 0, v114
    v_cvt_pk_bf16_f32 v115, 0, v115
    v_cvt_pk_bf16_f32 v116, 0, v116
    v_cvt_pk_bf16_f32 v117, 0, v117
    v_cvt_pk_bf16_f32 v118, 0, v118
    v_cvt_pk_bf16_f32 v119, 0, v119
    v_cvt_pk_bf16_f32 v120, 0, v120
    v_cvt_pk_bf16_f32 v121, 0, v121
    v_cvt_pk_bf16_f32 v122, 0, v122
    v_cvt_pk_bf16_f32 v123, 0, v123
    v_cvt_pk_bf16_f32 v124, 0, v124
    v_cvt_pk_bf16_f32 v125, 0, v125
    v_cvt_pk_bf16_f32 v126, 0, v126
    v_cvt_pk_bf16_f32 v127, 0, v127
    v_max3_f32 v4, v112, v113, v114
    v_min3_f32 v5, v112, v113, v114
    v_max3_f32 v4, v4, v115, v116
    v_min3_f32 v5, v5, v115, v116
    v_max3_f32 v4, v4, v117, v118
    v_min3_f32 v5, v5, v117, v118
    v_max3_f32 v4, v4, v119, v120
    v_min3_f32 v5, v5, v119, v120
    v_max3_f32 v4, v4, v121, v122
    v_min3_f32 v5, v5, v121, v122
    v_max3_f32 v4, v4, v123, v124
    v_min3_f32 v5, v5, v123, v124
    v_max3_f32 v4, v4, v125, v126
    v_min3_f32 v5, v5, v125, v126
    v_max_f32 v6, v4, v127
    v_min_f32 v7, v5, v127
    v_max_f32 v4, v4, v127
    v_min_f32 v5, v5, v127
    s_nop 0
    v_permlane32_swap_b32 v4, v6
    v_permlane32_swap_b32 v5, v7
    v_max_f32 v4, v4, v6
    v_min_f32 v5, v5, v7
    v_pk_mul_f32 v[4:5], v[4:5], s[6:7] op_sel:[0,1]
    v_pk_fma_f32 v[128:129], v[112:113], s[6:7], v[4:5] op_sel:[0,1,0] op_sel_hi:[1,1,0] neg_lo:[0,0,1] neg_hi:[0,0,1]
    v_pk_fma_f32 v[112:113], v[112:113], s[6:7], v[4:5] op_sel:[0,1,1] neg_lo:[1,0,0] neg_hi:[1,0,0]
    v_pk_fma_f32 v[130:131], v[114:115], s[6:7], v[4:5] op_sel:[0,1,0] op_sel_hi:[1,1,0] neg_lo:[0,0,1] neg_hi:[0,0,1]
    v_pk_fma_f32 v[114:115], v[114:115], s[6:7], v[4:5] op_sel:[0,1,1] neg_lo:[1,0,0] neg_hi:[1,0,0]
    v_pk_fma_f32 v[132:133], v[116:117], s[6:7], v[4:5] op_sel:[0,1,0] op_sel_hi:[1,1,0] neg_lo:[0,0,1] neg_hi:[0,0,1]
    v_pk_fma_f32 v[116:117], v[116:117], s[6:7], v[4:5] op_sel:[0,1,1] neg_lo:[1,0,0] neg_hi:[1,0,0]
    v_pk_fma_f32 v[134:135], v[118:119], s[6:7], v[4:5] op_sel:[0,1,0] op_sel_hi:[1,1,0] neg_lo:[0,0,1] neg_hi:[0,0,1]
    v_pk_fma_f32 v[118:119], v[118:119], s[6:7], v[4:5] op_sel:[0,1,1] neg_lo:[1,0,0] neg_hi:[1,0,0]
    v_pk_fma_f32 v[136:137], v[120:121], s[6:7], v[4:5] op_sel:[0,1,0] op_sel_hi:[1,1,0] neg_lo:[0,0,1] neg_hi:[0,0,1]
    v_pk_fma_f32 v[120:121], v[120:121], s[6:7], v[4:5] op_sel:[0,1,1] neg_lo:[1,0,0] neg_hi:[1,0,0]
    v_pk_fma_f32 v[138:139], v[122:123], s[6:7], v[4:5] op_sel:[0,1,0] op_sel_hi:[1,1,0] neg_lo:[0,0,1] neg_hi:[0,0,1]
    v_pk_fma_f32 v[122:123], v[122:123], s[6:7], v[4:5] op_sel:[0,1,1] neg_lo:[1,0,0] neg_hi:[1,0,0]
    v_pk_fma_f32 v[140:141], v[124:125], s[6:7], v[4:5] op_sel:[0,1,0] op_sel_hi:[1,1,0] neg_lo:[0,0,1] neg_hi:[0,0,1]
    v_pk_fma_f32 v[124:125], v[124:125], s[6:7], v[4:5] op_sel:[0,1,1] neg_lo:[1,0,0] neg_hi:[1,0,0]
    v_pk_fma_f32 v[142:143], v[126:127], s[6:7], v[4:5] op_sel:[0,1,0] op_sel_hi:[1,1,0] neg_lo:[0,0,1] neg_hi:[0,0,1]
    v_pk_fma_f32 v[126:127], v[126:127], s[6:7], v[4:5] op_sel:[0,1,1] neg_lo:[1,0,0] neg_hi:[1,0,0]
    v_exp_f32 v128, v128
    v_exp_f32 v112, v112
    v_exp_f32 v129, v129
    v_exp_f32 v113, v113
    v_exp_f32 v130, v130
    v_exp_f32 v114, v114
    v_exp_f32 v131, v131
    v_exp_f32 v115, v115
    v_exp_f32 v132, v132
    v_exp_f32 v116, v116
    v_exp_f32 v133, v133
    v_exp_f32 v117, v117
    v_exp_f32 v134, v134
    v_exp_f32 v118, v118
    v_exp_f32 v135, v135
    v_exp_f32 v119, v119
    v_exp_f32 v136, v136
    v_exp_f32 v120, v120
    v_exp_f32 v137, v137
    v_exp_f32 v121, v121
    v_exp_f32 v138, v138
    v_exp_f32 v122, v122
    v_exp_f32 v139, v139
    v_exp_f32 v123, v123
    v_exp_f32 v140, v140
    v_exp_f32 v124, v124
    v_exp_f32 v141, v141
    v_exp_f32 v125, v125
    v_exp_f32 v142, v142
    v_exp_f32 v126, v126
    v_exp_f32 v143, v143
    v_exp_f32 v127, v127
    v_pk_add_f32 v[8:9], v[128:129], v[130:131]
    v_pk_add_f32 v[10:11], v[112:113], v[114:115]
    v_pk_add_f32 v[8:9], v[8:9], v[132:133]
    v_pk_add_f32 v[10:11], v[10:11], v[116:117]
    v_pk_add_f32 v[8:9], v[8:9], v[134:135]
    v_pk_add_f32 v[10:11], v[10:11], v[118:119]
    v_pk_add_f32 v[8:9], v[8:9], v[136:137]
    v_pk_add_f32 v[10:11], v[10:11], v[120:121]
    v_pk_add_f32 v[8:9], v[8:9], v[138:139]
    v_pk_add_f32 v[10:11], v[10:11], v[122:123]
    v_pk_add_f32 v[8:9], v[8:9], v[140:141]
    v_pk_add_f32 v[10:11], v[10:11], v[124:125]
    v_pk_add_f32 v[8:9], v[8:9], v[142:143]
    v_pk_add_f32 v[10:11], v[10:11], v[126:127]
    v_add_f32 v6, v8, v9
    v_add_f32 v7, v10, v11
    v_add_f32 v4, v8, v9
    v_add_f32 v5, v10, v11
    s_nop 0
    v_permlane32_swap_b32 v4, v6
    v_permlane32_swap_b32 v5, v7
    v_pk_add_f32 v[4:5], v[4:5], v[6:7]
    v_rcp_f32 v4, v4
    v_rcp_f32 v5, v5
    s_nop 0
    v_pk_mul_f32 v[128:129], v[128:129], v[4:5] op_sel_hi:[1,0]
    v_pk_mul_f32 v[130:131], v[130:131], v[4:5] op_sel_hi:[1,0]
    v_pk_mul_f32 v[132:133], v[132:133], v[4:5] op_sel_hi:[1,0]
    v_pk_mul_f32 v[134:135], v[134:135], v[4:5] op_sel_hi:[1,0]
    v_cvt_pk_bf16_f32 v80, v128, v129
    v_cvt_pk_bf16_f32 v81, v130, v131
    v_cvt_pk_bf16_f32 v82, v132, v133
    v_cvt_pk_bf16_f32 v83, v134, v135
    ds_write_b128 v75, v[80:83]
    v_pk_mul_f32 v[136:137], v[136:137], v[4:5] op_sel_hi:[1,0]
    v_pk_mul_f32 v[138:139], v[138:139], v[4:5] op_sel_hi:[1,0]
    v_pk_mul_f32 v[140:141], v[140:141], v[4:5] op_sel_hi:[1,0]
    v_pk_mul_f32 v[142:143], v[142:143], v[4:5] op_sel_hi:[1,0]
    v_cvt_pk_bf16_f32 v84, v136, v137
    v_cvt_pk_bf16_f32 v85, v138, v139
    v_cvt_pk_bf16_f32 v86, v140, v141
    v_cvt_pk_bf16_f32 v87, v142, v143
    ds_write_b128 v75, v[84:87] offset:4096
    v_pk_mul_f32 v[112:113], v[112:113], v[4:5] op_sel:[0,1]
    v_pk_mul_f32 v[114:115], v[114:115], v[4:5] op_sel:[0,1]
    v_pk_mul_f32 v[116:117], v[116:117], v[4:5] op_sel:[0,1]
    v_pk_mul_f32 v[118:119], v[118:119], v[4:5] op_sel:[0,1]
    v_cvt_pk_bf16_f32 v88, v112, v113
    v_cvt_pk_bf16_f32 v89, v114, v115
    v_cvt_pk_bf16_f32 v90, v116, v117
    v_cvt_pk_bf16_f32 v91, v118, v119
    ds_write_b128 v75, v[88:91] offset:8192
    v_pk_mul_f32 v[120:121], v[120:121], v[4:5] op_sel:[0,1]
    v_pk_mul_f32 v[122:123], v[122:123], v[4:5] op_sel:[0,1]
    v_pk_mul_f32 v[124:125], v[124:125], v[4:5] op_sel:[0,1]
    v_pk_mul_f32 v[126:127], v[126:127], v[4:5] op_sel:[0,1]
    v_cvt_pk_bf16_f32 v92, v120, v121
    v_cvt_pk_bf16_f32 v93, v122, v123
    v_cvt_pk_bf16_f32 v94, v124, v125
    v_cvt_pk_bf16_f32 v95, v126, v127
    ds_write_b128 v75, v[92:95] offset:12288
    v_mov_b32 v36, 0x3f803f80
    v_mov_b32 v37, 0x3f803f80
    v_mov_b32 v38, 0x3f803f80
    v_mov_b32 v39, 0x3f803f80
    s_waitcnt lgkmcnt(0)
    s_barrier
    ds_read_b64_tr_b16 v[128:129], v20
    ds_read_b64_tr_b16 v[130:131], v20 offset:512
    ds_read_b64_tr_b16 v[144:145], v21
    ds_read_b64_tr_b16 v[146:147], v21 offset:512
    ds_read_b64_tr_b16 v[148:149], v21 offset:4096
    ds_read_b64_tr_b16 v[150:151], v21 offset:4608
    ds_read_b64_tr_b16 v[132:133], v20 offset:1024
    ds_read_b64_tr_b16 v[134:135], v20 offset:1536
    ds_read_b64_tr_b16 v[152:153], v21 offset:1024
    ds_read_b64_tr_b16 v[154:155], v21 offset:1536
    ds_read_b64_tr_b16 v[156:157], v21 offset:5120
    ds_read_b64_tr_b16 v[158:159], v21 offset:5632
    ds_read_b64_tr_b16 v[136:137], v20 offset:2048
    ds_read_b64_tr_b16 v[138:139], v20 offset:2560
    ds_read_b64_tr_b16 v[160:161], v21 offset:2048
    ds_read_b64_tr_b16 v[162:163], v21 offset:2560
    ds_read_b64_tr_b16 v[164:165], v21 offset:6144
    ds_read_b64_tr_b16 v[166:167], v21 offset:6656
    s_waitcnt lgkmcnt(12)
    v_mfma_f32_16x16x32_bf16 v[52:55], v[128:131], v[144:147], 0
    v_mfma_f32_16x16x32_bf16 v[56:59], v[128:131], v[148:151], 0
    v_mfma_f32_16x16x32_bf16 v[40:43], v[128:131], v[36:39], 0
    ds_read_b64_tr_b16 v[140:141], v20 offset:3072
    ds_read_b64_tr_b16 v[142:143], v20 offset:3584
    ds_read_b64_tr_b16 v[168:169], v21 offset:3072
    ds_read_b64_tr_b16 v[170:171], v21 offset:3584
    ds_read_b64_tr_b16 v[172:173], v21 offset:7168
    ds_read_b64_tr_b16 v[174:175], v21 offset:7680
    s_waitcnt lgkmcnt(12)
    v_mfma_f32_16x16x32_bf16 v[52:55], v[132:135], v[152:155], v[52:55]
    v_mfma_f32_16x16x32_bf16 v[56:59], v[132:135], v[156:159], v[56:59]
    v_mfma_f32_16x16x32_bf16 v[40:43], v[132:135], v[36:39], v[40:43]
    v_and_b32 v75, 15, v1
    v_lshlrev_b32 v75, 15, v75
    s_and_b32 s96, s10, 1
    s_and_b32 s97, s2, 135
    s_lshl_b32 s98, s97, 12
    s_lshr_b32 s99, s10, 1
    s_lshl_b32 s97, s99, 6
    s_add_u32 s99, s98, s97
    s_lshl2_add_u32 s98, s96, s99
    s_add_u32 s97, s98, 1048576
    s_add_u32 s17, s97, 512
    s_waitcnt lgkmcnt(6)
    v_mfma_f32_16x16x32_bf16 v[52:55], v[136:139], v[160:163], v[52:55]
    v_mfma_f32_16x16x32_bf16 v[56:59], v[136:139], v[164:167], v[56:59]
    v_mfma_f32_16x16x32_bf16 v[40:43], v[136:139], v[36:39], v[40:43]
    s_waitcnt lgkmcnt(0)
    v_mfma_f32_16x16x32_bf16 v[52:55], v[140:143], v[168:171], v[52:55]
    v_mfma_f32_16x16x32_bf16 v[56:59], v[140:143], v[172:175], v[56:59]
    v_mfma_f32_16x16x32_bf16 v[40:43], v[140:143], v[36:39], v[40:43]
    s_cmp_lt_u32 s3, 4
    s_cbranch_scc1 L_NOQX
    ds_read_b128 v[44:47], v76 offset:2048
    ds_read_b128 v[48:51], v76 offset:3072
L_NOQX:
    s_nop 3
    buffer_store_dwordx4 v[52:55], v2, s[32:35], s13 offen sc1
    buffer_store_dwordx4 v[56:59], v2, s[32:35], s15 offen sc1
    v_lshlrev_b32 v4, 6, v1
    ds_bpermute_b32 v40, v4, v40
    ds_bpermute_b32 v41, v4, v41
    ds_bpermute_b32 v42, v4, v42
    ds_bpermute_b32 v43, v4, v43
    s_waitcnt lgkmcnt(0)
    s_mov_b64 exec, 15
    buffer_store_dwordx4 v[40:43], v2, s[32:35], s14 offen sc1
    s_mov_b64 exec, -1
    s_waitcnt lgkmcnt(0)
    v_mfma_f32_32x32x16_bf16 v[112:127], v[28:31], v[44:47], 0
    v_mfma_f32_32x32x16_bf16 v[112:127], v[32:35], v[48:51], v[112:127]
    v_lshrrev_b32 v22, 3, v1
    v_lshlrev_b32 v22, 10, v22
    v_and_b32 v9, 7, v1
    v_lshl_add_u32 v22, v9, 4, v22
    s_nop 7
    v_cvt_pk_bf16_f32 v112, 0, v112
    v_cvt_pk_bf16_f32 v113, 0, v113
    v_cvt_pk_bf16_f32 v114, 0, v114
    v_cvt_pk_bf16_f32 v115, 0, v115
    v_cvt_pk_bf16_f32 v116, 0, v116
    v_cvt_pk_bf16_f32 v117, 0, v117
    v_cvt_pk_bf16_f32 v118, 0, v118
    v_cvt_pk_bf16_f32 v119, 0, v119
    v_cvt_pk_bf16_f32 v120, 0, v120
    v_cvt_pk_bf16_f32 v121, 0, v121
    v_cvt_pk_bf16_f32 v122, 0, v122
    v_cvt_pk_bf16_f32 v123, 0, v123
    v_cvt_pk_bf16_f32 v124, 0, v124
    v_cvt_pk_bf16_f32 v125, 0, v125
    v_cvt_pk_bf16_f32 v126, 0, v126
    v_cvt_pk_bf16_f32 v127, 0, v127
    v_max3_f32 v52, v112, v113, v114
    v_min3_f32 v53, v112, v113, v114
    v_max3_f32 v52, v52, v115, v116
    v_min3_f32 v53, v53, v115, v116
    v_max3_f32 v52, v52, v117, v118
    v_min3_f32 v53, v53, v117, v118
    v_max3_f32 v52, v52, v119, v120
    v_min3_f32 v53, v53, v119, v120
    v_max3_f32 v52, v52, v121, v122
    v_min3_f32 v53, v53, v121, v122
    v_max3_f32 v52, v52, v123, v124
    v_min3_f32 v53, v53, v123, v124
    v_max3_f32 v52, v52, v125, v126
    v_min3_f32 v53, v53, v125, v126
    v_max_f32 v54, v52, v127
    v_min_f32 v55, v53, v127
    v_max_f32 v52, v52, v127
    v_min_f32 v53, v53, v127
    s_nop 0
    v_permlane32_swap_b32 v52, v54
    v_permlane32_swap_b32 v53, v55
    v_max_f32 v52, v52, v54
    v_min_f32 v53, v53, v55
    v_pk_mul_f32 v[52:53], v[52:53], s[6:7] op_sel:[0,1]
    v_pk_fma_f32 v[128:129], v[112:113], s[6:7], v[52:53] op_sel:[0,1,0] op_sel_hi:[1,1,0] neg_lo:[0,0,1] neg_hi:[0,0,1]
    v_pk_fma_f32 v[112:113], v[112:113], s[6:7], v[52:53] op_sel:[0,1,1] neg_lo:[1,0,0] neg_hi:[1,0,0]
    v_pk_fma_f32 v[130:131], v[114:115], s[6:7], v[52:53] op_sel:[0,1,0] op_sel_hi:[1,1,0] neg_lo:[0,0,1] neg_hi:[0,0,1]
    v_pk_fma_f32 v[114:115], v[114:115], s[6:7], v[52:53] op_sel:[0,1,1] neg_lo:[1,0,0] neg_hi:[1,0,0]
    v_pk_fma_f32 v[132:133], v[116:117], s[6:7], v[52:53] op_sel:[0,1,0] op_sel_hi:[1,1,0] neg_lo:[0,0,1] neg_hi:[0,0,1]
    v_pk_fma_f32 v[116:117], v[116:117], s[6:7], v[52:53] op_sel:[0,1,1] neg_lo:[1,0,0] neg_hi:[1,0,0]
    v_pk_fma_f32 v[134:135], v[118:119], s[6:7], v[52:53] op_sel:[0,1,0] op_sel_hi:[1,1,0] neg_lo:[0,0,1] neg_hi:[0,0,1]
    v_pk_fma_f32 v[118:119], v[118:119], s[6:7], v[52:53] op_sel:[0,1,1] neg_lo:[1,0,0] neg_hi:[1,0,0]
    v_pk_fma_f32 v[136:137], v[120:121], s[6:7], v[52:53] op_sel:[0,1,0] op_sel_hi:[1,1,0] neg_lo:[0,0,1] neg_hi:[0,0,1]
    v_pk_fma_f32 v[120:121], v[120:121], s[6:7], v[52:53] op_sel:[0,1,1] neg_lo:[1,0,0] neg_hi:[1,0,0]
    v_pk_fma_f32 v[138:139], v[122:123], s[6:7], v[52:53] op_sel:[0,1,0] op_sel_hi:[1,1,0] neg_lo:[0,0,1] neg_hi:[0,0,1]
    v_pk_fma_f32 v[122:123], v[122:123], s[6:7], v[52:53] op_sel:[0,1,1] neg_lo:[1,0,0] neg_hi:[1,0,0]
    v_pk_fma_f32 v[140:141], v[124:125], s[6:7], v[52:53] op_sel:[0,1,0] op_sel_hi:[1,1,0] neg_lo:[0,0,1] neg_hi:[0,0,1]
    v_pk_fma_f32 v[124:125], v[124:125], s[6:7], v[52:53] op_sel:[0,1,1] neg_lo:[1,0,0] neg_hi:[1,0,0]
    v_pk_fma_f32 v[142:143], v[126:127], s[6:7], v[52:53] op_sel:[0,1,0] op_sel_hi:[1,1,0] neg_lo:[0,0,1] neg_hi:[0,0,1]
    v_pk_fma_f32 v[126:127], v[126:127], s[6:7], v[52:53] op_sel:[0,1,1] neg_lo:[1,0,0] neg_hi:[1,0,0]
    v_exp_f32 v128, v128
    v_exp_f32 v112, v112
    v_exp_f32 v129, v129
    s_lshl_b32 s96, s11, 7
    s_add_u32 s18, s96, 32768
    s_lshl3_add_u32 s14, s10, s18
    v_and_b32 v23, 15, v1
    v_lshlrev_b32 v23, 3, v23
    s_waitcnt vmcnt(0)
    s_barrier
    s_cmp_lg_u32 s3, 0
    s_cbranch_scc1 L_PC
    v_mov_b32 v21, s4
    s_mov_b32 exec_hi, 0
    s_mov_b32 exec_lo, 65535
    buffer_store_dword v21, v75, s[32:35], s17 offen sc1
    s_mov_b64 exec, -1
L_PC:
    s_cmp_lt_u32 s3, 4
    s_cbranch_scc1 L_NOM
    v_and_b32 v105, 31, v1
    v_lshlrev_b32 v105, 4, v105
    v_lshrrev_b32 v9, 5, v1
    v_lshl_add_u32 v105, v9, 9, v105
    s_and_b32 s96, s3, 3
    s_lshl4_add_u32 s97, s96, s12
    s_lshl_b32 s98, s97, 11
    s_add_u32 s20, s98, 131072
    buffer_load_dwordx4 v[96:99], v105, s[32:35], s20 offen sc1
    buffer_load_dwordx4 v[100:103], v105, s[32:35], s20 offen offset:1024 sc1
L_NOM:
    s_lshl4_add_u32 s96, s11, s10
    s_lshl_b32 s97, s96, 14
    s_lshl_b32 s98, s3, 7
    s_add_u32 s99, s97, s98
    s_add_u32 s13, s99, 25165824
    s_lshl4_add_u32 s96, s11, s10
    s_lshl_b32 s97, s96, 10
    s_lshl_b32 s98, s3, 7
    s_add_u32 s99, s97, s98
    s_add_u32 s15, s99, 29360128
    s_add_u32 s17, s17, 3072
    s_load_dwordx2 s[24:25], s[32:33], s92 offset:512 glc
    s_add_u32 s96, s84, 262144
    s_and_b32 s97, s96, 1048575
    s_lshl_b32 s98, s83, 16
    s_xor_b32 s99, s97, s98
    s_add_u32 s19, s99, s88
    s_add_u32 m0, s89, 49152
    s_nop 0
    buffer_load_dwordx4 v74, s[44:47], s19 offen lds
    v_exp_f32 v113, v113
    v_exp_f32 v130, v130
    v_exp_f32 v114, v114
    v_exp_f32 v131, v131
    v_exp_f32 v115, v115
    v_exp_f32 v132, v132
    v_exp_f32 v116, v116
    v_exp_f32 v133, v133
    v_exp_f32 v117, v117
    v_exp_f32 v134, v134
    s_add_u32 s96, s84, 393216
    s_and_b32 s97, s96, 1048575
    s_lshl_b32 s98, s83, 16
    s_xor_b32 s99, s97, s98
    s_add_u32 s19, s99, s88
    s_add_u32 m0, s89, 57344
    s_nop 0
    buffer_load_dwordx4 v74, s[44:47], s19 offen lds
    v_exp_f32 v118, v118
    v_exp_f32 v135, v135
    v_exp_f32 v119, v119
    v_exp_f32 v136, v136
    v_exp_f32 v120, v120
    v_exp_f32 v137, v137
    v_exp_f32 v121, v121
    v_exp_f32 v138, v138
    v_exp_f32 v122, v122
    s_add_u32 s96, s84, 524288
    s_and_b32 s97, s96, 1048575
    s_lshl_b32 s98, s83, 16
    s_xor_b32 s99, s97, s98
    s_add_u32 s19, s99, s88
    s_add_u32 m0, s89, 65536
    s_nop 0
    buffer_load_dwordx4 v74, s[44:47], s19 offen lds
    v_exp_f32 v139, v139
    v_exp_f32 v123, v123
    v_exp_f32 v140, v140
    v_exp_f32 v124, v124
    v_exp_f32 v141, v141
    v_exp_f32 v125, v125
    v_exp_f32 v142, v142
    v_exp_f32 v126, v126
    v_exp_f32 v143, v143
    v_exp_f32 v127, v127
    s_add_u32 s96, s84, 655360
    s_and_b32 s97, s96, 1048575
    s_lshl_b32 s98, s83, 16
    s_xor_b32 s99, s97, s98
    s_add_u32 s19, s99, s88
    s_add_u32 m0, s89, 73728
    s_nop 0
    buffer_load_dwordx4 v74, s[44:47], s19 offen lds
    v_pk_add_f32 v[56:57], v[128:129], v[130:131]
    v_pk_add_f32 v[58:59], v[112:113], v[114:115]
    v_pk_add_f32 v[56:57], v[56:57], v[132:133]
    v_pk_add_f32 v[58:59], v[58:59], v[116:117]
    v_pk_add_f32 v[56:57], v[56:57], v[134:135]
    v_pk_add_f32 v[58:59], v[58:59], v[118:119]
    v_pk_add_f32 v[56:57], v[56:57], v[136:137]
    v_pk_add_f32 v[58:59], v[58:59], v[120:121]
    v_pk_add_f32 v[56:57], v[56:57], v[138:139]
    s_add_u32 s96, s84, 786432
    s_and_b32 s97, s96, 1048575
    s_lshl_b32 s98, s83, 16
    s_xor_b32 s99, s97, s98
    s_add_u32 s19, s99, s88
    s_add_u32 m0, s89, 81920
    s_nop 0
    buffer_load_dwordx4 v74, s[44:47], s19 offen lds
    v_pk_add_f32 v[58:59], v[58:59], v[122:123]
    v_pk_add_f32 v[56:57], v[56:57], v[140:141]
    v_pk_add_f32 v[58:59], v[58:59], v[124:125]
    v_pk_add_f32 v[56:57], v[56:57], v[142:143]
    v_pk_add_f32 v[58:59], v[58:59], v[126:127]
    v_add_f32 v54, v56, v57
    v_add_f32 v55, v58, v59
    v_add_f32 v52, v56, v57
    v_add_f32 v53, v58, v59
    s_nop 0
    v_permlane32_swap_b32 v52, v54
    s_add_u32 s96, s84, 917504
    s_and_b32 s97, s96, 1048575
    s_lshl_b32 s98, s83, 16
    s_xor_b32 s99, s97, s98
    s_add_u32 s19, s99, s88
    s_add_u32 m0, s89, 90112
    s_nop 0
    buffer_load_dwordx4 v74, s[44:47], s19 offen lds
    v_permlane32_swap_b32 v53, v55
    v_pk_add_f32 v[52:53], v[52:53], v[54:55]
    v_rcp_f32 v52, v52
    v_rcp_f32 v53, v53
    s_nop 0
    v_pk_mul_f32 v[128:129], v[128:129], v[52:53] op_sel_hi:[1,0]
    v_pk_mul_f32 v[130:131], v[130:131], v[52:53] op_sel_hi:[1,0]
    v_pk_mul_f32 v[132:133], v[132:133], v[52:53] op_sel_hi:[1,0]
    v_pk_mul_f32 v[134:135], v[134:135], v[52:53] op_sel_hi:[1,0]
    v_cvt_pk_bf16_f32 v80, v128, v129
    s_cmp_lt_u32 s3, 4
    s_cbranch_scc1 L_NOG
    s_waitcnt vmcnt(6)
    v_bitop3_b32 v4, v97, v99, s4 bitop3:0x7e
    v_bitop3_b32 v4, v4, v101, s4 bitop3:0xf6
    v_bitop3_b32 v4, v4, v103, s4 bitop3:0xf6
    v_cmp_ne_u32 vcc, 0, v4
    s_cbranch_vccz TOK_17
POLL_18:
    buffer_load_dwordx4 v[96:99], v105, s[32:35], s20 offen sc1
    buffer_load_dwordx4 v[100:103], v105, s[32:35], s20 offen offset:1024 sc1
    s_waitcnt vmcnt(0)
    v_bitop3_b32 v4, v97, v99, s4 bitop3:0x7e
    v_bitop3_b32 v4, v4, v101, s4 bitop3:0xf6
    v_bitop3_b32 v4, v4, v103, s4 bitop3:0xf6
    v_cmp_ne_u32 vcc, 0, v4
    s_cbranch_vccz PDONE_19
    s_add_u32 s5, s5, 1
    s_cmp_lt_u32 s5, 300000
    s_cbranch_scc1 POLL_18
PDONE_19:
TOK_17:
    s_and_b32 s96, s3, 3
    s_lshl_b32 s97, s96, 7
    s_add_u32 s14, s97, 12288
    v_and_b32 v4, 31, v1
    v_lshl_add_u32 v4, v4, 2, s14
    s_and_b32 s82, s3, 3
    v_add_f32 v96, v96, v100
    v_add_f32 v97, v98, v102
    v_mov_b32 v98, v96
    v_mov_b32 v99, v97
    s_cmp_eq_u32 s82, 2
    s_cselect_b32 s91, 1.0, 0
    v_permlane32_swap_b32 v96, v98
    v_permlane32_swap_b32 v97, v99
    v_pk_add_f32 v[96:97], v[96:97], v[98:99]
    v_cvt_pk_bf16_f32 v96, 0, v96
    v_cvt_pk_bf16_f32 v97, 0, v97
    v_add_f32 v96, s91, v96
    v_add_f32 v97, s91, v97
    v_cvt_pk_bf16_f32 v98, v96, v97
    ds_write_b32 v4, v98
    s_cbranch_scc0 L_NOG
    v_lshlrev_b32 v96, 16, v98
    v_and_b32 v97, s6, v98
    v_lshlrev_b32 v100, 16, v104
    v_and_b32 v101, s6, v104
    v_pk_mul_f32 v[100:101], v[100:101], v[96:97]
    v_cvt_pk_bf16_f32 v102, v100, v101
    v_lshlrev_b32 v96, 16, v102
    v_and_b32 v97, s6, v102
    v_pk_add_f32 v[96:97], v[100:101], v[96:97] neg_lo:[0,1] neg_hi:[0,1]
    v_cvt_pk_bf16_f32 v103, v96, v97
    v_add_f32 v96, v100, v101
    ds_write2_b32 v4, v102, v103 offset0:64 offset1:96
    ds_write_b32 v4, v104 offset:512
    v_add_f32_dpp v96, v96, v96 quad_perm:[1,0,3,2] row_mask:0xf bank_mask:0xf
    s_nop 1
    v_add_f32_dpp v96, v96, v96 quad_perm:[2,3,0,1] row_mask:0xf bank_mask:0xf
    s_nop 1
    v_add_f32_dpp v96, v96, v96 row_half_mirror row_mask:0xf bank_mask:0xf
    s_nop 1
    v_add_f32_dpp v96, v96, v96 row_ror:8 row_mask:0xf bank_mask:0xf
    s_lshl4_add_u32 s96, s21, s12
    s_lshl_b32 s97, s96, 6
    s_add_u32 s14, s97, 65536
    v_mov_b32 v98, v96
    v_mov_b32 v97, s4
    s_nop 0
    v_permlane16_swap_b32 v96, v98
    v_add_f32 v96, v96, v98
    v_mov_b32 v99, s4
    s_mov_b64 exec, 15
    buffer_store_dwordx4 v[96:99], v2, s[32:35], s14 offen sc1
    s_mov_b64 exec, -1
L_NOG:
    s_branch SCHK_15
SPOLL_14:
    s_load_dwordx2 s[24:25], s[32:33], s92 offset:512 glc
SCHK_15:
    s_add_u32 s5, s5, 1
    s_cmp_ge_u32 s5, 300000
    s_waitcnt lgkmcnt(0)
    s_cbranch_scc1 SDONE_16
    s_cmp_lg_u32 s24, s4
    s_cbranch_scc1 SPOLL_14
    s_cmp_lg_u32 s25, s4
    s_cbranch_scc1 SPOLL_14
SDONE_16:
    s_barrier
    s_add_u32 s18, s13, 8192
    buffer_load_dword v24, v3, s[32:35], 0 offen offset:256 sc1
    buffer_load_dwordx4 v[144:147], v22, s[32:35], s13 offen sc1
    buffer_load_dwordx4 v[148:151], v22, s[32:35], s18 offen sc1
    buffer_load_dwordx4 v[160:163], v2, s[32:35], s16 offen sc1
    s_lshl_b32 s96, s3, 5
    s_add_u32 s14, s96, 8192
    v_and_b32 v6, 3, v1
    v_lshl_add_u32 v6, v6, 3, s14
    v_lshrrev_b32 v9, 5, v1
    v_lshl_add_u32 v6, v9, 2, v6
    s_lshl_b32 s14, s3, 10
    v_and_b32 v5, 15, v1
    v_lshl_add_u32 v5, v5, 4, s14
    v_lshrrev_b32 v9, 5, v1
    v_lshl_add_u32 v5, v9, 9, v5
    v_bfe_u32 v9, v1, 4, 1
    v_lshl_add_u32 v5, v9, 3, v5
    s_lshl_b32 s96, s76, 7
    s_add_u32 s14, s96, 8192
    v_lshrrev_b32 v7, 5, v1
    v_lshl_add_u32 v7, v7, 4, s14
    s_lshl_b32 s14, s76, 12
    v_add_u32 v20, s14, v2
    v_cvt_pk_bf16_f32 v81, v130, v131
    v_cvt_pk_bf16_f32 v82, v132, v133
    v_cvt_pk_bf16_f32 v83, v134, v135
    v_pk_mul_f32 v[136:137], v[136:137], v[52:53] op_sel_hi:[1,0]
    v_pk_mul_f32 v[138:139], v[138:139], v[52:53] op_sel_hi:[1,0]
    v_pk_mul_f32 v[140:141], v[140:141], v[52:53] op_sel_hi:[1,0]
    v_pk_mul_f32 v[142:143], v[142:143], v[52:53] op_sel_hi:[1,0]
    v_cvt_pk_bf16_f32 v84, v136, v137
    v_cvt_pk_bf16_f32 v85, v138, v139
    v_cvt_pk_bf16_f32 v86, v140, v141
    v_cvt_pk_bf16_f32 v87, v142, v143
    v_pk_mul_f32 v[112:113], v[112:113], v[52:53] op_sel:[0,1]
    v_pk_mul_f32 v[114:115], v[114:115], v[52:53] op_sel:[0,1]
    v_pk_mul_f32 v[116:117], v[116:117], v[52:53] op_sel:[0,1]
    v_pk_mul_f32 v[118:119], v[118:119], v[52:53] op_sel:[0,1]
    v_cvt_pk_bf16_f32 v88, v112, v113
    v_cvt_pk_bf16_f32 v89, v114, v115
    v_cvt_pk_bf16_f32 v90, v116, v117
    v_cvt_pk_bf16_f32 v91, v118, v119
    v_pk_mul_f32 v[120:121], v[120:121], v[52:53] op_sel:[0,1]
    v_pk_mul_f32 v[122:123], v[122:123], v[52:53] op_sel:[0,1]
    v_pk_mul_f32 v[124:125], v[124:125], v[52:53] op_sel:[0,1]
    v_pk_mul_f32 v[126:127], v[126:127], v[52:53] op_sel:[0,1]
    v_cvt_pk_bf16_f32 v92, v120, v121
    v_cvt_pk_bf16_f32 v93, v122, v123
    v_cvt_pk_bf16_f32 v94, v124, v125
    v_cvt_pk_bf16_f32 v95, v126, v127
    s_waitcnt vmcnt(1)
    v_cmp_eq_u32 vcc, s4, v24
    s_nop 0
    s_cmp_eq_u32 vcc_lo, 0
    s_cselect_b32 s93, 1, 0
    v_pk_add_f32 v[144:145], v[144:145], v[148:149]
    v_pk_add_f32 v[146:147], v[146:147], v[150:151]
    s_nop 1
    v_permlane32_swap_b32 v144, v146
    v_permlane32_swap_b32 v145, v147
    v_pk_add_f32 v[144:145], v[144:145], v[146:147]
    s_nop 1
    v_add_f32_dpp v144, v144, v144 row_ror:8 row_mask:0xf bank_mask:0xf
    v_add_f32_dpp v145, v145, v145 row_ror:8 row_mask:0xf bank_mask:0xf
    v_mov_b32 v146, v144
    v_mov_b32 v147, v145
    s_nop 0
    v_permlane16_swap_b32 v144, v146
    v_permlane16_swap_b32 v145, v147
    v_pk_add_f32 v[144:145], v[144:145], v[146:147]
    v_cvt_pk_bf16_f32 v144, v144, v145
    v_mov_b32 v224, v144
    v_mov_b32 v226, v144
    v_mov_b32 v225, s4
    v_mov_b32 v227, s4
    v_permlane32_swap_b32 v224, v226
    v_add_u32 v228, s15, v2
    s_mov_b64 exec, 0xff
    s_cmp_lg_u32 s93, 0
    s_cbranch_scc1 LOC_20
    buffer_store_dwordx4 v[224:227], v2, s[32:35], s15 offen sc1
    s_branch LOCD_21
LOC_20:
    buffer_store_dwordx4 v[224:227], v2, s[32:35], s15 offen
LOCD_21:
    s_mov_b64 exec, -1
    s_cbranch_scc1 L_PC2
    s_barrier
    s_cmp_lg_u32 s3, 0
    s_cbranch_scc1 L_PC2
    v_mov_b32 v21, s4
    s_mov_b32 exec_hi, 0
    s_mov_b32 exec_lo, 65535
    buffer_store_dword v21, v75, s[32:35], s17 offen sc1
    s_mov_b64 exec, -1
L_PC2:
    s_lshl3_add_u32 s96, s11, s3
    s_lshl_b32 s97, s96, 11
    s_add_u32 s13, s97, 29360128
    s_waitcnt vmcnt(0)
    v_permlane32_swap_b32 v160, v162
    v_permlane32_swap_b32 v161, v163
    v_pk_add_f32 v[160:161], v[160:161], v[162:163]
    s_nop 1
    v_add_f32_dpp v160, v160, v160 row_ror:4 row_mask:0xf bank_mask:0xf
    v_add_f32_dpp v161, v161, v161 row_ror:4 row_mask:0xf bank_mask:0xf
    s_nop 0
    v_add_f32_dpp v160, v160, v160 row_ror:8 row_mask:0xf bank_mask:0xf
    v_add_f32_dpp v161, v161, v161 row_ror:8 row_mask:0xf bank_mask:0xf
    v_mov_b32 v162, v160
    v_mov_b32 v163, v161
    s_nop 0
    v_permlane16_swap_b32 v160, v162
    v_permlane16_swap_b32 v161, v163
    v_pk_add_f32 v[160:161], v[160:161], v[162:163]
    v_cvt_pk_bf16_f32 v160, v160, v161
    ds_write_b32 v6, v160
    s_cmp_lg_u32 s93, 0
    s_cbranch_scc1 L_C2L
SPOLL_22:
    s_load_dwordx2 s[24:25], s[32:33], s92 offset:3584 glc
SCHK_23:
    s_add_u32 s5, s5, 1
    s_cmp_ge_u32 s5, 300000
    s_waitcnt lgkmcnt(0)
    s_cbranch_scc1 SDONE_24
    s_cmp_lg_u32 s24, s4
    s_cbranch_scc1 SPOLL_22
    s_cmp_lg_u32 s25, s4
    s_cbranch_scc1 SPOLL_22
SDONE_24:
L_C2L:
    buffer_load_dwordx4 v[152:155], v2, s[32:35], s13 offen sc1
    buffer_load_dwordx4 v[156:159], v2, s[32:35], s13 offen offset:1024 sc1
    s_waitcnt vmcnt(0)
    v_bitop3_b32 v4, v153, v155, s4 bitop3:0x7e
    v_bitop3_b32 v4, v4, v157, s4 bitop3:0xf6
    v_bitop3_b32 v4, v4, v159, s4 bitop3:0xf6
    v_cmp_ne_u32 vcc, 0, v4
    s_cbranch_vccz TOK_26
POLL_27:
    buffer_load_dwordx4 v[152:155], v2, s[32:35], s13 offen sc1
    buffer_load_dwordx4 v[156:159], v2, s[32:35], s13 offen offset:1024 sc1
    s_waitcnt vmcnt(0)
    v_bitop3_b32 v4, v153, v155, s4 bitop3:0x7e
    v_bitop3_b32 v4, v4, v157, s4 bitop3:0xf6
    v_bitop3_b32 v4, v4, v159, s4 bitop3:0xf6
    v_cmp_ne_u32 vcc, 0, v4
    s_cbranch_vccz PDONE_28
    s_add_u32 s5, s5, 1
    s_cmp_lt_u32 s5, 300000
    s_cbranch_scc1 POLL_27
PDONE_28:
TOK_26:
    ds_write2_b32 v5, v152, v154 offset0:0 offset1:1
    ds_write2_b32 v5, v156, v158 offset0:64 offset1:65
    s_waitcnt lgkmcnt(0)
    s_barrier
    ds_read_b128 v[160:163], v7
    ds_read_b128 v[164:167], v7 offset:32
    ds_read_b128 v[168:171], v7 offset:64
    ds_read_b128 v[172:175], v7 offset:96
    ds_read_b128 v[144:147], v20
    ds_read_b128 v[148:151], v20 offset:1024
    ds_read_b128 v[152:155], v20 offset:2048
    ds_read_b128 v[156:159], v20 offset:3072
    s_waitcnt lgkmcnt(7)
    v_mfma_f32_32x32x16_bf16 v[128:143], v[160:163], v[80:83], 0
    s_waitcnt lgkmcnt(6)
    v_mfma_f32_32x32x16_bf16 v[128:143], v[164:167], v[84:87], v[128:143]
    s_waitcnt lgkmcnt(5)
    v_mfma_f32_32x32x16_bf16 v[128:143], v[168:171], v[88:91], v[128:143]
    s_waitcnt lgkmcnt(4)
    v_mfma_f32_32x32x16_bf16 v[128:143], v[172:175], v[92:95], v[128:143]
    s_waitcnt lgkmcnt(3)
    v_mfma_f32_32x32x16_bf16 v[112:127], v[144:147], v[80:83], 0
    s_waitcnt lgkmcnt(2)
    v_mfma_f32_32x32x16_bf16 v[112:127], v[148:151], v[84:87], v[112:127]
    s_waitcnt lgkmcnt(1)
    v_mfma_f32_32x32x16_bf16 v[112:127], v[152:155], v[88:91], v[112:127]
    s_waitcnt lgkmcnt(0)
    v_mfma_f32_32x32x16_bf16 v[112:127], v[156:159], v[92:95], v[112:127]
    s_lshl_b32 s96, s76, 6
    s_add_u32 s18, s96, 12288
    v_and_b32 v67, 7, v1
    v_lshl_add_u32 v67, v67, 2, s18
    v_lshrrev_b32 v9, 5, v1
    v_lshl_add_u32 v67, v9, 5, v67
    ds_read_b32 v64, v67
    ds_read_b32 v65, v67 offset:512
    ds_read_b32 v66, v67 offset:640
    ds_read_b32 v68, v67 offset:128
    ds_read_b32 v69, v67 offset:256
    ds_read_b32 v70, v67 offset:384
    ds_read_b32 v71, v67 offset:768
    s_add_u32 s96, s84, 1048576
    s_and_b32 s97, s96, 1048575
    s_lshl_b32 s98, s83, 16
    s_xor_b32 s99, s97, s98
    s_xor_b32 s96, s88, 1048576
    s_add_u32 s19, s99, s96
    s_add_u32 m0, s89, 98304
    s_nop 0
    buffer_load_dwordx4 v74, s[44:47], s19 offen lds
    s_add_u32 s96, s84, 1703936
    s_and_b32 s97, s96, 1048575
    s_lshl_b32 s98, s83, 16
    s_xor_b32 s99, s97, s98
    s_xor_b32 s96, s88, 1048576
    s_add_u32 s19, s99, s96
    s_add_u32 m0, s89, 139264
    s_nop 0
    buffer_load_dwordx4 v74, s[44:47], s19 offen lds
    s_add_u32 s96, s84, 1835008
    s_and_b32 s97, s96, 1048575
    s_lshl_b32 s98, s83, 16
    s_xor_b32 s99, s97, s98
    s_xor_b32 s96, s88, 1048576
    s_add_u32 s19, s99, s96
    s_add_u32 m0, s89, 147456
    s_nop 0
    buffer_load_dwordx4 v74, s[44:47], s19 offen lds
    s_and_b32 s96, s3, 3
    s_lshl2_add_u32 s97, s10, s96
    s_lshl4_add_u32 s98, s97, s11
    s_lshl1_add_u32 s99, s98, s76
    s_lshl_b32 s96, s99, 11
    s_add_u32 s13, s96, 8388608
    v_and_b32 v8, 15, v1
    v_lshlrev_b32 v8, 4, v8
    v_bfe_u32 v9, v1, 4, 1
    v_lshl_add_u32 v8, v9, 10, v8
    v_lshrrev_b32 v9, 5, v1
    v_lshl_add_u32 v8, v9, 8, v8
    v_cvt_pk_bf16_f32 v128, 0, v128
    v_add_f32 v128, 0x358637bd, v128
    v_cvt_pk_bf16_f32 v128, 0, v128
    v_rcp_f32 v128, v128
    v_cvt_pk_bf16_f32 v112, 0, v112
    v_cvt_pk_bf16_f32 v113, 0, v113
    v_cvt_pk_bf16_f32 v114, 0, v114
    v_cvt_pk_bf16_f32 v115, 0, v115
    v_cvt_pk_bf16_f32 v116, 0, v116
    v_cvt_pk_bf16_f32 v117, 0, v117
    v_cvt_pk_bf16_f32 v118, 0, v118
    v_cvt_pk_bf16_f32 v119, 0, v119
    v_pk_mul_f32 v[112:113], v[112:113], v[128:129] op_sel_hi:[1,0]
    v_pk_mul_f32 v[114:115], v[114:115], v[128:129] op_sel_hi:[1,0]
    v_pk_mul_f32 v[116:117], v[116:117], v[128:129] op_sel_hi:[1,0]
    v_pk_mul_f32 v[118:119], v[118:119], v[128:129] op_sel_hi:[1,0]
    v_cvt_pk_bf16_f32 v44, v112, v113
    v_cvt_pk_bf16_f32 v45, v114, v115
    v_cvt_pk_bf16_f32 v46, v116, v117
    v_cvt_pk_bf16_f32 v47, v118, v119
    buffer_store_dwordx4 v[44:47], v8, s[32:35], s13 offen sc1
    v_cvt_pk_bf16_f32 v120, 0, v120
    v_cvt_pk_bf16_f32 v121, 0, v121
    v_cvt_pk_bf16_f32 v122, 0, v122
    v_cvt_pk_bf16_f32 v123, 0, v123
    v_cvt_pk_bf16_f32 v124, 0, v124
    v_cvt_pk_bf16_f32 v125, 0, v125
    v_cvt_pk_bf16_f32 v126, 0, v126
    v_cvt_pk_bf16_f32 v127, 0, v127
    v_pk_mul_f32 v[120:121], v[120:121], v[128:129] op_sel_hi:[1,0]
    v_pk_mul_f32 v[122:123], v[122:123], v[128:129] op_sel_hi:[1,0]
    v_pk_mul_f32 v[124:125], v[124:125], v[128:129] op_sel_hi:[1,0]
    v_pk_mul_f32 v[126:127], v[126:127], v[128:129] op_sel_hi:[1,0]
    v_cvt_pk_bf16_f32 v48, v120, v121
    v_cvt_pk_bf16_f32 v49, v122, v123
    v_cvt_pk_bf16_f32 v50, v124, v125
    v_cvt_pk_bf16_f32 v51, v126, v127
    buffer_store_dwordx4 v[48:51], v8, s[32:35], s13 offen offset:512 sc1
    s_mul_i32 s96, s76, 65600
    s_add_u32 s17, s96, 32768
    v_lshrrev_b32 v20, 5, v1
    v_lshlrev_b32 v20, 11, v20
    v_bfe_u32 v9, v1, 4, 1
    v_lshl_add_u32 v20, v9, 9, v20
    v_bfe_u32 v9, v1, 2, 2
    v_lshl_add_u32 v20, v9, 7, v20
    v_bfe_u32 v9, v1, 3, 1
    v_lshl_add_u32 v20, v9, 6, v20
    v_bfe_u32 v9, v1, 1, 1
    v_lshl_add_u32 v20, v9, 5, v20
    v_bfe_u32 v9, v1, 4, 1
    v_lshl_add_u32 v20, v9, 4, v20
    v_and_b32 v9, 1, v1
    v_lshl_add_u32 v20, v9, 3, v20
    v_xor_b32 v20, s17, v20
    v_xor_b32 v21, 16, v20
    v_xor_b32 v22, 64, v20
    v_xor_b32 v23, 80, v20
    v_and_b32 v5, 7, v1
    v_lshlrev_b32 v5, 15, v5
    v_bfe_u32 v9, v1, 3, 1
    v_lshl_add_u32 v5, v9, 12, v5
    s_lshr_b32 s96, s11, 2
    s_xor_b32 s97, s96, 1
    s_and_b32 s98, s97, 1
    s_lshr_b32 s99, s10, 2
    s_and_b32 s96, s10, 3
    s_lshl_b32 s97, s96, 6
    s_lshl1_add_u32 s96, s99, s97
    s_lshl_b32 s99, s96, 12
    s_lshr_b32 s97, s11, 3
    s_and_b32 s96, s11, 3
    s_lshl2_add_u32 s97, s97, s96
    s_lshl_b32 s96, s97, 6
    s_add_u32 s97, s99, s96
    s_lshl2_add_u32 s99, s98, s97
    s_add_u32 s96, s99, 1048576
    s_add_u32 s15, s96, 1024
    v_mov_b32 v52, 0x10000
    v_mov_b32 v53, s6
    v_lshlrev_b32 v28, 16, v12
    v_and_b32 v29, s6, v12
    v_lshlrev_b32 v30, 16, v13
    v_and_b32 v31, s6, v13
    v_lshlrev_b32 v32, 16, v14
    v_and_b32 v33, s6, v14
    v_lshlrev_b32 v34, 16, v15
    v_and_b32 v35, s6, v15
    v_lshlrev_b32 v36, 16, v16
    v_and_b32 v37, s6, v16
    v_lshlrev_b32 v38, 16, v17
    v_and_b32 v39, s6, v17
    v_lshlrev_b32 v40, 16, v18
    v_and_b32 v41, s6, v18
    v_lshlrev_b32 v42, 16, v19
    v_and_b32 v43, s6, v19
    s_waitcnt lgkmcnt(0)
    v_mul_u32_u24_dpp v76, v64, v52 row_newbcast:0 row_mask:0xf bank_mask:0xf
    v_and_b32_dpp v77, v64, v53 row_newbcast:0 row_mask:0xf bank_mask:0xf
    v_mul_u32_u24_dpp v78, v64, v52 row_newbcast:1 row_mask:0xf bank_mask:0xf
    v_and_b32_dpp v79, v64, v53 row_newbcast:1 row_mask:0xf bank_mask:0xf
    v_mul_u32_u24_dpp v80, v64, v52 row_newbcast:2 row_mask:0xf bank_mask:0xf
    v_and_b32_dpp v81, v64, v53 row_newbcast:2 row_mask:0xf bank_mask:0xf
    v_mul_u32_u24_dpp v82, v64, v52 row_newbcast:3 row_mask:0xf bank_mask:0xf
    v_and_b32_dpp v83, v64, v53 row_newbcast:3 row_mask:0xf bank_mask:0xf
    v_mul_u32_u24_dpp v84, v64, v52 row_newbcast:4 row_mask:0xf bank_mask:0xf
    v_and_b32_dpp v85, v64, v53 row_newbcast:4 row_mask:0xf bank_mask:0xf
    v_mul_u32_u24_dpp v86, v64, v52 row_newbcast:5 row_mask:0xf bank_mask:0xf
    v_and_b32_dpp v87, v64, v53 row_newbcast:5 row_mask:0xf bank_mask:0xf
    v_mul_u32_u24_dpp v88, v64, v52 row_newbcast:6 row_mask:0xf bank_mask:0xf
    v_and_b32_dpp v89, v64, v53 row_newbcast:6 row_mask:0xf bank_mask:0xf
    v_mul_u32_u24_dpp v90, v64, v52 row_newbcast:7 row_mask:0xf bank_mask:0xf
    v_and_b32_dpp v91, v64, v53 row_newbcast:7 row_mask:0xf bank_mask:0xf
    s_lshl1_add_u32 s96, s94, s77
    s_lshl_b32 s97, s96, 15
    s_add_u32 s19, s97, 8388608
    v_and_b32 v25, 15, v1
    v_lshlrev_b32 v25, 6, v25
    s_waitcnt vmcnt(0)
    s_waitcnt lgkmcnt(0)
    s_barrier
    s_cmp_lg_u32 s3, 0
    s_cbranch_scc1 L_PD
    v_mov_b32 v6, s4
    s_mov_b32 exec_hi, 0
    s_mov_b32 exec_lo, 65535
    buffer_store_dword v6, v5, s[32:35], s15 offen sc1
    s_mov_b64 exec, -1
L_PD:
    s_add_u32 s96, s84, 1966080
    s_and_b32 s97, s96, 1048575
    s_lshl_b32 s98, s83, 16
    s_xor_b32 s99, s97, s98
    s_xor_b32 s96, s88, 1048576
    s_add_u32 s13, s99, s96
    s_add_u32 m0, s89, 155648
    s_nop 0
    buffer_load_dwordx4 v74, s[44:47], s13 offen lds
    s_and_b32 s96, s84, 1048575
    s_lshl_b32 s97, s83, 16
    s_xor_b32 s98, s96, s97
    s_add_u32 s13, s98, s88
    s_add_u32 m0, s89, 32768
    s_nop 0
    buffer_load_dwordx4 v74, s[44:47], s13 offen lds
    s_add_u32 s96, s84, 131072
    s_and_b32 s97, s96, 1048575
    s_lshl_b32 s98, s83, 16
    s_xor_b32 s99, s97, s98
    s_add_u32 s13, s99, s88
    s_add_u32 m0, s89, 40960
    s_nop 0
    buffer_load_dwordx4 v74, s[44:47], s13 offen lds
    s_load_dwordx2 s[24:25], s[32:33], s92 offset:1024 glc
    v_mov_b32_dpp v92, v65 row_newbcast:0 row_mask:0xf bank_mask:0xf
    v_mov_b32_dpp v93, v65 row_newbcast:1 row_mask:0xf bank_mask:0xf
    v_mov_b32_dpp v94, v65 row_newbcast:2 row_mask:0xf bank_mask:0xf
    v_mov_b32_dpp v95, v65 row_newbcast:3 row_mask:0xf bank_mask:0xf
    v_mov_b32_dpp v96, v65 row_newbcast:4 row_mask:0xf bank_mask:0xf
    v_mov_b32_dpp v97, v65 row_newbcast:5 row_mask:0xf bank_mask:0xf
    v_mov_b32_dpp v98, v65 row_newbcast:6 row_mask:0xf bank_mask:0xf
    v_mov_b32_dpp v99, v65 row_newbcast:7 row_mask:0xf bank_mask:0xf
    v_mov_b32_dpp v100, v66 row_newbcast:0 row_mask:0xf bank_mask:0xf
    v_mov_b32_dpp v101, v66 row_newbcast:1 row_mask:0xf bank_mask:0xf
    v_mov_b32_dpp v102, v66 row_newbcast:2 row_mask:0xf bank_mask:0xf
    v_mov_b32_dpp v103, v66 row_newbcast:3 row_mask:0xf bank_mask:0xf
    v_mov_b32_dpp v104, v66 row_newbcast:4 row_mask:0xf bank_mask:0xf
    v_mov_b32_dpp v105, v66 row_newbcast:5 row_mask:0xf bank_mask:0xf
    v_mov_b32_dpp v106, v66 row_newbcast:6 row_mask:0xf bank_mask:0xf
    v_mov_b32_dpp v107, v66 row_newbcast:7 row_mask:0xf bank_mask:0xf
    v_and_b32 v4, 3, v1
    v_cmp_eq_u32 vcc, 1, v4
    v_cmp_eq_u32 s[22:23], 0, v4
    v_mov_b32 v5, 0x3f803f80
    v_cndmask_b32 v92, v100, v92, vcc
    v_cndmask_b32 v93, v101, v93, vcc
    v_cndmask_b32 v94, v102, v94, vcc
    v_cndmask_b32 v95, v103, v95, vcc
    v_cndmask_b32 v96, v104, v96, vcc
    v_cndmask_b32 v97, v105, v97, vcc
    v_cndmask_b32 v98, v106, v98, vcc
    v_cndmask_b32 v99, v107, v99, vcc
    v_cndmask_b32 v92, v92, v5, s[22:23]
    v_cndmask_b32 v93, v93, v5, s[22:23]
    v_cndmask_b32 v94, v94, v5, s[22:23]
    v_cndmask_b32 v95, v95, v5, s[22:23]
    v_cndmask_b32 v96, v96, v5, s[22:23]
    v_cndmask_b32 v97, v97, v5, s[22:23]
    v_cndmask_b32 v98, v98, v5, s[22:23]
    v_cndmask_b32 v99, v99, v5, s[22:23]
    s_lshl_b32 s13, s3, 12
    v_add_u32 v4, s13, v2
    s_xor_b32 s96, s3, 4
    s_lshl_b32 s13, s96, 12
    v_and_b32 v5, 15, v1
    v_lshl_add_u32 v5, v5, 4, s13
    v_bfe_u32 v9, v1, 4, 1
    v_lshl_add_u32 v5, v9, 10, v5
    v_lshrrev_b32 v9, 5, v1
    v_lshl_add_u32 v5, v9, 9, v5
    s_lshl_b32 s96, s76, 11
    s_and_b32 s97, s3, 3
    s_lshl_b32 s98, s97, 9
    s_add_u32 s99, s96, s98
    s_add_u32 s13, s99, 131072
    v_and_b32 v6, 31, v1
    v_lshl_add_u32 v6, v6, 4, s13
    v_lshrrev_b32 v9, 5, v1
    v_lshl_add_u32 v6, v9, 3, v6
    s_lshl_b32 s96, s76, 6
    s_add_u32 s13, s96, 139008
    v_and_b32 v7, 7, v1
    v_lshl_add_u32 v7, v7, 2, s13
    v_lshrrev_b32 v9, 5, v1
    v_lshl_add_u32 v7, v9, 5, v7
    v_add_u32 v8, 131072, v2
    v_and_b32 v10, 7, v1
    v_lshlrev_b32 v10, 15, v10
    v_bfe_u32 v9, v1, 3, 1
    v_lshl_add_u32 v10, v9, 12, v10
    s_lshl_b32 s96, s21, 15
    s_lshl_b32 s97, s3, 8
    s_add_u32 s98, s96, s97
    s_add_u32 s17, s98, 12582912
    v_and_b32 v44, 15, v1
    v_lshlrev_b32 v44, 4, v44
    v_lshrrev_b32 v9, 4, v1
    v_lshl_add_u32 v44, v9, 11, v44
    s_lshl4_add_u32 s96, s21, s12
    s_lshl_b32 s97, s96, 11
    s_add_u32 s14, s97, 12582912
    s_and_b32 s96, s12, 1
    s_lshr_b32 s97, s21, 2
    s_and_b32 s98, s21, 3
    s_lshl_b32 s99, s98, 6
    s_lshl1_add_u32 s98, s97, s99
    s_lshl_b32 s97, s98, 12
    s_lshr_b32 s99, s12, 1
    s_lshl_b32 s98, s99, 6
    s_add_u32 s99, s97, s98
    s_lshl2_add_u32 s97, s96, s99
    s_add_u32 s98, s97, 1048576
    s_add_u32 s16, s98, 1536
    s_waitcnt vmcnt(0)
    s_branch SCHK_30
SPOLL_29:
    s_load_dwordx2 s[24:25], s[32:33], s92 offset:1024 glc
SCHK_30:
    s_add_u32 s5, s5, 1
    s_cmp_ge_u32 s5, 300000
    s_waitcnt lgkmcnt(0)
    s_cbranch_scc1 SDONE_31
    s_cmp_lg_u32 s24, s4
    s_cbranch_scc1 SPOLL_29
SDONE_31:
    s_barrier
    s_cmp_lt_u32 s3, 4
    s_cbranch_scc1 L_P2
    s_setprio 1
L_P2:
    s_lshl_b32 s96, s21, 10
    s_add_u32 s18, s96, 65536
    s_lshl_b32 s96, s83, 11
    s_add_u32 s20, s96, s19
    buffer_load_dwordx4 v[140:143], v2, s[32:35], s20 offen sc1
    buffer_load_dwordx4 v[144:147], v2, s[32:35], s20 offen offset:1024 sc1
    ds_read_b64_tr_b16 v[232:233], v22
    ds_read_b64_tr_b16 v[234:235], v22 offset:1024
    ds_read_b64_tr_b16 v[236:237], v23
    ds_read_b64_tr_b16 v[238:239], v23 offset:1024
    ds_read_b64_tr_b16 v[240:241], v20
    ds_read_b64_tr_b16 v[242:243], v20 offset:1024
    ds_read_b64_tr_b16 v[244:245], v21
    ds_read_b64_tr_b16 v[246:247], v21 offset:1024
    s_xor_b32 s96, s83, 1
    s_lshl_b32 s97, s96, 11
    s_add_u32 s20, s97, s19
    buffer_load_dwordx4 v[148:151], v2, s[32:35], s20 offen sc1
    buffer_load_dwordx4 v[152:155], v2, s[32:35], s20 offen offset:1024 sc1
    s_xor_b32 s96, s83, 2
    s_lshl_b32 s97, s96, 11
    s_add_u32 s20, s97, s19
    buffer_load_dwordx4 v[156:159], v2, s[32:35], s20 offen sc1
    buffer_load_dwordx4 v[160:163], v2, s[32:35], s20 offen offset:1024 sc1
    s_waitcnt lgkmcnt(6)
    s_waitcnt vmcnt(5)
    v_mfma_f32_16x16x32_bf16 v[124:127], v[232:235], v[140:143], 0
    ds_read_b64_tr_b16 v[248:249], v22 offset:4096
    s_waitcnt vmcnt(4)
    v_mfma_f32_16x16x32_bf16 v[128:131], v[232:235], v[144:147], 0
    ds_read_b64_tr_b16 v[250:251], v22 offset:5120
    s_xor_b32 s96, s83, 3
    s_lshl_b32 s97, s96, 11
    s_add_u32 s20, s97, s19
    buffer_load_dwordx4 v[164:167], v2, s[32:35], s20 offen sc1
    s_waitcnt lgkmcnt(6)
    v_mfma_f32_16x16x32_bf16 v[132:135], v[236:239], v[140:143], 0
    ds_read_b64_tr_b16 v[232:233], v23 offset:4096
    v_mfma_f32_16x16x32_bf16 v[136:139], v[236:239], v[144:147], 0
    ds_read_b64_tr_b16 v[234:235], v23 offset:5120
    buffer_load_dwordx4 v[168:171], v2, s[32:35], s20 offen offset:1024 sc1
    s_waitcnt lgkmcnt(6)
    v_mfma_f32_16x16x32_bf16 v[108:111], v[240:243], v[140:143], 0
    ds_read_b64_tr_b16 v[236:237], v20 offset:4096
    v_mfma_f32_16x16x32_bf16 v[112:115], v[240:243], v[144:147], 0
    ds_read_b64_tr_b16 v[238:239], v20 offset:5120
    s_waitcnt lgkmcnt(6)
    v_mfma_f32_16x16x32_bf16 v[116:119], v[244:247], v[140:143], 0
    ds_read_b64_tr_b16 v[240:241], v21 offset:4096
    v_mfma_f32_16x16x32_bf16 v[120:123], v[244:247], v[144:147], 0
    ds_read_b64_tr_b16 v[242:243], v21 offset:5120
    s_waitcnt lgkmcnt(6)
    s_waitcnt vmcnt(4)
    v_mfma_f32_16x16x32_bf16 v[124:127], v[248:251], v[148:151], v[124:127]
    ds_read_b64_tr_b16 v[244:245], v22 offset:8192
    v_mfma_f32_16x16x32_bf16 v[128:131], v[248:251], v[152:155], v[128:131]
    ds_read_b64_tr_b16 v[246:247], v22 offset:9216
    s_xor_b32 s96, s83, 4
    s_lshl_b32 s97, s96, 11
    s_add_u32 s20, s97, s19
    buffer_load_dwordx4 v[140:143], v2, s[32:35], s20 offen sc1
    s_waitcnt lgkmcnt(6)
    v_mfma_f32_16x16x32_bf16 v[132:135], v[232:235], v[148:151], v[132:135]
    ds_read_b64_tr_b16 v[248:249], v23 offset:8192
    v_mfma_f32_16x16x32_bf16 v[136:139], v[232:235], v[152:155], v[136:139]
    ds_read_b64_tr_b16 v[250:251], v23 offset:9216
    buffer_load_dwordx4 v[144:147], v2, s[32:35], s20 offen offset:1024 sc1
    s_waitcnt lgkmcnt(6)
    v_mfma_f32_16x16x32_bf16 v[108:111], v[236:239], v[148:151], v[108:111]
    ds_read_b64_tr_b16 v[232:233], v20 offset:8192
    v_mfma_f32_16x16x32_bf16 v[112:115], v[236:239], v[152:155], v[112:115]
    ds_read_b64_tr_b16 v[234:235], v20 offset:9216
    s_waitcnt lgkmcnt(6)
    v_mfma_f32_16x16x32_bf16 v[116:119], v[240:243], v[148:151], v[116:119]
    ds_read_b64_tr_b16 v[236:237], v21 offset:8192
    v_mfma_f32_16x16x32_bf16 v[120:123], v[240:243], v[152:155], v[120:123]
    ds_read_b64_tr_b16 v[238:239], v21 offset:9216
    s_waitcnt lgkmcnt(6)
    s_waitcnt vmcnt(4)
    v_mfma_f32_16x16x32_bf16 v[124:127], v[244:247], v[156:159], v[124:127]
    ds_read_b64_tr_b16 v[240:241], v22 offset:12288
    v_mfma_f32_16x16x32_bf16 v[128:131], v[244:247], v[160:163], v[128:131]
    ds_read_b64_tr_b16 v[242:243], v22 offset:13312
    s_xor_b32 s96, s83, 5
    s_lshl_b32 s97, s96, 11
    s_add_u32 s20, s97, s19
    buffer_load_dwordx4 v[148:151], v2, s[32:35], s20 offen sc1
    s_waitcnt lgkmcnt(6)
    v_mfma_f32_16x16x32_bf16 v[132:135], v[248:251], v[156:159], v[132:135]
    ds_read_b64_tr_b16 v[244:245], v23 offset:12288
    v_mfma_f32_16x16x32_bf16 v[136:139], v[248:251], v[160:163], v[136:139]
    ds_read_b64_tr_b16 v[246:247], v23 offset:13312
    buffer_load_dwordx4 v[152:155], v2, s[32:35], s20 offen offset:1024 sc1
    s_waitcnt lgkmcnt(6)
    v_mfma_f32_16x16x32_bf16 v[108:111], v[232:235], v[156:159], v[108:111]
    ds_read_b64_tr_b16 v[248:249], v20 offset:12288
    v_mfma_f32_16x16x32_bf16 v[112:115], v[232:235], v[160:163], v[112:115]
    ds_read_b64_tr_b16 v[250:251], v20 offset:13312
    s_waitcnt lgkmcnt(6)
    v_mfma_f32_16x16x32_bf16 v[116:119], v[236:239], v[156:159], v[116:119]
    ds_read_b64_tr_b16 v[232:233], v21 offset:12288
    v_mfma_f32_16x16x32_bf16 v[120:123], v[236:239], v[160:163], v[120:123]
    ds_read_b64_tr_b16 v[234:235], v21 offset:13312
    s_waitcnt lgkmcnt(6)
    s_waitcnt vmcnt(4)
    v_mfma_f32_16x16x32_bf16 v[124:127], v[240:243], v[164:167], v[124:127]
    ds_read_b64_tr_b16 v[236:237], v22 offset:16384
    v_mfma_f32_16x16x32_bf16 v[128:131], v[240:243], v[168:171], v[128:131]
    ds_read_b64_tr_b16 v[238:239], v22 offset:17408
    s_xor_b32 s96, s83, 6
    s_lshl_b32 s97, s96, 11
    s_add_u32 s20, s97, s19
    buffer_load_dwordx4 v[156:159], v2, s[32:35], s20 offen sc1
    s_waitcnt lgkmcnt(6)
    v_mfma_f32_16x16x32_bf16 v[132:135], v[244:247], v[164:167], v[132:135]
    ds_read_b64_tr_b16 v[240:241], v23 offset:16384
    v_mfma_f32_16x16x32_bf16 v[136:139], v[244:247], v[168:171], v[136:139]
    ds_read_b64_tr_b16 v[242:243], v23 offset:17408
    buffer_load_dwordx4 v[160:163], v2, s[32:35], s20 offen offset:1024 sc1
    s_waitcnt lgkmcnt(6)
    v_mfma_f32_16x16x32_bf16 v[108:111], v[248:251], v[164:167], v[108:111]
    ds_read_b64_tr_b16 v[244:245], v20 offset:16384
    v_mfma_f32_16x16x32_bf16 v[112:115], v[248:251], v[168:171], v[112:115]
    ds_read_b64_tr_b16 v[246:247], v20 offset:17408
    s_waitcnt lgkmcnt(6)
    v_mfma_f32_16x16x32_bf16 v[116:119], v[232:235], v[164:167], v[116:119]
    ds_read_b64_tr_b16 v[248:249], v21 offset:16384
    v_mfma_f32_16x16x32_bf16 v[120:123], v[232:235], v[168:171], v[120:123]
    ds_read_b64_tr_b16 v[250:251], v21 offset:17408
    s_waitcnt lgkmcnt(6)
    s_waitcnt vmcnt(4)
    v_mfma_f32_16x16x32_bf16 v[124:127], v[236:239], v[140:143], v[124:127]
    ds_read_b64_tr_b16 v[232:233], v22 offset:20480
    v_mfma_f32_16x16x32_bf16 v[128:131], v[236:239], v[144:147], v[128:131]
    ds_read_b64_tr_b16 v[234:235], v22 offset:21504
    s_xor_b32 s96, s83, 7
    s_lshl_b32 s97, s96, 11
    s_add_u32 s20, s97, s19
    buffer_load_dwordx4 v[164:167], v2, s[32:35], s20 offen sc1
    s_waitcnt lgkmcnt(6)
    v_mfma_f32_16x16x32_bf16 v[132:135], v[240:243], v[140:143], v[132:135]
    ds_read_b64_tr_b16 v[236:237], v23 offset:20480
    v_mfma_f32_16x16x32_bf16 v[136:139], v[240:243], v[144:147], v[136:139]
    ds_read_b64_tr_b16 v[238:239], v23 offset:21504
    buffer_load_dwordx4 v[168:171], v2, s[32:35], s20 offen offset:1024 sc1
    s_waitcnt lgkmcnt(6)
    v_mfma_f32_16x16x32_bf16 v[108:111], v[244:247], v[140:143], v[108:111]
    ds_read_b64_tr_b16 v[240:241], v20 offset:20480
    v_mfma_f32_16x16x32_bf16 v[112:115], v[244:247], v[144:147], v[112:115]
    ds_read_b64_tr_b16 v[242:243], v20 offset:21504
    s_setprio 0
    s_waitcnt lgkmcnt(6)
    v_mfma_f32_16x16x32_bf16 v[116:119], v[248:251], v[140:143], v[116:119]
    ds_read_b64_tr_b16 v[244:245], v21 offset:20480
    v_mfma_f32_16x16x32_bf16 v[120:123], v[248:251], v[144:147], v[120:123]
    ds_read_b64_tr_b16 v[246:247], v21 offset:21504
    s_waitcnt lgkmcnt(6)
    s_waitcnt vmcnt(4)
    v_mfma_f32_16x16x32_bf16 v[124:127], v[232:235], v[148:151], v[124:127]
    ds_read_b64_tr_b16 v[248:249], v22 offset:24576
    v_mfma_f32_16x16x32_bf16 v[128:131], v[232:235], v[152:155], v[128:131]
    ds_read_b64_tr_b16 v[250:251], v22 offset:25600
    s_cmp_eq_u32 s25, s4
    s_cbranch_scc1 L_D2
SPOLL_32:
    s_load_dwordx2 s[24:25], s[32:33], s92 offset:1024 glc
SCHK_33:
    s_add_u32 s5, s5, 1
    s_cmp_ge_u32 s5, 300000
    s_waitcnt lgkmcnt(0)
    s_cbranch_scc1 SDONE_34
    s_cmp_lg_u32 s25, s4
    s_cbranch_scc1 SPOLL_32
SDONE_34:
L_D2:
    s_barrier
    s_xor_b32 s96, s83, 8
    s_lshl_b32 s97, s96, 11
    s_add_u32 s20, s97, s19
    buffer_load_dwordx4 v[140:143], v2, s[32:35], s20 offen sc1
    s_waitcnt lgkmcnt(6)
    v_mfma_f32_16x16x32_bf16 v[132:135], v[236:239], v[148:151], v[132:135]
    ds_read_b64_tr_b16 v[232:233], v23 offset:24576
    v_mfma_f32_16x16x32_bf16 v[136:139], v[236:239], v[152:155], v[136:139]
    ds_read_b64_tr_b16 v[234:235], v23 offset:25600
    buffer_load_dwordx4 v[144:147], v2, s[32:35], s20 offen offset:1024 sc1
    s_waitcnt lgkmcnt(6)
    v_mfma_f32_16x16x32_bf16 v[108:111], v[240:243], v[148:151], v[108:111]
    ds_read_b64_tr_b16 v[236:237], v20 offset:24576
    v_mfma_f32_16x16x32_bf16 v[112:115], v[240:243], v[152:155], v[112:115]
    ds_read_b64_tr_b16 v[238:239], v20 offset:25600
    s_waitcnt lgkmcnt(6)
    v_mfma_f32_16x16x32_bf16 v[116:119], v[244:247], v[148:151], v[116:119]
    ds_read_b64_tr_b16 v[240:241], v21 offset:24576
    v_mfma_f32_16x16x32_bf16 v[120:123], v[244:247], v[152:155], v[120:123]
    ds_read_b64_tr_b16 v[242:243], v21 offset:25600
    s_waitcnt lgkmcnt(6)
    s_waitcnt vmcnt(4)
    v_mfma_f32_16x16x32_bf16 v[124:127], v[248:251], v[156:159], v[124:127]
    ds_read_b64_tr_b16 v[244:245], v22 offset:28672
    v_mfma_f32_16x16x32_bf16 v[128:131], v[248:251], v[160:163], v[128:131]
    ds_read_b64_tr_b16 v[246:247], v22 offset:29696
    s_xor_b32 s96, s83, 9
    s_lshl_b32 s97, s96, 11
    s_add_u32 s20, s97, s19
    buffer_load_dwordx4 v[148:151], v2, s[32:35], s20 offen sc1
    s_waitcnt lgkmcnt(6)
    v_mfma_f32_16x16x32_bf16 v[132:135], v[232:235], v[156:159], v[132:135]
    ds_read_b64_tr_b16 v[248:249], v23 offset:28672
    v_mfma_f32_16x16x32_bf16 v[136:139], v[232:235], v[160:163], v[136:139]
    ds_read_b64_tr_b16 v[250:251], v23 offset:29696
    buffer_load_dwordx4 v[152:155], v2, s[32:35], s20 offen offset:1024 sc1
    s_waitcnt lgkmcnt(6)
    v_mfma_f32_16x16x32_bf16 v[108:111], v[236:239], v[156:159], v[108:111]
    ds_read_b64_tr_b16 v[232:233], v20 offset:28672
    v_mfma_f32_16x16x32_bf16 v[112:115], v[236:239], v[160:163], v[112:115]
    ds_read_b64_tr_b16 v[234:235], v20 offset:29696
    s_waitcnt lgkmcnt(6)
    v_mfma_f32_16x16x32_bf16 v[116:119], v[240:243], v[156:159], v[116:119]
    ds_read_b64_tr_b16 v[236:237], v21 offset:28672
    v_mfma_f32_16x16x32_bf16 v[120:123], v[240:243], v[160:163], v[120:123]
    ds_read_b64_tr_b16 v[238:239], v21 offset:29696
    s_waitcnt lgkmcnt(6)
    s_waitcnt vmcnt(4)
    v_mfma_f32_16x16x32_bf16 v[124:127], v[244:247], v[164:167], v[124:127]
    ds_read_b64_tr_b16 v[240:241], v22 offset:32768
    v_mfma_f32_16x16x32_bf16 v[128:131], v[244:247], v[168:171], v[128:131]
    ds_read_b64_tr_b16 v[242:243], v22 offset:33792
    s_xor_b32 s96, s83, 10
    s_lshl_b32 s97, s96, 11
    s_add_u32 s20, s97, s19
    buffer_load_dwordx4 v[156:159], v2, s[32:35], s20 offen sc1
    s_waitcnt lgkmcnt(6)
    v_mfma_f32_16x16x32_bf16 v[132:135], v[248:251], v[164:167], v[132:135]
    ds_read_b64_tr_b16 v[244:245], v23 offset:32768
    v_mfma_f32_16x16x32_bf16 v[136:139], v[248:251], v[168:171], v[136:139]
    ds_read_b64_tr_b16 v[246:247], v23 offset:33792
    buffer_load_dwordx4 v[160:163], v2, s[32:35], s20 offen offset:1024 sc1
    s_waitcnt lgkmcnt(6)
    v_mfma_f32_16x16x32_bf16 v[108:111], v[232:235], v[164:167], v[108:111]
    ds_read_b64_tr_b16 v[248:249], v20 offset:32768
    v_mfma_f32_16x16x32_bf16 v[112:115], v[232:235], v[168:171], v[112:115]
    ds_read_b64_tr_b16 v[250:251], v20 offset:33792
    s_waitcnt lgkmcnt(6)
    v_mfma_f32_16x16x32_bf16 v[116:119], v[236:239], v[164:167], v[116:119]
    ds_read_b64_tr_b16 v[232:233], v21 offset:32768
    v_mfma_f32_16x16x32_bf16 v[120:123], v[236:239], v[168:171], v[120:123]
    ds_read_b64_tr_b16 v[234:235], v21 offset:33792
    s_waitcnt lgkmcnt(6)
    s_waitcnt vmcnt(4)
    v_mfma_f32_16x16x32_bf16 v[124:127], v[240:243], v[140:143], v[124:127]
    ds_read_b64_tr_b16 v[236:237], v22 offset:36864
    v_mfma_f32_16x16x32_bf16 v[128:131], v[240:243], v[144:147], v[128:131]
    ds_read_b64_tr_b16 v[238:239], v22 offset:37888
    s_xor_b32 s96, s83, 11
    s_lshl_b32 s97, s96, 11
    s_add_u32 s20, s97, s19
    buffer_load_dwordx4 v[164:167], v2, s[32:35], s20 offen sc1
    s_waitcnt lgkmcnt(6)
    v_mfma_f32_16x16x32_bf16 v[132:135], v[244:247], v[140:143], v[132:135]
    ds_read_b64_tr_b16 v[240:241], v23 offset:36864
    v_mfma_f32_16x16x32_bf16 v[136:139], v[244:247], v[144:147], v[136:139]
    ds_read_b64_tr_b16 v[242:243], v23 offset:37888
    buffer_load_dwordx4 v[168:171], v2, s[32:35], s20 offen offset:1024 sc1
    s_waitcnt lgkmcnt(6)
    v_mfma_f32_16x16x32_bf16 v[108:111], v[248:251], v[140:143], v[108:111]
    ds_read_b64_tr_b16 v[244:245], v20 offset:36864
    v_mfma_f32_16x16x32_bf16 v[112:115], v[248:251], v[144:147], v[112:115]
    ds_read_b64_tr_b16 v[246:247], v20 offset:37888
    s_waitcnt lgkmcnt(6)
    v_mfma_f32_16x16x32_bf16 v[116:119], v[232:235], v[140:143], v[116:119]
    ds_read_b64_tr_b16 v[248:249], v21 offset:36864
    v_mfma_f32_16x16x32_bf16 v[120:123], v[232:235], v[144:147], v[120:123]
    ds_read_b64_tr_b16 v[250:251], v21 offset:37888
    s_waitcnt lgkmcnt(6)
    s_waitcnt vmcnt(4)
    v_mfma_f32_16x16x32_bf16 v[124:127], v[236:239], v[148:151], v[124:127]
    ds_read_b64_tr_b16 v[232:233], v22 offset:40960
    v_mfma_f32_16x16x32_bf16 v[128:131], v[236:239], v[152:155], v[128:131]
    ds_read_b64_tr_b16 v[234:235], v22 offset:41984
    s_xor_b32 s96, s83, 12
    s_lshl_b32 s97, s96, 11
    s_add_u32 s20, s97, s19
    buffer_load_dwordx4 v[140:143], v2, s[32:35], s20 offen sc1
    s_waitcnt lgkmcnt(6)
    v_mfma_f32_16x16x32_bf16 v[132:135], v[240:243], v[148:151], v[132:135]
    ds_read_b64_tr_b16 v[236:237], v23 offset:40960
    v_mfma_f32_16x16x32_bf16 v[136:139], v[240:243], v[152:155], v[136:139]
    ds_read_b64_tr_b16 v[238:239], v23 offset:41984
    buffer_load_dwordx4 v[144:147], v2, s[32:35], s20 offen offset:1024 sc1
    s_waitcnt lgkmcnt(6)
    v_mfma_f32_16x16x32_bf16 v[108:111], v[244:247], v[148:151], v[108:111]
    ds_read_b64_tr_b16 v[240:241], v20 offset:40960
    v_mfma_f32_16x16x32_bf16 v[112:115], v[244:247], v[152:155], v[112:115]
    ds_read_b64_tr_b16 v[242:243], v20 offset:41984
    s_waitcnt lgkmcnt(6)
    v_mfma_f32_16x16x32_bf16 v[116:119], v[248:251], v[148:151], v[116:119]
    ds_read_b64_tr_b16 v[244:245], v21 offset:40960
    v_mfma_f32_16x16x32_bf16 v[120:123], v[248:251], v[152:155], v[120:123]
    ds_read_b64_tr_b16 v[246:247], v21 offset:41984
    s_waitcnt lgkmcnt(6)
    s_waitcnt vmcnt(4)
    v_mfma_f32_16x16x32_bf16 v[124:127], v[232:235], v[156:159], v[124:127]
    ds_read_b64_tr_b16 v[248:249], v22 offset:45056
    v_mfma_f32_16x16x32_bf16 v[128:131], v[232:235], v[160:163], v[128:131]
    ds_read_b64_tr_b16 v[250:251], v22 offset:46080
    s_xor_b32 s96, s83, 13
    s_lshl_b32 s97, s96, 11
    s_add_u32 s20, s97, s19
    buffer_load_dwordx4 v[148:151], v2, s[32:35], s20 offen sc1
    s_waitcnt lgkmcnt(6)
    v_mfma_f32_16x16x32_bf16 v[132:135], v[236:239], v[156:159], v[132:135]
    ds_read_b64_tr_b16 v[232:233], v23 offset:45056
    v_mfma_f32_16x16x32_bf16 v[136:139], v[236:239], v[160:163], v[136:139]
    ds_read_b64_tr_b16 v[234:235], v23 offset:46080
    buffer_load_dwordx4 v[152:155], v2, s[32:35], s20 offen offset:1024 sc1
    s_waitcnt lgkmcnt(6)
    v_mfma_f32_16x16x32_bf16 v[108:111], v[240:243], v[156:159], v[108:111]
    ds_read_b64_tr_b16 v[236:237], v20 offset:45056
    v_mfma_f32_16x16x32_bf16 v[112:115], v[240:243], v[160:163], v[112:115]
    ds_read_b64_tr_b16 v[238:239], v20 offset:46080
    s_waitcnt lgkmcnt(6)
    v_mfma_f32_16x16x32_bf16 v[116:119], v[244:247], v[156:159], v[116:119]
    ds_read_b64_tr_b16 v[240:241], v21 offset:45056
    v_mfma_f32_16x16x32_bf16 v[120:123], v[244:247], v[160:163], v[120:123]
    ds_read_b64_tr_b16 v[242:243], v21 offset:46080
    s_waitcnt lgkmcnt(6)
    s_waitcnt vmcnt(4)
    v_mfma_f32_16x16x32_bf16 v[124:127], v[248:251], v[164:167], v[124:127]
    ds_read_b64_tr_b16 v[244:245], v22 offset:49152
    v_mfma_f32_16x16x32_bf16 v[128:131], v[248:251], v[168:171], v[128:131]
    ds_read_b64_tr_b16 v[246:247], v22 offset:50176
    s_xor_b32 s96, s83, 14
    s_lshl_b32 s97, s96, 11
    s_add_u32 s20, s97, s19
    buffer_load_dwordx4 v[156:159], v2, s[32:35], s20 offen sc1
    s_waitcnt lgkmcnt(6)
    v_mfma_f32_16x16x32_bf16 v[132:135], v[232:235], v[164:167], v[132:135]
    ds_read_b64_tr_b16 v[248:249], v23 offset:49152
    v_mfma_f32_16x16x32_bf16 v[136:139], v[232:235], v[168:171], v[136:139]
    ds_read_b64_tr_b16 v[250:251], v23 offset:50176
    buffer_load_dwordx4 v[160:163], v2, s[32:35], s20 offen offset:1024 sc1
    s_waitcnt lgkmcnt(6)
    v_mfma_f32_16x16x32_bf16 v[108:111], v[236:239], v[164:167], v[108:111]
    ds_read_b64_tr_b16 v[232:233], v20 offset:49152
    v_mfma_f32_16x16x32_bf16 v[112:115], v[236:239], v[168:171], v[112:115]
    ds_read_b64_tr_b16 v[234:235], v20 offset:50176
    s_waitcnt lgkmcnt(6)
    v_mfma_f32_16x16x32_bf16 v[116:119], v[240:243], v[164:167], v[116:119]
    ds_read_b64_tr_b16 v[236:237], v21 offset:49152
    v_mfma_f32_16x16x32_bf16 v[120:123], v[240:243], v[168:171], v[120:123]
    ds_read_b64_tr_b16 v[238:239], v21 offset:50176
    s_waitcnt lgkmcnt(6)
    s_waitcnt vmcnt(4)
    v_mfma_f32_16x16x32_bf16 v[124:127], v[244:247], v[140:143], v[124:127]
    ds_read_b64_tr_b16 v[240:241], v22 offset:53248
    v_mfma_f32_16x16x32_bf16 v[128:131], v[244:247], v[144:147], v[128:131]
    ds_read_b64_tr_b16 v[242:243], v22 offset:54272
    s_xor_b32 s96, s83, 15
    s_lshl_b32 s97, s96, 11
    s_add_u32 s20, s97, s19
    buffer_load_dwordx4 v[164:167], v2, s[32:35], s20 offen sc1
    s_waitcnt lgkmcnt(6)
    v_mfma_f32_16x16x32_bf16 v[132:135], v[248:251], v[140:143], v[132:135]
    ds_read_b64_tr_b16 v[244:245], v23 offset:53248
    v_mfma_f32_16x16x32_bf16 v[136:139], v[248:251], v[144:147], v[136:139]
    ds_read_b64_tr_b16 v[246:247], v23 offset:54272
    buffer_load_dwordx4 v[168:171], v2, s[32:35], s20 offen offset:1024 sc1
    buffer_load_dwordx2 v[26:27], v25, s[32:35], s18 offen sc1
    s_waitcnt lgkmcnt(6)
    v_mfma_f32_16x16x32_bf16 v[108:111], v[232:235], v[140:143], v[108:111]
    ds_read_b64_tr_b16 v[248:249], v20 offset:53248
    v_mfma_f32_16x16x32_bf16 v[112:115], v[232:235], v[144:147], v[112:115]
    ds_read_b64_tr_b16 v[250:251], v20 offset:54272
    s_waitcnt lgkmcnt(6)
    v_mfma_f32_16x16x32_bf16 v[116:119], v[236:239], v[140:143], v[116:119]
    ds_read_b64_tr_b16 v[232:233], v21 offset:53248
    v_mfma_f32_16x16x32_bf16 v[120:123], v[236:239], v[144:147], v[120:123]
    ds_read_b64_tr_b16 v[234:235], v21 offset:54272
    s_waitcnt lgkmcnt(6)
    s_waitcnt vmcnt(5)
    v_mfma_f32_16x16x32_bf16 v[124:127], v[240:243], v[148:151], v[124:127]
    ds_read_b64_tr_b16 v[236:237], v22 offset:57344
    v_mfma_f32_16x16x32_bf16 v[128:131], v[240:243], v[152:155], v[128:131]
    ds_read_b64_tr_b16 v[238:239], v22 offset:58368
    s_waitcnt lgkmcnt(6)
    v_mfma_f32_16x16x32_bf16 v[132:135], v[244:247], v[148:151], v[132:135]
    ds_read_b64_tr_b16 v[240:241], v23 offset:57344
    v_mfma_f32_16x16x32_bf16 v[136:139], v[244:247], v[152:155], v[136:139]
    ds_read_b64_tr_b16 v[242:243], v23 offset:58368
    s_waitcnt lgkmcnt(6)
    v_mfma_f32_16x16x32_bf16 v[108:111], v[248:251], v[148:151], v[108:111]
    ds_read_b64_tr_b16 v[244:245], v20 offset:57344
    v_mfma_f32_16x16x32_bf16 v[112:115], v[248:251], v[152:155], v[112:115]
    ds_read_b64_tr_b16 v[246:247], v20 offset:58368
    s_waitcnt lgkmcnt(6)
    v_mfma_f32_16x16x32_bf16 v[116:119], v[232:235], v[148:151], v[116:119]
    ds_read_b64_tr_b16 v[248:249], v21 offset:57344
    v_mfma_f32_16x16x32_bf16 v[120:123], v[232:235], v[152:155], v[120:123]
    ds_read_b64_tr_b16 v[250:251], v21 offset:58368
    s_waitcnt lgkmcnt(6)
    s_waitcnt vmcnt(3)
    v_mfma_f32_16x16x32_bf16 v[124:127], v[236:239], v[156:159], v[124:127]
    ds_read_b64_tr_b16 v[232:233], v22 offset:61440
    v_mfma_f32_16x16x32_bf16 v[128:131], v[236:239], v[160:163], v[128:131]
    ds_read_b64_tr_b16 v[234:235], v22 offset:62464
    s_waitcnt lgkmcnt(6)
    v_mfma_f32_16x16x32_bf16 v[132:135], v[240:243], v[156:159], v[132:135]
    ds_read_b64_tr_b16 v[236:237], v23 offset:61440
    v_mfma_f32_16x16x32_bf16 v[136:139], v[240:243], v[160:163], v[136:139]
    ds_read_b64_tr_b16 v[238:239], v23 offset:62464
    s_waitcnt lgkmcnt(6)
    v_mfma_f32_16x16x32_bf16 v[108:111], v[244:247], v[156:159], v[108:111]
    ds_read_b64_tr_b16 v[240:241], v20 offset:61440
    v_mfma_f32_16x16x32_bf16 v[112:115], v[244:247], v[160:163], v[112:115]
    ds_read_b64_tr_b16 v[242:243], v20 offset:62464
    s_waitcnt lgkmcnt(6)
    v_mfma_f32_16x16x32_bf16 v[116:119], v[248:251], v[156:159], v[116:119]
    ds_read_b64_tr_b16 v[244:245], v21 offset:61440
    v_mfma_f32_16x16x32_bf16 v[120:123], v[248:251], v[160:163], v[120:123]
    ds_read_b64_tr_b16 v[246:247], v21 offset:62464
    s_waitcnt lgkmcnt(6)
    s_waitcnt vmcnt(1)
    v_mfma_f32_16x16x32_bf16 v[124:127], v[232:235], v[164:167], v[124:127]
    v_mfma_f32_16x16x32_bf16 v[128:131], v[232:235], v[168:171], v[128:131]
    s_waitcnt lgkmcnt(4)
    v_mfma_f32_16x16x32_bf16 v[132:135], v[236:239], v[164:167], v[132:135]
    v_mfma_f32_16x16x32_bf16 v[136:139], v[236:239], v[168:171], v[136:139]
    s_waitcnt lgkmcnt(2)
    v_mfma_f32_16x16x32_bf16 v[108:111], v[240:243], v[164:167], v[108:111]
    v_mfma_f32_16x16x32_bf16 v[112:115], v[240:243], v[168:171], v[112:115]
    s_waitcnt lgkmcnt(0)
    v_mfma_f32_16x16x32_bf16 v[116:119], v[244:247], v[164:167], v[116:119]
    v_mfma_f32_16x16x32_bf16 v[120:123], v[244:247], v[168:171], v[120:123]
    s_setprio 0
    ds_write_b128 v4, v[124:127]
    ds_write_b128 v4, v[128:131] offset:1024
    ds_write_b128 v4, v[132:135] offset:2048
    ds_write_b128 v4, v[136:139] offset:3072
    v_permlane16_swap_b32 v108, v112
    v_permlane16_swap_b32 v109, v113
    v_permlane16_swap_b32 v110, v114
    v_permlane16_swap_b32 v111, v115
    v_permlane16_swap_b32 v116, v120
    v_permlane16_swap_b32 v117, v121
    v_permlane16_swap_b32 v118, v122
    v_permlane16_swap_b32 v119, v123
    s_waitcnt lgkmcnt(0)
    s_barrier
    ds_read_b128 v[124:127], v5
    ds_read_b128 v[128:131], v5 offset:256
    ds_read_b128 v[132:135], v5 offset:2048
    ds_read_b128 v[136:139], v5 offset:2304
    s_add_u32 s15, s80, 172032
    s_lshl2_add_u32 m0, s89, 35840
    s_nop 0
    buffer_load_dwordx4 v72, s[52:55], s15 offen nt lds
    s_lshl_b32 s96, s90, 7
    s_add_u32 s97, s96, s80
    s_add_u32 s15, s97, 172032
    s_lshl2_add_u32 m0, s89, 68608
    s_nop 0
    buffer_load_dwordx4 v72, s[56:59], s15 offen nt lds
    s_mov_b32 s15, s81
    s_lshl2_add_u32 m0, s89, 98304
    s_nop 0
    buffer_load_dwordx4 v73, s[60:63], s15 offen nt lds
    s_waitcnt lgkmcnt(3)
    v_pk_add_f32 v[108:109], v[108:109], v[124:125]
    v_pk_add_f32 v[110:111], v[110:111], v[126:127]
    s_waitcnt lgkmcnt(2)
    v_pk_add_f32 v[112:113], v[112:113], v[128:129]
    v_pk_add_f32 v[114:115], v[114:115], v[130:131]
    v_cvt_pk_bf16_f32 v108, 0, v108
    v_cvt_pk_bf16_f32 v109, 0, v109
    v_cvt_pk_bf16_f32 v110, 0, v110
    v_cvt_pk_bf16_f32 v111, 0, v111
    v_cvt_pk_bf16_f32 v112, 0, v112
    v_cvt_pk_bf16_f32 v113, 0, v113
    v_cvt_pk_bf16_f32 v114, 0, v114
    v_cvt_pk_bf16_f32 v115, 0, v115
    v_pk_mul_f32 v[108:109], v[108:109], v[76:77]
    v_pk_mul_f32 v[110:111], v[110:111], v[78:79]
    v_pk_mul_f32 v[112:113], v[112:113], v[80:81]
    v_pk_mul_f32 v[114:115], v[114:115], v[82:83]
    v_cvt_pk_bf16_f32 v108, 0, v108
    v_cvt_pk_bf16_f32 v109, 0, v109
    v_cvt_pk_bf16_f32 v110, 0, v110
    v_cvt_pk_bf16_f32 v111, 0, v111
    v_cvt_pk_bf16_f32 v112, 0, v112
    v_cvt_pk_bf16_f32 v113, 0, v113
    v_cvt_pk_bf16_f32 v114, 0, v114
    v_cvt_pk_bf16_f32 v115, 0, v115
    v_pk_add_f32 v[108:109], v[108:109], v[28:29]
    v_pk_add_f32 v[110:111], v[110:111], v[30:31]
    v_pk_add_f32 v[112:113], v[112:113], v[32:33]
    v_pk_add_f32 v[114:115], v[114:115], v[34:35]
    v_cvt_pk_bf16_f32 v12, v108, v109
    v_cvt_pk_bf16_f32 v13, v110, v111
    v_cvt_pk_bf16_f32 v14, v112, v113
    v_cvt_pk_bf16_f32 v15, v114, v115
    s_waitcnt lgkmcnt(1)
    v_pk_add_f32 v[116:117], v[116:117], v[132:133]
    v_pk_add_f32 v[118:119], v[118:119], v[134:135]
    s_waitcnt lgkmcnt(0)
    v_pk_add_f32 v[120:121], v[120:121], v[136:137]
    v_pk_add_f32 v[122:123], v[122:123], v[138:139]
    v_cvt_pk_bf16_f32 v116, 0, v116
    v_cvt_pk_bf16_f32 v117, 0, v117
    v_cvt_pk_bf16_f32 v118, 0, v118
    v_cvt_pk_bf16_f32 v119, 0, v119
    v_cvt_pk_bf16_f32 v120, 0, v120
    v_cvt_pk_bf16_f32 v121, 0, v121
    v_cvt_pk_bf16_f32 v122, 0, v122
    v_cvt_pk_bf16_f32 v123, 0, v123
    v_pk_mul_f32 v[116:117], v[116:117], v[84:85]
    v_pk_mul_f32 v[118:119], v[118:119], v[86:87]
    v_pk_mul_f32 v[120:121], v[120:121], v[88:89]
    v_pk_mul_f32 v[122:123], v[122:123], v[90:91]
    v_cvt_pk_bf16_f32 v116, 0, v116
    v_cvt_pk_bf16_f32 v117, 0, v117
    v_cvt_pk_bf16_f32 v118, 0, v118
    v_cvt_pk_bf16_f32 v119, 0, v119
    v_cvt_pk_bf16_f32 v120, 0, v120
    v_cvt_pk_bf16_f32 v121, 0, v121
    v_cvt_pk_bf16_f32 v122, 0, v122
    v_cvt_pk_bf16_f32 v123, 0, v123
    v_pk_add_f32 v[116:117], v[116:117], v[36:37]
    v_pk_add_f32 v[118:119], v[118:119], v[38:39]
    v_pk_add_f32 v[120:121], v[120:121], v[40:41]
    v_pk_add_f32 v[122:123], v[122:123], v[42:43]
    v_cvt_pk_bf16_f32 v16, v116, v117
    v_cvt_pk_bf16_f32 v17, v118, v119
    v_cvt_pk_bf16_f32 v18, v120, v121
    v_cvt_pk_bf16_f32 v19, v122, v123
    v_mfma_f32_32x32x16_bf16 v[124:139], v[92:95], v[12:15], 0
    s_nop 0
    v_mfma_f32_32x32x16_bf16 v[124:139], v[96:99], v[16:19], v[124:139]
    v_dot2_f32_bf16 v232, v12, v12, 0
    v_dot2_f32_bf16 v233, v13, v13, 0
    v_dot2_f32_bf16 v232, v14, v14, v232
    v_dot2_f32_bf16 v233, v15, v15, v233
    v_dot2_f32_bf16 v232, v16, v16, v232
    v_dot2_f32_bf16 v233, v17, v17, v233
    v_dot2_f32_bf16 v232, v18, v18, v232
    v_dot2_f32_bf16 v233, v19, v19, v233
    s_nop 2
    v_add_f32 v234, v232, v233
    v_add_f32 v232, v232, v233
    s_nop 1
    v_permlane32_swap_b32 v232, v234
    s_mov_b32 exec_lo, 0
    v_add_f32 v124, v232, v234
    v_mov_b32 v125, v126
    s_mov_b32 exec_lo, -1
    ds_write_b64 v6, v[124:125]
    ds_write_b32 v7, v68
    ds_write_b32 v7, v69 offset:128
    ds_write_b32 v7, v70 offset:256
    ds_write_b32 v7, v71 offset:384
    s_waitcnt lgkmcnt(0)
    s_barrier
    s_cmp_lg_u32 s3, 0
    s_cbranch_scc1 L_PE
    s_setprio 3
    ds_read_b128 v[124:127], v8 offset:0
    ds_read_b128 v[128:131], v8 offset:2048
    ds_read_b128 v[132:135], v8 offset:1024
    ds_read_b128 v[136:139], v8 offset:3072
    s_waitcnt lgkmcnt(2)
    v_pk_add_f32 v[124:125], v[124:125], v[128:129]
    v_pk_add_f32 v[126:127], v[126:127], v[130:131]
    v_add_f32 v125, v125, v127
    v_mov_b32 v127, s4
    s_waitcnt lgkmcnt(0)
    v_pk_add_f32 v[132:133], v[132:133], v[136:137]
    v_pk_add_f32 v[134:135], v[134:135], v[138:139]
    v_add_f32 v133, v133, v135
    v_mov_b32 v135, s4
    buffer_store_dwordx4 v[124:127], v2, s[32:35], s14 offen sc1
    buffer_store_dwordx4 v[132:135], v2, s[32:35], s14 offen offset:1024 sc1
    s_mov_b64 exec, 0xffff
    buffer_store_dword v127, v10, s[32:35], s16 offen sc1
    s_setprio 0
    s_mov_b64 exec, -1
L_PE:
    s_load_dwordx2 s[24:25], s[32:33], s92 offset:1536 glc
    s_and_b32 s96, s3, 3
    s_mul_i32 s97, s96, 4608
    s_lshl_b32 s98, s76, 6
    s_add_u32 s16, s97, s98
    v_and_b32 v23, 31, v1
    v_mul_u32_u24 v23, 144, v23
    v_lshrrev_b32 v9, 5, v1
    v_lshl_add_u32 v23, v9, 5, v23
    v_add_u32 v23, s16, v23
    ds_write_b128 v23, v[12:15]
    ds_write_b128 v23, v[16:19] offset:16
    v_add_u32 v23, 139776, v23
    s_lshl3_add_u32 s96, s21, s3
    s_lshl_b32 s97, s96, 5
    s_sub_u32 s15, 4094, s97
    v_and_b32 v22, 15, v1
    v_lshlrev_b32 v22, 1, v22
    v_sub_u32 v22, s15, v22
    s_lshl_b32 s96, s3, 7
    s_add_u32 s15, s96, 135168
    v_and_b32 v8, 15, v1
    v_lshl_add_u32 v8, v8, 3, s15
    s_and_b32 s96, s3, 3
    s_lshl_b32 s97, s96, 8
    s_add_u32 s15, s97, 135168
    v_and_b32 v10, 31, v1
    v_lshl_add_u32 v10, v10, 3, s15
    v_and_b32 v11, 7, v1
    v_lshlrev_b32 v11, 3, v11
    v_add_u32 v11, 136192, v11
    s_waitcnt vmcnt(3)
    v_cmp_ne_u32 vcc, s4, v27
    s_cbranch_vccz TOK_38
POLL_39:
    buffer_load_dwordx2 v[26:27], v25, s[32:35], s18 offen sc1
    s_waitcnt vmcnt(0)
    v_cmp_ne_u32 vcc, s4, v27
    s_cbranch_vccz PDONE_40
    s_add_u32 s5, s5, 1
    s_cmp_lt_u32 s5, 300000
    s_cbranch_scc1 POLL_39
PDONE_40:
TOK_38:
    v_add_f32_dpp v26, v26, v26 quad_perm:[1,0,3,2] row_mask:0xf bank_mask:0xf
    s_nop 1
    v_add_f32_dpp v26, v26, v26 quad_perm:[2,3,0,1] row_mask:0xf bank_mask:0xf
    s_nop 1
    v_add_f32_dpp v26, v26, v26 row_half_mirror row_mask:0xf bank_mask:0xf
    s_nop 1
    v_add_f32_dpp v26, v26, v26 row_ror:8 row_mask:0xf bank_mask:0xf
    s_cmp_lg_u32 s3, 1
    s_cbranch_scc1 L_NOCT
    v_and_b32 v5, 15, v1
    v_lshlrev_b32 v5, 3, v5
    v_add_u32 v5, 139008, v5
    ds_read_b64 v[150:151], v5
    ds_read_b64 v[154:155], v5 offset:128
    ds_read_b64 v[156:157], v5 offset:384
    s_waitcnt lgkmcnt(0)
    v_lshlrev_b32 v148, 16, v150
    v_and_b32 v149, s6, v150
    v_lshlrev_b32 v150, 16, v151
    v_and_b32 v151, s6, v151
    v_lshlrev_b32 v152, 16, v154
    v_and_b32 v153, s6, v154
    v_lshlrev_b32 v154, 16, v155
    v_and_b32 v155, s6, v155
L_NOCT:
    s_lshl3_add_u32 s15, s3, 136192
    v_mov_b32 v5, s15
    v_and_b32 v6, 3, v1
    v_lshlrev_b32 v6, 18, v6
    v_bfe_u32 v9, v1, 2, 2
    v_lshl_add_u32 v6, v9, 13, v6
    s_and_b32 s96, s21, 1
    s_and_b32 s97, s12, 7
    s_lshr_b32 s98, s12, 3
    s_lshl3_add_u32 s99, s97, s98
    s_lshl_b32 s97, s99, 12
    s_lshr_b32 s98, s21, 1
    s_lshl_b32 s99, s98, 6
    s_add_u32 s98, s97, s99
    s_lshl4_add_u32 s97, s96, s98
    s_add_u32 s99, s97, 1048576
    s_add_u32 s14, s99, 2560
    s_cmp_lt_u32 s3, 4
    s_cbranch_scc1 L_NOST
    s_sub_u32 s96, s3, 4
    s_lshl_b32 s97, s96, 12
    s_add_u32 s13, s97, 32768
    v_add_u32 v4, s13, v2
    v_add_u32 v7, 65536, v4
    ds_write_b128 v4, v[176:179] offset:16384
    ds_write_b128 v4, v[180:183]
    ds_write_b128 v4, v[184:187] offset:49152
    ds_write_b128 v4, v[188:191] offset:32768
    ds_write_b128 v4, v[192:195] offset:17408
    ds_write_b128 v4, v[196:199] offset:1024
    ds_write_b128 v4, v[200:203] offset:50176
    ds_write_b128 v4, v[204:207] offset:33792
    ds_write_b128 v4, v[208:211] offset:18432
    ds_write_b128 v4, v[212:215] offset:2048
    ds_write_b128 v4, v[216:219] offset:51200
    ds_write_b128 v4, v[220:223] offset:34816
L_NOST:
    s_branch SCHK_36
SPOLL_35:
    s_load_dwordx2 s[24:25], s[32:33], s92 offset:1536 glc
SCHK_36:
    s_add_u32 s5, s5, 1
    s_cmp_ge_u32 s5, 300000
    s_waitcnt lgkmcnt(0)
    s_cbranch_scc1 SDONE_37
    s_cmp_lg_u32 s24, s4
    s_cbranch_scc1 SPOLL_35
    s_cmp_lg_u32 s25, s4
    s_cbranch_scc1 SPOLL_35
SDONE_37:
    s_barrier
    s_mov_b32 s13, s17
    buffer_load_dwordx4 v[124:127], v44, s[32:35], s13 offen sc1
    s_add_u32 s13, s17, 8192
    buffer_load_dwordx4 v[128:131], v44, s[32:35], s13 offen sc1
    s_add_u32 s13, s17, 16384
    buffer_load_dwordx4 v[132:135], v44, s[32:35], s13 offen sc1
    s_add_u32 s13, s17, 24576
    buffer_load_dwordx4 v[136:139], v44, s[32:35], s13 offen sc1
    v_lshlrev_b32 v28, 16, v12
    v_and_b32 v29, s6, v12
    v_lshlrev_b32 v30, 16, v13
    v_and_b32 v31, s6, v13
    v_lshlrev_b32 v32, 16, v14
    v_and_b32 v33, s6, v14
    v_lshlrev_b32 v34, 16, v15
    v_and_b32 v35, s6, v15
    v_lshlrev_b32 v36, 16, v16
    v_and_b32 v37, s6, v16
    v_lshlrev_b32 v38, 16, v17
    v_and_b32 v39, s6, v17
    v_lshlrev_b32 v40, 16, v18
    v_and_b32 v41, s6, v18
    v_lshlrev_b32 v42, 16, v19
    v_and_b32 v43, s6, v19
    v_mul_u32_u24_dpp v92, v68, v52 row_newbcast:0 row_mask:0xf bank_mask:0xf
    v_and_b32_dpp v93, v68, v53 row_newbcast:0 row_mask:0xf bank_mask:0xf
    v_mul_u32_u24_dpp v94, v68, v52 row_newbcast:1 row_mask:0xf bank_mask:0xf
    v_and_b32_dpp v95, v68, v53 row_newbcast:1 row_mask:0xf bank_mask:0xf
    v_mul_u32_u24_dpp v96, v68, v52 row_newbcast:2 row_mask:0xf bank_mask:0xf
    v_and_b32_dpp v97, v68, v53 row_newbcast:2 row_mask:0xf bank_mask:0xf
    v_mul_u32_u24_dpp v98, v68, v52 row_newbcast:3 row_mask:0xf bank_mask:0xf
    v_and_b32_dpp v99, v68, v53 row_newbcast:3 row_mask:0xf bank_mask:0xf
    v_mul_u32_u24_dpp v100, v68, v52 row_newbcast:4 row_mask:0xf bank_mask:0xf
    v_and_b32_dpp v101, v68, v53 row_newbcast:4 row_mask:0xf bank_mask:0xf
    v_mul_u32_u24_dpp v102, v68, v52 row_newbcast:5 row_mask:0xf bank_mask:0xf
    v_and_b32_dpp v103, v68, v53 row_newbcast:5 row_mask:0xf bank_mask:0xf
    v_mul_u32_u24_dpp v104, v68, v52 row_newbcast:6 row_mask:0xf bank_mask:0xf
    v_and_b32_dpp v105, v68, v53 row_newbcast:6 row_mask:0xf bank_mask:0xf
    v_mul_u32_u24_dpp v106, v68, v52 row_newbcast:7 row_mask:0xf bank_mask:0xf
    v_and_b32_dpp v107, v68, v53 row_newbcast:7 row_mask:0xf bank_mask:0xf
    v_mul_u32_u24_dpp v108, v69, v52 row_newbcast:0 row_mask:0xf bank_mask:0xf
    v_and_b32_dpp v109, v69, v53 row_newbcast:0 row_mask:0xf bank_mask:0xf
    v_mul_u32_u24_dpp v110, v69, v52 row_newbcast:1 row_mask:0xf bank_mask:0xf
    v_and_b32_dpp v111, v69, v53 row_newbcast:1 row_mask:0xf bank_mask:0xf
    v_mul_u32_u24_dpp v112, v69, v52 row_newbcast:2 row_mask:0xf bank_mask:0xf
    v_and_b32_dpp v113, v69, v53 row_newbcast:2 row_mask:0xf bank_mask:0xf
    v_mul_u32_u24_dpp v114, v69, v52 row_newbcast:3 row_mask:0xf bank_mask:0xf
    v_and_b32_dpp v115, v69, v53 row_newbcast:3 row_mask:0xf bank_mask:0xf
    v_mul_u32_u24_dpp v116, v69, v52 row_newbcast:4 row_mask:0xf bank_mask:0xf
    v_and_b32_dpp v117, v69, v53 row_newbcast:4 row_mask:0xf bank_mask:0xf
    v_mul_u32_u24_dpp v118, v69, v52 row_newbcast:5 row_mask:0xf bank_mask:0xf
    v_and_b32_dpp v119, v69, v53 row_newbcast:5 row_mask:0xf bank_mask:0xf
    v_mul_u32_u24_dpp v120, v69, v52 row_newbcast:6 row_mask:0xf bank_mask:0xf
    v_and_b32_dpp v121, v69, v53 row_newbcast:6 row_mask:0xf bank_mask:0xf
    v_mul_u32_u24_dpp v122, v69, v52 row_newbcast:7 row_mask:0xf bank_mask:0xf
    v_and_b32_dpp v123, v69, v53 row_newbcast:7 row_mask:0xf bank_mask:0xf
    s_waitcnt vmcnt(0)
    v_bitop3_b32 v4, v127, v131, s4 bitop3:0x7e
    v_bitop3_b32 v4, v4, v135, s4 bitop3:0xf6
    v_bitop3_b32 v4, v4, v139, s4 bitop3:0xf6
    v_cmp_ne_u32 vcc, 0, v4
    s_cbranch_vccz TOK_42
POLL_43:
    s_mov_b32 s13, s17
    buffer_load_dwordx4 v[124:127], v44, s[32:35], s13 offen sc1
    s_add_u32 s13, s17, 8192
    buffer_load_dwordx4 v[128:131], v44, s[32:35], s13 offen sc1
    s_add_u32 s13, s17, 16384
    buffer_load_dwordx4 v[132:135], v44, s[32:35], s13 offen sc1
    s_add_u32 s13, s17, 24576
    buffer_load_dwordx4 v[136:139], v44, s[32:35], s13 offen sc1
    s_waitcnt vmcnt(0)
    v_bitop3_b32 v4, v127, v131, s4 bitop3:0x7e
    v_bitop3_b32 v4, v4, v135, s4 bitop3:0xf6
    v_bitop3_b32 v4, v4, v139, s4 bitop3:0xf6
    v_cmp_ne_u32 vcc, 0, v4
    s_cbranch_vccz PDONE_44
    s_add_u32 s5, s5, 1
    s_cmp_lt_u32 s5, 300000
    s_cbranch_scc1 POLL_43
PDONE_44:
TOK_42:
    v_pk_add_f32 v[124:125], v[124:125], v[128:129]
    v_pk_add_f32 v[132:133], v[132:133], v[136:137]
    v_add_f32 v126, v126, v130
    v_add_f32 v134, v134, v138
    v_pk_add_f32 v[124:125], v[124:125], v[132:133]
    v_add_f32 v126, v126, v134
    v_mov_b32 v127, v125
    s_nop 0
    v_permlane32_swap_b32 v124, v126
    v_permlane32_swap_b32 v125, v127
    v_add_f32 v124, v124, v126
    v_add_f32 v125, v125, v127
    s_nop 1
    v_permlane16_swap_b32 v124, v125
    v_add_f32 v127, v124, v125
    v_add_f32 v124, v124, v125
    s_nop 1
    v_permlane16_swap_b32 v124, v127
    v_mul_f32 v126, 0x3a800000, v124
    v_mul_f32 v124, 0x3a800000, v124
    s_nop 1
    v_permlane32_swap_b32 v124, v126
    v_fma_f32 v21, -v124, v124, v126
    v_cvt_pk_bf16_f32 v20, 0, v124
    v_max_f32 v21, 0, v21
    v_cvt_pk_bf16_f32 v21, 0, v21
    v_add_f32 v21, 0x3727c5ac, v21
    v_cvt_pk_bf16_f32 v21, 0, v21
    v_sqrt_f32 v21, v21
    s_nop 0
    v_cvt_pk_bf16_f32 v21, 0, v21
    v_rcp_f32 v21, v21
    v_fma_f32 v127, -v20, v26, v127
    v_mul_f32 v127, v127, v21
    ds_write_b64 v8, v[20:21]
    s_movk_i32 s13, 0xfff
    v_ashrrev_i32 v124, 31, v127
    v_or_b32 v124, 0x80000000, v124
    v_xor_b32 v124, v124, v127
    v_bfi_b32 v48, s13, v22, v124
    s_nop 1
    v_min_u32_dpp v49, v48, v48 row_ror:8 row_mask:0xf bank_mask:0xf
    v_max_u32_dpp v48, v48, v48 row_ror:8 row_mask:0xf bank_mask:0xf
    s_nop 1
    v_min_u32_dpp v50, v48, v48 row_ror:4 row_mask:0xf bank_mask:0xf
    v_max_u32_dpp v49, v49, v49 row_ror:4 row_mask:0xf bank_mask:0xf
    v_max_u32_dpp v48, v48, v48 row_ror:4 row_mask:0xf bank_mask:0xf
    v_max_u32 v49, v49, v50
    s_nop 0
    v_min_u32_dpp v50, v48, v48 row_ror:2 row_mask:0xf bank_mask:0xf
    v_max_u32_dpp v49, v49, v49 row_ror:2 row_mask:0xf bank_mask:0xf
    v_max_u32_dpp v48, v48, v48 row_ror:2 row_mask:0xf bank_mask:0xf
    v_max_u32 v49, v49, v50
    s_nop 0
    v_min_u32_dpp v50, v48, v48 row_ror:1 row_mask:0xf bank_mask:0xf
    v_max_u32_dpp v49, v49, v49 row_ror:1 row_mask:0xf bank_mask:0xf
    v_max_u32_dpp v48, v48, v48 row_ror:1 row_mask:0xf bank_mask:0xf
    v_max_u32 v49, v49, v50
    ds_write_b64 v5, v[48:49]
    s_lshl2_add_u32 s96, s74, s75
    s_lshl_b32 s97, s96, 11
    s_lshl_b32 s98, s3, 8
    s_add_u32 s99, s97, s98
    s_add_u32 s15, s99, 20971520
    v_lshlrev_b32 v44, 7, v1
    s_mov_b64 exec, 3
    buffer_load_dword v44, v44, s[32:35], s15 offen
    s_mov_b64 exec, -1
    s_add_u32 s15, s81, 4096
    s_lshl2_add_u32 m0, s89, 99328
    s_nop 0
    buffer_load_dwordx4 v73, s[60:63], s15 offen nt lds
    s_waitcnt lgkmcnt(0)
    s_barrier
    s_cmp_ge_u32 s3, 2
    s_cbranch_scc1 L_PR1
    s_setprio 3
L_PR1:
    ds_read_b64 v[48:49], v11
    ds_read_b64 v[20:21], v10
    s_waitcnt lgkmcnt(1)
    v_min_u32_dpp v50, v48, v48 quad_perm:[1,0,3,2] row_mask:0xf bank_mask:0xf
    v_max_u32_dpp v49, v49, v49 quad_perm:[1,0,3,2] row_mask:0xf bank_mask:0xf
    v_max_u32_dpp v48, v48, v48 quad_perm:[1,0,3,2] row_mask:0xf bank_mask:0xf
    v_max_u32 v49, v49, v50
    s_nop 0
    v_min_u32_dpp v50, v48, v48 quad_perm:[2,3,0,1] row_mask:0xf bank_mask:0xf
    v_max_u32_dpp v49, v49, v49 quad_perm:[2,3,0,1] row_mask:0xf bank_mask:0xf
    v_max_u32_dpp v48, v48, v48 quad_perm:[2,3,0,1] row_mask:0xf bank_mask:0xf
    v_max_u32 v49, v49, v50
    s_nop 0
    v_min_u32_dpp v50, v48, v48 row_half_mirror row_mask:0xf bank_mask:0xf
    v_max_u32_dpp v49, v49, v49 row_half_mirror row_mask:0xf bank_mask:0xf
    v_max_u32_dpp v48, v48, v48 row_half_mirror row_mask:0xf bank_mask:0xf
    v_max_u32 v49, v49, v50
    v_or_b32 v50, 1, v49
    v_mov_b32 v49, s4
    v_mov_b32 v51, s4
    s_cmp_lg_u32 s3, 0
    s_cbranch_scc1 L_NOF
    s_mov_b64 exec, 0xffff
    buffer_store_dwordx4 v[48:51], v6, s[32:35], s14 offen sc1
    s_mov_b64 exec, -1
L_NOF:
    s_cmp_lg_u32 s3, 1
    s_cbranch_scc1 L_NOC
    v_and_b32 v4, 16, v1
    v_cmp_eq_u32 vcc, 0, v4
    s_nop 1
    v_cndmask_b32 v4, v50, v48, vcc
    v_not_b32 v4, v4
    v_bfe_u32 v4, v4, 1, 7
    v_lshlrev_b32 v6, 3, v4
    v_mul_u32_u24 v4, 144, v4
    v_add_u32 v6, 135168, v6
    v_and_b32 v5, 15, v1
    v_lshlrev_b32 v5, 3, v5
    v_add_u32 v4, v4, v5
    ds_read_b64 v[128:129], v6
    ds_read_b64 v[124:125], v4 offset:0
    v_and_b32 v6, 15, v1
    v_lshlrev_b32 v6, 4, v6
    v_bfe_u32 v9, v1, 4, 1
    v_lshl_add_u32 v6, v9, 14, v6
    v_lshrrev_b32 v9, 5, v1
    v_lshl_add_u32 v6, v9, 12, v6
    v_bfe_u32 v7, v1, 4, 1
    v_lshlrev_b32 v7, 14, v7
    v_and_b32 v9, 3, v1
    v_lshl_add_u32 v7, v9, 4, v7
    s_lshl_b32 s96, s21, 15
    s_lshl_b32 s97, s12, 8
    s_add_u32 s98, s96, s97
    s_add_u32 s13, s98, 33554432
    s_lshl_b32 s96, s21, 15
    s_lshl_b32 s97, s12, 6
    s_add_u32 s98, s96, s97
    s_add_u32 s99, s98, 8192
    s_add_u32 s16, s99, 33554432
    v_mov_b32 v127, s4
    s_waitcnt lgkmcnt(0)
    v_lshlrev_b32 v132, 16, v124
    v_and_b32 v133, s6, v124
    v_lshlrev_b32 v134, 16, v125
    v_and_b32 v135, s6, v125
    v_pk_add_f32 v[132:133], v[132:133], v[128:129] op_sel_hi:[1,0] neg_lo:[0,1] neg_hi:[0,1]
    v_pk_add_f32 v[134:135], v[134:135], v[128:129] op_sel_hi:[1,0] neg_lo:[0,1] neg_hi:[0,1]
    v_cvt_pk_bf16_f32 v132, 0, v132
    v_cvt_pk_bf16_f32 v133, 0, v133
    v_cvt_pk_bf16_f32 v134, 0, v134
    v_cvt_pk_bf16_f32 v135, 0, v135
    v_pk_mul_f32 v[132:133], v[132:133], v[128:129] op_sel:[0,1]
    v_pk_mul_f32 v[134:135], v[134:135], v[128:129] op_sel:[0,1]
    v_cvt_pk_bf16_f32 v132, 0, v132
    v_cvt_pk_bf16_f32 v133, 0, v133
    v_cvt_pk_bf16_f32 v134, 0, v134
    v_cvt_pk_bf16_f32 v135, 0, v135
    v_pk_mul_f32 v[132:133], v[132:133], v[152:153]
    v_pk_mul_f32 v[134:135], v[134:135], v[154:155]
    v_cvt_pk_bf16_f32 v132, 0, v132
    v_cvt_pk_bf16_f32 v133, 0, v133
    v_cvt_pk_bf16_f32 v134, 0, v134
    v_cvt_pk_bf16_f32 v135, 0, v135
    v_pk_add_f32 v[132:133], v[132:133], v[148:149]
    v_pk_add_f32 v[134:135], v[134:135], v[150:151]
    v_mov_b32 v126, v125
    v_mov_b32 v125, s4
    s_mov_b32 exec_hi, 0
    v_cvt_pk_bf16_f32 v124, v132, v133
    v_cvt_pk_bf16_f32 v126, v134, v135
    s_mov_b32 exec_hi, -1
    v_dot2_f32_bf16 v128, v124, v156, 0
    v_mov_b32 v129, s4
    v_dot2_f32_bf16 v128, v126, v157, v128
    buffer_store_dwordx4 v[124:127], v6, s[32:35], s13 offen sc1
    s_nop 1
    v_add_f32_dpp v128, v128, v128 quad_perm:[1,0,3,2] row_mask:0xf bank_mask:0xf
    s_nop 1
    v_add_f32_dpp v128, v128, v128 quad_perm:[2,3,0,1] row_mask:0xf bank_mask:0xf
    s_nop 1
    v_add_f32_dpp v128, v128, v128 row_half_mirror row_mask:0xf bank_mask:0xf
    s_nop 1
    v_add_f32_dpp v128, v128, v128 row_ror:8 row_mask:0xf bank_mask:0xf
    v_mov_b32 v130, v128
    v_mov_b32 v131, s4
    s_mov_b64 exec, 0xf000f
    buffer_store_dwordx4 v[128:131], v7, s[32:35], s16 offen sc1
    s_mov_b64 exec, -1
L_NOC:
    s_waitcnt lgkmcnt(0)
    s_setprio 0
    s_mov_b64 exec, 0xff
    buffer_store_dwordx4 v[224:227], v228, s[32:35], 0 offen sc1
    s_mov_b64 exec, -1
    s_add_u32 s13, s81, 8192
    s_lshl2_add_u32 m0, s89, 100352
    s_nop 0
    buffer_load_dwordx4 v73, s[60:63], s13 offen nt lds
    s_load_dwordx8 s[24:31], s[32:33], s92 offset:2560 glc
    v_pk_add_f32 v[76:77], v[28:29], v[20:21] op_sel_hi:[1,0] neg_lo:[0,1] neg_hi:[0,1]
    v_pk_add_f32 v[78:79], v[30:31], v[20:21] op_sel_hi:[1,0] neg_lo:[0,1] neg_hi:[0,1]
    v_pk_add_f32 v[80:81], v[32:33], v[20:21] op_sel_hi:[1,0] neg_lo:[0,1] neg_hi:[0,1]
    v_pk_add_f32 v[82:83], v[34:35], v[20:21] op_sel_hi:[1,0] neg_lo:[0,1] neg_hi:[0,1]
    v_pk_add_f32 v[84:85], v[36:37], v[20:21] op_sel_hi:[1,0] neg_lo:[0,1] neg_hi:[0,1]
    v_pk_add_f32 v[86:87], v[38:39], v[20:21] op_sel_hi:[1,0] neg_lo:[0,1] neg_hi:[0,1]
    v_pk_add_f32 v[88:89], v[40:41], v[20:21] op_sel_hi:[1,0] neg_lo:[0,1] neg_hi:[0,1]
    v_pk_add_f32 v[90:91], v[42:43], v[20:21] op_sel_hi:[1,0] neg_lo:[0,1] neg_hi:[0,1]
    v_cvt_pk_bf16_f32 v76, 0, v76
    v_cvt_pk_bf16_f32 v77, 0, v77
    v_cvt_pk_bf16_f32 v78, 0, v78
    v_cvt_pk_bf16_f32 v79, 0, v79
    v_cvt_pk_bf16_f32 v80, 0, v80
    v_cvt_pk_bf16_f32 v81, 0, v81
    v_cvt_pk_bf16_f32 v82, 0, v82
    v_cvt_pk_bf16_f32 v83, 0, v83
    v_cvt_pk_bf16_f32 v84, 0, v84
    v_cvt_pk_bf16_f32 v85, 0, v85
    v_cvt_pk_bf16_f32 v86, 0, v86
    v_cvt_pk_bf16_f32 v87, 0, v87
    v_cvt_pk_bf16_f32 v88, 0, v88
    v_cvt_pk_bf16_f32 v89, 0, v89
    v_cvt_pk_bf16_f32 v90, 0, v90
    v_cvt_pk_bf16_f32 v91, 0, v91
    v_pk_mul_f32 v[76:77], v[76:77], v[20:21] op_sel:[0,1]
    v_pk_mul_f32 v[78:79], v[78:79], v[20:21] op_sel:[0,1]
    v_pk_mul_f32 v[80:81], v[80:81], v[20:21] op_sel:[0,1]
    v_pk_mul_f32 v[82:83], v[82:83], v[20:21] op_sel:[0,1]
    v_pk_mul_f32 v[84:85], v[84:85], v[20:21] op_sel:[0,1]
    v_pk_mul_f32 v[86:87], v[86:87], v[20:21] op_sel:[0,1]
    v_pk_mul_f32 v[88:89], v[88:89], v[20:21] op_sel:[0,1]
    v_pk_mul_f32 v[90:91], v[90:91], v[20:21] op_sel:[0,1]
    v_cvt_pk_bf16_f32 v76, 0, v76
    v_cvt_pk_bf16_f32 v77, 0, v77
    v_cvt_pk_bf16_f32 v78, 0, v78
    v_cvt_pk_bf16_f32 v79, 0, v79
    v_cvt_pk_bf16_f32 v80, 0, v80
    v_cvt_pk_bf16_f32 v81, 0, v81
    v_cvt_pk_bf16_f32 v82, 0, v82
    v_cvt_pk_bf16_f32 v83, 0, v83
    v_cvt_pk_bf16_f32 v84, 0, v84
    v_cvt_pk_bf16_f32 v85, 0, v85
    v_cvt_pk_bf16_f32 v86, 0, v86
    v_cvt_pk_bf16_f32 v87, 0, v87
    v_cvt_pk_bf16_f32 v88, 0, v88
    v_cvt_pk_bf16_f32 v89, 0, v89
    v_cvt_pk_bf16_f32 v90, 0, v90
    v_cvt_pk_bf16_f32 v91, 0, v91
    v_pk_mul_f32 v[76:77], v[76:77], v[108:109]
    v_pk_mul_f32 v[78:79], v[78:79], v[110:111]
    v_pk_mul_f32 v[80:81], v[80:81], v[112:113]
    v_pk_mul_f32 v[82:83], v[82:83], v[114:115]
    v_pk_mul_f32 v[84:85], v[84:85], v[116:117]
    v_pk_mul_f32 v[86:87], v[86:87], v[118:119]
    v_pk_mul_f32 v[88:89], v[88:89], v[120:121]
    v_pk_mul_f32 v[90:91], v[90:91], v[122:123]
    v_cvt_pk_bf16_f32 v76, 0, v76
    v_cvt_pk_bf16_f32 v77, 0, v77
    v_cvt_pk_bf16_f32 v78, 0, v78
    v_cvt_pk_bf16_f32 v79, 0, v79
    v_cvt_pk_bf16_f32 v80, 0, v80
    v_cvt_pk_bf16_f32 v81, 0, v81
    v_cvt_pk_bf16_f32 v82, 0, v82
    v_cvt_pk_bf16_f32 v83, 0, v83
    v_cvt_pk_bf16_f32 v84, 0, v84
    v_cvt_pk_bf16_f32 v85, 0, v85
    v_cvt_pk_bf16_f32 v86, 0, v86
    v_cvt_pk_bf16_f32 v87, 0, v87
    v_cvt_pk_bf16_f32 v88, 0, v88
    v_cvt_pk_bf16_f32 v89, 0, v89
    v_cvt_pk_bf16_f32 v90, 0, v90
    v_cvt_pk_bf16_f32 v91, 0, v91
    v_pk_add_f32 v[76:77], v[76:77], v[92:93]
    v_pk_add_f32 v[78:79], v[78:79], v[94:95]
    v_pk_add_f32 v[80:81], v[80:81], v[96:97]
    v_pk_add_f32 v[82:83], v[82:83], v[98:99]
    v_pk_add_f32 v[84:85], v[84:85], v[100:101]
    v_pk_add_f32 v[86:87], v[86:87], v[102:103]
    v_pk_add_f32 v[88:89], v[88:89], v[104:105]
    v_pk_add_f32 v[90:91], v[90:91], v[106:107]
    v_cvt_pk_bf16_f32 v76, 0, v76
    v_cvt_pk_bf16_f32 v77, 0, v77
    v_cvt_pk_bf16_f32 v78, 0, v78
    v_cvt_pk_bf16_f32 v79, 0, v79
    v_cvt_pk_bf16_f32 v80, 0, v80
    v_cvt_pk_bf16_f32 v81, 0, v81
    v_cvt_pk_bf16_f32 v82, 0, v82
    v_cvt_pk_bf16_f32 v83, 0, v83
    v_cvt_pk_bf16_f32 v84, 0, v84
    v_cvt_pk_bf16_f32 v85, 0, v85
    v_cvt_pk_bf16_f32 v86, 0, v86
    v_cvt_pk_bf16_f32 v87, 0, v87
    v_cvt_pk_bf16_f32 v88, 0, v88
    v_cvt_pk_bf16_f32 v89, 0, v89
    v_cvt_pk_bf16_f32 v90, 0, v90
    v_cvt_pk_bf16_f32 v91, 0, v91
    s_lshr_b32 s96, s3, 2
    s_lshl_b32 s97, s96, 15
    s_and_b32 s98, s3, 3
    s_lshl_b32 s99, s98, 5
    s_add_u32 s96, s97, s99
    s_add_u32 s13, s96, 32768
    v_lshrrev_b32 v24, 4, v1
    v_lshlrev_b32 v24, 13, v24
    v_bfe_u32 v9, v1, 2, 2
    v_lshl_add_u32 v24, v9, 7, v24
    v_bfe_u32 v9, v1, 3, 2
    v_lshl_add_u32 v24, v9, 5, v24
    v_and_b32 v9, 3, v1
    v_lshl_add_u32 v24, v9, 3, v24
    v_xor_b32 v24, s13, v24
    s_lshl_b32 s13, s3, 6
    v_bfe_u32 v45, v1, 2, 1
    v_lshlrev_b32 v45, 9, v45
    v_bfe_u32 v9, v1, 3, 1
    v_lshl_add_u32 v45, v9, 12, v45
    v_lshrrev_b32 v9, 5, v1
    v_lshl_add_u32 v45, v9, 11, v45
    v_bfe_u32 v9, v1, 2, 2
    v_lshl_add_u32 v45, v9, 6, v45
    v_bfe_u32 v9, v1, 4, 1
    v_lshl_add_u32 v45, v9, 5, v45
    v_and_b32 v9, 3, v1
    v_lshl_add_u32 v45, v9, 3, v45
    v_xor_b32 v45, s13, v45
    v_add_u32 v45, 98304, v45
    v_and_b32 v46, 7, v1
    v_lshlrev_b32 v46, 4, v46
    v_lshrrev_b32 v9, 4, v1
    v_lshl_add_u32 v46, v9, 7, v46
    v_add_u32 v46, 136704, v46
    s_lshl_b32 s13, s75, 10
    v_add_u32 v54, s13, v2
    v_and_b32 v55, 15, v1
    v_lshlrev_b32 v55, 6, v55
    v_add_u32 v55, 8192, v55
    s_lshl_b32 s96, s74, 13
    s_add_u32 s84, s96, 20971520
    s_mul_i32 s96, s90, s76
    s_lshl_b32 s97, s96, 13
    s_lshl3_add_u32 s98, s75, s3
    s_lshl_b32 s99, s98, 8
    s_add_u32 s96, s97, s99
    s_add_u32 s20, s96, s84
    s_lshl4_add_u32 s13, s3, 136256
    v_mov_b32 v4, s13
    v_and_b32 v5, 7, v1
    v_lshlrev_b32 v5, 4, v5
    v_add_u32 v5, 136256, v5
    v_and_b32 v8, 8, v1
    v_cmp_eq_u32 s[22:23], 0, v8
    s_branch SCHK_46
SPOLL_45:
    s_load_dwordx8 s[24:31], s[32:33], s92 offset:2560 glc
SCHK_46:
    s_add_u32 s5, s5, 1
    s_cmp_ge_u32 s5, 300000
    s_waitcnt lgkmcnt(0)
    s_cbranch_scc1 SDONE_47
    s_cmp_lg_u32 s25, s4
    s_cbranch_scc1 SPOLL_45
    s_cmp_lg_u32 s27, s4
    s_cbranch_scc1 SPOLL_45
    s_cmp_lg_u32 s29, s4
    s_cbranch_scc1 SPOLL_45
    s_cmp_lg_u32 s31, s4
    s_cbranch_scc1 SPOLL_45
SDONE_47:
    s_min_u32 s25, s24, s28
    s_max_u32 s24, s24, s28
    s_max_u32 s27, s26, s30
    s_min_u32 s26, s26, s30
    s_max_u32 s28, s25, s27
    s_min_u32 s25, s25, s27
    v_mov_b32 v148, s24
    v_mov_b32 v151, s26
    v_mov_b32 v149, s28
    v_mov_b32 v150, s25
    ds_write_b128 v4, v[148:151]
    s_waitcnt lgkmcnt(0)
    s_barrier
    s_cmp_lt_u32 s3, 4
    s_cbranch_scc1 L_CSEL
    ds_read_b64_tr_b16 v[164:165], v24
    ds_read_b64_tr_b16 v[166:167], v24 offset:512
    ds_read_b64_tr_b16 v[168:169], v24 offset:1024
    ds_read_b64_tr_b16 v[170:171], v24 offset:1536
    ds_read_b64_tr_b16 v[172:173], v24 offset:2048
    ds_read_b64_tr_b16 v[174:175], v24 offset:2560
    ds_read_b64_tr_b16 v[176:177], v24 offset:3072
    ds_read_b64_tr_b16 v[178:179], v24 offset:3584
    ds_read_b64_tr_b16 v[180:181], v24 offset:4096
    ds_read_b64_tr_b16 v[182:183], v24 offset:4608
    ds_read_b64_tr_b16 v[184:185], v24 offset:5120
    ds_read_b64_tr_b16 v[186:187], v24 offset:5632
    ds_read_b64_tr_b16 v[188:189], v24 offset:6144
    ds_read_b64_tr_b16 v[190:191], v24 offset:6656
    ds_read_b64_tr_b16 v[192:193], v24 offset:7168
    ds_read_b64_tr_b16 v[194:195], v24 offset:7680
    v_mul_u32_u24_dpp v92, v70, v52 row_newbcast:0 row_mask:0xf bank_mask:0xf
    v_and_b32_dpp v93, v70, v53 row_newbcast:0 row_mask:0xf bank_mask:0xf
    v_mul_u32_u24_dpp v94, v70, v52 row_newbcast:1 row_mask:0xf bank_mask:0xf
    v_and_b32_dpp v95, v70, v53 row_newbcast:1 row_mask:0xf bank_mask:0xf
    v_mul_u32_u24_dpp v96, v70, v52 row_newbcast:2 row_mask:0xf bank_mask:0xf
    v_and_b32_dpp v97, v70, v53 row_newbcast:2 row_mask:0xf bank_mask:0xf
    v_mul_u32_u24_dpp v98, v70, v52 row_newbcast:3 row_mask:0xf bank_mask:0xf
    v_and_b32_dpp v99, v70, v53 row_newbcast:3 row_mask:0xf bank_mask:0xf
    v_mul_u32_u24_dpp v100, v70, v52 row_newbcast:4 row_mask:0xf bank_mask:0xf
    v_and_b32_dpp v101, v70, v53 row_newbcast:4 row_mask:0xf bank_mask:0xf
    v_mul_u32_u24_dpp v102, v70, v52 row_newbcast:5 row_mask:0xf bank_mask:0xf
    v_and_b32_dpp v103, v70, v53 row_newbcast:5 row_mask:0xf bank_mask:0xf
    v_mul_u32_u24_dpp v104, v70, v52 row_newbcast:6 row_mask:0xf bank_mask:0xf
    v_and_b32_dpp v105, v70, v53 row_newbcast:6 row_mask:0xf bank_mask:0xf
    v_mul_u32_u24_dpp v106, v70, v52 row_newbcast:7 row_mask:0xf bank_mask:0xf
    v_and_b32_dpp v107, v70, v53 row_newbcast:7 row_mask:0xf bank_mask:0xf
    v_pk_mul_f32 v[76:77], v[76:77], v[92:93]
    v_pk_mul_f32 v[78:79], v[78:79], v[94:95]
    v_pk_mul_f32 v[80:81], v[80:81], v[96:97]
    v_pk_mul_f32 v[82:83], v[82:83], v[98:99]
    v_pk_mul_f32 v[84:85], v[84:85], v[100:101]
    v_pk_mul_f32 v[86:87], v[86:87], v[102:103]
    v_pk_mul_f32 v[88:89], v[88:89], v[104:105]
    v_pk_mul_f32 v[90:91], v[90:91], v[106:107]
    v_cvt_pk_bf16_f32 v76, 0, v76
    v_cvt_pk_bf16_f32 v77, 0, v77
    v_cvt_pk_bf16_f32 v78, 0, v78
    v_cvt_pk_bf16_f32 v79, 0, v79
    v_cvt_pk_bf16_f32 v80, 0, v80
    v_cvt_pk_bf16_f32 v81, 0, v81
    v_cvt_pk_bf16_f32 v82, 0, v82
    v_cvt_pk_bf16_f32 v83, 0, v83
    v_cvt_pk_bf16_f32 v84, 0, v84
    v_cvt_pk_bf16_f32 v85, 0, v85
    v_cvt_pk_bf16_f32 v86, 0, v86
    v_cvt_pk_bf16_f32 v87, 0, v87
    v_cvt_pk_bf16_f32 v88, 0, v88
    v_cvt_pk_bf16_f32 v89, 0, v89
    v_cvt_pk_bf16_f32 v90, 0, v90
    v_cvt_pk_bf16_f32 v91, 0, v91
    v_pk_add_f32 v[76:77], v[76:77], v[28:29]
    v_pk_add_f32 v[78:79], v[78:79], v[30:31]
    v_pk_add_f32 v[80:81], v[80:81], v[32:33]
    v_pk_add_f32 v[82:83], v[82:83], v[34:35]
    v_pk_add_f32 v[84:85], v[84:85], v[36:37]
    v_pk_add_f32 v[86:87], v[86:87], v[38:39]
    v_pk_add_f32 v[88:89], v[88:89], v[40:41]
    v_pk_add_f32 v[90:91], v[90:91], v[42:43]
    v_cvt_pk_bf16_f32 v140, v76, v77
    v_cvt_pk_bf16_f32 v141, v78, v79
    v_cvt_pk_bf16_f32 v142, v80, v81
    v_cvt_pk_bf16_f32 v143, v82, v83
    v_cvt_pk_bf16_f32 v144, v84, v85
    v_cvt_pk_bf16_f32 v145, v86, v87
    v_cvt_pk_bf16_f32 v146, v88, v89
    v_cvt_pk_bf16_f32 v147, v90, v91
    ds_write_b128 v23, v[140:143]
    ds_write_b128 v23, v[144:147] offset:16
    s_mul_i32 s96, s3, 2304
    s_add_u32 s16, s96, 139776
    v_lshrrev_b32 v23, 3, v1
    v_mul_u32_u24 v23, 144, v23
    v_and_b32 v9, 7, v1
    v_lshl_add_u32 v23, v9, 4, v23
    v_add_u32 v23, s16, v23
    s_add_u32 s13, s81, 12288
    s_lshl2_add_u32 m0, s89, 101376
    s_nop 0
    buffer_load_dwordx4 v73, s[60:63], s13 offen nt lds
    s_branch L_CSELD
L_CSEL:
    s_setprio 3
    ds_read_b128 v[148:151], v5
    s_lshl_b32 s96, s3, 9
    s_add_u32 s13, s96, 136704
    v_add_u32 v6, s13, v63
    s_lshl2_add_u32 s13, s3, 136384
    v_mov_b32 v7, s13
    s_waitcnt lgkmcnt(0)
    v_max_u32_dpp v152, v151, v148 quad_perm:[1,0,3,2] row_mask:0xf bank_mask:0xf
    v_max_u32_dpp v153, v150, v149 quad_perm:[1,0,3,2] row_mask:0xf bank_mask:0xf
    v_max_u32_dpp v154, v149, v150 quad_perm:[1,0,3,2] row_mask:0xf bank_mask:0xf
    v_max_u32_dpp v155, v148, v151 quad_perm:[1,0,3,2] row_mask:0xf bank_mask:0xf
    v_max_u32 v156, v152, v154
    v_max_u32 v157, v153, v155
    v_min_u32 v158, v152, v154
    v_min_u32 v159, v153, v155
    v_max_u32 v148, v156, v157
    v_min_u32 v149, v156, v157
    v_max_u32 v150, v158, v159
    v_min_u32 v151, v158, v159
    s_nop 1
    v_max_u32_dpp v152, v151, v148 quad_perm:[2,3,0,1] row_mask:0xf bank_mask:0xf
    v_max_u32_dpp v153, v150, v149 quad_perm:[2,3,0,1] row_mask:0xf bank_mask:0xf
    v_max_u32_dpp v154, v149, v150 quad_perm:[2,3,0,1] row_mask:0xf bank_mask:0xf
    v_max_u32_dpp v155, v148, v151 quad_perm:[2,3,0,1] row_mask:0xf bank_mask:0xf
    v_max_u32 v156, v152, v154
    v_max_u32 v157, v153, v155
    v_min_u32 v158, v152, v154
    v_min_u32 v159, v153, v155
    v_max_u32 v148, v156, v157
    v_min_u32 v149, v156, v157
    v_max_u32 v150, v158, v159
    v_min_u32 v151, v158, v159
    s_nop 1
    v_max_u32_dpp v152, v151, v148 row_half_mirror row_mask:0xf bank_mask:0xf
    v_max_u32_dpp v153, v150, v149 row_half_mirror row_mask:0xf bank_mask:0xf
    v_max_u32_dpp v154, v149, v150 row_half_mirror row_mask:0xf bank_mask:0xf
    v_max_u32_dpp v155, v148, v151 row_half_mirror row_mask:0xf bank_mask:0xf
    v_readfirstlane_b32 s24, v152
    v_readfirstlane_b32 s25, v153
    v_readfirstlane_b32 s26, v154
    v_readfirstlane_b32 s27, v155
    s_bitcmp1_b32 s3, 0
    s_cselect_b32 s24, s25, s24
    s_cselect_b32 s26, s27, s26
    s_bitcmp1_b32 s3, 1
    s_cselect_b32 s24, s26, s24
    s_and_b32 s15, s24, 4095
    s_lshr_b32 s96, s15, 8
    s_sub_u32 s97, 15, s96
    s_and_b32 s98, s15, 1
    s_lshl1_add_u32 s99, s97, s98
    s_lshl_b32 s96, s99, 14
    s_add_u32 s13, s96, 33554432
    buffer_load_dwordx2 v[152:153], v55, s[32:35], s13 offen sc1
    buffer_load_dwordx4 v[148:151], v54, s[32:35], s13 offen sc1
    s_setprio 0
    s_add_u32 s16, s81, 12288
    s_lshl2_add_u32 m0, s89, 101376
    s_nop 0
    buffer_load_dwordx4 v73, s[60:63], s16 offen nt lds
    ds_read_b64_tr_b16 v[164:165], v24
    ds_read_b64_tr_b16 v[166:167], v24 offset:512
    ds_read_b64_tr_b16 v[168:169], v24 offset:1024
    ds_read_b64_tr_b16 v[170:171], v24 offset:1536
    ds_read_b64_tr_b16 v[172:173], v24 offset:2048
    ds_read_b64_tr_b16 v[174:175], v24 offset:2560
    ds_read_b64_tr_b16 v[176:177], v24 offset:3072
    ds_read_b64_tr_b16 v[178:179], v24 offset:3584
    ds_read_b64_tr_b16 v[180:181], v24 offset:4096
    ds_read_b64_tr_b16 v[182:183], v24 offset:4608
    ds_read_b64_tr_b16 v[184:185], v24 offset:5120
    ds_read_b64_tr_b16 v[186:187], v24 offset:5632
    ds_read_b64_tr_b16 v[188:189], v24 offset:6144
    ds_read_b64_tr_b16 v[190:191], v24 offset:6656
    ds_read_b64_tr_b16 v[192:193], v24 offset:7168
    ds_read_b64_tr_b16 v[194:195], v24 offset:7680
    v_mul_u32_u24_dpp v92, v70, v52 row_newbcast:0 row_mask:0xf bank_mask:0xf
    v_and_b32_dpp v93, v70, v53 row_newbcast:0 row_mask:0xf bank_mask:0xf
    v_mul_u32_u24_dpp v94, v70, v52 row_newbcast:1 row_mask:0xf bank_mask:0xf
    v_and_b32_dpp v95, v70, v53 row_newbcast:1 row_mask:0xf bank_mask:0xf
    v_mul_u32_u24_dpp v96, v70, v52 row_newbcast:2 row_mask:0xf bank_mask:0xf
    v_and_b32_dpp v97, v70, v53 row_newbcast:2 row_mask:0xf bank_mask:0xf
    v_mul_u32_u24_dpp v98, v70, v52 row_newbcast:3 row_mask:0xf bank_mask:0xf
    v_and_b32_dpp v99, v70, v53 row_newbcast:3 row_mask:0xf bank_mask:0xf
    v_mul_u32_u24_dpp v100, v70, v52 row_newbcast:4 row_mask:0xf bank_mask:0xf
    v_and_b32_dpp v101, v70, v53 row_newbcast:4 row_mask:0xf bank_mask:0xf
    v_mul_u32_u24_dpp v102, v70, v52 row_newbcast:5 row_mask:0xf bank_mask:0xf
    v_and_b32_dpp v103, v70, v53 row_newbcast:5 row_mask:0xf bank_mask:0xf
    v_mul_u32_u24_dpp v104, v70, v52 row_newbcast:6 row_mask:0xf bank_mask:0xf
    v_and_b32_dpp v105, v70, v53 row_newbcast:6 row_mask:0xf bank_mask:0xf
    v_mul_u32_u24_dpp v106, v70, v52 row_newbcast:7 row_mask:0xf bank_mask:0xf
    v_and_b32_dpp v107, v70, v53 row_newbcast:7 row_mask:0xf bank_mask:0xf
    v_pk_mul_f32 v[76:77], v[76:77], v[92:93]
    v_pk_mul_f32 v[78:79], v[78:79], v[94:95]
    v_pk_mul_f32 v[80:81], v[80:81], v[96:97]
    v_pk_mul_f32 v[82:83], v[82:83], v[98:99]
    v_pk_mul_f32 v[84:85], v[84:85], v[100:101]
    v_pk_mul_f32 v[86:87], v[86:87], v[102:103]
    v_pk_mul_f32 v[88:89], v[88:89], v[104:105]
    v_pk_mul_f32 v[90:91], v[90:91], v[106:107]
    v_cvt_pk_bf16_f32 v76, 0, v76
    v_cvt_pk_bf16_f32 v77, 0, v77
    v_cvt_pk_bf16_f32 v78, 0, v78
    v_cvt_pk_bf16_f32 v79, 0, v79
    v_cvt_pk_bf16_f32 v80, 0, v80
    v_cvt_pk_bf16_f32 v81, 0, v81
    v_cvt_pk_bf16_f32 v82, 0, v82
    v_cvt_pk_bf16_f32 v83, 0, v83
    v_cvt_pk_bf16_f32 v84, 0, v84
    v_cvt_pk_bf16_f32 v85, 0, v85
    v_cvt_pk_bf16_f32 v86, 0, v86
    v_cvt_pk_bf16_f32 v87, 0, v87
    v_cvt_pk_bf16_f32 v88, 0, v88
    v_cvt_pk_bf16_f32 v89, 0, v89
    v_cvt_pk_bf16_f32 v90, 0, v90
    v_cvt_pk_bf16_f32 v91, 0, v91
    v_pk_add_f32 v[76:77], v[76:77], v[28:29]
    v_pk_add_f32 v[78:79], v[78:79], v[30:31]
    v_pk_add_f32 v[80:81], v[80:81], v[32:33]
    v_pk_add_f32 v[82:83], v[82:83], v[34:35]
    v_pk_add_f32 v[84:85], v[84:85], v[36:37]
    v_pk_add_f32 v[86:87], v[86:87], v[38:39]
    v_pk_add_f32 v[88:89], v[88:89], v[40:41]
    v_pk_add_f32 v[90:91], v[90:91], v[42:43]
    v_cvt_pk_bf16_f32 v140, v76, v77
    v_cvt_pk_bf16_f32 v141, v78, v79
    v_cvt_pk_bf16_f32 v142, v80, v81
    v_cvt_pk_bf16_f32 v143, v82, v83
    v_cvt_pk_bf16_f32 v144, v84, v85
    v_cvt_pk_bf16_f32 v145, v86, v87
    v_cvt_pk_bf16_f32 v146, v88, v89
    v_cvt_pk_bf16_f32 v147, v90, v91
    ds_write_b128 v23, v[140:143]
    ds_write_b128 v23, v[144:147] offset:16
    s_mul_i32 s96, s3, 2304
    s_add_u32 s16, s96, 139776
    v_lshrrev_b32 v23, 3, v1
    v_mul_u32_u24 v23, 144, v23
    v_and_b32 v9, 7, v1
    v_lshl_add_u32 v23, v9, 4, v23
    v_add_u32 v23, s16, v23
    s_lshl2_add_u32 s15, s15, s3
    s_waitcnt vmcnt(1)
    v_bitop3_b32 v8, v149, v151, s4 bitop3:0x7e
    v_bitop3_b32 v8, v8, v153, s4 bitop3:0xf6
    v_cmp_ne_u32 vcc, 0, v8
    s_cbranch_vccz TOK_49
POLL_50:
    buffer_load_dwordx2 v[152:153], v55, s[32:35], s13 offen sc1
    buffer_load_dwordx4 v[148:151], v54, s[32:35], s13 offen sc1
    s_waitcnt vmcnt(0)
    v_bitop3_b32 v8, v149, v151, s4 bitop3:0x7e
    v_bitop3_b32 v8, v8, v153, s4 bitop3:0xf6
    v_cmp_ne_u32 vcc, 0, v8
    s_cbranch_vccz PDONE_51
    s_add_u32 s5, s5, 1
    s_cmp_lt_u32 s5, 300000
    s_cbranch_scc1 POLL_50
PDONE_51:
TOK_49:
    s_setprio 3
    ds_write2_b32 v6, v148, v150 offset0:0 offset1:1
    v_add_f32_dpp v152, v152, v152 quad_perm:[1,0,3,2] row_mask:0xf bank_mask:0xf
    s_nop 1
    v_add_f32_dpp v152, v152, v152 quad_perm:[2,3,0,1] row_mask:0xf bank_mask:0xf
    s_nop 1
    v_add_f32_dpp v152, v152, v152 row_half_mirror row_mask:0xf bank_mask:0xf
    s_nop 1
    v_add_f32_dpp v152, v152, v152 row_ror:8 row_mask:0xf bank_mask:0xf
    v_cvt_pk_bf16_f32 v152, 0, v152
    v_ashrrev_i32 v153, 31, v152
    v_or_b32 v153, 0x80000000, v153
    v_xor_b32 v152, v152, v153
    v_and_b32 v152, s6, v152
    v_or_b32 v152, s15, v152
    ds_write_b32 v7, v152
    s_setprio 0
L_CSELD:
    v_mov_b32 v4, 136384
    s_waitcnt lgkmcnt(0)
    s_barrier
    ds_read_b128 v[148:151], v4
    s_waitcnt lgkmcnt(0)
    v_max_u32 v152, v148, v149
    v_max_u32 v153, v150, v151
    v_min_u32 v154, v148, v149
    v_min_u32 v155, v150, v151
    v_min_u32 v149, v152, v153
    v_max_u32 v148, v152, v153
    v_max3_u32 v149, v149, v154, v155
    v_cndmask_b32 v4, v149, v148, s[22:23]
    v_readfirstlane_b32 s68, v148
    v_and_b32 v4, 3, v4
    v_readfirstlane_b32 s69, v149
    v_lshl_add_u32 v4, v4, 9, v46
    ds_read_b128 v[152:155], v4
    ds_read_b128 v[140:143], v23
    ds_read_b128 v[144:147], v23 offset:1152
    s_bfe_u32 s70, s68, 720899
    s_bfe_u32 s71, s69, 720899
    s_sub_u32 s70, 2047, s70
    s_sub_u32 s71, 2047, s71
    s_waitcnt lgkmcnt(2)
    v_mfma_f32_16x16x32_bf16 v[212:215], v[152:155], v[164:167], 0
    v_mfma_f32_16x16x32_bf16 v[216:219], v[152:155], v[168:171], 0
    v_mfma_f32_16x16x32_bf16 v[220:223], v[152:155], v[172:175], 0
    v_mfma_f32_16x16x32_bf16 v[224:227], v[152:155], v[176:179], 0
    v_mfma_f32_16x16x32_bf16 v[228:231], v[152:155], v[180:183], 0
    v_mfma_f32_16x16x32_bf16 v[232:235], v[152:155], v[184:187], 0
    v_mfma_f32_16x16x32_bf16 v[236:239], v[152:155], v[188:191], 0
    v_mfma_f32_16x16x32_bf16 v[240:243], v[152:155], v[192:195], 0
    s_nop 1
    v_add_f32 v148, v212, v217
    s_nop 0
    v_add_f32 v149, v222, v227
    s_nop 0
    v_add_f32 v150, v228, v233
    s_nop 0
    v_add_f32 v151, v238, v243
    v_add_f32 v148, v148, v149
    v_add_f32 v150, v150, v151
    s_nop 1
    v_permlane16_swap_b32 v150, v151
    v_add_f32 v56, v148, v151
    v_add_f32 v58, v148, v151
    v_mov_b32 v57, s4
    v_mov_b32 v59, s4
    v_permlane32_swap_b32 v56, v58
    s_cmp_ge_u32 s9, 28
    s_cbranch_scc1 L_NOHP
    s_mov_b64 exec, 0xffff
    s_cmp_lg_u32 s93, 0
    s_cbranch_scc1 LOC_52
    buffer_store_dwordx4 v[56:59], v2, s[32:35], s20 offen sc1
    s_branch LOCD_53
LOC_52:
    buffer_store_dwordx4 v[56:59], v2, s[32:35], s20 offen
LOCD_53:
    s_mov_b64 exec, -1
L_NOHP:
    v_add_u32 v60, s20, v2
    s_waitcnt lgkmcnt(0)
    s_bitcmp1_b32 s21, 2
    s_cselect_b32 s17, s71, s70
    s_cselect_b32 s18, s69, s68
    s_cmp_lg_u32 s3, 7
    s_cbranch_scc1 L_NOFZ
    s_cmp_lg_u32 s2, 0
    s_cbranch_scc1 L_NONON
    v_mov_b32 v6, s4
    s_mov_b64 exec, 1
    buffer_store_dword v6, v3, s[32:35], 0 offen sc1
    s_mov_b64 exec, -1
L_NONON:
    s_lshr_b32 s96, s21, 3
    s_and_b32 s97, s21, 1
    s_lshl1_add_u32 s19, s96, s97
    s_lshr_b32 s96, s21, 2
    s_lshl_b32 s97, s96, 1
    s_lshl3_add_u32 s98, s12, s97
    s_and_b32 s99, s21, 1
    s_add_u32 s96, s98, s99
    s_mul_i32 s97, s96, 7168
    s_add_u32 s20, s97, 22020096
    s_lshl_b32 s96, s17, 11
    s_lshl_b32 s97, s12, 7
    s_add_u32 s98, s96, s97
    s_lshl_b32 s99, s19, 5
    s_add_u32 s82, s98, s99
    v_and_b32 v10, 1, v1
    v_lshlrev_b32 v10, 2, v10
    v_bfe_u32 v9, v1, 2, 1
    v_lshl_add_u32 v10, v9, 3, v10
    v_bfe_u32 v9, v1, 1, 1
    v_lshl_add_u32 v10, v9, 4, v10
    s_lshl_b32 s96, s19, 5
    s_add_u32 s13, s96, 139264
    v_add_u32 v5, s13, v10
    ds_read_b32 v74, v5
    s_lshr_b32 s96, s17, 7
    s_bfe_u32 s97, s18, 65538
    s_lshl1_add_u32 s98, s96, s97
    s_lshl_b32 s99, s98, 14
    s_lshl_b32 s96, s12, 8
    s_add_u32 s97, s99, s96
    s_lshl_b32 s98, s19, 6
    s_add_u32 s99, s97, s98
    s_add_u32 s68, s99, 33554432
    s_add_u32 s69, s68, 4096
    v_and_b32 v11, 1, v1
    v_lshlrev_b32 v11, 3, v11
    v_bfe_u32 v9, v1, 2, 1
    v_lshl_add_u32 v11, v9, 4, v11
    v_bfe_u32 v9, v1, 1, 1
    v_lshl_add_u32 v11, v9, 5, v11
    buffer_load_dwordx2 v[20:21], v11, s[32:35], s68 offen sc1
    buffer_load_dwordx2 v[72:73], v11, s[32:35], s69 offen sc1
    s_and_b32 s13, s18, s6
    s_ashr_i32 s15, s13, 31
    s_andn2_b32 s15, 0x7fff0000, s15
    s_or_b32 s15, s15, 0x80000000
    s_xor_b32 s13, s13, s15
    v_mov_b32 v75, s13
    v_mul_f32 v75, s7, v75
    v_exp_f32 v75, -v75
    s_nop 0
    v_add_f32 v75, 1.0, v75
    v_rcp_f32 v75, v75
    s_nop 0
    v_cvt_pk_bf16_f32 v75, 0, v75
L_NOFZ:
    s_cmp_lt_u32 s9, 28
    s_cbranch_scc1 L_HSEC
    s_branch L_GSEC
L_HSEC:
    s_cmp_lt_u32 s3, 4
    s_cbranch_scc1 L_HW
    v_bfe_u32 v25, v1, 2, 1
    v_lshlrev_b32 v25, 7, v25
    v_lshrrev_b32 v9, 5, v1
    v_lshl_add_u32 v25, v9, 4, v25
    v_add_u32 v25, 138752, v25
    v_lshrrev_b32 v26, 4, v1
    v_mul_u32_u24 v26, 7168, v26
    v_and_b32 v9, 7, v1
    v_lshl_add_u32 v26, v9, 4, v26
    v_and_b32 v27, 1, v1
    v_lshlrev_b32 v27, 18, v27
    v_bfe_u32 v9, v1, 1, 1
    v_lshl_add_u32 v27, v9, 13, v27
    s_lshl3_add_u32 s96, s75, s3
    s_mul_i32 s97, s96, 28672
    s_lshl_b32 s98, s74, 7
    s_add_u32 s99, s97, s98
    s_add_u32 s84, s99, 22020096
    s_lshr_b32 s96, s9, 2
    s_and_b32 s97, s75, 1
    s_lshr_b32 s98, s3, 1
    s_lshl2_add_u32 s99, s97, s98
    s_and_b32 s97, s3, 1
    s_lshl_b32 s98, s97, 2
    s_lshl3_add_u32 s97, s99, s98
    s_lshr_b32 s99, s75, 1
    s_add_u32 s98, s97, s99
    s_lshl_b32 s97, s98, 12
    s_lshl_b32 s99, s8, 6
    s_add_u32 s98, s97, s99
    s_lshl2_add_u32 s97, s96, s98
    s_add_u32 s99, s97, 1048576
    s_add_u32 s85, s99, 3072
    s_branch L_NOH
L_HW:
    s_lshl_b32 s96, s3, 8
    s_add_u32 s13, s96, s84
    v_lshrrev_b32 v4, 4, v1
    v_lshlrev_b32 v4, 11, v4
    v_and_b32 v9, 15, v1
    v_lshl_add_u32 v4, v9, 4, v4
    s_lshl_b32 s96, s3, 5
    s_add_u32 s15, s96, 138752
    v_lshrrev_b32 v5, 5, v1
    v_lshl_add_u32 v5, v5, 7, s15
    v_bfe_u32 v9, v1, 2, 1
    v_lshl_add_u32 v5, v9, 4, v5
    v_bfe_u32 v9, v1, 1, 1
    v_lshl_add_u32 v5, v9, 3, v5
    v_bfe_u32 v9, v1, 3, 1
    v_lshl_add_u32 v5, v9, 2, v5
    v_and_b32 v9, 1, v1
    v_lshl_add_u32 v5, v9, 1, v5
    s_cmp_lg_u32 s93, 0
    s_cbranch_scc1 L_HLOC
SPOLL_54:
    s_load_dword s24, s[32:33], s13 offset:1276 glc
    s_load_dword s25, s[32:33], s13 offset:3324 glc
    s_load_dword s26, s[32:33], s13 offset:5372 glc
    s_load_dword s27, s[32:33], s13 offset:7420 glc
SCHK_55:
    s_add_u32 s5, s5, 1
    s_cmp_ge_u32 s5, 300000
    s_waitcnt lgkmcnt(0)
    s_cbranch_scc1 SDONE_56
    s_cmp_lg_u32 s24, s4
    s_cbranch_scc1 SPOLL_54
    s_cmp_lg_u32 s25, s4
    s_cbranch_scc1 SPOLL_54
    s_cmp_lg_u32 s26, s4
    s_cbranch_scc1 SPOLL_54
    s_cmp_lg_u32 s27, s4
    s_cbranch_scc1 SPOLL_54
SDONE_56:
L_HLOC:
    buffer_load_dwordx4 v[212:215], v4, s[32:35], s13 offen sc1
    buffer_load_dwordx4 v[216:219], v4, s[32:35], s13 offen offset:1024 sc1
    v_bfe_u32 v25, v1, 2, 1
    v_lshlrev_b32 v25, 7, v25
    v_lshrrev_b32 v9, 5, v1
    v_lshl_add_u32 v25, v9, 4, v25
    v_add_u32 v25, 138752, v25
    v_lshrrev_b32 v26, 4, v1
    v_mul_u32_u24 v26, 7168, v26
    v_and_b32 v9, 7, v1
    v_lshl_add_u32 v26, v9, 4, v26
    v_and_b32 v27, 1, v1
    v_lshlrev_b32 v27, 18, v27
    v_bfe_u32 v9, v1, 1, 1
    v_lshl_add_u32 v27, v9, 13, v27
    s_lshl3_add_u32 s96, s75, s3
    s_mul_i32 s97, s96, 28672
    s_lshl_b32 s98, s74, 7
    s_add_u32 s99, s97, s98
    s_add_u32 s84, s99, 22020096
    s_lshr_b32 s96, s9, 2
    s_and_b32 s97, s75, 1
    s_lshr_b32 s98, s3, 1
    s_lshl2_add_u32 s99, s97, s98
    s_and_b32 s97, s3, 1
    s_lshl_b32 s98, s97, 2
    s_lshl3_add_u32 s97, s99, s98
    s_lshr_b32 s99, s75, 1
    s_add_u32 s98, s97, s99
    s_lshl_b32 s97, s98, 12
    s_lshl_b32 s99, s8, 6
    s_add_u32 s98, s97, s99
    s_lshl2_add_u32 s97, s96, s98
    s_add_u32 s99, s97, 1048576
    s_add_u32 s85, s99, 3072
    s_waitcnt vmcnt(0)
    v_bitop3_b32 v6, v213, v215, s4 bitop3:0x7e
    v_bitop3_b32 v6, v6, v217, s4 bitop3:0xf6
    v_bitop3_b32 v6, v6, v219, s4 bitop3:0xf6
    v_cmp_ne_u32 vcc, 0, v6
    s_cbranch_vccz TOK_58
POLL_59:
    buffer_load_dwordx4 v[212:215], v4, s[32:35], s13 offen sc1
    buffer_load_dwordx4 v[216:219], v4, s[32:35], s13 offen offset:1024 sc1
    s_waitcnt vmcnt(0)
    v_bitop3_b32 v6, v213, v215, s4 bitop3:0x7e
    v_bitop3_b32 v6, v6, v217, s4 bitop3:0xf6
    v_bitop3_b32 v6, v6, v219, s4 bitop3:0xf6
    v_cmp_ne_u32 vcc, 0, v6
    s_cbranch_vccz PDONE_60
    s_add_u32 s5, s5, 1
    s_cmp_lt_u32 s5, 300000
    s_cbranch_scc1 POLL_59
PDONE_60:
TOK_58:
    v_permlane32_swap_b32 v212, v214
    v_permlane32_swap_b32 v216, v218
    v_add_f32 v212, v212, v214
    v_add_f32 v216, v216, v218
    v_mov_b32 v214, v212
    v_mov_b32 v218, v216
    s_nop 0
    v_permlane16_swap_b32 v212, v214
    v_permlane16_swap_b32 v216, v218
    v_add_f32 v212, v212, v214
    v_add_f32 v216, v216, v218
    v_cvt_pk_bf16_f32 v212, 0, v212
    v_cvt_pk_bf16_f32 v216, 0, v216
    v_mul_f32 v6, s7, v212
    v_exp_f32 v6, -v6
    s_nop 0
    v_add_f32 v6, 1.0, v6
    v_rcp_f32 v6, v6
    s_nop 0
    v_mul_f32 v212, v212, v6
    v_cvt_pk_bf16_f32 v212, 0, v212
    v_mul_f32 v212, v212, v216
    v_cvt_pk_bf16_f32 v212, v212, v212
    ds_write_b16 v5, v212
L_NOH:
    s_waitcnt vmcnt(0)
    s_waitcnt lgkmcnt(0)
    s_barrier
    ds_read_b128 v[212:215], v25
    ds_read_b64_tr_b16 v[196:197], v45
    ds_read_b64_tr_b16 v[198:199], v45 offset:1024
    ds_read_b128 v[216:219], v25 offset:32
    ds_read_b64_tr_b16 v[200:201], v45 offset:8192
    ds_read_b64_tr_b16 v[202:203], v45 offset:9216
    ds_read_b128 v[220:223], v25 offset:64
    ds_read_b64_tr_b16 v[204:205], v45 offset:16384
    ds_read_b64_tr_b16 v[206:207], v45 offset:17408
    ds_read_b128 v[224:227], v25 offset:96
    ds_read_b64_tr_b16 v[208:209], v45 offset:24576
    ds_read_b64_tr_b16 v[210:211], v45 offset:25600
    s_waitcnt lgkmcnt(9)
    v_mfma_f32_32x32x16_bf16 v[228:243], v[212:215], v[196:199], 0
    s_waitcnt lgkmcnt(6)
    v_mfma_f32_32x32x16_bf16 v[228:243], v[216:219], v[200:203], v[228:243]
    s_waitcnt lgkmcnt(3)
    v_mfma_f32_32x32x16_bf16 v[228:243], v[220:223], v[204:207], v[228:243]
    s_waitcnt lgkmcnt(0)
    v_mfma_f32_32x32x16_bf16 v[228:243], v[224:227], v[208:211], v[228:243]
    s_nop 11
    v_mov_b32_dpp v230, v228 row_ror:8 row_mask:0xf bank_mask:0xf
    v_mov_b32 v229, s4
    v_mov_b32 v231, s4
    s_mov_b32 exec_lo, 0x00ff00ff
    s_mov_b32 exec_hi, 0x00ff00ff
    buffer_store_dwordx4 v[228:231], v26, s[32:35], s84 offen sc1
    s_mov_b64 exec, 15
    buffer_store_dword v229, v27, s[32:35], s85 offen sc1
    s_mov_b64 exec, -1
    s_waitcnt lgkmcnt(0)
L_GSEC:
    s_lshl_b32 s96, s21, 7
    s_lshl4_add_u32 s13, s3, s96
    v_lshrrev_b32 v22, 3, v1
    v_lshl_add_u32 v22, v22, 0, s13
    s_lshl_b32 s96, s13, 11
    s_lshl_b32 s97, s12, 7
    s_add_u32 s15, s96, s97
    s_add_u32 s16, s15, 16384
    v_lshrrev_b32 v47, 3, v1
    v_lshlrev_b32 v47, 11, v47
    v_and_b32 v9, 7, v1
    v_lshl_add_u32 v47, v9, 4, v47
    v_cmp_ne_u32 vcc, s70, v22
    v_cmp_ne_u32 s[22:23], s71, v22
    s_nop 0
    s_and_b64 exec, vcc, s[22:23]
    buffer_store_dwordx4 v[140:143], v47, s[64:67], s15 offen sc1
    s_mov_b64 exec, -1
    v_add_u32 v22, 8, v22
    v_cmp_ne_u32 vcc, s70, v22
    v_cmp_ne_u32 s[22:23], s71, v22
    s_nop 0
    s_and_b64 exec, vcc, s[22:23]
    buffer_store_dwordx4 v[144:147], v47, s[64:67], s16 offen sc1
    s_mov_b64 exec, -1
    s_cmp_lt_u32 s9, 16
    s_cbranch_scc1 L_GF
    s_cmp_ge_u32 s9, 28
    s_cbranch_scc1 L_FIN
    s_waitcnt vmcnt(0)
    s_mov_b64 exec, 0xffff
    buffer_store_dwordx4 v[56:59], v60, s[32:35], 0 offen sc1
    s_mov_b64 exec, -1
    s_branch L_FIN
L_GF:
SPOLL_61:
    s_load_dwordx8 s[24:31], s[32:33], s92 offset:3072 glc
SCHK_62:
    s_add_u32 s5, s5, 1
    s_cmp_ge_u32 s5, 300000
    s_waitcnt lgkmcnt(0)
    s_cbranch_scc1 SDONE_63
    s_cmp_lg_u32 s24, s4
    s_cbranch_scc1 SPOLL_61
    s_cmp_lg_u32 s25, s4
    s_cbranch_scc1 SPOLL_61
    s_cmp_lg_u32 s26, s4
    s_cbranch_scc1 SPOLL_61
    s_cmp_lg_u32 s27, s4
    s_cbranch_scc1 SPOLL_61
    s_cmp_lg_u32 s28, s4
    s_cbranch_scc1 SPOLL_61
    s_cmp_lg_u32 s29, s4
    s_cbranch_scc1 SPOLL_61
    s_cmp_lg_u32 s30, s4
    s_cbranch_scc1 SPOLL_61
SDONE_63:
    s_barrier
    s_cmp_eq_u32 s3, 7
    s_cbranch_scc1 L_G7
    s_barrier
    s_mov_b64 exec, 0xffff
    buffer_store_dwordx4 v[56:59], v60, s[32:35], 0 offen sc1
    s_mov_b64 exec, -1
    s_branch L_FIN
L_G7:
    s_cmp_lg_u32 s3, 7
    s_cbranch_scc1 L_FIN
    s_add_u32 s13, s20, 4096
    buffer_load_dwordx4 v[212:215], v2, s[32:35], s20 offen sc1
    buffer_load_dwordx4 v[216:219], v2, s[32:35], s20 offen offset:1024 sc1
    buffer_load_dwordx4 v[220:223], v2, s[32:35], s20 offen offset:2048 sc1
    buffer_load_dwordx4 v[224:227], v2, s[32:35], s20 offen offset:3072 sc1
    buffer_load_dwordx4 v[148:151], v2, s[32:35], s13 offen sc1
    buffer_load_dwordx4 v[152:155], v2, s[32:35], s13 offen offset:1024 sc1
    buffer_load_dwordx4 v[156:159], v2, s[32:35], s13 offen offset:2048 sc1
    s_waitcnt vmcnt(7)
    v_bitop3_b32 v4, v21, v73, s4 bitop3:0x7e
    v_cmp_ne_u32 vcc, 0, v4
    s_cbranch_vccz TOK_65
POLL_66:
    buffer_load_dwordx2 v[20:21], v11, s[32:35], s68 offen sc1
    buffer_load_dwordx2 v[72:73], v11, s[32:35], s69 offen sc1
    s_waitcnt vmcnt(0)
    v_bitop3_b32 v4, v21, v73, s4 bitop3:0x7e
    v_cmp_ne_u32 vcc, 0, v4
    s_cbranch_vccz PDONE_67
    s_add_u32 s5, s5, 1
    s_cmp_lt_u32 s5, 300000
    s_cbranch_scc1 POLL_66
PDONE_67:
TOK_65:
    v_lshlrev_b32 v244, 16, v20
    v_and_b32 v245, s6, v20
    v_lshlrev_b32 v246, 16, v74
    v_and_b32 v247, s6, v74
    v_lshlrev_b32 v248, 16, v72
    v_and_b32 v249, s6, v72
    s_waitcnt vmcnt(0)
    v_bitop3_b32 v4, v213, v215, s4 bitop3:0x7e
    v_bitop3_b32 v4, v4, v217, s4 bitop3:0xf6
    v_bitop3_b32 v4, v4, v219, s4 bitop3:0xf6
    v_bitop3_b32 v4, v4, v221, s4 bitop3:0xf6
    v_bitop3_b32 v4, v4, v223, s4 bitop3:0xf6
    v_bitop3_b32 v4, v4, v225, s4 bitop3:0xf6
    v_bitop3_b32 v4, v4, v227, s4 bitop3:0xf6
    v_bitop3_b32 v4, v4, v149, s4 bitop3:0xf6
    v_bitop3_b32 v4, v4, v151, s4 bitop3:0xf6
    v_bitop3_b32 v4, v4, v153, s4 bitop3:0xf6
    v_bitop3_b32 v4, v4, v155, s4 bitop3:0xf6
    v_bitop3_b32 v4, v4, v157, s4 bitop3:0xf6
    v_bitop3_b32 v4, v4, v159, s4 bitop3:0xf6
    v_cmp_ne_u32 vcc, 0, v4
    s_cbranch_vccz TOK_68
POLL_69:
    buffer_load_dwordx4 v[212:215], v2, s[32:35], s20 offen sc1
    buffer_load_dwordx4 v[216:219], v2, s[32:35], s20 offen offset:1024 sc1
    buffer_load_dwordx4 v[220:223], v2, s[32:35], s20 offen offset:2048 sc1
    buffer_load_dwordx4 v[224:227], v2, s[32:35], s20 offen offset:3072 sc1
    buffer_load_dwordx4 v[148:151], v2, s[32:35], s13 offen sc1
    buffer_load_dwordx4 v[152:155], v2, s[32:35], s13 offen offset:1024 sc1
    buffer_load_dwordx4 v[156:159], v2, s[32:35], s13 offen offset:2048 sc1
    s_waitcnt vmcnt(0)
    v_bitop3_b32 v4, v213, v215, s4 bitop3:0x7e
    v_bitop3_b32 v4, v4, v217, s4 bitop3:0xf6
    v_bitop3_b32 v4, v4, v219, s4 bitop3:0xf6
    v_bitop3_b32 v4, v4, v221, s4 bitop3:0xf6
    v_bitop3_b32 v4, v4, v223, s4 bitop3:0xf6
    v_bitop3_b32 v4, v4, v225, s4 bitop3:0xf6
    v_bitop3_b32 v4, v4, v227, s4 bitop3:0xf6
    v_bitop3_b32 v4, v4, v149, s4 bitop3:0xf6
    v_bitop3_b32 v4, v4, v151, s4 bitop3:0xf6
    v_bitop3_b32 v4, v4, v153, s4 bitop3:0xf6
    v_bitop3_b32 v4, v4, v155, s4 bitop3:0xf6
    v_bitop3_b32 v4, v4, v157, s4 bitop3:0xf6
    v_bitop3_b32 v4, v4, v159, s4 bitop3:0xf6
    v_cmp_ne_u32 vcc, 0, v4
    s_cbranch_vccz PDONE_70
    s_add_u32 s5, s5, 1
    s_cmp_lt_u32 s5, 300000
    s_cbranch_scc1 POLL_69
PDONE_70:
TOK_68:
    s_barrier
    v_add_f32 v212, v212, v216
    v_add_f32 v214, v214, v218
    v_add_f32 v220, v220, v224
    v_add_f32 v222, v222, v226
    v_add_f32 v148, v148, v152
    v_add_f32 v150, v150, v154
    v_add_f32 v212, v212, v220
    v_add_f32 v214, v214, v222
    v_add_f32 v148, v148, v156
    v_add_f32 v150, v150, v158
    v_add_f32 v212, v212, v148
    v_add_f32 v214, v214, v150
    v_mov_b32 v213, v214
    v_add_f32_dpp v212, v212, v212 row_ror:8 row_mask:0xf bank_mask:0xf
    s_nop 0
    v_add_f32_dpp v213, v213, v213 row_ror:8 row_mask:0xf bank_mask:0xf
    v_mov_b32 v214, v212
    v_mov_b32 v215, v213
    s_nop 0
    v_permlane16_swap_b32 v212, v214
    v_permlane16_swap_b32 v213, v215
    v_pk_add_f32 v[212:213], v[212:213], v[214:215]
    v_mov_b32 v214, v212
    v_mov_b32 v215, v213
    s_nop 0
    v_permlane32_swap_b32 v212, v214
    v_permlane32_swap_b32 v213, v215
    v_pk_add_f32 v[212:213], v[212:213], v[214:215]
    s_nop 1
    v_mov_b32_dpp v214, v212 quad_perm:[0,2,0,2] row_mask:0xf bank_mask:0xf
    v_mov_b32_dpp v215, v212 quad_perm:[1,3,1,3] row_mask:0xf bank_mask:0xf
    v_mov_b32_dpp v212, v213 quad_perm:[0,2,0,2] row_mask:0xf bank_mask:0xf
    v_mov_b32_dpp v213, v213 quad_perm:[1,3,1,3] row_mask:0xf bank_mask:0xf
    s_mov_b32 exec_lo, 0x33333333
    v_mov_b32 v212, v214
    v_mov_b32 v213, v215
    s_mov_b32 exec_lo, -1
    v_cvt_pk_bf16_f32 v212, 0, v212
    v_cvt_pk_bf16_f32 v213, 0, v213
    v_pk_mul_f32 v[212:213], v[212:213], v[74:75] op_sel:[0,1]
    v_cvt_pk_bf16_f32 v212, 0, v212
    v_cvt_pk_bf16_f32 v213, 0, v213
    v_pk_add_f32 v[212:213], v[212:213], v[244:245]
    v_cvt_pk_bf16_f32 v212, 0, v212
    v_cvt_pk_bf16_f32 v213, 0, v213
    v_pk_mul_f32 v[212:213], v[212:213], v[246:247]
    v_cvt_pk_bf16_f32 v212, 0, v212
    v_cvt_pk_bf16_f32 v213, 0, v213
    v_pk_add_f32 v[212:213], v[212:213], v[248:249]
    v_cvt_pk_bf16_f32 v212, v212, v213
    s_mov_b64 exec, 0xff
    buffer_store_dword v212, v10, s[64:67], s82 offen sc1
    s_mov_b64 exec, -1
    s_mov_b64 exec, 0xffff
    buffer_store_dwordx4 v[56:59], v60, s[32:35], 0 offen sc1
    s_mov_b64 exec, -1
L_FIN:
L_END:
    s_endpgm
.p2align 10
.fill 768, 4, 0xbf800000
.section .rodata,"a"
.p2align 6
.amdhsa_kernel adaLN_cond__linear_kernel_hedgehog__moe_arch_mod__prompt_kernel
  .amdhsa_next_free_vgpr 256
  .amdhsa_next_free_sgpr 102
  .amdhsa_accum_offset 256
  .amdhsa_group_segment_fixed_size 0
  .amdhsa_kernarg_size 112
  .amdhsa_user_sgpr_count 2
  .amdhsa_user_sgpr_kernarg_segment_ptr 1
  .amdhsa_system_sgpr_workgroup_id_x 1
  .amdhsa_float_denorm_mode_32 3
  .amdhsa_float_denorm_mode_16_64 3
.end_amdhsa_kernel
```
